```python
import torch

def _softmax(x, axis=-1):
    return torch.softmax(x, dim=axis)
def _gelu(x):
    return torch.nn.functional.gelu(x, approximate="tanh")
def _silu(x):
    return torch.nn.functional.silu(x)
def _sigmoid(x):
    return torch.sigmoid(x)
def _layernorm(x, axis=-1, eps=1e-5):
    m = x.mean(dim=axis, keepdim=True)
    v = x.var(dim=axis, keepdim=True, unbiased=False)
    return (x - m) / torch.sqrt(v + eps)
def _scatter_add(tgt, idx, src, axis=0):
    return tgt.clone().index_add_(axis, idx, src)
def _segment_sum(src, seg, n):
    out = torch.zeros((n,) + src.shape[1:], dtype=src.dtype)
    return out.index_add_(0, seg, src)
def _pad(x, pw):
    flat = tuple(v for pair in reversed(pw) for v in pair)
    return torch.nn.functional.pad(x, flat)

kernel_name = 'interleave_layers__softmax_full_mha__glu_gated_reglu__prompt'

def setup_inputs():

    _w = (lambda a: (lambda t: t.to(torch.bfloat16) if t.is_floating_point() else t)(torch.as_tensor(a)))
    def _A_setup():
        B, S, D = 1, 2048, 640
        return {
            "x": _w((lambda *s: torch.randn(*s, dtype=torch.bfloat16) * 0.05)(B, S, D)),
            "wqkv": _w((lambda *s: torch.randn(*s, dtype=torch.bfloat16) * 0.05)(D, 3 * D)),
            "wo": _w((lambda *s: torch.randn(*s, dtype=torch.bfloat16) * 0.05)(D, D)),
        }
    _A_in = _A_setup()

    def _B_setup():
        B, S, D, F = 1, 2048, 640, 1536
        return {
            "x": _w((lambda *s: torch.randn(*s, dtype=torch.bfloat16) * 0.05)(B, S, D)),
            "W_gate": _w((lambda *s: torch.randn(*s, dtype=torch.bfloat16) * 0.8)(D, F) * (2.0 / D) ** 0.5),
            "W_up": _w((lambda *s: torch.randn(*s, dtype=torch.bfloat16) * 0.8)(D, F) * (2.0 / D) ** 0.5),
            "W_down": _w((lambda *s: torch.randn(*s, dtype=torch.bfloat16) * 0.8)(F, D) * (1.0 / F) ** 0.5),
        }
    _B_in = _B_setup()

    return {
        "A_x": _A_in["x"],
        "A_wqkv": _A_in["wqkv"],
        "A_wo": _A_in["wo"],
        "B_x": _B_in["x"],
        "B_W_gate": _B_in["W_gate"],
        "B_W_up": _B_in["W_up"],
        "B_W_down": _B_in["W_down"],
    }

def reference(A_x, A_wqkv, A_wo, B_x, B_W_gate, B_W_up, B_W_down):
    def _A_ref(x, wqkv, wo):
        B, S, D = x.shape
        H = 32; Dh = D // H
        qkv = (lambda x, *d: x.permute(*d))((x @ wqkv).reshape(B, S, 3, H, Dh), 2, 0, 3, 1, 4)
        q, k, v = qkv[0], qkv[1], qkv[2]
        scale = Dh ** -0.5
        scores = torch.einsum("bhqd,bhkd->bhqk", q, k) * scale
        p = _softmax(scores, axis=-1)
        o = torch.einsum("bhqk,bhkd->bhqd", p, v)
        return (lambda x, *d: x.permute(*d))(o, 0, 2, 1, 3).reshape(B, S, D) @ wo

    def _B_ref(x, W_gate, W_up, W_down):
        gate = torch.einsum("bsd,df->bsf", x, W_gate)
        up = torch.einsum("bsd,df->bsf", x, W_up)
        gate = gate * (lambda x, dt: x.to(dt))(gate > 0, gate.dtype)
        h = gate * up
        return torch.einsum("bsf,fd->bsd", h, W_down)

    x = A_x
    x = x + _A_ref(_layernorm(x, axis=-1), A_wqkv, A_wo)
    x = x + _B_ref(_layernorm(x, axis=-1), B_W_gate, B_W_up, B_W_down)
    x = x + _A_ref(_layernorm(x, axis=-1), A_wqkv, A_wo)
    x = x + _B_ref(_layernorm(x, axis=-1), B_W_gate, B_W_up, B_W_down)
    return x
```

```asm
; @launch grid=(256,1,1) block=(512,1,1) lds=163840
.amdgcn_target "amdgcn-amd-amdhsa--gfx950"
.text
.globl interleave_layers__softmax_full_mha__glu_gated_reglu__prompt_kernel
.p2align 8
.type interleave_layers__softmax_full_mha__glu_gated_reglu__prompt_kernel,@function
interleave_layers__softmax_full_mha__glu_gated_reglu__prompt_kernel:
s_load_dwordx16 s[16:31], s[0:1], 0
s_load_dwordx4 s[32:35], s[0:1], 64
s_cmp_ge_u32 s2, 256
s_cbranch_scc1 L_exit
s_and_b32 s4, s2, 7
s_lshr_b32 s5, s2, 3
v_lshrrev_b32 v1, 6, v0
v_and_b32 v0, 63, v0
v_readfirstlane_b32 s6, v1
s_lshl_b32 s13, s4, 5
s_add_u32 s13, s13, s5
s_mov_b32 s3, 0
s_mov_b32 s7, 0
s_mov_b32 s8, 0
s_mov_b32 s9, 0
s_lshr_b32 s60, s13, 4
s_and_b32 s61, s5, 15
s_cmp_lt_u32 s6, 4
s_cbranch_scc1 L_q1c
s_cmp_eq_u32 s61, 15
s_cbranch_scc1 L_q1c
s_sub_u32 s62, s6, 4
v_lshrrev_b32 v2, 4, v0
v_mul_u32_u24 v1, 3840, v2
v_lshlrev_b32 v7, 1, v2
v_and_b32 v3, 15, v0
v_xor_b32 v3, v3, v7
v_lshl_add_u32 v6, v3, 4, v1
v_xor_b32 v3, 8, v3
v_lshl_add_u32 v7, v3, 4, v1
s_mul_i32 s64, s62, 61440
s_lshl_b32 s66, s61, 8
s_add_u32 s64, s64, s66
s_lshl_b32 s65, s62, 12
s_lshl_b32 s63, s60, 2
s_add_u32 s63, s63, s62
s_mul_i32 s63, s63, 40960
v_lshrrev_b32 v1, 3, v0
v_mul_u32_u24 v1, 1280, v1
v_and_b32 v3, 7, v0
v_xor_b32 v3, v3, v2
v_lshl_add_u32 v4, v3, 4, v1
v_xor_b32 v3, 4, v3
v_lshl_add_u32 v5, v3, 4, v1
s_waitcnt lgkmcnt(0)
s_mov_b32 s40, s16
s_mov_b32 s41, s17
s_mov_b32 s42, 2621440
s_mov_b32 s43, 0x20000
s_mov_b32 s44, s18
s_mov_b32 s45, s19
s_mov_b32 s46, 2457600
s_mov_b32 s47, 0x20000
s_add_u32 m0, s65, 131072
s_add_u32 s66, s64, 0
buffer_load_dwordx4 v6, s[44:47], s66 offen lds
s_add_u32 m0, s65, 132096
s_add_u32 s66, s64, 15360
buffer_load_dwordx4 v6, s[44:47], s66 offen lds
s_add_u32 m0, s65, 133120
s_add_u32 s66, s64, 30720
buffer_load_dwordx4 v7, s[44:47], s66 offen lds
s_add_u32 m0, s65, 134144
s_add_u32 s66, s64, 46080
buffer_load_dwordx4 v7, s[44:47], s66 offen lds
s_add_u32 m0, s65, 0
s_add_u32 s66, s63, 0
buffer_load_dwordx4 v4, s[40:43], s66 offen lds
s_add_u32 m0, s65, 1024
s_add_u32 s66, s63, 10240
buffer_load_dwordx4 v5, s[40:43], s66 offen lds
s_add_u32 m0, s65, 2048
s_add_u32 s66, s63, 20480
buffer_load_dwordx4 v4, s[40:43], s66 offen lds
s_add_u32 m0, s65, 3072
s_add_u32 s66, s63, 30720
buffer_load_dwordx4 v5, s[40:43], s66 offen lds
s_add_u32 m0, s65, 147456
s_add_u32 s66, s64, 245760
buffer_load_dwordx4 v6, s[44:47], s66 offen lds
s_add_u32 m0, s65, 148480
s_add_u32 s66, s64, 261120
buffer_load_dwordx4 v6, s[44:47], s66 offen lds
s_add_u32 m0, s65, 149504
s_add_u32 s66, s64, 276480
buffer_load_dwordx4 v7, s[44:47], s66 offen lds
s_add_u32 m0, s65, 150528
s_add_u32 s66, s64, 291840
buffer_load_dwordx4 v7, s[44:47], s66 offen lds
s_add_u32 m0, s65, 16384
s_add_u32 s66, s63, 128
buffer_load_dwordx4 v4, s[40:43], s66 offen lds
s_add_u32 m0, s65, 17408
s_add_u32 s66, s63, 10368
buffer_load_dwordx4 v5, s[40:43], s66 offen lds
s_waitcnt vmcnt(6)
s_barrier
s_add_u32 m0, s65, 18432
s_add_u32 s66, s63, 20608
buffer_load_dwordx4 v4, s[40:43], s66 offen lds
s_add_u32 m0, s65, 19456
s_add_u32 s66, s63, 30848
buffer_load_dwordx4 v5, s[40:43], s66 offen lds
s_add_u32 m0, s65, 65536
s_add_u32 s66, s64, 491520
buffer_load_dwordx4 v6, s[44:47], s66 offen lds
s_add_u32 m0, s65, 66560
s_add_u32 s66, s64, 506880
buffer_load_dwordx4 v6, s[44:47], s66 offen lds
s_add_u32 m0, s65, 67584
s_add_u32 s66, s64, 522240
buffer_load_dwordx4 v7, s[44:47], s66 offen lds
s_add_u32 m0, s65, 68608
s_add_u32 s66, s64, 537600
buffer_load_dwordx4 v7, s[44:47], s66 offen lds
s_add_u32 m0, s65, 32768
s_add_u32 s66, s63, 256
buffer_load_dwordx4 v4, s[40:43], s66 offen lds
s_add_u32 m0, s65, 33792
s_add_u32 s66, s63, 10496
buffer_load_dwordx4 v5, s[40:43], s66 offen lds
s_mov_b32 s36, s34
s_mov_b32 s37, s35
s_mov_b32 s38, 51806208
s_mov_b32 s39, 0x20000
s_mov_b32 s48, s24
s_mov_b32 s49, s25
s_mov_b32 s50, 1966080
s_mov_b32 s51, 0x20000
s_mov_b32 s52, s26
s_mov_b32 s53, s27
s_mov_b32 s54, 1966080
s_mov_b32 s55, 0x20000
s_mov_b32 s56, s34
s_mov_b32 s57, s35
s_mov_b32 s58, 51806208
s_mov_b32 s59, 0x20000
v_bfe_u32 v8, v0, 2, 2
v_lshrrev_b32 v9, 4, v0
v_lshl_add_u32 v9, v9, 3, v8
v_lshlrev_b32 v9, 8, v9
v_and_b32 v10, 3, v0
v_lshl_add_u32 v9, v10, 3, v9
v_add_u32 v9, 65536, v9
v_bfe_u32 v10, v0, 2, 3
s_lshl_b32 s67, s62, 1
v_xor_b32 v10, s67, v10
v_lshl_add_u32 v8, v10, 5, v9
v_xor_b32 v10, 1, v10
v_lshl_add_u32 v9, v10, 5, v9
v_add_u32 v10, 49152, v8
v_add_u32 v11, 49152, v9
v_mov_b32 v12, 0x3f803f80
v_mov_b32 v13, 0x3f803f80
v_mov_b32 v14, 0x3f803f80
v_mov_b32 v15, 0x3f803f80
ds_read_b64_tr_b16 v[16:17], v10 offset:16384
ds_read_b64_tr_b16 v[18:19], v10 offset:17408
ds_read_b64_tr_b16 v[20:21], v11 offset:16384
ds_read_b64_tr_b16 v[22:23], v11 offset:17408
ds_read_b64_tr_b16 v[24:25], v10 offset:24576
ds_read_b64_tr_b16 v[26:27], v10 offset:25600
ds_read_b64_tr_b16 v[28:29], v11 offset:24576
ds_read_b64_tr_b16 v[30:31], v11 offset:25600
s_waitcnt lgkmcnt(0)
v_mfma_f32_16x16x32_bf16 v[32:35], v[12:15], v[16:19], 0
v_mfma_f32_16x16x32_bf16 v[36:39], v[12:15], v[20:23], 0
v_mfma_f32_16x16x32_bf16 v[32:35], v[12:15], v[24:27], v[32:35]
v_mfma_f32_16x16x32_bf16 v[36:39], v[12:15], v[28:31], v[36:39]
s_cmp_lg_u32 s6, 7
s_cbranch_scc1 w7_1
s_lshl_b32 s76, s13, 5
s_add_u32 s76, s76, 51798016
s_lshl_b32 s77, s13, 7
s_add_u32 s77, s77, 22282240
s_add_u32 s78, s77, 22315008
v_lshlrev_b32 v236, 2, v0
v_mov_b32 v237, 0
s_mov_b64 exec, 0xff
buffer_store_dword v237, v236, s[36:39], s76 offen sc1
s_mov_b64 exec, 0x7ff
buffer_store_dword v237, v236, s[36:39], s77 offen sc1
buffer_store_dword v237, v236, s[36:39], s78 offen sc1
s_mov_b64 exec, -1
v_mov_b32 v82, 0
global_load_dword v81, v82, s[32:33] sc1
w7_1:
s_waitcnt vmcnt(10)
s_cmp_eq_u32 s6, 7
s_cbranch_scc1 w7_2
s_waitcnt vmcnt(6)
w7_2:
s_barrier
s_add_u32 m0, s65, 34816
s_add_u32 s66, s63, 20736
buffer_load_dwordx4 v4, s[40:43], s66 offen lds
s_add_u32 m0, s65, 35840
s_add_u32 s66, s63, 30976
buffer_load_dwordx4 v5, s[40:43], s66 offen lds
s_add_u32 m0, s65, 81920
s_add_u32 s66, s64, 737280
buffer_load_dwordx4 v6, s[44:47], s66 offen lds
s_add_u32 m0, s65, 82944
s_add_u32 s66, s64, 752640
buffer_load_dwordx4 v6, s[44:47], s66 offen lds
s_add_u32 m0, s65, 83968
s_add_u32 s66, s64, 768000
buffer_load_dwordx4 v7, s[44:47], s66 offen lds
s_add_u32 m0, s65, 84992
s_add_u32 s66, s64, 783360
buffer_load_dwordx4 v7, s[44:47], s66 offen lds
s_add_u32 m0, s65, 49152
s_add_u32 s66, s63, 384
buffer_load_dwordx4 v4, s[40:43], s66 offen lds
s_add_u32 m0, s65, 50176
s_add_u32 s66, s63, 10624
buffer_load_dwordx4 v5, s[40:43], s66 offen lds
ds_read_b64_tr_b16 v[16:17], v10 offset:32768
ds_read_b64_tr_b16 v[18:19], v10 offset:33792
ds_read_b64_tr_b16 v[20:21], v11 offset:32768
ds_read_b64_tr_b16 v[22:23], v11 offset:33792
ds_read_b64_tr_b16 v[24:25], v10 offset:40960
ds_read_b64_tr_b16 v[26:27], v10 offset:41984
ds_read_b64_tr_b16 v[28:29], v11 offset:40960
ds_read_b64_tr_b16 v[30:31], v11 offset:41984
s_waitcnt lgkmcnt(0)
v_mfma_f32_16x16x32_bf16 v[32:35], v[12:15], v[16:19], v[32:35]
v_mfma_f32_16x16x32_bf16 v[36:39], v[12:15], v[20:23], v[36:39]
v_mfma_f32_16x16x32_bf16 v[32:35], v[12:15], v[24:27], v[32:35]
v_mfma_f32_16x16x32_bf16 v[36:39], v[12:15], v[28:31], v[36:39]
s_waitcnt vmcnt(6)
s_barrier
s_add_u32 m0, s65, 51200
s_add_u32 s66, s63, 20864
buffer_load_dwordx4 v4, s[40:43], s66 offen lds
s_add_u32 m0, s65, 52224
s_add_u32 s66, s63, 31104
buffer_load_dwordx4 v5, s[40:43], s66 offen lds
s_add_u32 m0, s65, 98304
s_add_u32 s66, s64, 983040
buffer_load_dwordx4 v6, s[44:47], s66 offen lds
s_add_u32 m0, s65, 99328
s_add_u32 s66, s64, 998400
buffer_load_dwordx4 v6, s[44:47], s66 offen lds
s_add_u32 m0, s65, 100352
s_add_u32 s66, s64, 1013760
buffer_load_dwordx4 v7, s[44:47], s66 offen lds
s_add_u32 m0, s65, 101376
s_add_u32 s66, s64, 1029120
buffer_load_dwordx4 v7, s[44:47], s66 offen lds
s_add_u32 m0, s65, 0
s_add_u32 s66, s63, 512
buffer_load_dwordx4 v4, s[40:43], s66 offen lds
s_add_u32 m0, s65, 1024
s_add_u32 s66, s63, 10752
buffer_load_dwordx4 v5, s[40:43], s66 offen lds
ds_read_b64_tr_b16 v[16:17], v8 offset:0
ds_read_b64_tr_b16 v[18:19], v8 offset:1024
ds_read_b64_tr_b16 v[20:21], v9 offset:0
ds_read_b64_tr_b16 v[22:23], v9 offset:1024
ds_read_b64_tr_b16 v[24:25], v8 offset:8192
ds_read_b64_tr_b16 v[26:27], v8 offset:9216
ds_read_b64_tr_b16 v[28:29], v9 offset:8192
ds_read_b64_tr_b16 v[30:31], v9 offset:9216
s_waitcnt lgkmcnt(0)
v_mfma_f32_16x16x32_bf16 v[32:35], v[12:15], v[16:19], v[32:35]
v_mfma_f32_16x16x32_bf16 v[36:39], v[12:15], v[20:23], v[36:39]
v_mfma_f32_16x16x32_bf16 v[32:35], v[12:15], v[24:27], v[32:35]
v_mfma_f32_16x16x32_bf16 v[36:39], v[12:15], v[28:31], v[36:39]
s_cmp_lg_u32 s6, 7
s_cbranch_scc1 w7_3
s_mov_b32 s80, 0
v_mov_b32 v82, 0
s_lshl_b32 s78, s13, 7
s_add_u32 s78, s78, 22282240
s_waitcnt vmcnt(16)
s_branch non_4c
non_4:
global_load_dword v81, v82, s[32:33] sc1
s_waitcnt vmcnt(0)
non_4c:
v_cmp_eq_u32 vcc, 0, v81
s_cbranch_vccz nonok_5
s_sleep 4
s_add_u32 s80, s80, 1
s_cmp_lt_u32 s80, 200000
s_cbranch_scc1 non_4
s_mov_b32 s9, 200000
nonok_5:
v_readfirstlane_b32 s8, v81
s_getreg_b32 s80, hwreg(HW_REG_XCC_ID, 0, 4)
v_add_u32 v81, s80, v81
s_mov_b64 exec, 1
buffer_store_dword v81, v82, s[36:39], s78 offen offset:32 sc1
s_mov_b64 exec, -1
s_waitcnt lgkmcnt(0)
w7_3:
s_waitcnt vmcnt(7)
s_cmp_eq_u32 s6, 7
s_cbranch_scc1 w7_6
s_waitcnt vmcnt(6)
w7_6:
s_barrier
s_add_u32 m0, s65, 2048
s_add_u32 s66, s63, 20992
buffer_load_dwordx4 v4, s[40:43], s66 offen lds
s_add_u32 m0, s65, 3072
s_add_u32 s66, s63, 31232
buffer_load_dwordx4 v5, s[40:43], s66 offen lds
s_add_u32 m0, s65, 114688
s_add_u32 s66, s64, 1228800
buffer_load_dwordx4 v6, s[44:47], s66 offen lds
s_add_u32 m0, s65, 115712
s_add_u32 s66, s64, 1244160
buffer_load_dwordx4 v6, s[44:47], s66 offen lds
s_add_u32 m0, s65, 116736
s_add_u32 s66, s64, 1259520
buffer_load_dwordx4 v7, s[44:47], s66 offen lds
s_add_u32 m0, s65, 117760
s_add_u32 s66, s64, 1274880
buffer_load_dwordx4 v7, s[44:47], s66 offen lds
s_add_u32 m0, s65, 16384
s_add_u32 s66, s63, 640
buffer_load_dwordx4 v4, s[40:43], s66 offen lds
s_add_u32 m0, s65, 17408
s_add_u32 s66, s63, 10880
buffer_load_dwordx4 v5, s[40:43], s66 offen lds
ds_read_b64_tr_b16 v[16:17], v8 offset:16384
ds_read_b64_tr_b16 v[18:19], v8 offset:17408
ds_read_b64_tr_b16 v[20:21], v9 offset:16384
ds_read_b64_tr_b16 v[22:23], v9 offset:17408
ds_read_b64_tr_b16 v[24:25], v8 offset:24576
ds_read_b64_tr_b16 v[26:27], v8 offset:25600
ds_read_b64_tr_b16 v[28:29], v9 offset:24576
ds_read_b64_tr_b16 v[30:31], v9 offset:25600
s_waitcnt lgkmcnt(0)
v_mfma_f32_16x16x32_bf16 v[32:35], v[12:15], v[16:19], v[32:35]
v_mfma_f32_16x16x32_bf16 v[36:39], v[12:15], v[20:23], v[36:39]
v_mfma_f32_16x16x32_bf16 v[32:35], v[12:15], v[24:27], v[32:35]
v_mfma_f32_16x16x32_bf16 v[36:39], v[12:15], v[28:31], v[36:39]
s_waitcnt vmcnt(6)
s_barrier
s_add_u32 m0, s65, 18432
s_add_u32 s66, s63, 21120
buffer_load_dwordx4 v4, s[40:43], s66 offen lds
s_add_u32 m0, s65, 19456
s_add_u32 s66, s63, 31360
buffer_load_dwordx4 v5, s[40:43], s66 offen lds
s_add_u32 m0, s65, 131072
s_add_u32 s66, s64, 1474560
buffer_load_dwordx4 v6, s[44:47], s66 offen lds
s_add_u32 m0, s65, 132096
s_add_u32 s66, s64, 1489920
buffer_load_dwordx4 v6, s[44:47], s66 offen lds
s_add_u32 m0, s65, 133120
s_add_u32 s66, s64, 1505280
buffer_load_dwordx4 v7, s[44:47], s66 offen lds
s_add_u32 m0, s65, 134144
s_add_u32 s66, s64, 1520640
buffer_load_dwordx4 v7, s[44:47], s66 offen lds
s_add_u32 m0, s65, 32768
s_add_u32 s66, s63, 768
buffer_load_dwordx4 v4, s[40:43], s66 offen lds
s_add_u32 m0, s65, 33792
s_add_u32 s66, s63, 11008
buffer_load_dwordx4 v5, s[40:43], s66 offen lds
ds_read_b64_tr_b16 v[16:17], v8 offset:32768
ds_read_b64_tr_b16 v[18:19], v8 offset:33792
ds_read_b64_tr_b16 v[20:21], v9 offset:32768
ds_read_b64_tr_b16 v[22:23], v9 offset:33792
ds_read_b64_tr_b16 v[24:25], v8 offset:40960
ds_read_b64_tr_b16 v[26:27], v8 offset:41984
ds_read_b64_tr_b16 v[28:29], v9 offset:40960
ds_read_b64_tr_b16 v[30:31], v9 offset:41984
s_waitcnt lgkmcnt(0)
v_mfma_f32_16x16x32_bf16 v[32:35], v[12:15], v[16:19], v[32:35]
v_mfma_f32_16x16x32_bf16 v[36:39], v[12:15], v[20:23], v[36:39]
v_mfma_f32_16x16x32_bf16 v[32:35], v[12:15], v[24:27], v[32:35]
v_mfma_f32_16x16x32_bf16 v[36:39], v[12:15], v[28:31], v[36:39]
s_waitcnt vmcnt(6)
s_barrier
s_add_u32 m0, s65, 34816
s_add_u32 s66, s63, 21248
buffer_load_dwordx4 v4, s[40:43], s66 offen lds
s_add_u32 m0, s65, 35840
s_add_u32 s66, s63, 31488
buffer_load_dwordx4 v5, s[40:43], s66 offen lds
s_add_u32 m0, s65, 147456
s_add_u32 s66, s64, 1720320
buffer_load_dwordx4 v6, s[44:47], s66 offen lds
s_add_u32 m0, s65, 148480
s_add_u32 s66, s64, 1735680
buffer_load_dwordx4 v6, s[44:47], s66 offen lds
s_add_u32 m0, s65, 149504
s_add_u32 s66, s64, 1751040
buffer_load_dwordx4 v7, s[44:47], s66 offen lds
s_add_u32 m0, s65, 150528
s_add_u32 s66, s64, 1766400
buffer_load_dwordx4 v7, s[44:47], s66 offen lds
s_add_u32 m0, s65, 49152
s_add_u32 s66, s63, 896
buffer_load_dwordx4 v4, s[40:43], s66 offen lds
s_add_u32 m0, s65, 50176
s_add_u32 s66, s63, 11136
buffer_load_dwordx4 v5, s[40:43], s66 offen lds
ds_read_b64_tr_b16 v[16:17], v10 offset:0
ds_read_b64_tr_b16 v[18:19], v10 offset:1024
ds_read_b64_tr_b16 v[20:21], v11 offset:0
ds_read_b64_tr_b16 v[22:23], v11 offset:1024
ds_read_b64_tr_b16 v[24:25], v10 offset:8192
ds_read_b64_tr_b16 v[26:27], v10 offset:9216
ds_read_b64_tr_b16 v[28:29], v11 offset:8192
ds_read_b64_tr_b16 v[30:31], v11 offset:9216
s_waitcnt lgkmcnt(0)
v_mfma_f32_16x16x32_bf16 v[32:35], v[12:15], v[16:19], v[32:35]
v_mfma_f32_16x16x32_bf16 v[36:39], v[12:15], v[20:23], v[36:39]
v_mfma_f32_16x16x32_bf16 v[32:35], v[12:15], v[24:27], v[32:35]
v_mfma_f32_16x16x32_bf16 v[36:39], v[12:15], v[28:31], v[36:39]
s_waitcnt vmcnt(6)
s_barrier
s_add_u32 m0, s65, 51200
s_add_u32 s66, s63, 21376
buffer_load_dwordx4 v4, s[40:43], s66 offen lds
s_add_u32 m0, s65, 52224
s_add_u32 s66, s63, 31616
buffer_load_dwordx4 v5, s[40:43], s66 offen lds
s_add_u32 m0, s65, 65536
s_add_u32 s66, s64, 1966080
buffer_load_dwordx4 v6, s[44:47], s66 offen lds
s_add_u32 m0, s65, 66560
s_add_u32 s66, s64, 1981440
buffer_load_dwordx4 v6, s[44:47], s66 offen lds
s_add_u32 m0, s65, 67584
s_add_u32 s66, s64, 1996800
buffer_load_dwordx4 v7, s[44:47], s66 offen lds
s_add_u32 m0, s65, 68608
s_add_u32 s66, s64, 2012160
buffer_load_dwordx4 v7, s[44:47], s66 offen lds
s_add_u32 m0, s65, 0
s_add_u32 s66, s63, 1024
buffer_load_dwordx4 v4, s[40:43], s66 offen lds
s_add_u32 m0, s65, 1024
s_add_u32 s66, s63, 11264
buffer_load_dwordx4 v5, s[40:43], s66 offen lds
ds_read_b64_tr_b16 v[16:17], v10 offset:16384
ds_read_b64_tr_b16 v[18:19], v10 offset:17408
ds_read_b64_tr_b16 v[20:21], v11 offset:16384
ds_read_b64_tr_b16 v[22:23], v11 offset:17408
ds_read_b64_tr_b16 v[24:25], v10 offset:24576
ds_read_b64_tr_b16 v[26:27], v10 offset:25600
ds_read_b64_tr_b16 v[28:29], v11 offset:24576
ds_read_b64_tr_b16 v[30:31], v11 offset:25600
s_waitcnt lgkmcnt(0)
v_mfma_f32_16x16x32_bf16 v[32:35], v[12:15], v[16:19], v[32:35]
v_mfma_f32_16x16x32_bf16 v[36:39], v[12:15], v[20:23], v[36:39]
v_mfma_f32_16x16x32_bf16 v[32:35], v[12:15], v[24:27], v[32:35]
v_mfma_f32_16x16x32_bf16 v[36:39], v[12:15], v[28:31], v[36:39]
s_cmp_lg_u32 s6, 7
s_cbranch_scc1 w7_7
v_and_b32 v80, 31, v0
v_lshlrev_b32 v80, 7, v80
s_lshl_b32 s80, s4, 12
s_add_u32 s80, s80, 22282272
buffer_load_dword v81, v80, s[36:39], s80 offen sc1
w7_7:
s_waitcnt vmcnt(7)
s_cmp_eq_u32 s6, 7
s_cbranch_scc1 w7_8
s_waitcnt vmcnt(6)
w7_8:
s_barrier
s_add_u32 m0, s65, 2048
s_add_u32 s66, s63, 21504
buffer_load_dwordx4 v4, s[40:43], s66 offen lds
s_add_u32 m0, s65, 3072
s_add_u32 s66, s63, 31744
buffer_load_dwordx4 v5, s[40:43], s66 offen lds
s_add_u32 m0, s65, 81920
s_add_u32 s66, s64, 2211840
buffer_load_dwordx4 v6, s[44:47], s66 offen lds
s_add_u32 m0, s65, 82944
s_add_u32 s66, s64, 2227200
buffer_load_dwordx4 v6, s[44:47], s66 offen lds
s_add_u32 m0, s65, 83968
s_add_u32 s66, s64, 2242560
buffer_load_dwordx4 v7, s[44:47], s66 offen lds
s_add_u32 m0, s65, 84992
s_add_u32 s66, s64, 2257920
buffer_load_dwordx4 v7, s[44:47], s66 offen lds
s_add_u32 m0, s65, 16384
s_add_u32 s66, s63, 1152
buffer_load_dwordx4 v4, s[40:43], s66 offen lds
s_add_u32 m0, s65, 17408
s_add_u32 s66, s63, 11392
buffer_load_dwordx4 v5, s[40:43], s66 offen lds
ds_read_b64_tr_b16 v[16:17], v10 offset:32768
ds_read_b64_tr_b16 v[18:19], v10 offset:33792
ds_read_b64_tr_b16 v[20:21], v11 offset:32768
ds_read_b64_tr_b16 v[22:23], v11 offset:33792
ds_read_b64_tr_b16 v[24:25], v10 offset:40960
ds_read_b64_tr_b16 v[26:27], v10 offset:41984
ds_read_b64_tr_b16 v[28:29], v11 offset:40960
ds_read_b64_tr_b16 v[30:31], v11 offset:41984
s_waitcnt lgkmcnt(0)
v_mfma_f32_16x16x32_bf16 v[32:35], v[12:15], v[16:19], v[32:35]
v_mfma_f32_16x16x32_bf16 v[36:39], v[12:15], v[20:23], v[36:39]
v_mfma_f32_16x16x32_bf16 v[32:35], v[12:15], v[24:27], v[32:35]
v_mfma_f32_16x16x32_bf16 v[36:39], v[12:15], v[28:31], v[36:39]
s_cmp_lg_u32 s6, 7
s_cbranch_scc1 w7_9
v_and_b32 v80, 31, v0
v_lshlrev_b32 v80, 7, v80
s_lshl_b32 s80, s4, 12
s_add_u32 s80, s80, 22282272
s_mov_b32 s82, s9
s_waitcnt vmcnt(8)
s_branch poll_10c
poll_10:
buffer_load_dword v81, v80, s[36:39], s80 offen sc1
s_waitcnt vmcnt(0)
poll_10c:
v_subrev_u32 v81, s8, v81
v_cmp_lt_u32 vcc, 15, v81
s_cbranch_vccz pollok_11
s_sleep 4
s_add_u32 s82, s82, 1
s_cmp_lt_u32 s82, 200000
s_cbranch_scc1 poll_10
s_mov_b32 s9, 200000
pollok_11:
s_getreg_b32 s80, hwreg(HW_REG_XCC_ID, 0, 4)
v_cmp_ne_u32 vcc, s80, v81
s_cmp_eq_u64 vcc, 0
s_cselect_b32 s80, 1, 0
v_mov_b32 v80, 100352
v_mov_b32 v81, s80
ds_write_b32 v80, v81 offset:4
v_mov_b32 v81, s8
ds_write_b32 v80, v81
s_waitcnt lgkmcnt(0)
s_lshl_b32 s67, s60, 13
s_add_u32 s67, s67, 44466176
s_add_u32 s73, s67, 4096
v_lshlrev_b32 v82, 4, v0
buffer_load_dwordx4 v[96:99], v82, s[36:39], s67 offen offset:0 sc1
buffer_load_dwordx4 v[100:103], v82, s[36:39], s67 offen offset:1024 sc1
buffer_load_dwordx4 v[104:107], v82, s[36:39], s67 offen offset:2048 sc1
buffer_load_dwordx4 v[108:111], v82, s[36:39], s67 offen offset:3072 sc1
buffer_load_dwordx4 v[112:115], v82, s[36:39], s73 offen offset:0 sc1
buffer_load_dwordx4 v[116:119], v82, s[36:39], s73 offen offset:1024 sc1
buffer_load_dwordx4 v[120:123], v82, s[36:39], s73 offen offset:2048 sc1
buffer_load_dwordx4 v[124:127], v82, s[36:39], s73 offen offset:3072 sc1
w7_9:
s_waitcnt vmcnt(14)
s_cmp_eq_u32 s6, 7
s_cbranch_scc1 w7_12
s_waitcnt vmcnt(6)
w7_12:
s_barrier
s_add_u32 m0, s65, 18432
s_add_u32 s66, s63, 21632
buffer_load_dwordx4 v4, s[40:43], s66 offen lds
s_add_u32 m0, s65, 19456
s_add_u32 s66, s63, 31872
buffer_load_dwordx4 v5, s[40:43], s66 offen lds
ds_read_b64_tr_b16 v[16:17], v8 offset:0
ds_read_b64_tr_b16 v[18:19], v8 offset:1024
ds_read_b64_tr_b16 v[20:21], v9 offset:0
ds_read_b64_tr_b16 v[22:23], v9 offset:1024
ds_read_b64_tr_b16 v[24:25], v8 offset:8192
ds_read_b64_tr_b16 v[26:27], v8 offset:9216
ds_read_b64_tr_b16 v[28:29], v9 offset:8192
ds_read_b64_tr_b16 v[30:31], v9 offset:9216
s_waitcnt lgkmcnt(0)
v_mfma_f32_16x16x32_bf16 v[32:35], v[12:15], v[16:19], v[32:35]
v_mfma_f32_16x16x32_bf16 v[36:39], v[12:15], v[20:23], v[36:39]
v_mfma_f32_16x16x32_bf16 v[32:35], v[12:15], v[24:27], v[32:35]
v_mfma_f32_16x16x32_bf16 v[36:39], v[12:15], v[28:31], v[36:39]
s_cmp_lg_u32 s6, 7
s_cbranch_scc1 w7_13
s_waitcnt vmcnt(2)
v_lshlrev_b32 v82, 2, v0
v_add_u32 v82, 98304, v82
v_add_f32 v96, v96, v98
v_add_f32 v97, v97, v99
v_add_f32 v96, v96, v100
v_add_f32 v97, v97, v101
v_add_f32 v96, v96, v102
v_add_f32 v97, v97, v103
v_add_f32 v96, v96, v104
v_add_f32 v97, v97, v105
v_add_f32 v96, v96, v106
v_add_f32 v97, v97, v107
v_add_f32 v96, v96, v108
v_add_f32 v97, v97, v109
v_add_f32 v96, v96, v110
v_add_f32 v97, v97, v111
v_mul_f32 v84, 0x3acccccd, v96
v_mul_f32 v97, 0x3acccccd, v97
v_fma_f32 v97, -v84, v84, v97
v_max_f32 v97, 0, v97
v_add_f32 v97, 0x3727c5ac, v97
v_rsq_f32 v85, v97
s_nop 0
ds_write_b32 v82, v84 offset:0
ds_write_b32 v82, v85 offset:512
v_add_f32 v112, v112, v114
v_add_f32 v113, v113, v115
v_add_f32 v112, v112, v116
v_add_f32 v113, v113, v117
v_add_f32 v112, v112, v118
v_add_f32 v113, v113, v119
v_add_f32 v112, v112, v120
v_add_f32 v113, v113, v121
v_add_f32 v112, v112, v122
v_add_f32 v113, v113, v123
v_add_f32 v112, v112, v124
v_add_f32 v113, v113, v125
v_add_f32 v112, v112, v126
v_add_f32 v113, v113, v127
v_mul_f32 v84, 0x3acccccd, v112
v_mul_f32 v113, 0x3acccccd, v113
v_fma_f32 v113, -v84, v84, v113
v_max_f32 v113, 0, v113
v_add_f32 v113, 0x3727c5ac, v113
v_rsq_f32 v85, v113
s_nop 0
ds_write_b32 v82, v84 offset:256
ds_write_b32 v82, v85 offset:768
s_waitcnt lgkmcnt(0)
w7_13:
s_waitcnt vmcnt(0)
s_barrier
ds_read_b64_tr_b16 v[16:17], v8 offset:16384
ds_read_b64_tr_b16 v[18:19], v8 offset:17408
ds_read_b64_tr_b16 v[20:21], v9 offset:16384
ds_read_b64_tr_b16 v[22:23], v9 offset:17408
ds_read_b64_tr_b16 v[24:25], v8 offset:24576
ds_read_b64_tr_b16 v[26:27], v8 offset:25600
ds_read_b64_tr_b16 v[28:29], v9 offset:24576
ds_read_b64_tr_b16 v[30:31], v9 offset:25600
s_waitcnt lgkmcnt(0)
v_mfma_f32_16x16x32_bf16 v[32:35], v[12:15], v[16:19], v[32:35]
v_mfma_f32_16x16x32_bf16 v[36:39], v[12:15], v[20:23], v[36:39]
v_mfma_f32_16x16x32_bf16 v[32:35], v[12:15], v[24:27], v[32:35]
v_mfma_f32_16x16x32_bf16 v[36:39], v[12:15], v[28:31], v[36:39]
v_and_b32 v1, 15, v0
v_lshlrev_b32 v1, 2, v1
s_lshl_b32 s66, s62, 7
v_add_u32 v1, s66, v1
v_add_u32 v2, 100416, v1
s_lshl_b32 s66, s13, 9
s_add_u32 s66, s66, 51666944
s_setprio 0
s_nop 3
ds_write_b32 v2, v32
ds_write_b32 v2, v36 offset:64
buffer_store_dword v32, v1, s[36:39], s66 offen
buffer_store_dword v36, v1, s[36:39], s66 offen offset:64
s_waitcnt lgkmcnt(0)
s_barrier
v_mov_b32 v1, 100352
ds_read_b64 v[2:3], v1
s_waitcnt lgkmcnt(0)
v_readfirstlane_b32 s8, v2
v_readfirstlane_b32 s98, v3
s_branch L_q1done
L_q1c:
s_waitcnt lgkmcnt(0)
s_mov_b32 s40, s16
s_mov_b32 s41, s17
s_mov_b32 s42, 2621440
s_mov_b32 s43, 0x20000
s_mov_b32 s44, s18
s_mov_b32 s45, s19
s_mov_b32 s46, 2457600
s_mov_b32 s47, 0x20000
s_cmp_gt_u32 s6, 3
s_cbranch_scc1 L_npf
s_lshl_b32 s68, s13, 2
s_add_u32 s68, s68, s6
s_mul_i32 s68, s68, 2560
v_lshrrev_b32 v1, 5, v0
v_mul_u32_u24 v1, 1280, v1
v_and_b32 v2, 31, v0
v_lshl_add_u32 v1, v2, 4, v1
v_mov_b64 v[228:229], 0
v_mov_b64 v[230:231], 0
buffer_load_dwordx4 v[220:223], v1, s[40:43], s68 offen
buffer_load_dwordx4 v[224:227], v1, s[40:43], s68 offen offset:512
s_mov_b32 exec_lo, 0xffff
s_mov_b32 exec_hi, 0xffff
buffer_load_dwordx4 v[228:231], v1, s[40:43], s68 offen offset:1024
s_mov_b64 exec, -1
L_npf:
s_mov_b32 s36, s34
s_mov_b32 s37, s35
s_mov_b32 s38, 51806208
s_mov_b32 s39, 0x20000
s_mov_b32 s48, s24
s_mov_b32 s49, s25
s_mov_b32 s50, 1966080
s_mov_b32 s51, 0x20000
s_mov_b32 s52, s26
s_mov_b32 s53, s27
s_mov_b32 s54, 1966080
s_mov_b32 s55, 0x20000
s_mov_b32 s56, s34
s_mov_b32 s57, s35
s_mov_b32 s58, 51806208
s_mov_b32 s59, 0x20000
s_cmp_eq_u32 s61, 15
s_cbranch_scc1 L_q1idle
s_mul_i32 s62, s61, 52
s_lshr_b32 s62, s62, 8
s_mul_i32 s63, s62, 5
s_sub_u32 s63, s61, s63
s_lshl_b32 s63, s63, 7
s_and_b32 s65, s6, 1
s_lshr_b32 s66, s6, 1
v_lshrrev_b32 v14, 4, v0
v_and_b32 v15, 15, v0
s_lshl_b32 s75, s13, 9
s_lshl_b32 s67, s66, 8
s_add_u32 s75, s75, s67
s_add_u32 s75, s75, 51666944
v_lshlrev_b32 v210, 4, v14
v_lshlrev_b32 v211, 2, v15
s_lshl_b32 s67, s65, 13
v_lshlrev_b32 v1, 7, v15
v_add_u32 v1, s67, v1
v_bfe_u32 v12, v0, 1, 3
v_xor_b32 v12, v12, v14
v_lshl_add_u32 v2, v12, 4, v1
v_xor_b32 v12, 4, v12
v_lshl_add_u32 v3, v12, 4, v1
v_bfe_u32 v12, v0, 2, 2
v_lshl_add_u32 v13, v14, 3, v12
v_lshlrev_b32 v13, 8, v13
v_and_b32 v1, 3, v0
v_lshl_add_u32 v13, v1, 3, v13
v_add_u32 v13, 65536, v13
v_bfe_u32 v12, v0, 2, 3
s_lshl_b32 s67, s66, 2
v_xor_b32 v12, s67, v12
v_xor_b32 v1, 0, v12
v_lshl_add_u32 v4, v1, 5, v13
v_add_u32 v8, 49152, v4
v_xor_b32 v1, 1, v12
v_lshl_add_u32 v5, v1, 5, v13
v_add_u32 v9, 49152, v5
v_xor_b32 v1, 2, v12
v_lshl_add_u32 v6, v1, 5, v13
v_add_u32 v10, 49152, v6
v_xor_b32 v1, 3, v12
v_lshl_add_u32 v7, v1, 5, v13
v_add_u32 v11, 49152, v7
s_cmp_eq_u32 s62, 2
s_cbranch_scc1 qkv_v_14
s_mul_i32 s72, s62, 2621440
s_lshl_b32 s68, s60, 2
s_lshl_b32 s67, s65, 1
s_add_u32 s68, s68, s67
s_mul_i32 s68, s68, 1280
s_add_u32 s72, s72, s68
s_add_u32 s72, s72, 0
s_lshr_b32 s68, s63, 3
s_lshl_b32 s67, s66, 3
s_add_u32 s68, s68, s67
v_lshrrev_b32 v80, 5, v0
v_add_u32 v80, s68, v80
v_and_b32 v87, 31, v0
s_mov_b32 s73, 81920
v_mov_b32 v86, 0x7fffffff
s_mov_b32 s71, 0
s_add_u32 s96, s72, 1280
s_add_u32 s74, s72, s73
s_add_u32 s97, s96, s73
v_add_u32 v81, 0, v80
v_mul_u32_u24 v82, 205, v81
v_lshrrev_b32 v82, 10, v82
v_mad_i32_i24 v81, v82, -5, v81
v_cmp_lt_u32 vcc, 2, v81
v_lshlrev_b32 v82, 1, v82
v_add_u32 v83, -3, v81
v_cndmask_b32 v83, v81, v83, vcc
v_addc_co_u32 v82, vcc, 0, v82, vcc
v_lshlrev_b32 v83, 9, v83
v_lshl_add_u32 v83, v87, 4, v83
v_lshlrev_b32 v85, 3, v87
v_add_u32 v85, 1024, v85
v_cmp_eq_u32 vcc, 2, v81
v_mul_lo_u32 v84, v82, s73
s_cmp_lg_u64 vcc, 0
v_cndmask_b32 v83, v83, v86, vcc
v_cndmask_b32 v85, v86, v85, vcc
s_cselect_b32 s67, 1, 0
s_or_b32 s71, s71, s67
v_add_u32 v202, v83, v84
v_add_u32 v206, v85, v84
v_add_u32 v81, 2, v80
v_mul_u32_u24 v82, 205, v81
v_lshrrev_b32 v82, 10, v82
v_mad_i32_i24 v81, v82, -5, v81
v_cmp_lt_u32 vcc, 2, v81
v_lshlrev_b32 v82, 1, v82
v_add_u32 v83, -3, v81
v_cndmask_b32 v83, v81, v83, vcc
v_addc_co_u32 v82, vcc, 0, v82, vcc
v_lshlrev_b32 v83, 9, v83
v_lshl_add_u32 v83, v87, 4, v83
v_lshlrev_b32 v85, 3, v87
v_add_u32 v85, 1024, v85
v_cmp_eq_u32 vcc, 2, v81
v_mul_lo_u32 v84, v82, s73
s_cmp_lg_u64 vcc, 0
v_cndmask_b32 v83, v83, v86, vcc
v_cndmask_b32 v85, v86, v85, vcc
s_cselect_b32 s67, 2, 0
s_or_b32 s71, s71, s67
v_add_u32 v203, v83, v84
v_add_u32 v207, v85, v84
v_add_u32 v81, 4, v80
v_mul_u32_u24 v82, 205, v81
v_lshrrev_b32 v82, 10, v82
v_mad_i32_i24 v81, v82, -5, v81
v_cmp_lt_u32 vcc, 2, v81
v_lshlrev_b32 v82, 1, v82
v_add_u32 v83, -3, v81
v_cndmask_b32 v83, v81, v83, vcc
v_addc_co_u32 v82, vcc, 0, v82, vcc
v_lshlrev_b32 v83, 9, v83
v_lshl_add_u32 v83, v87, 4, v83
v_lshlrev_b32 v85, 3, v87
v_add_u32 v85, 1024, v85
v_cmp_eq_u32 vcc, 2, v81
v_mul_lo_u32 v84, v82, s73
s_cmp_lg_u64 vcc, 0
v_cndmask_b32 v83, v83, v86, vcc
v_cndmask_b32 v85, v86, v85, vcc
s_cselect_b32 s67, 4, 0
s_or_b32 s71, s71, s67
v_add_u32 v204, v83, v84
v_add_u32 v208, v85, v84
v_add_u32 v81, 6, v80
v_mul_u32_u24 v82, 205, v81
v_lshrrev_b32 v82, 10, v82
v_mad_i32_i24 v81, v82, -5, v81
v_cmp_lt_u32 vcc, 2, v81
v_lshlrev_b32 v82, 1, v82
v_add_u32 v83, -3, v81
v_cndmask_b32 v83, v81, v83, vcc
v_addc_co_u32 v82, vcc, 0, v82, vcc
v_lshlrev_b32 v83, 9, v83
v_lshl_add_u32 v83, v87, 4, v83
v_lshlrev_b32 v85, 3, v87
v_add_u32 v85, 1024, v85
v_cmp_eq_u32 vcc, 2, v81
v_mul_lo_u32 v84, v82, s73
s_cmp_lg_u64 vcc, 0
v_cndmask_b32 v83, v83, v86, vcc
v_cndmask_b32 v85, v86, v85, vcc
s_cselect_b32 s67, 8, 0
s_or_b32 s71, s71, s67
v_add_u32 v205, v83, v84
v_add_u32 v209, v85, v84
s_mov_b32 s76, 0xffff0000
v_mov_b64 v[232:233], 0
s_waitcnt vmcnt(0)
v_lshlrev_b32 v234, 16, v220
v_and_b32 v235, s76, v220
v_add_f32 v232, v232, v234
v_fmac_f32 v233, v234, v234
v_add_f32 v232, v232, v235
v_fmac_f32 v233, v235, v235
v_lshlrev_b32 v234, 16, v221
v_and_b32 v235, s76, v221
v_add_f32 v232, v232, v234
v_fmac_f32 v233, v234, v234
v_add_f32 v232, v232, v235
v_fmac_f32 v233, v235, v235
v_lshlrev_b32 v234, 16, v222
v_and_b32 v235, s76, v222
v_add_f32 v232, v232, v234
v_fmac_f32 v233, v234, v234
v_add_f32 v232, v232, v235
v_fmac_f32 v233, v235, v235
v_lshlrev_b32 v234, 16, v223
v_and_b32 v235, s76, v223
v_add_f32 v232, v232, v234
v_fmac_f32 v233, v234, v234
v_add_f32 v232, v232, v235
v_fmac_f32 v233, v235, v235
v_lshlrev_b32 v234, 16, v224
v_and_b32 v235, s76, v224
v_add_f32 v232, v232, v234
v_fmac_f32 v233, v234, v234
v_add_f32 v232, v232, v235
v_fmac_f32 v233, v235, v235
v_lshlrev_b32 v234, 16, v225
v_and_b32 v235, s76, v225
v_add_f32 v232, v232, v234
v_fmac_f32 v233, v234, v234
v_add_f32 v232, v232, v235
v_fmac_f32 v233, v235, v235
v_lshlrev_b32 v234, 16, v226
v_and_b32 v235, s76, v226
v_add_f32 v232, v232, v234
v_fmac_f32 v233, v234, v234
v_add_f32 v232, v232, v235
v_fmac_f32 v233, v235, v235
v_lshlrev_b32 v234, 16, v227
v_and_b32 v235, s76, v227
v_add_f32 v232, v232, v234
v_fmac_f32 v233, v234, v234
v_add_f32 v232, v232, v235
v_fmac_f32 v233, v235, v235
v_lshlrev_b32 v234, 16, v228
v_and_b32 v235, s76, v228
v_add_f32 v232, v232, v234
v_fmac_f32 v233, v234, v234
v_add_f32 v232, v232, v235
v_fmac_f32 v233, v235, v235
v_lshlrev_b32 v234, 16, v229
v_and_b32 v235, s76, v229
v_add_f32 v232, v232, v234
v_fmac_f32 v233, v234, v234
v_add_f32 v232, v232, v235
v_fmac_f32 v233, v235, v235
v_lshlrev_b32 v234, 16, v230
v_and_b32 v235, s76, v230
v_add_f32 v232, v232, v234
v_fmac_f32 v233, v234, v234
v_add_f32 v232, v232, v235
v_fmac_f32 v233, v235, v235
v_lshlrev_b32 v234, 16, v231
v_and_b32 v235, s76, v231
v_add_f32 v232, v232, v234
v_fmac_f32 v233, v234, v234
v_add_f32 v232, v232, v235
v_fmac_f32 v233, v235, v235
s_nop 1
v_add_f32_dpp v232, v232, v232 quad_perm:[1,0,3,2] row_mask:0xf bank_mask:0xf
v_add_f32_dpp v233, v233, v233 quad_perm:[1,0,3,2] row_mask:0xf bank_mask:0xf
s_nop 1
v_add_f32_dpp v232, v232, v232 quad_perm:[2,3,0,1] row_mask:0xf bank_mask:0xf
v_add_f32_dpp v233, v233, v233 quad_perm:[2,3,0,1] row_mask:0xf bank_mask:0xf
v_bfe_u32 v234, v0, 3, 2
v_lshlrev_b32 v234, 10, v234
v_bfe_u32 v235, v0, 2, 1
v_lshl_add_u32 v234, v235, 3, v234
v_lshrrev_b32 v235, 5, v0
v_lshl_add_u32 v234, v235, 4, v234
s_lshr_b32 s76, s13, 3
s_lshl_b32 s76, s76, 12
s_and_b32 s77, s13, 7
s_lshl_b32 s77, s77, 2
s_add_u32 s77, s77, s6
s_lshl_b32 s77, s77, 5
s_add_u32 s76, s76, s77
s_add_u32 s76, s76, 44466176
s_mov_b32 exec_lo, 0x11111111
s_mov_b32 exec_hi, 0x11111111
buffer_store_dwordx2 v[232:233], v234, s[36:39], s76 offen sc1
s_mov_b64 exec, -1
s_cmp_eq_u32 s62, 0
s_cselect_b32 s70, 0x3ea52b5c, 1.0
s_lshl_b32 s67, s65, 8
s_add_u32 s67, s67, 98304
v_add_u32 v13, s67, v211
s_lshl_b32 s67, s66, 8
s_add_u32 s67, s67, 100416
v_add_u32 v12, s67, v210
v_mov_b32 v1, 100352
s_barrier
ds_read_b128 v[16:19], v2 offset:0
ds_read_b128 v[20:23], v2 offset:2048
ds_read_b128 v[24:27], v2 offset:4096
ds_read_b128 v[28:31], v2 offset:6144
ds_read_b64_tr_b16 v[32:33], v8 offset:16384
ds_read_b64_tr_b16 v[34:35], v8 offset:17408
ds_read_b64_tr_b16 v[36:37], v9 offset:16384
ds_read_b64_tr_b16 v[38:39], v9 offset:17408
ds_read_b64_tr_b16 v[40:41], v10 offset:16384
ds_read_b64_tr_b16 v[42:43], v10 offset:17408
ds_read_b64_tr_b16 v[44:45], v11 offset:16384
ds_read_b64_tr_b16 v[46:47], v11 offset:17408
s_waitcnt lgkmcnt(0)
v_mfma_f32_16x16x32_bf16 v[128:131], v[32:35], v[16:19], 0
ds_read_b128 v[48:51], v3 offset:0
ds_read_b128 v[52:55], v3 offset:2048
v_mfma_f32_16x16x32_bf16 v[132:135], v[32:35], v[20:23], 0
ds_read_b128 v[56:59], v3 offset:4096
v_mfma_f32_16x16x32_bf16 v[136:139], v[32:35], v[24:27], 0
ds_read_b128 v[60:63], v3 offset:6144
v_mfma_f32_16x16x32_bf16 v[140:143], v[32:35], v[28:31], 0
ds_read_b64_tr_b16 v[64:65], v8 offset:24576
v_mfma_f32_16x16x32_bf16 v[144:147], v[36:39], v[16:19], 0
ds_read_b64_tr_b16 v[66:67], v8 offset:25600
v_mfma_f32_16x16x32_bf16 v[148:151], v[36:39], v[20:23], 0
ds_read_b64_tr_b16 v[68:69], v9 offset:24576
ds_read_b64_tr_b16 v[70:71], v9 offset:25600
v_mfma_f32_16x16x32_bf16 v[152:155], v[36:39], v[24:27], 0
ds_read_b64_tr_b16 v[72:73], v10 offset:24576
v_mfma_f32_16x16x32_bf16 v[156:159], v[36:39], v[28:31], 0
ds_read_b64_tr_b16 v[74:75], v10 offset:25600
v_mfma_f32_16x16x32_bf16 v[160:163], v[40:43], v[16:19], 0
ds_read_b64_tr_b16 v[76:77], v11 offset:24576
v_mfma_f32_16x16x32_bf16 v[164:167], v[40:43], v[20:23], 0
ds_read_b64_tr_b16 v[78:79], v11 offset:25600
v_mfma_f32_16x16x32_bf16 v[168:171], v[40:43], v[24:27], 0
v_mfma_f32_16x16x32_bf16 v[172:175], v[40:43], v[28:31], 0
v_mfma_f32_16x16x32_bf16 v[176:179], v[44:47], v[16:19], 0
v_mfma_f32_16x16x32_bf16 v[180:183], v[44:47], v[20:23], 0
v_mfma_f32_16x16x32_bf16 v[184:187], v[44:47], v[24:27], 0
s_waitcnt lgkmcnt(0)
v_mfma_f32_16x16x32_bf16 v[188:191], v[44:47], v[28:31], 0
s_barrier
v_mfma_f32_16x16x32_bf16 v[128:131], v[64:67], v[48:51], v[128:131]
ds_read_b128 v[16:19], v2 offset:16384
ds_read_b128 v[20:23], v2 offset:18432
v_mfma_f32_16x16x32_bf16 v[132:135], v[64:67], v[52:55], v[132:135]
ds_read_b128 v[24:27], v2 offset:20480
v_mfma_f32_16x16x32_bf16 v[136:139], v[64:67], v[56:59], v[136:139]
ds_read_b128 v[28:31], v2 offset:22528
v_mfma_f32_16x16x32_bf16 v[140:143], v[64:67], v[60:63], v[140:143]
ds_read_b64_tr_b16 v[32:33], v8 offset:32768
v_mfma_f32_16x16x32_bf16 v[144:147], v[68:71], v[48:51], v[144:147]
ds_read_b64_tr_b16 v[34:35], v8 offset:33792
v_mfma_f32_16x16x32_bf16 v[148:151], v[68:71], v[52:55], v[148:151]
ds_read_b64_tr_b16 v[36:37], v9 offset:32768
ds_read_b64_tr_b16 v[38:39], v9 offset:33792
v_mfma_f32_16x16x32_bf16 v[152:155], v[68:71], v[56:59], v[152:155]
ds_read_b64_tr_b16 v[40:41], v10 offset:32768
v_mfma_f32_16x16x32_bf16 v[156:159], v[68:71], v[60:63], v[156:159]
ds_read_b64_tr_b16 v[42:43], v10 offset:33792
v_mfma_f32_16x16x32_bf16 v[160:163], v[72:75], v[48:51], v[160:163]
ds_read_b64_tr_b16 v[44:45], v11 offset:32768
v_mfma_f32_16x16x32_bf16 v[164:167], v[72:75], v[52:55], v[164:167]
ds_read_b64_tr_b16 v[46:47], v11 offset:33792
v_mfma_f32_16x16x32_bf16 v[168:171], v[72:75], v[56:59], v[168:171]
v_mfma_f32_16x16x32_bf16 v[172:175], v[72:75], v[60:63], v[172:175]
v_mfma_f32_16x16x32_bf16 v[176:179], v[76:79], v[48:51], v[176:179]
v_mfma_f32_16x16x32_bf16 v[180:183], v[76:79], v[52:55], v[180:183]
v_mfma_f32_16x16x32_bf16 v[184:187], v[76:79], v[56:59], v[184:187]
v_mfma_f32_16x16x32_bf16 v[188:191], v[76:79], v[60:63], v[188:191]
s_waitcnt lgkmcnt(0)
v_mfma_f32_16x16x32_bf16 v[128:131], v[32:35], v[16:19], v[128:131]
ds_read_b128 v[48:51], v3 offset:16384
ds_read_b128 v[52:55], v3 offset:18432
v_mfma_f32_16x16x32_bf16 v[132:135], v[32:35], v[20:23], v[132:135]
ds_read_b128 v[56:59], v3 offset:20480
v_mfma_f32_16x16x32_bf16 v[136:139], v[32:35], v[24:27], v[136:139]
ds_read_b128 v[60:63], v3 offset:22528
v_mfma_f32_16x16x32_bf16 v[140:143], v[32:35], v[28:31], v[140:143]
ds_read_b64_tr_b16 v[64:65], v8 offset:40960
v_mfma_f32_16x16x32_bf16 v[144:147], v[36:39], v[16:19], v[144:147]
ds_read_b64_tr_b16 v[66:67], v8 offset:41984
v_mfma_f32_16x16x32_bf16 v[148:151], v[36:39], v[20:23], v[148:151]
ds_read_b64_tr_b16 v[68:69], v9 offset:40960
ds_read_b64_tr_b16 v[70:71], v9 offset:41984
v_mfma_f32_16x16x32_bf16 v[152:155], v[36:39], v[24:27], v[152:155]
ds_read_b64_tr_b16 v[72:73], v10 offset:40960
v_mfma_f32_16x16x32_bf16 v[156:159], v[36:39], v[28:31], v[156:159]
ds_read_b64_tr_b16 v[74:75], v10 offset:41984
v_mfma_f32_16x16x32_bf16 v[160:163], v[40:43], v[16:19], v[160:163]
ds_read_b64_tr_b16 v[76:77], v11 offset:40960
s_waitcnt vmcnt(0)
v_mfma_f32_16x16x32_bf16 v[164:167], v[40:43], v[20:23], v[164:167]
ds_read_b64_tr_b16 v[78:79], v11 offset:41984
v_mfma_f32_16x16x32_bf16 v[168:171], v[40:43], v[24:27], v[168:171]
v_mfma_f32_16x16x32_bf16 v[172:175], v[40:43], v[28:31], v[172:175]
v_mfma_f32_16x16x32_bf16 v[176:179], v[44:47], v[16:19], v[176:179]
v_mfma_f32_16x16x32_bf16 v[180:183], v[44:47], v[20:23], v[180:183]
v_mfma_f32_16x16x32_bf16 v[184:187], v[44:47], v[24:27], v[184:187]
s_waitcnt lgkmcnt(0)
v_mfma_f32_16x16x32_bf16 v[188:191], v[44:47], v[28:31], v[188:191]
s_barrier
v_mfma_f32_16x16x32_bf16 v[128:131], v[64:67], v[48:51], v[128:131]
ds_read_b128 v[16:19], v2 offset:32768
ds_read_b128 v[20:23], v2 offset:34816
v_mfma_f32_16x16x32_bf16 v[132:135], v[64:67], v[52:55], v[132:135]
ds_read_b128 v[24:27], v2 offset:36864
v_mfma_f32_16x16x32_bf16 v[136:139], v[64:67], v[56:59], v[136:139]
ds_read_b128 v[28:31], v2 offset:38912
v_mfma_f32_16x16x32_bf16 v[140:143], v[64:67], v[60:63], v[140:143]
ds_read_b64_tr_b16 v[32:33], v4 offset:0
v_mfma_f32_16x16x32_bf16 v[144:147], v[68:71], v[48:51], v[144:147]
ds_read_b64_tr_b16 v[34:35], v4 offset:1024
v_mfma_f32_16x16x32_bf16 v[148:151], v[68:71], v[52:55], v[148:151]
ds_read_b64_tr_b16 v[36:37], v5 offset:0
ds_read_b64_tr_b16 v[38:39], v5 offset:1024
v_mfma_f32_16x16x32_bf16 v[152:155], v[68:71], v[56:59], v[152:155]
ds_read_b64_tr_b16 v[40:41], v6 offset:0
v_mfma_f32_16x16x32_bf16 v[156:159], v[68:71], v[60:63], v[156:159]
ds_read_b64_tr_b16 v[42:43], v6 offset:1024
v_mfma_f32_16x16x32_bf16 v[160:163], v[72:75], v[48:51], v[160:163]
ds_read_b64_tr_b16 v[44:45], v7 offset:0
v_mfma_f32_16x16x32_bf16 v[164:167], v[72:75], v[52:55], v[164:167]
ds_read_b64_tr_b16 v[46:47], v7 offset:1024
v_mfma_f32_16x16x32_bf16 v[168:171], v[72:75], v[56:59], v[168:171]
v_mfma_f32_16x16x32_bf16 v[172:175], v[72:75], v[60:63], v[172:175]
v_mfma_f32_16x16x32_bf16 v[176:179], v[76:79], v[48:51], v[176:179]
v_mfma_f32_16x16x32_bf16 v[180:183], v[76:79], v[52:55], v[180:183]
v_mfma_f32_16x16x32_bf16 v[184:187], v[76:79], v[56:59], v[184:187]
v_mfma_f32_16x16x32_bf16 v[188:191], v[76:79], v[60:63], v[188:191]
s_waitcnt lgkmcnt(0)
v_mfma_f32_16x16x32_bf16 v[128:131], v[32:35], v[16:19], v[128:131]
ds_read_b128 v[48:51], v3 offset:32768
ds_read_b128 v[52:55], v3 offset:34816
v_mfma_f32_16x16x32_bf16 v[132:135], v[32:35], v[20:23], v[132:135]
ds_read_b128 v[56:59], v3 offset:36864
v_mfma_f32_16x16x32_bf16 v[136:139], v[32:35], v[24:27], v[136:139]
ds_read_b128 v[60:63], v3 offset:38912
v_mfma_f32_16x16x32_bf16 v[140:143], v[32:35], v[28:31], v[140:143]
ds_read_b64_tr_b16 v[64:65], v4 offset:8192
v_mfma_f32_16x16x32_bf16 v[144:147], v[36:39], v[16:19], v[144:147]
ds_read_b64_tr_b16 v[66:67], v4 offset:9216
v_mfma_f32_16x16x32_bf16 v[148:151], v[36:39], v[20:23], v[148:151]
ds_read_b64_tr_b16 v[68:69], v5 offset:8192
ds_read_b64_tr_b16 v[70:71], v5 offset:9216
v_mfma_f32_16x16x32_bf16 v[152:155], v[36:39], v[24:27], v[152:155]
ds_read_b64_tr_b16 v[72:73], v6 offset:8192
v_mfma_f32_16x16x32_bf16 v[156:159], v[36:39], v[28:31], v[156:159]
ds_read_b64_tr_b16 v[74:75], v6 offset:9216
v_mfma_f32_16x16x32_bf16 v[160:163], v[40:43], v[16:19], v[160:163]
ds_read_b64_tr_b16 v[76:77], v7 offset:8192
v_mfma_f32_16x16x32_bf16 v[164:167], v[40:43], v[20:23], v[164:167]
ds_read_b64_tr_b16 v[78:79], v7 offset:9216
v_mfma_f32_16x16x32_bf16 v[168:171], v[40:43], v[24:27], v[168:171]
v_mfma_f32_16x16x32_bf16 v[172:175], v[40:43], v[28:31], v[172:175]
v_mfma_f32_16x16x32_bf16 v[176:179], v[44:47], v[16:19], v[176:179]
v_mfma_f32_16x16x32_bf16 v[180:183], v[44:47], v[20:23], v[180:183]
v_mfma_f32_16x16x32_bf16 v[184:187], v[44:47], v[24:27], v[184:187]
s_waitcnt lgkmcnt(0)
v_mfma_f32_16x16x32_bf16 v[188:191], v[44:47], v[28:31], v[188:191]
s_barrier
v_mfma_f32_16x16x32_bf16 v[128:131], v[64:67], v[48:51], v[128:131]
ds_read_b128 v[16:19], v2 offset:49152
ds_read_b128 v[20:23], v2 offset:51200
v_mfma_f32_16x16x32_bf16 v[132:135], v[64:67], v[52:55], v[132:135]
ds_read_b128 v[24:27], v2 offset:53248
v_mfma_f32_16x16x32_bf16 v[136:139], v[64:67], v[56:59], v[136:139]
ds_read_b128 v[28:31], v2 offset:55296
v_mfma_f32_16x16x32_bf16 v[140:143], v[64:67], v[60:63], v[140:143]
ds_read_b64_tr_b16 v[32:33], v4 offset:16384
v_mfma_f32_16x16x32_bf16 v[144:147], v[68:71], v[48:51], v[144:147]
ds_read_b64_tr_b16 v[34:35], v4 offset:17408
v_mfma_f32_16x16x32_bf16 v[148:151], v[68:71], v[52:55], v[148:151]
ds_read_b64_tr_b16 v[36:37], v5 offset:16384
ds_read_b64_tr_b16 v[38:39], v5 offset:17408
v_mfma_f32_16x16x32_bf16 v[152:155], v[68:71], v[56:59], v[152:155]
ds_read_b64_tr_b16 v[40:41], v6 offset:16384
v_mfma_f32_16x16x32_bf16 v[156:159], v[68:71], v[60:63], v[156:159]
ds_read_b64_tr_b16 v[42:43], v6 offset:17408
v_mfma_f32_16x16x32_bf16 v[160:163], v[72:75], v[48:51], v[160:163]
ds_read_b64_tr_b16 v[44:45], v7 offset:16384
v_mfma_f32_16x16x32_bf16 v[164:167], v[72:75], v[52:55], v[164:167]
ds_read_b64_tr_b16 v[46:47], v7 offset:17408
v_mfma_f32_16x16x32_bf16 v[168:171], v[72:75], v[56:59], v[168:171]
v_mfma_f32_16x16x32_bf16 v[172:175], v[72:75], v[60:63], v[172:175]
v_mfma_f32_16x16x32_bf16 v[176:179], v[76:79], v[48:51], v[176:179]
v_mfma_f32_16x16x32_bf16 v[180:183], v[76:79], v[52:55], v[180:183]
v_mfma_f32_16x16x32_bf16 v[184:187], v[76:79], v[56:59], v[184:187]
v_mfma_f32_16x16x32_bf16 v[188:191], v[76:79], v[60:63], v[188:191]
s_waitcnt lgkmcnt(0)
v_mfma_f32_16x16x32_bf16 v[128:131], v[32:35], v[16:19], v[128:131]
ds_read_b128 v[48:51], v3 offset:49152
ds_read_b128 v[52:55], v3 offset:51200
v_mfma_f32_16x16x32_bf16 v[132:135], v[32:35], v[20:23], v[132:135]
ds_read_b128 v[56:59], v3 offset:53248
v_mfma_f32_16x16x32_bf16 v[136:139], v[32:35], v[24:27], v[136:139]
ds_read_b128 v[60:63], v3 offset:55296
v_mfma_f32_16x16x32_bf16 v[140:143], v[32:35], v[28:31], v[140:143]
ds_read_b64_tr_b16 v[64:65], v4 offset:24576
v_mfma_f32_16x16x32_bf16 v[144:147], v[36:39], v[16:19], v[144:147]
ds_read_b64_tr_b16 v[66:67], v4 offset:25600
v_mfma_f32_16x16x32_bf16 v[148:151], v[36:39], v[20:23], v[148:151]
ds_read_b64_tr_b16 v[68:69], v5 offset:24576
ds_read_b64_tr_b16 v[70:71], v5 offset:25600
v_mfma_f32_16x16x32_bf16 v[152:155], v[36:39], v[24:27], v[152:155]
ds_read_b64_tr_b16 v[72:73], v6 offset:24576
v_mfma_f32_16x16x32_bf16 v[156:159], v[36:39], v[28:31], v[156:159]
ds_read_b64_tr_b16 v[74:75], v6 offset:25600
v_mfma_f32_16x16x32_bf16 v[160:163], v[40:43], v[16:19], v[160:163]
ds_read_b64_tr_b16 v[76:77], v7 offset:24576
v_mfma_f32_16x16x32_bf16 v[164:167], v[40:43], v[20:23], v[164:167]
ds_read_b64_tr_b16 v[78:79], v7 offset:25600
v_mfma_f32_16x16x32_bf16 v[168:171], v[40:43], v[24:27], v[168:171]
v_mfma_f32_16x16x32_bf16 v[172:175], v[40:43], v[28:31], v[172:175]
v_mfma_f32_16x16x32_bf16 v[176:179], v[44:47], v[16:19], v[176:179]
v_mfma_f32_16x16x32_bf16 v[180:183], v[44:47], v[20:23], v[180:183]
v_mfma_f32_16x16x32_bf16 v[184:187], v[44:47], v[24:27], v[184:187]
s_waitcnt lgkmcnt(0)
v_mfma_f32_16x16x32_bf16 v[188:191], v[44:47], v[28:31], v[188:191]
s_barrier
v_mfma_f32_16x16x32_bf16 v[128:131], v[64:67], v[48:51], v[128:131]
ds_read_b128 v[16:19], v2 offset:0
ds_read_b128 v[20:23], v2 offset:2048
v_mfma_f32_16x16x32_bf16 v[132:135], v[64:67], v[52:55], v[132:135]
ds_read_b128 v[24:27], v2 offset:4096
v_mfma_f32_16x16x32_bf16 v[136:139], v[64:67], v[56:59], v[136:139]
ds_read_b128 v[28:31], v2 offset:6144
v_mfma_f32_16x16x32_bf16 v[140:143], v[64:67], v[60:63], v[140:143]
ds_read_b64_tr_b16 v[32:33], v4 offset:32768
v_mfma_f32_16x16x32_bf16 v[144:147], v[68:71], v[48:51], v[144:147]
ds_read_b64_tr_b16 v[34:35], v4 offset:33792
v_mfma_f32_16x16x32_bf16 v[148:151], v[68:71], v[52:55], v[148:151]
ds_read_b64_tr_b16 v[36:37], v5 offset:32768
ds_read_b64_tr_b16 v[38:39], v5 offset:33792
v_mfma_f32_16x16x32_bf16 v[152:155], v[68:71], v[56:59], v[152:155]
ds_read_b64_tr_b16 v[40:41], v6 offset:32768
v_mfma_f32_16x16x32_bf16 v[156:159], v[68:71], v[60:63], v[156:159]
ds_read_b64_tr_b16 v[42:43], v6 offset:33792
v_mfma_f32_16x16x32_bf16 v[160:163], v[72:75], v[48:51], v[160:163]
ds_read_b64_tr_b16 v[44:45], v7 offset:32768
v_mfma_f32_16x16x32_bf16 v[164:167], v[72:75], v[52:55], v[164:167]
ds_read_b64_tr_b16 v[46:47], v7 offset:33792
v_mfma_f32_16x16x32_bf16 v[168:171], v[72:75], v[56:59], v[168:171]
v_mfma_f32_16x16x32_bf16 v[172:175], v[72:75], v[60:63], v[172:175]
v_mfma_f32_16x16x32_bf16 v[176:179], v[76:79], v[48:51], v[176:179]
v_mfma_f32_16x16x32_bf16 v[180:183], v[76:79], v[52:55], v[180:183]
v_mfma_f32_16x16x32_bf16 v[184:187], v[76:79], v[56:59], v[184:187]
v_mfma_f32_16x16x32_bf16 v[188:191], v[76:79], v[60:63], v[188:191]
s_waitcnt lgkmcnt(0)
v_mfma_f32_16x16x32_bf16 v[128:131], v[32:35], v[16:19], v[128:131]
ds_read_b128 v[48:51], v3 offset:0
ds_read_b128 v[52:55], v3 offset:2048
v_mfma_f32_16x16x32_bf16 v[132:135], v[32:35], v[20:23], v[132:135]
ds_read_b128 v[56:59], v3 offset:4096
v_mfma_f32_16x16x32_bf16 v[136:139], v[32:35], v[24:27], v[136:139]
ds_read_b128 v[60:63], v3 offset:6144
v_mfma_f32_16x16x32_bf16 v[140:143], v[32:35], v[28:31], v[140:143]
ds_read_b64_tr_b16 v[64:65], v4 offset:40960
v_mfma_f32_16x16x32_bf16 v[144:147], v[36:39], v[16:19], v[144:147]
ds_read_b64_tr_b16 v[66:67], v4 offset:41984
v_mfma_f32_16x16x32_bf16 v[148:151], v[36:39], v[20:23], v[148:151]
ds_read_b64_tr_b16 v[68:69], v5 offset:40960
ds_read_b64_tr_b16 v[70:71], v5 offset:41984
v_mfma_f32_16x16x32_bf16 v[152:155], v[36:39], v[24:27], v[152:155]
ds_read_b64_tr_b16 v[72:73], v6 offset:40960
v_mfma_f32_16x16x32_bf16 v[156:159], v[36:39], v[28:31], v[156:159]
ds_read_b64_tr_b16 v[74:75], v6 offset:41984
v_mfma_f32_16x16x32_bf16 v[160:163], v[40:43], v[16:19], v[160:163]
ds_read_b64_tr_b16 v[76:77], v7 offset:40960
v_mfma_f32_16x16x32_bf16 v[164:167], v[40:43], v[20:23], v[164:167]
ds_read_b64_tr_b16 v[78:79], v7 offset:41984
v_mfma_f32_16x16x32_bf16 v[168:171], v[40:43], v[24:27], v[168:171]
v_mfma_f32_16x16x32_bf16 v[172:175], v[40:43], v[28:31], v[172:175]
v_mfma_f32_16x16x32_bf16 v[176:179], v[44:47], v[16:19], v[176:179]
v_mfma_f32_16x16x32_bf16 v[180:183], v[44:47], v[20:23], v[180:183]
v_mfma_f32_16x16x32_bf16 v[184:187], v[44:47], v[24:27], v[184:187]
s_waitcnt lgkmcnt(0)
v_mfma_f32_16x16x32_bf16 v[188:191], v[44:47], v[28:31], v[188:191]
s_barrier
v_mfma_f32_16x16x32_bf16 v[128:131], v[64:67], v[48:51], v[128:131]
ds_read_b128 v[16:19], v2 offset:16384
ds_read_b128 v[20:23], v2 offset:18432
v_mfma_f32_16x16x32_bf16 v[132:135], v[64:67], v[52:55], v[132:135]
ds_read_b128 v[24:27], v2 offset:20480
v_mfma_f32_16x16x32_bf16 v[136:139], v[64:67], v[56:59], v[136:139]
ds_read_b128 v[28:31], v2 offset:22528
v_mfma_f32_16x16x32_bf16 v[140:143], v[64:67], v[60:63], v[140:143]
ds_read_b64_tr_b16 v[32:33], v8 offset:0
v_mfma_f32_16x16x32_bf16 v[144:147], v[68:71], v[48:51], v[144:147]
ds_read_b64_tr_b16 v[34:35], v8 offset:1024
v_mfma_f32_16x16x32_bf16 v[148:151], v[68:71], v[52:55], v[148:151]
ds_read_b64_tr_b16 v[36:37], v9 offset:0
ds_read_b64_tr_b16 v[38:39], v9 offset:1024
v_mfma_f32_16x16x32_bf16 v[152:155], v[68:71], v[56:59], v[152:155]
ds_read_b64_tr_b16 v[40:41], v10 offset:0
v_mfma_f32_16x16x32_bf16 v[156:159], v[68:71], v[60:63], v[156:159]
ds_read_b64_tr_b16 v[42:43], v10 offset:1024
v_mfma_f32_16x16x32_bf16 v[160:163], v[72:75], v[48:51], v[160:163]
ds_read_b64_tr_b16 v[44:45], v11 offset:0
v_mfma_f32_16x16x32_bf16 v[164:167], v[72:75], v[52:55], v[164:167]
ds_read_b64_tr_b16 v[46:47], v11 offset:1024
v_mfma_f32_16x16x32_bf16 v[168:171], v[72:75], v[56:59], v[168:171]
v_mfma_f32_16x16x32_bf16 v[172:175], v[72:75], v[60:63], v[172:175]
v_mfma_f32_16x16x32_bf16 v[176:179], v[76:79], v[48:51], v[176:179]
v_mfma_f32_16x16x32_bf16 v[180:183], v[76:79], v[52:55], v[180:183]
v_mfma_f32_16x16x32_bf16 v[184:187], v[76:79], v[56:59], v[184:187]
v_mfma_f32_16x16x32_bf16 v[188:191], v[76:79], v[60:63], v[188:191]
s_waitcnt lgkmcnt(0)
v_mfma_f32_16x16x32_bf16 v[128:131], v[32:35], v[16:19], v[128:131]
ds_read_b128 v[48:51], v3 offset:16384
ds_read_b128 v[52:55], v3 offset:18432
v_mfma_f32_16x16x32_bf16 v[132:135], v[32:35], v[20:23], v[132:135]
ds_read_b128 v[56:59], v3 offset:20480
v_mfma_f32_16x16x32_bf16 v[136:139], v[32:35], v[24:27], v[136:139]
ds_read_b128 v[60:63], v3 offset:22528
v_mfma_f32_16x16x32_bf16 v[140:143], v[32:35], v[28:31], v[140:143]
ds_read_b64_tr_b16 v[64:65], v8 offset:8192
v_mfma_f32_16x16x32_bf16 v[144:147], v[36:39], v[16:19], v[144:147]
ds_read_b64_tr_b16 v[66:67], v8 offset:9216
v_mfma_f32_16x16x32_bf16 v[148:151], v[36:39], v[20:23], v[148:151]
ds_read_b64_tr_b16 v[68:69], v9 offset:8192
ds_read_b64_tr_b16 v[70:71], v9 offset:9216
v_mfma_f32_16x16x32_bf16 v[152:155], v[36:39], v[24:27], v[152:155]
ds_read_b64_tr_b16 v[72:73], v10 offset:8192
v_mfma_f32_16x16x32_bf16 v[156:159], v[36:39], v[28:31], v[156:159]
ds_read_b64_tr_b16 v[74:75], v10 offset:9216
v_mfma_f32_16x16x32_bf16 v[160:163], v[40:43], v[16:19], v[160:163]
ds_read_b64_tr_b16 v[76:77], v11 offset:8192
v_mfma_f32_16x16x32_bf16 v[164:167], v[40:43], v[20:23], v[164:167]
ds_read_b64_tr_b16 v[78:79], v11 offset:9216
v_mfma_f32_16x16x32_bf16 v[168:171], v[40:43], v[24:27], v[168:171]
v_mfma_f32_16x16x32_bf16 v[172:175], v[40:43], v[28:31], v[172:175]
v_mfma_f32_16x16x32_bf16 v[176:179], v[44:47], v[16:19], v[176:179]
v_mfma_f32_16x16x32_bf16 v[180:183], v[44:47], v[20:23], v[180:183]
v_mfma_f32_16x16x32_bf16 v[184:187], v[44:47], v[24:27], v[184:187]
s_waitcnt lgkmcnt(0)
v_mfma_f32_16x16x32_bf16 v[188:191], v[44:47], v[28:31], v[188:191]
s_barrier
v_mfma_f32_16x16x32_bf16 v[128:131], v[64:67], v[48:51], v[128:131]
ds_read_b128 v[16:19], v2 offset:32768
ds_read_b128 v[20:23], v2 offset:34816
v_mfma_f32_16x16x32_bf16 v[132:135], v[64:67], v[52:55], v[132:135]
ds_read_b128 v[24:27], v2 offset:36864
v_mfma_f32_16x16x32_bf16 v[136:139], v[64:67], v[56:59], v[136:139]
ds_read_b128 v[28:31], v2 offset:38912
v_mfma_f32_16x16x32_bf16 v[140:143], v[64:67], v[60:63], v[140:143]
ds_read_b64_tr_b16 v[32:33], v8 offset:16384
v_mfma_f32_16x16x32_bf16 v[144:147], v[68:71], v[48:51], v[144:147]
ds_read_b64_tr_b16 v[34:35], v8 offset:17408
v_mfma_f32_16x16x32_bf16 v[148:151], v[68:71], v[52:55], v[148:151]
ds_read_b64_tr_b16 v[36:37], v9 offset:16384
ds_read_b64_tr_b16 v[38:39], v9 offset:17408
v_mfma_f32_16x16x32_bf16 v[152:155], v[68:71], v[56:59], v[152:155]
ds_read_b64_tr_b16 v[40:41], v10 offset:16384
v_mfma_f32_16x16x32_bf16 v[156:159], v[68:71], v[60:63], v[156:159]
ds_read_b64_tr_b16 v[42:43], v10 offset:17408
v_mfma_f32_16x16x32_bf16 v[160:163], v[72:75], v[48:51], v[160:163]
ds_read_b64_tr_b16 v[44:45], v11 offset:16384
v_mfma_f32_16x16x32_bf16 v[164:167], v[72:75], v[52:55], v[164:167]
ds_read_b64_tr_b16 v[46:47], v11 offset:17408
v_mfma_f32_16x16x32_bf16 v[168:171], v[72:75], v[56:59], v[168:171]
v_mfma_f32_16x16x32_bf16 v[172:175], v[72:75], v[60:63], v[172:175]
v_mfma_f32_16x16x32_bf16 v[176:179], v[76:79], v[48:51], v[176:179]
v_mfma_f32_16x16x32_bf16 v[180:183], v[76:79], v[52:55], v[180:183]
v_mfma_f32_16x16x32_bf16 v[184:187], v[76:79], v[56:59], v[184:187]
v_mfma_f32_16x16x32_bf16 v[188:191], v[76:79], v[60:63], v[188:191]
s_waitcnt lgkmcnt(0)
v_mfma_f32_16x16x32_bf16 v[128:131], v[32:35], v[16:19], v[128:131]
ds_read_b128 v[48:51], v3 offset:32768
ds_read_b128 v[52:55], v3 offset:34816
v_mfma_f32_16x16x32_bf16 v[132:135], v[32:35], v[20:23], v[132:135]
ds_read_b128 v[56:59], v3 offset:36864
v_mfma_f32_16x16x32_bf16 v[136:139], v[32:35], v[24:27], v[136:139]
ds_read_b128 v[60:63], v3 offset:38912
v_mfma_f32_16x16x32_bf16 v[140:143], v[32:35], v[28:31], v[140:143]
ds_read_b64_tr_b16 v[64:65], v8 offset:24576
v_mfma_f32_16x16x32_bf16 v[144:147], v[36:39], v[16:19], v[144:147]
ds_read_b64_tr_b16 v[66:67], v8 offset:25600
v_mfma_f32_16x16x32_bf16 v[148:151], v[36:39], v[20:23], v[148:151]
ds_read_b64_tr_b16 v[68:69], v9 offset:24576
ds_read_b64_tr_b16 v[70:71], v9 offset:25600
v_mfma_f32_16x16x32_bf16 v[152:155], v[36:39], v[24:27], v[152:155]
ds_read_b64_tr_b16 v[72:73], v10 offset:24576
v_mfma_f32_16x16x32_bf16 v[156:159], v[36:39], v[28:31], v[156:159]
ds_read_b64_tr_b16 v[74:75], v10 offset:25600
v_mfma_f32_16x16x32_bf16 v[160:163], v[40:43], v[16:19], v[160:163]
ds_read_b64_tr_b16 v[76:77], v11 offset:24576
v_mfma_f32_16x16x32_bf16 v[164:167], v[40:43], v[20:23], v[164:167]
ds_read_b64_tr_b16 v[78:79], v11 offset:25600
v_mfma_f32_16x16x32_bf16 v[168:171], v[40:43], v[24:27], v[168:171]
v_mfma_f32_16x16x32_bf16 v[172:175], v[40:43], v[28:31], v[172:175]
v_mfma_f32_16x16x32_bf16 v[176:179], v[44:47], v[16:19], v[176:179]
v_mfma_f32_16x16x32_bf16 v[180:183], v[44:47], v[20:23], v[180:183]
v_mfma_f32_16x16x32_bf16 v[184:187], v[44:47], v[24:27], v[184:187]
s_waitcnt lgkmcnt(0)
v_mfma_f32_16x16x32_bf16 v[188:191], v[44:47], v[28:31], v[188:191]
s_barrier
v_mfma_f32_16x16x32_bf16 v[128:131], v[64:67], v[48:51], v[128:131]
ds_read_b128 v[16:19], v2 offset:49152
ds_read_b128 v[20:23], v2 offset:51200
v_mfma_f32_16x16x32_bf16 v[132:135], v[64:67], v[52:55], v[132:135]
ds_read_b128 v[24:27], v2 offset:53248
v_mfma_f32_16x16x32_bf16 v[136:139], v[64:67], v[56:59], v[136:139]
ds_read_b128 v[28:31], v2 offset:55296
v_mfma_f32_16x16x32_bf16 v[140:143], v[64:67], v[60:63], v[140:143]
ds_read_b64_tr_b16 v[32:33], v8 offset:32768
v_mfma_f32_16x16x32_bf16 v[144:147], v[68:71], v[48:51], v[144:147]
ds_read_b64_tr_b16 v[34:35], v8 offset:33792
v_mfma_f32_16x16x32_bf16 v[148:151], v[68:71], v[52:55], v[148:151]
ds_read_b64_tr_b16 v[36:37], v9 offset:32768
ds_read_b64_tr_b16 v[38:39], v9 offset:33792
v_mfma_f32_16x16x32_bf16 v[152:155], v[68:71], v[56:59], v[152:155]
ds_read_b64_tr_b16 v[40:41], v10 offset:32768
v_mfma_f32_16x16x32_bf16 v[156:159], v[68:71], v[60:63], v[156:159]
ds_read_b64_tr_b16 v[42:43], v10 offset:33792
v_mfma_f32_16x16x32_bf16 v[160:163], v[72:75], v[48:51], v[160:163]
ds_read_b64_tr_b16 v[44:45], v11 offset:32768
v_mfma_f32_16x16x32_bf16 v[164:167], v[72:75], v[52:55], v[164:167]
ds_read_b64_tr_b16 v[46:47], v11 offset:33792
v_mfma_f32_16x16x32_bf16 v[168:171], v[72:75], v[56:59], v[168:171]
v_mfma_f32_16x16x32_bf16 v[172:175], v[72:75], v[60:63], v[172:175]
v_mfma_f32_16x16x32_bf16 v[176:179], v[76:79], v[48:51], v[176:179]
v_mfma_f32_16x16x32_bf16 v[180:183], v[76:79], v[52:55], v[180:183]
v_mfma_f32_16x16x32_bf16 v[184:187], v[76:79], v[56:59], v[184:187]
v_mfma_f32_16x16x32_bf16 v[188:191], v[76:79], v[60:63], v[188:191]
s_waitcnt lgkmcnt(0)
v_mfma_f32_16x16x32_bf16 v[128:131], v[32:35], v[16:19], v[128:131]
ds_read_b128 v[48:51], v3 offset:49152
ds_read_b128 v[52:55], v3 offset:51200
v_mfma_f32_16x16x32_bf16 v[132:135], v[32:35], v[20:23], v[132:135]
ds_read_b128 v[56:59], v3 offset:53248
v_mfma_f32_16x16x32_bf16 v[136:139], v[32:35], v[24:27], v[136:139]
ds_read_b128 v[60:63], v3 offset:55296
v_mfma_f32_16x16x32_bf16 v[140:143], v[32:35], v[28:31], v[140:143]
ds_read_b64_tr_b16 v[64:65], v8 offset:40960
v_mfma_f32_16x16x32_bf16 v[144:147], v[36:39], v[16:19], v[144:147]
ds_read_b64_tr_b16 v[66:67], v8 offset:41984
v_mfma_f32_16x16x32_bf16 v[148:151], v[36:39], v[20:23], v[148:151]
ds_read_b64_tr_b16 v[68:69], v9 offset:40960
ds_read_b64_tr_b16 v[70:71], v9 offset:41984
v_mfma_f32_16x16x32_bf16 v[152:155], v[36:39], v[24:27], v[152:155]
ds_read_b64_tr_b16 v[72:73], v10 offset:40960
v_mfma_f32_16x16x32_bf16 v[156:159], v[36:39], v[28:31], v[156:159]
ds_read_b64_tr_b16 v[74:75], v10 offset:41984
v_mfma_f32_16x16x32_bf16 v[160:163], v[40:43], v[16:19], v[160:163]
ds_read_b64_tr_b16 v[76:77], v11 offset:40960
v_mfma_f32_16x16x32_bf16 v[164:167], v[40:43], v[20:23], v[164:167]
ds_read_b64_tr_b16 v[78:79], v11 offset:41984
v_mfma_f32_16x16x32_bf16 v[168:171], v[40:43], v[24:27], v[168:171]
v_mfma_f32_16x16x32_bf16 v[172:175], v[40:43], v[28:31], v[172:175]
v_mfma_f32_16x16x32_bf16 v[176:179], v[44:47], v[16:19], v[176:179]
v_mfma_f32_16x16x32_bf16 v[180:183], v[44:47], v[20:23], v[180:183]
v_mfma_f32_16x16x32_bf16 v[184:187], v[44:47], v[24:27], v[184:187]
s_waitcnt lgkmcnt(0)
v_mfma_f32_16x16x32_bf16 v[188:191], v[44:47], v[28:31], v[188:191]
s_barrier
v_mfma_f32_16x16x32_bf16 v[128:131], v[64:67], v[48:51], v[128:131]
ds_read_b128 v[16:19], v2 offset:0
ds_read_b128 v[20:23], v2 offset:2048
v_mfma_f32_16x16x32_bf16 v[132:135], v[64:67], v[52:55], v[132:135]
ds_read_b128 v[24:27], v2 offset:4096
v_mfma_f32_16x16x32_bf16 v[136:139], v[64:67], v[56:59], v[136:139]
ds_read_b128 v[28:31], v2 offset:6144
v_mfma_f32_16x16x32_bf16 v[140:143], v[64:67], v[60:63], v[140:143]
ds_read_b64_tr_b16 v[32:33], v4 offset:0
v_mfma_f32_16x16x32_bf16 v[144:147], v[68:71], v[48:51], v[144:147]
ds_read_b64_tr_b16 v[34:35], v4 offset:1024
v_mfma_f32_16x16x32_bf16 v[148:151], v[68:71], v[52:55], v[148:151]
ds_read_b64_tr_b16 v[36:37], v5 offset:0
ds_read_b64_tr_b16 v[38:39], v5 offset:1024
v_mfma_f32_16x16x32_bf16 v[152:155], v[68:71], v[56:59], v[152:155]
ds_read_b64_tr_b16 v[40:41], v6 offset:0
v_mfma_f32_16x16x32_bf16 v[156:159], v[68:71], v[60:63], v[156:159]
ds_read_b64_tr_b16 v[42:43], v6 offset:1024
v_mfma_f32_16x16x32_bf16 v[160:163], v[72:75], v[48:51], v[160:163]
ds_read_b64_tr_b16 v[44:45], v7 offset:0
v_mfma_f32_16x16x32_bf16 v[164:167], v[72:75], v[52:55], v[164:167]
ds_read_b64_tr_b16 v[46:47], v7 offset:1024
v_mfma_f32_16x16x32_bf16 v[168:171], v[72:75], v[56:59], v[168:171]
v_mfma_f32_16x16x32_bf16 v[172:175], v[72:75], v[60:63], v[172:175]
v_mfma_f32_16x16x32_bf16 v[176:179], v[76:79], v[48:51], v[176:179]
v_mfma_f32_16x16x32_bf16 v[180:183], v[76:79], v[52:55], v[180:183]
v_mfma_f32_16x16x32_bf16 v[184:187], v[76:79], v[56:59], v[184:187]
v_mfma_f32_16x16x32_bf16 v[188:191], v[76:79], v[60:63], v[188:191]
s_waitcnt lgkmcnt(0)
v_mfma_f32_16x16x32_bf16 v[128:131], v[32:35], v[16:19], v[128:131]
ds_read_b128 v[48:51], v3 offset:0
ds_read_b128 v[52:55], v3 offset:2048
v_mfma_f32_16x16x32_bf16 v[132:135], v[32:35], v[20:23], v[132:135]
ds_read_b128 v[56:59], v3 offset:4096
v_mfma_f32_16x16x32_bf16 v[136:139], v[32:35], v[24:27], v[136:139]
ds_read_b128 v[60:63], v3 offset:6144
v_mfma_f32_16x16x32_bf16 v[140:143], v[32:35], v[28:31], v[140:143]
ds_read_b64_tr_b16 v[64:65], v4 offset:8192
v_mfma_f32_16x16x32_bf16 v[144:147], v[36:39], v[16:19], v[144:147]
ds_read_b64_tr_b16 v[66:67], v4 offset:9216
v_mfma_f32_16x16x32_bf16 v[148:151], v[36:39], v[20:23], v[148:151]
ds_read_b64_tr_b16 v[68:69], v5 offset:8192
ds_read_b64_tr_b16 v[70:71], v5 offset:9216
v_mfma_f32_16x16x32_bf16 v[152:155], v[36:39], v[24:27], v[152:155]
ds_read_b64_tr_b16 v[72:73], v6 offset:8192
v_mfma_f32_16x16x32_bf16 v[156:159], v[36:39], v[28:31], v[156:159]
ds_read_b64_tr_b16 v[74:75], v6 offset:9216
v_mfma_f32_16x16x32_bf16 v[160:163], v[40:43], v[16:19], v[160:163]
ds_read_b64_tr_b16 v[76:77], v7 offset:8192
v_mfma_f32_16x16x32_bf16 v[164:167], v[40:43], v[20:23], v[164:167]
ds_read_b64_tr_b16 v[78:79], v7 offset:9216
v_mfma_f32_16x16x32_bf16 v[168:171], v[40:43], v[24:27], v[168:171]
v_mfma_f32_16x16x32_bf16 v[172:175], v[40:43], v[28:31], v[172:175]
v_mfma_f32_16x16x32_bf16 v[176:179], v[44:47], v[16:19], v[176:179]
v_mfma_f32_16x16x32_bf16 v[180:183], v[44:47], v[20:23], v[180:183]
v_mfma_f32_16x16x32_bf16 v[184:187], v[44:47], v[24:27], v[184:187]
s_waitcnt lgkmcnt(0)
v_mfma_f32_16x16x32_bf16 v[188:191], v[44:47], v[28:31], v[188:191]
s_barrier
v_mfma_f32_16x16x32_bf16 v[128:131], v[64:67], v[48:51], v[128:131]
ds_read_b128 v[16:19], v2 offset:16384
ds_read_b128 v[20:23], v2 offset:18432
v_mfma_f32_16x16x32_bf16 v[132:135], v[64:67], v[52:55], v[132:135]
ds_read_b128 v[24:27], v2 offset:20480
v_mfma_f32_16x16x32_bf16 v[136:139], v[64:67], v[56:59], v[136:139]
ds_read_b128 v[28:31], v2 offset:22528
v_mfma_f32_16x16x32_bf16 v[140:143], v[64:67], v[60:63], v[140:143]
ds_read_b64_tr_b16 v[32:33], v4 offset:16384
v_mfma_f32_16x16x32_bf16 v[144:147], v[68:71], v[48:51], v[144:147]
ds_read_b64_tr_b16 v[34:35], v4 offset:17408
v_mfma_f32_16x16x32_bf16 v[148:151], v[68:71], v[52:55], v[148:151]
ds_read_b64_tr_b16 v[36:37], v5 offset:16384
ds_read_b64_tr_b16 v[38:39], v5 offset:17408
v_mfma_f32_16x16x32_bf16 v[152:155], v[68:71], v[56:59], v[152:155]
ds_read_b64_tr_b16 v[40:41], v6 offset:16384
v_mfma_f32_16x16x32_bf16 v[156:159], v[68:71], v[60:63], v[156:159]
ds_read_b64_tr_b16 v[42:43], v6 offset:17408
v_mfma_f32_16x16x32_bf16 v[160:163], v[72:75], v[48:51], v[160:163]
ds_read_b64_tr_b16 v[44:45], v7 offset:16384
v_mfma_f32_16x16x32_bf16 v[164:167], v[72:75], v[52:55], v[164:167]
ds_read_b64_tr_b16 v[46:47], v7 offset:17408
v_mfma_f32_16x16x32_bf16 v[168:171], v[72:75], v[56:59], v[168:171]
v_mfma_f32_16x16x32_bf16 v[172:175], v[72:75], v[60:63], v[172:175]
v_mfma_f32_16x16x32_bf16 v[176:179], v[76:79], v[48:51], v[176:179]
v_mfma_f32_16x16x32_bf16 v[180:183], v[76:79], v[52:55], v[180:183]
v_mfma_f32_16x16x32_bf16 v[184:187], v[76:79], v[56:59], v[184:187]
v_mfma_f32_16x16x32_bf16 v[188:191], v[76:79], v[60:63], v[188:191]
s_waitcnt lgkmcnt(0)
v_mfma_f32_16x16x32_bf16 v[128:131], v[32:35], v[16:19], v[128:131]
ds_read_b128 v[48:51], v3 offset:16384
ds_read_b128 v[52:55], v3 offset:18432
v_mfma_f32_16x16x32_bf16 v[132:135], v[32:35], v[20:23], v[132:135]
ds_read_b128 v[56:59], v3 offset:20480
ds_read_b128 v[60:63], v3 offset:22528
v_mfma_f32_16x16x32_bf16 v[136:139], v[32:35], v[24:27], v[136:139]
ds_read_b64_tr_b16 v[64:65], v4 offset:24576
v_mfma_f32_16x16x32_bf16 v[140:143], v[32:35], v[28:31], v[140:143]
ds_read_b64_tr_b16 v[66:67], v4 offset:25600
ds_read_b64_tr_b16 v[68:69], v5 offset:24576
v_mfma_f32_16x16x32_bf16 v[144:147], v[36:39], v[16:19], v[144:147]
ds_read_b64_tr_b16 v[70:71], v5 offset:25600
ds_read_b64_tr_b16 v[72:73], v6 offset:24576
v_mfma_f32_16x16x32_bf16 v[148:151], v[36:39], v[20:23], v[148:151]
ds_read_b64_tr_b16 v[74:75], v6 offset:25600
v_mfma_f32_16x16x32_bf16 v[152:155], v[36:39], v[24:27], v[152:155]
ds_read_b64_tr_b16 v[76:77], v7 offset:24576
ds_read_b64_tr_b16 v[78:79], v7 offset:25600
v_mfma_f32_16x16x32_bf16 v[156:159], v[36:39], v[28:31], v[156:159]
ds_read_b32 v212, v13 offset:0
ds_read_b32 v214, v13 offset:64
v_mfma_f32_16x16x32_bf16 v[160:163], v[40:43], v[16:19], v[160:163]
ds_read_b32 v216, v13 offset:128
v_mfma_f32_16x16x32_bf16 v[164:167], v[40:43], v[20:23], v[164:167]
ds_read_b32 v218, v13 offset:192
ds_read_b32 v240, v13 offset:512
v_mfma_f32_16x16x32_bf16 v[168:171], v[40:43], v[24:27], v[168:171]
ds_read_b32 v242, v13 offset:576
ds_read_b32 v244, v13 offset:640
v_mfma_f32_16x16x32_bf16 v[172:175], v[40:43], v[28:31], v[172:175]
ds_read_b32 v246, v13 offset:704
s_waitcnt lgkmcnt(0)
v_mfma_f32_16x16x32_bf16 v[128:131], v[64:67], v[48:51], v[128:131]
s_barrier
ds_read_b64 v[200:201], v1
v_mfma_f32_16x16x32_bf16 v[132:135], v[64:67], v[52:55], v[132:135]
ds_read_b128 v[96:99], v12 offset:0
v_mfma_f32_16x16x32_bf16 v[136:139], v[64:67], v[56:59], v[136:139]
ds_read_b128 v[100:103], v12 offset:64
ds_read_b128 v[104:107], v12 offset:128
v_mfma_f32_16x16x32_bf16 v[140:143], v[64:67], v[60:63], v[140:143]
ds_read_b128 v[108:111], v12 offset:192
v_mfma_f32_16x16x32_bf16 v[144:147], v[68:71], v[48:51], v[144:147]
s_nop 1
v_mfma_f32_16x16x32_bf16 v[148:151], v[68:71], v[52:55], v[148:151]
s_nop 1
v_mfma_f32_16x16x32_bf16 v[152:155], v[68:71], v[56:59], v[152:155]
s_waitcnt lgkmcnt(0)
v_readfirstlane_b32 s8, v200
v_readfirstlane_b32 s98, v201
v_mfma_f32_16x16x32_bf16 v[156:159], v[68:71], v[60:63], v[156:159]
v_sub_f32 v212, 0, v212
v_mul_f32 v240, s70, v240
v_sub_f32 v214, 0, v214
v_mfma_f32_16x16x32_bf16 v[160:163], v[72:75], v[48:51], v[160:163]
v_mul_f32 v242, s70, v242
v_sub_f32 v216, 0, v216
v_mul_f32 v244, s70, v244
v_mfma_f32_16x16x32_bf16 v[164:167], v[72:75], v[52:55], v[164:167]
v_sub_f32 v218, 0, v218
v_mul_f32 v246, s70, v246
v_fmac_f32 v128, v212, v96
v_mfma_f32_16x16x32_bf16 v[168:171], v[72:75], v[56:59], v[168:171]
v_fmac_f32 v129, v212, v97
v_fmac_f32 v130, v212, v98
v_fmac_f32 v131, v212, v99
v_mfma_f32_16x16x32_bf16 v[172:175], v[72:75], v[60:63], v[172:175]
v_fmac_f32 v132, v214, v96
v_fmac_f32 v133, v214, v97
v_fmac_f32 v134, v214, v98
v_mfma_f32_16x16x32_bf16 v[176:179], v[44:47], v[16:19], v[176:179]
v_fmac_f32 v135, v214, v99
v_fmac_f32 v136, v216, v96
v_fmac_f32 v137, v216, v97
v_mfma_f32_16x16x32_bf16 v[180:183], v[44:47], v[20:23], v[180:183]
v_fmac_f32 v138, v216, v98
v_fmac_f32 v139, v216, v99
v_fmac_f32 v140, v218, v96
v_mfma_f32_16x16x32_bf16 v[184:187], v[44:47], v[24:27], v[184:187]
v_fmac_f32 v141, v218, v97
v_fmac_f32 v142, v218, v98
v_fmac_f32 v143, v218, v99
v_mfma_f32_16x16x32_bf16 v[188:191], v[44:47], v[28:31], v[188:191]
v_mul_f32 v128, v240, v128
v_mul_f32 v129, v240, v129
v_mul_f32 v130, v240, v130
v_mfma_f32_16x16x32_bf16 v[176:179], v[76:79], v[48:51], v[176:179]
v_mul_f32 v131, v240, v131
v_mul_f32 v132, v242, v132
v_mul_f32 v133, v242, v133
v_mfma_f32_16x16x32_bf16 v[180:183], v[76:79], v[52:55], v[180:183]
v_mul_f32 v134, v242, v134
v_mul_f32 v135, v242, v135
v_cvt_pk_bf16_f32 v128, v128, v129
v_mfma_f32_16x16x32_bf16 v[184:187], v[76:79], v[56:59], v[184:187]
v_cvt_pk_bf16_f32 v129, v130, v131
v_cvt_pk_bf16_f32 v130, v132, v133
v_cvt_pk_bf16_f32 v131, v134, v135
v_mfma_f32_16x16x32_bf16 v[188:191], v[76:79], v[60:63], v[188:191]
s_nop 0
v_permlane16_swap_b32 v128, v130
v_permlane16_swap_b32 v129, v131
buffer_store_dwordx4 v[128:131], v202, s[36:39], s72 offen sc1
v_mul_f32 v136, v244, v136
v_mul_f32 v137, v244, v137
v_mul_f32 v138, v244, v138
v_mul_f32 v139, v244, v139
v_mul_f32 v140, v246, v140
v_mul_f32 v141, v246, v141
v_mul_f32 v142, v246, v142
v_mul_f32 v143, v246, v143
v_cvt_pk_bf16_f32 v136, v136, v137
v_cvt_pk_bf16_f32 v137, v138, v139
v_cvt_pk_bf16_f32 v138, v140, v141
v_cvt_pk_bf16_f32 v139, v142, v143
s_nop 0
v_permlane16_swap_b32 v136, v138
v_permlane16_swap_b32 v137, v139
buffer_store_dwordx4 v[136:139], v202, s[36:39], s96 offen sc1
v_fmac_f32 v144, v212, v100
v_fmac_f32 v145, v212, v101
v_fmac_f32 v146, v212, v102
v_fmac_f32 v147, v212, v103
v_fmac_f32 v148, v214, v100
v_fmac_f32 v149, v214, v101
v_fmac_f32 v150, v214, v102
v_fmac_f32 v151, v214, v103
v_fmac_f32 v152, v216, v100
v_fmac_f32 v153, v216, v101
v_fmac_f32 v154, v216, v102
v_fmac_f32 v155, v216, v103
v_fmac_f32 v156, v218, v100
v_fmac_f32 v157, v218, v101
v_fmac_f32 v158, v218, v102
v_fmac_f32 v159, v218, v103
v_mul_f32 v144, v240, v144
v_mul_f32 v145, v240, v145
v_mul_f32 v146, v240, v146
v_mul_f32 v147, v240, v147
v_mul_f32 v148, v242, v148
v_mul_f32 v149, v242, v149
v_mul_f32 v150, v242, v150
v_mul_f32 v151, v242, v151
v_cvt_pk_bf16_f32 v144, v144, v145
v_cvt_pk_bf16_f32 v145, v146, v147
v_cvt_pk_bf16_f32 v146, v148, v149
v_cvt_pk_bf16_f32 v147, v150, v151
s_nop 0
v_permlane16_swap_b32 v144, v146
v_permlane16_swap_b32 v145, v147
buffer_store_dwordx4 v[144:147], v203, s[36:39], s72 offen sc1
v_mul_f32 v152, v244, v152
v_mul_f32 v153, v244, v153
v_mul_f32 v154, v244, v154
v_mul_f32 v155, v244, v155
v_mul_f32 v156, v246, v156
v_mul_f32 v157, v246, v157
v_mul_f32 v158, v246, v158
v_mul_f32 v159, v246, v159
v_cvt_pk_bf16_f32 v152, v152, v153
v_cvt_pk_bf16_f32 v153, v154, v155
v_cvt_pk_bf16_f32 v154, v156, v157
v_cvt_pk_bf16_f32 v155, v158, v159
s_nop 0
v_permlane16_swap_b32 v152, v154
v_permlane16_swap_b32 v153, v155
buffer_store_dwordx4 v[152:155], v203, s[36:39], s96 offen sc1
v_fmac_f32 v160, v212, v104
v_fmac_f32 v161, v212, v105
v_fmac_f32 v162, v212, v106
v_fmac_f32 v163, v212, v107
v_fmac_f32 v164, v214, v104
v_fmac_f32 v165, v214, v105
v_fmac_f32 v166, v214, v106
v_fmac_f32 v167, v214, v107
v_fmac_f32 v168, v216, v104
v_fmac_f32 v169, v216, v105
v_fmac_f32 v170, v216, v106
v_fmac_f32 v171, v216, v107
v_fmac_f32 v172, v218, v104
v_fmac_f32 v173, v218, v105
v_fmac_f32 v174, v218, v106
v_fmac_f32 v175, v218, v107
v_pk_mul_f32 v[160:161], v[160:161], v[240:241] op_sel_hi:[1,0]
v_pk_mul_f32 v[162:163], v[162:163], v[240:241] op_sel_hi:[1,0]
v_pk_mul_f32 v[164:165], v[164:165], v[242:243] op_sel_hi:[1,0]
v_pk_mul_f32 v[166:167], v[166:167], v[242:243] op_sel_hi:[1,0]
v_cvt_pk_bf16_f32 v160, v160, v161
v_cvt_pk_bf16_f32 v161, v162, v163
v_cvt_pk_bf16_f32 v162, v164, v165
v_cvt_pk_bf16_f32 v163, v166, v167
s_nop 0
v_permlane16_swap_b32 v160, v162
v_permlane16_swap_b32 v161, v163
buffer_store_dwordx4 v[160:163], v204, s[36:39], s72 offen sc1
v_pk_mul_f32 v[168:169], v[168:169], v[244:245] op_sel_hi:[1,0]
v_pk_mul_f32 v[170:171], v[170:171], v[244:245] op_sel_hi:[1,0]
v_pk_mul_f32 v[172:173], v[172:173], v[246:247] op_sel_hi:[1,0]
v_pk_mul_f32 v[174:175], v[174:175], v[246:247] op_sel_hi:[1,0]
v_cvt_pk_bf16_f32 v168, v168, v169
v_cvt_pk_bf16_f32 v169, v170, v171
v_cvt_pk_bf16_f32 v170, v172, v173
v_cvt_pk_bf16_f32 v171, v174, v175
s_nop 0
v_permlane16_swap_b32 v168, v170
v_permlane16_swap_b32 v169, v171
buffer_store_dwordx4 v[168:171], v204, s[36:39], s96 offen sc1
v_fmac_f32 v176, v212, v108
v_fmac_f32 v177, v212, v109
v_fmac_f32 v178, v212, v110
v_fmac_f32 v179, v212, v111
v_fmac_f32 v180, v214, v108
v_fmac_f32 v181, v214, v109
v_fmac_f32 v182, v214, v110
v_fmac_f32 v183, v214, v111
v_fmac_f32 v184, v216, v108
v_fmac_f32 v185, v216, v109
v_fmac_f32 v186, v216, v110
v_fmac_f32 v187, v216, v111
v_fmac_f32 v188, v218, v108
v_fmac_f32 v189, v218, v109
v_fmac_f32 v190, v218, v110
v_fmac_f32 v191, v218, v111
v_pk_mul_f32 v[176:177], v[176:177], v[240:241] op_sel_hi:[1,0]
v_pk_mul_f32 v[178:179], v[178:179], v[240:241] op_sel_hi:[1,0]
v_pk_mul_f32 v[180:181], v[180:181], v[242:243] op_sel_hi:[1,0]
v_pk_mul_f32 v[182:183], v[182:183], v[242:243] op_sel_hi:[1,0]
v_cvt_pk_bf16_f32 v176, v176, v177
v_cvt_pk_bf16_f32 v177, v178, v179
v_cvt_pk_bf16_f32 v178, v180, v181
v_cvt_pk_bf16_f32 v179, v182, v183
s_nop 0
v_permlane16_swap_b32 v176, v178
v_permlane16_swap_b32 v177, v179
buffer_store_dwordx4 v[176:179], v205, s[36:39], s72 offen sc1
v_pk_mul_f32 v[184:185], v[184:185], v[244:245] op_sel_hi:[1,0]
v_pk_mul_f32 v[186:187], v[186:187], v[244:245] op_sel_hi:[1,0]
v_pk_mul_f32 v[188:189], v[188:189], v[246:247] op_sel_hi:[1,0]
v_pk_mul_f32 v[190:191], v[190:191], v[246:247] op_sel_hi:[1,0]
v_cvt_pk_bf16_f32 v184, v184, v185
v_cvt_pk_bf16_f32 v185, v186, v187
v_cvt_pk_bf16_f32 v186, v188, v189
v_cvt_pk_bf16_f32 v187, v190, v191
s_nop 0
v_permlane16_swap_b32 v184, v186
v_permlane16_swap_b32 v185, v187
buffer_store_dwordx4 v[184:187], v205, s[36:39], s96 offen sc1
s_bitcmp0_b32 s71, 0
s_cbranch_scc1 qk_b_16
buffer_store_dwordx2 v[128:129], v206, s[36:39], s72 offen sc1
buffer_store_dwordx2 v[130:131], v206, s[36:39], s74 offen sc1
buffer_store_dwordx2 v[136:137], v206, s[36:39], s96 offen sc1
buffer_store_dwordx2 v[138:139], v206, s[36:39], s97 offen sc1
qk_b_16:
s_bitcmp0_b32 s71, 1
s_cbranch_scc1 qk_b_17
buffer_store_dwordx2 v[144:145], v207, s[36:39], s72 offen sc1
buffer_store_dwordx2 v[146:147], v207, s[36:39], s74 offen sc1
buffer_store_dwordx2 v[152:153], v207, s[36:39], s96 offen sc1
buffer_store_dwordx2 v[154:155], v207, s[36:39], s97 offen sc1
qk_b_17:
s_bitcmp0_b32 s71, 2
s_cbranch_scc1 qk_b_18
buffer_store_dwordx2 v[160:161], v208, s[36:39], s72 offen sc1
buffer_store_dwordx2 v[162:163], v208, s[36:39], s74 offen sc1
buffer_store_dwordx2 v[168:169], v208, s[36:39], s96 offen sc1
buffer_store_dwordx2 v[170:171], v208, s[36:39], s97 offen sc1
qk_b_18:
s_bitcmp0_b32 s71, 3
s_cbranch_scc1 qk_b_19
buffer_store_dwordx2 v[176:177], v209, s[36:39], s72 offen sc1
buffer_store_dwordx2 v[178:179], v209, s[36:39], s74 offen sc1
buffer_store_dwordx2 v[184:185], v209, s[36:39], s96 offen sc1
buffer_store_dwordx2 v[186:187], v209, s[36:39], s97 offen sc1
qk_b_19:
s_branch qkv_fin_15
qkv_v_14:
s_lshl_b32 s68, s60, 3
s_lshl_b32 s67, s65, 2
s_add_u32 s68, s68, s67
s_mul_i32 s72, s68, 640
s_add_u32 s72, s72, 5242880
s_lshl_b32 s67, s66, 6
s_add_u32 s68, s63, s67
v_lshrrev_b32 v80, 5, v0
v_lshl_add_u32 v80, v80, 4, v15
v_add_u32 v80, s68, v80
v_and_b32 v81, 1, v14
v_mul_u32_u24 v81, 320, v81
s_mov_b32 s73, 81920
s_movk_i32 s74, 3277
s_movk_i32 s67, -20
v_add_u32 v83, 0, v80
v_mul_u32_u24 v84, s74, v83
v_lshrrev_b32 v84, 16, v84
v_mad_i32_i24 v83, v84, s67, v83
v_lshl_add_u32 v83, v83, 4, v81
v_mul_lo_u32 v85, v84, s73
v_add_u32 v202, v83, v85
v_add_u32 v83, 32, v80
v_mul_u32_u24 v84, s74, v83
v_lshrrev_b32 v84, 16, v84
v_mad_i32_i24 v83, v84, s67, v83
v_lshl_add_u32 v83, v83, 4, v81
v_mul_lo_u32 v85, v84, s73
v_add_u32 v203, v83, v85
s_mov_b32 s76, 0xffff0000
v_mov_b64 v[232:233], 0
s_waitcnt vmcnt(0)
v_lshlrev_b32 v234, 16, v220
v_and_b32 v235, s76, v220
v_add_f32 v232, v232, v234
v_fmac_f32 v233, v234, v234
v_add_f32 v232, v232, v235
v_fmac_f32 v233, v235, v235
v_lshlrev_b32 v234, 16, v221
v_and_b32 v235, s76, v221
v_add_f32 v232, v232, v234
v_fmac_f32 v233, v234, v234
v_add_f32 v232, v232, v235
v_fmac_f32 v233, v235, v235
v_lshlrev_b32 v234, 16, v222
v_and_b32 v235, s76, v222
v_add_f32 v232, v232, v234
v_fmac_f32 v233, v234, v234
v_add_f32 v232, v232, v235
v_fmac_f32 v233, v235, v235
v_lshlrev_b32 v234, 16, v223
v_and_b32 v235, s76, v223
v_add_f32 v232, v232, v234
v_fmac_f32 v233, v234, v234
v_add_f32 v232, v232, v235
v_fmac_f32 v233, v235, v235
v_lshlrev_b32 v234, 16, v224
v_and_b32 v235, s76, v224
v_add_f32 v232, v232, v234
v_fmac_f32 v233, v234, v234
v_add_f32 v232, v232, v235
v_fmac_f32 v233, v235, v235
v_lshlrev_b32 v234, 16, v225
v_and_b32 v235, s76, v225
v_add_f32 v232, v232, v234
v_fmac_f32 v233, v234, v234
v_add_f32 v232, v232, v235
v_fmac_f32 v233, v235, v235
v_lshlrev_b32 v234, 16, v226
v_and_b32 v235, s76, v226
v_add_f32 v232, v232, v234
v_fmac_f32 v233, v234, v234
v_add_f32 v232, v232, v235
v_fmac_f32 v233, v235, v235
v_lshlrev_b32 v234, 16, v227
v_and_b32 v235, s76, v227
v_add_f32 v232, v232, v234
v_fmac_f32 v233, v234, v234
v_add_f32 v232, v232, v235
v_fmac_f32 v233, v235, v235
v_lshlrev_b32 v234, 16, v228
v_and_b32 v235, s76, v228
v_add_f32 v232, v232, v234
v_fmac_f32 v233, v234, v234
v_add_f32 v232, v232, v235
v_fmac_f32 v233, v235, v235
v_lshlrev_b32 v234, 16, v229
v_and_b32 v235, s76, v229
v_add_f32 v232, v232, v234
v_fmac_f32 v233, v234, v234
v_add_f32 v232, v232, v235
v_fmac_f32 v233, v235, v235
v_lshlrev_b32 v234, 16, v230
v_and_b32 v235, s76, v230
v_add_f32 v232, v232, v234
v_fmac_f32 v233, v234, v234
v_add_f32 v232, v232, v235
v_fmac_f32 v233, v235, v235
v_lshlrev_b32 v234, 16, v231
v_and_b32 v235, s76, v231
v_add_f32 v232, v232, v234
v_fmac_f32 v233, v234, v234
v_add_f32 v232, v232, v235
v_fmac_f32 v233, v235, v235
s_nop 1
v_add_f32_dpp v232, v232, v232 quad_perm:[1,0,3,2] row_mask:0xf bank_mask:0xf
v_add_f32_dpp v233, v233, v233 quad_perm:[1,0,3,2] row_mask:0xf bank_mask:0xf
s_nop 1
v_add_f32_dpp v232, v232, v232 quad_perm:[2,3,0,1] row_mask:0xf bank_mask:0xf
v_add_f32_dpp v233, v233, v233 quad_perm:[2,3,0,1] row_mask:0xf bank_mask:0xf
v_bfe_u32 v234, v0, 3, 2
v_lshlrev_b32 v234, 10, v234
v_bfe_u32 v235, v0, 2, 1
v_lshl_add_u32 v234, v235, 3, v234
v_lshrrev_b32 v235, 5, v0
v_lshl_add_u32 v234, v235, 4, v234
s_lshr_b32 s76, s13, 3
s_lshl_b32 s76, s76, 12
s_and_b32 s77, s13, 7
s_lshl_b32 s77, s77, 2
s_add_u32 s77, s77, s6
s_lshl_b32 s77, s77, 5
s_add_u32 s76, s76, s77
s_add_u32 s76, s76, 44466176
s_mov_b32 exec_lo, 0x11111111
s_mov_b32 exec_hi, 0x11111111
buffer_store_dwordx2 v[232:233], v234, s[36:39], s76 offen sc1
s_mov_b64 exec, -1
s_cmp_eq_u32 s62, 0
s_cselect_b32 s70, 0x3ea52b5c, 1.0
s_lshl_b32 s67, s65, 8
s_add_u32 s67, s67, 98304
v_add_u32 v13, s67, v210
s_lshl_b32 s67, s66, 8
s_add_u32 s67, s67, 100416
v_add_u32 v12, s67, v211
v_mov_b32 v1, 100352
s_barrier
ds_read_b128 v[16:19], v2 offset:0
ds_read_b128 v[20:23], v2 offset:2048
ds_read_b128 v[24:27], v2 offset:4096
ds_read_b128 v[28:31], v2 offset:6144
ds_read_b64_tr_b16 v[32:33], v8 offset:16384
ds_read_b64_tr_b16 v[34:35], v8 offset:17408
ds_read_b64_tr_b16 v[36:37], v9 offset:16384
ds_read_b64_tr_b16 v[38:39], v9 offset:17408
ds_read_b64_tr_b16 v[40:41], v10 offset:16384
ds_read_b64_tr_b16 v[42:43], v10 offset:17408
ds_read_b64_tr_b16 v[44:45], v11 offset:16384
ds_read_b64_tr_b16 v[46:47], v11 offset:17408
s_waitcnt lgkmcnt(0)
v_mfma_f32_16x16x32_bf16 v[128:131], v[16:19], v[32:35], 0
ds_read_b128 v[48:51], v3 offset:0
ds_read_b128 v[52:55], v3 offset:2048
v_mfma_f32_16x16x32_bf16 v[132:135], v[16:19], v[36:39], 0
ds_read_b128 v[56:59], v3 offset:4096
v_mfma_f32_16x16x32_bf16 v[136:139], v[16:19], v[40:43], 0
ds_read_b128 v[60:63], v3 offset:6144
v_mfma_f32_16x16x32_bf16 v[140:143], v[16:19], v[44:47], 0
ds_read_b64_tr_b16 v[64:65], v8 offset:24576
v_mfma_f32_16x16x32_bf16 v[144:147], v[20:23], v[32:35], 0
ds_read_b64_tr_b16 v[66:67], v8 offset:25600
v_mfma_f32_16x16x32_bf16 v[148:151], v[20:23], v[36:39], 0
ds_read_b64_tr_b16 v[68:69], v9 offset:24576
ds_read_b64_tr_b16 v[70:71], v9 offset:25600
v_mfma_f32_16x16x32_bf16 v[152:155], v[20:23], v[40:43], 0
ds_read_b64_tr_b16 v[72:73], v10 offset:24576
v_mfma_f32_16x16x32_bf16 v[156:159], v[20:23], v[44:47], 0
ds_read_b64_tr_b16 v[74:75], v10 offset:25600
v_mfma_f32_16x16x32_bf16 v[160:163], v[24:27], v[32:35], 0
ds_read_b64_tr_b16 v[76:77], v11 offset:24576
v_mfma_f32_16x16x32_bf16 v[164:167], v[24:27], v[36:39], 0
ds_read_b64_tr_b16 v[78:79], v11 offset:25600
v_mfma_f32_16x16x32_bf16 v[168:171], v[24:27], v[40:43], 0
v_mfma_f32_16x16x32_bf16 v[172:175], v[24:27], v[44:47], 0
v_mfma_f32_16x16x32_bf16 v[176:179], v[28:31], v[32:35], 0
v_mfma_f32_16x16x32_bf16 v[180:183], v[28:31], v[36:39], 0
v_mfma_f32_16x16x32_bf16 v[184:187], v[28:31], v[40:43], 0
s_waitcnt lgkmcnt(0)
v_mfma_f32_16x16x32_bf16 v[188:191], v[28:31], v[44:47], 0
s_barrier
v_mfma_f32_16x16x32_bf16 v[128:131], v[48:51], v[64:67], v[128:131]
ds_read_b128 v[16:19], v2 offset:16384
ds_read_b128 v[20:23], v2 offset:18432
v_mfma_f32_16x16x32_bf16 v[132:135], v[48:51], v[68:71], v[132:135]
ds_read_b128 v[24:27], v2 offset:20480
v_mfma_f32_16x16x32_bf16 v[136:139], v[48:51], v[72:75], v[136:139]
ds_read_b128 v[28:31], v2 offset:22528
v_mfma_f32_16x16x32_bf16 v[140:143], v[48:51], v[76:79], v[140:143]
ds_read_b64_tr_b16 v[32:33], v8 offset:32768
v_mfma_f32_16x16x32_bf16 v[144:147], v[52:55], v[64:67], v[144:147]
ds_read_b64_tr_b16 v[34:35], v8 offset:33792
v_mfma_f32_16x16x32_bf16 v[148:151], v[52:55], v[68:71], v[148:151]
ds_read_b64_tr_b16 v[36:37], v9 offset:32768
ds_read_b64_tr_b16 v[38:39], v9 offset:33792
v_mfma_f32_16x16x32_bf16 v[152:155], v[52:55], v[72:75], v[152:155]
ds_read_b64_tr_b16 v[40:41], v10 offset:32768
v_mfma_f32_16x16x32_bf16 v[156:159], v[52:55], v[76:79], v[156:159]
ds_read_b64_tr_b16 v[42:43], v10 offset:33792
v_mfma_f32_16x16x32_bf16 v[160:163], v[56:59], v[64:67], v[160:163]
ds_read_b64_tr_b16 v[44:45], v11 offset:32768
v_mfma_f32_16x16x32_bf16 v[164:167], v[56:59], v[68:71], v[164:167]
ds_read_b64_tr_b16 v[46:47], v11 offset:33792
v_mfma_f32_16x16x32_bf16 v[168:171], v[56:59], v[72:75], v[168:171]
v_mfma_f32_16x16x32_bf16 v[172:175], v[56:59], v[76:79], v[172:175]
v_mfma_f32_16x16x32_bf16 v[176:179], v[60:63], v[64:67], v[176:179]
v_mfma_f32_16x16x32_bf16 v[180:183], v[60:63], v[68:71], v[180:183]
v_mfma_f32_16x16x32_bf16 v[184:187], v[60:63], v[72:75], v[184:187]
v_mfma_f32_16x16x32_bf16 v[188:191], v[60:63], v[76:79], v[188:191]
s_waitcnt lgkmcnt(0)
v_mfma_f32_16x16x32_bf16 v[128:131], v[16:19], v[32:35], v[128:131]
ds_read_b128 v[48:51], v3 offset:16384
ds_read_b128 v[52:55], v3 offset:18432
v_mfma_f32_16x16x32_bf16 v[132:135], v[16:19], v[36:39], v[132:135]
ds_read_b128 v[56:59], v3 offset:20480
v_mfma_f32_16x16x32_bf16 v[136:139], v[16:19], v[40:43], v[136:139]
ds_read_b128 v[60:63], v3 offset:22528
v_mfma_f32_16x16x32_bf16 v[140:143], v[16:19], v[44:47], v[140:143]
ds_read_b64_tr_b16 v[64:65], v8 offset:40960
v_mfma_f32_16x16x32_bf16 v[144:147], v[20:23], v[32:35], v[144:147]
ds_read_b64_tr_b16 v[66:67], v8 offset:41984
v_mfma_f32_16x16x32_bf16 v[148:151], v[20:23], v[36:39], v[148:151]
ds_read_b64_tr_b16 v[68:69], v9 offset:40960
ds_read_b64_tr_b16 v[70:71], v9 offset:41984
v_mfma_f32_16x16x32_bf16 v[152:155], v[20:23], v[40:43], v[152:155]
ds_read_b64_tr_b16 v[72:73], v10 offset:40960
v_mfma_f32_16x16x32_bf16 v[156:159], v[20:23], v[44:47], v[156:159]
ds_read_b64_tr_b16 v[74:75], v10 offset:41984
v_mfma_f32_16x16x32_bf16 v[160:163], v[24:27], v[32:35], v[160:163]
ds_read_b64_tr_b16 v[76:77], v11 offset:40960
s_waitcnt vmcnt(0)
v_mfma_f32_16x16x32_bf16 v[164:167], v[24:27], v[36:39], v[164:167]
ds_read_b64_tr_b16 v[78:79], v11 offset:41984
v_mfma_f32_16x16x32_bf16 v[168:171], v[24:27], v[40:43], v[168:171]
v_mfma_f32_16x16x32_bf16 v[172:175], v[24:27], v[44:47], v[172:175]
v_mfma_f32_16x16x32_bf16 v[176:179], v[28:31], v[32:35], v[176:179]
v_mfma_f32_16x16x32_bf16 v[180:183], v[28:31], v[36:39], v[180:183]
v_mfma_f32_16x16x32_bf16 v[184:187], v[28:31], v[40:43], v[184:187]
s_waitcnt lgkmcnt(0)
v_mfma_f32_16x16x32_bf16 v[188:191], v[28:31], v[44:47], v[188:191]
s_barrier
v_mfma_f32_16x16x32_bf16 v[128:131], v[48:51], v[64:67], v[128:131]
ds_read_b128 v[16:19], v2 offset:32768
ds_read_b128 v[20:23], v2 offset:34816
v_mfma_f32_16x16x32_bf16 v[132:135], v[48:51], v[68:71], v[132:135]
ds_read_b128 v[24:27], v2 offset:36864
v_mfma_f32_16x16x32_bf16 v[136:139], v[48:51], v[72:75], v[136:139]
ds_read_b128 v[28:31], v2 offset:38912
v_mfma_f32_16x16x32_bf16 v[140:143], v[48:51], v[76:79], v[140:143]
ds_read_b64_tr_b16 v[32:33], v4 offset:0
v_mfma_f32_16x16x32_bf16 v[144:147], v[52:55], v[64:67], v[144:147]
ds_read_b64_tr_b16 v[34:35], v4 offset:1024
v_mfma_f32_16x16x32_bf16 v[148:151], v[52:55], v[68:71], v[148:151]
ds_read_b64_tr_b16 v[36:37], v5 offset:0
ds_read_b64_tr_b16 v[38:39], v5 offset:1024
v_mfma_f32_16x16x32_bf16 v[152:155], v[52:55], v[72:75], v[152:155]
ds_read_b64_tr_b16 v[40:41], v6 offset:0
v_mfma_f32_16x16x32_bf16 v[156:159], v[52:55], v[76:79], v[156:159]
ds_read_b64_tr_b16 v[42:43], v6 offset:1024
v_mfma_f32_16x16x32_bf16 v[160:163], v[56:59], v[64:67], v[160:163]
ds_read_b64_tr_b16 v[44:45], v7 offset:0
v_mfma_f32_16x16x32_bf16 v[164:167], v[56:59], v[68:71], v[164:167]
ds_read_b64_tr_b16 v[46:47], v7 offset:1024
v_mfma_f32_16x16x32_bf16 v[168:171], v[56:59], v[72:75], v[168:171]
v_mfma_f32_16x16x32_bf16 v[172:175], v[56:59], v[76:79], v[172:175]
v_mfma_f32_16x16x32_bf16 v[176:179], v[60:63], v[64:67], v[176:179]
v_mfma_f32_16x16x32_bf16 v[180:183], v[60:63], v[68:71], v[180:183]
v_mfma_f32_16x16x32_bf16 v[184:187], v[60:63], v[72:75], v[184:187]
v_mfma_f32_16x16x32_bf16 v[188:191], v[60:63], v[76:79], v[188:191]
s_waitcnt lgkmcnt(0)
v_mfma_f32_16x16x32_bf16 v[128:131], v[16:19], v[32:35], v[128:131]
ds_read_b128 v[48:51], v3 offset:32768
ds_read_b128 v[52:55], v3 offset:34816
v_mfma_f32_16x16x32_bf16 v[132:135], v[16:19], v[36:39], v[132:135]
ds_read_b128 v[56:59], v3 offset:36864
v_mfma_f32_16x16x32_bf16 v[136:139], v[16:19], v[40:43], v[136:139]
ds_read_b128 v[60:63], v3 offset:38912
v_mfma_f32_16x16x32_bf16 v[140:143], v[16:19], v[44:47], v[140:143]
ds_read_b64_tr_b16 v[64:65], v4 offset:8192
v_mfma_f32_16x16x32_bf16 v[144:147], v[20:23], v[32:35], v[144:147]
ds_read_b64_tr_b16 v[66:67], v4 offset:9216
v_mfma_f32_16x16x32_bf16 v[148:151], v[20:23], v[36:39], v[148:151]
ds_read_b64_tr_b16 v[68:69], v5 offset:8192
ds_read_b64_tr_b16 v[70:71], v5 offset:9216
v_mfma_f32_16x16x32_bf16 v[152:155], v[20:23], v[40:43], v[152:155]
ds_read_b64_tr_b16 v[72:73], v6 offset:8192
v_mfma_f32_16x16x32_bf16 v[156:159], v[20:23], v[44:47], v[156:159]
ds_read_b64_tr_b16 v[74:75], v6 offset:9216
v_mfma_f32_16x16x32_bf16 v[160:163], v[24:27], v[32:35], v[160:163]
ds_read_b64_tr_b16 v[76:77], v7 offset:8192
v_mfma_f32_16x16x32_bf16 v[164:167], v[24:27], v[36:39], v[164:167]
ds_read_b64_tr_b16 v[78:79], v7 offset:9216
v_mfma_f32_16x16x32_bf16 v[168:171], v[24:27], v[40:43], v[168:171]
v_mfma_f32_16x16x32_bf16 v[172:175], v[24:27], v[44:47], v[172:175]
v_mfma_f32_16x16x32_bf16 v[176:179], v[28:31], v[32:35], v[176:179]
v_mfma_f32_16x16x32_bf16 v[180:183], v[28:31], v[36:39], v[180:183]
v_mfma_f32_16x16x32_bf16 v[184:187], v[28:31], v[40:43], v[184:187]
s_waitcnt lgkmcnt(0)
v_mfma_f32_16x16x32_bf16 v[188:191], v[28:31], v[44:47], v[188:191]
s_barrier
v_mfma_f32_16x16x32_bf16 v[128:131], v[48:51], v[64:67], v[128:131]
ds_read_b128 v[16:19], v2 offset:49152
ds_read_b128 v[20:23], v2 offset:51200
v_mfma_f32_16x16x32_bf16 v[132:135], v[48:51], v[68:71], v[132:135]
ds_read_b128 v[24:27], v2 offset:53248
v_mfma_f32_16x16x32_bf16 v[136:139], v[48:51], v[72:75], v[136:139]
ds_read_b128 v[28:31], v2 offset:55296
v_mfma_f32_16x16x32_bf16 v[140:143], v[48:51], v[76:79], v[140:143]
ds_read_b64_tr_b16 v[32:33], v4 offset:16384
v_mfma_f32_16x16x32_bf16 v[144:147], v[52:55], v[64:67], v[144:147]
ds_read_b64_tr_b16 v[34:35], v4 offset:17408
v_mfma_f32_16x16x32_bf16 v[148:151], v[52:55], v[68:71], v[148:151]
ds_read_b64_tr_b16 v[36:37], v5 offset:16384
ds_read_b64_tr_b16 v[38:39], v5 offset:17408
v_mfma_f32_16x16x32_bf16 v[152:155], v[52:55], v[72:75], v[152:155]
ds_read_b64_tr_b16 v[40:41], v6 offset:16384
v_mfma_f32_16x16x32_bf16 v[156:159], v[52:55], v[76:79], v[156:159]
ds_read_b64_tr_b16 v[42:43], v6 offset:17408
v_mfma_f32_16x16x32_bf16 v[160:163], v[56:59], v[64:67], v[160:163]
ds_read_b64_tr_b16 v[44:45], v7 offset:16384
v_mfma_f32_16x16x32_bf16 v[164:167], v[56:59], v[68:71], v[164:167]
ds_read_b64_tr_b16 v[46:47], v7 offset:17408
v_mfma_f32_16x16x32_bf16 v[168:171], v[56:59], v[72:75], v[168:171]
v_mfma_f32_16x16x32_bf16 v[172:175], v[56:59], v[76:79], v[172:175]
v_mfma_f32_16x16x32_bf16 v[176:179], v[60:63], v[64:67], v[176:179]
v_mfma_f32_16x16x32_bf16 v[180:183], v[60:63], v[68:71], v[180:183]
v_mfma_f32_16x16x32_bf16 v[184:187], v[60:63], v[72:75], v[184:187]
v_mfma_f32_16x16x32_bf16 v[188:191], v[60:63], v[76:79], v[188:191]
s_waitcnt lgkmcnt(0)
v_mfma_f32_16x16x32_bf16 v[128:131], v[16:19], v[32:35], v[128:131]
ds_read_b128 v[48:51], v3 offset:49152
ds_read_b128 v[52:55], v3 offset:51200
v_mfma_f32_16x16x32_bf16 v[132:135], v[16:19], v[36:39], v[132:135]
ds_read_b128 v[56:59], v3 offset:53248
v_mfma_f32_16x16x32_bf16 v[136:139], v[16:19], v[40:43], v[136:139]
ds_read_b128 v[60:63], v3 offset:55296
v_mfma_f32_16x16x32_bf16 v[140:143], v[16:19], v[44:47], v[140:143]
ds_read_b64_tr_b16 v[64:65], v4 offset:24576
v_mfma_f32_16x16x32_bf16 v[144:147], v[20:23], v[32:35], v[144:147]
ds_read_b64_tr_b16 v[66:67], v4 offset:25600
v_mfma_f32_16x16x32_bf16 v[148:151], v[20:23], v[36:39], v[148:151]
ds_read_b64_tr_b16 v[68:69], v5 offset:24576
ds_read_b64_tr_b16 v[70:71], v5 offset:25600
v_mfma_f32_16x16x32_bf16 v[152:155], v[20:23], v[40:43], v[152:155]
ds_read_b64_tr_b16 v[72:73], v6 offset:24576
v_mfma_f32_16x16x32_bf16 v[156:159], v[20:23], v[44:47], v[156:159]
ds_read_b64_tr_b16 v[74:75], v6 offset:25600
v_mfma_f32_16x16x32_bf16 v[160:163], v[24:27], v[32:35], v[160:163]
ds_read_b64_tr_b16 v[76:77], v7 offset:24576
v_mfma_f32_16x16x32_bf16 v[164:167], v[24:27], v[36:39], v[164:167]
ds_read_b64_tr_b16 v[78:79], v7 offset:25600
v_mfma_f32_16x16x32_bf16 v[168:171], v[24:27], v[40:43], v[168:171]
v_mfma_f32_16x16x32_bf16 v[172:175], v[24:27], v[44:47], v[172:175]
v_mfma_f32_16x16x32_bf16 v[176:179], v[28:31], v[32:35], v[176:179]
v_mfma_f32_16x16x32_bf16 v[180:183], v[28:31], v[36:39], v[180:183]
v_mfma_f32_16x16x32_bf16 v[184:187], v[28:31], v[40:43], v[184:187]
s_waitcnt lgkmcnt(0)
v_mfma_f32_16x16x32_bf16 v[188:191], v[28:31], v[44:47], v[188:191]
s_barrier
v_mfma_f32_16x16x32_bf16 v[128:131], v[48:51], v[64:67], v[128:131]
ds_read_b128 v[16:19], v2 offset:0
ds_read_b128 v[20:23], v2 offset:2048
v_mfma_f32_16x16x32_bf16 v[132:135], v[48:51], v[68:71], v[132:135]
ds_read_b128 v[24:27], v2 offset:4096
v_mfma_f32_16x16x32_bf16 v[136:139], v[48:51], v[72:75], v[136:139]
ds_read_b128 v[28:31], v2 offset:6144
v_mfma_f32_16x16x32_bf16 v[140:143], v[48:51], v[76:79], v[140:143]
ds_read_b64_tr_b16 v[32:33], v4 offset:32768
v_mfma_f32_16x16x32_bf16 v[144:147], v[52:55], v[64:67], v[144:147]
ds_read_b64_tr_b16 v[34:35], v4 offset:33792
v_mfma_f32_16x16x32_bf16 v[148:151], v[52:55], v[68:71], v[148:151]
ds_read_b64_tr_b16 v[36:37], v5 offset:32768
ds_read_b64_tr_b16 v[38:39], v5 offset:33792
v_mfma_f32_16x16x32_bf16 v[152:155], v[52:55], v[72:75], v[152:155]
ds_read_b64_tr_b16 v[40:41], v6 offset:32768
v_mfma_f32_16x16x32_bf16 v[156:159], v[52:55], v[76:79], v[156:159]
ds_read_b64_tr_b16 v[42:43], v6 offset:33792
v_mfma_f32_16x16x32_bf16 v[160:163], v[56:59], v[64:67], v[160:163]
ds_read_b64_tr_b16 v[44:45], v7 offset:32768
v_mfma_f32_16x16x32_bf16 v[164:167], v[56:59], v[68:71], v[164:167]
ds_read_b64_tr_b16 v[46:47], v7 offset:33792
v_mfma_f32_16x16x32_bf16 v[168:171], v[56:59], v[72:75], v[168:171]
v_mfma_f32_16x16x32_bf16 v[172:175], v[56:59], v[76:79], v[172:175]
v_mfma_f32_16x16x32_bf16 v[176:179], v[60:63], v[64:67], v[176:179]
v_mfma_f32_16x16x32_bf16 v[180:183], v[60:63], v[68:71], v[180:183]
v_mfma_f32_16x16x32_bf16 v[184:187], v[60:63], v[72:75], v[184:187]
v_mfma_f32_16x16x32_bf16 v[188:191], v[60:63], v[76:79], v[188:191]
s_waitcnt lgkmcnt(0)
v_mfma_f32_16x16x32_bf16 v[128:131], v[16:19], v[32:35], v[128:131]
ds_read_b128 v[48:51], v3 offset:0
ds_read_b128 v[52:55], v3 offset:2048
v_mfma_f32_16x16x32_bf16 v[132:135], v[16:19], v[36:39], v[132:135]
ds_read_b128 v[56:59], v3 offset:4096
v_mfma_f32_16x16x32_bf16 v[136:139], v[16:19], v[40:43], v[136:139]
ds_read_b128 v[60:63], v3 offset:6144
v_mfma_f32_16x16x32_bf16 v[140:143], v[16:19], v[44:47], v[140:143]
ds_read_b64_tr_b16 v[64:65], v4 offset:40960
v_mfma_f32_16x16x32_bf16 v[144:147], v[20:23], v[32:35], v[144:147]
ds_read_b64_tr_b16 v[66:67], v4 offset:41984
v_mfma_f32_16x16x32_bf16 v[148:151], v[20:23], v[36:39], v[148:151]
ds_read_b64_tr_b16 v[68:69], v5 offset:40960
ds_read_b64_tr_b16 v[70:71], v5 offset:41984
v_mfma_f32_16x16x32_bf16 v[152:155], v[20:23], v[40:43], v[152:155]
ds_read_b64_tr_b16 v[72:73], v6 offset:40960
v_mfma_f32_16x16x32_bf16 v[156:159], v[20:23], v[44:47], v[156:159]
ds_read_b64_tr_b16 v[74:75], v6 offset:41984
v_mfma_f32_16x16x32_bf16 v[160:163], v[24:27], v[32:35], v[160:163]
ds_read_b64_tr_b16 v[76:77], v7 offset:40960
v_mfma_f32_16x16x32_bf16 v[164:167], v[24:27], v[36:39], v[164:167]
ds_read_b64_tr_b16 v[78:79], v7 offset:41984
v_mfma_f32_16x16x32_bf16 v[168:171], v[24:27], v[40:43], v[168:171]
v_mfma_f32_16x16x32_bf16 v[172:175], v[24:27], v[44:47], v[172:175]
v_mfma_f32_16x16x32_bf16 v[176:179], v[28:31], v[32:35], v[176:179]
v_mfma_f32_16x16x32_bf16 v[180:183], v[28:31], v[36:39], v[180:183]
v_mfma_f32_16x16x32_bf16 v[184:187], v[28:31], v[40:43], v[184:187]
s_waitcnt lgkmcnt(0)
v_mfma_f32_16x16x32_bf16 v[188:191], v[28:31], v[44:47], v[188:191]
s_barrier
v_mfma_f32_16x16x32_bf16 v[128:131], v[48:51], v[64:67], v[128:131]
ds_read_b128 v[16:19], v2 offset:16384
ds_read_b128 v[20:23], v2 offset:18432
v_mfma_f32_16x16x32_bf16 v[132:135], v[48:51], v[68:71], v[132:135]
ds_read_b128 v[24:27], v2 offset:20480
v_mfma_f32_16x16x32_bf16 v[136:139], v[48:51], v[72:75], v[136:139]
ds_read_b128 v[28:31], v2 offset:22528
v_mfma_f32_16x16x32_bf16 v[140:143], v[48:51], v[76:79], v[140:143]
ds_read_b64_tr_b16 v[32:33], v8 offset:0
v_mfma_f32_16x16x32_bf16 v[144:147], v[52:55], v[64:67], v[144:147]
ds_read_b64_tr_b16 v[34:35], v8 offset:1024
v_mfma_f32_16x16x32_bf16 v[148:151], v[52:55], v[68:71], v[148:151]
ds_read_b64_tr_b16 v[36:37], v9 offset:0
ds_read_b64_tr_b16 v[38:39], v9 offset:1024
v_mfma_f32_16x16x32_bf16 v[152:155], v[52:55], v[72:75], v[152:155]
ds_read_b64_tr_b16 v[40:41], v10 offset:0
v_mfma_f32_16x16x32_bf16 v[156:159], v[52:55], v[76:79], v[156:159]
ds_read_b64_tr_b16 v[42:43], v10 offset:1024
v_mfma_f32_16x16x32_bf16 v[160:163], v[56:59], v[64:67], v[160:163]
ds_read_b64_tr_b16 v[44:45], v11 offset:0
v_mfma_f32_16x16x32_bf16 v[164:167], v[56:59], v[68:71], v[164:167]
ds_read_b64_tr_b16 v[46:47], v11 offset:1024
v_mfma_f32_16x16x32_bf16 v[168:171], v[56:59], v[72:75], v[168:171]
v_mfma_f32_16x16x32_bf16 v[172:175], v[56:59], v[76:79], v[172:175]
v_mfma_f32_16x16x32_bf16 v[176:179], v[60:63], v[64:67], v[176:179]
v_mfma_f32_16x16x32_bf16 v[180:183], v[60:63], v[68:71], v[180:183]
v_mfma_f32_16x16x32_bf16 v[184:187], v[60:63], v[72:75], v[184:187]
v_mfma_f32_16x16x32_bf16 v[188:191], v[60:63], v[76:79], v[188:191]
s_waitcnt lgkmcnt(0)
v_mfma_f32_16x16x32_bf16 v[128:131], v[16:19], v[32:35], v[128:131]
ds_read_b128 v[48:51], v3 offset:16384
ds_read_b128 v[52:55], v3 offset:18432
v_mfma_f32_16x16x32_bf16 v[132:135], v[16:19], v[36:39], v[132:135]
ds_read_b128 v[56:59], v3 offset:20480
v_mfma_f32_16x16x32_bf16 v[136:139], v[16:19], v[40:43], v[136:139]
ds_read_b128 v[60:63], v3 offset:22528
v_mfma_f32_16x16x32_bf16 v[140:143], v[16:19], v[44:47], v[140:143]
ds_read_b64_tr_b16 v[64:65], v8 offset:8192
v_mfma_f32_16x16x32_bf16 v[144:147], v[20:23], v[32:35], v[144:147]
ds_read_b64_tr_b16 v[66:67], v8 offset:9216
v_mfma_f32_16x16x32_bf16 v[148:151], v[20:23], v[36:39], v[148:151]
ds_read_b64_tr_b16 v[68:69], v9 offset:8192
ds_read_b64_tr_b16 v[70:71], v9 offset:9216
v_mfma_f32_16x16x32_bf16 v[152:155], v[20:23], v[40:43], v[152:155]
ds_read_b64_tr_b16 v[72:73], v10 offset:8192
v_mfma_f32_16x16x32_bf16 v[156:159], v[20:23], v[44:47], v[156:159]
ds_read_b64_tr_b16 v[74:75], v10 offset:9216
v_mfma_f32_16x16x32_bf16 v[160:163], v[24:27], v[32:35], v[160:163]
ds_read_b64_tr_b16 v[76:77], v11 offset:8192
v_mfma_f32_16x16x32_bf16 v[164:167], v[24:27], v[36:39], v[164:167]
ds_read_b64_tr_b16 v[78:79], v11 offset:9216
v_mfma_f32_16x16x32_bf16 v[168:171], v[24:27], v[40:43], v[168:171]
v_mfma_f32_16x16x32_bf16 v[172:175], v[24:27], v[44:47], v[172:175]
v_mfma_f32_16x16x32_bf16 v[176:179], v[28:31], v[32:35], v[176:179]
v_mfma_f32_16x16x32_bf16 v[180:183], v[28:31], v[36:39], v[180:183]
v_mfma_f32_16x16x32_bf16 v[184:187], v[28:31], v[40:43], v[184:187]
s_waitcnt lgkmcnt(0)
v_mfma_f32_16x16x32_bf16 v[188:191], v[28:31], v[44:47], v[188:191]
s_barrier
v_mfma_f32_16x16x32_bf16 v[128:131], v[48:51], v[64:67], v[128:131]
ds_read_b128 v[16:19], v2 offset:32768
ds_read_b128 v[20:23], v2 offset:34816
v_mfma_f32_16x16x32_bf16 v[132:135], v[48:51], v[68:71], v[132:135]
ds_read_b128 v[24:27], v2 offset:36864
v_mfma_f32_16x16x32_bf16 v[136:139], v[48:51], v[72:75], v[136:139]
ds_read_b128 v[28:31], v2 offset:38912
v_mfma_f32_16x16x32_bf16 v[140:143], v[48:51], v[76:79], v[140:143]
ds_read_b64_tr_b16 v[32:33], v8 offset:16384
v_mfma_f32_16x16x32_bf16 v[144:147], v[52:55], v[64:67], v[144:147]
ds_read_b64_tr_b16 v[34:35], v8 offset:17408
v_mfma_f32_16x16x32_bf16 v[148:151], v[52:55], v[68:71], v[148:151]
ds_read_b64_tr_b16 v[36:37], v9 offset:16384
ds_read_b64_tr_b16 v[38:39], v9 offset:17408
v_mfma_f32_16x16x32_bf16 v[152:155], v[52:55], v[72:75], v[152:155]
ds_read_b64_tr_b16 v[40:41], v10 offset:16384
v_mfma_f32_16x16x32_bf16 v[156:159], v[52:55], v[76:79], v[156:159]
ds_read_b64_tr_b16 v[42:43], v10 offset:17408
v_mfma_f32_16x16x32_bf16 v[160:163], v[56:59], v[64:67], v[160:163]
ds_read_b64_tr_b16 v[44:45], v11 offset:16384
v_mfma_f32_16x16x32_bf16 v[164:167], v[56:59], v[68:71], v[164:167]
ds_read_b64_tr_b16 v[46:47], v11 offset:17408
v_mfma_f32_16x16x32_bf16 v[168:171], v[56:59], v[72:75], v[168:171]
v_mfma_f32_16x16x32_bf16 v[172:175], v[56:59], v[76:79], v[172:175]
v_mfma_f32_16x16x32_bf16 v[176:179], v[60:63], v[64:67], v[176:179]
v_mfma_f32_16x16x32_bf16 v[180:183], v[60:63], v[68:71], v[180:183]
v_mfma_f32_16x16x32_bf16 v[184:187], v[60:63], v[72:75], v[184:187]
v_mfma_f32_16x16x32_bf16 v[188:191], v[60:63], v[76:79], v[188:191]
s_waitcnt lgkmcnt(0)
v_mfma_f32_16x16x32_bf16 v[128:131], v[16:19], v[32:35], v[128:131]
ds_read_b128 v[48:51], v3 offset:32768
ds_read_b128 v[52:55], v3 offset:34816
v_mfma_f32_16x16x32_bf16 v[132:135], v[16:19], v[36:39], v[132:135]
ds_read_b128 v[56:59], v3 offset:36864
v_mfma_f32_16x16x32_bf16 v[136:139], v[16:19], v[40:43], v[136:139]
ds_read_b128 v[60:63], v3 offset:38912
v_mfma_f32_16x16x32_bf16 v[140:143], v[16:19], v[44:47], v[140:143]
ds_read_b64_tr_b16 v[64:65], v8 offset:24576
v_mfma_f32_16x16x32_bf16 v[144:147], v[20:23], v[32:35], v[144:147]
ds_read_b64_tr_b16 v[66:67], v8 offset:25600
v_mfma_f32_16x16x32_bf16 v[148:151], v[20:23], v[36:39], v[148:151]
ds_read_b64_tr_b16 v[68:69], v9 offset:24576
ds_read_b64_tr_b16 v[70:71], v9 offset:25600
v_mfma_f32_16x16x32_bf16 v[152:155], v[20:23], v[40:43], v[152:155]
ds_read_b64_tr_b16 v[72:73], v10 offset:24576
v_mfma_f32_16x16x32_bf16 v[156:159], v[20:23], v[44:47], v[156:159]
ds_read_b64_tr_b16 v[74:75], v10 offset:25600
v_mfma_f32_16x16x32_bf16 v[160:163], v[24:27], v[32:35], v[160:163]
ds_read_b64_tr_b16 v[76:77], v11 offset:24576
v_mfma_f32_16x16x32_bf16 v[164:167], v[24:27], v[36:39], v[164:167]
ds_read_b64_tr_b16 v[78:79], v11 offset:25600
v_mfma_f32_16x16x32_bf16 v[168:171], v[24:27], v[40:43], v[168:171]
v_mfma_f32_16x16x32_bf16 v[172:175], v[24:27], v[44:47], v[172:175]
v_mfma_f32_16x16x32_bf16 v[176:179], v[28:31], v[32:35], v[176:179]
v_mfma_f32_16x16x32_bf16 v[180:183], v[28:31], v[36:39], v[180:183]
v_mfma_f32_16x16x32_bf16 v[184:187], v[28:31], v[40:43], v[184:187]
s_waitcnt lgkmcnt(0)
v_mfma_f32_16x16x32_bf16 v[188:191], v[28:31], v[44:47], v[188:191]
s_barrier
v_mfma_f32_16x16x32_bf16 v[128:131], v[48:51], v[64:67], v[128:131]
ds_read_b128 v[16:19], v2 offset:49152
ds_read_b128 v[20:23], v2 offset:51200
v_mfma_f32_16x16x32_bf16 v[132:135], v[48:51], v[68:71], v[132:135]
ds_read_b128 v[24:27], v2 offset:53248
v_mfma_f32_16x16x32_bf16 v[136:139], v[48:51], v[72:75], v[136:139]
ds_read_b128 v[28:31], v2 offset:55296
v_mfma_f32_16x16x32_bf16 v[140:143], v[48:51], v[76:79], v[140:143]
ds_read_b64_tr_b16 v[32:33], v8 offset:32768
v_mfma_f32_16x16x32_bf16 v[144:147], v[52:55], v[64:67], v[144:147]
ds_read_b64_tr_b16 v[34:35], v8 offset:33792
v_mfma_f32_16x16x32_bf16 v[148:151], v[52:55], v[68:71], v[148:151]
ds_read_b64_tr_b16 v[36:37], v9 offset:32768
ds_read_b64_tr_b16 v[38:39], v9 offset:33792
v_mfma_f32_16x16x32_bf16 v[152:155], v[52:55], v[72:75], v[152:155]
ds_read_b64_tr_b16 v[40:41], v10 offset:32768
v_mfma_f32_16x16x32_bf16 v[156:159], v[52:55], v[76:79], v[156:159]
ds_read_b64_tr_b16 v[42:43], v10 offset:33792
v_mfma_f32_16x16x32_bf16 v[160:163], v[56:59], v[64:67], v[160:163]
ds_read_b64_tr_b16 v[44:45], v11 offset:32768
v_mfma_f32_16x16x32_bf16 v[164:167], v[56:59], v[68:71], v[164:167]
ds_read_b64_tr_b16 v[46:47], v11 offset:33792
v_mfma_f32_16x16x32_bf16 v[168:171], v[56:59], v[72:75], v[168:171]
v_mfma_f32_16x16x32_bf16 v[172:175], v[56:59], v[76:79], v[172:175]
v_mfma_f32_16x16x32_bf16 v[176:179], v[60:63], v[64:67], v[176:179]
v_mfma_f32_16x16x32_bf16 v[180:183], v[60:63], v[68:71], v[180:183]
v_mfma_f32_16x16x32_bf16 v[184:187], v[60:63], v[72:75], v[184:187]
v_mfma_f32_16x16x32_bf16 v[188:191], v[60:63], v[76:79], v[188:191]
s_waitcnt lgkmcnt(0)
v_mfma_f32_16x16x32_bf16 v[128:131], v[16:19], v[32:35], v[128:131]
ds_read_b128 v[48:51], v3 offset:49152
ds_read_b128 v[52:55], v3 offset:51200
v_mfma_f32_16x16x32_bf16 v[132:135], v[16:19], v[36:39], v[132:135]
ds_read_b128 v[56:59], v3 offset:53248
v_mfma_f32_16x16x32_bf16 v[136:139], v[16:19], v[40:43], v[136:139]
ds_read_b128 v[60:63], v3 offset:55296
v_mfma_f32_16x16x32_bf16 v[140:143], v[16:19], v[44:47], v[140:143]
ds_read_b64_tr_b16 v[64:65], v8 offset:40960
v_mfma_f32_16x16x32_bf16 v[144:147], v[20:23], v[32:35], v[144:147]
ds_read_b64_tr_b16 v[66:67], v8 offset:41984
v_mfma_f32_16x16x32_bf16 v[148:151], v[20:23], v[36:39], v[148:151]
ds_read_b64_tr_b16 v[68:69], v9 offset:40960
ds_read_b64_tr_b16 v[70:71], v9 offset:41984
v_mfma_f32_16x16x32_bf16 v[152:155], v[20:23], v[40:43], v[152:155]
ds_read_b64_tr_b16 v[72:73], v10 offset:40960
v_mfma_f32_16x16x32_bf16 v[156:159], v[20:23], v[44:47], v[156:159]
ds_read_b64_tr_b16 v[74:75], v10 offset:41984
v_mfma_f32_16x16x32_bf16 v[160:163], v[24:27], v[32:35], v[160:163]
ds_read_b64_tr_b16 v[76:77], v11 offset:40960
v_mfma_f32_16x16x32_bf16 v[164:167], v[24:27], v[36:39], v[164:167]
ds_read_b64_tr_b16 v[78:79], v11 offset:41984
v_mfma_f32_16x16x32_bf16 v[168:171], v[24:27], v[40:43], v[168:171]
v_mfma_f32_16x16x32_bf16 v[172:175], v[24:27], v[44:47], v[172:175]
v_mfma_f32_16x16x32_bf16 v[176:179], v[28:31], v[32:35], v[176:179]
v_mfma_f32_16x16x32_bf16 v[180:183], v[28:31], v[36:39], v[180:183]
v_mfma_f32_16x16x32_bf16 v[184:187], v[28:31], v[40:43], v[184:187]
s_waitcnt lgkmcnt(0)
v_mfma_f32_16x16x32_bf16 v[188:191], v[28:31], v[44:47], v[188:191]
s_barrier
v_mfma_f32_16x16x32_bf16 v[128:131], v[48:51], v[64:67], v[128:131]
ds_read_b128 v[16:19], v2 offset:0
ds_read_b128 v[20:23], v2 offset:2048
v_mfma_f32_16x16x32_bf16 v[132:135], v[48:51], v[68:71], v[132:135]
ds_read_b128 v[24:27], v2 offset:4096
v_mfma_f32_16x16x32_bf16 v[136:139], v[48:51], v[72:75], v[136:139]
ds_read_b128 v[28:31], v2 offset:6144
v_mfma_f32_16x16x32_bf16 v[140:143], v[48:51], v[76:79], v[140:143]
ds_read_b64_tr_b16 v[32:33], v4 offset:0
v_mfma_f32_16x16x32_bf16 v[144:147], v[52:55], v[64:67], v[144:147]
ds_read_b64_tr_b16 v[34:35], v4 offset:1024
v_mfma_f32_16x16x32_bf16 v[148:151], v[52:55], v[68:71], v[148:151]
ds_read_b64_tr_b16 v[36:37], v5 offset:0
ds_read_b64_tr_b16 v[38:39], v5 offset:1024
v_mfma_f32_16x16x32_bf16 v[152:155], v[52:55], v[72:75], v[152:155]
ds_read_b64_tr_b16 v[40:41], v6 offset:0
v_mfma_f32_16x16x32_bf16 v[156:159], v[52:55], v[76:79], v[156:159]
ds_read_b64_tr_b16 v[42:43], v6 offset:1024
v_mfma_f32_16x16x32_bf16 v[160:163], v[56:59], v[64:67], v[160:163]
ds_read_b64_tr_b16 v[44:45], v7 offset:0
v_mfma_f32_16x16x32_bf16 v[164:167], v[56:59], v[68:71], v[164:167]
ds_read_b64_tr_b16 v[46:47], v7 offset:1024
v_mfma_f32_16x16x32_bf16 v[168:171], v[56:59], v[72:75], v[168:171]
v_mfma_f32_16x16x32_bf16 v[172:175], v[56:59], v[76:79], v[172:175]
v_mfma_f32_16x16x32_bf16 v[176:179], v[60:63], v[64:67], v[176:179]
v_mfma_f32_16x16x32_bf16 v[180:183], v[60:63], v[68:71], v[180:183]
v_mfma_f32_16x16x32_bf16 v[184:187], v[60:63], v[72:75], v[184:187]
v_mfma_f32_16x16x32_bf16 v[188:191], v[60:63], v[76:79], v[188:191]
s_waitcnt lgkmcnt(0)
v_mfma_f32_16x16x32_bf16 v[128:131], v[16:19], v[32:35], v[128:131]
ds_read_b128 v[48:51], v3 offset:0
ds_read_b128 v[52:55], v3 offset:2048
v_mfma_f32_16x16x32_bf16 v[132:135], v[16:19], v[36:39], v[132:135]
ds_read_b128 v[56:59], v3 offset:4096
v_mfma_f32_16x16x32_bf16 v[136:139], v[16:19], v[40:43], v[136:139]
ds_read_b128 v[60:63], v3 offset:6144
v_mfma_f32_16x16x32_bf16 v[140:143], v[16:19], v[44:47], v[140:143]
ds_read_b64_tr_b16 v[64:65], v4 offset:8192
v_mfma_f32_16x16x32_bf16 v[144:147], v[20:23], v[32:35], v[144:147]
ds_read_b64_tr_b16 v[66:67], v4 offset:9216
v_mfma_f32_16x16x32_bf16 v[148:151], v[20:23], v[36:39], v[148:151]
ds_read_b64_tr_b16 v[68:69], v5 offset:8192
ds_read_b64_tr_b16 v[70:71], v5 offset:9216
v_mfma_f32_16x16x32_bf16 v[152:155], v[20:23], v[40:43], v[152:155]
ds_read_b64_tr_b16 v[72:73], v6 offset:8192
v_mfma_f32_16x16x32_bf16 v[156:159], v[20:23], v[44:47], v[156:159]
ds_read_b64_tr_b16 v[74:75], v6 offset:9216
v_mfma_f32_16x16x32_bf16 v[160:163], v[24:27], v[32:35], v[160:163]
ds_read_b64_tr_b16 v[76:77], v7 offset:8192
v_mfma_f32_16x16x32_bf16 v[164:167], v[24:27], v[36:39], v[164:167]
ds_read_b64_tr_b16 v[78:79], v7 offset:9216
v_mfma_f32_16x16x32_bf16 v[168:171], v[24:27], v[40:43], v[168:171]
v_mfma_f32_16x16x32_bf16 v[172:175], v[24:27], v[44:47], v[172:175]
v_mfma_f32_16x16x32_bf16 v[176:179], v[28:31], v[32:35], v[176:179]
v_mfma_f32_16x16x32_bf16 v[180:183], v[28:31], v[36:39], v[180:183]
v_mfma_f32_16x16x32_bf16 v[184:187], v[28:31], v[40:43], v[184:187]
s_waitcnt lgkmcnt(0)
v_mfma_f32_16x16x32_bf16 v[188:191], v[28:31], v[44:47], v[188:191]
s_barrier
v_mfma_f32_16x16x32_bf16 v[128:131], v[48:51], v[64:67], v[128:131]
ds_read_b128 v[16:19], v2 offset:16384
ds_read_b128 v[20:23], v2 offset:18432
v_mfma_f32_16x16x32_bf16 v[132:135], v[48:51], v[68:71], v[132:135]
ds_read_b128 v[24:27], v2 offset:20480
v_mfma_f32_16x16x32_bf16 v[136:139], v[48:51], v[72:75], v[136:139]
ds_read_b128 v[28:31], v2 offset:22528
v_mfma_f32_16x16x32_bf16 v[140:143], v[48:51], v[76:79], v[140:143]
ds_read_b64_tr_b16 v[32:33], v4 offset:16384
v_mfma_f32_16x16x32_bf16 v[144:147], v[52:55], v[64:67], v[144:147]
ds_read_b64_tr_b16 v[34:35], v4 offset:17408
v_mfma_f32_16x16x32_bf16 v[148:151], v[52:55], v[68:71], v[148:151]
ds_read_b64_tr_b16 v[36:37], v5 offset:16384
ds_read_b64_tr_b16 v[38:39], v5 offset:17408
v_mfma_f32_16x16x32_bf16 v[152:155], v[52:55], v[72:75], v[152:155]
ds_read_b64_tr_b16 v[40:41], v6 offset:16384
v_mfma_f32_16x16x32_bf16 v[156:159], v[52:55], v[76:79], v[156:159]
ds_read_b64_tr_b16 v[42:43], v6 offset:17408
v_mfma_f32_16x16x32_bf16 v[160:163], v[56:59], v[64:67], v[160:163]
ds_read_b64_tr_b16 v[44:45], v7 offset:16384
v_mfma_f32_16x16x32_bf16 v[164:167], v[56:59], v[68:71], v[164:167]
ds_read_b64_tr_b16 v[46:47], v7 offset:17408
v_mfma_f32_16x16x32_bf16 v[168:171], v[56:59], v[72:75], v[168:171]
v_mfma_f32_16x16x32_bf16 v[172:175], v[56:59], v[76:79], v[172:175]
v_mfma_f32_16x16x32_bf16 v[176:179], v[60:63], v[64:67], v[176:179]
v_mfma_f32_16x16x32_bf16 v[180:183], v[60:63], v[68:71], v[180:183]
v_mfma_f32_16x16x32_bf16 v[184:187], v[60:63], v[72:75], v[184:187]
v_mfma_f32_16x16x32_bf16 v[188:191], v[60:63], v[76:79], v[188:191]
s_waitcnt lgkmcnt(0)
v_mfma_f32_16x16x32_bf16 v[128:131], v[16:19], v[32:35], v[128:131]
ds_read_b128 v[48:51], v3 offset:16384
ds_read_b128 v[52:55], v3 offset:18432
v_mfma_f32_16x16x32_bf16 v[132:135], v[16:19], v[36:39], v[132:135]
ds_read_b128 v[56:59], v3 offset:20480
ds_read_b128 v[60:63], v3 offset:22528
v_mfma_f32_16x16x32_bf16 v[136:139], v[16:19], v[40:43], v[136:139]
ds_read_b64_tr_b16 v[64:65], v4 offset:24576
v_mfma_f32_16x16x32_bf16 v[140:143], v[16:19], v[44:47], v[140:143]
ds_read_b64_tr_b16 v[66:67], v4 offset:25600
ds_read_b64_tr_b16 v[68:69], v5 offset:24576
v_mfma_f32_16x16x32_bf16 v[144:147], v[20:23], v[32:35], v[144:147]
ds_read_b64_tr_b16 v[70:71], v5 offset:25600
ds_read_b64_tr_b16 v[72:73], v6 offset:24576
v_mfma_f32_16x16x32_bf16 v[148:151], v[20:23], v[36:39], v[148:151]
ds_read_b64_tr_b16 v[74:75], v6 offset:25600
v_mfma_f32_16x16x32_bf16 v[152:155], v[20:23], v[40:43], v[152:155]
ds_read_b64_tr_b16 v[76:77], v7 offset:24576
ds_read_b64_tr_b16 v[78:79], v7 offset:25600
v_mfma_f32_16x16x32_bf16 v[156:159], v[20:23], v[44:47], v[156:159]
ds_read_b128 v[96:99], v13 offset:0
ds_read_b128 v[100:103], v13 offset:64
v_mfma_f32_16x16x32_bf16 v[160:163], v[24:27], v[32:35], v[160:163]
ds_read_b128 v[104:107], v13 offset:128
v_mfma_f32_16x16x32_bf16 v[164:167], v[24:27], v[36:39], v[164:167]
ds_read_b128 v[108:111], v13 offset:192
ds_read_b128 v[112:115], v13 offset:512
v_mfma_f32_16x16x32_bf16 v[168:171], v[24:27], v[40:43], v[168:171]
ds_read_b128 v[116:119], v13 offset:576
ds_read_b128 v[120:123], v13 offset:640
v_mfma_f32_16x16x32_bf16 v[172:175], v[24:27], v[44:47], v[172:175]
ds_read_b128 v[124:127], v13 offset:704
s_waitcnt lgkmcnt(0)
v_mfma_f32_16x16x32_bf16 v[128:131], v[48:51], v[64:67], v[128:131]
s_barrier
ds_read_b64 v[200:201], v1
v_mfma_f32_16x16x32_bf16 v[132:135], v[48:51], v[68:71], v[132:135]
ds_read_b32 v192, v12 offset:0
v_mfma_f32_16x16x32_bf16 v[136:139], v[48:51], v[72:75], v[136:139]
ds_read_b32 v194, v12 offset:64
ds_read_b32 v196, v12 offset:128
v_mfma_f32_16x16x32_bf16 v[140:143], v[48:51], v[76:79], v[140:143]
ds_read_b32 v198, v12 offset:192
v_mfma_f32_16x16x32_bf16 v[144:147], v[52:55], v[64:67], v[144:147]
s_nop 1
v_mfma_f32_16x16x32_bf16 v[148:151], v[52:55], v[68:71], v[148:151]
s_nop 1
v_mfma_f32_16x16x32_bf16 v[152:155], v[52:55], v[72:75], v[152:155]
s_waitcnt lgkmcnt(0)
v_readfirstlane_b32 s8, v200
v_readfirstlane_b32 s98, v201
v_mfma_f32_16x16x32_bf16 v[156:159], v[52:55], v[76:79], v[156:159]
v_sub_f32 v192, 0, v192
v_sub_f32 v194, 0, v194
v_sub_f32 v196, 0, v196
v_mfma_f32_16x16x32_bf16 v[160:163], v[56:59], v[64:67], v[160:163]
v_sub_f32 v198, 0, v198
v_fmac_f32 v128, v192, v96
v_fmac_f32 v129, v192, v97
v_mfma_f32_16x16x32_bf16 v[164:167], v[56:59], v[68:71], v[164:167]
v_fmac_f32 v130, v192, v98
v_fmac_f32 v131, v192, v99
v_fmac_f32 v132, v194, v96
v_mfma_f32_16x16x32_bf16 v[168:171], v[56:59], v[72:75], v[168:171]
v_fmac_f32 v133, v194, v97
v_fmac_f32 v134, v194, v98
v_fmac_f32 v135, v194, v99
v_mfma_f32_16x16x32_bf16 v[172:175], v[56:59], v[76:79], v[172:175]
v_fmac_f32 v136, v196, v96
v_fmac_f32 v137, v196, v97
v_fmac_f32 v138, v196, v98
v_mfma_f32_16x16x32_bf16 v[176:179], v[28:31], v[32:35], v[176:179]
v_fmac_f32 v139, v196, v99
v_fmac_f32 v140, v198, v96
v_fmac_f32 v141, v198, v97
v_mfma_f32_16x16x32_bf16 v[180:183], v[28:31], v[36:39], v[180:183]
v_fmac_f32 v142, v198, v98
v_fmac_f32 v143, v198, v99
v_mul_f32 v128, v112, v128
v_mfma_f32_16x16x32_bf16 v[184:187], v[28:31], v[40:43], v[184:187]
v_mul_f32 v129, v113, v129
v_mul_f32 v130, v114, v130
v_mul_f32 v131, v115, v131
v_mfma_f32_16x16x32_bf16 v[188:191], v[28:31], v[44:47], v[188:191]
v_mul_f32 v132, v112, v132
v_mul_f32 v133, v113, v133
v_mul_f32 v134, v114, v134
v_mfma_f32_16x16x32_bf16 v[176:179], v[60:63], v[64:67], v[176:179]
v_mul_f32 v135, v115, v135
v_cvt_pk_bf16_f32 v128, v128, v129
v_cvt_pk_bf16_f32 v129, v130, v131
v_mfma_f32_16x16x32_bf16 v[180:183], v[60:63], v[68:71], v[180:183]
v_cvt_pk_bf16_f32 v130, v132, v133
v_cvt_pk_bf16_f32 v131, v134, v135
s_nop 0
v_mfma_f32_16x16x32_bf16 v[184:187], v[60:63], v[72:75], v[184:187]
v_permlane32_swap_b32 v128, v130
v_permlane32_swap_b32 v129, v131
buffer_store_dwordx4 v[128:131], v202, s[36:39], s72 offen offset:0 sc1
v_mfma_f32_16x16x32_bf16 v[188:191], v[60:63], v[76:79], v[188:191]
v_mul_f32 v136, v112, v136
v_mul_f32 v137, v113, v137
v_mul_f32 v138, v114, v138
v_mul_f32 v139, v115, v139
v_mul_f32 v140, v112, v140
v_mul_f32 v141, v113, v141
v_mul_f32 v142, v114, v142
v_mul_f32 v143, v115, v143
v_cvt_pk_bf16_f32 v136, v136, v137
v_cvt_pk_bf16_f32 v137, v138, v139
v_cvt_pk_bf16_f32 v138, v140, v141
v_cvt_pk_bf16_f32 v139, v142, v143
s_nop 0
v_permlane32_swap_b32 v136, v138
v_permlane32_swap_b32 v137, v139
buffer_store_dwordx4 v[136:139], v203, s[36:39], s72 offen offset:0 sc1
v_fmac_f32 v144, v192, v100
v_fmac_f32 v145, v192, v101
v_fmac_f32 v146, v192, v102
v_fmac_f32 v147, v192, v103
v_fmac_f32 v148, v194, v100
v_fmac_f32 v149, v194, v101
v_fmac_f32 v150, v194, v102
v_fmac_f32 v151, v194, v103
v_fmac_f32 v152, v196, v100
v_fmac_f32 v153, v196, v101
v_fmac_f32 v154, v196, v102
v_fmac_f32 v155, v196, v103
v_fmac_f32 v156, v198, v100
v_fmac_f32 v157, v198, v101
v_fmac_f32 v158, v198, v102
v_fmac_f32 v159, v198, v103
v_mul_f32 v144, v116, v144
v_mul_f32 v145, v117, v145
v_mul_f32 v146, v118, v146
v_mul_f32 v147, v119, v147
v_mul_f32 v148, v116, v148
v_mul_f32 v149, v117, v149
v_mul_f32 v150, v118, v150
v_mul_f32 v151, v119, v151
v_cvt_pk_bf16_f32 v144, v144, v145
v_cvt_pk_bf16_f32 v145, v146, v147
v_cvt_pk_bf16_f32 v146, v148, v149
v_cvt_pk_bf16_f32 v147, v150, v151
s_nop 0
v_permlane32_swap_b32 v144, v146
v_permlane32_swap_b32 v145, v147
buffer_store_dwordx4 v[144:147], v202, s[36:39], s72 offen offset:640 sc1
v_mul_f32 v152, v116, v152
v_mul_f32 v153, v117, v153
v_mul_f32 v154, v118, v154
v_mul_f32 v155, v119, v155
v_mul_f32 v156, v116, v156
v_mul_f32 v157, v117, v157
v_mul_f32 v158, v118, v158
v_mul_f32 v159, v119, v159
v_cvt_pk_bf16_f32 v152, v152, v153
v_cvt_pk_bf16_f32 v153, v154, v155
v_cvt_pk_bf16_f32 v154, v156, v157
v_cvt_pk_bf16_f32 v155, v158, v159
s_nop 0
v_permlane32_swap_b32 v152, v154
v_permlane32_swap_b32 v153, v155
buffer_store_dwordx4 v[152:155], v203, s[36:39], s72 offen offset:640 sc1
v_fmac_f32 v160, v192, v104
v_fmac_f32 v161, v192, v105
v_fmac_f32 v162, v192, v106
v_fmac_f32 v163, v192, v107
v_fmac_f32 v164, v194, v104
v_fmac_f32 v165, v194, v105
v_fmac_f32 v166, v194, v106
v_fmac_f32 v167, v194, v107
v_fmac_f32 v168, v196, v104
v_fmac_f32 v169, v196, v105
v_fmac_f32 v170, v196, v106
v_fmac_f32 v171, v196, v107
v_fmac_f32 v172, v198, v104
v_fmac_f32 v173, v198, v105
v_fmac_f32 v174, v198, v106
v_fmac_f32 v175, v198, v107
v_pk_mul_f32 v[160:161], v[160:161], v[120:121]
v_pk_mul_f32 v[162:163], v[162:163], v[122:123]
v_pk_mul_f32 v[164:165], v[164:165], v[120:121]
v_pk_mul_f32 v[166:167], v[166:167], v[122:123]
v_cvt_pk_bf16_f32 v160, v160, v161
v_cvt_pk_bf16_f32 v161, v162, v163
v_cvt_pk_bf16_f32 v162, v164, v165
v_cvt_pk_bf16_f32 v163, v166, v167
s_nop 0
v_permlane32_swap_b32 v160, v162
v_permlane32_swap_b32 v161, v163
buffer_store_dwordx4 v[160:163], v202, s[36:39], s72 offen offset:1280 sc1
v_pk_mul_f32 v[168:169], v[168:169], v[120:121]
v_pk_mul_f32 v[170:171], v[170:171], v[122:123]
v_pk_mul_f32 v[172:173], v[172:173], v[120:121]
v_pk_mul_f32 v[174:175], v[174:175], v[122:123]
v_cvt_pk_bf16_f32 v168, v168, v169
v_cvt_pk_bf16_f32 v169, v170, v171
v_cvt_pk_bf16_f32 v170, v172, v173
v_cvt_pk_bf16_f32 v171, v174, v175
s_nop 0
v_permlane32_swap_b32 v168, v170
v_permlane32_swap_b32 v169, v171
buffer_store_dwordx4 v[168:171], v203, s[36:39], s72 offen offset:1280 sc1
v_fmac_f32 v176, v192, v108
v_fmac_f32 v177, v192, v109
v_fmac_f32 v178, v192, v110
v_fmac_f32 v179, v192, v111
v_fmac_f32 v180, v194, v108
v_fmac_f32 v181, v194, v109
v_fmac_f32 v182, v194, v110
v_fmac_f32 v183, v194, v111
v_fmac_f32 v184, v196, v108
v_fmac_f32 v185, v196, v109
v_fmac_f32 v186, v196, v110
v_fmac_f32 v187, v196, v111
v_fmac_f32 v188, v198, v108
v_fmac_f32 v189, v198, v109
v_fmac_f32 v190, v198, v110
v_fmac_f32 v191, v198, v111
v_pk_mul_f32 v[176:177], v[176:177], v[124:125]
v_pk_mul_f32 v[178:179], v[178:179], v[126:127]
v_pk_mul_f32 v[180:181], v[180:181], v[124:125]
v_pk_mul_f32 v[182:183], v[182:183], v[126:127]
v_cvt_pk_bf16_f32 v176, v176, v177
v_cvt_pk_bf16_f32 v177, v178, v179
v_cvt_pk_bf16_f32 v178, v180, v181
v_cvt_pk_bf16_f32 v179, v182, v183
s_nop 0
v_permlane32_swap_b32 v176, v178
v_permlane32_swap_b32 v177, v179
buffer_store_dwordx4 v[176:179], v202, s[36:39], s72 offen offset:1920 sc1
v_pk_mul_f32 v[184:185], v[184:185], v[124:125]
v_pk_mul_f32 v[186:187], v[186:187], v[126:127]
v_pk_mul_f32 v[188:189], v[188:189], v[124:125]
v_pk_mul_f32 v[190:191], v[190:191], v[126:127]
v_cvt_pk_bf16_f32 v184, v184, v185
v_cvt_pk_bf16_f32 v185, v186, v187
v_cvt_pk_bf16_f32 v186, v188, v189
v_cvt_pk_bf16_f32 v187, v190, v191
s_nop 0
v_permlane32_swap_b32 v184, v186
v_permlane32_swap_b32 v185, v187
buffer_store_dwordx4 v[184:187], v203, s[36:39], s72 offen offset:1920 sc1
qkv_fin_15:
s_lshl_b32 s80, s13, 3
s_add_u32 s80, s80, s6
s_lshl_b32 s80, s80, 2
s_add_u32 s80, s80, 51798016
s_add_u32 s81, s8, 1
v_mov_b32 v1, 0
v_mov_b32 v2, s81
s_lshl_b32 s67, s13, 5
s_add_u32 s67, s67, s6
s_lshl_b32 s67, s67, 2
s_add_u32 s67, s67, 22282240
s_waitcnt vmcnt(0)
s_cmp_eq_u32 s98, 0
s_cbranch_scc1 q1f_20
s_mov_b64 exec, 1
buffer_store_dword v2, v1, s[36:39], s80 offen
s_mov_b64 exec, -1
s_branch q1g_21
q1f_20:
s_mov_b64 exec, 1
buffer_store_dword v2, v1, s[36:39], s80 offen sc1
s_mov_b64 exec, -1
q1g_21:
s_mov_b64 exec, 1
buffer_store_dword v2, v1, s[36:39], s67 offen sc1
s_mov_b64 exec, -1
s_branch L_q1done
L_q1idle:
v_lshlrev_b32 v5, 4, v0
s_cmp_lt_u32 s6, 4
s_cbranch_scc1 idl_23
s_xor_b32 s84, s6, 7
s_or_b32 s84, s84, s60
s_cmp_lg_u32 s84, 0
s_cbranch_scc1 idl_24
s_memrealtime s[68:69]
v_mov_b32 v1, 0
s_waitcnt lgkmcnt(0)
s_or_b32 s70, s68, 0x80000000
v_mov_b32 v2, s70
s_mov_b64 exec, 1
global_store_dword v1, v2, s[32:33] sc1
s_mov_b64 exec, -1
idl_24:
s_getpc_b64 s[88:89]
L_pc:
s_sub_u32 s88, s88, L_pc-interleave_layers__softmax_full_mha__glu_gated_reglu__prompt_kernel
s_subb_u32 s89, s89, 0
s_and_b32 s84, s60, 1
s_lshl_b32 s84, s84, 2
s_add_u32 s84, s84, s6
s_sub_u32 s84, s84, 4
s_lshl_b32 s84, s84, 13
v_lshlrev_b32 v1, 7, v0
v_add_u32 v2, s84, v1
global_load_dword v251, v2, s[88:89]
s_lshl_b32 s84, s60, 2
s_add_u32 s84, s84, s6
s_add_u32 s86, s84, 56
s_lshl_b32 s86, s86, 13
buffer_load_dword v251, v1, s[44:47], s86 offen
s_add_u32 s86, s86, 524288
s_barrier
buffer_load_dword v251, v1, s[44:47], s86 offen
s_add_u32 s86, s86, 524288
buffer_load_dword v251, v1, s[44:47], s86 offen
s_add_u32 s86, s86, 524288
buffer_load_dword v251, v1, s[44:47], s86 offen
s_add_u32 s86, s86, 524288
s_branch idl_22
idl_23:
s_mov_b32 s76, 0xffff0000
v_mov_b64 v[232:233], 0
s_waitcnt vmcnt(0)
v_lshlrev_b32 v234, 16, v220
v_and_b32 v235, s76, v220
v_add_f32 v232, v232, v234
v_fmac_f32 v233, v234, v234
v_add_f32 v232, v232, v235
v_fmac_f32 v233, v235, v235
v_lshlrev_b32 v234, 16, v221
v_and_b32 v235, s76, v221
v_add_f32 v232, v232, v234
v_fmac_f32 v233, v234, v234
v_add_f32 v232, v232, v235
v_fmac_f32 v233, v235, v235
v_lshlrev_b32 v234, 16, v222
v_and_b32 v235, s76, v222
v_add_f32 v232, v232, v234
v_fmac_f32 v233, v234, v234
v_add_f32 v232, v232, v235
v_fmac_f32 v233, v235, v235
v_lshlrev_b32 v234, 16, v223
v_and_b32 v235, s76, v223
v_add_f32 v232, v232, v234
v_fmac_f32 v233, v234, v234
v_add_f32 v232, v232, v235
v_fmac_f32 v233, v235, v235
v_lshlrev_b32 v234, 16, v224
v_and_b32 v235, s76, v224
v_add_f32 v232, v232, v234
v_fmac_f32 v233, v234, v234
v_add_f32 v232, v232, v235
v_fmac_f32 v233, v235, v235
v_lshlrev_b32 v234, 16, v225
v_and_b32 v235, s76, v225
v_add_f32 v232, v232, v234
v_fmac_f32 v233, v234, v234
v_add_f32 v232, v232, v235
v_fmac_f32 v233, v235, v235
v_lshlrev_b32 v234, 16, v226
v_and_b32 v235, s76, v226
v_add_f32 v232, v232, v234
v_fmac_f32 v233, v234, v234
v_add_f32 v232, v232, v235
v_fmac_f32 v233, v235, v235
v_lshlrev_b32 v234, 16, v227
v_and_b32 v235, s76, v227
v_add_f32 v232, v232, v234
v_fmac_f32 v233, v234, v234
v_add_f32 v232, v232, v235
v_fmac_f32 v233, v235, v235
v_lshlrev_b32 v234, 16, v228
v_and_b32 v235, s76, v228
v_add_f32 v232, v232, v234
v_fmac_f32 v233, v234, v234
v_add_f32 v232, v232, v235
v_fmac_f32 v233, v235, v235
v_lshlrev_b32 v234, 16, v229
v_and_b32 v235, s76, v229
v_add_f32 v232, v232, v234
v_fmac_f32 v233, v234, v234
v_add_f32 v232, v232, v235
v_fmac_f32 v233, v235, v235
v_lshlrev_b32 v234, 16, v230
v_and_b32 v235, s76, v230
v_add_f32 v232, v232, v234
v_fmac_f32 v233, v234, v234
v_add_f32 v232, v232, v235
v_fmac_f32 v233, v235, v235
v_lshlrev_b32 v234, 16, v231
v_and_b32 v235, s76, v231
v_add_f32 v232, v232, v234
v_fmac_f32 v233, v234, v234
v_add_f32 v232, v232, v235
v_fmac_f32 v233, v235, v235
s_nop 1
v_add_f32_dpp v232, v232, v232 quad_perm:[1,0,3,2] row_mask:0xf bank_mask:0xf
v_add_f32_dpp v233, v233, v233 quad_perm:[1,0,3,2] row_mask:0xf bank_mask:0xf
s_nop 1
v_add_f32_dpp v232, v232, v232 quad_perm:[2,3,0,1] row_mask:0xf bank_mask:0xf
v_add_f32_dpp v233, v233, v233 quad_perm:[2,3,0,1] row_mask:0xf bank_mask:0xf
v_bfe_u32 v234, v0, 3, 2
v_lshlrev_b32 v234, 10, v234
v_bfe_u32 v235, v0, 2, 1
v_lshl_add_u32 v234, v235, 3, v234
v_lshrrev_b32 v235, 5, v0
v_lshl_add_u32 v234, v235, 4, v234
s_lshr_b32 s76, s13, 3
s_lshl_b32 s76, s76, 12
s_and_b32 s77, s13, 7
s_lshl_b32 s77, s77, 2
s_add_u32 s77, s77, s6
s_lshl_b32 s77, s77, 5
s_add_u32 s76, s76, s77
s_add_u32 s76, s76, 44466176
s_mov_b32 exec_lo, 0x11111111
s_mov_b32 exec_hi, 0x11111111
buffer_store_dwordx2 v[232:233], v234, s[36:39], s76 offen sc1
s_mov_b64 exec, -1
s_cmp_lg_u32 s6, 0
s_cbranch_scc1 idl_25
s_lshl_b32 s76, s13, 5
s_add_u32 s76, s76, 51798016
s_lshl_b32 s77, s13, 7
s_add_u32 s77, s77, 22282240
s_add_u32 s78, s77, 22315008
v_lshlrev_b32 v236, 2, v0
v_mov_b32 v237, 0
s_mov_b64 exec, 0xff
buffer_store_dword v237, v236, s[36:39], s76 offen sc1
s_mov_b64 exec, 0x7ff
buffer_store_dword v237, v236, s[36:39], s77 offen sc1
buffer_store_dword v237, v236, s[36:39], s78 offen sc1
s_mov_b64 exec, -1
idl_25:
s_waitcnt vmcnt(0)
s_barrier
s_cmp_lg_u32 s6, 0
s_cbranch_scc1 idl_22
v_mov_b32 v82, 0
global_load_dword v81, v82, s[32:33] sc1
s_mov_b32 s80, 0
v_mov_b32 v82, 0
s_lshl_b32 s78, s13, 7
s_add_u32 s78, s78, 22282240
s_waitcnt vmcnt(0)
s_branch non_27c
non_27:
global_load_dword v81, v82, s[32:33] sc1
s_waitcnt vmcnt(0)
non_27c:
v_cmp_eq_u32 vcc, 0, v81
s_cbranch_vccz nonok_28
s_sleep 4
s_add_u32 s80, s80, 1
s_cmp_lt_u32 s80, 200000
s_cbranch_scc1 non_27
s_mov_b32 s9, 200000
nonok_28:
v_readfirstlane_b32 s8, v81
s_getreg_b32 s80, hwreg(HW_REG_XCC_ID, 0, 4)
v_add_u32 v81, s80, v81
s_mov_b64 exec, 1
buffer_store_dword v81, v82, s[36:39], s78 offen offset:32 sc1
s_mov_b64 exec, -1
s_waitcnt lgkmcnt(0)
idl_22:
s_mul_i32 s84, s60, 10
s_add_u32 s91, s84, 10
s_add_u32 s84, s84, s6
s_mul_i32 s85, s6, 5120
idl_26:
s_and_b32 s86, s84, 7
s_lshr_b32 s87, s84, 3
s_cmp_lt_u32 s87, 20
s_cselect_b32 s56, s20, s28
s_cselect_b32 s57, s21, s29
s_mov_b32 s58, 1966080
s_cselect_b32 s58, 819200, s58
s_mov_b32 s59, 0x20000
s_cselect_b32 s88, 0, 20
s_cselect_b32 s89, 20, 48
s_mov_b32 s90, 45449216
s_cselect_b32 s90, 44630016, s90
s_sub_u32 s87, s87, s88
s_mul_i32 s89, s89, s86
s_add_u32 s89, s89, s87
s_mul_i32 s89, s89, 5120
s_add_u32 s90, s90, s89
s_mul_i32 s87, s87, 40960
s_mul_i32 s86, s86, 160
s_add_u32 s87, s87, s86
s_movk_i32 s88, 6554
v_add_u32 v180, 0, v0
v_mul_u32_u24 v181, s88, v180
v_lshrrev_b32 v181, 16, v181
v_mad_i32_i24 v180, v181, -10, v180
v_mul_u32_u24 v181, 1280, v181
v_lshl_add_u32 v180, v180, 4, v181
s_add_u32 m0, s85, 0
s_nop 0
buffer_load_dwordx4 v180, s[56:59], s87 offen lds
v_add_u32 v180, 64, v0
v_mul_u32_u24 v181, s88, v180
v_lshrrev_b32 v181, 16, v181
v_mad_i32_i24 v180, v181, -10, v180
v_mul_u32_u24 v181, 1280, v181
v_lshl_add_u32 v180, v180, 4, v181
s_add_u32 m0, s85, 1024
s_nop 0
buffer_load_dwordx4 v180, s[56:59], s87 offen lds
v_add_u32 v180, 128, v0
v_mul_u32_u24 v181, s88, v180
v_lshrrev_b32 v181, 16, v181
v_mad_i32_i24 v180, v181, -10, v180
v_mul_u32_u24 v181, 1280, v181
v_lshl_add_u32 v180, v180, 4, v181
s_add_u32 m0, s85, 2048
s_nop 0
buffer_load_dwordx4 v180, s[56:59], s87 offen lds
v_add_u32 v180, 192, v0
v_mul_u32_u24 v181, s88, v180
v_lshrrev_b32 v181, 16, v181
v_mad_i32_i24 v180, v181, -10, v180
v_mul_u32_u24 v181, 1280, v181
v_lshl_add_u32 v180, v180, 4, v181
s_add_u32 m0, s85, 3072
s_nop 0
buffer_load_dwordx4 v180, s[56:59], s87 offen lds
v_add_u32 v180, 256, v0
v_mul_u32_u24 v181, s88, v180
v_lshrrev_b32 v181, 16, v181
v_mad_i32_i24 v180, v181, -10, v180
v_mul_u32_u24 v181, 1280, v181
v_lshl_add_u32 v180, v180, 4, v181
s_add_u32 m0, s85, 4096
s_nop 0
buffer_load_dwordx4 v180, s[56:59], s87 offen lds
s_waitcnt vmcnt(0)
v_lshrrev_b32 v180, 4, v0
v_bfe_u32 v181, v0, 2, 2
v_lshl_add_u32 v180, v180, 3, v181
v_mul_u32_u24 v180, 160, v180
v_add_u32 v180, s85, v180
v_and_b32 v181, 3, v0
v_lshl_add_u32 v182, v181, 3, v180
v_lshl_add_u32 v181, v181, 4, v180
ds_read_b64_tr_b16 v[184:185], v181 offset:0
ds_read_b64_tr_b16 v[186:187], v181 offset:640
ds_read_b64_tr_b16 v[188:189], v181 offset:8
ds_read_b64_tr_b16 v[190:191], v181 offset:648
ds_read_b64_tr_b16 v[192:193], v181 offset:64
ds_read_b64_tr_b16 v[194:195], v181 offset:704
ds_read_b64_tr_b16 v[196:197], v181 offset:72
ds_read_b64_tr_b16 v[198:199], v181 offset:712
ds_read_b64_tr_b16 v[200:201], v182 offset:128
ds_read_b64_tr_b16 v[202:203], v182 offset:768
s_add_u32 s89, s90, 4096
s_waitcnt lgkmcnt(0)
buffer_store_dwordx4 v[184:187], v5, s[36:39], s90 offen offset:0 sc1
buffer_store_dwordx4 v[188:191], v5, s[36:39], s90 offen offset:1024 sc1
buffer_store_dwordx4 v[192:195], v5, s[36:39], s90 offen offset:2048 sc1
buffer_store_dwordx4 v[196:199], v5, s[36:39], s90 offen offset:3072 sc1
buffer_store_dwordx4 v[200:203], v5, s[36:39], s89 offen offset:0 sc1
s_add_u32 s84, s84, 8
s_cmp_lt_u32 s84, s91
s_cbranch_scc1 idl_26
s_waitcnt vmcnt(0)
s_barrier
s_cmp_lg_u32 s6, 0
s_cbranch_scc1 idl_29
s_lshl_b32 s84, s13, 7
s_add_u32 s84, s84, 22282276
v_mov_b32 v1, 0
v_mov_b32 v2, s8
s_mov_b64 exec, 1
buffer_store_dword v2, v1, s[36:39], s84 offen sc1
s_mov_b64 exec, -1
v_and_b32 v80, 31, v0
v_lshlrev_b32 v80, 7, v80
s_lshl_b32 s80, s4, 12
s_add_u32 s80, s80, 22282272
buffer_load_dword v81, v80, s[36:39], s80 offen sc1
v_and_b32 v80, 31, v0
v_lshlrev_b32 v80, 7, v80
s_lshl_b32 s80, s4, 12
s_add_u32 s80, s80, 22282272
s_mov_b32 s82, s9
s_waitcnt vmcnt(0)
s_branch poll_30c
poll_30:
buffer_load_dword v81, v80, s[36:39], s80 offen sc1
s_waitcnt vmcnt(0)
poll_30c:
v_subrev_u32 v81, s8, v81
v_cmp_lt_u32 vcc, 15, v81
s_cbranch_vccz pollok_31
s_sleep 4
s_add_u32 s82, s82, 1
s_cmp_lt_u32 s82, 200000
s_cbranch_scc1 poll_30
s_mov_b32 s9, 200000
pollok_31:
s_getreg_b32 s80, hwreg(HW_REG_XCC_ID, 0, 4)
v_cmp_ne_u32 vcc, s80, v81
s_cmp_eq_u64 vcc, 0
s_cselect_b32 s80, 1, 0
v_mov_b32 v80, 100352
v_mov_b32 v81, s80
ds_write_b32 v80, v81 offset:4
v_mov_b32 v81, s8
ds_write_b32 v80, v81
s_waitcnt lgkmcnt(0)
idl_29:
s_barrier
v_mov_b32 v1, 100352
ds_read_b64 v[2:3], v1
s_waitcnt lgkmcnt(0)
v_readfirstlane_b32 s8, v2
v_readfirstlane_b32 s98, v3
L_q1done:
s_cmp_eq_u32 s98, 0
s_cbranch_scc1 L_slow
L_fast:
s_and_b32 s60, s6, 3
s_lshr_b32 s61, s6, 2
v_lshlrev_b32 v5, 4, v0
s_mul_i32 s68, s5, 81920
s_add_u32 s68, s68, s7
s_and_b32 s64, s60, 1
s_mul_i32 s62, s64, 5120
s_mul_i32 s63, s64, 10240
s_lshr_b32 s64, s60, 1
s_mul_i32 s65, s64, 5120
s_add_u32 s63, s63, s65
s_mul_i32 s65, s64, 2621440
s_add_u32 s62, s62, s65
s_add_u32 s62, s62, s68
s_add_u32 s62, s62, 2621440
v_lshrrev_b32 v14, 5, v0
v_and_b32 v15, 31, v0
v_lshlrev_b32 v6, 3, v15
s_mul_i32 s64, s61, 10240
v_add_u32 v2, s64, v5
v_add_u32 v3, s64, v6
v_mul_u32_u24 v7, 320, v14
v_lshl_add_u32 v7, v15, 4, v7
v_add_u32 v4, s64, v7
s_mov_b32 s66, 0x000fffff
s_mov_b32 s67, 0x000fffff
s_mov_b32 s76, -1
s_mov_b32 s77, 0
v_and_b32 v9, 27, v0
v_cmp_eq_u32 vcc, 24, v9
v_mov_b32 v8, 0x3f803f80
s_nop 0
v_cndmask_b32 v8, 0, v8, vcc
v_mov_b32 v9, v8
v_lshlrev_b32 v13, 7, v0
v_mov_b32 v12, 0
v_mov_b64 v[144:145], v[8:9]
v_mov_b64 v[146:147], v[8:9]
v_mov_b64 v[148:149], v[8:9]
v_mov_b64 v[150:151], v[8:9]
v_mov_b64 v[152:153], v[8:9]
v_mov_b64 v[154:155], v[8:9]
v_mov_b64 v[156:157], v[8:9]
v_mov_b64 v[158:159], v[8:9]
v_mov_b64 v[160:161], v[8:9]
v_mov_b64 v[162:163], v[8:9]
v_mov_b64 v[164:165], v[8:9]
v_mov_b64 v[166:167], v[8:9]
v_mov_b64 v[168:169], v[8:9]
v_mov_b64 v[170:171], v[8:9]
v_mov_b64 v[172:173], v[8:9]
v_mov_b64 v[174:175], v[8:9]
v_mov_b64 v[40:41], v[8:9]
v_mov_b64 v[42:43], v[8:9]
v_mov_b64 v[44:45], v[8:9]
v_mov_b64 v[46:47], v[8:9]
v_mov_b64 v[112:113], 0
v_mov_b64 v[114:115], 0
v_mov_b64 v[116:117], 0
v_mov_b64 v[118:119], 0
v_mov_b64 v[120:121], 0
v_mov_b64 v[122:123], 0
v_mov_b64 v[124:125], 0
v_mov_b64 v[126:127], 0
v_mov_b64 v[128:129], 0
v_mov_b64 v[130:131], 0
v_mov_b64 v[132:133], 0
v_mov_b64 v[134:135], 0
v_mov_b64 v[136:137], 0
v_mov_b64 v[138:139], 0
v_mov_b64 v[140:141], 0
v_mov_b64 v[142:143], 0
v_mov_b64 v[104:105], 0
v_mov_b64 v[106:107], 0
v_mov_b64 v[108:109], 0
v_mov_b64 v[110:111], 0
v_mov_b64 v[20:21], 0
v_mov_b64 v[26:27], 0
s_mul_i32 s65, s60, 7168
s_add_u32 s65, s65, 102400
v_add_u32 v28, s65, v5
v_lshrrev_b32 v29, 1, v5
v_add_u32 v29, s65, v29
s_lshl_b32 s64, s60, 2
s_add_u32 s64, s64, 131072
v_mov_b32 v177, s64
s_mul_i32 s64, s5, 5
v_add_u32 v30, s64, v14
v_lshrrev_b32 v10, 1, v30
v_and_b32 v30, 1, v30
v_lshlrev_b32 v30, 3, v30
v_lshl_add_u32 v30, v10, 9, v30
v_lshl_add_u32 v30, v15, 4, v30
s_lshl_b32 s64, s4, 2
s_add_u32 s64, s64, s60
s_mul_i32 s96, s64, 81920
s_add_u32 s96, s96, 7864320
s_add_u32 s97, s96, 40960
s_mov_b32 s99, 0
v_mov_b32 v52, 0x3f803f80
v_mov_b32 v53, 0x3f80
v_mov_b32 v58, 0x3f803f80
v_mov_b32 v59, 0x3f80
v_mov_b32 v240, 0x3f803f80
v_mov_b32 v241, 0x3f80
v_mov_b32 v246, 0x3f803f80
v_mov_b32 v247, 0x3f80
v_mov_b32 v252, 0x3f803f80
v_mov_b32 v253, 0x3f80
s_cmp_eq_u32 s61, 0
s_cbranch_scc1 att_old_32
v_and_b32 v10, 1, v0
v_mul_u32_u24 v10, 19, v10
s_mul_i32 s64, s5, 20
v_add_u32 v10, s64, v10
v_lshrrev_b32 v10, 7, v10
v_lshlrev_b32 v10, 5, v10
s_lshr_b32 s64, s60, 1
s_and_b32 s65, s60, 1
s_lshl_b32 s71, s64, 9
s_lshl_b32 s69, s65, 2
s_add_u32 s71, s71, s69
v_and_b32 v11, 2, v0
v_lshl_add_u32 v11, v11, 2, v10
v_add_u32 v11, s71, v11
s_mul_i32 s71, s64, 160
s_lshl_b32 s69, s65, 9
s_add_u32 s71, s71, s69
s_add_u32 s71, s71, 160
v_and_b32 v12, 6, v0
v_lshl_add_u32 v12, v12, 1, v10
v_add_u32 v12, s71, v12
v_cmp_gt_u32 vcc, 8, v0
s_lshl_b32 s94, s4, 10
s_add_u32 s94, s94, 51798016
v_cndmask_b32 v12, v12, v11, vcc
s_add_u32 s95, s8, 1
s_mul_i32 s74, s4, 10240
s_add_u32 s74, s74, s62
s_mov_b32 s92, -1
s_setprio 1
s_mul_i32 s65, s60, 2560
s_add_u32 s71, s65, 102400
s_mul_i32 s64, s4, 10240
s_add_u32 s64, s64, s65
s_add_u32 s64, s64, s68
s_add_u32 s65, s64, 1280
s_lshl_b32 s69, s4, 2
s_add_u32 s69, s69, s60
s_mul_i32 s69, s69, 196608
s_mul_i32 s70, s5, 1280
s_add_u32 s69, s69, s70
s_add_u32 s69, s69, 57344
s_add_u32 s70, s69, 98304
s_cmp_lg_u32 s3, 0
s_cselect_b32 s64, s69, s64
s_cselect_b32 s65, s70, s65
s_and_b32 s82, s92, 0xff
s_cbranch_scc0 gt_34k
s_mov_b32 s82, s9
gt_34:
buffer_load_dword v11, v12, s[36:39], s94 offen sc1
s_waitcnt vmcnt(0)
v_subrev_u32 v11, s95, v11
v_cmp_lt_u32 s[92:93], 15, v11
s_and_b32 s83, s92, 0xff
s_cbranch_scc0 gt_34k
s_add_u32 s82, s82, 1
s_cmp_lt_u32 s82, 200000
s_cbranch_scc1 gt_34
s_mov_b32 s9, 200000
gt_34k:
s_add_u32 m0, s71, 0
s_mov_b64 exec, -1
buffer_load_dwordx4 v5, s[36:39], s64 offen sc1 lds
s_mov_b64 exec, 0xffff
buffer_load_dwordx4 v5, s[36:39], s64 offen offset:1024 sc1 lds
s_add_u32 m0, s71, 1280
s_mov_b64 exec, -1
buffer_load_dwordx4 v5, s[36:39], s65 offen sc1 lds
s_mov_b64 exec, 0xffff
buffer_load_dwordx4 v5, s[36:39], s65 offen offset:1024 sc1 lds
s_mov_b64 exec, -1
s_and_b32 s82, s92, 0xff00
s_cbranch_scc0 gt_35k
s_mov_b32 s82, s9
gt_35:
buffer_load_dword v11, v12, s[36:39], s94 offen sc1
s_waitcnt vmcnt(0)
v_subrev_u32 v11, s95, v11
v_cmp_lt_u32 s[92:93], 15, v11
s_and_b32 s83, s92, 0xff00
s_cbranch_scc0 gt_35k
s_add_u32 s82, s82, 1
s_cmp_lt_u32 s82, 200000
s_cbranch_scc1 gt_35
s_mov_b32 s9, 200000
gt_35k:
s_cmp_ge_u32 s60, 2
s_cbranch_scc1 att_v_36
s_add_u32 m0, s63, 0
s_add_u32 s79, s74, 0
buffer_load_dwordx4 v5, s[36:39], s79 offen offset:0 sc1 lds
buffer_load_dwordx4 v5, s[36:39], s79 offen offset:1024 sc1 lds
s_waitcnt vmcnt(0)
s_add_u32 m0, s63, 2048
s_add_u32 s79, s74, 2048
buffer_load_dwordx4 v5, s[36:39], s79 offen offset:0 sc1 lds
buffer_load_dwordx4 v5, s[36:39], s79 offen offset:1024 sc1 lds
buffer_load_dwordx4 v5, s[36:39], s79 offen offset:2048 sc1 lds
s_branch att_j_33
att_v_36:
s_add_u32 m0, s63, 0
s_add_u32 s79, s74, 0
buffer_load_dwordx4 v5, s[36:39], s79 offen offset:0 sc1 lds
buffer_load_dwordx4 v5, s[36:39], s79 offen offset:1024 sc1 lds
s_waitcnt vmcnt(2)
s_branch att_j_33
att_old_32:
s_setprio 2
v_add_u32 v10, s4, v0
v_and_b32 v10, 7, v10
v_bfe_u32 v11, v0, 3, 1
v_mul_u32_u24 v11, 19, v11
s_mul_i32 s64, s5, 20
v_add_u32 v11, s64, v11
v_lshrrev_b32 v11, 7, v11
v_lshl_add_u32 v10, v10, 5, v11
s_and_b32 s64, s60, 1
s_lshl_b32 s64, s64, 4
s_lshr_b32 s65, s60, 1
s_mul_i32 s65, s65, 5
s_add_u32 s64, s64, s65
s_add_u32 s64, s64, 5
v_add_u32 v10, s64, v10
v_lshlrev_b32 v12, 7, v10
v_lshrrev_b32 v11, 4, v0
v_lshl_add_u32 v12, v11, 2, v12
s_and_b32 s69, s5, 7
s_mul_i32 s69, s69, 102400
s_mul_i32 s70, s6, 5120
s_add_u32 s69, s69, s70
s_add_u32 s69, s69, 44630016
s_add_u32 s94, s7, 22282240
s_add_u32 s95, s8, 1
s_or_b32 s65, s3, s6
s_cmp_lg_u32 s65, 0
s_cbranch_scc1 cpf_37
s_getpc_b64 s[72:73]
pc_38:
s_sub_u32 s72, s72, pc_38-interleave_layers__softmax_full_mha__glu_gated_reglu__prompt_kernel
s_subb_u32 s73, s73, 0
s_lshl_b32 s65, s5, 11
s_add_u32 s65, s65, L_fast-interleave_layers__softmax_full_mha__glu_gated_reglu__prompt_kernel
v_add_u32 v182, s65, v13
v_min_u32 v182, L_fast_post-interleave_layers__softmax_full_mha__glu_gated_reglu__prompt_kernel, v182
s_mov_b64 exec, 0xffff
global_load_dword v176, v182, s[72:73]
s_mov_b64 exec, -1
cpf_37:
att_j_33:
s_mul_i32 s65, s60, 2560
s_add_u32 s65, s65, 102400
v_add_u32 v10, s65, v5
v_add_u32 v11, s65, v6
s_barrier
ds_read_b128 v[16:19], v10
ds_read_b128 v[22:25], v10 offset:1280
s_mov_b32 exec_hi, 0
ds_read_b64 v[20:21], v11 offset:1024
ds_read_b64 v[26:27], v11 offset:2304
s_mov_b32 exec_hi, -1
s_cmp_lg_u32 s61, 0
s_cbranch_scc1 att_ap_39
buffer_load_dword v180, v12, s[36:39], s94 offen sc1
att_ap_39:
s_cmp_lt_u32 s6, 6
s_cbranch_scc1 att_v2_40
s_add_u32 m0, s63, 2048
s_add_u32 s79, s74, 2048
buffer_load_dwordx4 v5, s[36:39], s79 offen offset:0 sc1 lds
buffer_load_dwordx4 v5, s[36:39], s79 offen offset:1024 sc1 lds
buffer_load_dwordx4 v5, s[36:39], s79 offen offset:2048 sc1 lds
att_v2_40:
s_mov_b64 exec, s[76:77]
ds_read_b64 v[52:53], v3 offset:1024
s_mov_b64 exec, -1
ds_read_b128 v[48:51], v2 offset:0
s_waitcnt lgkmcnt(0)
v_mfma_f32_32x32x16_bf16 v[64:79], v[48:51], v[16:19], 0
v_mfma_f32_32x32x8_bf16 v[64:79], v[52:53], v[20:21], v[64:79]
v_mfma_f32_32x32x16_bf16 v[80:95], v[48:51], v[22:25], 0
v_mfma_f32_32x32x8_bf16 v[80:95], v[52:53], v[26:27], v[80:95]
s_nop 9
v_max3_f32 v8, v64, v65, v66
v_max3_f32 v8, v8, v67, v68
v_max3_f32 v8, v8, v69, v70
v_max3_f32 v8, v8, v71, v72
v_max3_f32 v8, v8, v73, v74
v_max3_f32 v8, v8, v75, v76
v_max3_f32 v8, v8, v77, v78
v_max_f32 v8, v8, v79
v_max3_f32 v9, v80, v81, v82
v_max3_f32 v9, v9, v83, v84
v_max3_f32 v9, v9, v85, v86
v_max3_f32 v9, v9, v87, v88
v_max3_f32 v9, v9, v89, v90
v_max3_f32 v9, v9, v91, v92
v_max3_f32 v9, v9, v93, v94
v_max_f32 v9, v9, v95
v_mov_b32 v10, v8
v_mov_b32 v11, v9
s_nop 0
v_permlane32_swap_b32 v8, v10
v_permlane32_swap_b32 v9, v11
s_nop 0
v_max_f32 v8, v8, v10
v_max_f32 v9, v9, v11
s_mov_b32 exec_lo, 0
v_sub_f32 v32, 0, v8
v_and_b32 v33, 0xffff0000, v32
v_sub_f32 v34, v32, v33
v_and_b32 v35, 0xffff0000, v34
v_sub_f32 v34, v34, v35
v_lshrrev_b32 v33, 16, v33
v_or_b32 v20, v33, v35
v_lshrrev_b32 v21, 16, v34
v_sub_f32 v36, 0, v9
v_and_b32 v37, 0xffff0000, v36
v_sub_f32 v38, v36, v37
v_and_b32 v39, 0xffff0000, v38
v_sub_f32 v38, v38, v39
v_lshrrev_b32 v37, 16, v37
v_or_b32 v26, v37, v39
v_lshrrev_b32 v27, 16, v38
s_mov_b32 exec_lo, -1
v_sub_f32 v64, v64, v8
v_sub_f32 v65, v65, v8
v_sub_f32 v66, v66, v8
v_sub_f32 v67, v67, v8
v_sub_f32 v68, v68, v8
v_sub_f32 v69, v69, v8
v_sub_f32 v70, v70, v8
v_sub_f32 v71, v71, v8
v_sub_f32 v72, v72, v8
v_sub_f32 v73, v73, v8
v_sub_f32 v74, v74, v8
v_sub_f32 v75, v75, v8
v_sub_f32 v76, v76, v8
v_sub_f32 v77, v77, v8
v_sub_f32 v78, v78, v8
v_sub_f32 v79, v79, v8
s_cmp_eq_u32 s61, 0
s_cbranch_scc1 att_w0_41
s_waitcnt vmcnt(3)
s_cmp_ge_u32 s60, 2
s_cbranch_scc1 att_w1_42b
s_waitcnt vmcnt(2)
att_w1_42b:
s_barrier
s_branch att_w1_42
att_w0_41:
s_barrier
s_waitcnt vmcnt(0)
v_subrev_u32 v180, s95, v180
v_cmp_lt_u32 s[92:93], 15, v180
s_or_b32 s92, s92, s93
s_and_b32 s75, s92, 0x02020202
s_cbranch_scc1 att_w1_42
s_add_u32 s64, s4, 1
s_and_b32 s64, s64, 7
s_mul_i32 s64, s64, 10240
s_add_u32 s64, s64, s62
s_add_u32 m0, s63, 20480
s_add_u32 s79, s64, 0
buffer_load_dwordx4 v5, s[36:39], s79 offen offset:0 sc1 lds
buffer_load_dwordx4 v5, s[36:39], s79 offen offset:1024 sc1 lds
buffer_load_dwordx4 v5, s[36:39], s79 offen offset:2048 sc1 lds
buffer_load_dwordx4 v5, s[36:39], s79 offen offset:3072 sc1 lds
s_add_u32 m0, s63, 24576
s_add_u32 s79, s64, 4096
buffer_load_dwordx4 v5, s[36:39], s79 offen offset:0 sc1 lds
att_w1_42:
v_mfma_f32_32x32x16_bf16 v[80:95], v[48:51], v[22:25], 0
ds_read_b128 v[54:57], v2 offset:1280
s_mov_b64 exec, s[76:77]
ds_read_b64 v[58:59], v3 offset:2304
s_mov_b64 exec, s[66:67]
ds_read_b128 v[144:147], v4 offset:5120
ds_read_b128 v[148:151], v4 offset:5760
s_mov_b64 exec, -1
v_exp_f32 v64, v64
v_exp_f32 v65, v65
v_exp_f32 v66, v66
v_exp_f32 v67, v67
v_cvt_pk_bf16_f32 v96, v64, v65
v_exp_f32 v68, v68
v_mfma_f32_32x32x16_bf16 v[128:143], v[40:43], v[104:107], v[128:143]
v_exp_f32 v69, v69
v_cvt_pk_bf16_f32 v97, v66, v67
v_exp_f32 v70, v70
v_exp_f32 v71, v71
v_cvt_pk_bf16_f32 v98, v68, v69
v_exp_f32 v72, v72
v_mfma_f32_32x32x8_bf16 v[80:95], v[52:53], v[26:27], v[80:95]
v_exp_f32 v73, v73
v_cvt_pk_bf16_f32 v99, v70, v71
v_exp_f32 v74, v74
v_exp_f32 v75, v75
v_cvt_pk_bf16_f32 v100, v72, v73
v_exp_f32 v76, v76
v_mfma_f32_32x32x16_bf16 v[128:143], v[44:47], v[108:111], v[128:143]
v_exp_f32 v77, v77
v_cvt_pk_bf16_f32 v101, v74, v75
v_exp_f32 v78, v78
v_exp_f32 v79, v79
v_cvt_pk_bf16_f32 v102, v76, v77
v_cvt_pk_bf16_f32 v103, v78, v79
s_waitcnt lgkmcnt(0)
v_mfma_f32_32x32x16_bf16 v[64:79], v[54:57], v[16:19], 0
v_exp_f32 v80, v80
v_exp_f32 v81, v81
v_exp_f32 v82, v82
v_exp_f32 v83, v83
v_cvt_pk_bf16_f32 v104, v80, v81
v_exp_f32 v84, v84
v_mfma_f32_32x32x16_bf16 v[112:127], v[144:147], v[96:99], v[112:127]
v_exp_f32 v85, v85
v_cvt_pk_bf16_f32 v105, v82, v83
v_exp_f32 v86, v86
v_exp_f32 v87, v87
v_cvt_pk_bf16_f32 v106, v84, v85
v_exp_f32 v88, v88
v_mfma_f32_32x32x8_bf16 v[64:79], v[58:59], v[20:21], v[64:79]
v_exp_f32 v89, v89
v_cvt_pk_bf16_f32 v107, v86, v87
v_exp_f32 v90, v90
v_exp_f32 v91, v91
v_cvt_pk_bf16_f32 v108, v88, v89
v_exp_f32 v92, v92
v_mfma_f32_32x32x16_bf16 v[112:127], v[148:151], v[100:103], v[112:127]
v_exp_f32 v93, v93
v_cvt_pk_bf16_f32 v109, v90, v91
v_exp_f32 v94, v94
v_exp_f32 v95, v95
v_cvt_pk_bf16_f32 v110, v92, v93
v_cvt_pk_bf16_f32 v111, v94, v95
s_cmp_eq_u32 s61, 0
s_cbranch_scc1 att_hk_43
s_waitcnt vmcnt(0)
s_barrier
att_hk_43r:
v_mfma_f32_32x32x16_bf16 v[80:95], v[54:57], v[22:25], 0
ds_read_b128 v[236:239], v2 offset:2560
s_mov_b64 exec, s[76:77]
ds_read_b64 v[240:241], v3 offset:3584
ds_read_b64 v[246:247], v3 offset:4864
s_mov_b64 exec, s[66:67]
ds_read_b128 v[152:155], v4 offset:6400
ds_read_b128 v[156:159], v4 offset:7040
ds_read_b128 v[160:163], v4 offset:7680
ds_read_b128 v[164:167], v4 offset:8320
s_mov_b64 exec, -1
v_exp_f32 v64, v64
v_exp_f32 v65, v65
v_exp_f32 v66, v66
v_exp_f32 v67, v67
v_cvt_pk_bf16_f32 v96, v64, v65
v_exp_f32 v68, v68
v_mfma_f32_32x32x16_bf16 v[128:143], v[144:147], v[104:107], v[128:143]
ds_read_b128 v[242:245], v2 offset:3840
v_exp_f32 v69, v69
v_cvt_pk_bf16_f32 v97, v66, v67
v_exp_f32 v70, v70
v_exp_f32 v71, v71
v_cvt_pk_bf16_f32 v98, v68, v69
v_exp_f32 v72, v72
v_mfma_f32_32x32x8_bf16 v[80:95], v[58:59], v[26:27], v[80:95]
v_exp_f32 v73, v73
v_cvt_pk_bf16_f32 v99, v70, v71
v_exp_f32 v74, v74
v_exp_f32 v75, v75
v_cvt_pk_bf16_f32 v100, v72, v73
v_exp_f32 v76, v76
v_mfma_f32_32x32x16_bf16 v[128:143], v[148:151], v[108:111], v[128:143]
v_exp_f32 v77, v77
v_cvt_pk_bf16_f32 v101, v74, v75
v_exp_f32 v78, v78
v_exp_f32 v79, v79
v_cvt_pk_bf16_f32 v102, v76, v77
v_cvt_pk_bf16_f32 v103, v78, v79
s_waitcnt lgkmcnt(0)
v_mfma_f32_32x32x16_bf16 v[64:79], v[236:239], v[16:19], 0
v_exp_f32 v80, v80
v_exp_f32 v81, v81
v_exp_f32 v82, v82
v_exp_f32 v83, v83
v_cvt_pk_bf16_f32 v104, v80, v81
v_exp_f32 v84, v84
v_mfma_f32_32x32x16_bf16 v[112:127], v[152:155], v[96:99], v[112:127]
v_exp_f32 v85, v85
v_cvt_pk_bf16_f32 v105, v82, v83
v_exp_f32 v86, v86
v_exp_f32 v87, v87
v_cvt_pk_bf16_f32 v106, v84, v85
v_exp_f32 v88, v88
v_mfma_f32_32x32x8_bf16 v[64:79], v[240:241], v[20:21], v[64:79]
v_exp_f32 v89, v89
v_cvt_pk_bf16_f32 v107, v86, v87
v_exp_f32 v90, v90
v_exp_f32 v91, v91
v_cvt_pk_bf16_f32 v108, v88, v89
v_exp_f32 v92, v92
v_mfma_f32_32x32x16_bf16 v[112:127], v[156:159], v[100:103], v[112:127]
v_exp_f32 v93, v93
v_cvt_pk_bf16_f32 v109, v90, v91
v_exp_f32 v94, v94
v_exp_f32 v95, v95
v_cvt_pk_bf16_f32 v110, v92, v93
v_cvt_pk_bf16_f32 v111, v94, v95
v_mfma_f32_32x32x16_bf16 v[80:95], v[236:239], v[22:25], 0
v_exp_f32 v64, v64
v_exp_f32 v65, v65
v_exp_f32 v66, v66
v_exp_f32 v67, v67
v_cvt_pk_bf16_f32 v96, v64, v65
v_exp_f32 v68, v68
v_mfma_f32_32x32x16_bf16 v[128:143], v[152:155], v[104:107], v[128:143]
v_exp_f32 v69, v69
v_cvt_pk_bf16_f32 v97, v66, v67
v_exp_f32 v70, v70
v_exp_f32 v71, v71
v_cvt_pk_bf16_f32 v98, v68, v69
v_exp_f32 v72, v72
v_mfma_f32_32x32x8_bf16 v[80:95], v[240:241], v[26:27], v[80:95]
v_exp_f32 v73, v73
v_cvt_pk_bf16_f32 v99, v70, v71
v_exp_f32 v74, v74
v_exp_f32 v75, v75
v_cvt_pk_bf16_f32 v100, v72, v73
v_exp_f32 v76, v76
v_mfma_f32_32x32x16_bf16 v[128:143], v[156:159], v[108:111], v[128:143]
v_exp_f32 v77, v77
v_cvt_pk_bf16_f32 v101, v74, v75
v_exp_f32 v78, v78
v_exp_f32 v79, v79
v_cvt_pk_bf16_f32 v102, v76, v77
v_cvt_pk_bf16_f32 v103, v78, v79
v_mfma_f32_32x32x16_bf16 v[64:79], v[242:245], v[16:19], 0
v_exp_f32 v80, v80
v_exp_f32 v81, v81
v_exp_f32 v82, v82
v_exp_f32 v83, v83
v_cvt_pk_bf16_f32 v104, v80, v81
v_exp_f32 v84, v84
v_mfma_f32_32x32x16_bf16 v[112:127], v[160:163], v[96:99], v[112:127]
v_exp_f32 v85, v85
v_cvt_pk_bf16_f32 v105, v82, v83
v_exp_f32 v86, v86
v_exp_f32 v87, v87
v_cvt_pk_bf16_f32 v106, v84, v85
v_exp_f32 v88, v88
v_mfma_f32_32x32x8_bf16 v[64:79], v[246:247], v[20:21], v[64:79]
v_exp_f32 v89, v89
v_cvt_pk_bf16_f32 v107, v86, v87
v_exp_f32 v90, v90
v_exp_f32 v91, v91
v_cvt_pk_bf16_f32 v108, v88, v89
v_exp_f32 v92, v92
v_mfma_f32_32x32x16_bf16 v[112:127], v[164:167], v[100:103], v[112:127]
v_exp_f32 v93, v93
v_cvt_pk_bf16_f32 v109, v90, v91
v_exp_f32 v94, v94
v_exp_f32 v95, v95
v_cvt_pk_bf16_f32 v110, v92, v93
v_cvt_pk_bf16_f32 v111, v94, v95
s_cmp_eq_u32 s61, 0
s_cbranch_scc1 att_hk_44
att_hk_44r:
s_barrier
v_mfma_f32_32x32x16_bf16 v[80:95], v[242:245], v[22:25], 0
ds_read_b128 v[248:251], v2 offset:20480
s_mov_b64 exec, s[76:77]
ds_read_b64 v[252:253], v3 offset:21504
ds_read_b64 v[52:53], v3 offset:22784
s_mov_b64 exec, s[66:67]
ds_read_b128 v[168:171], v4 offset:8960
ds_read_b128 v[172:175], v4 offset:9600
ds_read_b128 v[40:43], v4 offset:25600
ds_read_b128 v[44:47], v4 offset:26240
s_mov_b64 exec, -1
v_exp_f32 v64, v64
v_exp_f32 v65, v65
v_exp_f32 v66, v66
v_exp_f32 v67, v67
v_cvt_pk_bf16_f32 v96, v64, v65
v_exp_f32 v68, v68
v_mfma_f32_32x32x16_bf16 v[128:143], v[160:163], v[104:107], v[128:143]
ds_read_b128 v[48:51], v2 offset:21760
v_exp_f32 v69, v69
v_cvt_pk_bf16_f32 v97, v66, v67
v_exp_f32 v70, v70
v_exp_f32 v71, v71
v_cvt_pk_bf16_f32 v98, v68, v69
v_exp_f32 v72, v72
v_mfma_f32_32x32x8_bf16 v[80:95], v[246:247], v[26:27], v[80:95]
v_exp_f32 v73, v73
v_cvt_pk_bf16_f32 v99, v70, v71
v_exp_f32 v74, v74
v_exp_f32 v75, v75
v_cvt_pk_bf16_f32 v100, v72, v73
v_exp_f32 v76, v76
v_mfma_f32_32x32x16_bf16 v[128:143], v[164:167], v[108:111], v[128:143]
v_exp_f32 v77, v77
v_cvt_pk_bf16_f32 v101, v74, v75
v_exp_f32 v78, v78
v_exp_f32 v79, v79
v_cvt_pk_bf16_f32 v102, v76, v77
v_cvt_pk_bf16_f32 v103, v78, v79
s_waitcnt lgkmcnt(0)
v_mfma_f32_32x32x16_bf16 v[64:79], v[248:251], v[16:19], 0
v_exp_f32 v80, v80
v_exp_f32 v81, v81
v_exp_f32 v82, v82
v_exp_f32 v83, v83
v_cvt_pk_bf16_f32 v104, v80, v81
v_exp_f32 v84, v84
v_mfma_f32_32x32x16_bf16 v[112:127], v[168:171], v[96:99], v[112:127]
v_exp_f32 v85, v85
v_cvt_pk_bf16_f32 v105, v82, v83
v_exp_f32 v86, v86
v_exp_f32 v87, v87
v_cvt_pk_bf16_f32 v106, v84, v85
v_exp_f32 v88, v88
v_mfma_f32_32x32x8_bf16 v[64:79], v[252:253], v[20:21], v[64:79]
v_exp_f32 v89, v89
v_cvt_pk_bf16_f32 v107, v86, v87
v_exp_f32 v90, v90
v_exp_f32 v91, v91
v_cvt_pk_bf16_f32 v108, v88, v89
v_exp_f32 v92, v92
v_mfma_f32_32x32x16_bf16 v[112:127], v[172:175], v[100:103], v[112:127]
v_exp_f32 v93, v93
v_cvt_pk_bf16_f32 v109, v90, v91
v_exp_f32 v94, v94
v_exp_f32 v95, v95
v_cvt_pk_bf16_f32 v110, v92, v93
v_cvt_pk_bf16_f32 v111, v94, v95
v_mfma_f32_32x32x16_bf16 v[80:95], v[248:251], v[22:25], 0
v_exp_f32 v64, v64
v_exp_f32 v65, v65
v_exp_f32 v66, v66
v_exp_f32 v67, v67
v_cvt_pk_bf16_f32 v96, v64, v65
v_exp_f32 v68, v68
v_mfma_f32_32x32x16_bf16 v[128:143], v[168:171], v[104:107], v[128:143]
v_exp_f32 v69, v69
v_cvt_pk_bf16_f32 v97, v66, v67
v_exp_f32 v70, v70
v_exp_f32 v71, v71
v_cvt_pk_bf16_f32 v98, v68, v69
v_exp_f32 v72, v72
v_mfma_f32_32x32x8_bf16 v[80:95], v[252:253], v[26:27], v[80:95]
v_exp_f32 v73, v73
v_cvt_pk_bf16_f32 v99, v70, v71
v_exp_f32 v74, v74
v_exp_f32 v75, v75
v_cvt_pk_bf16_f32 v100, v72, v73
v_exp_f32 v76, v76
v_mfma_f32_32x32x16_bf16 v[128:143], v[172:175], v[108:111], v[128:143]
v_exp_f32 v77, v77
v_cvt_pk_bf16_f32 v101, v74, v75
v_exp_f32 v78, v78
v_exp_f32 v79, v79
v_cvt_pk_bf16_f32 v102, v76, v77
v_cvt_pk_bf16_f32 v103, v78, v79
v_mfma_f32_32x32x16_bf16 v[64:79], v[48:51], v[16:19], 0
v_exp_f32 v80, v80
v_exp_f32 v81, v81
v_exp_f32 v82, v82
v_exp_f32 v83, v83
v_cvt_pk_bf16_f32 v104, v80, v81
v_exp_f32 v84, v84
v_mfma_f32_32x32x16_bf16 v[112:127], v[40:43], v[96:99], v[112:127]
v_exp_f32 v85, v85
v_cvt_pk_bf16_f32 v105, v82, v83
v_exp_f32 v86, v86
v_exp_f32 v87, v87
v_cvt_pk_bf16_f32 v106, v84, v85
v_exp_f32 v88, v88
v_mfma_f32_32x32x8_bf16 v[64:79], v[52:53], v[20:21], v[64:79]
v_exp_f32 v89, v89
v_cvt_pk_bf16_f32 v107, v86, v87
v_exp_f32 v90, v90
v_exp_f32 v91, v91
v_cvt_pk_bf16_f32 v108, v88, v89
v_exp_f32 v92, v92
v_mfma_f32_32x32x16_bf16 v[112:127], v[44:47], v[100:103], v[112:127]
v_exp_f32 v93, v93
v_cvt_pk_bf16_f32 v109, v90, v91
v_exp_f32 v94, v94
v_exp_f32 v95, v95
v_cvt_pk_bf16_f32 v110, v92, v93
v_cvt_pk_bf16_f32 v111, v94, v95
v_mfma_f32_32x32x16_bf16 v[80:95], v[48:51], v[22:25], 0
ds_read_b128 v[54:57], v2 offset:23040
s_mov_b64 exec, s[76:77]
ds_read_b64 v[58:59], v3 offset:24064
ds_read_b64 v[240:241], v3 offset:25344
s_mov_b64 exec, s[66:67]
ds_read_b128 v[144:147], v4 offset:26880
ds_read_b128 v[148:151], v4 offset:27520
ds_read_b128 v[152:155], v4 offset:28160
ds_read_b128 v[156:159], v4 offset:28800
s_mov_b64 exec, -1
v_exp_f32 v64, v64
v_exp_f32 v65, v65
v_exp_f32 v66, v66
v_exp_f32 v67, v67
v_cvt_pk_bf16_f32 v96, v64, v65
v_exp_f32 v68, v68
v_mfma_f32_32x32x16_bf16 v[128:143], v[40:43], v[104:107], v[128:143]
ds_read_b128 v[236:239], v2 offset:24320
v_exp_f32 v69, v69
v_cvt_pk_bf16_f32 v97, v66, v67
v_exp_f32 v70, v70
v_exp_f32 v71, v71
v_cvt_pk_bf16_f32 v98, v68, v69
v_exp_f32 v72, v72
v_mfma_f32_32x32x8_bf16 v[80:95], v[52:53], v[26:27], v[80:95]
v_exp_f32 v73, v73
v_cvt_pk_bf16_f32 v99, v70, v71
v_exp_f32 v74, v74
v_exp_f32 v75, v75
v_cvt_pk_bf16_f32 v100, v72, v73
v_exp_f32 v76, v76
v_mfma_f32_32x32x16_bf16 v[128:143], v[44:47], v[108:111], v[128:143]
v_exp_f32 v77, v77
v_cvt_pk_bf16_f32 v101, v74, v75
v_exp_f32 v78, v78
v_exp_f32 v79, v79
v_cvt_pk_bf16_f32 v102, v76, v77
v_cvt_pk_bf16_f32 v103, v78, v79
s_waitcnt lgkmcnt(0)
v_mfma_f32_32x32x16_bf16 v[64:79], v[54:57], v[16:19], 0
v_exp_f32 v80, v80
v_exp_f32 v81, v81
v_exp_f32 v82, v82
v_exp_f32 v83, v83
v_cvt_pk_bf16_f32 v104, v80, v81
v_exp_f32 v84, v84
v_mfma_f32_32x32x16_bf16 v[112:127], v[144:147], v[96:99], v[112:127]
v_exp_f32 v85, v85
v_cvt_pk_bf16_f32 v105, v82, v83
v_exp_f32 v86, v86
v_exp_f32 v87, v87
v_cvt_pk_bf16_f32 v106, v84, v85
v_exp_f32 v88, v88
v_mfma_f32_32x32x8_bf16 v[64:79], v[58:59], v[20:21], v[64:79]
v_exp_f32 v89, v89
v_cvt_pk_bf16_f32 v107, v86, v87
v_exp_f32 v90, v90
v_exp_f32 v91, v91
v_cvt_pk_bf16_f32 v108, v88, v89
v_exp_f32 v92, v92
v_mfma_f32_32x32x16_bf16 v[112:127], v[148:151], v[100:103], v[112:127]
v_exp_f32 v93, v93
v_cvt_pk_bf16_f32 v109, v90, v91
v_exp_f32 v94, v94
v_exp_f32 v95, v95
v_cvt_pk_bf16_f32 v110, v92, v93
v_cvt_pk_bf16_f32 v111, v94, v95
v_mfma_f32_32x32x16_bf16 v[80:95], v[54:57], v[22:25], 0
v_exp_f32 v64, v64
v_exp_f32 v65, v65
v_exp_f32 v66, v66
v_exp_f32 v67, v67
v_cvt_pk_bf16_f32 v96, v64, v65
v_exp_f32 v68, v68
v_mfma_f32_32x32x16_bf16 v[128:143], v[144:147], v[104:107], v[128:143]
v_exp_f32 v69, v69
v_cvt_pk_bf16_f32 v97, v66, v67
v_exp_f32 v70, v70
v_exp_f32 v71, v71
v_cvt_pk_bf16_f32 v98, v68, v69
v_exp_f32 v72, v72
v_mfma_f32_32x32x8_bf16 v[80:95], v[58:59], v[26:27], v[80:95]
v_exp_f32 v73, v73
v_cvt_pk_bf16_f32 v99, v70, v71
v_exp_f32 v74, v74
v_exp_f32 v75, v75
v_cvt_pk_bf16_f32 v100, v72, v73
v_exp_f32 v76, v76
v_mfma_f32_32x32x16_bf16 v[128:143], v[148:151], v[108:111], v[128:143]
v_exp_f32 v77, v77
v_cvt_pk_bf16_f32 v101, v74, v75
v_exp_f32 v78, v78
v_exp_f32 v79, v79
v_cvt_pk_bf16_f32 v102, v76, v77
v_cvt_pk_bf16_f32 v103, v78, v79
v_mfma_f32_32x32x16_bf16 v[64:79], v[236:239], v[16:19], 0
v_exp_f32 v80, v80
v_exp_f32 v81, v81
v_exp_f32 v82, v82
v_exp_f32 v83, v83
v_cvt_pk_bf16_f32 v104, v80, v81
v_exp_f32 v84, v84
v_mfma_f32_32x32x16_bf16 v[112:127], v[152:155], v[96:99], v[112:127]
v_exp_f32 v85, v85
v_cvt_pk_bf16_f32 v105, v82, v83
v_exp_f32 v86, v86
v_exp_f32 v87, v87
v_cvt_pk_bf16_f32 v106, v84, v85
v_exp_f32 v88, v88
v_mfma_f32_32x32x8_bf16 v[64:79], v[240:241], v[20:21], v[64:79]
v_exp_f32 v89, v89
v_cvt_pk_bf16_f32 v107, v86, v87
v_exp_f32 v90, v90
v_exp_f32 v91, v91
v_cvt_pk_bf16_f32 v108, v88, v89
v_exp_f32 v92, v92
v_mfma_f32_32x32x16_bf16 v[112:127], v[156:159], v[100:103], v[112:127]
v_exp_f32 v93, v93
v_cvt_pk_bf16_f32 v109, v90, v91
v_exp_f32 v94, v94
v_exp_f32 v95, v95
v_cvt_pk_bf16_f32 v110, v92, v93
v_cvt_pk_bf16_f32 v111, v94, v95
s_cmp_eq_u32 s61, 0
s_cbranch_scc1 att_hk_45
att_hk_45r:
s_barrier
v_mfma_f32_32x32x16_bf16 v[80:95], v[236:239], v[22:25], 0
ds_read_b128 v[242:245], v2 offset:40960
s_mov_b64 exec, s[76:77]
ds_read_b64 v[246:247], v3 offset:41984
ds_read_b64 v[252:253], v3 offset:43264
s_mov_b64 exec, s[66:67]
ds_read_b128 v[160:163], v4 offset:29440
ds_read_b128 v[164:167], v4 offset:30080
ds_read_b128 v[168:171], v4 offset:46080
ds_read_b128 v[172:175], v4 offset:46720
s_mov_b64 exec, -1
v_exp_f32 v64, v64
v_exp_f32 v65, v65
v_exp_f32 v66, v66
v_exp_f32 v67, v67
v_cvt_pk_bf16_f32 v96, v64, v65
v_exp_f32 v68, v68
v_mfma_f32_32x32x16_bf16 v[128:143], v[152:155], v[104:107], v[128:143]
ds_read_b128 v[248:251], v2 offset:42240
v_exp_f32 v69, v69
v_cvt_pk_bf16_f32 v97, v66, v67
v_exp_f32 v70, v70
v_exp_f32 v71, v71
v_cvt_pk_bf16_f32 v98, v68, v69
v_exp_f32 v72, v72
v_mfma_f32_32x32x8_bf16 v[80:95], v[240:241], v[26:27], v[80:95]
v_exp_f32 v73, v73
v_cvt_pk_bf16_f32 v99, v70, v71
v_exp_f32 v74, v74
v_exp_f32 v75, v75
v_cvt_pk_bf16_f32 v100, v72, v73
v_exp_f32 v76, v76
v_mfma_f32_32x32x16_bf16 v[128:143], v[156:159], v[108:111], v[128:143]
v_exp_f32 v77, v77
v_cvt_pk_bf16_f32 v101, v74, v75
v_exp_f32 v78, v78
v_exp_f32 v79, v79
v_cvt_pk_bf16_f32 v102, v76, v77
v_cvt_pk_bf16_f32 v103, v78, v79
s_waitcnt lgkmcnt(0)
v_mfma_f32_32x32x16_bf16 v[64:79], v[242:245], v[16:19], 0
v_exp_f32 v80, v80
v_exp_f32 v81, v81
v_exp_f32 v82, v82
v_exp_f32 v83, v83
v_cvt_pk_bf16_f32 v104, v80, v81
v_exp_f32 v84, v84
v_mfma_f32_32x32x16_bf16 v[112:127], v[160:163], v[96:99], v[112:127]
v_exp_f32 v85, v85
v_cvt_pk_bf16_f32 v105, v82, v83
v_exp_f32 v86, v86
v_exp_f32 v87, v87
v_cvt_pk_bf16_f32 v106, v84, v85
v_exp_f32 v88, v88
v_mfma_f32_32x32x8_bf16 v[64:79], v[246:247], v[20:21], v[64:79]
v_exp_f32 v89, v89
v_cvt_pk_bf16_f32 v107, v86, v87
v_exp_f32 v90, v90
v_exp_f32 v91, v91
v_cvt_pk_bf16_f32 v108, v88, v89
v_exp_f32 v92, v92
v_mfma_f32_32x32x16_bf16 v[112:127], v[164:167], v[100:103], v[112:127]
v_exp_f32 v93, v93
v_cvt_pk_bf16_f32 v109, v90, v91
v_exp_f32 v94, v94
v_exp_f32 v95, v95
v_cvt_pk_bf16_f32 v110, v92, v93
v_cvt_pk_bf16_f32 v111, v94, v95
v_mfma_f32_32x32x16_bf16 v[80:95], v[242:245], v[22:25], 0
v_exp_f32 v64, v64
v_exp_f32 v65, v65
v_exp_f32 v66, v66
v_exp_f32 v67, v67
v_cvt_pk_bf16_f32 v96, v64, v65
v_exp_f32 v68, v68
v_mfma_f32_32x32x16_bf16 v[128:143], v[160:163], v[104:107], v[128:143]
v_exp_f32 v69, v69
v_cvt_pk_bf16_f32 v97, v66, v67
v_exp_f32 v70, v70
v_exp_f32 v71, v71
v_cvt_pk_bf16_f32 v98, v68, v69
v_exp_f32 v72, v72
v_mfma_f32_32x32x8_bf16 v[80:95], v[246:247], v[26:27], v[80:95]
v_exp_f32 v73, v73
v_cvt_pk_bf16_f32 v99, v70, v71
v_exp_f32 v74, v74
v_exp_f32 v75, v75
v_cvt_pk_bf16_f32 v100, v72, v73
v_exp_f32 v76, v76
v_mfma_f32_32x32x16_bf16 v[128:143], v[164:167], v[108:111], v[128:143]
v_exp_f32 v77, v77
v_cvt_pk_bf16_f32 v101, v74, v75
v_exp_f32 v78, v78
v_exp_f32 v79, v79
v_cvt_pk_bf16_f32 v102, v76, v77
v_cvt_pk_bf16_f32 v103, v78, v79
v_mfma_f32_32x32x16_bf16 v[64:79], v[248:251], v[16:19], 0
v_exp_f32 v80, v80
v_exp_f32 v81, v81
v_exp_f32 v82, v82
v_exp_f32 v83, v83
v_cvt_pk_bf16_f32 v104, v80, v81
v_exp_f32 v84, v84
v_mfma_f32_32x32x16_bf16 v[112:127], v[168:171], v[96:99], v[112:127]
v_exp_f32 v85, v85
v_cvt_pk_bf16_f32 v105, v82, v83
v_exp_f32 v86, v86
v_exp_f32 v87, v87
v_cvt_pk_bf16_f32 v106, v84, v85
v_exp_f32 v88, v88
v_mfma_f32_32x32x8_bf16 v[64:79], v[252:253], v[20:21], v[64:79]
v_exp_f32 v89, v89
v_cvt_pk_bf16_f32 v107, v86, v87
v_exp_f32 v90, v90
v_exp_f32 v91, v91
v_cvt_pk_bf16_f32 v108, v88, v89
v_exp_f32 v92, v92
v_mfma_f32_32x32x16_bf16 v[112:127], v[172:175], v[100:103], v[112:127]
v_exp_f32 v93, v93
v_cvt_pk_bf16_f32 v109, v90, v91
v_exp_f32 v94, v94
v_exp_f32 v95, v95
v_cvt_pk_bf16_f32 v110, v92, v93
v_cvt_pk_bf16_f32 v111, v94, v95
v_mfma_f32_32x32x16_bf16 v[80:95], v[248:251], v[22:25], 0
ds_read_b128 v[48:51], v2 offset:43520
s_mov_b64 exec, s[76:77]
ds_read_b64 v[52:53], v3 offset:44544
ds_read_b64 v[58:59], v3 offset:45824
s_mov_b64 exec, s[66:67]
ds_read_b128 v[40:43], v4 offset:47360
ds_read_b128 v[44:47], v4 offset:48000
ds_read_b128 v[144:147], v4 offset:48640
ds_read_b128 v[148:151], v4 offset:49280
s_mov_b64 exec, -1
v_exp_f32 v64, v64
v_exp_f32 v65, v65
v_exp_f32 v66, v66
v_exp_f32 v67, v67
v_cvt_pk_bf16_f32 v96, v64, v65
v_exp_f32 v68, v68
v_mfma_f32_32x32x16_bf16 v[128:143], v[168:171], v[104:107], v[128:143]
ds_read_b128 v[54:57], v2 offset:44800
v_exp_f32 v69, v69
v_cvt_pk_bf16_f32 v97, v66, v67
v_exp_f32 v70, v70
v_exp_f32 v71, v71
v_cvt_pk_bf16_f32 v98, v68, v69
v_exp_f32 v72, v72
v_mfma_f32_32x32x8_bf16 v[80:95], v[252:253], v[26:27], v[80:95]
v_exp_f32 v73, v73
v_cvt_pk_bf16_f32 v99, v70, v71
v_exp_f32 v74, v74
v_exp_f32 v75, v75
v_cvt_pk_bf16_f32 v100, v72, v73
v_exp_f32 v76, v76
v_mfma_f32_32x32x16_bf16 v[128:143], v[172:175], v[108:111], v[128:143]
v_exp_f32 v77, v77
v_cvt_pk_bf16_f32 v101, v74, v75
v_exp_f32 v78, v78
v_exp_f32 v79, v79
v_cvt_pk_bf16_f32 v102, v76, v77
v_cvt_pk_bf16_f32 v103, v78, v79
s_waitcnt lgkmcnt(0)
v_mfma_f32_32x32x16_bf16 v[64:79], v[48:51], v[16:19], 0
v_exp_f32 v80, v80
v_exp_f32 v81, v81
v_exp_f32 v82, v82
v_exp_f32 v83, v83
v_cvt_pk_bf16_f32 v104, v80, v81
v_exp_f32 v84, v84
v_mfma_f32_32x32x16_bf16 v[112:127], v[40:43], v[96:99], v[112:127]
v_exp_f32 v85, v85
v_cvt_pk_bf16_f32 v105, v82, v83
v_exp_f32 v86, v86
v_exp_f32 v87, v87
v_cvt_pk_bf16_f32 v106, v84, v85
v_exp_f32 v88, v88
v_mfma_f32_32x32x8_bf16 v[64:79], v[52:53], v[20:21], v[64:79]
v_exp_f32 v89, v89
v_cvt_pk_bf16_f32 v107, v86, v87
v_exp_f32 v90, v90
v_exp_f32 v91, v91
v_cvt_pk_bf16_f32 v108, v88, v89
v_exp_f32 v92, v92
v_mfma_f32_32x32x16_bf16 v[112:127], v[44:47], v[100:103], v[112:127]
v_exp_f32 v93, v93
v_cvt_pk_bf16_f32 v109, v90, v91
v_exp_f32 v94, v94
v_exp_f32 v95, v95
v_cvt_pk_bf16_f32 v110, v92, v93
v_cvt_pk_bf16_f32 v111, v94, v95
v_mfma_f32_32x32x16_bf16 v[80:95], v[48:51], v[22:25], 0
v_exp_f32 v64, v64
v_exp_f32 v65, v65
v_exp_f32 v66, v66
v_exp_f32 v67, v67
v_cvt_pk_bf16_f32 v96, v64, v65
v_exp_f32 v68, v68
v_mfma_f32_32x32x16_bf16 v[128:143], v[40:43], v[104:107], v[128:143]
v_exp_f32 v69, v69
v_cvt_pk_bf16_f32 v97, v66, v67
v_exp_f32 v70, v70
v_exp_f32 v71, v71
v_cvt_pk_bf16_f32 v98, v68, v69
v_exp_f32 v72, v72
v_mfma_f32_32x32x8_bf16 v[80:95], v[52:53], v[26:27], v[80:95]
v_exp_f32 v73, v73
v_cvt_pk_bf16_f32 v99, v70, v71
v_exp_f32 v74, v74
v_exp_f32 v75, v75
v_cvt_pk_bf16_f32 v100, v72, v73
v_exp_f32 v76, v76
v_mfma_f32_32x32x16_bf16 v[128:143], v[44:47], v[108:111], v[128:143]
v_exp_f32 v77, v77
v_cvt_pk_bf16_f32 v101, v74, v75
v_exp_f32 v78, v78
v_exp_f32 v79, v79
v_cvt_pk_bf16_f32 v102, v76, v77
v_cvt_pk_bf16_f32 v103, v78, v79
v_mfma_f32_32x32x16_bf16 v[64:79], v[54:57], v[16:19], 0
v_exp_f32 v80, v80
v_exp_f32 v81, v81
v_exp_f32 v82, v82
v_exp_f32 v83, v83
v_cvt_pk_bf16_f32 v104, v80, v81
v_exp_f32 v84, v84
v_mfma_f32_32x32x16_bf16 v[112:127], v[144:147], v[96:99], v[112:127]
v_exp_f32 v85, v85
v_cvt_pk_bf16_f32 v105, v82, v83
v_exp_f32 v86, v86
v_exp_f32 v87, v87
v_cvt_pk_bf16_f32 v106, v84, v85
v_exp_f32 v88, v88
v_mfma_f32_32x32x8_bf16 v[64:79], v[58:59], v[20:21], v[64:79]
v_exp_f32 v89, v89
v_cvt_pk_bf16_f32 v107, v86, v87
v_exp_f32 v90, v90
v_exp_f32 v91, v91
v_cvt_pk_bf16_f32 v108, v88, v89
v_exp_f32 v92, v92
v_mfma_f32_32x32x16_bf16 v[112:127], v[148:151], v[100:103], v[112:127]
v_exp_f32 v93, v93
v_cvt_pk_bf16_f32 v109, v90, v91
v_exp_f32 v94, v94
v_exp_f32 v95, v95
v_cvt_pk_bf16_f32 v110, v92, v93
v_cvt_pk_bf16_f32 v111, v94, v95
s_cmp_eq_u32 s61, 0
s_cbranch_scc1 att_hk_46
att_hk_46r:
s_barrier
v_mfma_f32_32x32x16_bf16 v[80:95], v[54:57], v[22:25], 0
v_add_u32 v2, 40960, v2
v_add_u32 v3, 40960, v3
v_add_u32 v4, 40960, v4
ds_read_b128 v[236:239], v2 offset:20480
s_mov_b64 exec, s[76:77]
ds_read_b64 v[240:241], v3 offset:21504
ds_read_b64 v[246:247], v3 offset:22784
s_mov_b64 exec, s[66:67]
ds_read_b128 v[152:155], v4 offset:8960
ds_read_b128 v[156:159], v4 offset:9600
ds_read_b128 v[160:163], v4 offset:25600
ds_read_b128 v[164:167], v4 offset:26240
s_mov_b64 exec, -1
v_exp_f32 v64, v64
v_exp_f32 v65, v65
v_exp_f32 v66, v66
v_exp_f32 v67, v67
v_cvt_pk_bf16_f32 v96, v64, v65
v_exp_f32 v68, v68
v_mfma_f32_32x32x16_bf16 v[128:143], v[144:147], v[104:107], v[128:143]
ds_read_b128 v[242:245], v2 offset:21760
v_exp_f32 v69, v69
v_cvt_pk_bf16_f32 v97, v66, v67
v_exp_f32 v70, v70
v_exp_f32 v71, v71
v_cvt_pk_bf16_f32 v98, v68, v69
v_exp_f32 v72, v72
v_mfma_f32_32x32x8_bf16 v[80:95], v[58:59], v[26:27], v[80:95]
v_exp_f32 v73, v73
v_cvt_pk_bf16_f32 v99, v70, v71
v_exp_f32 v74, v74
v_exp_f32 v75, v75
v_cvt_pk_bf16_f32 v100, v72, v73
v_exp_f32 v76, v76
v_mfma_f32_32x32x16_bf16 v[128:143], v[148:151], v[108:111], v[128:143]
v_exp_f32 v77, v77
v_cvt_pk_bf16_f32 v101, v74, v75
v_exp_f32 v78, v78
v_exp_f32 v79, v79
v_cvt_pk_bf16_f32 v102, v76, v77
v_cvt_pk_bf16_f32 v103, v78, v79
s_waitcnt lgkmcnt(0)
v_mfma_f32_32x32x16_bf16 v[64:79], v[236:239], v[16:19], 0
v_exp_f32 v80, v80
v_exp_f32 v81, v81
v_exp_f32 v82, v82
v_exp_f32 v83, v83
v_cvt_pk_bf16_f32 v104, v80, v81
v_exp_f32 v84, v84
v_mfma_f32_32x32x16_bf16 v[112:127], v[152:155], v[96:99], v[112:127]
v_exp_f32 v85, v85
v_cvt_pk_bf16_f32 v105, v82, v83
v_exp_f32 v86, v86
v_exp_f32 v87, v87
v_cvt_pk_bf16_f32 v106, v84, v85
v_exp_f32 v88, v88
v_mfma_f32_32x32x8_bf16 v[64:79], v[240:241], v[20:21], v[64:79]
v_exp_f32 v89, v89
v_cvt_pk_bf16_f32 v107, v86, v87
v_exp_f32 v90, v90
v_exp_f32 v91, v91
v_cvt_pk_bf16_f32 v108, v88, v89
v_exp_f32 v92, v92
v_mfma_f32_32x32x16_bf16 v[112:127], v[156:159], v[100:103], v[112:127]
v_exp_f32 v93, v93
v_cvt_pk_bf16_f32 v109, v90, v91
v_exp_f32 v94, v94
v_exp_f32 v95, v95
v_cvt_pk_bf16_f32 v110, v92, v93
v_cvt_pk_bf16_f32 v111, v94, v95
v_mfma_f32_32x32x16_bf16 v[80:95], v[236:239], v[22:25], 0
v_exp_f32 v64, v64
v_exp_f32 v65, v65
v_exp_f32 v66, v66
v_exp_f32 v67, v67
v_cvt_pk_bf16_f32 v96, v64, v65
v_exp_f32 v68, v68
v_mfma_f32_32x32x16_bf16 v[128:143], v[152:155], v[104:107], v[128:143]
v_exp_f32 v69, v69
v_cvt_pk_bf16_f32 v97, v66, v67
v_exp_f32 v70, v70
v_exp_f32 v71, v71
v_cvt_pk_bf16_f32 v98, v68, v69
v_exp_f32 v72, v72
v_mfma_f32_32x32x8_bf16 v[80:95], v[240:241], v[26:27], v[80:95]
v_exp_f32 v73, v73
v_cvt_pk_bf16_f32 v99, v70, v71
v_exp_f32 v74, v74
v_exp_f32 v75, v75
v_cvt_pk_bf16_f32 v100, v72, v73
v_exp_f32 v76, v76
v_mfma_f32_32x32x16_bf16 v[128:143], v[156:159], v[108:111], v[128:143]
v_exp_f32 v77, v77
v_cvt_pk_bf16_f32 v101, v74, v75
v_exp_f32 v78, v78
v_exp_f32 v79, v79
v_cvt_pk_bf16_f32 v102, v76, v77
v_cvt_pk_bf16_f32 v103, v78, v79
v_mfma_f32_32x32x16_bf16 v[64:79], v[242:245], v[16:19], 0
v_exp_f32 v80, v80
v_exp_f32 v81, v81
v_exp_f32 v82, v82
v_exp_f32 v83, v83
v_cvt_pk_bf16_f32 v104, v80, v81
v_exp_f32 v84, v84
v_mfma_f32_32x32x16_bf16 v[112:127], v[160:163], v[96:99], v[112:127]
v_exp_f32 v85, v85
v_cvt_pk_bf16_f32 v105, v82, v83
v_exp_f32 v86, v86
v_exp_f32 v87, v87
v_cvt_pk_bf16_f32 v106, v84, v85
v_exp_f32 v88, v88
v_mfma_f32_32x32x8_bf16 v[64:79], v[246:247], v[20:21], v[64:79]
v_exp_f32 v89, v89
v_cvt_pk_bf16_f32 v107, v86, v87
v_exp_f32 v90, v90
v_exp_f32 v91, v91
v_cvt_pk_bf16_f32 v108, v88, v89
v_exp_f32 v92, v92
v_mfma_f32_32x32x16_bf16 v[112:127], v[164:167], v[100:103], v[112:127]
v_exp_f32 v93, v93
v_cvt_pk_bf16_f32 v109, v90, v91
v_exp_f32 v94, v94
v_exp_f32 v95, v95
v_cvt_pk_bf16_f32 v110, v92, v93
v_cvt_pk_bf16_f32 v111, v94, v95
v_mfma_f32_32x32x16_bf16 v[80:95], v[242:245], v[22:25], 0
ds_read_b128 v[248:251], v2 offset:23040
s_mov_b64 exec, s[76:77]
ds_read_b64 v[252:253], v3 offset:24064
ds_read_b64 v[52:53], v3 offset:25344
s_mov_b64 exec, s[66:67]
ds_read_b128 v[168:171], v4 offset:26880
ds_read_b128 v[172:175], v4 offset:27520
ds_read_b128 v[40:43], v4 offset:28160
ds_read_b128 v[44:47], v4 offset:28800
s_mov_b64 exec, -1
v_exp_f32 v64, v64
v_exp_f32 v65, v65
v_exp_f32 v66, v66
v_exp_f32 v67, v67
v_cvt_pk_bf16_f32 v96, v64, v65
v_exp_f32 v68, v68
v_mfma_f32_32x32x16_bf16 v[128:143], v[160:163], v[104:107], v[128:143]
ds_read_b128 v[48:51], v2 offset:24320
v_exp_f32 v69, v69
v_cvt_pk_bf16_f32 v97, v66, v67
v_exp_f32 v70, v70
v_exp_f32 v71, v71
v_cvt_pk_bf16_f32 v98, v68, v69
v_exp_f32 v72, v72
v_mfma_f32_32x32x8_bf16 v[80:95], v[246:247], v[26:27], v[80:95]
v_exp_f32 v73, v73
v_cvt_pk_bf16_f32 v99, v70, v71
v_exp_f32 v74, v74
v_exp_f32 v75, v75
v_cvt_pk_bf16_f32 v100, v72, v73
v_exp_f32 v76, v76
v_mfma_f32_32x32x16_bf16 v[128:143], v[164:167], v[108:111], v[128:143]
v_exp_f32 v77, v77
v_cvt_pk_bf16_f32 v101, v74, v75
v_exp_f32 v78, v78
v_exp_f32 v79, v79
v_cvt_pk_bf16_f32 v102, v76, v77
v_cvt_pk_bf16_f32 v103, v78, v79
s_waitcnt lgkmcnt(0)
v_mfma_f32_32x32x16_bf16 v[64:79], v[248:251], v[16:19], 0
v_exp_f32 v80, v80
v_exp_f32 v81, v81
v_exp_f32 v82, v82
v_exp_f32 v83, v83
v_cvt_pk_bf16_f32 v104, v80, v81
v_exp_f32 v84, v84
v_mfma_f32_32x32x16_bf16 v[112:127], v[168:171], v[96:99], v[112:127]
v_exp_f32 v85, v85
v_cvt_pk_bf16_f32 v105, v82, v83
v_exp_f32 v86, v86
v_exp_f32 v87, v87
v_cvt_pk_bf16_f32 v106, v84, v85
v_exp_f32 v88, v88
v_mfma_f32_32x32x8_bf16 v[64:79], v[252:253], v[20:21], v[64:79]
v_exp_f32 v89, v89
v_cvt_pk_bf16_f32 v107, v86, v87
v_exp_f32 v90, v90
v_exp_f32 v91, v91
v_cvt_pk_bf16_f32 v108, v88, v89
v_exp_f32 v92, v92
v_mfma_f32_32x32x16_bf16 v[112:127], v[172:175], v[100:103], v[112:127]
v_exp_f32 v93, v93
v_cvt_pk_bf16_f32 v109, v90, v91
v_exp_f32 v94, v94
v_exp_f32 v95, v95
v_cvt_pk_bf16_f32 v110, v92, v93
v_cvt_pk_bf16_f32 v111, v94, v95
v_mfma_f32_32x32x16_bf16 v[80:95], v[248:251], v[22:25], 0
v_exp_f32 v64, v64
v_exp_f32 v65, v65
v_exp_f32 v66, v66
v_exp_f32 v67, v67
v_cvt_pk_bf16_f32 v96, v64, v65
v_exp_f32 v68, v68
v_mfma_f32_32x32x16_bf16 v[128:143], v[168:171], v[104:107], v[128:143]
v_exp_f32 v69, v69
v_cvt_pk_bf16_f32 v97, v66, v67
v_exp_f32 v70, v70
v_exp_f32 v71, v71
v_cvt_pk_bf16_f32 v98, v68, v69
v_exp_f32 v72, v72
v_mfma_f32_32x32x8_bf16 v[80:95], v[252:253], v[26:27], v[80:95]
v_exp_f32 v73, v73
v_cvt_pk_bf16_f32 v99, v70, v71
v_exp_f32 v74, v74
v_exp_f32 v75, v75
v_cvt_pk_bf16_f32 v100, v72, v73
v_exp_f32 v76, v76
v_mfma_f32_32x32x16_bf16 v[128:143], v[172:175], v[108:111], v[128:143]
v_exp_f32 v77, v77
v_cvt_pk_bf16_f32 v101, v74, v75
v_exp_f32 v78, v78
v_exp_f32 v79, v79
v_cvt_pk_bf16_f32 v102, v76, v77
v_cvt_pk_bf16_f32 v103, v78, v79
v_mfma_f32_32x32x16_bf16 v[64:79], v[48:51], v[16:19], 0
v_exp_f32 v80, v80
v_exp_f32 v81, v81
v_exp_f32 v82, v82
v_exp_f32 v83, v83
v_cvt_pk_bf16_f32 v104, v80, v81
v_exp_f32 v84, v84
v_mfma_f32_32x32x16_bf16 v[112:127], v[40:43], v[96:99], v[112:127]
v_exp_f32 v85, v85
v_cvt_pk_bf16_f32 v105, v82, v83
v_exp_f32 v86, v86
v_exp_f32 v87, v87
v_cvt_pk_bf16_f32 v106, v84, v85
v_exp_f32 v88, v88
v_mfma_f32_32x32x8_bf16 v[64:79], v[52:53], v[20:21], v[64:79]
v_exp_f32 v89, v89
v_cvt_pk_bf16_f32 v107, v86, v87
v_exp_f32 v90, v90
v_exp_f32 v91, v91
v_cvt_pk_bf16_f32 v108, v88, v89
v_exp_f32 v92, v92
v_mfma_f32_32x32x16_bf16 v[112:127], v[44:47], v[100:103], v[112:127]
v_exp_f32 v93, v93
v_cvt_pk_bf16_f32 v109, v90, v91
v_exp_f32 v94, v94
v_exp_f32 v95, v95
v_cvt_pk_bf16_f32 v110, v92, v93
v_cvt_pk_bf16_f32 v111, v94, v95
s_cmp_eq_u32 s61, 0
s_cbranch_scc1 att_hk_47
att_hk_47r:
s_barrier
v_mfma_f32_32x32x16_bf16 v[80:95], v[48:51], v[22:25], 0
ds_read_b128 v[54:57], v2 offset:40960
s_mov_b64 exec, s[76:77]
ds_read_b64 v[58:59], v3 offset:41984
ds_read_b64 v[240:241], v3 offset:43264
s_mov_b64 exec, s[66:67]
ds_read_b128 v[144:147], v4 offset:29440
ds_read_b128 v[148:151], v4 offset:30080
ds_read_b128 v[152:155], v4 offset:46080
ds_read_b128 v[156:159], v4 offset:46720
s_mov_b64 exec, -1
v_exp_f32 v64, v64
v_exp_f32 v65, v65
v_exp_f32 v66, v66
v_exp_f32 v67, v67
v_cvt_pk_bf16_f32 v96, v64, v65
v_exp_f32 v68, v68
v_mfma_f32_32x32x16_bf16 v[128:143], v[40:43], v[104:107], v[128:143]
ds_read_b128 v[236:239], v2 offset:42240
v_exp_f32 v69, v69
v_cvt_pk_bf16_f32 v97, v66, v67
v_exp_f32 v70, v70
v_exp_f32 v71, v71
v_cvt_pk_bf16_f32 v98, v68, v69
v_exp_f32 v72, v72
v_mfma_f32_32x32x8_bf16 v[80:95], v[52:53], v[26:27], v[80:95]
v_exp_f32 v73, v73
v_cvt_pk_bf16_f32 v99, v70, v71
v_exp_f32 v74, v74
v_exp_f32 v75, v75
v_cvt_pk_bf16_f32 v100, v72, v73
v_exp_f32 v76, v76
v_mfma_f32_32x32x16_bf16 v[128:143], v[44:47], v[108:111], v[128:143]
v_exp_f32 v77, v77
v_cvt_pk_bf16_f32 v101, v74, v75
v_exp_f32 v78, v78
v_exp_f32 v79, v79
v_cvt_pk_bf16_f32 v102, v76, v77
v_cvt_pk_bf16_f32 v103, v78, v79
s_waitcnt lgkmcnt(0)
v_mfma_f32_32x32x16_bf16 v[64:79], v[54:57], v[16:19], 0
v_exp_f32 v80, v80
v_exp_f32 v81, v81
v_exp_f32 v82, v82
v_exp_f32 v83, v83
v_cvt_pk_bf16_f32 v104, v80, v81
v_exp_f32 v84, v84
v_mfma_f32_32x32x16_bf16 v[112:127], v[144:147], v[96:99], v[112:127]
v_exp_f32 v85, v85
v_cvt_pk_bf16_f32 v105, v82, v83
v_exp_f32 v86, v86
v_exp_f32 v87, v87
v_cvt_pk_bf16_f32 v106, v84, v85
v_exp_f32 v88, v88
v_mfma_f32_32x32x8_bf16 v[64:79], v[58:59], v[20:21], v[64:79]
v_exp_f32 v89, v89
v_cvt_pk_bf16_f32 v107, v86, v87
v_exp_f32 v90, v90
v_exp_f32 v91, v91
v_cvt_pk_bf16_f32 v108, v88, v89
v_exp_f32 v92, v92
v_mfma_f32_32x32x16_bf16 v[112:127], v[148:151], v[100:103], v[112:127]
v_exp_f32 v93, v93
v_cvt_pk_bf16_f32 v109, v90, v91
v_exp_f32 v94, v94
v_exp_f32 v95, v95
v_cvt_pk_bf16_f32 v110, v92, v93
v_cvt_pk_bf16_f32 v111, v94, v95
v_mfma_f32_32x32x16_bf16 v[80:95], v[54:57], v[22:25], 0
v_exp_f32 v64, v64
v_exp_f32 v65, v65
v_exp_f32 v66, v66
v_exp_f32 v67, v67
v_cvt_pk_bf16_f32 v96, v64, v65
v_exp_f32 v68, v68
v_mfma_f32_32x32x16_bf16 v[128:143], v[144:147], v[104:107], v[128:143]
v_exp_f32 v69, v69
v_cvt_pk_bf16_f32 v97, v66, v67
v_exp_f32 v70, v70
v_exp_f32 v71, v71
v_cvt_pk_bf16_f32 v98, v68, v69
v_exp_f32 v72, v72
v_mfma_f32_32x32x8_bf16 v[80:95], v[58:59], v[26:27], v[80:95]
v_exp_f32 v73, v73
v_cvt_pk_bf16_f32 v99, v70, v71
v_exp_f32 v74, v74
v_exp_f32 v75, v75
v_cvt_pk_bf16_f32 v100, v72, v73
v_exp_f32 v76, v76
v_mfma_f32_32x32x16_bf16 v[128:143], v[148:151], v[108:111], v[128:143]
v_exp_f32 v77, v77
v_cvt_pk_bf16_f32 v101, v74, v75
v_exp_f32 v78, v78
v_exp_f32 v79, v79
v_cvt_pk_bf16_f32 v102, v76, v77
v_cvt_pk_bf16_f32 v103, v78, v79
v_mfma_f32_32x32x16_bf16 v[64:79], v[236:239], v[16:19], 0
v_exp_f32 v80, v80
v_exp_f32 v81, v81
v_exp_f32 v82, v82
v_exp_f32 v83, v83
v_cvt_pk_bf16_f32 v104, v80, v81
v_exp_f32 v84, v84
v_mfma_f32_32x32x16_bf16 v[112:127], v[152:155], v[96:99], v[112:127]
v_exp_f32 v85, v85
v_cvt_pk_bf16_f32 v105, v82, v83
v_exp_f32 v86, v86
v_exp_f32 v87, v87
v_cvt_pk_bf16_f32 v106, v84, v85
v_exp_f32 v88, v88
v_mfma_f32_32x32x8_bf16 v[64:79], v[240:241], v[20:21], v[64:79]
v_exp_f32 v89, v89
v_cvt_pk_bf16_f32 v107, v86, v87
v_exp_f32 v90, v90
v_exp_f32 v91, v91
v_cvt_pk_bf16_f32 v108, v88, v89
v_exp_f32 v92, v92
v_mfma_f32_32x32x16_bf16 v[112:127], v[156:159], v[100:103], v[112:127]
v_exp_f32 v93, v93
v_cvt_pk_bf16_f32 v109, v90, v91
v_exp_f32 v94, v94
v_exp_f32 v95, v95
v_cvt_pk_bf16_f32 v110, v92, v93
v_cvt_pk_bf16_f32 v111, v94, v95
v_mfma_f32_32x32x16_bf16 v[80:95], v[236:239], v[22:25], 0
ds_read_b128 v[242:245], v2 offset:43520
s_mov_b64 exec, s[76:77]
ds_read_b64 v[246:247], v3 offset:44544
ds_read_b64 v[252:253], v3 offset:45824
s_mov_b64 exec, s[66:67]
ds_read_b128 v[160:163], v4 offset:47360
ds_read_b128 v[164:167], v4 offset:48000
ds_read_b128 v[168:171], v4 offset:48640
ds_read_b128 v[172:175], v4 offset:49280
s_mov_b64 exec, -1
v_exp_f32 v64, v64
v_exp_f32 v65, v65
v_exp_f32 v66, v66
v_exp_f32 v67, v67
v_cvt_pk_bf16_f32 v96, v64, v65
v_exp_f32 v68, v68
v_mfma_f32_32x32x16_bf16 v[128:143], v[152:155], v[104:107], v[128:143]
ds_read_b128 v[248:251], v2 offset:44800
v_exp_f32 v69, v69
v_cvt_pk_bf16_f32 v97, v66, v67
v_exp_f32 v70, v70
v_exp_f32 v71, v71
v_cvt_pk_bf16_f32 v98, v68, v69
v_exp_f32 v72, v72
v_mfma_f32_32x32x8_bf16 v[80:95], v[240:241], v[26:27], v[80:95]
v_exp_f32 v73, v73
v_cvt_pk_bf16_f32 v99, v70, v71
v_exp_f32 v74, v74
v_exp_f32 v75, v75
v_cvt_pk_bf16_f32 v100, v72, v73
v_exp_f32 v76, v76
v_mfma_f32_32x32x16_bf16 v[128:143], v[156:159], v[108:111], v[128:143]
v_exp_f32 v77, v77
v_cvt_pk_bf16_f32 v101, v74, v75
v_exp_f32 v78, v78
v_exp_f32 v79, v79
v_cvt_pk_bf16_f32 v102, v76, v77
v_cvt_pk_bf16_f32 v103, v78, v79
s_waitcnt lgkmcnt(0)
v_mfma_f32_32x32x16_bf16 v[64:79], v[242:245], v[16:19], 0
v_exp_f32 v80, v80
v_exp_f32 v81, v81
v_exp_f32 v82, v82
v_exp_f32 v83, v83
v_cvt_pk_bf16_f32 v104, v80, v81
v_exp_f32 v84, v84
v_mfma_f32_32x32x16_bf16 v[112:127], v[160:163], v[96:99], v[112:127]
v_exp_f32 v85, v85
v_cvt_pk_bf16_f32 v105, v82, v83
v_exp_f32 v86, v86
v_exp_f32 v87, v87
v_cvt_pk_bf16_f32 v106, v84, v85
v_exp_f32 v88, v88
v_mfma_f32_32x32x8_bf16 v[64:79], v[246:247], v[20:21], v[64:79]
v_exp_f32 v89, v89
v_cvt_pk_bf16_f32 v107, v86, v87
v_exp_f32 v90, v90
v_exp_f32 v91, v91
v_cvt_pk_bf16_f32 v108, v88, v89
v_exp_f32 v92, v92
v_mfma_f32_32x32x16_bf16 v[112:127], v[164:167], v[100:103], v[112:127]
v_exp_f32 v93, v93
v_cvt_pk_bf16_f32 v109, v90, v91
v_exp_f32 v94, v94
v_exp_f32 v95, v95
v_cvt_pk_bf16_f32 v110, v92, v93
v_cvt_pk_bf16_f32 v111, v94, v95
v_mfma_f32_32x32x16_bf16 v[80:95], v[242:245], v[22:25], 0
v_exp_f32 v64, v64
v_exp_f32 v65, v65
v_exp_f32 v66, v66
v_exp_f32 v67, v67
v_cvt_pk_bf16_f32 v96, v64, v65
v_exp_f32 v68, v68
v_mfma_f32_32x32x16_bf16 v[128:143], v[160:163], v[104:107], v[128:143]
v_exp_f32 v69, v69
v_cvt_pk_bf16_f32 v97, v66, v67
v_exp_f32 v70, v70
v_exp_f32 v71, v71
v_cvt_pk_bf16_f32 v98, v68, v69
v_exp_f32 v72, v72
v_mfma_f32_32x32x8_bf16 v[80:95], v[246:247], v[26:27], v[80:95]
v_exp_f32 v73, v73
v_cvt_pk_bf16_f32 v99, v70, v71
v_exp_f32 v74, v74
v_exp_f32 v75, v75
v_cvt_pk_bf16_f32 v100, v72, v73
v_exp_f32 v76, v76
v_mfma_f32_32x32x16_bf16 v[128:143], v[164:167], v[108:111], v[128:143]
v_exp_f32 v77, v77
v_cvt_pk_bf16_f32 v101, v74, v75
v_exp_f32 v78, v78
v_exp_f32 v79, v79
v_cvt_pk_bf16_f32 v102, v76, v77
v_cvt_pk_bf16_f32 v103, v78, v79
v_mfma_f32_32x32x16_bf16 v[64:79], v[248:251], v[16:19], 0
v_exp_f32 v80, v80
v_exp_f32 v81, v81
v_exp_f32 v82, v82
v_exp_f32 v83, v83
v_cvt_pk_bf16_f32 v104, v80, v81
v_exp_f32 v84, v84
v_mfma_f32_32x32x16_bf16 v[112:127], v[168:171], v[96:99], v[112:127]
v_exp_f32 v85, v85
v_cvt_pk_bf16_f32 v105, v82, v83
v_exp_f32 v86, v86
v_exp_f32 v87, v87
v_cvt_pk_bf16_f32 v106, v84, v85
v_exp_f32 v88, v88
v_mfma_f32_32x32x8_bf16 v[64:79], v[252:253], v[20:21], v[64:79]
v_exp_f32 v89, v89
v_cvt_pk_bf16_f32 v107, v86, v87
v_exp_f32 v90, v90
v_exp_f32 v91, v91
v_cvt_pk_bf16_f32 v108, v88, v89
v_exp_f32 v92, v92
v_mfma_f32_32x32x16_bf16 v[112:127], v[172:175], v[100:103], v[112:127]
v_exp_f32 v93, v93
v_cvt_pk_bf16_f32 v109, v90, v91
v_exp_f32 v94, v94
v_exp_f32 v95, v95
v_cvt_pk_bf16_f32 v110, v92, v93
v_cvt_pk_bf16_f32 v111, v94, v95
s_cmp_eq_u32 s61, 0
s_cbranch_scc1 att_hk_48
att_hk_48r:
s_barrier
v_mfma_f32_32x32x16_bf16 v[80:95], v[248:251], v[22:25], 0
v_add_u32 v2, 40960, v2
v_add_u32 v3, 40960, v3
v_add_u32 v4, 40960, v4
ds_read_b128 v[48:51], v2 offset:20480
s_mov_b64 exec, s[76:77]
ds_read_b64 v[52:53], v3 offset:21504
ds_read_b64 v[58:59], v3 offset:22784
s_mov_b64 exec, s[66:67]
ds_read_b128 v[40:43], v4 offset:8960
ds_read_b128 v[44:47], v4 offset:9600
ds_read_b128 v[144:147], v4 offset:25600
ds_read_b128 v[148:151], v4 offset:26240
s_mov_b64 exec, -1
v_exp_f32 v64, v64
v_exp_f32 v65, v65
v_exp_f32 v66, v66
v_exp_f32 v67, v67
v_cvt_pk_bf16_f32 v96, v64, v65
v_exp_f32 v68, v68
v_mfma_f32_32x32x16_bf16 v[128:143], v[168:171], v[104:107], v[128:143]
ds_read_b128 v[54:57], v2 offset:21760
v_exp_f32 v69, v69
v_cvt_pk_bf16_f32 v97, v66, v67
v_exp_f32 v70, v70
v_exp_f32 v71, v71
v_cvt_pk_bf16_f32 v98, v68, v69
v_exp_f32 v72, v72
v_mfma_f32_32x32x8_bf16 v[80:95], v[252:253], v[26:27], v[80:95]
v_exp_f32 v73, v73
v_cvt_pk_bf16_f32 v99, v70, v71
v_exp_f32 v74, v74
v_exp_f32 v75, v75
v_cvt_pk_bf16_f32 v100, v72, v73
v_exp_f32 v76, v76
v_mfma_f32_32x32x16_bf16 v[128:143], v[172:175], v[108:111], v[128:143]
v_exp_f32 v77, v77
v_cvt_pk_bf16_f32 v101, v74, v75
v_exp_f32 v78, v78
v_exp_f32 v79, v79
v_cvt_pk_bf16_f32 v102, v76, v77
v_cvt_pk_bf16_f32 v103, v78, v79
s_waitcnt lgkmcnt(0)
v_mfma_f32_32x32x16_bf16 v[64:79], v[48:51], v[16:19], 0
v_exp_f32 v80, v80
v_exp_f32 v81, v81
v_exp_f32 v82, v82
v_exp_f32 v83, v83
v_cvt_pk_bf16_f32 v104, v80, v81
v_exp_f32 v84, v84
v_mfma_f32_32x32x16_bf16 v[112:127], v[40:43], v[96:99], v[112:127]
v_exp_f32 v85, v85
v_cvt_pk_bf16_f32 v105, v82, v83
v_exp_f32 v86, v86
v_exp_f32 v87, v87
v_cvt_pk_bf16_f32 v106, v84, v85
v_exp_f32 v88, v88
v_mfma_f32_32x32x8_bf16 v[64:79], v[52:53], v[20:21], v[64:79]
v_exp_f32 v89, v89
v_cvt_pk_bf16_f32 v107, v86, v87
v_exp_f32 v90, v90
v_exp_f32 v91, v91
v_cvt_pk_bf16_f32 v108, v88, v89
v_exp_f32 v92, v92
v_mfma_f32_32x32x16_bf16 v[112:127], v[44:47], v[100:103], v[112:127]
v_exp_f32 v93, v93
v_cvt_pk_bf16_f32 v109, v90, v91
v_exp_f32 v94, v94
v_exp_f32 v95, v95
v_cvt_pk_bf16_f32 v110, v92, v93
v_cvt_pk_bf16_f32 v111, v94, v95
v_mfma_f32_32x32x16_bf16 v[80:95], v[48:51], v[22:25], 0
v_exp_f32 v64, v64
v_exp_f32 v65, v65
v_exp_f32 v66, v66
v_exp_f32 v67, v67
v_cvt_pk_bf16_f32 v96, v64, v65
v_exp_f32 v68, v68
v_mfma_f32_32x32x16_bf16 v[128:143], v[40:43], v[104:107], v[128:143]
v_exp_f32 v69, v69
v_cvt_pk_bf16_f32 v97, v66, v67
v_exp_f32 v70, v70
v_exp_f32 v71, v71
v_cvt_pk_bf16_f32 v98, v68, v69
v_exp_f32 v72, v72
v_mfma_f32_32x32x8_bf16 v[80:95], v[52:53], v[26:27], v[80:95]
v_exp_f32 v73, v73
v_cvt_pk_bf16_f32 v99, v70, v71
v_exp_f32 v74, v74
v_exp_f32 v75, v75
v_cvt_pk_bf16_f32 v100, v72, v73
v_exp_f32 v76, v76
v_mfma_f32_32x32x16_bf16 v[128:143], v[44:47], v[108:111], v[128:143]
v_exp_f32 v77, v77
v_cvt_pk_bf16_f32 v101, v74, v75
v_exp_f32 v78, v78
v_exp_f32 v79, v79
v_cvt_pk_bf16_f32 v102, v76, v77
v_cvt_pk_bf16_f32 v103, v78, v79
v_mfma_f32_32x32x16_bf16 v[64:79], v[54:57], v[16:19], 0
v_exp_f32 v80, v80
v_exp_f32 v81, v81
v_exp_f32 v82, v82
v_exp_f32 v83, v83
v_cvt_pk_bf16_f32 v104, v80, v81
v_exp_f32 v84, v84
v_mfma_f32_32x32x16_bf16 v[112:127], v[144:147], v[96:99], v[112:127]
v_exp_f32 v85, v85
v_cvt_pk_bf16_f32 v105, v82, v83
v_exp_f32 v86, v86
v_exp_f32 v87, v87
v_cvt_pk_bf16_f32 v106, v84, v85
v_exp_f32 v88, v88
v_mfma_f32_32x32x8_bf16 v[64:79], v[58:59], v[20:21], v[64:79]
v_exp_f32 v89, v89
v_cvt_pk_bf16_f32 v107, v86, v87
v_exp_f32 v90, v90
v_exp_f32 v91, v91
v_cvt_pk_bf16_f32 v108, v88, v89
v_exp_f32 v92, v92
v_mfma_f32_32x32x16_bf16 v[112:127], v[148:151], v[100:103], v[112:127]
v_exp_f32 v93, v93
v_cvt_pk_bf16_f32 v109, v90, v91
v_exp_f32 v94, v94
v_exp_f32 v95, v95
v_cvt_pk_bf16_f32 v110, v92, v93
v_cvt_pk_bf16_f32 v111, v94, v95
v_mfma_f32_32x32x16_bf16 v[80:95], v[54:57], v[22:25], 0
ds_read_b128 v[236:239], v2 offset:23040
s_mov_b64 exec, s[76:77]
ds_read_b64 v[240:241], v3 offset:24064
ds_read_b64 v[246:247], v3 offset:25344
s_mov_b64 exec, s[66:67]
ds_read_b128 v[152:155], v4 offset:26880
ds_read_b128 v[156:159], v4 offset:27520
ds_read_b128 v[160:163], v4 offset:28160
ds_read_b128 v[164:167], v4 offset:28800
s_mov_b64 exec, -1
v_exp_f32 v64, v64
v_exp_f32 v65, v65
v_exp_f32 v66, v66
v_exp_f32 v67, v67
v_cvt_pk_bf16_f32 v96, v64, v65
v_exp_f32 v68, v68
v_mfma_f32_32x32x16_bf16 v[128:143], v[144:147], v[104:107], v[128:143]
ds_read_b128 v[242:245], v2 offset:24320
v_exp_f32 v69, v69
v_cvt_pk_bf16_f32 v97, v66, v67
v_exp_f32 v70, v70
v_exp_f32 v71, v71
v_cvt_pk_bf16_f32 v98, v68, v69
v_exp_f32 v72, v72
v_mfma_f32_32x32x8_bf16 v[80:95], v[58:59], v[26:27], v[80:95]
v_exp_f32 v73, v73
v_cvt_pk_bf16_f32 v99, v70, v71
v_exp_f32 v74, v74
v_exp_f32 v75, v75
v_cvt_pk_bf16_f32 v100, v72, v73
v_exp_f32 v76, v76
v_mfma_f32_32x32x16_bf16 v[128:143], v[148:151], v[108:111], v[128:143]
v_exp_f32 v77, v77
v_cvt_pk_bf16_f32 v101, v74, v75
v_exp_f32 v78, v78
v_exp_f32 v79, v79
v_cvt_pk_bf16_f32 v102, v76, v77
v_cvt_pk_bf16_f32 v103, v78, v79
s_waitcnt lgkmcnt(0)
v_mfma_f32_32x32x16_bf16 v[64:79], v[236:239], v[16:19], 0
v_exp_f32 v80, v80
v_exp_f32 v81, v81
v_exp_f32 v82, v82
v_exp_f32 v83, v83
v_cvt_pk_bf16_f32 v104, v80, v81
v_exp_f32 v84, v84
v_mfma_f32_32x32x16_bf16 v[112:127], v[152:155], v[96:99], v[112:127]
v_exp_f32 v85, v85
v_cvt_pk_bf16_f32 v105, v82, v83
v_exp_f32 v86, v86
v_exp_f32 v87, v87
v_cvt_pk_bf16_f32 v106, v84, v85
v_exp_f32 v88, v88
v_mfma_f32_32x32x8_bf16 v[64:79], v[240:241], v[20:21], v[64:79]
v_exp_f32 v89, v89
v_cvt_pk_bf16_f32 v107, v86, v87
v_exp_f32 v90, v90
v_exp_f32 v91, v91
v_cvt_pk_bf16_f32 v108, v88, v89
v_exp_f32 v92, v92
v_mfma_f32_32x32x16_bf16 v[112:127], v[156:159], v[100:103], v[112:127]
v_exp_f32 v93, v93
v_cvt_pk_bf16_f32 v109, v90, v91
v_exp_f32 v94, v94
v_exp_f32 v95, v95
v_cvt_pk_bf16_f32 v110, v92, v93
v_cvt_pk_bf16_f32 v111, v94, v95
v_mfma_f32_32x32x16_bf16 v[80:95], v[236:239], v[22:25], 0
v_exp_f32 v64, v64
v_exp_f32 v65, v65
v_exp_f32 v66, v66
v_exp_f32 v67, v67
v_cvt_pk_bf16_f32 v96, v64, v65
v_exp_f32 v68, v68
v_mfma_f32_32x32x16_bf16 v[128:143], v[152:155], v[104:107], v[128:143]
v_exp_f32 v69, v69
v_cvt_pk_bf16_f32 v97, v66, v67
v_exp_f32 v70, v70
v_exp_f32 v71, v71
v_cvt_pk_bf16_f32 v98, v68, v69
v_exp_f32 v72, v72
v_mfma_f32_32x32x8_bf16 v[80:95], v[240:241], v[26:27], v[80:95]
v_exp_f32 v73, v73
v_cvt_pk_bf16_f32 v99, v70, v71
v_exp_f32 v74, v74
v_exp_f32 v75, v75
v_cvt_pk_bf16_f32 v100, v72, v73
v_exp_f32 v76, v76
v_mfma_f32_32x32x16_bf16 v[128:143], v[156:159], v[108:111], v[128:143]
v_exp_f32 v77, v77
v_cvt_pk_bf16_f32 v101, v74, v75
v_exp_f32 v78, v78
v_exp_f32 v79, v79
v_cvt_pk_bf16_f32 v102, v76, v77
v_cvt_pk_bf16_f32 v103, v78, v79
v_mfma_f32_32x32x16_bf16 v[64:79], v[242:245], v[16:19], 0
v_exp_f32 v80, v80
v_exp_f32 v81, v81
v_exp_f32 v82, v82
v_exp_f32 v83, v83
v_cvt_pk_bf16_f32 v104, v80, v81
v_exp_f32 v84, v84
v_mfma_f32_32x32x16_bf16 v[112:127], v[160:163], v[96:99], v[112:127]
v_exp_f32 v85, v85
v_cvt_pk_bf16_f32 v105, v82, v83
v_exp_f32 v86, v86
v_exp_f32 v87, v87
v_cvt_pk_bf16_f32 v106, v84, v85
v_exp_f32 v88, v88
v_mfma_f32_32x32x8_bf16 v[64:79], v[246:247], v[20:21], v[64:79]
v_exp_f32 v89, v89
v_cvt_pk_bf16_f32 v107, v86, v87
v_exp_f32 v90, v90
v_exp_f32 v91, v91
v_cvt_pk_bf16_f32 v108, v88, v89
v_exp_f32 v92, v92
v_mfma_f32_32x32x16_bf16 v[112:127], v[164:167], v[100:103], v[112:127]
v_exp_f32 v93, v93
v_cvt_pk_bf16_f32 v109, v90, v91
v_exp_f32 v94, v94
v_exp_f32 v95, v95
v_cvt_pk_bf16_f32 v110, v92, v93
v_cvt_pk_bf16_f32 v111, v94, v95
s_cmp_eq_u32 s61, 0
s_cbranch_scc1 att_hk_49
att_hk_49r:
s_barrier
v_mfma_f32_32x32x16_bf16 v[80:95], v[242:245], v[22:25], 0
ds_read_b128 v[248:251], v2 offset:40960
s_mov_b64 exec, s[76:77]
ds_read_b64 v[252:253], v3 offset:41984
ds_read_b64 v[52:53], v3 offset:43264
s_mov_b64 exec, s[66:67]
ds_read_b128 v[168:171], v4 offset:29440
ds_read_b128 v[172:175], v4 offset:30080
ds_read_b128 v[40:43], v4 offset:46080
ds_read_b128 v[44:47], v4 offset:46720
s_mov_b64 exec, -1
v_exp_f32 v64, v64
v_exp_f32 v65, v65
v_exp_f32 v66, v66
v_exp_f32 v67, v67
v_cvt_pk_bf16_f32 v96, v64, v65
v_exp_f32 v68, v68
v_mfma_f32_32x32x16_bf16 v[128:143], v[160:163], v[104:107], v[128:143]
ds_read_b128 v[48:51], v2 offset:42240
v_exp_f32 v69, v69
v_cvt_pk_bf16_f32 v97, v66, v67
v_exp_f32 v70, v70
v_exp_f32 v71, v71
v_cvt_pk_bf16_f32 v98, v68, v69
v_exp_f32 v72, v72
v_mfma_f32_32x32x8_bf16 v[80:95], v[246:247], v[26:27], v[80:95]
v_exp_f32 v73, v73
v_cvt_pk_bf16_f32 v99, v70, v71
v_exp_f32 v74, v74
v_exp_f32 v75, v75
v_cvt_pk_bf16_f32 v100, v72, v73
v_exp_f32 v76, v76
v_mfma_f32_32x32x16_bf16 v[128:143], v[164:167], v[108:111], v[128:143]
v_exp_f32 v77, v77
v_cvt_pk_bf16_f32 v101, v74, v75
v_exp_f32 v78, v78
v_exp_f32 v79, v79
v_cvt_pk_bf16_f32 v102, v76, v77
v_cvt_pk_bf16_f32 v103, v78, v79
s_waitcnt lgkmcnt(0)
v_mfma_f32_32x32x16_bf16 v[64:79], v[248:251], v[16:19], 0
v_exp_f32 v80, v80
v_exp_f32 v81, v81
v_exp_f32 v82, v82
v_exp_f32 v83, v83
v_cvt_pk_bf16_f32 v104, v80, v81
v_exp_f32 v84, v84
v_mfma_f32_32x32x16_bf16 v[112:127], v[168:171], v[96:99], v[112:127]
v_exp_f32 v85, v85
v_cvt_pk_bf16_f32 v105, v82, v83
v_exp_f32 v86, v86
v_exp_f32 v87, v87
v_cvt_pk_bf16_f32 v106, v84, v85
v_exp_f32 v88, v88
v_mfma_f32_32x32x8_bf16 v[64:79], v[252:253], v[20:21], v[64:79]
v_exp_f32 v89, v89
v_cvt_pk_bf16_f32 v107, v86, v87
v_exp_f32 v90, v90
v_exp_f32 v91, v91
v_cvt_pk_bf16_f32 v108, v88, v89
v_exp_f32 v92, v92
v_mfma_f32_32x32x16_bf16 v[112:127], v[172:175], v[100:103], v[112:127]
v_exp_f32 v93, v93
v_cvt_pk_bf16_f32 v109, v90, v91
v_exp_f32 v94, v94
v_exp_f32 v95, v95
v_cvt_pk_bf16_f32 v110, v92, v93
v_cvt_pk_bf16_f32 v111, v94, v95
v_mfma_f32_32x32x16_bf16 v[80:95], v[248:251], v[22:25], 0
v_exp_f32 v64, v64
v_exp_f32 v65, v65
v_exp_f32 v66, v66
v_exp_f32 v67, v67
v_cvt_pk_bf16_f32 v96, v64, v65
v_exp_f32 v68, v68
v_mfma_f32_32x32x16_bf16 v[128:143], v[168:171], v[104:107], v[128:143]
v_exp_f32 v69, v69
v_cvt_pk_bf16_f32 v97, v66, v67
v_exp_f32 v70, v70
v_exp_f32 v71, v71
v_cvt_pk_bf16_f32 v98, v68, v69
v_exp_f32 v72, v72
v_mfma_f32_32x32x8_bf16 v[80:95], v[252:253], v[26:27], v[80:95]
v_exp_f32 v73, v73
v_cvt_pk_bf16_f32 v99, v70, v71
v_exp_f32 v74, v74
v_exp_f32 v75, v75
v_cvt_pk_bf16_f32 v100, v72, v73
v_exp_f32 v76, v76
v_mfma_f32_32x32x16_bf16 v[128:143], v[172:175], v[108:111], v[128:143]
v_exp_f32 v77, v77
v_cvt_pk_bf16_f32 v101, v74, v75
v_exp_f32 v78, v78
v_exp_f32 v79, v79
v_cvt_pk_bf16_f32 v102, v76, v77
v_cvt_pk_bf16_f32 v103, v78, v79
v_mfma_f32_32x32x16_bf16 v[64:79], v[48:51], v[16:19], 0
v_exp_f32 v80, v80
v_exp_f32 v81, v81
v_exp_f32 v82, v82
v_exp_f32 v83, v83
v_cvt_pk_bf16_f32 v104, v80, v81
v_exp_f32 v84, v84
v_mfma_f32_32x32x16_bf16 v[112:127], v[40:43], v[96:99], v[112:127]
v_exp_f32 v85, v85
v_cvt_pk_bf16_f32 v105, v82, v83
v_exp_f32 v86, v86
v_exp_f32 v87, v87
v_cvt_pk_bf16_f32 v106, v84, v85
v_exp_f32 v88, v88
v_mfma_f32_32x32x8_bf16 v[64:79], v[52:53], v[20:21], v[64:79]
v_exp_f32 v89, v89
v_cvt_pk_bf16_f32 v107, v86, v87
v_exp_f32 v90, v90
v_exp_f32 v91, v91
v_cvt_pk_bf16_f32 v108, v88, v89
v_exp_f32 v92, v92
v_mfma_f32_32x32x16_bf16 v[112:127], v[44:47], v[100:103], v[112:127]
v_exp_f32 v93, v93
v_cvt_pk_bf16_f32 v109, v90, v91
v_exp_f32 v94, v94
v_exp_f32 v95, v95
v_cvt_pk_bf16_f32 v110, v92, v93
v_cvt_pk_bf16_f32 v111, v94, v95
v_mfma_f32_32x32x16_bf16 v[80:95], v[48:51], v[22:25], 0
ds_read_b128 v[54:57], v2 offset:43520
s_mov_b64 exec, s[76:77]
ds_read_b64 v[58:59], v3 offset:44544
ds_read_b64 v[240:241], v3 offset:45824
s_mov_b64 exec, s[66:67]
ds_read_b128 v[144:147], v4 offset:47360
ds_read_b128 v[148:151], v4 offset:48000
ds_read_b128 v[152:155], v4 offset:48640
ds_read_b128 v[156:159], v4 offset:49280
s_mov_b64 exec, -1
v_exp_f32 v64, v64
v_exp_f32 v65, v65
v_exp_f32 v66, v66
v_exp_f32 v67, v67
v_cvt_pk_bf16_f32 v96, v64, v65
v_exp_f32 v68, v68
v_mfma_f32_32x32x16_bf16 v[128:143], v[40:43], v[104:107], v[128:143]
ds_read_b128 v[236:239], v2 offset:44800
v_exp_f32 v69, v69
v_cvt_pk_bf16_f32 v97, v66, v67
v_exp_f32 v70, v70
v_exp_f32 v71, v71
v_cvt_pk_bf16_f32 v98, v68, v69
v_exp_f32 v72, v72
v_mfma_f32_32x32x8_bf16 v[80:95], v[52:53], v[26:27], v[80:95]
v_exp_f32 v73, v73
v_cvt_pk_bf16_f32 v99, v70, v71
v_exp_f32 v74, v74
v_exp_f32 v75, v75
v_cvt_pk_bf16_f32 v100, v72, v73
v_exp_f32 v76, v76
v_mfma_f32_32x32x16_bf16 v[128:143], v[44:47], v[108:111], v[128:143]
v_exp_f32 v77, v77
v_cvt_pk_bf16_f32 v101, v74, v75
v_exp_f32 v78, v78
v_exp_f32 v79, v79
v_cvt_pk_bf16_f32 v102, v76, v77
v_cvt_pk_bf16_f32 v103, v78, v79
s_waitcnt lgkmcnt(0)
v_mfma_f32_32x32x16_bf16 v[64:79], v[54:57], v[16:19], 0
v_exp_f32 v80, v80
v_exp_f32 v81, v81
v_exp_f32 v82, v82
v_exp_f32 v83, v83
v_cvt_pk_bf16_f32 v104, v80, v81
v_exp_f32 v84, v84
v_mfma_f32_32x32x16_bf16 v[112:127], v[144:147], v[96:99], v[112:127]
v_exp_f32 v85, v85
v_cvt_pk_bf16_f32 v105, v82, v83
v_exp_f32 v86, v86
v_exp_f32 v87, v87
v_cvt_pk_bf16_f32 v106, v84, v85
v_exp_f32 v88, v88
v_mfma_f32_32x32x8_bf16 v[64:79], v[58:59], v[20:21], v[64:79]
v_exp_f32 v89, v89
v_cvt_pk_bf16_f32 v107, v86, v87
v_exp_f32 v90, v90
v_exp_f32 v91, v91
v_cvt_pk_bf16_f32 v108, v88, v89
v_exp_f32 v92, v92
v_mfma_f32_32x32x16_bf16 v[112:127], v[148:151], v[100:103], v[112:127]
v_exp_f32 v93, v93
v_cvt_pk_bf16_f32 v109, v90, v91
v_exp_f32 v94, v94
v_exp_f32 v95, v95
v_cvt_pk_bf16_f32 v110, v92, v93
v_cvt_pk_bf16_f32 v111, v94, v95
v_mfma_f32_32x32x16_bf16 v[80:95], v[54:57], v[22:25], 0
v_exp_f32 v64, v64
v_exp_f32 v65, v65
v_exp_f32 v66, v66
v_exp_f32 v67, v67
v_cvt_pk_bf16_f32 v96, v64, v65
v_exp_f32 v68, v68
v_mfma_f32_32x32x16_bf16 v[128:143], v[144:147], v[104:107], v[128:143]
v_exp_f32 v69, v69
v_cvt_pk_bf16_f32 v97, v66, v67
v_exp_f32 v70, v70
v_exp_f32 v71, v71
v_cvt_pk_bf16_f32 v98, v68, v69
v_exp_f32 v72, v72
v_mfma_f32_32x32x8_bf16 v[80:95], v[58:59], v[26:27], v[80:95]
v_exp_f32 v73, v73
v_cvt_pk_bf16_f32 v99, v70, v71
v_exp_f32 v74, v74
v_exp_f32 v75, v75
v_cvt_pk_bf16_f32 v100, v72, v73
v_exp_f32 v76, v76
v_mfma_f32_32x32x16_bf16 v[128:143], v[148:151], v[108:111], v[128:143]
v_exp_f32 v77, v77
v_cvt_pk_bf16_f32 v101, v74, v75
v_exp_f32 v78, v78
v_exp_f32 v79, v79
v_cvt_pk_bf16_f32 v102, v76, v77
v_cvt_pk_bf16_f32 v103, v78, v79
v_mfma_f32_32x32x16_bf16 v[64:79], v[236:239], v[16:19], 0
v_exp_f32 v80, v80
v_exp_f32 v81, v81
v_exp_f32 v82, v82
v_exp_f32 v83, v83
v_cvt_pk_bf16_f32 v104, v80, v81
v_exp_f32 v84, v84
v_mfma_f32_32x32x16_bf16 v[112:127], v[152:155], v[96:99], v[112:127]
v_exp_f32 v85, v85
v_cvt_pk_bf16_f32 v105, v82, v83
v_exp_f32 v86, v86
v_exp_f32 v87, v87
v_cvt_pk_bf16_f32 v106, v84, v85
v_exp_f32 v88, v88
v_mfma_f32_32x32x8_bf16 v[64:79], v[240:241], v[20:21], v[64:79]
v_exp_f32 v89, v89
v_cvt_pk_bf16_f32 v107, v86, v87
v_exp_f32 v90, v90
v_exp_f32 v91, v91
v_cvt_pk_bf16_f32 v108, v88, v89
v_exp_f32 v92, v92
v_mfma_f32_32x32x16_bf16 v[112:127], v[156:159], v[100:103], v[112:127]
v_exp_f32 v93, v93
v_cvt_pk_bf16_f32 v109, v90, v91
v_exp_f32 v94, v94
v_exp_f32 v95, v95
v_cvt_pk_bf16_f32 v110, v92, v93
v_cvt_pk_bf16_f32 v111, v94, v95
v_mfma_f32_32x32x16_bf16 v[80:95], v[236:239], v[22:25], 0
v_add_u32 v2, 40960, v2
v_add_u32 v3, 40960, v3
v_add_u32 v4, 40960, v4
ds_read_b128 v[242:245], v2 offset:20480
s_mov_b64 exec, s[76:77]
ds_read_b64 v[246:247], v3 offset:21504
ds_read_b64 v[252:253], v3 offset:22784
s_mov_b64 exec, s[66:67]
ds_read_b128 v[160:163], v4 offset:8960
ds_read_b128 v[164:167], v4 offset:9600
ds_read_b128 v[168:171], v4 offset:25600
ds_read_b128 v[172:175], v4 offset:26240
s_mov_b64 exec, -1
v_exp_f32 v64, v64
v_exp_f32 v65, v65
v_exp_f32 v66, v66
v_exp_f32 v67, v67
v_cvt_pk_bf16_f32 v96, v64, v65
v_exp_f32 v68, v68
v_mfma_f32_32x32x16_bf16 v[128:143], v[152:155], v[104:107], v[128:143]
ds_read_b128 v[248:251], v2 offset:21760
v_exp_f32 v69, v69
v_cvt_pk_bf16_f32 v97, v66, v67
v_exp_f32 v70, v70
v_exp_f32 v71, v71
v_cvt_pk_bf16_f32 v98, v68, v69
v_exp_f32 v72, v72
v_mfma_f32_32x32x8_bf16 v[80:95], v[240:241], v[26:27], v[80:95]
v_exp_f32 v73, v73
v_cvt_pk_bf16_f32 v99, v70, v71
v_exp_f32 v74, v74
v_exp_f32 v75, v75
v_cvt_pk_bf16_f32 v100, v72, v73
v_exp_f32 v76, v76
v_mfma_f32_32x32x16_bf16 v[128:143], v[156:159], v[108:111], v[128:143]
v_exp_f32 v77, v77
v_cvt_pk_bf16_f32 v101, v74, v75
v_exp_f32 v78, v78
v_exp_f32 v79, v79
v_cvt_pk_bf16_f32 v102, v76, v77
v_cvt_pk_bf16_f32 v103, v78, v79
s_waitcnt lgkmcnt(0)
v_mfma_f32_32x32x16_bf16 v[64:79], v[242:245], v[16:19], 0
v_exp_f32 v80, v80
v_exp_f32 v81, v81
v_exp_f32 v82, v82
v_exp_f32 v83, v83
v_cvt_pk_bf16_f32 v104, v80, v81
v_exp_f32 v84, v84
v_mfma_f32_32x32x16_bf16 v[112:127], v[160:163], v[96:99], v[112:127]
v_exp_f32 v85, v85
v_cvt_pk_bf16_f32 v105, v82, v83
v_exp_f32 v86, v86
v_exp_f32 v87, v87
v_cvt_pk_bf16_f32 v106, v84, v85
v_exp_f32 v88, v88
v_mfma_f32_32x32x8_bf16 v[64:79], v[246:247], v[20:21], v[64:79]
v_exp_f32 v89, v89
v_cvt_pk_bf16_f32 v107, v86, v87
v_exp_f32 v90, v90
v_exp_f32 v91, v91
v_cvt_pk_bf16_f32 v108, v88, v89
v_exp_f32 v92, v92
v_mfma_f32_32x32x16_bf16 v[112:127], v[164:167], v[100:103], v[112:127]
v_exp_f32 v93, v93
v_cvt_pk_bf16_f32 v109, v90, v91
v_exp_f32 v94, v94
v_exp_f32 v95, v95
v_cvt_pk_bf16_f32 v110, v92, v93
v_cvt_pk_bf16_f32 v111, v94, v95
s_cmp_eq_u32 s61, 0
s_cbranch_scc1 att_hk_50
att_hk_50r:
s_barrier
v_mfma_f32_32x32x16_bf16 v[80:95], v[242:245], v[22:25], 0
v_exp_f32 v64, v64
v_exp_f32 v65, v65
v_exp_f32 v66, v66
v_exp_f32 v67, v67
v_cvt_pk_bf16_f32 v96, v64, v65
v_exp_f32 v68, v68
v_mfma_f32_32x32x16_bf16 v[128:143], v[160:163], v[104:107], v[128:143]
v_exp_f32 v69, v69
v_cvt_pk_bf16_f32 v97, v66, v67
v_exp_f32 v70, v70
v_exp_f32 v71, v71
v_cvt_pk_bf16_f32 v98, v68, v69
v_exp_f32 v72, v72
v_mfma_f32_32x32x8_bf16 v[80:95], v[246:247], v[26:27], v[80:95]
v_exp_f32 v73, v73
v_cvt_pk_bf16_f32 v99, v70, v71
v_exp_f32 v74, v74
v_exp_f32 v75, v75
v_cvt_pk_bf16_f32 v100, v72, v73
v_exp_f32 v76, v76
v_mfma_f32_32x32x16_bf16 v[128:143], v[164:167], v[108:111], v[128:143]
v_exp_f32 v77, v77
v_cvt_pk_bf16_f32 v101, v74, v75
v_exp_f32 v78, v78
v_exp_f32 v79, v79
v_cvt_pk_bf16_f32 v102, v76, v77
v_cvt_pk_bf16_f32 v103, v78, v79
v_mfma_f32_32x32x16_bf16 v[64:79], v[248:251], v[16:19], 0
v_exp_f32 v80, v80
v_exp_f32 v81, v81
v_exp_f32 v82, v82
v_exp_f32 v83, v83
v_cvt_pk_bf16_f32 v104, v80, v81
v_exp_f32 v84, v84
v_mfma_f32_32x32x16_bf16 v[112:127], v[168:171], v[96:99], v[112:127]
v_exp_f32 v85, v85
v_cvt_pk_bf16_f32 v105, v82, v83
v_exp_f32 v86, v86
v_exp_f32 v87, v87
v_cvt_pk_bf16_f32 v106, v84, v85
v_exp_f32 v88, v88
v_mfma_f32_32x32x8_bf16 v[64:79], v[252:253], v[20:21], v[64:79]
v_exp_f32 v89, v89
v_cvt_pk_bf16_f32 v107, v86, v87
v_exp_f32 v90, v90
v_exp_f32 v91, v91
v_cvt_pk_bf16_f32 v108, v88, v89
v_exp_f32 v92, v92
v_mfma_f32_32x32x16_bf16 v[112:127], v[172:175], v[100:103], v[112:127]
v_exp_f32 v93, v93
v_cvt_pk_bf16_f32 v109, v90, v91
v_exp_f32 v94, v94
v_exp_f32 v95, v95
v_cvt_pk_bf16_f32 v110, v92, v93
v_cvt_pk_bf16_f32 v111, v94, v95
v_mfma_f32_32x32x16_bf16 v[80:95], v[248:251], v[22:25], 0
ds_read_b128 v[48:51], v2 offset:23040
s_mov_b64 exec, s[76:77]
ds_read_b64 v[52:53], v3 offset:24064
ds_read_b64 v[58:59], v3 offset:25344
s_mov_b64 exec, s[66:67]
ds_read_b128 v[40:43], v4 offset:26880
ds_read_b128 v[44:47], v4 offset:27520
ds_read_b128 v[144:147], v4 offset:28160
ds_read_b128 v[148:151], v4 offset:28800
s_mov_b64 exec, -1
v_exp_f32 v64, v64
v_exp_f32 v65, v65
v_exp_f32 v66, v66
v_exp_f32 v67, v67
v_cvt_pk_bf16_f32 v96, v64, v65
v_exp_f32 v68, v68
v_mfma_f32_32x32x16_bf16 v[128:143], v[168:171], v[104:107], v[128:143]
ds_read_b128 v[54:57], v2 offset:24320
v_exp_f32 v69, v69
v_cvt_pk_bf16_f32 v97, v66, v67
v_exp_f32 v70, v70
v_exp_f32 v71, v71
v_cvt_pk_bf16_f32 v98, v68, v69
v_exp_f32 v72, v72
v_mfma_f32_32x32x8_bf16 v[80:95], v[252:253], v[26:27], v[80:95]
v_exp_f32 v73, v73
v_cvt_pk_bf16_f32 v99, v70, v71
v_exp_f32 v74, v74
v_exp_f32 v75, v75
v_cvt_pk_bf16_f32 v100, v72, v73
v_exp_f32 v76, v76
v_mfma_f32_32x32x16_bf16 v[128:143], v[172:175], v[108:111], v[128:143]
v_exp_f32 v77, v77
v_cvt_pk_bf16_f32 v101, v74, v75
v_exp_f32 v78, v78
v_exp_f32 v79, v79
v_cvt_pk_bf16_f32 v102, v76, v77
v_cvt_pk_bf16_f32 v103, v78, v79
s_waitcnt lgkmcnt(0)
v_mfma_f32_32x32x16_bf16 v[64:79], v[48:51], v[16:19], 0
v_exp_f32 v80, v80
v_exp_f32 v81, v81
v_exp_f32 v82, v82
v_exp_f32 v83, v83
v_cvt_pk_bf16_f32 v104, v80, v81
v_exp_f32 v84, v84
v_mfma_f32_32x32x16_bf16 v[112:127], v[40:43], v[96:99], v[112:127]
v_exp_f32 v85, v85
v_cvt_pk_bf16_f32 v105, v82, v83
v_exp_f32 v86, v86
v_exp_f32 v87, v87
v_cvt_pk_bf16_f32 v106, v84, v85
v_exp_f32 v88, v88
v_mfma_f32_32x32x8_bf16 v[64:79], v[52:53], v[20:21], v[64:79]
v_exp_f32 v89, v89
v_cvt_pk_bf16_f32 v107, v86, v87
v_exp_f32 v90, v90
v_exp_f32 v91, v91
v_cvt_pk_bf16_f32 v108, v88, v89
v_exp_f32 v92, v92
v_mfma_f32_32x32x16_bf16 v[112:127], v[44:47], v[100:103], v[112:127]
v_exp_f32 v93, v93
v_cvt_pk_bf16_f32 v109, v90, v91
v_exp_f32 v94, v94
v_exp_f32 v95, v95
v_cvt_pk_bf16_f32 v110, v92, v93
v_cvt_pk_bf16_f32 v111, v94, v95
v_mfma_f32_32x32x16_bf16 v[80:95], v[48:51], v[22:25], 0
v_exp_f32 v64, v64
v_exp_f32 v65, v65
v_exp_f32 v66, v66
v_exp_f32 v67, v67
v_cvt_pk_bf16_f32 v96, v64, v65
v_exp_f32 v68, v68
v_mfma_f32_32x32x16_bf16 v[128:143], v[40:43], v[104:107], v[128:143]
v_exp_f32 v69, v69
v_cvt_pk_bf16_f32 v97, v66, v67
v_exp_f32 v70, v70
v_exp_f32 v71, v71
v_cvt_pk_bf16_f32 v98, v68, v69
v_exp_f32 v72, v72
v_mfma_f32_32x32x8_bf16 v[80:95], v[52:53], v[26:27], v[80:95]
v_exp_f32 v73, v73
v_cvt_pk_bf16_f32 v99, v70, v71
v_exp_f32 v74, v74
v_exp_f32 v75, v75
v_cvt_pk_bf16_f32 v100, v72, v73
v_exp_f32 v76, v76
v_mfma_f32_32x32x16_bf16 v[128:143], v[44:47], v[108:111], v[128:143]
v_exp_f32 v77, v77
v_cvt_pk_bf16_f32 v101, v74, v75
v_exp_f32 v78, v78
v_exp_f32 v79, v79
v_cvt_pk_bf16_f32 v102, v76, v77
v_cvt_pk_bf16_f32 v103, v78, v79
v_mfma_f32_32x32x16_bf16 v[64:79], v[54:57], v[16:19], 0
v_exp_f32 v80, v80
v_exp_f32 v81, v81
v_exp_f32 v82, v82
v_exp_f32 v83, v83
v_cvt_pk_bf16_f32 v104, v80, v81
v_exp_f32 v84, v84
v_mfma_f32_32x32x16_bf16 v[112:127], v[144:147], v[96:99], v[112:127]
v_exp_f32 v85, v85
v_cvt_pk_bf16_f32 v105, v82, v83
v_exp_f32 v86, v86
v_exp_f32 v87, v87
v_cvt_pk_bf16_f32 v106, v84, v85
v_exp_f32 v88, v88
v_mfma_f32_32x32x8_bf16 v[64:79], v[58:59], v[20:21], v[64:79]
v_exp_f32 v89, v89
v_cvt_pk_bf16_f32 v107, v86, v87
v_exp_f32 v90, v90
v_exp_f32 v91, v91
v_cvt_pk_bf16_f32 v108, v88, v89
v_exp_f32 v92, v92
v_mfma_f32_32x32x16_bf16 v[112:127], v[148:151], v[100:103], v[112:127]
v_exp_f32 v93, v93
v_cvt_pk_bf16_f32 v109, v90, v91
v_exp_f32 v94, v94
v_exp_f32 v95, v95
v_cvt_pk_bf16_f32 v110, v92, v93
v_cvt_pk_bf16_f32 v111, v94, v95
v_mfma_f32_32x32x16_bf16 v[80:95], v[54:57], v[22:25], 0
s_mov_b64 exec, s[66:67]
ds_read_b128 v[152:155], v4 offset:29440
ds_read_b128 v[156:159], v4 offset:30080
s_mov_b64 exec, -1
v_exp_f32 v64, v64
v_exp_f32 v65, v65
v_exp_f32 v66, v66
v_exp_f32 v67, v67
v_cvt_pk_bf16_f32 v96, v64, v65
v_exp_f32 v68, v68
v_mfma_f32_32x32x16_bf16 v[128:143], v[144:147], v[104:107], v[128:143]
v_exp_f32 v69, v69
v_cvt_pk_bf16_f32 v97, v66, v67
v_exp_f32 v70, v70
v_exp_f32 v71, v71
v_cvt_pk_bf16_f32 v98, v68, v69
v_exp_f32 v72, v72
v_mfma_f32_32x32x8_bf16 v[80:95], v[58:59], v[26:27], v[80:95]
v_exp_f32 v73, v73
v_cvt_pk_bf16_f32 v99, v70, v71
v_exp_f32 v74, v74
v_exp_f32 v75, v75
v_cvt_pk_bf16_f32 v100, v72, v73
v_exp_f32 v76, v76
v_mfma_f32_32x32x16_bf16 v[128:143], v[148:151], v[108:111], v[128:143]
v_exp_f32 v77, v77
v_cvt_pk_bf16_f32 v101, v74, v75
v_exp_f32 v78, v78
v_exp_f32 v79, v79
v_cvt_pk_bf16_f32 v102, v76, v77
v_cvt_pk_bf16_f32 v103, v78, v79
s_waitcnt lgkmcnt(0)
v_mfma_f32_32x32x16_bf16 v[112:127], v[152:155], v[96:99], v[112:127]
v_exp_f32 v80, v80
v_exp_f32 v81, v81
v_exp_f32 v82, v82
v_exp_f32 v83, v83
v_cvt_pk_bf16_f32 v104, v80, v81
v_exp_f32 v84, v84
v_mfma_f32_32x32x16_bf16 v[112:127], v[156:159], v[100:103], v[112:127]
ds_read_b32 v31, v177
ds_read_b64 v[196:197], v29 offset:3072
ds_read_b64 v[212:213], v29 offset:6656
ds_read_b128 v[184:187], v28 offset:0
ds_read_b128 v[188:191], v28 offset:1024
ds_read_b128 v[192:195], v28 offset:2048
ds_read_b128 v[200:203], v28 offset:3584
ds_read_b128 v[204:207], v28 offset:4608
ds_read_b128 v[208:211], v28 offset:5632
v_exp_f32 v85, v85
v_cvt_pk_bf16_f32 v105, v82, v83
v_exp_f32 v86, v86
v_exp_f32 v87, v87
v_cvt_pk_bf16_f32 v106, v84, v85
v_exp_f32 v88, v88
v_exp_f32 v89, v89
v_cvt_pk_bf16_f32 v107, v86, v87
v_exp_f32 v90, v90
v_exp_f32 v91, v91
v_mfma_f32_32x32x16_bf16 v[128:143], v[152:155], v[104:107], v[128:143]
v_cvt_pk_bf16_f32 v108, v88, v89
v_exp_f32 v92, v92
v_exp_f32 v93, v93
v_cvt_pk_bf16_f32 v109, v90, v91
v_exp_f32 v94, v94
v_exp_f32 v95, v95
v_cvt_pk_bf16_f32 v110, v92, v93
v_cvt_pk_bf16_f32 v111, v94, v95
s_nop 1
v_mfma_f32_32x32x16_bf16 v[128:143], v[156:159], v[108:111], v[128:143]
L_fast_tail:
s_cmp_eq_u32 s61, 0
s_cbranch_scc1 att_y_54
s_waitcnt lgkmcnt(0)
v_cmp_ne_u32 vcc, s8, v31
s_cbranch_vccnz att_x_55
att_x_55k:
v_max_f32 v66, v8, v197
v_sub_f32 v64, v8, v66
v_sub_f32 v65, v197, v66
v_max_f32 v70, v9, v213
v_sub_f32 v68, v9, v70
v_sub_f32 v69, v213, v70
v_exp_f32 v64, v64
v_exp_f32 v65, v65
v_exp_f32 v68, v68
v_exp_f32 v69, v69
v_mul_f32 v66, v64, v124
v_fmac_f32 v66, v65, v196
v_rcp_f32 v66, v66
s_nop 0
v_mul_f32 v64, v64, v66
v_mul_f32 v66, v65, v66
v_pk_mul_f32 v[112:113], v[112:113], v[64:65] op_sel_hi:[1,0]
v_pk_mul_f32 v[114:115], v[114:115], v[64:65] op_sel_hi:[1,0]
v_pk_mul_f32 v[116:117], v[116:117], v[64:65] op_sel_hi:[1,0]
v_pk_mul_f32 v[118:119], v[118:119], v[64:65] op_sel_hi:[1,0]
v_pk_mul_f32 v[120:121], v[120:121], v[64:65] op_sel_hi:[1,0]
v_pk_mul_f32 v[122:123], v[122:123], v[64:65] op_sel_hi:[1,0]
v_pk_fma_f32 v[112:113], v[184:185], v[66:67], v[112:113] op_sel_hi:[1,0,1]
v_pk_fma_f32 v[114:115], v[186:187], v[66:67], v[114:115] op_sel_hi:[1,0,1]
v_pk_fma_f32 v[116:117], v[188:189], v[66:67], v[116:117] op_sel_hi:[1,0,1]
v_pk_fma_f32 v[118:119], v[190:191], v[66:67], v[118:119] op_sel_hi:[1,0,1]
v_pk_fma_f32 v[120:121], v[192:193], v[66:67], v[120:121] op_sel_hi:[1,0,1]
v_pk_fma_f32 v[122:123], v[194:195], v[66:67], v[122:123] op_sel_hi:[1,0,1]
v_cvt_pk_bf16_f32 v72, v112, v113
v_cvt_pk_bf16_f32 v73, v114, v115
v_cvt_pk_bf16_f32 v74, v116, v117
v_cvt_pk_bf16_f32 v75, v118, v119
v_cvt_pk_bf16_f32 v76, v120, v121
v_cvt_pk_bf16_f32 v77, v122, v123
buffer_store_dwordx2 v[72:73], v30, s[36:39], s96 offen
buffer_store_dwordx2 v[74:75], v30, s[36:39], s96 offen offset:512
s_mov_b32 exec_hi, 0
buffer_store_dwordx2 v[76:77], v30, s[36:39], s96 offen offset:1024
s_mov_b32 exec_hi, -1
v_mul_f32 v70, v68, v140
v_fmac_f32 v70, v69, v212
v_rcp_f32 v70, v70
s_nop 0
v_mul_f32 v68, v68, v70
v_mul_f32 v70, v69, v70
v_pk_mul_f32 v[128:129], v[128:129], v[68:69] op_sel_hi:[1,0]
v_pk_mul_f32 v[130:131], v[130:131], v[68:69] op_sel_hi:[1,0]
v_pk_mul_f32 v[132:133], v[132:133], v[68:69] op_sel_hi:[1,0]
v_pk_mul_f32 v[134:135], v[134:135], v[68:69] op_sel_hi:[1,0]
v_pk_mul_f32 v[136:137], v[136:137], v[68:69] op_sel_hi:[1,0]
v_pk_mul_f32 v[138:139], v[138:139], v[68:69] op_sel_hi:[1,0]
v_pk_fma_f32 v[128:129], v[200:201], v[70:71], v[128:129] op_sel_hi:[1,0,1]
v_pk_fma_f32 v[130:131], v[202:203], v[70:71], v[130:131] op_sel_hi:[1,0,1]
v_pk_fma_f32 v[132:133], v[204:205], v[70:71], v[132:133] op_sel_hi:[1,0,1]
v_pk_fma_f32 v[134:135], v[206:207], v[70:71], v[134:135] op_sel_hi:[1,0,1]
v_pk_fma_f32 v[136:137], v[208:209], v[70:71], v[136:137] op_sel_hi:[1,0,1]
v_pk_fma_f32 v[138:139], v[210:211], v[70:71], v[138:139] op_sel_hi:[1,0,1]
v_cvt_pk_bf16_f32 v78, v128, v129
v_cvt_pk_bf16_f32 v79, v130, v131
v_cvt_pk_bf16_f32 v80, v132, v133
v_cvt_pk_bf16_f32 v81, v134, v135
v_cvt_pk_bf16_f32 v82, v136, v137
v_cvt_pk_bf16_f32 v83, v138, v139
buffer_store_dwordx2 v[78:79], v30, s[36:39], s97 offen
buffer_store_dwordx2 v[80:81], v30, s[36:39], s97 offen offset:512
s_mov_b32 exec_hi, 0
buffer_store_dwordx2 v[82:83], v30, s[36:39], s97 offen offset:1024
s_mov_b32 exec_hi, -1
s_cmp_lg_u32 s99, 0
s_cbranch_scc1 att_nc_56
v_add_f32 v10, v124, v196
v_add_f32 v11, v140, v212
v_mul_f32 v10, 0x5f000000, v10
v_mul_f32 v11, 0x5f000000, v11
v_add_f32 v10, v10, v10
v_add_f32 v11, v11, v11
v_mul_f32 v10, 0, v10
v_mul_f32 v11, 0, v11
v_fmac_f32 v10, 0, v112
v_fmac_f32 v11, 0, v128
v_fmac_f32 v10, 0, v113
v_fmac_f32 v11, 0, v129
v_fmac_f32 v10, 0, v114
v_fmac_f32 v11, 0, v130
v_fmac_f32 v10, 0, v115
v_fmac_f32 v11, 0, v131
v_fmac_f32 v10, 0, v116
v_fmac_f32 v11, 0, v132
v_fmac_f32 v10, 0, v117
v_fmac_f32 v11, 0, v133
v_fmac_f32 v10, 0, v118
v_fmac_f32 v11, 0, v134
v_fmac_f32 v10, 0, v119
v_fmac_f32 v11, 0, v135
v_fmac_f32 v10, 0, v120
v_fmac_f32 v11, 0, v136
v_fmac_f32 v10, 0, v121
v_fmac_f32 v11, 0, v137
v_fmac_f32 v10, 0, v122
v_fmac_f32 v11, 0, v138
v_fmac_f32 v10, 0, v123
v_fmac_f32 v11, 0, v139
v_cmp_u_f32 vcc, v10, v11
s_cbranch_vccnz att_fb_51
att_nc_56:
s_lshl_b32 s80, s13, 3
s_add_u32 s80, s80, s6
s_lshl_b32 s80, s80, 2
s_add_u32 s80, s80, 51798016
s_add_u32 s81, s8, 2
v_mov_b32 v1, 0
v_mov_b32 v2, s81
s_setprio 0
s_waitcnt vmcnt(0)
s_mov_b64 exec, 1
buffer_store_dword v2, v1, s[36:39], s80 offen
s_mov_b64 exec, -1
s_barrier
s_branch L_fast_ld
att_hk_43:
s_barrier
s_cmp_eq_u32 s75, 0
s_cbranch_scc1 h0_57
s_and_b32 s82, s92, 0x2020202
s_cbranch_scc0 gt_58k
s_mov_b32 s82, s9
gt_58:
buffer_load_dword v180, v12, s[36:39], s94 offen sc1
s_waitcnt vmcnt(0)
v_subrev_u32 v180, s95, v180
v_cmp_lt_u32 s[92:93], 15, v180
s_or_b32 s92, s92, s93
s_and_b32 s83, s92, 0x2020202
s_cbranch_scc0 gt_58k
s_sleep 2
s_add_u32 s82, s82, 1
s_cmp_lt_u32 s82, 200000
s_cbranch_scc1 gt_58
s_mov_b32 s9, 200000
gt_58k:
s_add_u32 s64, s4, 1
s_and_b32 s64, s64, 7
s_mul_i32 s64, s64, 10240
s_add_u32 s64, s64, s62
s_add_u32 m0, s63, 20480
s_add_u32 s79, s64, 0
buffer_load_dwordx4 v5, s[36:39], s79 offen offset:0 sc1 lds
buffer_load_dwordx4 v5, s[36:39], s79 offen offset:1024 sc1 lds
buffer_load_dwordx4 v5, s[36:39], s79 offen offset:2048 sc1 lds
buffer_load_dwordx4 v5, s[36:39], s79 offen offset:3072 sc1 lds
s_add_u32 m0, s63, 24576
s_add_u32 s79, s64, 4096
buffer_load_dwordx4 v5, s[36:39], s79 offen offset:0 sc1 lds
h0_57:
s_branch att_hk_43r
att_hk_44:
s_and_b32 s82, s92, 0x4040404
s_cbranch_scc0 gt_59k
s_mov_b32 s82, s9
gt_59:
buffer_load_dword v180, v12, s[36:39], s94 offen sc1
s_waitcnt vmcnt(0)
v_subrev_u32 v180, s95, v180
v_cmp_lt_u32 s[92:93], 15, v180
s_or_b32 s92, s92, s93
s_and_b32 s83, s92, 0x4040404
s_cbranch_scc0 gt_59k
s_sleep 2
s_add_u32 s82, s82, 1
s_cmp_lt_u32 s82, 200000
s_cbranch_scc1 gt_59
s_mov_b32 s9, 200000
gt_59k:
s_add_u32 s64, s4, 2
s_and_b32 s64, s64, 7
s_mul_i32 s64, s64, 10240
s_add_u32 s64, s64, s62
s_add_u32 m0, s63, 40960
s_add_u32 s79, s64, 0
buffer_load_dwordx4 v5, s[36:39], s79 offen offset:0 sc1 lds
buffer_load_dwordx4 v5, s[36:39], s79 offen offset:1024 sc1 lds
buffer_load_dwordx4 v5, s[36:39], s79 offen offset:2048 sc1 lds
buffer_load_dwordx4 v5, s[36:39], s79 offen offset:3072 sc1 lds
s_add_u32 m0, s63, 45056
s_add_u32 s79, s64, 4096
buffer_load_dwordx4 v5, s[36:39], s79 offen offset:0 sc1 lds
s_and_b32 s82, s92, 0x8080808
s_cbranch_scc0 gt_60k
s_mov_b32 s82, s9
gt_60:
buffer_load_dword v180, v12, s[36:39], s94 offen sc1
s_waitcnt vmcnt(0)
v_subrev_u32 v180, s95, v180
v_cmp_lt_u32 s[92:93], 15, v180
s_or_b32 s92, s92, s93
s_and_b32 s83, s92, 0x8080808
s_cbranch_scc0 gt_60k
s_sleep 2
s_add_u32 s82, s82, 1
s_cmp_lt_u32 s82, 200000
s_cbranch_scc1 gt_60
s_mov_b32 s9, 200000
gt_60k:
s_add_u32 s64, s4, 3
s_and_b32 s64, s64, 7
s_mul_i32 s64, s64, 10240
s_add_u32 s64, s64, s62
s_add_u32 m0, s63, 61440
s_add_u32 s79, s64, 0
buffer_load_dwordx4 v5, s[36:39], s79 offen offset:0 sc1 lds
buffer_load_dwordx4 v5, s[36:39], s79 offen offset:1024 sc1 lds
buffer_load_dwordx4 v5, s[36:39], s79 offen offset:2048 sc1 lds
buffer_load_dwordx4 v5, s[36:39], s79 offen offset:3072 sc1 lds
s_add_u32 m0, s63, 65536
s_add_u32 s79, s64, 4096
buffer_load_dwordx4 v5, s[36:39], s79 offen offset:0 sc1 lds
s_waitcnt vmcnt(10)
s_branch att_hk_44r
att_hk_45:
s_cmp_lg_u32 s3, 0
s_cbranch_scc1 l0_61
s_waitcnt vmcnt(0)
s_sub_u32 s85, s6, 1
s_lshl_b32 s84, s85, 8
s_add_u32 s84, s84, s13
s_add_u32 s84, s84, 160
s_mul_i32 s85, s85, 5120
s_add_u32 s85, s85, 147456
s_cmp_eq_u32 s6, 0
s_cbranch_scc1 pg_62
s_cmp_eq_u32 s6, 3
s_cbranch_scc1 pg_62
s_cmp_ge_u32 s84, 544
s_cbranch_scc1 pe_63
s_and_b32 s86, s84, 7
s_lshr_b32 s87, s84, 3
s_cmp_lt_u32 s87, 20
s_cselect_b32 s56, s20, s28
s_cselect_b32 s57, s21, s29
s_mov_b32 s58, 1966080
s_cselect_b32 s58, 819200, s58
s_mov_b32 s59, 0x20000
s_cselect_b32 s88, 0, 20
s_cselect_b32 s89, 20, 48
s_mov_b32 s90, 45449216
s_cselect_b32 s90, 44630016, s90
s_sub_u32 s87, s87, s88
s_mul_i32 s89, s89, s86
s_add_u32 s89, s89, s87
s_mul_i32 s89, s89, 5120
s_add_u32 s90, s90, s89
s_mul_i32 s87, s87, 40960
s_mul_i32 s86, s86, 160
s_add_u32 s87, s87, s86
s_movk_i32 s88, 6554
v_add_u32 v180, 0, v0
v_mul_u32_u24 v181, s88, v180
v_lshrrev_b32 v181, 16, v181
v_mad_i32_i24 v180, v181, -10, v180
v_mul_u32_u24 v181, 1280, v181
v_lshl_add_u32 v180, v180, 4, v181
s_add_u32 m0, s85, 0
s_nop 0
buffer_load_dwordx4 v180, s[56:59], s87 offen lds
v_add_u32 v180, 64, v0
v_mul_u32_u24 v181, s88, v180
v_lshrrev_b32 v181, 16, v181
v_mad_i32_i24 v180, v181, -10, v180
v_mul_u32_u24 v181, 1280, v181
v_lshl_add_u32 v180, v180, 4, v181
s_add_u32 m0, s85, 1024
s_nop 0
buffer_load_dwordx4 v180, s[56:59], s87 offen lds
v_add_u32 v180, 128, v0
v_mul_u32_u24 v181, s88, v180
v_lshrrev_b32 v181, 16, v181
v_mad_i32_i24 v180, v181, -10, v180
v_mul_u32_u24 v181, 1280, v181
v_lshl_add_u32 v180, v180, 4, v181
s_add_u32 m0, s85, 2048
s_nop 0
buffer_load_dwordx4 v180, s[56:59], s87 offen lds
v_add_u32 v180, 192, v0
v_mul_u32_u24 v181, s88, v180
v_lshrrev_b32 v181, 16, v181
v_mad_i32_i24 v180, v181, -10, v180
v_mul_u32_u24 v181, 1280, v181
v_lshl_add_u32 v180, v180, 4, v181
s_add_u32 m0, s85, 3072
s_nop 0
buffer_load_dwordx4 v180, s[56:59], s87 offen lds
v_add_u32 v180, 256, v0
v_mul_u32_u24 v181, s88, v180
v_lshrrev_b32 v181, 16, v181
v_mad_i32_i24 v180, v181, -10, v180
v_mul_u32_u24 v181, 1280, v181
v_lshl_add_u32 v180, v180, 4, v181
s_add_u32 m0, s85, 4096
s_nop 0
buffer_load_dwordx4 v180, s[56:59], s87 offen lds
s_branch pe_63
pg_62:
s_cmp_ge_u32 s13, 240
s_cbranch_scc1 pe_63
s_mul_i32 s86, s13, 2731
s_lshr_b32 s86, s86, 16
s_mul_i32 s87, s86, 24
s_sub_u32 s87, s13, s87
s_mul_i32 s88, s86, 196608
s_lshl_b32 s89, s87, 7
s_add_u32 s88, s88, s89
v_lshrrev_b32 v180, 3, v0
v_mul_u32_u24 v180, 3072, v180
v_and_b32 v181, 7, v0
v_lshl_add_u32 v180, v181, 4, v180
s_and_b32 s85, s6, 1
s_cselect_b32 s56, s26, s24
s_cselect_b32 s57, s27, s25
s_mov_b32 s58, 1966080
s_mov_b32 s59, 0x20000
s_lshl_b32 s90, s85, 13
s_add_u32 m0, s90, 131072
s_add_u32 s89, s88, 0
buffer_load_dwordx4 v180, s[56:59], s89 offen lds
s_add_u32 m0, s90, 132096
s_add_u32 s89, s88, 24576
buffer_load_dwordx4 v180, s[56:59], s89 offen lds
s_add_u32 m0, s90, 133120
s_add_u32 s89, s88, 49152
buffer_load_dwordx4 v180, s[56:59], s89 offen lds
s_add_u32 m0, s90, 134144
s_add_u32 s89, s88, 73728
buffer_load_dwordx4 v180, s[56:59], s89 offen lds
s_add_u32 m0, s90, 135168
s_add_u32 s89, s88, 98304
buffer_load_dwordx4 v180, s[56:59], s89 offen lds
s_add_u32 m0, s90, 136192
s_add_u32 s89, s88, 122880
buffer_load_dwordx4 v180, s[56:59], s89 offen lds
s_add_u32 m0, s90, 137216
s_add_u32 s89, s88, 147456
buffer_load_dwordx4 v180, s[56:59], s89 offen lds
s_add_u32 m0, s90, 138240
s_add_u32 s89, s88, 172032
buffer_load_dwordx4 v180, s[56:59], s89 offen lds
pe_63:
l0_61:
s_cmp_eq_u32 s3, 0
s_cbranch_scc1 l1_64
s_waitcnt vmcnt(5)
s_and_b32 s82, s92, 0x10101010
s_cbranch_scc0 gt_65k
s_mov_b32 s82, s9
gt_65:
buffer_load_dword v180, v12, s[36:39], s94 offen sc1
s_waitcnt vmcnt(0)
v_subrev_u32 v180, s95, v180
v_cmp_lt_u32 s[92:93], 15, v180
s_or_b32 s92, s92, s93
s_and_b32 s83, s92, 0x10101010
s_cbranch_scc0 gt_65k
s_sleep 2
s_add_u32 s82, s82, 1
s_cmp_lt_u32 s82, 200000
s_cbranch_scc1 gt_65
s_mov_b32 s9, 200000
gt_65k:
s_add_u32 s64, s4, 4
s_and_b32 s64, s64, 7
s_mul_i32 s64, s64, 10240
s_add_u32 s64, s64, s62
s_add_u32 m0, s63, 81920
s_add_u32 s79, s64, 0
buffer_load_dwordx4 v5, s[36:39], s79 offen offset:0 sc1 lds
buffer_load_dwordx4 v5, s[36:39], s79 offen offset:1024 sc1 lds
buffer_load_dwordx4 v5, s[36:39], s79 offen offset:2048 sc1 lds
buffer_load_dwordx4 v5, s[36:39], s79 offen offset:3072 sc1 lds
s_add_u32 m0, s63, 86016
s_add_u32 s79, s64, 4096
buffer_load_dwordx4 v5, s[36:39], s79 offen offset:0 sc1 lds
l1_64:
s_branch att_hk_45r
att_hk_46:
s_cmp_lg_u32 s3, 0
s_cbranch_scc1 l0_66
s_and_b32 s82, s92, 0x10101010
s_cbranch_scc0 gt_67k
s_mov_b32 s82, s9
gt_67:
buffer_load_dword v180, v12, s[36:39], s94 offen sc1
s_waitcnt vmcnt(0)
v_subrev_u32 v180, s95, v180
v_cmp_lt_u32 s[92:93], 15, v180
s_or_b32 s92, s92, s93
s_and_b32 s83, s92, 0x10101010
s_cbranch_scc0 gt_67k
s_sleep 2
s_add_u32 s82, s82, 1
s_cmp_lt_u32 s82, 200000
s_cbranch_scc1 gt_67
s_mov_b32 s9, 200000
gt_67k:
s_add_u32 s64, s4, 4
s_and_b32 s64, s64, 7
s_mul_i32 s64, s64, 10240
s_add_u32 s64, s64, s62
s_add_u32 m0, s63, 81920
s_add_u32 s79, s64, 0
buffer_load_dwordx4 v5, s[36:39], s79 offen offset:0 sc1 lds
buffer_load_dwordx4 v5, s[36:39], s79 offen offset:1024 sc1 lds
buffer_load_dwordx4 v5, s[36:39], s79 offen offset:2048 sc1 lds
buffer_load_dwordx4 v5, s[36:39], s79 offen offset:3072 sc1 lds
s_add_u32 m0, s63, 86016
s_add_u32 s79, s64, 4096
buffer_load_dwordx4 v5, s[36:39], s79 offen offset:0 sc1 lds
s_and_b32 s82, s92, 0x20202020
s_cbranch_scc0 gt_68k
s_mov_b32 s82, s9
gt_68:
buffer_load_dword v180, v12, s[36:39], s94 offen sc1
s_waitcnt vmcnt(0)
v_subrev_u32 v180, s95, v180
v_cmp_lt_u32 s[92:93], 15, v180
s_or_b32 s92, s92, s93
s_and_b32 s83, s92, 0x20202020
s_cbranch_scc0 gt_68k
s_sleep 2
s_add_u32 s82, s82, 1
s_cmp_lt_u32 s82, 200000
s_cbranch_scc1 gt_68
s_mov_b32 s9, 200000
gt_68k:
s_add_u32 s64, s4, 5
s_and_b32 s64, s64, 7
s_mul_i32 s64, s64, 10240
s_add_u32 s64, s64, s62
s_add_u32 m0, s63, 102400
s_add_u32 s79, s64, 0
buffer_load_dwordx4 v5, s[36:39], s79 offen offset:0 sc1 lds
buffer_load_dwordx4 v5, s[36:39], s79 offen offset:1024 sc1 lds
buffer_load_dwordx4 v5, s[36:39], s79 offen offset:2048 sc1 lds
buffer_load_dwordx4 v5, s[36:39], s79 offen offset:3072 sc1 lds
s_add_u32 m0, s63, 106496
s_add_u32 s79, s64, 4096
buffer_load_dwordx4 v5, s[36:39], s79 offen offset:0 sc1 lds
l0_66:
s_cmp_eq_u32 s3, 0
s_cbranch_scc1 l1_69
s_waitcnt vmcnt(5)
s_and_b32 s82, s92, 0x20202020
s_cbranch_scc0 gt_70k
s_mov_b32 s82, s9
gt_70:
buffer_load_dword v180, v12, s[36:39], s94 offen sc1
s_waitcnt vmcnt(0)
v_subrev_u32 v180, s95, v180
v_cmp_lt_u32 s[92:93], 15, v180
s_or_b32 s92, s92, s93
s_and_b32 s83, s92, 0x20202020
s_cbranch_scc0 gt_70k
s_sleep 2
s_add_u32 s82, s82, 1
s_cmp_lt_u32 s82, 200000
s_cbranch_scc1 gt_70
s_mov_b32 s9, 200000
gt_70k:
s_add_u32 s64, s4, 5
s_and_b32 s64, s64, 7
s_mul_i32 s64, s64, 10240
s_add_u32 s64, s64, s62
s_add_u32 m0, s63, 102400
s_add_u32 s79, s64, 0
buffer_load_dwordx4 v5, s[36:39], s79 offen offset:0 sc1 lds
buffer_load_dwordx4 v5, s[36:39], s79 offen offset:1024 sc1 lds
buffer_load_dwordx4 v5, s[36:39], s79 offen offset:2048 sc1 lds
buffer_load_dwordx4 v5, s[36:39], s79 offen offset:3072 sc1 lds
s_add_u32 m0, s63, 106496
s_add_u32 s79, s64, 4096
buffer_load_dwordx4 v5, s[36:39], s79 offen offset:0 sc1 lds
s_and_b32 s82, s92, 0x40404040
s_cbranch_scc0 gt_71k
s_mov_b32 s82, s9
gt_71:
buffer_load_dword v180, v12, s[36:39], s94 offen sc1
s_waitcnt vmcnt(0)
v_subrev_u32 v180, s95, v180
v_cmp_lt_u32 s[92:93], 15, v180
s_or_b32 s92, s92, s93
s_and_b32 s83, s92, 0x40404040
s_cbranch_scc0 gt_71k
s_sleep 2
s_add_u32 s82, s82, 1
s_cmp_lt_u32 s82, 200000
s_cbranch_scc1 gt_71
s_mov_b32 s9, 200000
gt_71k:
s_add_u32 s64, s4, 6
s_and_b32 s64, s64, 7
s_mul_i32 s64, s64, 10240
s_add_u32 s64, s64, s62
s_add_u32 m0, s63, 122880
s_add_u32 s79, s64, 0
buffer_load_dwordx4 v5, s[36:39], s79 offen offset:0 sc1 lds
buffer_load_dwordx4 v5, s[36:39], s79 offen offset:1024 sc1 lds
buffer_load_dwordx4 v5, s[36:39], s79 offen offset:2048 sc1 lds
buffer_load_dwordx4 v5, s[36:39], s79 offen offset:3072 sc1 lds
s_add_u32 m0, s63, 126976
s_add_u32 s79, s64, 4096
buffer_load_dwordx4 v5, s[36:39], s79 offen offset:0 sc1 lds
l1_69:
s_branch att_hk_46r
att_hk_47:
s_cmp_lg_u32 s3, 0
s_cbranch_scc1 l0_72
s_waitcnt vmcnt(5)
s_cmp_eq_u32 s6, 0
s_cbranch_scc1 pg_73
s_cmp_eq_u32 s6, 3
s_cbranch_scc1 pg_73
s_cmp_ge_u32 s84, 544
s_cbranch_scc1 pe_74
v_lshrrev_b32 v180, 4, v0
v_bfe_u32 v181, v0, 2, 2
v_lshl_add_u32 v180, v180, 3, v181
v_mul_u32_u24 v180, 160, v180
v_add_u32 v180, s85, v180
v_and_b32 v181, 3, v0
v_lshl_add_u32 v182, v181, 3, v180
v_lshl_add_u32 v181, v181, 4, v180
ds_read_b64_tr_b16 v[184:185], v181 offset:0
ds_read_b64_tr_b16 v[186:187], v181 offset:640
ds_read_b64_tr_b16 v[188:189], v181 offset:8
ds_read_b64_tr_b16 v[190:191], v181 offset:648
ds_read_b64_tr_b16 v[192:193], v181 offset:64
ds_read_b64_tr_b16 v[194:195], v181 offset:704
ds_read_b64_tr_b16 v[196:197], v181 offset:72
ds_read_b64_tr_b16 v[198:199], v181 offset:712
ds_read_b64_tr_b16 v[200:201], v182 offset:128
ds_read_b64_tr_b16 v[202:203], v182 offset:768
s_add_u32 s89, s90, 4096
s_waitcnt lgkmcnt(0)
buffer_store_dwordx4 v[184:187], v5, s[36:39], s90 offen offset:0 sc1
buffer_store_dwordx4 v[188:191], v5, s[36:39], s90 offen offset:1024 sc1
buffer_store_dwordx4 v[192:195], v5, s[36:39], s90 offen offset:2048 sc1
buffer_store_dwordx4 v[196:199], v5, s[36:39], s90 offen offset:3072 sc1
buffer_store_dwordx4 v[200:203], v5, s[36:39], s89 offen offset:0 sc1
s_branch pe_74
pg_73:
s_cmp_ge_u32 s13, 240
s_cbranch_scc1 pe_74
v_lshrrev_b32 v182, 4, v0
v_bfe_u32 v180, v0, 2, 2
v_lshl_add_u32 v180, v182, 3, v180
v_lshlrev_b32 v180, 7, v180
v_and_b32 v181, 3, v0
v_lshl_add_u32 v180, v181, 3, v180
s_add_u32 s90, s90, 131072
v_add_u32 v180, s90, v180
v_lshlrev_b32 v182, 4, v182
ds_read_b64_tr_b16 v[188:189], v180 offset:0
ds_read_b64_tr_b16 v[190:191], v180 offset:512
ds_read_b64_tr_b16 v[192:193], v180 offset:4096
ds_read_b64_tr_b16 v[194:195], v180 offset:4608
ds_read_b64_tr_b16 v[196:197], v180 offset:32
ds_read_b64_tr_b16 v[198:199], v180 offset:544
ds_read_b64_tr_b16 v[200:201], v180 offset:4128
ds_read_b64_tr_b16 v[202:203], v180 offset:4640
ds_read_b64_tr_b16 v[204:205], v180 offset:64
ds_read_b64_tr_b16 v[206:207], v180 offset:576
ds_read_b64_tr_b16 v[208:209], v180 offset:4160
ds_read_b64_tr_b16 v[210:211], v180 offset:4672
ds_read_b64_tr_b16 v[212:213], v180 offset:96
ds_read_b64_tr_b16 v[214:215], v180 offset:608
ds_read_b64_tr_b16 v[216:217], v180 offset:4192
ds_read_b64_tr_b16 v[218:219], v180 offset:4704
s_mul_i32 s90, s86, 12288
s_lshl_b32 s89, s87, 9
s_add_u32 s90, s90, s89
s_lshl_b32 s89, s85, 6
s_add_u32 s90, s90, s89
s_add_u32 s90, s90, 51347456
v_mov_b32 v184, 0x3f803f80
v_mov_b32 v185, 0x3f803f80
v_mov_b32 v186, 0x3f803f80
v_mov_b32 v187, 0x3f803f80
s_nop 0
s_waitcnt lgkmcnt(0)
v_mfma_f32_16x16x32_bf16 v[220:223], v[188:191], v[184:187], 0
v_mfma_f32_16x16x32_bf16 v[224:227], v[196:199], v[184:187], 0
v_mfma_f32_16x16x32_bf16 v[228:231], v[204:207], v[184:187], 0
v_mfma_f32_16x16x32_bf16 v[232:235], v[212:215], v[184:187], 0
v_mfma_f32_16x16x32_bf16 v[220:223], v[192:195], v[184:187], v[220:223]
v_mfma_f32_16x16x32_bf16 v[224:227], v[200:203], v[184:187], v[224:227]
v_mfma_f32_16x16x32_bf16 v[228:231], v[208:211], v[184:187], v[228:231]
v_mfma_f32_16x16x32_bf16 v[232:235], v[216:219], v[184:187], v[232:235]
s_lshl_b32 s88, s87, 2
s_add_u32 s88, s88, 0
s_mul_i32 s89, s88, 43
s_lshr_b32 s89, s89, 8
s_mul_i32 s89, s89, 228
s_lshl_b32 s88, s88, 1
s_add_u32 s88, s88, s89
s_mul_i32 s89, s86, 24
s_add_u32 s88, s88, s89
s_add_u32 s88, s88, s85
s_lshl_b32 s88, s88, 10
s_add_u32 s88, s88, 47415296
s_add_u32 s89, s88, 12288
buffer_store_dwordx4 v[188:191], v5, s[36:39], s88 offen sc1
buffer_store_dwordx4 v[192:195], v5, s[36:39], s89 offen sc1
s_lshl_b32 s88, s87, 2
s_add_u32 s88, s88, 1
s_mul_i32 s89, s88, 43
s_lshr_b32 s89, s89, 8
s_mul_i32 s89, s89, 228
s_lshl_b32 s88, s88, 1
s_add_u32 s88, s88, s89
s_mul_i32 s89, s86, 24
s_add_u32 s88, s88, s89
s_add_u32 s88, s88, s85
s_lshl_b32 s88, s88, 10
s_add_u32 s88, s88, 47415296
s_add_u32 s89, s88, 12288
buffer_store_dwordx4 v[196:199], v5, s[36:39], s88 offen sc1
buffer_store_dwordx4 v[200:203], v5, s[36:39], s89 offen sc1
s_lshl_b32 s88, s87, 2
s_add_u32 s88, s88, 2
s_mul_i32 s89, s88, 43
s_lshr_b32 s89, s89, 8
s_mul_i32 s89, s89, 228
s_lshl_b32 s88, s88, 1
s_add_u32 s88, s88, s89
s_mul_i32 s89, s86, 24
s_add_u32 s88, s88, s89
s_add_u32 s88, s88, s85
s_lshl_b32 s88, s88, 10
s_add_u32 s88, s88, 47415296
s_add_u32 s89, s88, 12288
buffer_store_dwordx4 v[204:207], v5, s[36:39], s88 offen sc1
buffer_store_dwordx4 v[208:211], v5, s[36:39], s89 offen sc1
s_lshl_b32 s88, s87, 2
s_add_u32 s88, s88, 3
s_mul_i32 s89, s88, 43
s_lshr_b32 s89, s89, 8
s_mul_i32 s89, s89, 228
s_lshl_b32 s88, s88, 1
s_add_u32 s88, s88, s89
s_mul_i32 s89, s86, 24
s_add_u32 s88, s88, s89
s_add_u32 s88, s88, s85
s_lshl_b32 s88, s88, 10
s_add_u32 s88, s88, 47415296
s_add_u32 s89, s88, 12288
buffer_store_dwordx4 v[212:215], v5, s[36:39], s88 offen sc1
buffer_store_dwordx4 v[216:219], v5, s[36:39], s89 offen sc1
s_mov_b32 exec_lo, 0x10001
s_mov_b32 exec_hi, 0x10001
buffer_store_dwordx4 v[220:223], v182, s[36:39], s90 offen offset:0 sc1
buffer_store_dwordx4 v[224:227], v182, s[36:39], s90 offen offset:128 sc1
buffer_store_dwordx4 v[228:231], v182, s[36:39], s90 offen offset:256 sc1
buffer_store_dwordx4 v[232:235], v182, s[36:39], s90 offen offset:384 sc1
s_mov_b64 exec, -1
pe_74:
l0_72:
s_cmp_eq_u32 s3, 0
s_cbranch_scc1 l1_75
s_waitcnt vmcnt(10)
s_and_b32 s82, s92, 0x80808080
s_cbranch_scc0 gt_76k
s_mov_b32 s82, s9
gt_76:
buffer_load_dword v180, v12, s[36:39], s94 offen sc1
s_waitcnt vmcnt(0)
v_subrev_u32 v180, s95, v180
v_cmp_lt_u32 s[92:93], 15, v180
s_or_b32 s92, s92, s93
s_and_b32 s83, s92, 0x80808080
s_cbranch_scc0 gt_76k
s_sleep 2
s_add_u32 s82, s82, 1
s_cmp_lt_u32 s82, 200000
s_cbranch_scc1 gt_76
s_mov_b32 s9, 200000
gt_76k:
s_add_u32 s64, s4, 7
s_and_b32 s64, s64, 7
s_mul_i32 s64, s64, 10240
s_add_u32 s64, s64, s62
s_add_u32 m0, s63, 143360
s_add_u32 s79, s64, 0
buffer_load_dwordx4 v5, s[36:39], s79 offen offset:0 sc1 lds
buffer_load_dwordx4 v5, s[36:39], s79 offen offset:1024 sc1 lds
buffer_load_dwordx4 v5, s[36:39], s79 offen offset:2048 sc1 lds
buffer_load_dwordx4 v5, s[36:39], s79 offen offset:3072 sc1 lds
s_add_u32 m0, s63, 147456
s_add_u32 s79, s64, 4096
buffer_load_dwordx4 v5, s[36:39], s79 offen offset:0 sc1 lds
l1_75:
s_branch att_hk_47r
att_hk_48:
s_cmp_lg_u32 s3, 0
s_cbranch_scc1 l0_77
v_and_b32 v181, 15, v0
v_lshlrev_b32 v181, 11, v181
s_mov_b32 s65, 22284196
s_mov_b32 s82, s9
poll_78:
buffer_load_dword v180, v181, s[36:39], s65 offen sc1
s_waitcnt vmcnt(0)
v_subrev_u32 v180, s8, v180
v_cmp_lt_u32 vcc, 15, v180
s_cbranch_vccz pollok_79
s_sleep 2
s_add_u32 s82, s82, 1
s_cmp_lt_u32 s82, 200000
s_cbranch_scc1 poll_78
s_mov_b32 s9, 200000
pollok_79:
s_lshl_b32 s65, s13, 5
s_add_u32 s65, s65, s6
s_lshl_b32 s65, s65, 2
s_add_u32 s65, s65, 22282256
v_mov_b32 v10, 0
v_mov_b32 v11, s8
s_mov_b64 exec, 1
buffer_store_dword v11, v10, s[36:39], s65 offen sc1
s_mov_b64 exec, -1
s_and_b32 s82, s92, 0x40404040
s_cbranch_scc0 gt_80k
s_mov_b32 s82, s9
gt_80:
buffer_load_dword v180, v12, s[36:39], s94 offen sc1
s_waitcnt vmcnt(0)
v_subrev_u32 v180, s95, v180
v_cmp_lt_u32 s[92:93], 15, v180
s_or_b32 s92, s92, s93
s_and_b32 s83, s92, 0x40404040
s_cbranch_scc0 gt_80k
s_sleep 2
s_add_u32 s82, s82, 1
s_cmp_lt_u32 s82, 200000
s_cbranch_scc1 gt_80
s_mov_b32 s9, 200000
gt_80k:
s_add_u32 s64, s4, 6
s_and_b32 s64, s64, 7
s_mul_i32 s64, s64, 10240
s_add_u32 s64, s64, s62
s_add_u32 m0, s63, 122880
s_add_u32 s79, s64, 0
buffer_load_dwordx4 v5, s[36:39], s79 offen offset:0 sc1 lds
buffer_load_dwordx4 v5, s[36:39], s79 offen offset:1024 sc1 lds
buffer_load_dwordx4 v5, s[36:39], s79 offen offset:2048 sc1 lds
buffer_load_dwordx4 v5, s[36:39], s79 offen offset:3072 sc1 lds
s_add_u32 m0, s63, 126976
s_add_u32 s79, s64, 4096
buffer_load_dwordx4 v5, s[36:39], s79 offen offset:0 sc1 lds
s_and_b32 s82, s92, 0x80808080
s_cbranch_scc0 gt_81k
s_mov_b32 s82, s9
gt_81:
buffer_load_dword v180, v12, s[36:39], s94 offen sc1
s_waitcnt vmcnt(0)
v_subrev_u32 v180, s95, v180
v_cmp_lt_u32 s[92:93], 15, v180
s_or_b32 s92, s92, s93
s_and_b32 s83, s92, 0x80808080
s_cbranch_scc0 gt_81k
s_sleep 2
s_add_u32 s82, s82, 1
s_cmp_lt_u32 s82, 200000
s_cbranch_scc1 gt_81
s_mov_b32 s9, 200000
gt_81k:
s_add_u32 s64, s4, 7
s_and_b32 s64, s64, 7
s_mul_i32 s64, s64, 10240
s_add_u32 s64, s64, s62
s_add_u32 m0, s63, 143360
s_add_u32 s79, s64, 0
buffer_load_dwordx4 v5, s[36:39], s79 offen offset:0 sc1 lds
buffer_load_dwordx4 v5, s[36:39], s79 offen offset:1024 sc1 lds
buffer_load_dwordx4 v5, s[36:39], s79 offen offset:2048 sc1 lds
buffer_load_dwordx4 v5, s[36:39], s79 offen offset:3072 sc1 lds
s_add_u32 m0, s63, 147456
s_add_u32 s79, s64, 4096
buffer_load_dwordx4 v5, s[36:39], s79 offen offset:0 sc1 lds
l0_77:
s_cmp_eq_u32 s3, 0
s_cbranch_scc1 l1_82
s_waitcnt vmcnt(10)
s_add_u32 m0, s70, 0
s_add_u32 s79, s69, 0
buffer_load_dwordx4 v5, s[36:39], s79 offen offset:0  lds
buffer_load_dwordx4 v5, s[36:39], s79 offen offset:1024  lds
buffer_load_dwordx4 v5, s[36:39], s79 offen offset:2048  lds
buffer_load_dwordx4 v5, s[36:39], s79 offen offset:3072  lds
s_add_u32 m0, s70, 4096
s_add_u32 s79, s69, 4096
buffer_load_dwordx4 v5, s[36:39], s79 offen offset:0  lds
s_add_u32 m0, s70, 20480
s_add_u32 s79, s69, 20480
buffer_load_dwordx4 v5, s[36:39], s79 offen offset:0  lds
buffer_load_dwordx4 v5, s[36:39], s79 offen offset:1024  lds
buffer_load_dwordx4 v5, s[36:39], s79 offen offset:2048  lds
buffer_load_dwordx4 v5, s[36:39], s79 offen offset:3072  lds
s_add_u32 m0, s70, 24576
s_add_u32 s79, s69, 24576
buffer_load_dwordx4 v5, s[36:39], s79 offen offset:0  lds
s_cmp_ge_u32 s6, 8
s_cbranch_scc1 pfs_83
s_lshr_b32 s71, s5, 4
s_mul_i32 s71, s71, 1
s_mul_i32 s65, s6, 2
s_add_u32 s71, s71, s65
s_add_u32 s71, s71, 0
s_lshl_b32 s71, s71, 13
s_and_b32 s65, s5, 15
s_mul_i32 s65, s65, 245760
s_add_u32 s71, s71, s65
s_add_u32 s71, s71, 47415296
buffer_load_dword v176, v13, s[36:39], s71 offen
pfs_83:
l1_82:
s_branch att_hk_48r
att_hk_49:
s_cmp_lg_u32 s3, 0
s_cbranch_scc1 l0_84
s_waitcnt vmcnt(0)
s_add_u32 m0, s70, 0
s_add_u32 s79, s69, 0
buffer_load_dwordx4 v5, s[36:39], s79 offen offset:0  lds
buffer_load_dwordx4 v5, s[36:39], s79 offen offset:1024  lds
buffer_load_dwordx4 v5, s[36:39], s79 offen offset:2048  lds
buffer_load_dwordx4 v5, s[36:39], s79 offen offset:3072  lds
s_add_u32 m0, s70, 4096
s_add_u32 s79, s69, 4096
buffer_load_dwordx4 v5, s[36:39], s79 offen offset:0  lds
s_add_u32 m0, s70, 20480
s_add_u32 s79, s69, 20480
buffer_load_dwordx4 v5, s[36:39], s79 offen offset:0  lds
buffer_load_dwordx4 v5, s[36:39], s79 offen offset:1024  lds
buffer_load_dwordx4 v5, s[36:39], s79 offen offset:2048  lds
buffer_load_dwordx4 v5, s[36:39], s79 offen offset:3072  lds
s_add_u32 m0, s70, 24576
s_add_u32 s79, s69, 24576
buffer_load_dwordx4 v5, s[36:39], s79 offen offset:0  lds
l0_84:
s_cmp_eq_u32 s3, 0
s_cbranch_scc1 l1_85
s_waitcnt vmcnt(10)
l1_85:
s_add_u32 m0, s70, 40960
s_add_u32 s79, s69, 40960
buffer_load_dwordx4 v5, s[36:39], s79 offen offset:0  lds
buffer_load_dwordx4 v5, s[36:39], s79 offen offset:1024  lds
buffer_load_dwordx4 v5, s[36:39], s79 offen offset:2048  lds
buffer_load_dwordx4 v5, s[36:39], s79 offen offset:3072  lds
s_add_u32 m0, s70, 45056
s_add_u32 s79, s69, 45056
buffer_load_dwordx4 v5, s[36:39], s79 offen offset:0  lds
s_add_u32 m0, s70, 61440
s_add_u32 s79, s69, 61440
buffer_load_dwordx4 v5, s[36:39], s79 offen offset:0  lds
buffer_load_dwordx4 v5, s[36:39], s79 offen offset:1024  lds
buffer_load_dwordx4 v5, s[36:39], s79 offen offset:2048  lds
buffer_load_dwordx4 v5, s[36:39], s79 offen offset:3072  lds
s_add_u32 m0, s70, 65536
s_add_u32 s79, s69, 65536
buffer_load_dwordx4 v5, s[36:39], s79 offen offset:0  lds
s_or_b32 s65, s3, s6
s_cmp_lg_u32 s65, 0
s_cbranch_scc1 cpf_86
s_getpc_b64 s[72:73]
pc_87:
s_sub_u32 s72, s72, pc_87-interleave_layers__softmax_full_mha__glu_gated_reglu__prompt_kernel
s_subb_u32 s73, s73, 0
s_lshl_b32 s65, s5, 11
s_add_u32 s65, s65, L_fast_tail-interleave_layers__softmax_full_mha__glu_gated_reglu__prompt_kernel
v_add_u32 v182, s65, v13
v_min_u32 v182, L_fast_end-interleave_layers__softmax_full_mha__glu_gated_reglu__prompt_kernel, v182
s_mov_b64 exec, 0xffff
global_load_dword v176, v182, s[72:73]
s_mov_b64 exec, -1
cpf_86:
s_cmp_eq_u32 s3, 0
s_cbranch_scc1 l1_88
s_cmp_ge_u32 s6, 4
s_cbranch_scc1 pfs_89
s_lshr_b32 s71, s5, 4
s_mul_i32 s71, s71, 1
s_mul_i32 s65, s6, 2
s_add_u32 s71, s71, s65
s_add_u32 s71, s71, 8
s_lshl_b32 s71, s71, 13
s_and_b32 s65, s5, 15
s_mul_i32 s65, s65, 245760
s_add_u32 s71, s71, s65
s_add_u32 s71, s71, 47415296
buffer_load_dword v176, v13, s[36:39], s71 offen
pfs_89:
l1_88:
s_lshl_b32 s71, s13, 1
s_and_b32 s65, s6, 1
s_add_u32 s71, s71, s65
s_mul_i32 s71, s71, 5120
s_mov_b32 s65, 7864320
s_bitcmp1_b32 s6, 1
s_cselect_b32 s65, 10485760, s65
s_add_u32 s71, s71, s65
s_mov_b32 exec_hi, 0xff
buffer_load_dword v176, v13, s[36:39], s71 offen
s_lshl_b32 s64, s13, 9
s_add_u32 s64, s64, s7
s_add_u32 s64, s64, 22020096
s_bitcmp1_b32 s6, 0
s_cselect_b32 s65, 131072, 0
s_add_u32 s64, s64, s65
s_mov_b64 exec, 15
buffer_load_dword v176, v13, s[36:39], s64 offen
s_mov_b64 exec, -1
s_branch att_hk_49r
att_hk_50:
s_cmp_lg_u32 s3, 0
s_cbranch_scc1 l0_90
s_lshl_b32 s65, s6, 13
s_add_u32 s65, s65, 22282256
s_mov_b32 s82, s9
poll_91:
buffer_load_dwordx4 v[180:183], v13, s[36:39], s65 offen sc1
s_waitcnt vmcnt(0)
v_subrev_u32 v180, s8, v180
v_subrev_u32 v181, s8, v181
v_max_u32 v180, v180, v181
v_subrev_u32 v182, s8, v182
v_max_u32 v180, v180, v182
v_subrev_u32 v183, s8, v183
v_max_u32 v180, v180, v183
v_cmp_lt_u32 vcc, 15, v180
s_cbranch_vccz pollok_92
s_sleep 2
s_add_u32 s82, s82, 1
s_cmp_lt_u32 s82, 200000
s_cbranch_scc1 poll_91
s_mov_b32 s9, 200000
pollok_92:
l0_90:
s_add_u32 m0, s70, 81920
s_add_u32 s79, s69, 81920
buffer_load_dwordx4 v5, s[36:39], s79 offen offset:0  lds
buffer_load_dwordx4 v5, s[36:39], s79 offen offset:1024  lds
buffer_load_dwordx4 v5, s[36:39], s79 offen offset:2048  lds
buffer_load_dwordx4 v5, s[36:39], s79 offen offset:3072  lds
s_add_u32 m0, s70, 86016
s_add_u32 s79, s69, 86016
buffer_load_dwordx4 v5, s[36:39], s79 offen offset:0  lds
s_cmp_eq_u32 s3, 0
s_cbranch_scc1 l1_93
l1_93:
s_branch att_hk_50r
att_comb_52:
s_mov_b32 s99, 1
v_mov_b32 v184, 0
v_mov_b32 v185, 0
v_mov_b32 v186, 0
v_mov_b32 v187, 0
v_mov_b32 v188, 0
v_mov_b32 v189, 0
v_mov_b32 v190, 0
v_mov_b32 v191, 0
v_mov_b32 v192, 0
v_mov_b32 v193, 0
v_mov_b32 v194, 0
v_mov_b32 v195, 0
v_mov_b32 v196, 0
v_mov_b32 v197, v8
v_mov_b32 v200, 0
v_mov_b32 v201, 0
v_mov_b32 v202, 0
v_mov_b32 v203, 0
v_mov_b32 v204, 0
v_mov_b32 v205, 0
v_mov_b32 v206, 0
v_mov_b32 v207, 0
v_mov_b32 v208, 0
v_mov_b32 v209, 0
v_mov_b32 v210, 0
v_mov_b32 v211, 0
v_mov_b32 v212, 0
v_mov_b32 v213, v9
s_branch att_x_55k
att_x_55:
s_mov_b32 s72, 0
att_x_55l:
ds_read_b32 v31, v177
ds_read_b64 v[196:197], v29 offset:3072
ds_read_b64 v[212:213], v29 offset:6656
ds_read_b128 v[184:187], v28 offset:0
ds_read_b128 v[188:191], v28 offset:1024
ds_read_b128 v[192:195], v28 offset:2048
ds_read_b128 v[200:203], v28 offset:3584
ds_read_b128 v[204:207], v28 offset:4608
ds_read_b128 v[208:211], v28 offset:5632
s_waitcnt lgkmcnt(0)
v_cmp_ne_u32 vcc, s8, v31
s_cbranch_vccz att_x_55k
s_add_u32 s72, s72, 1
s_cmp_lt_u32 s72, 800000
s_cbranch_scc1 att_x_55l
s_branch att_x_55k
att_y_54:
s_waitcnt lgkmcnt(0)
s_nop 8
v_mov_b32 v125, v8
v_mov_b32 v141, v9
v_mov_b32 v10, s8
ds_write_b128 v28, v[112:115] offset:0
ds_write_b128 v28, v[116:119] offset:1024
ds_write_b128 v28, v[120:123] offset:2048
ds_write_b64 v29, v[124:125] offset:3072
ds_write_b128 v28, v[128:131] offset:3584
ds_write_b128 v28, v[132:135] offset:4608
ds_write_b128 v28, v[136:139] offset:5632
ds_write_b64 v29, v[140:141] offset:6656
ds_write_b32 v177, v10
s_cmp_lg_u32 s3, 0
s_cbranch_scc1 l0_94
s_cmp_lg_u32 s6, 3
s_cbranch_scc1 cs_95
s_mov_b32 exec_hi, 0xffff
s_and_b32 s65, s5, 15
s_mul_i32 s65, s65, 768
s_add_u32 s65, s65, 51347456
buffer_load_dwordx4 v[180:183], v5, s[36:39], s65 offen
s_add_u32 s65, s65, 12288
buffer_load_dwordx4 v[184:187], v5, s[36:39], s65 offen
s_add_u32 s65, s65, 12288
buffer_load_dwordx4 v[188:191], v5, s[36:39], s65 offen
s_add_u32 s65, s65, 12288
buffer_load_dwordx4 v[192:195], v5, s[36:39], s65 offen
s_add_u32 s65, s65, 12288
buffer_load_dwordx4 v[196:199], v5, s[36:39], s65 offen
s_add_u32 s65, s65, 12288
buffer_load_dwordx4 v[200:203], v5, s[36:39], s65 offen
s_add_u32 s65, s65, 12288
buffer_load_dwordx4 v[204:207], v5, s[36:39], s65 offen
s_add_u32 s65, s65, 12288
buffer_load_dwordx4 v[208:211], v5, s[36:39], s65 offen
s_add_u32 s65, s65, 12288
buffer_load_dwordx4 v[212:215], v5, s[36:39], s65 offen
s_add_u32 s65, s65, 12288
buffer_load_dwordx4 v[216:219], v5, s[36:39], s65 offen
s_add_u32 s65, s65, 12288
s_mov_b32 exec_hi, -1
cs_95:
l0_94:
s_waitcnt lgkmcnt(0)
L_fast_post:
s_lshr_b32 s60, s13, 3
s_and_b32 s61, s5, 7
v_and_b32 v3, 15, v0
v_lshrrev_b32 v7, 4, v0
s_lshl_b32 s66, s60, 1
s_lshr_b32 s67, s6, 1
s_add_u32 s66, s66, s67
s_and_b32 s68, s6, 1
s_lshl_b32 s68, s68, 8
s_mul_i32 s62, s66, 40960
s_add_u32 s62, s62, s68
s_add_u32 s62, s62, 7864320
s_mul_i32 s64, s66, 40960
s_mul_i32 s67, s61, 5120
s_add_u32 s64, s64, s67
s_add_u32 s64, s64, s68
s_lshl_b32 s72, s6, 8
s_lshl_b32 s67, s60, 12
s_add_u32 s72, s72, s67
s_add_u32 s72, s72, s7
s_lshl_b32 s65, s60, 2
s_add_u32 s65, s65, s6
s_mul_i32 s65, s65, 20480
s_mul_i32 s67, s61, 160
s_add_u32 s65, s65, s67
v_lshlrev_b32 v1, 4, v3
v_lshl_add_u32 v10, v7, 9, v1
v_lshrrev_b32 v2, 5, v0
v_lshl_add_u32 v1, v2, 9, v1
v_and_b32 v2, 1, v7
v_lshl_add_u32 v11, v2, 3, v1
v_add_u32 v11, 4096, v11
v_mul_u32_u24 v1, 1280, v3
v_lshl_add_u32 v12, v7, 4, v1
v_lshl_add_u32 v13, v7, 3, v1
v_add_u32 v9, 4096, v10
s_cmp_lg_u32 s3, 0
s_cbranch_scc1 prj_r1_96
buffer_load_dwordx4 v[54:57], v12, s[40:43], s65 offen
buffer_load_dwordx4 v[58:61], v12, s[40:43], s65 offen offset:64
buffer_load_dwordx2 v[62:63], v13, s[40:43], s65 offen offset:128
s_branch prj_r2_97
prj_r1_96:
s_add_u32 s67, s64, 10485760
buffer_load_dwordx4 v[54:57], v10, s[36:39], s67 offen sc1
buffer_load_dwordx4 v[58:61], v10, s[36:39], s67 offen offset:2048 sc1
buffer_load_dwordx2 v[62:63], v11, s[36:39], s67 offen offset:0 sc1
prj_r2_97:
s_setprio 0
s_waitcnt vmcnt(0)
s_barrier
s_cmp_lg_u32 s3, 0
s_cbranch_scc1 l0_98
s_cmp_lg_u32 s6, 3
s_cbranch_scc1 cs_99
s_mov_b32 exec_hi, 0xffff
v_pk_add_f32 v[180:181], v[180:181], v[184:185]
v_pk_add_f32 v[182:183], v[182:183], v[186:187]
v_pk_add_f32 v[180:181], v[180:181], v[188:189]
v_pk_add_f32 v[182:183], v[182:183], v[190:191]
v_pk_add_f32 v[180:181], v[180:181], v[192:193]
v_pk_add_f32 v[182:183], v[182:183], v[194:195]
v_pk_add_f32 v[180:181], v[180:181], v[196:197]
v_pk_add_f32 v[182:183], v[182:183], v[198:199]
v_pk_add_f32 v[180:181], v[180:181], v[200:201]
v_pk_add_f32 v[182:183], v[182:183], v[202:203]
v_pk_add_f32 v[180:181], v[180:181], v[204:205]
v_pk_add_f32 v[182:183], v[182:183], v[206:207]
v_pk_add_f32 v[180:181], v[180:181], v[208:209]
v_pk_add_f32 v[182:183], v[182:183], v[210:211]
v_pk_add_f32 v[180:181], v[180:181], v[212:213]
v_pk_add_f32 v[182:183], v[182:183], v[214:215]
v_pk_add_f32 v[180:181], v[180:181], v[216:217]
v_pk_add_f32 v[182:183], v[182:183], v[218:219]
s_mul_i32 s78, s13, 768
s_add_u32 s78, s78, 51470336
v_lshlrev_b32 v184, 4, v0
buffer_store_dwordx4 v[180:183], v184, s[36:39], s78 offen
s_mov_b32 exec_hi, -1
s_nop 1
cs_99:
l0_98:
v_lshlrev_b32 v4, 4, v0
v_add_u32 v5, 61440, v4
v_add_u32 v6, 122880, v4
s_mov_b32 s68, 0xffff0000
v_and_b32 v1, 31, v0
v_lshlrev_b32 v1, 5, v1
s_lshr_b32 s94, s5, 3
s_lshl_b32 s94, s94, 2
s_add_u32 s94, s94, 16
s_lshl_b32 s81, s4, 10
s_add_u32 s94, s94, s81
s_add_u32 s94, s94, 51798016
s_add_u32 s95, s8, 2
s_mov_b32 s92, -1
buffer_load_dword v2, v1, s[36:39], s94 offen sc1
ds_read_b128 v[134:137], v4 offset:0
ds_read_b128 v[138:141], v4 offset:1024
ds_read_b128 v[142:145], v4 offset:2048
ds_read_b128 v[146:149], v4 offset:3072
ds_read_b128 v[150:153], v4 offset:4096
ds_read_b128 v[154:157], v4 offset:5120
ds_read_b128 v[158:161], v4 offset:6144
ds_read_b128 v[162:165], v4 offset:7168
ds_read_b128 v[166:169], v4 offset:8192
ds_read_b128 v[170:173], v4 offset:9216
ds_read_b128 v[174:177], v4 offset:10240
ds_read_b128 v[178:181], v4 offset:11264
ds_read_b128 v[182:185], v4 offset:12288
ds_read_b128 v[186:189], v4 offset:13312
ds_read_b128 v[190:193], v4 offset:14336
ds_read_b128 v[194:197], v4 offset:15360
ds_read_b128 v[198:201], v4 offset:16384
ds_read_b128 v[202:205], v4 offset:17408
ds_read_b128 v[206:209], v4 offset:18432
ds_read_b128 v[210:213], v4 offset:19456
ds_read_b128 v[214:217], v4 offset:20480
ds_read_b128 v[218:221], v4 offset:21504
ds_read_b128 v[222:225], v4 offset:22528
ds_read_b128 v[226:229], v4 offset:23552
ds_read_b128 v[230:233], v4 offset:24576
v_lshlrev_b32 v34, 16, v54
v_and_b32 v35, s68, v54
v_lshlrev_b32 v36, 16, v55
v_and_b32 v37, s68, v55
v_lshlrev_b32 v38, 16, v56
v_and_b32 v39, s68, v56
v_lshlrev_b32 v40, 16, v57
v_and_b32 v41, s68, v57
v_lshlrev_b32 v42, 16, v58
v_and_b32 v43, s68, v58
v_lshlrev_b32 v44, 16, v59
v_and_b32 v45, s68, v59
v_lshlrev_b32 v46, 16, v60
v_and_b32 v47, s68, v60
v_lshlrev_b32 v48, 16, v61
v_and_b32 v49, s68, v61
v_lshlrev_b32 v50, 16, v62
v_and_b32 v51, s68, v62
v_lshlrev_b32 v52, 16, v63
v_and_b32 v53, s68, v63
s_waitcnt vmcnt(0)
v_subrev_u32 v2, s95, v2
v_cmp_lt_u32 s[92:93], 15, v2
s_and_b32 s82, s92, 0x7f
s_cbranch_scc0 gt_100k
s_mov_b32 s82, s9
gt_100:
buffer_load_dword v2, v1, s[36:39], s94 offen sc1
s_waitcnt vmcnt(0)
v_subrev_u32 v2, s95, v2
v_cmp_lt_u32 s[92:93], 15, v2
s_and_b32 s83, s92, 0x7f
s_cbranch_scc0 gt_100k
s_add_u32 s82, s82, 1
s_cmp_lt_u32 s82, 200000
s_cbranch_scc1 gt_100
s_mov_b32 s9, 200000
gt_100k:
s_add_u32 s70, s62, 0
buffer_load_dwordx4 v[54:57], v10, s[36:39], s70 offen offset:0 sc1
buffer_load_dwordx4 v[58:61], v10, s[36:39], s70 offen offset:2048 sc1
buffer_load_dwordx4 v[62:65], v9, s[36:39], s70 offen offset:0 sc1
buffer_load_dwordx4 v[66:69], v9, s[36:39], s70 offen offset:2048 sc1
s_and_b32 s82, s92, 0x1f80
s_cbranch_scc0 gt_101k
s_mov_b32 s82, s9
gt_101:
buffer_load_dword v2, v1, s[36:39], s94 offen sc1
s_waitcnt vmcnt(0)
v_subrev_u32 v2, s95, v2
v_cmp_lt_u32 s[92:93], 15, v2
s_and_b32 s83, s92, 0x1f80
s_cbranch_scc0 gt_101k
s_add_u32 s82, s82, 1
s_cmp_lt_u32 s82, 200000
s_cbranch_scc1 gt_101
s_mov_b32 s9, 200000
gt_101k:
s_add_u32 s70, s62, 8192
buffer_load_dwordx4 v[70:73], v10, s[36:39], s70 offen offset:0 sc1
buffer_load_dwordx4 v[74:77], v10, s[36:39], s70 offen offset:2048 sc1
buffer_load_dwordx4 v[78:81], v9, s[36:39], s70 offen offset:0 sc1
buffer_load_dwordx4 v[82:85], v9, s[36:39], s70 offen offset:2048 sc1
s_waitcnt vmcnt(7) lgkmcnt(15)
s_and_b32 s82, s92, 0xfe000
s_cbranch_scc0 gt_102k
s_mov_b32 s82, s9
gt_102:
buffer_load_dword v2, v1, s[36:39], s94 offen sc1
s_waitcnt vmcnt(0)
v_subrev_u32 v2, s95, v2
v_cmp_lt_u32 s[92:93], 15, v2
s_and_b32 s83, s92, 0xfe000
s_cbranch_scc0 gt_102k
s_add_u32 s82, s82, 1
s_cmp_lt_u32 s82, 200000
s_cbranch_scc1 gt_102
s_mov_b32 s9, 200000
gt_102k:
s_add_u32 s70, s62, 16384
v_mfma_f32_16x16x32_bf16 v[14:17], v[134:137], v[54:57], 0
ds_read_b128 v[234:237], v4 offset:25600
v_mfma_f32_16x16x32_bf16 v[18:21], v[138:141], v[54:57], 0
ds_read_b128 v[238:241], v4 offset:26624
buffer_load_dwordx4 v[86:89], v10, s[36:39], s70 offen offset:0 sc1
v_mfma_f32_16x16x32_bf16 v[22:25], v[142:145], v[54:57], 0
ds_read_b128 v[242:245], v4 offset:27648
v_mfma_f32_16x16x32_bf16 v[26:29], v[146:149], v[54:57], 0
ds_read_b128 v[246:249], v4 offset:28672
v_mfma_f32_16x16x32_bf16 v[30:33], v[150:153], v[54:57], 0
ds_read_b128 v[250:253], v4 offset:29696
buffer_load_dwordx4 v[90:93], v10, s[36:39], s70 offen offset:2048 sc1
s_waitcnt vmcnt(8) lgkmcnt(15)
v_mfma_f32_16x16x32_bf16 v[14:17], v[154:157], v[58:61], v[14:17]
ds_read_b128 v[134:137], v4 offset:30720
v_mfma_f32_16x16x32_bf16 v[18:21], v[158:161], v[58:61], v[18:21]
ds_read_b128 v[138:141], v4 offset:31744
buffer_load_dwordx4 v[94:97], v9, s[36:39], s70 offen offset:0 sc1
v_mfma_f32_16x16x32_bf16 v[22:25], v[162:165], v[58:61], v[22:25]
ds_read_b128 v[142:145], v4 offset:32768
v_mfma_f32_16x16x32_bf16 v[26:29], v[166:169], v[58:61], v[26:29]
ds_read_b128 v[146:149], v4 offset:33792
v_mfma_f32_16x16x32_bf16 v[30:33], v[170:173], v[58:61], v[30:33]
ds_read_b128 v[150:153], v4 offset:34816
buffer_load_dwordx4 v[98:101], v9, s[36:39], s70 offen offset:2048 sc1
s_waitcnt vmcnt(9) lgkmcnt(15)
s_and_b32 s82, s92, 0x3f00000
s_cbranch_scc0 gt_103k
s_mov_b32 s82, s9
gt_103:
buffer_load_dword v2, v1, s[36:39], s94 offen sc1
s_waitcnt vmcnt(0)
v_subrev_u32 v2, s95, v2
v_cmp_lt_u32 s[92:93], 15, v2
s_and_b32 s83, s92, 0x3f00000
s_cbranch_scc0 gt_103k
s_add_u32 s82, s82, 1
s_cmp_lt_u32 s82, 200000
s_cbranch_scc1 gt_103
s_mov_b32 s9, 200000
gt_103k:
s_add_u32 s70, s62, 24576
v_mfma_f32_16x16x32_bf16 v[14:17], v[174:177], v[62:65], v[14:17]
ds_read_b128 v[154:157], v4 offset:35840
v_mfma_f32_16x16x32_bf16 v[18:21], v[178:181], v[62:65], v[18:21]
ds_read_b128 v[158:161], v4 offset:36864
buffer_load_dwordx4 v[102:105], v10, s[36:39], s70 offen offset:0 sc1
v_mfma_f32_16x16x32_bf16 v[22:25], v[182:185], v[62:65], v[22:25]
ds_read_b128 v[162:165], v4 offset:37888
v_mfma_f32_16x16x32_bf16 v[26:29], v[186:189], v[62:65], v[26:29]
ds_read_b128 v[166:169], v4 offset:38912
v_mfma_f32_16x16x32_bf16 v[30:33], v[190:193], v[62:65], v[30:33]
ds_read_b128 v[170:173], v4 offset:39936
buffer_load_dwordx4 v[106:109], v10, s[36:39], s70 offen offset:2048 sc1
s_waitcnt vmcnt(10) lgkmcnt(15)
v_mfma_f32_16x16x32_bf16 v[14:17], v[194:197], v[66:69], v[14:17]
ds_read_b128 v[174:177], v4 offset:40960
v_mfma_f32_16x16x32_bf16 v[18:21], v[198:201], v[66:69], v[18:21]
ds_read_b128 v[178:181], v4 offset:41984
buffer_load_dwordx4 v[110:113], v9, s[36:39], s70 offen offset:0 sc1
v_mfma_f32_16x16x32_bf16 v[22:25], v[202:205], v[66:69], v[22:25]
ds_read_b128 v[182:185], v4 offset:43008
v_mfma_f32_16x16x32_bf16 v[26:29], v[206:209], v[66:69], v[26:29]
ds_read_b128 v[186:189], v4 offset:44032
v_mfma_f32_16x16x32_bf16 v[30:33], v[210:213], v[66:69], v[30:33]
ds_read_b128 v[190:193], v4 offset:45056
buffer_load_dwordx4 v[114:117], v9, s[36:39], s70 offen offset:2048 sc1
s_waitcnt vmcnt(11) lgkmcnt(15)
s_and_b32 s82, s92, 0xfc000000
s_cbranch_scc0 gt_104k
s_mov_b32 s82, s9
gt_104:
buffer_load_dword v2, v1, s[36:39], s94 offen sc1
s_waitcnt vmcnt(0)
v_subrev_u32 v2, s95, v2
v_cmp_lt_u32 s[92:93], 15, v2
s_and_b32 s83, s92, 0xfc000000
s_cbranch_scc0 gt_104k
s_add_u32 s82, s82, 1
s_cmp_lt_u32 s82, 200000
s_cbranch_scc1 gt_104
s_mov_b32 s9, 200000
gt_104k:
s_add_u32 s70, s62, 32768
v_mfma_f32_16x16x32_bf16 v[14:17], v[214:217], v[70:73], v[14:17]
ds_read_b128 v[194:197], v4 offset:46080
v_mfma_f32_16x16x32_bf16 v[18:21], v[218:221], v[70:73], v[18:21]
ds_read_b128 v[198:201], v4 offset:47104
buffer_load_dwordx4 v[118:121], v10, s[36:39], s70 offen offset:0 sc1
v_mfma_f32_16x16x32_bf16 v[22:25], v[222:225], v[70:73], v[22:25]
ds_read_b128 v[202:205], v4 offset:48128
v_mfma_f32_16x16x32_bf16 v[26:29], v[226:229], v[70:73], v[26:29]
ds_read_b128 v[206:209], v4 offset:49152
v_mfma_f32_16x16x32_bf16 v[30:33], v[230:233], v[70:73], v[30:33]
ds_read_b128 v[210:213], v4 offset:50176
buffer_load_dwordx4 v[122:125], v10, s[36:39], s70 offen offset:2048 sc1
s_waitcnt vmcnt(12) lgkmcnt(15)
v_mfma_f32_16x16x32_bf16 v[14:17], v[234:237], v[74:77], v[14:17]
ds_read_b128 v[214:217], v4 offset:51200
v_mfma_f32_16x16x32_bf16 v[18:21], v[238:241], v[74:77], v[18:21]
ds_read_b128 v[218:221], v4 offset:52224
buffer_load_dwordx4 v[126:129], v9, s[36:39], s70 offen offset:0 sc1
v_mfma_f32_16x16x32_bf16 v[22:25], v[242:245], v[74:77], v[22:25]
ds_read_b128 v[222:225], v4 offset:53248
v_mfma_f32_16x16x32_bf16 v[26:29], v[246:249], v[74:77], v[26:29]
ds_read_b128 v[226:229], v4 offset:54272
v_mfma_f32_16x16x32_bf16 v[30:33], v[250:253], v[74:77], v[30:33]
ds_read_b128 v[230:233], v4 offset:55296
buffer_load_dwordx4 v[130:133], v9, s[36:39], s70 offen offset:2048 sc1
s_waitcnt vmcnt(13) lgkmcnt(15)
v_mfma_f32_16x16x32_bf16 v[14:17], v[134:137], v[78:81], v[14:17]
ds_read_b128 v[234:237], v4 offset:56320
v_mfma_f32_16x16x32_bf16 v[18:21], v[138:141], v[78:81], v[18:21]
ds_read_b128 v[238:241], v4 offset:57344
v_mfma_f32_16x16x32_bf16 v[22:25], v[142:145], v[78:81], v[22:25]
ds_read_b128 v[242:245], v4 offset:58368
v_mfma_f32_16x16x32_bf16 v[26:29], v[146:149], v[78:81], v[26:29]
ds_read_b128 v[246:249], v4 offset:59392
v_mfma_f32_16x16x32_bf16 v[30:33], v[150:153], v[78:81], v[30:33]
ds_read_b128 v[250:253], v4 offset:60416
s_waitcnt vmcnt(12) lgkmcnt(15)
v_mfma_f32_16x16x32_bf16 v[14:17], v[154:157], v[82:85], v[14:17]
ds_read_b128 v[134:137], v5 offset:0
v_mfma_f32_16x16x32_bf16 v[18:21], v[158:161], v[82:85], v[18:21]
ds_read_b128 v[138:141], v5 offset:1024
v_mfma_f32_16x16x32_bf16 v[22:25], v[162:165], v[82:85], v[22:25]
ds_read_b128 v[142:145], v5 offset:2048
v_mfma_f32_16x16x32_bf16 v[26:29], v[166:169], v[82:85], v[26:29]
ds_read_b128 v[146:149], v5 offset:3072
v_mfma_f32_16x16x32_bf16 v[30:33], v[170:173], v[82:85], v[30:33]
ds_read_b128 v[150:153], v5 offset:4096
s_waitcnt vmcnt(11) lgkmcnt(15)
v_mfma_f32_16x16x32_bf16 v[14:17], v[174:177], v[86:89], v[14:17]
ds_read_b128 v[154:157], v5 offset:5120
v_mfma_f32_16x16x32_bf16 v[18:21], v[178:181], v[86:89], v[18:21]
ds_read_b128 v[158:161], v5 offset:6144
v_mfma_f32_16x16x32_bf16 v[22:25], v[182:185], v[86:89], v[22:25]
ds_read_b128 v[162:165], v5 offset:7168
v_mfma_f32_16x16x32_bf16 v[26:29], v[186:189], v[86:89], v[26:29]
ds_read_b128 v[166:169], v5 offset:8192
v_mfma_f32_16x16x32_bf16 v[30:33], v[190:193], v[86:89], v[30:33]
ds_read_b128 v[170:173], v5 offset:9216
s_waitcnt vmcnt(10) lgkmcnt(15)
v_mfma_f32_16x16x32_bf16 v[14:17], v[194:197], v[90:93], v[14:17]
ds_read_b128 v[174:177], v5 offset:10240
v_mfma_f32_16x16x32_bf16 v[18:21], v[198:201], v[90:93], v[18:21]
ds_read_b128 v[178:181], v5 offset:11264
v_mfma_f32_16x16x32_bf16 v[22:25], v[202:205], v[90:93], v[22:25]
ds_read_b128 v[182:185], v5 offset:12288
v_mfma_f32_16x16x32_bf16 v[26:29], v[206:209], v[90:93], v[26:29]
ds_read_b128 v[186:189], v5 offset:13312
v_mfma_f32_16x16x32_bf16 v[30:33], v[210:213], v[90:93], v[30:33]
ds_read_b128 v[190:193], v5 offset:14336
s_waitcnt vmcnt(9) lgkmcnt(15)
v_mfma_f32_16x16x32_bf16 v[14:17], v[214:217], v[94:97], v[14:17]
ds_read_b128 v[194:197], v5 offset:15360
v_mfma_f32_16x16x32_bf16 v[18:21], v[218:221], v[94:97], v[18:21]
ds_read_b128 v[198:201], v5 offset:16384
v_mfma_f32_16x16x32_bf16 v[22:25], v[222:225], v[94:97], v[22:25]
ds_read_b128 v[202:205], v5 offset:17408
v_mfma_f32_16x16x32_bf16 v[26:29], v[226:229], v[94:97], v[26:29]
ds_read_b128 v[206:209], v5 offset:18432
v_mfma_f32_16x16x32_bf16 v[30:33], v[230:233], v[94:97], v[30:33]
ds_read_b128 v[210:213], v5 offset:19456
s_waitcnt vmcnt(8) lgkmcnt(15)
v_mfma_f32_16x16x32_bf16 v[14:17], v[234:237], v[98:101], v[14:17]
ds_read_b128 v[214:217], v5 offset:20480
v_mfma_f32_16x16x32_bf16 v[18:21], v[238:241], v[98:101], v[18:21]
ds_read_b128 v[218:221], v5 offset:21504
v_mfma_f32_16x16x32_bf16 v[22:25], v[242:245], v[98:101], v[22:25]
ds_read_b128 v[222:225], v5 offset:22528
v_mfma_f32_16x16x32_bf16 v[26:29], v[246:249], v[98:101], v[26:29]
ds_read_b128 v[226:229], v5 offset:23552
v_mfma_f32_16x16x32_bf16 v[30:33], v[250:253], v[98:101], v[30:33]
ds_read_b128 v[230:233], v5 offset:24576
s_waitcnt vmcnt(7) lgkmcnt(15)
v_mfma_f32_16x16x32_bf16 v[14:17], v[134:137], v[102:105], v[14:17]
ds_read_b128 v[234:237], v5 offset:25600
v_mfma_f32_16x16x32_bf16 v[18:21], v[138:141], v[102:105], v[18:21]
ds_read_b128 v[238:241], v5 offset:26624
v_mfma_f32_16x16x32_bf16 v[22:25], v[142:145], v[102:105], v[22:25]
ds_read_b128 v[242:245], v5 offset:27648
v_mfma_f32_16x16x32_bf16 v[26:29], v[146:149], v[102:105], v[26:29]
ds_read_b128 v[246:249], v5 offset:28672
v_mfma_f32_16x16x32_bf16 v[30:33], v[150:153], v[102:105], v[30:33]
ds_read_b128 v[250:253], v5 offset:29696
s_waitcnt vmcnt(6) lgkmcnt(15)
v_mfma_f32_16x16x32_bf16 v[14:17], v[154:157], v[106:109], v[14:17]
ds_read_b128 v[134:137], v5 offset:30720
v_mfma_f32_16x16x32_bf16 v[18:21], v[158:161], v[106:109], v[18:21]
ds_read_b128 v[138:141], v5 offset:31744
v_mfma_f32_16x16x32_bf16 v[22:25], v[162:165], v[106:109], v[22:25]
ds_read_b128 v[142:145], v5 offset:32768
v_mfma_f32_16x16x32_bf16 v[26:29], v[166:169], v[106:109], v[26:29]
ds_read_b128 v[146:149], v5 offset:33792
v_mfma_f32_16x16x32_bf16 v[30:33], v[170:173], v[106:109], v[30:33]
ds_read_b128 v[150:153], v5 offset:34816
s_waitcnt vmcnt(5) lgkmcnt(15)
v_mfma_f32_16x16x32_bf16 v[14:17], v[174:177], v[110:113], v[14:17]
ds_read_b128 v[154:157], v5 offset:35840
v_mfma_f32_16x16x32_bf16 v[18:21], v[178:181], v[110:113], v[18:21]
ds_read_b128 v[158:161], v5 offset:36864
v_mfma_f32_16x16x32_bf16 v[22:25], v[182:185], v[110:113], v[22:25]
ds_read_b128 v[162:165], v5 offset:37888
v_mfma_f32_16x16x32_bf16 v[26:29], v[186:189], v[110:113], v[26:29]
ds_read_b128 v[166:169], v5 offset:38912
v_mfma_f32_16x16x32_bf16 v[30:33], v[190:193], v[110:113], v[30:33]
ds_read_b128 v[170:173], v5 offset:39936
s_waitcnt vmcnt(4) lgkmcnt(15)
v_mfma_f32_16x16x32_bf16 v[14:17], v[194:197], v[114:117], v[14:17]
v_mfma_f32_16x16x32_bf16 v[18:21], v[198:201], v[114:117], v[18:21]
v_mfma_f32_16x16x32_bf16 v[22:25], v[202:205], v[114:117], v[22:25]
v_mfma_f32_16x16x32_bf16 v[26:29], v[206:209], v[114:117], v[26:29]
v_mfma_f32_16x16x32_bf16 v[30:33], v[210:213], v[114:117], v[30:33]
s_waitcnt vmcnt(3) lgkmcnt(15)
v_mfma_f32_16x16x32_bf16 v[14:17], v[214:217], v[118:121], v[14:17]
v_mfma_f32_16x16x32_bf16 v[18:21], v[218:221], v[118:121], v[18:21]
v_mfma_f32_16x16x32_bf16 v[22:25], v[222:225], v[118:121], v[22:25]
v_mfma_f32_16x16x32_bf16 v[26:29], v[226:229], v[118:121], v[26:29]
v_mfma_f32_16x16x32_bf16 v[30:33], v[230:233], v[118:121], v[30:33]
s_waitcnt vmcnt(2) lgkmcnt(10)
v_mfma_f32_16x16x32_bf16 v[14:17], v[234:237], v[122:125], v[14:17]
v_mfma_f32_16x16x32_bf16 v[18:21], v[238:241], v[122:125], v[18:21]
v_mfma_f32_16x16x32_bf16 v[22:25], v[242:245], v[122:125], v[22:25]
v_mfma_f32_16x16x32_bf16 v[26:29], v[246:249], v[122:125], v[26:29]
v_mfma_f32_16x16x32_bf16 v[30:33], v[250:253], v[122:125], v[30:33]
s_waitcnt vmcnt(1) lgkmcnt(5)
v_mfma_f32_16x16x32_bf16 v[14:17], v[134:137], v[126:129], v[14:17]
v_mfma_f32_16x16x32_bf16 v[18:21], v[138:141], v[126:129], v[18:21]
v_mfma_f32_16x16x32_bf16 v[22:25], v[142:145], v[126:129], v[22:25]
v_mfma_f32_16x16x32_bf16 v[26:29], v[146:149], v[126:129], v[26:29]
v_mfma_f32_16x16x32_bf16 v[30:33], v[150:153], v[126:129], v[30:33]
s_waitcnt vmcnt(0) lgkmcnt(0)
s_barrier
v_mfma_f32_16x16x32_bf16 v[14:17], v[154:157], v[130:133], v[14:17]
v_mfma_f32_16x16x32_bf16 v[18:21], v[158:161], v[130:133], v[18:21]
v_mfma_f32_16x16x32_bf16 v[22:25], v[162:165], v[130:133], v[22:25]
v_mfma_f32_16x16x32_bf16 v[26:29], v[166:169], v[130:133], v[26:29]
v_mfma_f32_16x16x32_bf16 v[30:33], v[170:173], v[130:133], v[30:33]
s_add_u32 s67, s64, 10485760
s_lshl_b32 s80, s13, 3
s_add_u32 s80, s80, s6
s_lshl_b32 s80, s80, 2
s_add_u32 s80, s80, 51798016
s_add_u32 s81, s8, 3
v_mov_b32 v1, 0
v_mov_b32 v2, s81
v_pk_add_f32 v[14:15], v[14:15], v[34:35]
v_cvt_pk_bf16_f32 v60, v14, v15
v_pk_add_f32 v[16:17], v[16:17], v[36:37]
v_cvt_pk_bf16_f32 v61, v16, v17
v_pk_add_f32 v[18:19], v[18:19], v[38:39]
v_cvt_pk_bf16_f32 v62, v18, v19
v_pk_add_f32 v[20:21], v[20:21], v[40:41]
v_cvt_pk_bf16_f32 v63, v20, v21
v_pk_add_f32 v[22:23], v[22:23], v[42:43]
v_cvt_pk_bf16_f32 v64, v22, v23
v_pk_add_f32 v[24:25], v[24:25], v[44:45]
v_cvt_pk_bf16_f32 v65, v24, v25
v_pk_add_f32 v[26:27], v[26:27], v[46:47]
v_cvt_pk_bf16_f32 v66, v26, v27
v_pk_add_f32 v[28:29], v[28:29], v[48:49]
v_cvt_pk_bf16_f32 v67, v28, v29
v_pk_add_f32 v[30:31], v[30:31], v[50:51]
v_cvt_pk_bf16_f32 v68, v30, v31
v_pk_add_f32 v[32:33], v[32:33], v[52:53]
v_cvt_pk_bf16_f32 v69, v32, v33
buffer_store_dwordx4 v[60:63], v10, s[36:39], s67 offen
buffer_store_dwordx4 v[64:67], v10, s[36:39], s67 offen offset:2048
buffer_store_dwordx2 v[68:69], v11, s[36:39], s67 offen offset:0
v_pk_add_f32 v[72:73], v[14:15], v[16:17]
v_pk_mul_f32 v[74:75], v[14:15], v[14:15]
v_pk_fma_f32 v[74:75], v[16:17], v[16:17], v[74:75]
v_pk_add_f32 v[72:73], v[72:73], v[18:19]
v_pk_fma_f32 v[74:75], v[18:19], v[18:19], v[74:75]
v_pk_add_f32 v[72:73], v[72:73], v[20:21]
v_pk_fma_f32 v[74:75], v[20:21], v[20:21], v[74:75]
v_pk_add_f32 v[72:73], v[72:73], v[22:23]
v_pk_fma_f32 v[74:75], v[22:23], v[22:23], v[74:75]
v_pk_add_f32 v[72:73], v[72:73], v[24:25]
v_pk_fma_f32 v[74:75], v[24:25], v[24:25], v[74:75]
v_pk_add_f32 v[72:73], v[72:73], v[26:27]
v_pk_fma_f32 v[74:75], v[26:27], v[26:27], v[74:75]
v_pk_add_f32 v[72:73], v[72:73], v[28:29]
v_pk_fma_f32 v[74:75], v[28:29], v[28:29], v[74:75]
v_pk_add_f32 v[72:73], v[72:73], v[30:31]
v_pk_fma_f32 v[74:75], v[30:31], v[30:31], v[74:75]
v_pk_add_f32 v[72:73], v[72:73], v[32:33]
v_pk_fma_f32 v[74:75], v[32:33], v[32:33], v[74:75]
v_add_f32 v72, v72, v73
v_add_f32 v73, v74, v75
s_lshr_b32 s67, s61, 1
s_lshl_b32 s67, s67, 10
v_permlane32_swap_b32 v72, v73
s_and_b32 s68, s61, 1
s_lshl_b32 s68, s68, 3
v_add_f32 v72, v72, v73
v_mov_b32 v73, v72
s_add_u32 s67, s67, s68
s_add_u32 s67, s67, s72
v_permlane16_swap_b32 v72, v73
s_add_u32 s67, s67, 22020096
v_lshrrev_b32 v8, 5, v0
v_lshlrev_b32 v8, 2, v8
v_lshl_add_u32 v8, v3, 4, v8
v_add_f32 v72, v72, v73
buffer_store_dword v72, v8, s[36:39], s67 offen
s_waitcnt vmcnt(1)
s_mov_b64 exec, 1
buffer_store_dword v2, v1, s[36:39], s80 offen
s_mov_b64 exec, -1
s_barrier
v_add_u32 v253, 1, v2
v_mov_b32 v252, 0
s_mov_b32 s100, s80
s_or_b32 s67, s6, s61
s_or_b32 s67, s67, s3
s_cbranch_scc1 fk_105
s_lshl_b32 s67, s13, 7
s_add_u32 s67, s67, 22282280
s_mov_b64 exec, 1
buffer_store_dword v2, v1, s[36:39], s67 offen sc1
s_mov_b64 exec, -1
fk_105:
s_lshr_b32 s60, s13, 4
s_and_b32 s61, s5, 15
s_and_b32 s62, s6, 1
s_lshr_b32 s63, s6, 1
s_lshl_b32 s64, s60, 1
s_add_u32 s64, s64, s62
s_mul_i32 s66, s61, 96
s_mul_i32 s65, s63, 48
s_add_u32 s66, s66, s65
s_mul_i32 s65, s13, 768
s_mul_i32 s67, s63, 384
s_add_u32 s65, s65, s67
s_add_u32 s73, s65, 51470336
v_lshrrev_b32 v12, 4, v0
v_lshlrev_b32 v7, 4, v12
v_and_b32 v13, 15, v0
v_lshlrev_b32 v3, 4, v13
v_lshl_add_u32 v3, v12, 9, v3
s_lshl_b32 s65, s62, 13
v_add_u32 v3, s65, v3
v_lshlrev_b32 v11, 4, v0
s_mul_i32 s65, s63, 6144
s_add_u32 s65, s65, 65536
v_add_u32 v4, s65, v11
v_add_u32 v5, 49152, v4
v_lshlrev_b32 v6, 2, v13
s_mul_i32 s71, s64, 196608
s_lshl_b32 s67, s66, 6
s_add_u32 s71, s71, s67
s_add_u32 s71, s71, 0
s_add_u32 s72, s71, 98304
s_lshl_b32 s80, s13, 3
s_add_u32 s80, s80, s6
s_lshl_b32 s80, s80, 2
s_add_u32 s80, s80, 51798016
s_add_u32 s81, s8, 5
v_mov_b32 v1, 0
v_mov_b32 v2, s81
s_lshl_b32 s65, s64, 12
s_add_u32 s65, s65, s7
s_add_u32 s65, s65, 22020096
s_waitcnt vmcnt(0)
s_mov_b64 exec, 1
buffer_store_dword v253, v252, s[36:39], s100 offen
s_mov_b64 exec, -1
s_barrier
ds_read_b128 v[16:19], v3 offset:0
ds_read_b128 v[20:23], v3 offset:256
ds_read_b128 v[24:27], v3 offset:4096
ds_read_b128 v[28:31], v3 offset:4352
ds_read_b128 v[32:35], v5 offset:24576
ds_read_b128 v[36:39], v5 offset:25600
ds_read_b128 v[40:43], v5 offset:26624
ds_read_b128 v[44:47], v5 offset:27648
ds_read_b128 v[48:51], v5 offset:28672
ds_read_b128 v[52:55], v5 offset:29696
s_waitcnt lgkmcnt(0)
v_mfma_f32_16x16x32_bf16 v[96:99], v[32:35], v[16:19], 0
ds_read_b128 v[56:59], v3 offset:2048
v_mfma_f32_16x16x32_bf16 v[100:103], v[32:35], v[20:23], 0
ds_read_b128 v[60:63], v3 offset:2304
v_mfma_f32_16x16x32_bf16 v[104:107], v[32:35], v[24:27], 0
ds_read_b128 v[64:67], v3 offset:6144
v_mfma_f32_16x16x32_bf16 v[108:111], v[32:35], v[28:31], 0
ds_read_b128 v[68:71], v3 offset:6400
v_mfma_f32_16x16x32_bf16 v[112:115], v[36:39], v[16:19], 0
ds_read_b128 v[72:75], v5 offset:36864
v_mfma_f32_16x16x32_bf16 v[116:119], v[36:39], v[20:23], 0
ds_read_b128 v[76:79], v5 offset:37888
v_mfma_f32_16x16x32_bf16 v[120:123], v[36:39], v[24:27], 0
ds_read_b128 v[80:83], v5 offset:38912
v_mfma_f32_16x16x32_bf16 v[124:127], v[36:39], v[28:31], 0
ds_read_b128 v[84:87], v5 offset:39936
v_mfma_f32_16x16x32_bf16 v[128:131], v[40:43], v[16:19], 0
ds_read_b128 v[88:91], v5 offset:40960
v_mfma_f32_16x16x32_bf16 v[132:135], v[40:43], v[20:23], 0
ds_read_b128 v[92:95], v5 offset:41984
v_mfma_f32_16x16x32_bf16 v[136:139], v[40:43], v[24:27], 0
v_mfma_f32_16x16x32_bf16 v[140:143], v[40:43], v[28:31], 0
v_mfma_f32_16x16x32_bf16 v[144:147], v[44:47], v[16:19], 0
v_mfma_f32_16x16x32_bf16 v[148:151], v[44:47], v[20:23], 0
v_mfma_f32_16x16x32_bf16 v[152:155], v[44:47], v[24:27], 0
v_mfma_f32_16x16x32_bf16 v[156:159], v[44:47], v[28:31], 0
v_mfma_f32_16x16x32_bf16 v[160:163], v[48:51], v[16:19], 0
v_mfma_f32_16x16x32_bf16 v[164:167], v[48:51], v[20:23], 0
v_mfma_f32_16x16x32_bf16 v[168:171], v[48:51], v[24:27], 0
v_mfma_f32_16x16x32_bf16 v[172:175], v[48:51], v[28:31], 0
v_mfma_f32_16x16x32_bf16 v[176:179], v[52:55], v[16:19], 0
v_mfma_f32_16x16x32_bf16 v[180:183], v[52:55], v[20:23], 0
v_mfma_f32_16x16x32_bf16 v[184:187], v[52:55], v[24:27], 0
s_waitcnt lgkmcnt(0)
v_mfma_f32_16x16x32_bf16 v[188:191], v[52:55], v[28:31], 0
s_barrier
v_mfma_f32_16x16x32_bf16 v[96:99], v[72:75], v[56:59], v[96:99]
ds_read_b128 v[16:19], v3 offset:16384
v_mfma_f32_16x16x32_bf16 v[100:103], v[72:75], v[60:63], v[100:103]
ds_read_b128 v[20:23], v3 offset:16640
v_mfma_f32_16x16x32_bf16 v[104:107], v[72:75], v[64:67], v[104:107]
ds_read_b128 v[24:27], v3 offset:20480
v_mfma_f32_16x16x32_bf16 v[108:111], v[72:75], v[68:71], v[108:111]
ds_read_b128 v[28:31], v3 offset:20736
v_mfma_f32_16x16x32_bf16 v[112:115], v[76:79], v[56:59], v[112:115]
ds_read_b128 v[32:35], v5 offset:0
v_mfma_f32_16x16x32_bf16 v[116:119], v[76:79], v[60:63], v[116:119]
ds_read_b128 v[36:39], v5 offset:1024
v_mfma_f32_16x16x32_bf16 v[120:123], v[76:79], v[64:67], v[120:123]
ds_read_b128 v[40:43], v5 offset:2048
v_mfma_f32_16x16x32_bf16 v[124:127], v[76:79], v[68:71], v[124:127]
ds_read_b128 v[44:47], v5 offset:3072
v_mfma_f32_16x16x32_bf16 v[128:131], v[80:83], v[56:59], v[128:131]
ds_read_b128 v[48:51], v5 offset:4096
v_mfma_f32_16x16x32_bf16 v[132:135], v[80:83], v[60:63], v[132:135]
ds_read_b128 v[52:55], v5 offset:5120
v_mfma_f32_16x16x32_bf16 v[136:139], v[80:83], v[64:67], v[136:139]
v_mfma_f32_16x16x32_bf16 v[140:143], v[80:83], v[68:71], v[140:143]
buffer_load_dwordx4 v[192:195], v7, s[36:39], s73 offen offset:0 sc1
v_mfma_f32_16x16x32_bf16 v[144:147], v[84:87], v[56:59], v[144:147]
v_mfma_f32_16x16x32_bf16 v[148:151], v[84:87], v[60:63], v[148:151]
buffer_load_dwordx4 v[196:199], v7, s[36:39], s73 offen offset:64 sc1
v_mfma_f32_16x16x32_bf16 v[152:155], v[84:87], v[64:67], v[152:155]
v_mfma_f32_16x16x32_bf16 v[156:159], v[84:87], v[68:71], v[156:159]
buffer_load_dwordx4 v[200:203], v7, s[36:39], s73 offen offset:128 sc1
v_mfma_f32_16x16x32_bf16 v[160:163], v[88:91], v[56:59], v[160:163]
v_mfma_f32_16x16x32_bf16 v[164:167], v[88:91], v[60:63], v[164:167]
buffer_load_dwordx4 v[204:207], v7, s[36:39], s73 offen offset:192 sc1
v_mfma_f32_16x16x32_bf16 v[168:171], v[88:91], v[64:67], v[168:171]
v_mfma_f32_16x16x32_bf16 v[172:175], v[88:91], v[68:71], v[172:175]
buffer_load_dwordx4 v[208:211], v7, s[36:39], s73 offen offset:256 sc1
v_mfma_f32_16x16x32_bf16 v[176:179], v[92:95], v[56:59], v[176:179]
v_mfma_f32_16x16x32_bf16 v[180:183], v[92:95], v[60:63], v[180:183]
buffer_load_dwordx4 v[212:215], v7, s[36:39], s73 offen offset:320 sc1
v_mfma_f32_16x16x32_bf16 v[184:187], v[92:95], v[64:67], v[184:187]
v_mfma_f32_16x16x32_bf16 v[188:191], v[92:95], v[68:71], v[188:191]
s_waitcnt lgkmcnt(0)
v_mfma_f32_16x16x32_bf16 v[96:99], v[32:35], v[16:19], v[96:99]
ds_read_b128 v[56:59], v3 offset:18432
v_mfma_f32_16x16x32_bf16 v[100:103], v[32:35], v[20:23], v[100:103]
ds_read_b128 v[60:63], v3 offset:18688
v_mfma_f32_16x16x32_bf16 v[104:107], v[32:35], v[24:27], v[104:107]
ds_read_b128 v[64:67], v3 offset:22528
v_mfma_f32_16x16x32_bf16 v[108:111], v[32:35], v[28:31], v[108:111]
ds_read_b128 v[68:71], v3 offset:22784
v_mfma_f32_16x16x32_bf16 v[112:115], v[36:39], v[16:19], v[112:115]
ds_read_b128 v[72:75], v5 offset:12288
v_mfma_f32_16x16x32_bf16 v[116:119], v[36:39], v[20:23], v[116:119]
ds_read_b128 v[76:79], v5 offset:13312
v_mfma_f32_16x16x32_bf16 v[120:123], v[36:39], v[24:27], v[120:123]
ds_read_b128 v[80:83], v5 offset:14336
v_mfma_f32_16x16x32_bf16 v[124:127], v[36:39], v[28:31], v[124:127]
ds_read_b128 v[84:87], v5 offset:15360
v_mfma_f32_16x16x32_bf16 v[128:131], v[40:43], v[16:19], v[128:131]
ds_read_b128 v[88:91], v5 offset:16384
v_mfma_f32_16x16x32_bf16 v[132:135], v[40:43], v[20:23], v[132:135]
ds_read_b128 v[92:95], v5 offset:17408
v_mfma_f32_16x16x32_bf16 v[136:139], v[40:43], v[24:27], v[136:139]
v_mfma_f32_16x16x32_bf16 v[140:143], v[40:43], v[28:31], v[140:143]
v_mfma_f32_16x16x32_bf16 v[144:147], v[44:47], v[16:19], v[144:147]
v_mfma_f32_16x16x32_bf16 v[148:151], v[44:47], v[20:23], v[148:151]
v_mfma_f32_16x16x32_bf16 v[152:155], v[44:47], v[24:27], v[152:155]
v_mfma_f32_16x16x32_bf16 v[156:159], v[44:47], v[28:31], v[156:159]
v_mfma_f32_16x16x32_bf16 v[160:163], v[48:51], v[16:19], v[160:163]
v_mfma_f32_16x16x32_bf16 v[164:167], v[48:51], v[20:23], v[164:167]
v_mfma_f32_16x16x32_bf16 v[168:171], v[48:51], v[24:27], v[168:171]
v_mfma_f32_16x16x32_bf16 v[172:175], v[48:51], v[28:31], v[172:175]
v_mfma_f32_16x16x32_bf16 v[176:179], v[52:55], v[16:19], v[176:179]
v_mfma_f32_16x16x32_bf16 v[180:183], v[52:55], v[20:23], v[180:183]
v_mfma_f32_16x16x32_bf16 v[184:187], v[52:55], v[24:27], v[184:187]
s_waitcnt lgkmcnt(0)
v_mfma_f32_16x16x32_bf16 v[188:191], v[52:55], v[28:31], v[188:191]
s_barrier
v_mfma_f32_16x16x32_bf16 v[96:99], v[72:75], v[56:59], v[96:99]
ds_read_b128 v[16:19], v3 offset:32768
v_mfma_f32_16x16x32_bf16 v[100:103], v[72:75], v[60:63], v[100:103]
ds_read_b128 v[20:23], v3 offset:33024
v_mfma_f32_16x16x32_bf16 v[104:107], v[72:75], v[64:67], v[104:107]
ds_read_b128 v[24:27], v3 offset:36864
v_mfma_f32_16x16x32_bf16 v[108:111], v[72:75], v[68:71], v[108:111]
ds_read_b128 v[28:31], v3 offset:37120
v_mfma_f32_16x16x32_bf16 v[112:115], v[76:79], v[56:59], v[112:115]
ds_read_b128 v[32:35], v4 offset:24576
v_mfma_f32_16x16x32_bf16 v[116:119], v[76:79], v[60:63], v[116:119]
ds_read_b128 v[36:39], v4 offset:25600
v_mfma_f32_16x16x32_bf16 v[120:123], v[76:79], v[64:67], v[120:123]
ds_read_b128 v[40:43], v4 offset:26624
v_mfma_f32_16x16x32_bf16 v[124:127], v[76:79], v[68:71], v[124:127]
ds_read_b128 v[44:47], v4 offset:27648
v_mfma_f32_16x16x32_bf16 v[128:131], v[80:83], v[56:59], v[128:131]
ds_read_b128 v[48:51], v4 offset:28672
v_mfma_f32_16x16x32_bf16 v[132:135], v[80:83], v[60:63], v[132:135]
ds_read_b128 v[52:55], v4 offset:29696
v_mfma_f32_16x16x32_bf16 v[136:139], v[80:83], v[64:67], v[136:139]
v_mfma_f32_16x16x32_bf16 v[140:143], v[80:83], v[68:71], v[140:143]
v_mfma_f32_16x16x32_bf16 v[144:147], v[84:87], v[56:59], v[144:147]
buffer_load_dwordx4 v[216:219], v11, s[36:39], s65 offen offset:0 sc1
v_mfma_f32_16x16x32_bf16 v[148:151], v[84:87], v[60:63], v[148:151]
v_mfma_f32_16x16x32_bf16 v[152:155], v[84:87], v[64:67], v[152:155]
v_mfma_f32_16x16x32_bf16 v[156:159], v[84:87], v[68:71], v[156:159]
buffer_load_dwordx4 v[220:223], v11, s[36:39], s65 offen offset:1024 sc1
v_mfma_f32_16x16x32_bf16 v[160:163], v[88:91], v[56:59], v[160:163]
v_mfma_f32_16x16x32_bf16 v[164:167], v[88:91], v[60:63], v[164:167]
v_mfma_f32_16x16x32_bf16 v[168:171], v[88:91], v[64:67], v[168:171]
buffer_load_dwordx4 v[224:227], v11, s[36:39], s65 offen offset:2048 sc1
v_mfma_f32_16x16x32_bf16 v[172:175], v[88:91], v[68:71], v[172:175]
v_mfma_f32_16x16x32_bf16 v[176:179], v[92:95], v[56:59], v[176:179]
v_mfma_f32_16x16x32_bf16 v[180:183], v[92:95], v[60:63], v[180:183]
buffer_load_dwordx4 v[228:231], v11, s[36:39], s65 offen offset:3072 sc1
v_mfma_f32_16x16x32_bf16 v[184:187], v[92:95], v[64:67], v[184:187]
v_mfma_f32_16x16x32_bf16 v[188:191], v[92:95], v[68:71], v[188:191]
s_waitcnt lgkmcnt(0)
v_mfma_f32_16x16x32_bf16 v[96:99], v[32:35], v[16:19], v[96:99]
ds_read_b128 v[56:59], v3 offset:34816
v_mfma_f32_16x16x32_bf16 v[100:103], v[32:35], v[20:23], v[100:103]
ds_read_b128 v[60:63], v3 offset:35072
v_mfma_f32_16x16x32_bf16 v[104:107], v[32:35], v[24:27], v[104:107]
ds_read_b128 v[64:67], v3 offset:38912
v_mfma_f32_16x16x32_bf16 v[108:111], v[32:35], v[28:31], v[108:111]
ds_read_b128 v[68:71], v3 offset:39168
v_mfma_f32_16x16x32_bf16 v[112:115], v[36:39], v[16:19], v[112:115]
ds_read_b128 v[72:75], v4 offset:36864
v_mfma_f32_16x16x32_bf16 v[116:119], v[36:39], v[20:23], v[116:119]
ds_read_b128 v[76:79], v4 offset:37888
v_mfma_f32_16x16x32_bf16 v[120:123], v[36:39], v[24:27], v[120:123]
ds_read_b128 v[80:83], v4 offset:38912
v_mfma_f32_16x16x32_bf16 v[124:127], v[36:39], v[28:31], v[124:127]
ds_read_b128 v[84:87], v4 offset:39936
v_mfma_f32_16x16x32_bf16 v[128:131], v[40:43], v[16:19], v[128:131]
ds_read_b128 v[88:91], v4 offset:40960
v_mfma_f32_16x16x32_bf16 v[132:135], v[40:43], v[20:23], v[132:135]
ds_read_b128 v[92:95], v4 offset:41984
v_mfma_f32_16x16x32_bf16 v[136:139], v[40:43], v[24:27], v[136:139]
v_mfma_f32_16x16x32_bf16 v[140:143], v[40:43], v[28:31], v[140:143]
v_mfma_f32_16x16x32_bf16 v[144:147], v[44:47], v[16:19], v[144:147]
v_mfma_f32_16x16x32_bf16 v[148:151], v[44:47], v[20:23], v[148:151]
v_mfma_f32_16x16x32_bf16 v[152:155], v[44:47], v[24:27], v[152:155]
v_mfma_f32_16x16x32_bf16 v[156:159], v[44:47], v[28:31], v[156:159]
v_mfma_f32_16x16x32_bf16 v[160:163], v[48:51], v[16:19], v[160:163]
v_mfma_f32_16x16x32_bf16 v[164:167], v[48:51], v[20:23], v[164:167]
v_mfma_f32_16x16x32_bf16 v[168:171], v[48:51], v[24:27], v[168:171]
v_mfma_f32_16x16x32_bf16 v[172:175], v[48:51], v[28:31], v[172:175]
v_mfma_f32_16x16x32_bf16 v[176:179], v[52:55], v[16:19], v[176:179]
v_mfma_f32_16x16x32_bf16 v[180:183], v[52:55], v[20:23], v[180:183]
v_mfma_f32_16x16x32_bf16 v[184:187], v[52:55], v[24:27], v[184:187]
s_waitcnt lgkmcnt(0)
v_mfma_f32_16x16x32_bf16 v[188:191], v[52:55], v[28:31], v[188:191]
s_barrier
v_mfma_f32_16x16x32_bf16 v[96:99], v[72:75], v[56:59], v[96:99]
ds_read_b128 v[16:19], v3 offset:49152
v_mfma_f32_16x16x32_bf16 v[100:103], v[72:75], v[60:63], v[100:103]
ds_read_b128 v[20:23], v3 offset:49408
v_mfma_f32_16x16x32_bf16 v[104:107], v[72:75], v[64:67], v[104:107]
ds_read_b128 v[24:27], v3 offset:53248
v_mfma_f32_16x16x32_bf16 v[108:111], v[72:75], v[68:71], v[108:111]
ds_read_b128 v[28:31], v3 offset:53504
v_mfma_f32_16x16x32_bf16 v[112:115], v[76:79], v[56:59], v[112:115]
ds_read_b128 v[32:35], v4 offset:0
v_mfma_f32_16x16x32_bf16 v[116:119], v[76:79], v[60:63], v[116:119]
ds_read_b128 v[36:39], v4 offset:1024
v_mfma_f32_16x16x32_bf16 v[120:123], v[76:79], v[64:67], v[120:123]
ds_read_b128 v[40:43], v4 offset:2048
v_mfma_f32_16x16x32_bf16 v[124:127], v[76:79], v[68:71], v[124:127]
ds_read_b128 v[44:47], v4 offset:3072
v_mfma_f32_16x16x32_bf16 v[128:131], v[80:83], v[56:59], v[128:131]
ds_read_b128 v[48:51], v4 offset:4096
v_mfma_f32_16x16x32_bf16 v[132:135], v[80:83], v[60:63], v[132:135]
ds_read_b128 v[52:55], v4 offset:5120
v_mfma_f32_16x16x32_bf16 v[136:139], v[80:83], v[64:67], v[136:139]
s_waitcnt vmcnt(0)
v_mfma_f32_16x16x32_bf16 v[140:143], v[80:83], v[68:71], v[140:143]
v_add_f32 v216, v216, v218
v_mfma_f32_16x16x32_bf16 v[144:147], v[84:87], v[56:59], v[144:147]
v_add_f32 v216, v216, v220
v_mfma_f32_16x16x32_bf16 v[148:151], v[84:87], v[60:63], v[148:151]
v_add_f32 v216, v216, v222
v_mfma_f32_16x16x32_bf16 v[152:155], v[84:87], v[64:67], v[152:155]
v_add_f32 v216, v216, v224
v_mfma_f32_16x16x32_bf16 v[156:159], v[84:87], v[68:71], v[156:159]
v_add_f32 v216, v216, v226
v_mfma_f32_16x16x32_bf16 v[160:163], v[88:91], v[56:59], v[160:163]
v_add_f32 v216, v216, v228
v_mfma_f32_16x16x32_bf16 v[164:167], v[88:91], v[60:63], v[164:167]
v_add_f32 v216, v216, v230
v_mfma_f32_16x16x32_bf16 v[168:171], v[88:91], v[64:67], v[168:171]
v_mul_f32 v232, 0xbacccccd, v216
v_mfma_f32_16x16x32_bf16 v[172:175], v[88:91], v[68:71], v[172:175]
v_mul_f32 v233, 0xbacccccd, v216
v_mfma_f32_16x16x32_bf16 v[176:179], v[92:95], v[56:59], v[176:179]
s_nop 0
v_mfma_f32_16x16x32_bf16 v[180:183], v[92:95], v[60:63], v[180:183]
v_permlane16_swap_b32 v232, v233
v_mfma_f32_16x16x32_bf16 v[184:187], v[92:95], v[64:67], v[184:187]
v_mov_b32 v234, v232
v_mfma_f32_16x16x32_bf16 v[188:191], v[92:95], v[68:71], v[188:191]
s_waitcnt lgkmcnt(0)
v_mfma_f32_16x16x32_bf16 v[96:99], v[32:35], v[16:19], v[96:99]
ds_read_b128 v[56:59], v3 offset:51200
v_mfma_f32_16x16x32_bf16 v[100:103], v[32:35], v[20:23], v[100:103]
ds_read_b128 v[60:63], v3 offset:51456
v_mfma_f32_16x16x32_bf16 v[104:107], v[32:35], v[24:27], v[104:107]
ds_read_b128 v[64:67], v3 offset:55296
v_mfma_f32_16x16x32_bf16 v[108:111], v[32:35], v[28:31], v[108:111]
ds_read_b128 v[68:71], v3 offset:55552
v_mfma_f32_16x16x32_bf16 v[112:115], v[36:39], v[16:19], v[112:115]
ds_read_b128 v[72:75], v4 offset:12288
v_mfma_f32_16x16x32_bf16 v[116:119], v[36:39], v[20:23], v[116:119]
ds_read_b128 v[76:79], v4 offset:13312
v_mfma_f32_16x16x32_bf16 v[120:123], v[36:39], v[24:27], v[120:123]
ds_read_b128 v[80:83], v4 offset:14336
v_mfma_f32_16x16x32_bf16 v[124:127], v[36:39], v[28:31], v[124:127]
ds_read_b128 v[84:87], v4 offset:15360
v_mfma_f32_16x16x32_bf16 v[128:131], v[40:43], v[16:19], v[128:131]
ds_read_b128 v[88:91], v4 offset:16384
v_mfma_f32_16x16x32_bf16 v[132:135], v[40:43], v[20:23], v[132:135]
ds_read_b128 v[92:95], v4 offset:17408
v_mfma_f32_16x16x32_bf16 v[136:139], v[40:43], v[24:27], v[136:139]
v_mov_b32 v235, v233
v_mfma_f32_16x16x32_bf16 v[140:143], v[40:43], v[28:31], v[140:143]
s_nop 0
v_mfma_f32_16x16x32_bf16 v[144:147], v[44:47], v[16:19], v[144:147]
v_permlane32_swap_b32 v232, v234
v_mfma_f32_16x16x32_bf16 v[148:151], v[44:47], v[20:23], v[148:151]
v_permlane32_swap_b32 v233, v235
v_mfma_f32_16x16x32_bf16 v[152:155], v[44:47], v[24:27], v[152:155]
v_mfma_f32_16x16x32_bf16 v[156:159], v[44:47], v[28:31], v[156:159]
v_mfma_f32_16x16x32_bf16 v[160:163], v[48:51], v[16:19], v[160:163]
v_mfma_f32_16x16x32_bf16 v[164:167], v[48:51], v[20:23], v[164:167]
v_mfma_f32_16x16x32_bf16 v[168:171], v[48:51], v[24:27], v[168:171]
v_mfma_f32_16x16x32_bf16 v[172:175], v[48:51], v[28:31], v[172:175]
v_mfma_f32_16x16x32_bf16 v[176:179], v[52:55], v[16:19], v[176:179]
v_mfma_f32_16x16x32_bf16 v[180:183], v[52:55], v[20:23], v[180:183]
v_mfma_f32_16x16x32_bf16 v[184:187], v[52:55], v[24:27], v[184:187]
s_waitcnt lgkmcnt(0)
v_mfma_f32_16x16x32_bf16 v[188:191], v[52:55], v[28:31], v[188:191]
s_barrier
v_mfma_f32_16x16x32_bf16 v[96:99], v[72:75], v[56:59], v[96:99]
ds_read_b128 v[16:19], v3 offset:0
v_mfma_f32_16x16x32_bf16 v[100:103], v[72:75], v[60:63], v[100:103]
ds_read_b128 v[20:23], v3 offset:256
v_mfma_f32_16x16x32_bf16 v[104:107], v[72:75], v[64:67], v[104:107]
ds_read_b128 v[24:27], v3 offset:4096
v_mfma_f32_16x16x32_bf16 v[108:111], v[72:75], v[68:71], v[108:111]
ds_read_b128 v[28:31], v3 offset:4352
v_mfma_f32_16x16x32_bf16 v[112:115], v[76:79], v[56:59], v[112:115]
ds_read_b128 v[32:35], v5 offset:24576
v_mfma_f32_16x16x32_bf16 v[116:119], v[76:79], v[60:63], v[116:119]
ds_read_b128 v[36:39], v5 offset:25600
v_mfma_f32_16x16x32_bf16 v[120:123], v[76:79], v[64:67], v[120:123]
ds_read_b128 v[40:43], v5 offset:26624
v_mfma_f32_16x16x32_bf16 v[124:127], v[76:79], v[68:71], v[124:127]
ds_read_b128 v[44:47], v5 offset:27648
v_mfma_f32_16x16x32_bf16 v[128:131], v[80:83], v[56:59], v[128:131]
ds_read_b128 v[48:51], v5 offset:28672
v_mfma_f32_16x16x32_bf16 v[132:135], v[80:83], v[60:63], v[132:135]
ds_read_b128 v[52:55], v5 offset:29696
v_mfma_f32_16x16x32_bf16 v[136:139], v[80:83], v[64:67], v[136:139]
v_fmac_f32 v148, v233, v204
v_mfma_f32_16x16x32_bf16 v[140:143], v[80:83], v[68:71], v[140:143]
v_fmac_f32 v152, v234, v204
v_mfma_f32_16x16x32_bf16 v[144:147], v[84:87], v[56:59], v[144:147]
v_fmac_f32 v156, v235, v204
v_mfma_f32_16x16x32_bf16 v[148:151], v[84:87], v[60:63], v[148:151]
v_fmac_f32 v160, v232, v208
v_mfma_f32_16x16x32_bf16 v[152:155], v[84:87], v[64:67], v[152:155]
v_fmac_f32 v164, v233, v208
v_mfma_f32_16x16x32_bf16 v[156:159], v[84:87], v[68:71], v[156:159]
v_fmac_f32 v168, v234, v208
v_mfma_f32_16x16x32_bf16 v[160:163], v[88:91], v[56:59], v[160:163]
v_fmac_f32 v172, v235, v208
v_mfma_f32_16x16x32_bf16 v[164:167], v[88:91], v[60:63], v[164:167]
v_fmac_f32 v176, v232, v212
v_mfma_f32_16x16x32_bf16 v[168:171], v[88:91], v[64:67], v[168:171]
v_fmac_f32 v180, v233, v212
v_mfma_f32_16x16x32_bf16 v[172:175], v[88:91], v[68:71], v[172:175]
v_fmac_f32 v184, v234, v212
v_mfma_f32_16x16x32_bf16 v[176:179], v[92:95], v[56:59], v[176:179]
v_fmac_f32 v188, v235, v212
v_mfma_f32_16x16x32_bf16 v[180:183], v[92:95], v[60:63], v[180:183]
v_fmac_f32 v96, v232, v192
v_mfma_f32_16x16x32_bf16 v[184:187], v[92:95], v[64:67], v[184:187]
v_fmac_f32 v100, v233, v192
v_mfma_f32_16x16x32_bf16 v[188:191], v[92:95], v[68:71], v[188:191]
s_waitcnt lgkmcnt(0)
v_mfma_f32_16x16x32_bf16 v[96:99], v[32:35], v[16:19], v[96:99]
ds_read_b128 v[56:59], v3 offset:2048
v_mfma_f32_16x16x32_bf16 v[100:103], v[32:35], v[20:23], v[100:103]
ds_read_b128 v[60:63], v3 offset:2304
v_mfma_f32_16x16x32_bf16 v[104:107], v[32:35], v[24:27], v[104:107]
ds_read_b128 v[64:67], v3 offset:6144
v_mfma_f32_16x16x32_bf16 v[108:111], v[32:35], v[28:31], v[108:111]
ds_read_b128 v[68:71], v3 offset:6400
v_mfma_f32_16x16x32_bf16 v[112:115], v[36:39], v[16:19], v[112:115]
ds_read_b128 v[72:75], v5 offset:36864
v_mfma_f32_16x16x32_bf16 v[116:119], v[36:39], v[20:23], v[116:119]
ds_read_b128 v[76:79], v5 offset:37888
v_mfma_f32_16x16x32_bf16 v[120:123], v[36:39], v[24:27], v[120:123]
ds_read_b128 v[80:83], v5 offset:38912
v_mfma_f32_16x16x32_bf16 v[124:127], v[36:39], v[28:31], v[124:127]
ds_read_b128 v[84:87], v5 offset:39936
v_mfma_f32_16x16x32_bf16 v[128:131], v[40:43], v[16:19], v[128:131]
ds_read_b128 v[88:91], v5 offset:40960
v_mfma_f32_16x16x32_bf16 v[132:135], v[40:43], v[20:23], v[132:135]
ds_read_b128 v[92:95], v5 offset:41984
v_mfma_f32_16x16x32_bf16 v[136:139], v[40:43], v[24:27], v[136:139]
v_fmac_f32 v104, v234, v192
v_mfma_f32_16x16x32_bf16 v[140:143], v[40:43], v[28:31], v[140:143]
v_fmac_f32 v108, v235, v192
v_mfma_f32_16x16x32_bf16 v[144:147], v[44:47], v[16:19], v[144:147]
v_fmac_f32 v112, v232, v196
v_mfma_f32_16x16x32_bf16 v[148:151], v[44:47], v[20:23], v[148:151]
v_fmac_f32 v116, v233, v196
v_mfma_f32_16x16x32_bf16 v[152:155], v[44:47], v[24:27], v[152:155]
v_fmac_f32 v120, v234, v196
v_mfma_f32_16x16x32_bf16 v[156:159], v[44:47], v[28:31], v[156:159]
v_fmac_f32 v124, v235, v196
v_mfma_f32_16x16x32_bf16 v[160:163], v[48:51], v[16:19], v[160:163]
v_fmac_f32 v128, v232, v200
v_mfma_f32_16x16x32_bf16 v[164:167], v[48:51], v[20:23], v[164:167]
v_fmac_f32 v132, v233, v200
v_mfma_f32_16x16x32_bf16 v[168:171], v[48:51], v[24:27], v[168:171]
v_fmac_f32 v136, v234, v200
v_mfma_f32_16x16x32_bf16 v[172:175], v[48:51], v[28:31], v[172:175]
v_fmac_f32 v140, v235, v200
v_mfma_f32_16x16x32_bf16 v[176:179], v[52:55], v[16:19], v[176:179]
v_fmac_f32 v144, v232, v204
v_mfma_f32_16x16x32_bf16 v[180:183], v[52:55], v[20:23], v[180:183]
v_fmac_f32 v97, v232, v193
v_mfma_f32_16x16x32_bf16 v[184:187], v[52:55], v[24:27], v[184:187]
s_waitcnt lgkmcnt(0)
v_mfma_f32_16x16x32_bf16 v[188:191], v[52:55], v[28:31], v[188:191]
s_barrier
v_mfma_f32_16x16x32_bf16 v[96:99], v[72:75], v[56:59], v[96:99]
ds_read_b128 v[16:19], v3 offset:16384
v_mfma_f32_16x16x32_bf16 v[100:103], v[72:75], v[60:63], v[100:103]
ds_read_b128 v[20:23], v3 offset:16640
v_mfma_f32_16x16x32_bf16 v[104:107], v[72:75], v[64:67], v[104:107]
ds_read_b128 v[24:27], v3 offset:20480
v_mfma_f32_16x16x32_bf16 v[108:111], v[72:75], v[68:71], v[108:111]
ds_read_b128 v[28:31], v3 offset:20736
v_mfma_f32_16x16x32_bf16 v[112:115], v[76:79], v[56:59], v[112:115]
ds_read_b128 v[32:35], v5 offset:0
v_mfma_f32_16x16x32_bf16 v[116:119], v[76:79], v[60:63], v[116:119]
ds_read_b128 v[36:39], v5 offset:1024
v_mfma_f32_16x16x32_bf16 v[120:123], v[76:79], v[64:67], v[120:123]
ds_read_b128 v[40:43], v5 offset:2048
v_mfma_f32_16x16x32_bf16 v[124:127], v[76:79], v[68:71], v[124:127]
ds_read_b128 v[44:47], v5 offset:3072
v_mfma_f32_16x16x32_bf16 v[128:131], v[80:83], v[56:59], v[128:131]
ds_read_b128 v[48:51], v5 offset:4096
v_mfma_f32_16x16x32_bf16 v[132:135], v[80:83], v[60:63], v[132:135]
ds_read_b128 v[52:55], v5 offset:5120
v_mfma_f32_16x16x32_bf16 v[136:139], v[80:83], v[64:67], v[136:139]
v_fmac_f32 v149, v233, v205
v_mfma_f32_16x16x32_bf16 v[140:143], v[80:83], v[68:71], v[140:143]
v_fmac_f32 v153, v234, v205
v_mfma_f32_16x16x32_bf16 v[144:147], v[84:87], v[56:59], v[144:147]
v_fmac_f32 v157, v235, v205
v_mfma_f32_16x16x32_bf16 v[148:151], v[84:87], v[60:63], v[148:151]
v_fmac_f32 v161, v232, v209
v_mfma_f32_16x16x32_bf16 v[152:155], v[84:87], v[64:67], v[152:155]
v_fmac_f32 v165, v233, v209
v_mfma_f32_16x16x32_bf16 v[156:159], v[84:87], v[68:71], v[156:159]
v_fmac_f32 v169, v234, v209
v_mfma_f32_16x16x32_bf16 v[160:163], v[88:91], v[56:59], v[160:163]
v_fmac_f32 v173, v235, v209
v_mfma_f32_16x16x32_bf16 v[164:167], v[88:91], v[60:63], v[164:167]
v_fmac_f32 v177, v232, v213
v_mfma_f32_16x16x32_bf16 v[168:171], v[88:91], v[64:67], v[168:171]
v_fmac_f32 v181, v233, v213
v_mfma_f32_16x16x32_bf16 v[172:175], v[88:91], v[68:71], v[172:175]
v_fmac_f32 v185, v234, v213
v_mfma_f32_16x16x32_bf16 v[176:179], v[92:95], v[56:59], v[176:179]
v_fmac_f32 v189, v235, v213
v_mfma_f32_16x16x32_bf16 v[180:183], v[92:95], v[60:63], v[180:183]
v_fmac_f32 v101, v233, v193
v_mfma_f32_16x16x32_bf16 v[184:187], v[92:95], v[64:67], v[184:187]
v_fmac_f32 v105, v234, v193
v_mfma_f32_16x16x32_bf16 v[188:191], v[92:95], v[68:71], v[188:191]
s_waitcnt lgkmcnt(0)
v_mfma_f32_16x16x32_bf16 v[96:99], v[32:35], v[16:19], v[96:99]
ds_read_b128 v[56:59], v3 offset:18432
v_mfma_f32_16x16x32_bf16 v[100:103], v[32:35], v[20:23], v[100:103]
ds_read_b128 v[60:63], v3 offset:18688
v_mfma_f32_16x16x32_bf16 v[104:107], v[32:35], v[24:27], v[104:107]
ds_read_b128 v[64:67], v3 offset:22528
v_mfma_f32_16x16x32_bf16 v[108:111], v[32:35], v[28:31], v[108:111]
ds_read_b128 v[68:71], v3 offset:22784
v_mfma_f32_16x16x32_bf16 v[112:115], v[36:39], v[16:19], v[112:115]
ds_read_b128 v[72:75], v5 offset:12288
v_mfma_f32_16x16x32_bf16 v[116:119], v[36:39], v[20:23], v[116:119]
ds_read_b128 v[76:79], v5 offset:13312
v_mfma_f32_16x16x32_bf16 v[120:123], v[36:39], v[24:27], v[120:123]
ds_read_b128 v[80:83], v5 offset:14336
v_mfma_f32_16x16x32_bf16 v[124:127], v[36:39], v[28:31], v[124:127]
ds_read_b128 v[84:87], v5 offset:15360
v_mfma_f32_16x16x32_bf16 v[128:131], v[40:43], v[16:19], v[128:131]
ds_read_b128 v[88:91], v5 offset:16384
v_mfma_f32_16x16x32_bf16 v[132:135], v[40:43], v[20:23], v[132:135]
ds_read_b128 v[92:95], v5 offset:17408
v_mfma_f32_16x16x32_bf16 v[136:139], v[40:43], v[24:27], v[136:139]
v_fmac_f32 v109, v235, v193
v_mfma_f32_16x16x32_bf16 v[140:143], v[40:43], v[28:31], v[140:143]
v_fmac_f32 v113, v232, v197
v_mfma_f32_16x16x32_bf16 v[144:147], v[44:47], v[16:19], v[144:147]
v_fmac_f32 v117, v233, v197
v_mfma_f32_16x16x32_bf16 v[148:151], v[44:47], v[20:23], v[148:151]
v_fmac_f32 v121, v234, v197
v_mfma_f32_16x16x32_bf16 v[152:155], v[44:47], v[24:27], v[152:155]
v_fmac_f32 v125, v235, v197
v_mfma_f32_16x16x32_bf16 v[156:159], v[44:47], v[28:31], v[156:159]
v_fmac_f32 v129, v232, v201
v_mfma_f32_16x16x32_bf16 v[160:163], v[48:51], v[16:19], v[160:163]
v_fmac_f32 v133, v233, v201
v_mfma_f32_16x16x32_bf16 v[164:167], v[48:51], v[20:23], v[164:167]
v_fmac_f32 v137, v234, v201
v_mfma_f32_16x16x32_bf16 v[168:171], v[48:51], v[24:27], v[168:171]
v_fmac_f32 v141, v235, v201
v_mfma_f32_16x16x32_bf16 v[172:175], v[48:51], v[28:31], v[172:175]
v_fmac_f32 v145, v232, v205
v_mfma_f32_16x16x32_bf16 v[176:179], v[52:55], v[16:19], v[176:179]
v_fmac_f32 v190, v235, v214
v_mfma_f32_16x16x32_bf16 v[180:183], v[52:55], v[20:23], v[180:183]
v_fmac_f32 v98, v232, v194
v_mfma_f32_16x16x32_bf16 v[184:187], v[52:55], v[24:27], v[184:187]
s_waitcnt lgkmcnt(0)
v_mfma_f32_16x16x32_bf16 v[188:191], v[52:55], v[28:31], v[188:191]
s_barrier
v_mfma_f32_16x16x32_bf16 v[96:99], v[72:75], v[56:59], v[96:99]
ds_read_b128 v[16:19], v3 offset:32768
v_mfma_f32_16x16x32_bf16 v[100:103], v[72:75], v[60:63], v[100:103]
ds_read_b128 v[20:23], v3 offset:33024
v_mfma_f32_16x16x32_bf16 v[104:107], v[72:75], v[64:67], v[104:107]
ds_read_b128 v[24:27], v3 offset:36864
v_mfma_f32_16x16x32_bf16 v[108:111], v[72:75], v[68:71], v[108:111]
ds_read_b128 v[28:31], v3 offset:37120
v_mfma_f32_16x16x32_bf16 v[112:115], v[76:79], v[56:59], v[112:115]
ds_read_b128 v[32:35], v4 offset:24576
v_mfma_f32_16x16x32_bf16 v[116:119], v[76:79], v[60:63], v[116:119]
ds_read_b128 v[36:39], v4 offset:25600
v_mfma_f32_16x16x32_bf16 v[120:123], v[76:79], v[64:67], v[120:123]
ds_read_b128 v[40:43], v4 offset:26624
v_mfma_f32_16x16x32_bf16 v[124:127], v[76:79], v[68:71], v[124:127]
ds_read_b128 v[44:47], v4 offset:27648
v_mfma_f32_16x16x32_bf16 v[128:131], v[80:83], v[56:59], v[128:131]
ds_read_b128 v[48:51], v4 offset:28672
v_mfma_f32_16x16x32_bf16 v[132:135], v[80:83], v[60:63], v[132:135]
ds_read_b128 v[52:55], v4 offset:29696
v_mfma_f32_16x16x32_bf16 v[136:139], v[80:83], v[64:67], v[136:139]
v_fmac_f32 v150, v233, v206
v_mfma_f32_16x16x32_bf16 v[140:143], v[80:83], v[68:71], v[140:143]
v_fmac_f32 v154, v234, v206
v_mfma_f32_16x16x32_bf16 v[144:147], v[84:87], v[56:59], v[144:147]
v_fmac_f32 v158, v235, v206
v_mfma_f32_16x16x32_bf16 v[148:151], v[84:87], v[60:63], v[148:151]
v_fmac_f32 v162, v232, v210
v_mfma_f32_16x16x32_bf16 v[152:155], v[84:87], v[64:67], v[152:155]
v_fmac_f32 v166, v233, v210
v_mfma_f32_16x16x32_bf16 v[156:159], v[84:87], v[68:71], v[156:159]
v_fmac_f32 v170, v234, v210
v_mfma_f32_16x16x32_bf16 v[160:163], v[88:91], v[56:59], v[160:163]
v_fmac_f32 v174, v235, v210
v_mfma_f32_16x16x32_bf16 v[164:167], v[88:91], v[60:63], v[164:167]
v_fmac_f32 v178, v232, v214
v_mfma_f32_16x16x32_bf16 v[168:171], v[88:91], v[64:67], v[168:171]
v_fmac_f32 v182, v233, v214
v_mfma_f32_16x16x32_bf16 v[172:175], v[88:91], v[68:71], v[172:175]
v_fmac_f32 v186, v234, v214
v_mfma_f32_16x16x32_bf16 v[176:179], v[92:95], v[56:59], v[176:179]
v_fmac_f32 v102, v233, v194
v_mfma_f32_16x16x32_bf16 v[180:183], v[92:95], v[60:63], v[180:183]
v_fmac_f32 v106, v234, v194
v_mfma_f32_16x16x32_bf16 v[184:187], v[92:95], v[64:67], v[184:187]
v_fmac_f32 v110, v235, v194
v_mfma_f32_16x16x32_bf16 v[188:191], v[92:95], v[68:71], v[188:191]
s_waitcnt lgkmcnt(0)
v_mfma_f32_16x16x32_bf16 v[96:99], v[32:35], v[16:19], v[96:99]
ds_read_b128 v[56:59], v3 offset:34816
v_mfma_f32_16x16x32_bf16 v[100:103], v[32:35], v[20:23], v[100:103]
ds_read_b128 v[60:63], v3 offset:35072
v_mfma_f32_16x16x32_bf16 v[104:107], v[32:35], v[24:27], v[104:107]
ds_read_b128 v[64:67], v3 offset:38912
v_mfma_f32_16x16x32_bf16 v[108:111], v[32:35], v[28:31], v[108:111]
ds_read_b128 v[68:71], v3 offset:39168
v_mfma_f32_16x16x32_bf16 v[112:115], v[36:39], v[16:19], v[112:115]
ds_read_b128 v[72:75], v4 offset:36864
v_mfma_f32_16x16x32_bf16 v[116:119], v[36:39], v[20:23], v[116:119]
ds_read_b128 v[76:79], v4 offset:37888
v_mfma_f32_16x16x32_bf16 v[120:123], v[36:39], v[24:27], v[120:123]
ds_read_b128 v[80:83], v4 offset:38912
v_mfma_f32_16x16x32_bf16 v[124:127], v[36:39], v[28:31], v[124:127]
ds_read_b128 v[84:87], v4 offset:39936
v_mfma_f32_16x16x32_bf16 v[128:131], v[40:43], v[16:19], v[128:131]
ds_read_b128 v[88:91], v4 offset:40960
v_mfma_f32_16x16x32_bf16 v[132:135], v[40:43], v[20:23], v[132:135]
ds_read_b128 v[92:95], v4 offset:41984
v_mfma_f32_16x16x32_bf16 v[136:139], v[40:43], v[24:27], v[136:139]
v_fmac_f32 v114, v232, v198
v_mfma_f32_16x16x32_bf16 v[140:143], v[40:43], v[28:31], v[140:143]
v_fmac_f32 v118, v233, v198
v_mfma_f32_16x16x32_bf16 v[144:147], v[44:47], v[16:19], v[144:147]
v_fmac_f32 v122, v234, v198
v_mfma_f32_16x16x32_bf16 v[148:151], v[44:47], v[20:23], v[148:151]
v_fmac_f32 v126, v235, v198
v_mfma_f32_16x16x32_bf16 v[152:155], v[44:47], v[24:27], v[152:155]
v_fmac_f32 v130, v232, v202
v_mfma_f32_16x16x32_bf16 v[156:159], v[44:47], v[28:31], v[156:159]
v_fmac_f32 v134, v233, v202
v_mfma_f32_16x16x32_bf16 v[160:163], v[48:51], v[16:19], v[160:163]
v_fmac_f32 v138, v234, v202
v_mfma_f32_16x16x32_bf16 v[164:167], v[48:51], v[20:23], v[164:167]
v_fmac_f32 v142, v235, v202
v_mfma_f32_16x16x32_bf16 v[168:171], v[48:51], v[24:27], v[168:171]
v_fmac_f32 v146, v232, v206
v_mfma_f32_16x16x32_bf16 v[172:175], v[48:51], v[28:31], v[172:175]
v_fmac_f32 v187, v234, v215
v_mfma_f32_16x16x32_bf16 v[176:179], v[52:55], v[16:19], v[176:179]
v_fmac_f32 v191, v235, v215
v_mfma_f32_16x16x32_bf16 v[180:183], v[52:55], v[20:23], v[180:183]
v_fmac_f32 v99, v232, v195
v_mfma_f32_16x16x32_bf16 v[184:187], v[52:55], v[24:27], v[184:187]
s_waitcnt lgkmcnt(0)
v_mfma_f32_16x16x32_bf16 v[188:191], v[52:55], v[28:31], v[188:191]
s_barrier
v_mfma_f32_16x16x32_bf16 v[96:99], v[72:75], v[56:59], v[96:99]
ds_read_b128 v[16:19], v3 offset:49152
v_mfma_f32_16x16x32_bf16 v[100:103], v[72:75], v[60:63], v[100:103]
ds_read_b128 v[20:23], v3 offset:49408
v_mfma_f32_16x16x32_bf16 v[104:107], v[72:75], v[64:67], v[104:107]
ds_read_b128 v[24:27], v3 offset:53248
v_mfma_f32_16x16x32_bf16 v[108:111], v[72:75], v[68:71], v[108:111]
ds_read_b128 v[28:31], v3 offset:53504
v_mfma_f32_16x16x32_bf16 v[112:115], v[76:79], v[56:59], v[112:115]
ds_read_b128 v[32:35], v4 offset:0
v_mfma_f32_16x16x32_bf16 v[116:119], v[76:79], v[60:63], v[116:119]
ds_read_b128 v[36:39], v4 offset:1024
v_mfma_f32_16x16x32_bf16 v[120:123], v[76:79], v[64:67], v[120:123]
ds_read_b128 v[40:43], v4 offset:2048
v_mfma_f32_16x16x32_bf16 v[124:127], v[76:79], v[68:71], v[124:127]
ds_read_b128 v[44:47], v4 offset:3072
v_mfma_f32_16x16x32_bf16 v[128:131], v[80:83], v[56:59], v[128:131]
ds_read_b128 v[48:51], v4 offset:4096
v_mfma_f32_16x16x32_bf16 v[132:135], v[80:83], v[60:63], v[132:135]
ds_read_b128 v[52:55], v4 offset:5120
v_mfma_f32_16x16x32_bf16 v[136:139], v[80:83], v[64:67], v[136:139]
v_fmac_f32 v151, v233, v207
v_mfma_f32_16x16x32_bf16 v[140:143], v[80:83], v[68:71], v[140:143]
v_fmac_f32 v155, v234, v207
v_mfma_f32_16x16x32_bf16 v[144:147], v[84:87], v[56:59], v[144:147]
v_fmac_f32 v159, v235, v207
v_mfma_f32_16x16x32_bf16 v[148:151], v[84:87], v[60:63], v[148:151]
v_fmac_f32 v163, v232, v211
v_mfma_f32_16x16x32_bf16 v[152:155], v[84:87], v[64:67], v[152:155]
v_fmac_f32 v167, v233, v211
v_mfma_f32_16x16x32_bf16 v[156:159], v[84:87], v[68:71], v[156:159]
v_fmac_f32 v171, v234, v211
v_mfma_f32_16x16x32_bf16 v[160:163], v[88:91], v[56:59], v[160:163]
v_fmac_f32 v175, v235, v211
v_mfma_f32_16x16x32_bf16 v[164:167], v[88:91], v[60:63], v[164:167]
v_fmac_f32 v179, v232, v215
v_mfma_f32_16x16x32_bf16 v[168:171], v[88:91], v[64:67], v[168:171]
v_fmac_f32 v183, v233, v215
v_mfma_f32_16x16x32_bf16 v[172:175], v[88:91], v[68:71], v[172:175]
v_fmac_f32 v103, v233, v195
v_mfma_f32_16x16x32_bf16 v[176:179], v[92:95], v[56:59], v[176:179]
v_fmac_f32 v107, v234, v195
v_mfma_f32_16x16x32_bf16 v[180:183], v[92:95], v[60:63], v[180:183]
v_fmac_f32 v111, v235, v195
v_mfma_f32_16x16x32_bf16 v[184:187], v[92:95], v[64:67], v[184:187]
v_fmac_f32 v115, v232, v199
v_mfma_f32_16x16x32_bf16 v[188:191], v[92:95], v[68:71], v[188:191]
s_waitcnt lgkmcnt(0)
v_mfma_f32_16x16x32_bf16 v[96:99], v[32:35], v[16:19], v[96:99]
ds_read_b128 v[56:59], v3 offset:51200
v_mfma_f32_16x16x32_bf16 v[100:103], v[32:35], v[20:23], v[100:103]
ds_read_b128 v[60:63], v3 offset:51456
v_mfma_f32_16x16x32_bf16 v[104:107], v[32:35], v[24:27], v[104:107]
ds_read_b128 v[64:67], v3 offset:55296
v_mfma_f32_16x16x32_bf16 v[108:111], v[32:35], v[28:31], v[108:111]
ds_read_b128 v[68:71], v3 offset:55552
v_mfma_f32_16x16x32_bf16 v[112:115], v[36:39], v[16:19], v[112:115]
ds_read_b128 v[72:75], v4 offset:12288
v_mfma_f32_16x16x32_bf16 v[116:119], v[36:39], v[20:23], v[116:119]
ds_read_b128 v[76:79], v4 offset:13312
v_mfma_f32_16x16x32_bf16 v[120:123], v[36:39], v[24:27], v[120:123]
ds_read_b128 v[80:83], v4 offset:14336
v_mfma_f32_16x16x32_bf16 v[124:127], v[36:39], v[28:31], v[124:127]
ds_read_b128 v[84:87], v4 offset:15360
v_mfma_f32_16x16x32_bf16 v[128:131], v[40:43], v[16:19], v[128:131]
ds_read_b128 v[88:91], v4 offset:16384
v_mfma_f32_16x16x32_bf16 v[132:135], v[40:43], v[20:23], v[132:135]
ds_read_b128 v[92:95], v4 offset:17408
v_mfma_f32_16x16x32_bf16 v[136:139], v[40:43], v[24:27], v[136:139]
v_fmac_f32 v119, v233, v199
v_mfma_f32_16x16x32_bf16 v[140:143], v[40:43], v[28:31], v[140:143]
v_fmac_f32 v123, v234, v199
v_mfma_f32_16x16x32_bf16 v[144:147], v[44:47], v[16:19], v[144:147]
v_fmac_f32 v127, v235, v199
v_mfma_f32_16x16x32_bf16 v[148:151], v[44:47], v[20:23], v[148:151]
v_fmac_f32 v131, v232, v203
v_mfma_f32_16x16x32_bf16 v[152:155], v[44:47], v[24:27], v[152:155]
v_fmac_f32 v135, v233, v203
v_mfma_f32_16x16x32_bf16 v[156:159], v[44:47], v[28:31], v[156:159]
v_fmac_f32 v139, v234, v203
v_mfma_f32_16x16x32_bf16 v[160:163], v[48:51], v[16:19], v[160:163]
v_fmac_f32 v143, v235, v203
v_mfma_f32_16x16x32_bf16 v[164:167], v[48:51], v[20:23], v[164:167]
v_fmac_f32 v147, v232, v207
v_mfma_f32_16x16x32_bf16 v[168:171], v[48:51], v[24:27], v[168:171]
v_mfma_f32_16x16x32_bf16 v[172:175], v[48:51], v[28:31], v[172:175]
v_mfma_f32_16x16x32_bf16 v[176:179], v[52:55], v[16:19], v[176:179]
v_mfma_f32_16x16x32_bf16 v[180:183], v[52:55], v[20:23], v[180:183]
v_mfma_f32_16x16x32_bf16 v[184:187], v[52:55], v[24:27], v[184:187]
s_waitcnt lgkmcnt(0)
v_mfma_f32_16x16x32_bf16 v[188:191], v[52:55], v[28:31], v[188:191]
s_barrier
v_mfma_f32_16x16x32_bf16 v[96:99], v[72:75], v[56:59], v[96:99]
ds_read_b128 v[16:19], v3 offset:0
v_mfma_f32_16x16x32_bf16 v[100:103], v[72:75], v[60:63], v[100:103]
ds_read_b128 v[20:23], v3 offset:256
v_mfma_f32_16x16x32_bf16 v[104:107], v[72:75], v[64:67], v[104:107]
ds_read_b128 v[24:27], v3 offset:4096
v_mfma_f32_16x16x32_bf16 v[108:111], v[72:75], v[68:71], v[108:111]
ds_read_b128 v[28:31], v3 offset:4352
v_mfma_f32_16x16x32_bf16 v[112:115], v[76:79], v[56:59], v[112:115]
ds_read_b128 v[32:35], v5 offset:24576
v_mfma_f32_16x16x32_bf16 v[116:119], v[76:79], v[60:63], v[116:119]
ds_read_b128 v[36:39], v5 offset:25600
v_mfma_f32_16x16x32_bf16 v[120:123], v[76:79], v[64:67], v[120:123]
ds_read_b128 v[40:43], v5 offset:26624
v_mfma_f32_16x16x32_bf16 v[124:127], v[76:79], v[68:71], v[124:127]
ds_read_b128 v[44:47], v5 offset:27648
v_mfma_f32_16x16x32_bf16 v[128:131], v[80:83], v[56:59], v[128:131]
ds_read_b128 v[48:51], v5 offset:28672
v_mfma_f32_16x16x32_bf16 v[132:135], v[80:83], v[60:63], v[132:135]
ds_read_b128 v[52:55], v5 offset:29696
v_mfma_f32_16x16x32_bf16 v[136:139], v[80:83], v[64:67], v[136:139]
v_mfma_f32_16x16x32_bf16 v[140:143], v[80:83], v[68:71], v[140:143]
v_mfma_f32_16x16x32_bf16 v[144:147], v[84:87], v[56:59], v[144:147]
v_mfma_f32_16x16x32_bf16 v[148:151], v[84:87], v[60:63], v[148:151]
v_mfma_f32_16x16x32_bf16 v[152:155], v[84:87], v[64:67], v[152:155]
v_mfma_f32_16x16x32_bf16 v[156:159], v[84:87], v[68:71], v[156:159]
v_mfma_f32_16x16x32_bf16 v[160:163], v[88:91], v[56:59], v[160:163]
v_mfma_f32_16x16x32_bf16 v[164:167], v[88:91], v[60:63], v[164:167]
v_mfma_f32_16x16x32_bf16 v[168:171], v[88:91], v[64:67], v[168:171]
v_mfma_f32_16x16x32_bf16 v[172:175], v[88:91], v[68:71], v[172:175]
v_mfma_f32_16x16x32_bf16 v[176:179], v[92:95], v[56:59], v[176:179]
v_mfma_f32_16x16x32_bf16 v[180:183], v[92:95], v[60:63], v[180:183]
v_mfma_f32_16x16x32_bf16 v[184:187], v[92:95], v[64:67], v[184:187]
v_mfma_f32_16x16x32_bf16 v[188:191], v[92:95], v[68:71], v[188:191]
s_waitcnt lgkmcnt(0)
v_mfma_f32_16x16x32_bf16 v[96:99], v[32:35], v[16:19], v[96:99]
ds_read_b128 v[56:59], v3 offset:2048
v_mfma_f32_16x16x32_bf16 v[100:103], v[32:35], v[20:23], v[100:103]
ds_read_b128 v[60:63], v3 offset:2304
v_mfma_f32_16x16x32_bf16 v[104:107], v[32:35], v[24:27], v[104:107]
ds_read_b128 v[64:67], v3 offset:6144
v_mfma_f32_16x16x32_bf16 v[108:111], v[32:35], v[28:31], v[108:111]
ds_read_b128 v[68:71], v3 offset:6400
v_mfma_f32_16x16x32_bf16 v[112:115], v[36:39], v[16:19], v[112:115]
ds_read_b128 v[72:75], v5 offset:36864
v_mfma_f32_16x16x32_bf16 v[116:119], v[36:39], v[20:23], v[116:119]
ds_read_b128 v[76:79], v5 offset:37888
v_mfma_f32_16x16x32_bf16 v[120:123], v[36:39], v[24:27], v[120:123]
ds_read_b128 v[80:83], v5 offset:38912
v_mfma_f32_16x16x32_bf16 v[124:127], v[36:39], v[28:31], v[124:127]
ds_read_b128 v[84:87], v5 offset:39936
v_mfma_f32_16x16x32_bf16 v[128:131], v[40:43], v[16:19], v[128:131]
ds_read_b128 v[88:91], v5 offset:40960
v_mfma_f32_16x16x32_bf16 v[132:135], v[40:43], v[20:23], v[132:135]
ds_read_b128 v[92:95], v5 offset:41984
v_mfma_f32_16x16x32_bf16 v[136:139], v[40:43], v[24:27], v[136:139]
v_mfma_f32_16x16x32_bf16 v[140:143], v[40:43], v[28:31], v[140:143]
v_mfma_f32_16x16x32_bf16 v[144:147], v[44:47], v[16:19], v[144:147]
v_mfma_f32_16x16x32_bf16 v[148:151], v[44:47], v[20:23], v[148:151]
v_mfma_f32_16x16x32_bf16 v[152:155], v[44:47], v[24:27], v[152:155]
v_mfma_f32_16x16x32_bf16 v[156:159], v[44:47], v[28:31], v[156:159]
v_mfma_f32_16x16x32_bf16 v[160:163], v[48:51], v[16:19], v[160:163]
v_mfma_f32_16x16x32_bf16 v[164:167], v[48:51], v[20:23], v[164:167]
v_mfma_f32_16x16x32_bf16 v[168:171], v[48:51], v[24:27], v[168:171]
v_mfma_f32_16x16x32_bf16 v[172:175], v[48:51], v[28:31], v[172:175]
v_mfma_f32_16x16x32_bf16 v[176:179], v[52:55], v[16:19], v[176:179]
v_mfma_f32_16x16x32_bf16 v[180:183], v[52:55], v[20:23], v[180:183]
v_mfma_f32_16x16x32_bf16 v[184:187], v[52:55], v[24:27], v[184:187]
s_waitcnt lgkmcnt(0)
v_mfma_f32_16x16x32_bf16 v[188:191], v[52:55], v[28:31], v[188:191]
s_barrier
v_mfma_f32_16x16x32_bf16 v[96:99], v[72:75], v[56:59], v[96:99]
ds_read_b128 v[16:19], v3 offset:16384
v_mfma_f32_16x16x32_bf16 v[100:103], v[72:75], v[60:63], v[100:103]
ds_read_b128 v[20:23], v3 offset:16640
v_mfma_f32_16x16x32_bf16 v[104:107], v[72:75], v[64:67], v[104:107]
ds_read_b128 v[24:27], v3 offset:20480
v_mfma_f32_16x16x32_bf16 v[108:111], v[72:75], v[68:71], v[108:111]
ds_read_b128 v[28:31], v3 offset:20736
v_mfma_f32_16x16x32_bf16 v[112:115], v[76:79], v[56:59], v[112:115]
ds_read_b128 v[32:35], v5 offset:0
v_mfma_f32_16x16x32_bf16 v[116:119], v[76:79], v[60:63], v[116:119]
ds_read_b128 v[36:39], v5 offset:1024
v_mfma_f32_16x16x32_bf16 v[120:123], v[76:79], v[64:67], v[120:123]
ds_read_b128 v[40:43], v5 offset:2048
v_mfma_f32_16x16x32_bf16 v[124:127], v[76:79], v[68:71], v[124:127]
ds_read_b128 v[44:47], v5 offset:3072
v_mfma_f32_16x16x32_bf16 v[128:131], v[80:83], v[56:59], v[128:131]
ds_read_b128 v[48:51], v5 offset:4096
v_mfma_f32_16x16x32_bf16 v[132:135], v[80:83], v[60:63], v[132:135]
ds_read_b128 v[52:55], v5 offset:5120
v_mfma_f32_16x16x32_bf16 v[136:139], v[80:83], v[64:67], v[136:139]
v_mfma_f32_16x16x32_bf16 v[140:143], v[80:83], v[68:71], v[140:143]
v_mfma_f32_16x16x32_bf16 v[144:147], v[84:87], v[56:59], v[144:147]
v_mfma_f32_16x16x32_bf16 v[148:151], v[84:87], v[60:63], v[148:151]
v_mfma_f32_16x16x32_bf16 v[152:155], v[84:87], v[64:67], v[152:155]
v_mfma_f32_16x16x32_bf16 v[156:159], v[84:87], v[68:71], v[156:159]
v_mfma_f32_16x16x32_bf16 v[160:163], v[88:91], v[56:59], v[160:163]
v_mfma_f32_16x16x32_bf16 v[164:167], v[88:91], v[60:63], v[164:167]
v_mfma_f32_16x16x32_bf16 v[168:171], v[88:91], v[64:67], v[168:171]
v_mfma_f32_16x16x32_bf16 v[172:175], v[88:91], v[68:71], v[172:175]
v_mfma_f32_16x16x32_bf16 v[176:179], v[92:95], v[56:59], v[176:179]
v_mfma_f32_16x16x32_bf16 v[180:183], v[92:95], v[60:63], v[180:183]
v_mfma_f32_16x16x32_bf16 v[184:187], v[92:95], v[64:67], v[184:187]
v_mfma_f32_16x16x32_bf16 v[188:191], v[92:95], v[68:71], v[188:191]
s_waitcnt lgkmcnt(0)
v_mfma_f32_16x16x32_bf16 v[96:99], v[32:35], v[16:19], v[96:99]
ds_read_b128 v[56:59], v3 offset:18432
v_mfma_f32_16x16x32_bf16 v[100:103], v[32:35], v[20:23], v[100:103]
ds_read_b128 v[60:63], v3 offset:18688
v_mfma_f32_16x16x32_bf16 v[104:107], v[32:35], v[24:27], v[104:107]
ds_read_b128 v[64:67], v3 offset:22528
v_mfma_f32_16x16x32_bf16 v[108:111], v[32:35], v[28:31], v[108:111]
ds_read_b128 v[68:71], v3 offset:22784
v_mfma_f32_16x16x32_bf16 v[112:115], v[36:39], v[16:19], v[112:115]
ds_read_b128 v[72:75], v5 offset:12288
v_mfma_f32_16x16x32_bf16 v[116:119], v[36:39], v[20:23], v[116:119]
ds_read_b128 v[76:79], v5 offset:13312
v_mfma_f32_16x16x32_bf16 v[120:123], v[36:39], v[24:27], v[120:123]
ds_read_b128 v[80:83], v5 offset:14336
v_mfma_f32_16x16x32_bf16 v[124:127], v[36:39], v[28:31], v[124:127]
ds_read_b128 v[84:87], v5 offset:15360
v_mfma_f32_16x16x32_bf16 v[128:131], v[40:43], v[16:19], v[128:131]
ds_read_b128 v[88:91], v5 offset:16384
v_mfma_f32_16x16x32_bf16 v[132:135], v[40:43], v[20:23], v[132:135]
ds_read_b128 v[92:95], v5 offset:17408
v_mfma_f32_16x16x32_bf16 v[136:139], v[40:43], v[24:27], v[136:139]
v_mfma_f32_16x16x32_bf16 v[140:143], v[40:43], v[28:31], v[140:143]
v_mfma_f32_16x16x32_bf16 v[144:147], v[44:47], v[16:19], v[144:147]
v_mfma_f32_16x16x32_bf16 v[148:151], v[44:47], v[20:23], v[148:151]
v_mfma_f32_16x16x32_bf16 v[152:155], v[44:47], v[24:27], v[152:155]
v_mfma_f32_16x16x32_bf16 v[156:159], v[44:47], v[28:31], v[156:159]
s_waitcnt lgkmcnt(0)
v_mfma_f32_16x16x32_bf16 v[96:99], v[72:75], v[56:59], v[96:99]
s_barrier
v_mfma_f32_16x16x32_bf16 v[100:103], v[72:75], v[60:63], v[100:103]
v_mfma_f32_16x16x32_bf16 v[104:107], v[72:75], v[64:67], v[104:107]
v_mfma_f32_16x16x32_bf16 v[108:111], v[72:75], v[68:71], v[108:111]
v_mfma_f32_16x16x32_bf16 v[112:115], v[76:79], v[56:59], v[112:115]
v_mfma_f32_16x16x32_bf16 v[116:119], v[76:79], v[60:63], v[116:119]
v_mfma_f32_16x16x32_bf16 v[120:123], v[76:79], v[64:67], v[120:123]
v_mfma_f32_16x16x32_bf16 v[124:127], v[76:79], v[68:71], v[124:127]
v_mfma_f32_16x16x32_bf16 v[128:131], v[80:83], v[56:59], v[128:131]
s_nop 1
v_mfma_f32_16x16x32_bf16 v[132:135], v[80:83], v[60:63], v[132:135]
s_nop 1
v_mfma_f32_16x16x32_bf16 v[136:139], v[80:83], v[64:67], v[136:139]
v_max_f32 v96, 0, v96
v_max_f32 v97, 0, v97
v_max_f32 v98, 0, v98
v_mfma_f32_16x16x32_bf16 v[140:143], v[80:83], v[68:71], v[140:143]
v_max_f32 v99, 0, v99
v_max_f32 v100, 0, v100
v_max_f32 v101, 0, v101
v_mfma_f32_16x16x32_bf16 v[144:147], v[84:87], v[56:59], v[144:147]
v_max_f32 v102, 0, v102
v_max_f32 v103, 0, v103
v_mul_f32 v96, v96, v112
v_mfma_f32_16x16x32_bf16 v[148:151], v[84:87], v[60:63], v[148:151]
v_mul_f32 v97, v97, v113
v_mul_f32 v98, v98, v114
v_mul_f32 v99, v99, v115
v_mfma_f32_16x16x32_bf16 v[152:155], v[84:87], v[64:67], v[152:155]
v_mul_f32 v100, v100, v116
v_mul_f32 v101, v101, v117
v_mul_f32 v102, v102, v118
v_mfma_f32_16x16x32_bf16 v[156:159], v[84:87], v[68:71], v[156:159]
v_mul_f32 v103, v103, v119
v_cvt_pk_bf16_f32 v96, v96, v97
v_cvt_pk_bf16_f32 v97, v98, v99
v_mfma_f32_16x16x32_bf16 v[160:163], v[48:51], v[16:19], v[160:163]
v_cvt_pk_bf16_f32 v98, v100, v101
v_cvt_pk_bf16_f32 v99, v102, v103
s_nop 0
v_mfma_f32_16x16x32_bf16 v[164:167], v[48:51], v[20:23], v[164:167]
v_permlane16_swap_b32 v96, v98
v_permlane16_swap_b32 v97, v99
buffer_store_dwordx4 v[96:99], v11, s[36:39], s71 offen offset:0
v_mfma_f32_16x16x32_bf16 v[168:171], v[48:51], v[24:27], v[168:171]
v_max_f32 v104, 0, v104
v_max_f32 v105, 0, v105
v_max_f32 v106, 0, v106
v_mfma_f32_16x16x32_bf16 v[172:175], v[48:51], v[28:31], v[172:175]
v_max_f32 v107, 0, v107
v_max_f32 v108, 0, v108
v_max_f32 v109, 0, v109
v_mfma_f32_16x16x32_bf16 v[176:179], v[52:55], v[16:19], v[176:179]
v_max_f32 v110, 0, v110
v_max_f32 v111, 0, v111
v_mul_f32 v104, v104, v120
v_mfma_f32_16x16x32_bf16 v[180:183], v[52:55], v[20:23], v[180:183]
v_mul_f32 v105, v105, v121
v_mul_f32 v106, v106, v122
v_mul_f32 v107, v107, v123
v_mfma_f32_16x16x32_bf16 v[184:187], v[52:55], v[24:27], v[184:187]
v_mul_f32 v108, v108, v124
v_mul_f32 v109, v109, v125
v_mul_f32 v110, v110, v126
v_mfma_f32_16x16x32_bf16 v[188:191], v[52:55], v[28:31], v[188:191]
v_mul_f32 v111, v111, v127
v_cvt_pk_bf16_f32 v104, v104, v105
v_cvt_pk_bf16_f32 v105, v106, v107
v_mfma_f32_16x16x32_bf16 v[160:163], v[88:91], v[56:59], v[160:163]
v_cvt_pk_bf16_f32 v106, v108, v109
v_cvt_pk_bf16_f32 v107, v110, v111
s_nop 0
v_mfma_f32_16x16x32_bf16 v[164:167], v[88:91], v[60:63], v[164:167]
v_permlane16_swap_b32 v104, v106
v_permlane16_swap_b32 v105, v107
buffer_store_dwordx4 v[104:107], v11, s[36:39], s72 offen offset:0
v_mfma_f32_16x16x32_bf16 v[168:171], v[88:91], v[64:67], v[168:171]
v_max_f32 v128, 0, v128
v_max_f32 v129, 0, v129
v_max_f32 v130, 0, v130
v_mfma_f32_16x16x32_bf16 v[172:175], v[88:91], v[68:71], v[172:175]
v_max_f32 v131, 0, v131
v_max_f32 v132, 0, v132
v_max_f32 v133, 0, v133
v_mfma_f32_16x16x32_bf16 v[176:179], v[92:95], v[56:59], v[176:179]
v_max_f32 v134, 0, v134
v_max_f32 v135, 0, v135
v_mul_f32 v128, v128, v144
v_mfma_f32_16x16x32_bf16 v[180:183], v[92:95], v[60:63], v[180:183]
v_mul_f32 v129, v129, v145
v_mul_f32 v130, v130, v146
v_mul_f32 v131, v131, v147
v_mfma_f32_16x16x32_bf16 v[184:187], v[92:95], v[64:67], v[184:187]
v_mul_f32 v132, v132, v148
v_mul_f32 v133, v133, v149
v_mul_f32 v134, v134, v150
v_mfma_f32_16x16x32_bf16 v[188:191], v[92:95], v[68:71], v[188:191]
v_mul_f32 v135, v135, v151
v_cvt_pk_bf16_f32 v128, v128, v129
v_cvt_pk_bf16_f32 v129, v130, v131
v_cvt_pk_bf16_f32 v130, v132, v133
v_cvt_pk_bf16_f32 v131, v134, v135
s_nop 0
v_permlane16_swap_b32 v128, v130
v_permlane16_swap_b32 v129, v131
buffer_store_dwordx4 v[128:131], v11, s[36:39], s71 offen offset:1024
v_max_f32 v136, 0, v136
v_max_f32 v137, 0, v137
v_max_f32 v138, 0, v138
v_max_f32 v139, 0, v139
v_max_f32 v140, 0, v140
v_max_f32 v141, 0, v141
v_max_f32 v142, 0, v142
v_max_f32 v143, 0, v143
v_mul_f32 v136, v136, v152
v_mul_f32 v137, v137, v153
v_mul_f32 v138, v138, v154
v_mul_f32 v139, v139, v155
v_mul_f32 v140, v140, v156
v_mul_f32 v141, v141, v157
v_mul_f32 v142, v142, v158
v_mul_f32 v143, v143, v159
v_cvt_pk_bf16_f32 v136, v136, v137
v_cvt_pk_bf16_f32 v137, v138, v139
v_cvt_pk_bf16_f32 v138, v140, v141
v_cvt_pk_bf16_f32 v139, v142, v143
s_nop 0
v_permlane16_swap_b32 v136, v138
v_permlane16_swap_b32 v137, v139
buffer_store_dwordx4 v[136:139], v11, s[36:39], s72 offen offset:1024
v_max_f32 v160, 0, v160
v_max_f32 v161, 0, v161
v_max_f32 v162, 0, v162
v_max_f32 v163, 0, v163
v_max_f32 v164, 0, v164
v_max_f32 v165, 0, v165
v_max_f32 v166, 0, v166
v_max_f32 v167, 0, v167
v_pk_mul_f32 v[160:161], v[160:161], v[176:177]
v_pk_mul_f32 v[162:163], v[162:163], v[178:179]
v_pk_mul_f32 v[164:165], v[164:165], v[180:181]
v_pk_mul_f32 v[166:167], v[166:167], v[182:183]
v_cvt_pk_bf16_f32 v160, v160, v161
v_cvt_pk_bf16_f32 v161, v162, v163
v_cvt_pk_bf16_f32 v162, v164, v165
v_cvt_pk_bf16_f32 v163, v166, v167
s_nop 0
v_permlane16_swap_b32 v160, v162
v_permlane16_swap_b32 v161, v163
buffer_store_dwordx4 v[160:163], v11, s[36:39], s71 offen offset:2048
v_max_f32 v168, 0, v168
v_max_f32 v169, 0, v169
v_max_f32 v170, 0, v170
v_max_f32 v171, 0, v171
v_max_f32 v172, 0, v172
v_max_f32 v173, 0, v173
v_max_f32 v174, 0, v174
v_max_f32 v175, 0, v175
v_pk_mul_f32 v[168:169], v[168:169], v[184:185]
v_pk_mul_f32 v[170:171], v[170:171], v[186:187]
v_pk_mul_f32 v[172:173], v[172:173], v[188:189]
v_pk_mul_f32 v[174:175], v[174:175], v[190:191]
v_cvt_pk_bf16_f32 v168, v168, v169
v_cvt_pk_bf16_f32 v169, v170, v171
v_cvt_pk_bf16_f32 v170, v172, v173
v_cvt_pk_bf16_f32 v171, v174, v175
s_nop 0
v_permlane16_swap_b32 v168, v170
v_permlane16_swap_b32 v169, v171
buffer_store_dwordx4 v[168:171], v11, s[36:39], s72 offen offset:2048
s_waitcnt vmcnt(0)
s_mov_b64 exec, 1
buffer_store_dword v2, v1, s[36:39], s80 offen
s_mov_b64 exec, -1
s_barrier
s_lshr_b32 s60, s13, 3
s_and_b32 s61, s5, 7
v_and_b32 v3, 15, v0
v_lshrrev_b32 v7, 4, v0
s_lshl_b32 s66, s60, 1
s_lshr_b32 s67, s6, 1
s_add_u32 s66, s66, s67
s_and_b32 s68, s6, 1
s_lshl_b32 s68, s68, 8
s_mul_i32 s62, s66, 98304
s_add_u32 s62, s62, s68
s_add_u32 s62, s62, 0
s_mul_i32 s64, s66, 40960
s_mul_i32 s67, s61, 5120
s_add_u32 s64, s64, s67
s_add_u32 s64, s64, s68
s_lshl_b32 s72, s6, 8
s_lshl_b32 s67, s60, 12
s_add_u32 s72, s72, s67
s_add_u32 s72, s72, s7
s_lshl_b32 s65, s60, 2
s_add_u32 s65, s65, s6
s_mul_i32 s65, s65, 20480
s_mul_i32 s67, s61, 160
s_add_u32 s65, s65, s67
v_lshlrev_b32 v1, 4, v3
v_lshl_add_u32 v10, v7, 9, v1
v_lshrrev_b32 v2, 5, v0
v_lshl_add_u32 v1, v2, 9, v1
v_and_b32 v2, 1, v7
v_lshl_add_u32 v11, v2, 3, v1
v_add_u32 v11, 4096, v11
v_mul_u32_u24 v1, 1280, v3
v_lshl_add_u32 v12, v7, 4, v1
v_lshl_add_u32 v13, v7, 3, v1
v_add_u32 v9, 4096, v10
s_and_b32 s67, s60, 3
s_mul_i32 s67, s67, 0
s_sub_u32 s69, 12, s67
s_mul_i32 s68, s67, 8192
s_add_u32 s62, s62, s68
s_sub_u32 s63, s62, 98304
s_add_u32 s73, s64, 10485760
s_add_u32 s74, s72, 22020096
v_lshlrev_b32 v8, 4, v3
v_lshlrev_b32 v4, 4, v0
v_add_u32 v5, 61440, v4
v_add_u32 v6, 122880, v4
s_mov_b32 s68, 0xffff0000
s_and_b32 s67, s60, 3
s_mul_i32 s67, s67, 0
v_lshrrev_b32 v1, 1, v0
v_add_u32 v1, s67, v1
v_and_b32 v1, 15, v1
v_lshlrev_b32 v1, 5, v1
v_and_b32 v2, 1, v0
v_lshl_add_u32 v1, v2, 3, v1
s_lshr_b32 s94, s5, 4
s_lshl_b32 s94, s94, 9
s_bfe_u32 s81, s5, 0x10003
s_lshl_b32 s81, s81, 2
s_add_u32 s94, s94, s81
s_lshl_b32 s81, s4, 10
s_add_u32 s94, s94, s81
s_add_u32 s94, s94, 51798016
s_add_u32 s95, s8, 5
s_mov_b32 s92, -1
ds_read_b128 v[134:137], v4 offset:40960
ds_read_b128 v[138:141], v4 offset:41984
ds_read_b128 v[142:145], v4 offset:43008
ds_read_b128 v[146:149], v4 offset:44032
ds_read_b128 v[150:153], v4 offset:45056
ds_read_b128 v[154:157], v4 offset:46080
ds_read_b128 v[158:161], v4 offset:47104
ds_read_b128 v[162:165], v4 offset:48128
ds_read_b128 v[166:169], v4 offset:49152
ds_read_b128 v[170:173], v4 offset:50176
s_and_b32 s82, s92, 0xf
s_cbranch_scc0 gt_106k
s_mov_b32 s82, s9
gt_106:
buffer_load_dword v2, v1, s[36:39], s94 offen sc1
s_waitcnt vmcnt(0)
v_subrev_u32 v2, s95, v2
v_cmp_lt_u32 s[92:93], 15, v2
s_and_b32 s83, s92, 0xf
s_cbranch_scc0 gt_106k
s_add_u32 s82, s82, 1
s_cmp_lt_u32 s82, 200000
s_cbranch_scc1 gt_106
s_mov_b32 s9, 200000
gt_106k:
s_add_u32 s70, s62, 0
buffer_load_dwordx4 v[54:57], v10, s[36:39], s70 offen offset:0 sc1
buffer_load_dwordx4 v[58:61], v10, s[36:39], s70 offen offset:2048 sc1
buffer_load_dwordx4 v[62:65], v9, s[36:39], s70 offen offset:0 sc1
buffer_load_dwordx4 v[66:69], v9, s[36:39], s70 offen offset:2048 sc1
s_and_b32 s82, s92, 0x30
s_cbranch_scc0 gt_107k
s_mov_b32 s82, s9
gt_107:
buffer_load_dword v2, v1, s[36:39], s94 offen sc1
s_waitcnt vmcnt(0)
v_subrev_u32 v2, s95, v2
v_cmp_lt_u32 s[92:93], 15, v2
s_and_b32 s83, s92, 0x30
s_cbranch_scc0 gt_107k
s_add_u32 s82, s82, 1
s_cmp_lt_u32 s82, 200000
s_cbranch_scc1 gt_107
s_mov_b32 s9, 200000
gt_107k:
s_add_u32 s70, s62, 8192
buffer_load_dwordx4 v[70:73], v10, s[36:39], s70 offen offset:0 sc1
buffer_load_dwordx4 v[74:77], v10, s[36:39], s70 offen offset:2048 sc1
buffer_load_dwordx4 v[78:81], v9, s[36:39], s70 offen offset:0 sc1
buffer_load_dwordx4 v[82:85], v9, s[36:39], s70 offen offset:2048 sc1
s_and_b32 s82, s92, 0xc0
s_cbranch_scc0 gt_108k
s_mov_b32 s82, s9
gt_108:
buffer_load_dword v2, v1, s[36:39], s94 offen sc1
s_waitcnt vmcnt(0)
v_subrev_u32 v2, s95, v2
v_cmp_lt_u32 s[92:93], 15, v2
s_and_b32 s83, s92, 0xc0
s_cbranch_scc0 gt_108k
s_add_u32 s82, s82, 1
s_cmp_lt_u32 s82, 200000
s_cbranch_scc1 gt_108
s_mov_b32 s9, 200000
gt_108k:
s_add_u32 s70, s62, 16384
buffer_load_dwordx4 v[86:89], v10, s[36:39], s70 offen offset:0 sc1
buffer_load_dwordx4 v[90:93], v10, s[36:39], s70 offen offset:2048 sc1
buffer_load_dwordx4 v[94:97], v9, s[36:39], s70 offen offset:0 sc1
buffer_load_dwordx4 v[98:101], v9, s[36:39], s70 offen offset:2048 sc1
s_waitcnt vmcnt(11) lgkmcnt(5)
s_and_b32 s82, s92, 0xf00
s_cbranch_scc0 gt_109k
s_mov_b32 s82, s9
gt_109:
buffer_load_dword v2, v1, s[36:39], s94 offen sc1
s_waitcnt vmcnt(0)
v_subrev_u32 v2, s95, v2
v_cmp_lt_u32 s[92:93], 15, v2
s_and_b32 s83, s92, 0xf00
s_cbranch_scc0 gt_109k
s_add_u32 s82, s82, 1
s_cmp_lt_u32 s82, 200000
s_cbranch_scc1 gt_109
s_mov_b32 s9, 200000
gt_109k:
s_add_u32 s70, s62, 24576
v_mfma_f32_16x16x32_bf16 v[14:17], v[134:137], v[54:57], 0
ds_read_b128 v[174:177], v4 offset:51200
v_mfma_f32_16x16x32_bf16 v[18:21], v[138:141], v[54:57], 0
ds_read_b128 v[178:181], v4 offset:52224
v_mfma_f32_16x16x32_bf16 v[22:25], v[142:145], v[54:57], 0
ds_read_b128 v[182:185], v4 offset:53248
buffer_load_dwordx4 v[220:223], v10, s[36:39], s73 offen sc1
v_mfma_f32_16x16x32_bf16 v[26:29], v[146:149], v[54:57], 0
ds_read_b128 v[186:189], v4 offset:54272
v_mfma_f32_16x16x32_bf16 v[30:33], v[150:153], v[54:57], 0
ds_read_b128 v[190:193], v4 offset:55296
buffer_load_dwordx4 v[102:105], v10, s[36:39], s70 offen offset:0 sc1
s_waitcnt vmcnt(12) lgkmcnt(5)
v_mfma_f32_16x16x32_bf16 v[14:17], v[154:157], v[58:61], v[14:17]
ds_read_b128 v[134:137], v4 offset:56320
v_mfma_f32_16x16x32_bf16 v[18:21], v[158:161], v[58:61], v[18:21]
ds_read_b128 v[138:141], v4 offset:57344
v_mfma_f32_16x16x32_bf16 v[22:25], v[162:165], v[58:61], v[22:25]
ds_read_b128 v[142:145], v4 offset:58368
buffer_load_dwordx4 v[224:227], v10, s[36:39], s73 offen offset:2048 sc1
v_mfma_f32_16x16x32_bf16 v[26:29], v[166:169], v[58:61], v[26:29]
ds_read_b128 v[146:149], v4 offset:59392
v_mfma_f32_16x16x32_bf16 v[30:33], v[170:173], v[58:61], v[30:33]
ds_read_b128 v[150:153], v4 offset:60416
buffer_load_dwordx4 v[106:109], v10, s[36:39], s70 offen offset:2048 sc1
s_waitcnt vmcnt(13) lgkmcnt(5)
s_barrier
v_mfma_f32_16x16x32_bf16 v[14:17], v[174:177], v[62:65], v[14:17]
ds_read_b128 v[154:157], v5 offset:0
v_mfma_f32_16x16x32_bf16 v[18:21], v[178:181], v[62:65], v[18:21]
ds_read_b128 v[158:161], v5 offset:1024
v_mfma_f32_16x16x32_bf16 v[22:25], v[182:185], v[62:65], v[22:25]
ds_read_b128 v[162:165], v5 offset:2048
buffer_load_dwordx2 v[228:229], v11, s[36:39], s73 offen offset:0 sc1
v_mfma_f32_16x16x32_bf16 v[26:29], v[186:189], v[62:65], v[26:29]
ds_read_b128 v[166:169], v5 offset:3072
v_mfma_f32_16x16x32_bf16 v[30:33], v[190:193], v[62:65], v[30:33]
ds_read_b128 v[170:173], v5 offset:4096
buffer_load_dwordx4 v[110:113], v9, s[36:39], s70 offen offset:0 sc1
s_waitcnt vmcnt(14) lgkmcnt(5)
v_mfma_f32_16x16x32_bf16 v[14:17], v[134:137], v[66:69], v[14:17]
ds_read_b128 v[174:177], v5 offset:5120
v_mfma_f32_16x16x32_bf16 v[18:21], v[138:141], v[66:69], v[18:21]
ds_read_b128 v[178:181], v5 offset:6144
v_mfma_f32_16x16x32_bf16 v[22:25], v[142:145], v[66:69], v[22:25]
ds_read_b128 v[182:185], v5 offset:7168
buffer_load_dwordx4 v[200:203], v8, s[36:39], s74 offen offset:0 sc1
v_mfma_f32_16x16x32_bf16 v[26:29], v[146:149], v[66:69], v[26:29]
ds_read_b128 v[186:189], v5 offset:8192
v_mfma_f32_16x16x32_bf16 v[30:33], v[150:153], v[66:69], v[30:33]
ds_read_b128 v[190:193], v5 offset:9216
buffer_load_dwordx4 v[114:117], v9, s[36:39], s70 offen offset:2048 sc1
s_waitcnt vmcnt(15) lgkmcnt(5)
s_and_b32 s82, s92, 0x3000
s_cbranch_scc0 gt_110k
s_mov_b32 s82, s9
gt_110:
buffer_load_dword v2, v1, s[36:39], s94 offen sc1
s_waitcnt vmcnt(0)
v_subrev_u32 v2, s95, v2
v_cmp_lt_u32 s[92:93], 15, v2
s_and_b32 s83, s92, 0x3000
s_cbranch_scc0 gt_110k
s_add_u32 s82, s82, 1
s_cmp_lt_u32 s82, 200000
s_cbranch_scc1 gt_110
s_mov_b32 s9, 200000
gt_110k:
s_add_u32 s70, s62, 32768
v_mfma_f32_16x16x32_bf16 v[14:17], v[154:157], v[70:73], v[14:17]
ds_read_b128 v[134:137], v5 offset:10240
v_mfma_f32_16x16x32_bf16 v[18:21], v[158:161], v[70:73], v[18:21]
ds_read_b128 v[138:141], v5 offset:11264
v_mfma_f32_16x16x32_bf16 v[22:25], v[162:165], v[70:73], v[22:25]
ds_read_b128 v[142:145], v5 offset:12288
buffer_load_dwordx4 v[204:207], v8, s[36:39], s74 offen offset:1024 sc1
v_mfma_f32_16x16x32_bf16 v[26:29], v[166:169], v[70:73], v[26:29]
ds_read_b128 v[146:149], v5 offset:13312
v_mfma_f32_16x16x32_bf16 v[30:33], v[170:173], v[70:73], v[30:33]
ds_read_b128 v[150:153], v5 offset:14336
buffer_load_dwordx4 v[118:121], v10, s[36:39], s70 offen offset:0 sc1
s_waitcnt vmcnt(16) lgkmcnt(5)
v_mfma_f32_16x16x32_bf16 v[14:17], v[174:177], v[74:77], v[14:17]
ds_read_b128 v[154:157], v5 offset:15360
v_mfma_f32_16x16x32_bf16 v[18:21], v[178:181], v[74:77], v[18:21]
ds_read_b128 v[158:161], v5 offset:16384
v_mfma_f32_16x16x32_bf16 v[22:25], v[182:185], v[74:77], v[22:25]
ds_read_b128 v[162:165], v5 offset:17408
buffer_load_dwordx4 v[208:211], v8, s[36:39], s74 offen offset:2048 sc1
v_mfma_f32_16x16x32_bf16 v[26:29], v[186:189], v[74:77], v[26:29]
ds_read_b128 v[166:169], v5 offset:18432
v_mfma_f32_16x16x32_bf16 v[30:33], v[190:193], v[74:77], v[30:33]
ds_read_b128 v[170:173], v5 offset:19456
buffer_load_dwordx4 v[122:125], v10, s[36:39], s70 offen offset:2048 sc1
s_waitcnt vmcnt(17) lgkmcnt(5)
s_barrier
v_mfma_f32_16x16x32_bf16 v[14:17], v[134:137], v[78:81], v[14:17]
ds_read_b128 v[174:177], v5 offset:20480
v_mfma_f32_16x16x32_bf16 v[18:21], v[138:141], v[78:81], v[18:21]
ds_read_b128 v[178:181], v5 offset:21504
v_mfma_f32_16x16x32_bf16 v[22:25], v[142:145], v[78:81], v[22:25]
ds_read_b128 v[182:185], v5 offset:22528
buffer_load_dwordx4 v[212:215], v8, s[36:39], s74 offen offset:3072 sc1
v_mfma_f32_16x16x32_bf16 v[26:29], v[146:149], v[78:81], v[26:29]
ds_read_b128 v[186:189], v5 offset:23552
v_mfma_f32_16x16x32_bf16 v[30:33], v[150:153], v[78:81], v[30:33]
ds_read_b128 v[190:193], v5 offset:24576
buffer_load_dwordx4 v[126:129], v9, s[36:39], s70 offen offset:0 sc1
s_waitcnt vmcnt(18) lgkmcnt(5)
v_mfma_f32_16x16x32_bf16 v[14:17], v[154:157], v[82:85], v[14:17]
ds_read_b128 v[134:137], v5 offset:25600
v_mfma_f32_16x16x32_bf16 v[18:21], v[158:161], v[82:85], v[18:21]
ds_read_b128 v[138:141], v5 offset:26624
v_mfma_f32_16x16x32_bf16 v[22:25], v[162:165], v[82:85], v[22:25]
ds_read_b128 v[142:145], v5 offset:27648
v_mfma_f32_16x16x32_bf16 v[26:29], v[166:169], v[82:85], v[26:29]
ds_read_b128 v[146:149], v5 offset:28672
v_mfma_f32_16x16x32_bf16 v[30:33], v[170:173], v[82:85], v[30:33]
ds_read_b128 v[150:153], v5 offset:29696
buffer_load_dwordx4 v[130:133], v9, s[36:39], s70 offen offset:2048 sc1
s_waitcnt vmcnt(18) lgkmcnt(5)
s_and_b32 s82, s92, 0xffffc000
s_cbranch_scc0 gt_111k
s_mov_b32 s82, s9
gt_111:
buffer_load_dword v2, v1, s[36:39], s94 offen sc1
s_waitcnt vmcnt(0)
v_subrev_u32 v2, s95, v2
v_cmp_lt_u32 s[92:93], 15, v2
s_and_b32 s83, s92, 0xffffc000
s_cbranch_scc0 gt_111k
s_add_u32 s82, s82, 1
s_cmp_lt_u32 s82, 200000
s_cbranch_scc1 gt_111
s_mov_b32 s9, 200000
gt_111k:
s_add_u32 s70, s62, 40960
v_mfma_f32_16x16x32_bf16 v[14:17], v[174:177], v[86:89], v[14:17]
ds_read_b128 v[154:157], v5 offset:30720
v_mfma_f32_16x16x32_bf16 v[18:21], v[178:181], v[86:89], v[18:21]
ds_read_b128 v[158:161], v5 offset:31744
v_mfma_f32_16x16x32_bf16 v[22:25], v[182:185], v[86:89], v[22:25]
ds_read_b128 v[162:165], v5 offset:32768
v_mfma_f32_16x16x32_bf16 v[26:29], v[186:189], v[86:89], v[26:29]
ds_read_b128 v[166:169], v5 offset:33792
v_mfma_f32_16x16x32_bf16 v[30:33], v[190:193], v[86:89], v[30:33]
ds_read_b128 v[170:173], v5 offset:34816
buffer_load_dwordx4 v[54:57], v10, s[36:39], s70 offen offset:0 sc1
s_waitcnt vmcnt(18) lgkmcnt(5)
v_mfma_f32_16x16x32_bf16 v[14:17], v[134:137], v[90:93], v[14:17]
ds_read_b128 v[174:177], v5 offset:35840
v_mfma_f32_16x16x32_bf16 v[18:21], v[138:141], v[90:93], v[18:21]
ds_read_b128 v[178:181], v5 offset:36864
v_mfma_f32_16x16x32_bf16 v[22:25], v[142:145], v[90:93], v[22:25]
ds_read_b128 v[182:185], v5 offset:37888
v_mfma_f32_16x16x32_bf16 v[26:29], v[146:149], v[90:93], v[26:29]
ds_read_b128 v[186:189], v5 offset:38912
v_mfma_f32_16x16x32_bf16 v[30:33], v[150:153], v[90:93], v[30:33]
ds_read_b128 v[190:193], v5 offset:39936
buffer_load_dwordx4 v[58:61], v10, s[36:39], s70 offen offset:2048 sc1
s_waitcnt vmcnt(18) lgkmcnt(5)
s_barrier
v_mfma_f32_16x16x32_bf16 v[14:17], v[154:157], v[94:97], v[14:17]
ds_read_b128 v[134:137], v5 offset:40960
v_mfma_f32_16x16x32_bf16 v[18:21], v[158:161], v[94:97], v[18:21]
ds_read_b128 v[138:141], v5 offset:41984
v_mfma_f32_16x16x32_bf16 v[22:25], v[162:165], v[94:97], v[22:25]
ds_read_b128 v[142:145], v5 offset:43008
v_mfma_f32_16x16x32_bf16 v[26:29], v[166:169], v[94:97], v[26:29]
ds_read_b128 v[146:149], v5 offset:44032
v_mfma_f32_16x16x32_bf16 v[30:33], v[170:173], v[94:97], v[30:33]
ds_read_b128 v[150:153], v5 offset:45056
buffer_load_dwordx4 v[62:65], v9, s[36:39], s70 offen offset:0 sc1
s_waitcnt vmcnt(18) lgkmcnt(5)
v_mfma_f32_16x16x32_bf16 v[14:17], v[174:177], v[98:101], v[14:17]
ds_read_b128 v[154:157], v5 offset:46080
v_mfma_f32_16x16x32_bf16 v[18:21], v[178:181], v[98:101], v[18:21]
ds_read_b128 v[158:161], v5 offset:47104
v_mfma_f32_16x16x32_bf16 v[22:25], v[182:185], v[98:101], v[22:25]
ds_read_b128 v[162:165], v5 offset:48128
v_mfma_f32_16x16x32_bf16 v[26:29], v[186:189], v[98:101], v[26:29]
ds_read_b128 v[166:169], v5 offset:49152
v_mfma_f32_16x16x32_bf16 v[30:33], v[190:193], v[98:101], v[30:33]
ds_read_b128 v[170:173], v5 offset:50176
buffer_load_dwordx4 v[66:69], v9, s[36:39], s70 offen offset:2048 sc1
s_waitcnt vmcnt(17) lgkmcnt(5)
s_add_u32 s70, s62, 49152
v_mfma_f32_16x16x32_bf16 v[14:17], v[134:137], v[102:105], v[14:17]
ds_read_b128 v[174:177], v5 offset:51200
v_mfma_f32_16x16x32_bf16 v[18:21], v[138:141], v[102:105], v[18:21]
ds_read_b128 v[178:181], v5 offset:52224
v_mfma_f32_16x16x32_bf16 v[22:25], v[142:145], v[102:105], v[22:25]
ds_read_b128 v[182:185], v5 offset:53248
v_mfma_f32_16x16x32_bf16 v[26:29], v[146:149], v[102:105], v[26:29]
ds_read_b128 v[186:189], v5 offset:54272
v_mfma_f32_16x16x32_bf16 v[30:33], v[150:153], v[102:105], v[30:33]
ds_read_b128 v[190:193], v5 offset:55296
buffer_load_dwordx4 v[70:73], v10, s[36:39], s70 offen offset:0 sc1
s_waitcnt vmcnt(16) lgkmcnt(5)
v_mfma_f32_16x16x32_bf16 v[14:17], v[154:157], v[106:109], v[14:17]
ds_read_b128 v[134:137], v5 offset:56320
v_mfma_f32_16x16x32_bf16 v[18:21], v[158:161], v[106:109], v[18:21]
ds_read_b128 v[138:141], v5 offset:57344
v_mfma_f32_16x16x32_bf16 v[22:25], v[162:165], v[106:109], v[22:25]
ds_read_b128 v[142:145], v5 offset:58368
v_mfma_f32_16x16x32_bf16 v[26:29], v[166:169], v[106:109], v[26:29]
ds_read_b128 v[146:149], v5 offset:59392
v_mfma_f32_16x16x32_bf16 v[30:33], v[170:173], v[106:109], v[30:33]
ds_read_b128 v[150:153], v5 offset:60416
buffer_load_dwordx4 v[74:77], v10, s[36:39], s70 offen offset:2048 sc1
s_waitcnt vmcnt(15) lgkmcnt(5)
s_barrier
v_mfma_f32_16x16x32_bf16 v[14:17], v[174:177], v[110:113], v[14:17]
ds_read_b128 v[154:157], v6 offset:0
v_mfma_f32_16x16x32_bf16 v[18:21], v[178:181], v[110:113], v[18:21]
ds_read_b128 v[158:161], v6 offset:1024
v_mfma_f32_16x16x32_bf16 v[22:25], v[182:185], v[110:113], v[22:25]
ds_read_b128 v[162:165], v6 offset:2048
v_mfma_f32_16x16x32_bf16 v[26:29], v[186:189], v[110:113], v[26:29]
ds_read_b128 v[166:169], v6 offset:3072
v_mfma_f32_16x16x32_bf16 v[30:33], v[190:193], v[110:113], v[30:33]
ds_read_b128 v[170:173], v6 offset:4096
buffer_load_dwordx4 v[78:81], v9, s[36:39], s70 offen offset:0 sc1
s_waitcnt vmcnt(14) lgkmcnt(5)
v_mfma_f32_16x16x32_bf16 v[14:17], v[134:137], v[114:117], v[14:17]
ds_read_b128 v[174:177], v6 offset:5120
v_mfma_f32_16x16x32_bf16 v[18:21], v[138:141], v[114:117], v[18:21]
ds_read_b128 v[178:181], v6 offset:6144
v_mfma_f32_16x16x32_bf16 v[22:25], v[142:145], v[114:117], v[22:25]
ds_read_b128 v[182:185], v6 offset:7168
v_mfma_f32_16x16x32_bf16 v[26:29], v[146:149], v[114:117], v[26:29]
ds_read_b128 v[186:189], v6 offset:8192
v_mfma_f32_16x16x32_bf16 v[30:33], v[150:153], v[114:117], v[30:33]
ds_read_b128 v[190:193], v6 offset:9216
buffer_load_dwordx4 v[82:85], v9, s[36:39], s70 offen offset:2048 sc1
s_waitcnt vmcnt(13) lgkmcnt(5)
s_add_u32 s70, s62, 57344
v_mfma_f32_16x16x32_bf16 v[14:17], v[154:157], v[118:121], v[14:17]
ds_read_b128 v[134:137], v6 offset:10240
v_mfma_f32_16x16x32_bf16 v[18:21], v[158:161], v[118:121], v[18:21]
ds_read_b128 v[138:141], v6 offset:11264
v_mfma_f32_16x16x32_bf16 v[22:25], v[162:165], v[118:121], v[22:25]
ds_read_b128 v[142:145], v6 offset:12288
v_mfma_f32_16x16x32_bf16 v[26:29], v[166:169], v[118:121], v[26:29]
ds_read_b128 v[146:149], v6 offset:13312
v_mfma_f32_16x16x32_bf16 v[30:33], v[170:173], v[118:121], v[30:33]
ds_read_b128 v[150:153], v6 offset:14336
buffer_load_dwordx4 v[86:89], v10, s[36:39], s70 offen offset:0 sc1
s_waitcnt vmcnt(12) lgkmcnt(5)
v_mfma_f32_16x16x32_bf16 v[14:17], v[174:177], v[122:125], v[14:17]
ds_read_b128 v[154:157], v6 offset:15360
v_mfma_f32_16x16x32_bf16 v[18:21], v[178:181], v[122:125], v[18:21]
ds_read_b128 v[158:161], v6 offset:16384
v_mfma_f32_16x16x32_bf16 v[22:25], v[182:185], v[122:125], v[22:25]
ds_read_b128 v[162:165], v6 offset:17408
v_mfma_f32_16x16x32_bf16 v[26:29], v[186:189], v[122:125], v[26:29]
ds_read_b128 v[166:169], v6 offset:18432
v_mfma_f32_16x16x32_bf16 v[30:33], v[190:193], v[122:125], v[30:33]
ds_read_b128 v[170:173], v6 offset:19456
buffer_load_dwordx4 v[90:93], v10, s[36:39], s70 offen offset:2048 sc1
s_waitcnt vmcnt(11) lgkmcnt(5)
s_barrier
v_mfma_f32_16x16x32_bf16 v[14:17], v[134:137], v[126:129], v[14:17]
ds_read_b128 v[174:177], v6 offset:20480
v_mfma_f32_16x16x32_bf16 v[18:21], v[138:141], v[126:129], v[18:21]
ds_read_b128 v[178:181], v6 offset:21504
v_mfma_f32_16x16x32_bf16 v[22:25], v[142:145], v[126:129], v[22:25]
ds_read_b128 v[182:185], v6 offset:22528
v_mfma_f32_16x16x32_bf16 v[26:29], v[146:149], v[126:129], v[26:29]
ds_read_b128 v[186:189], v6 offset:23552
v_mfma_f32_16x16x32_bf16 v[30:33], v[150:153], v[126:129], v[30:33]
ds_read_b128 v[190:193], v6 offset:24576
buffer_load_dwordx4 v[94:97], v9, s[36:39], s70 offen offset:0 sc1
s_waitcnt vmcnt(11) lgkmcnt(5)
v_mfma_f32_16x16x32_bf16 v[14:17], v[154:157], v[130:133], v[14:17]
ds_read_b128 v[134:137], v6 offset:25600
v_mfma_f32_16x16x32_bf16 v[18:21], v[158:161], v[130:133], v[18:21]
ds_read_b128 v[138:141], v6 offset:26624
v_mfma_f32_16x16x32_bf16 v[22:25], v[162:165], v[130:133], v[22:25]
ds_read_b128 v[142:145], v6 offset:27648
v_mfma_f32_16x16x32_bf16 v[26:29], v[166:169], v[130:133], v[26:29]
ds_read_b128 v[146:149], v6 offset:28672
v_mfma_f32_16x16x32_bf16 v[30:33], v[170:173], v[130:133], v[30:33]
ds_read_b128 v[150:153], v6 offset:29696
buffer_load_dwordx4 v[98:101], v9, s[36:39], s70 offen offset:2048 sc1
s_waitcnt vmcnt(11) lgkmcnt(5)
s_add_u32 s70, s62, 65536
v_mfma_f32_16x16x32_bf16 v[14:17], v[174:177], v[54:57], v[14:17]
ds_read_b128 v[154:157], v6 offset:30720
v_mfma_f32_16x16x32_bf16 v[18:21], v[178:181], v[54:57], v[18:21]
ds_read_b128 v[158:161], v6 offset:31744
v_mfma_f32_16x16x32_bf16 v[22:25], v[182:185], v[54:57], v[22:25]
ds_read_b128 v[162:165], v6 offset:32768
v_mfma_f32_16x16x32_bf16 v[26:29], v[186:189], v[54:57], v[26:29]
ds_read_b128 v[166:169], v6 offset:33792
v_mfma_f32_16x16x32_bf16 v[30:33], v[190:193], v[54:57], v[30:33]
ds_read_b128 v[170:173], v6 offset:34816
buffer_load_dwordx4 v[102:105], v10, s[36:39], s70 offen offset:0 sc1
s_waitcnt vmcnt(11) lgkmcnt(5)
v_mfma_f32_16x16x32_bf16 v[14:17], v[134:137], v[58:61], v[14:17]
ds_read_b128 v[174:177], v6 offset:35840
v_mfma_f32_16x16x32_bf16 v[18:21], v[138:141], v[58:61], v[18:21]
ds_read_b128 v[178:181], v6 offset:36864
v_mfma_f32_16x16x32_bf16 v[22:25], v[142:145], v[58:61], v[22:25]
ds_read_b128 v[182:185], v6 offset:37888
v_mfma_f32_16x16x32_bf16 v[26:29], v[146:149], v[58:61], v[26:29]
ds_read_b128 v[186:189], v6 offset:38912
v_mfma_f32_16x16x32_bf16 v[30:33], v[150:153], v[58:61], v[30:33]
ds_read_b128 v[190:193], v6 offset:39936
buffer_load_dwordx4 v[106:109], v10, s[36:39], s70 offen offset:2048 sc1
s_waitcnt vmcnt(11) lgkmcnt(5)
s_barrier
v_mfma_f32_16x16x32_bf16 v[14:17], v[154:157], v[62:65], v[14:17]
ds_read_b128 v[134:137], v4 offset:0
v_mfma_f32_16x16x32_bf16 v[18:21], v[158:161], v[62:65], v[18:21]
ds_read_b128 v[138:141], v4 offset:1024
v_mfma_f32_16x16x32_bf16 v[22:25], v[162:165], v[62:65], v[22:25]
ds_read_b128 v[142:145], v4 offset:2048
v_mfma_f32_16x16x32_bf16 v[26:29], v[166:169], v[62:65], v[26:29]
ds_read_b128 v[146:149], v4 offset:3072
v_mfma_f32_16x16x32_bf16 v[30:33], v[170:173], v[62:65], v[30:33]
ds_read_b128 v[150:153], v4 offset:4096
buffer_load_dwordx4 v[110:113], v9, s[36:39], s70 offen offset:0 sc1
s_waitcnt vmcnt(11) lgkmcnt(5)
v_mfma_f32_16x16x32_bf16 v[14:17], v[174:177], v[66:69], v[14:17]
ds_read_b128 v[154:157], v4 offset:5120
v_mfma_f32_16x16x32_bf16 v[18:21], v[178:181], v[66:69], v[18:21]
ds_read_b128 v[158:161], v4 offset:6144
v_mfma_f32_16x16x32_bf16 v[22:25], v[182:185], v[66:69], v[22:25]
ds_read_b128 v[162:165], v4 offset:7168
v_mfma_f32_16x16x32_bf16 v[26:29], v[186:189], v[66:69], v[26:29]
ds_read_b128 v[166:169], v4 offset:8192
v_mfma_f32_16x16x32_bf16 v[30:33], v[190:193], v[66:69], v[30:33]
ds_read_b128 v[170:173], v4 offset:9216
buffer_load_dwordx4 v[114:117], v9, s[36:39], s70 offen offset:2048 sc1
s_waitcnt vmcnt(11) lgkmcnt(5)
s_add_u32 s70, s62, 73728
v_mfma_f32_16x16x32_bf16 v[14:17], v[134:137], v[70:73], v[14:17]
ds_read_b128 v[174:177], v4 offset:10240
v_mfma_f32_16x16x32_bf16 v[18:21], v[138:141], v[70:73], v[18:21]
ds_read_b128 v[178:181], v4 offset:11264
v_mfma_f32_16x16x32_bf16 v[22:25], v[142:145], v[70:73], v[22:25]
ds_read_b128 v[182:185], v4 offset:12288
v_mfma_f32_16x16x32_bf16 v[26:29], v[146:149], v[70:73], v[26:29]
ds_read_b128 v[186:189], v4 offset:13312
v_mfma_f32_16x16x32_bf16 v[30:33], v[150:153], v[70:73], v[30:33]
ds_read_b128 v[190:193], v4 offset:14336
buffer_load_dwordx4 v[118:121], v10, s[36:39], s70 offen offset:0 sc1
s_waitcnt vmcnt(11) lgkmcnt(5)
v_mfma_f32_16x16x32_bf16 v[14:17], v[154:157], v[74:77], v[14:17]
ds_read_b128 v[134:137], v4 offset:15360
v_mfma_f32_16x16x32_bf16 v[18:21], v[158:161], v[74:77], v[18:21]
ds_read_b128 v[138:141], v4 offset:16384
v_mfma_f32_16x16x32_bf16 v[22:25], v[162:165], v[74:77], v[22:25]
ds_read_b128 v[142:145], v4 offset:17408
v_mfma_f32_16x16x32_bf16 v[26:29], v[166:169], v[74:77], v[26:29]
ds_read_b128 v[146:149], v4 offset:18432
v_mfma_f32_16x16x32_bf16 v[30:33], v[170:173], v[74:77], v[30:33]
ds_read_b128 v[150:153], v4 offset:19456
buffer_load_dwordx4 v[122:125], v10, s[36:39], s70 offen offset:2048 sc1
s_waitcnt vmcnt(11) lgkmcnt(5)
s_barrier
v_mfma_f32_16x16x32_bf16 v[14:17], v[174:177], v[78:81], v[14:17]
ds_read_b128 v[154:157], v4 offset:20480
v_mfma_f32_16x16x32_bf16 v[18:21], v[178:181], v[78:81], v[18:21]
ds_read_b128 v[158:161], v4 offset:21504
v_mfma_f32_16x16x32_bf16 v[22:25], v[182:185], v[78:81], v[22:25]
ds_read_b128 v[162:165], v4 offset:22528
v_mfma_f32_16x16x32_bf16 v[26:29], v[186:189], v[78:81], v[26:29]
ds_read_b128 v[166:169], v4 offset:23552
v_mfma_f32_16x16x32_bf16 v[30:33], v[190:193], v[78:81], v[30:33]
ds_read_b128 v[170:173], v4 offset:24576
buffer_load_dwordx4 v[126:129], v9, s[36:39], s70 offen offset:0 sc1
s_waitcnt vmcnt(11) lgkmcnt(5)
v_mfma_f32_16x16x32_bf16 v[14:17], v[134:137], v[82:85], v[14:17]
ds_read_b128 v[174:177], v4 offset:25600
v_mfma_f32_16x16x32_bf16 v[18:21], v[138:141], v[82:85], v[18:21]
ds_read_b128 v[178:181], v4 offset:26624
v_mfma_f32_16x16x32_bf16 v[22:25], v[142:145], v[82:85], v[22:25]
ds_read_b128 v[182:185], v4 offset:27648
v_mfma_f32_16x16x32_bf16 v[26:29], v[146:149], v[82:85], v[26:29]
ds_read_b128 v[186:189], v4 offset:28672
v_mfma_f32_16x16x32_bf16 v[30:33], v[150:153], v[82:85], v[30:33]
ds_read_b128 v[190:193], v4 offset:29696
buffer_load_dwordx4 v[130:133], v9, s[36:39], s70 offen offset:2048 sc1
s_waitcnt vmcnt(11) lgkmcnt(5)
s_add_u32 s70, s62, 81920
v_mfma_f32_16x16x32_bf16 v[14:17], v[154:157], v[86:89], v[14:17]
ds_read_b128 v[134:137], v4 offset:30720
v_mfma_f32_16x16x32_bf16 v[18:21], v[158:161], v[86:89], v[18:21]
ds_read_b128 v[138:141], v4 offset:31744
v_mfma_f32_16x16x32_bf16 v[22:25], v[162:165], v[86:89], v[22:25]
ds_read_b128 v[142:145], v4 offset:32768
v_mfma_f32_16x16x32_bf16 v[26:29], v[166:169], v[86:89], v[26:29]
ds_read_b128 v[146:149], v4 offset:33792
v_mfma_f32_16x16x32_bf16 v[30:33], v[170:173], v[86:89], v[30:33]
ds_read_b128 v[150:153], v4 offset:34816
buffer_load_dwordx4 v[54:57], v10, s[36:39], s70 offen offset:0 sc1
s_waitcnt vmcnt(11) lgkmcnt(5)
v_mfma_f32_16x16x32_bf16 v[14:17], v[174:177], v[90:93], v[14:17]
ds_read_b128 v[154:157], v4 offset:35840
v_mfma_f32_16x16x32_bf16 v[18:21], v[178:181], v[90:93], v[18:21]
ds_read_b128 v[158:161], v4 offset:36864
v_mfma_f32_16x16x32_bf16 v[22:25], v[182:185], v[90:93], v[22:25]
ds_read_b128 v[162:165], v4 offset:37888
v_mfma_f32_16x16x32_bf16 v[26:29], v[186:189], v[90:93], v[26:29]
ds_read_b128 v[166:169], v4 offset:38912
v_mfma_f32_16x16x32_bf16 v[30:33], v[190:193], v[90:93], v[30:33]
ds_read_b128 v[170:173], v4 offset:39936
buffer_load_dwordx4 v[58:61], v10, s[36:39], s70 offen offset:2048 sc1
s_waitcnt vmcnt(11) lgkmcnt(5)
s_barrier
v_mfma_f32_16x16x32_bf16 v[14:17], v[134:137], v[94:97], v[14:17]
ds_read_b128 v[174:177], v4 offset:40960
v_mfma_f32_16x16x32_bf16 v[18:21], v[138:141], v[94:97], v[18:21]
ds_read_b128 v[178:181], v4 offset:41984
v_mfma_f32_16x16x32_bf16 v[22:25], v[142:145], v[94:97], v[22:25]
ds_read_b128 v[182:185], v4 offset:43008
v_mfma_f32_16x16x32_bf16 v[26:29], v[146:149], v[94:97], v[26:29]
ds_read_b128 v[186:189], v4 offset:44032
v_mfma_f32_16x16x32_bf16 v[30:33], v[150:153], v[94:97], v[30:33]
ds_read_b128 v[190:193], v4 offset:45056
buffer_load_dwordx4 v[62:65], v9, s[36:39], s70 offen offset:0 sc1
s_waitcnt vmcnt(11) lgkmcnt(5)
v_mfma_f32_16x16x32_bf16 v[14:17], v[154:157], v[98:101], v[14:17]
ds_read_b128 v[134:137], v4 offset:46080
v_mfma_f32_16x16x32_bf16 v[18:21], v[158:161], v[98:101], v[18:21]
ds_read_b128 v[138:141], v4 offset:47104
v_mfma_f32_16x16x32_bf16 v[22:25], v[162:165], v[98:101], v[22:25]
ds_read_b128 v[142:145], v4 offset:48128
v_mfma_f32_16x16x32_bf16 v[26:29], v[166:169], v[98:101], v[26:29]
ds_read_b128 v[146:149], v4 offset:49152
v_mfma_f32_16x16x32_bf16 v[30:33], v[170:173], v[98:101], v[30:33]
ds_read_b128 v[150:153], v4 offset:50176
buffer_load_dwordx4 v[66:69], v9, s[36:39], s70 offen offset:2048 sc1
s_waitcnt vmcnt(11) lgkmcnt(5)
s_add_u32 s70, s62, 90112
v_mfma_f32_16x16x32_bf16 v[14:17], v[174:177], v[102:105], v[14:17]
ds_read_b128 v[154:157], v4 offset:51200
v_mfma_f32_16x16x32_bf16 v[18:21], v[178:181], v[102:105], v[18:21]
ds_read_b128 v[158:161], v4 offset:52224
v_mfma_f32_16x16x32_bf16 v[22:25], v[182:185], v[102:105], v[22:25]
ds_read_b128 v[162:165], v4 offset:53248
v_mfma_f32_16x16x32_bf16 v[26:29], v[186:189], v[102:105], v[26:29]
ds_read_b128 v[166:169], v4 offset:54272
v_mfma_f32_16x16x32_bf16 v[30:33], v[190:193], v[102:105], v[30:33]
ds_read_b128 v[170:173], v4 offset:55296
buffer_load_dwordx4 v[70:73], v10, s[36:39], s70 offen offset:0 sc1
s_waitcnt vmcnt(11) lgkmcnt(5)
v_mfma_f32_16x16x32_bf16 v[14:17], v[134:137], v[106:109], v[14:17]
ds_read_b128 v[174:177], v4 offset:56320
v_mfma_f32_16x16x32_bf16 v[18:21], v[138:141], v[106:109], v[18:21]
ds_read_b128 v[178:181], v4 offset:57344
v_mfma_f32_16x16x32_bf16 v[22:25], v[142:145], v[106:109], v[22:25]
ds_read_b128 v[182:185], v4 offset:58368
v_mfma_f32_16x16x32_bf16 v[26:29], v[146:149], v[106:109], v[26:29]
ds_read_b128 v[186:189], v4 offset:59392
v_mfma_f32_16x16x32_bf16 v[30:33], v[150:153], v[106:109], v[30:33]
ds_read_b128 v[190:193], v4 offset:60416
buffer_load_dwordx4 v[74:77], v10, s[36:39], s70 offen offset:2048 sc1
s_waitcnt vmcnt(11) lgkmcnt(5)
s_barrier
v_mfma_f32_16x16x32_bf16 v[14:17], v[154:157], v[110:113], v[14:17]
ds_read_b128 v[134:137], v5 offset:0
v_mfma_f32_16x16x32_bf16 v[18:21], v[158:161], v[110:113], v[18:21]
ds_read_b128 v[138:141], v5 offset:1024
v_mfma_f32_16x16x32_bf16 v[22:25], v[162:165], v[110:113], v[22:25]
ds_read_b128 v[142:145], v5 offset:2048
v_mfma_f32_16x16x32_bf16 v[26:29], v[166:169], v[110:113], v[26:29]
ds_read_b128 v[146:149], v5 offset:3072
v_mfma_f32_16x16x32_bf16 v[30:33], v[170:173], v[110:113], v[30:33]
ds_read_b128 v[150:153], v5 offset:4096
buffer_load_dwordx4 v[78:81], v9, s[36:39], s70 offen offset:0 sc1
s_waitcnt vmcnt(11) lgkmcnt(5)
v_mfma_f32_16x16x32_bf16 v[14:17], v[174:177], v[114:117], v[14:17]
ds_read_b128 v[154:157], v5 offset:5120
v_mfma_f32_16x16x32_bf16 v[18:21], v[178:181], v[114:117], v[18:21]
ds_read_b128 v[158:161], v5 offset:6144
v_mfma_f32_16x16x32_bf16 v[22:25], v[182:185], v[114:117], v[22:25]
ds_read_b128 v[162:165], v5 offset:7168
v_mfma_f32_16x16x32_bf16 v[26:29], v[186:189], v[114:117], v[26:29]
ds_read_b128 v[166:169], v5 offset:8192
v_mfma_f32_16x16x32_bf16 v[30:33], v[190:193], v[114:117], v[30:33]
ds_read_b128 v[170:173], v5 offset:9216
buffer_load_dwordx4 v[82:85], v9, s[36:39], s70 offen offset:2048 sc1
s_waitcnt vmcnt(11) lgkmcnt(5)
v_mfma_f32_16x16x32_bf16 v[14:17], v[134:137], v[118:121], v[14:17]
ds_read_b128 v[174:177], v5 offset:10240
v_mfma_f32_16x16x32_bf16 v[18:21], v[138:141], v[118:121], v[18:21]
ds_read_b128 v[178:181], v5 offset:11264
v_mfma_f32_16x16x32_bf16 v[22:25], v[142:145], v[118:121], v[22:25]
ds_read_b128 v[182:185], v5 offset:12288
v_mfma_f32_16x16x32_bf16 v[26:29], v[146:149], v[118:121], v[26:29]
ds_read_b128 v[186:189], v5 offset:13312
v_mfma_f32_16x16x32_bf16 v[30:33], v[150:153], v[118:121], v[30:33]
ds_read_b128 v[190:193], v5 offset:14336
s_waitcnt vmcnt(10) lgkmcnt(5)
v_mfma_f32_16x16x32_bf16 v[14:17], v[154:157], v[122:125], v[14:17]
ds_read_b128 v[134:137], v5 offset:15360
v_mfma_f32_16x16x32_bf16 v[18:21], v[158:161], v[122:125], v[18:21]
ds_read_b128 v[138:141], v5 offset:16384
v_mfma_f32_16x16x32_bf16 v[22:25], v[162:165], v[122:125], v[22:25]
ds_read_b128 v[142:145], v5 offset:17408
v_mfma_f32_16x16x32_bf16 v[26:29], v[166:169], v[122:125], v[26:29]
ds_read_b128 v[146:149], v5 offset:18432
v_mfma_f32_16x16x32_bf16 v[30:33], v[170:173], v[122:125], v[30:33]
ds_read_b128 v[150:153], v5 offset:19456
s_waitcnt vmcnt(9) lgkmcnt(5)
s_barrier
v_mfma_f32_16x16x32_bf16 v[14:17], v[174:177], v[126:129], v[14:17]
ds_read_b128 v[154:157], v5 offset:20480
v_mfma_f32_16x16x32_bf16 v[18:21], v[178:181], v[126:129], v[18:21]
ds_read_b128 v[158:161], v5 offset:21504
v_mfma_f32_16x16x32_bf16 v[22:25], v[182:185], v[126:129], v[22:25]
ds_read_b128 v[162:165], v5 offset:22528
v_mfma_f32_16x16x32_bf16 v[26:29], v[186:189], v[126:129], v[26:29]
ds_read_b128 v[166:169], v5 offset:23552
v_mfma_f32_16x16x32_bf16 v[30:33], v[190:193], v[126:129], v[30:33]
ds_read_b128 v[170:173], v5 offset:24576
s_waitcnt vmcnt(8) lgkmcnt(5)
v_mfma_f32_16x16x32_bf16 v[14:17], v[134:137], v[130:133], v[14:17]
ds_read_b128 v[174:177], v5 offset:25600
v_mfma_f32_16x16x32_bf16 v[18:21], v[138:141], v[130:133], v[18:21]
ds_read_b128 v[178:181], v5 offset:26624
v_mfma_f32_16x16x32_bf16 v[22:25], v[142:145], v[130:133], v[22:25]
ds_read_b128 v[182:185], v5 offset:27648
v_mfma_f32_16x16x32_bf16 v[26:29], v[146:149], v[130:133], v[26:29]
ds_read_b128 v[186:189], v5 offset:28672
v_mfma_f32_16x16x32_bf16 v[30:33], v[150:153], v[130:133], v[30:33]
ds_read_b128 v[190:193], v5 offset:29696
s_waitcnt vmcnt(7) lgkmcnt(5)
v_mfma_f32_16x16x32_bf16 v[14:17], v[154:157], v[54:57], v[14:17]
ds_read_b128 v[134:137], v5 offset:30720
v_lshlrev_b32 v34, 16, v220
v_mfma_f32_16x16x32_bf16 v[18:21], v[158:161], v[54:57], v[18:21]
ds_read_b128 v[138:141], v5 offset:31744
v_and_b32 v35, s68, v220
v_mfma_f32_16x16x32_bf16 v[22:25], v[162:165], v[54:57], v[22:25]
ds_read_b128 v[142:145], v5 offset:32768
v_lshlrev_b32 v36, 16, v221
v_mfma_f32_16x16x32_bf16 v[26:29], v[166:169], v[54:57], v[26:29]
ds_read_b128 v[146:149], v5 offset:33792
v_and_b32 v37, s68, v221
v_mfma_f32_16x16x32_bf16 v[30:33], v[170:173], v[54:57], v[30:33]
ds_read_b128 v[150:153], v5 offset:34816
v_lshlrev_b32 v38, 16, v222
s_waitcnt vmcnt(6) lgkmcnt(5)
v_mfma_f32_16x16x32_bf16 v[14:17], v[174:177], v[58:61], v[14:17]
ds_read_b128 v[154:157], v5 offset:35840
v_and_b32 v39, s68, v222
v_mfma_f32_16x16x32_bf16 v[18:21], v[178:181], v[58:61], v[18:21]
ds_read_b128 v[158:161], v5 offset:36864
v_lshlrev_b32 v40, 16, v223
v_mfma_f32_16x16x32_bf16 v[22:25], v[182:185], v[58:61], v[22:25]
ds_read_b128 v[162:165], v5 offset:37888
v_and_b32 v41, s68, v223
v_mfma_f32_16x16x32_bf16 v[26:29], v[186:189], v[58:61], v[26:29]
ds_read_b128 v[166:169], v5 offset:38912
v_lshlrev_b32 v42, 16, v224
v_mfma_f32_16x16x32_bf16 v[30:33], v[190:193], v[58:61], v[30:33]
ds_read_b128 v[170:173], v5 offset:39936
v_and_b32 v43, s68, v224
s_waitcnt vmcnt(5) lgkmcnt(5)
s_barrier
v_mfma_f32_16x16x32_bf16 v[14:17], v[134:137], v[62:65], v[14:17]
ds_read_b128 v[174:177], v5 offset:40960
v_lshlrev_b32 v44, 16, v225
v_mfma_f32_16x16x32_bf16 v[18:21], v[138:141], v[62:65], v[18:21]
ds_read_b128 v[178:181], v5 offset:41984
v_and_b32 v45, s68, v225
v_mfma_f32_16x16x32_bf16 v[22:25], v[142:145], v[62:65], v[22:25]
ds_read_b128 v[182:185], v5 offset:43008
v_lshlrev_b32 v46, 16, v226
v_mfma_f32_16x16x32_bf16 v[26:29], v[146:149], v[62:65], v[26:29]
ds_read_b128 v[186:189], v5 offset:44032
v_and_b32 v47, s68, v226
v_mfma_f32_16x16x32_bf16 v[30:33], v[150:153], v[62:65], v[30:33]
ds_read_b128 v[190:193], v5 offset:45056
v_lshlrev_b32 v48, 16, v227
s_waitcnt vmcnt(4) lgkmcnt(5)
v_mfma_f32_16x16x32_bf16 v[14:17], v[154:157], v[66:69], v[14:17]
ds_read_b128 v[134:137], v5 offset:46080
v_and_b32 v49, s68, v227
v_mfma_f32_16x16x32_bf16 v[18:21], v[158:161], v[66:69], v[18:21]
ds_read_b128 v[138:141], v5 offset:47104
v_lshlrev_b32 v50, 16, v228
v_mfma_f32_16x16x32_bf16 v[22:25], v[162:165], v[66:69], v[22:25]
ds_read_b128 v[142:145], v5 offset:48128
v_and_b32 v51, s68, v228
v_mfma_f32_16x16x32_bf16 v[26:29], v[166:169], v[66:69], v[26:29]
ds_read_b128 v[146:149], v5 offset:49152
v_lshlrev_b32 v52, 16, v229
v_mfma_f32_16x16x32_bf16 v[30:33], v[170:173], v[66:69], v[30:33]
ds_read_b128 v[150:153], v5 offset:50176
v_and_b32 v53, s68, v229
s_waitcnt vmcnt(3) lgkmcnt(5)
v_mfma_f32_16x16x32_bf16 v[14:17], v[174:177], v[70:73], v[14:17]
ds_read_b128 v[154:157], v5 offset:51200
v_add_f32 v200, v200, v202
v_mfma_f32_16x16x32_bf16 v[18:21], v[178:181], v[70:73], v[18:21]
ds_read_b128 v[158:161], v5 offset:52224
v_add_f32 v201, v201, v203
v_mfma_f32_16x16x32_bf16 v[22:25], v[182:185], v[70:73], v[22:25]
ds_read_b128 v[162:165], v5 offset:53248
v_add_f32 v200, v200, v204
v_mfma_f32_16x16x32_bf16 v[26:29], v[186:189], v[70:73], v[26:29]
ds_read_b128 v[166:169], v5 offset:54272
v_add_f32 v201, v201, v205
v_mfma_f32_16x16x32_bf16 v[30:33], v[190:193], v[70:73], v[30:33]
ds_read_b128 v[170:173], v5 offset:55296
v_add_f32 v200, v200, v206
s_waitcnt vmcnt(2) lgkmcnt(5)
v_mfma_f32_16x16x32_bf16 v[14:17], v[134:137], v[74:77], v[14:17]
ds_read_b128 v[174:177], v5 offset:56320
v_add_f32 v201, v201, v207
v_mfma_f32_16x16x32_bf16 v[18:21], v[138:141], v[74:77], v[18:21]
ds_read_b128 v[178:181], v5 offset:57344
v_add_f32 v200, v200, v208
v_mfma_f32_16x16x32_bf16 v[22:25], v[142:145], v[74:77], v[22:25]
ds_read_b128 v[182:185], v5 offset:58368
v_add_f32 v201, v201, v209
v_mfma_f32_16x16x32_bf16 v[26:29], v[146:149], v[74:77], v[26:29]
ds_read_b128 v[186:189], v5 offset:59392
v_add_f32 v200, v200, v210
v_mfma_f32_16x16x32_bf16 v[30:33], v[150:153], v[74:77], v[30:33]
ds_read_b128 v[190:193], v5 offset:60416
v_add_f32 v201, v201, v211
s_waitcnt vmcnt(1) lgkmcnt(5)
v_mfma_f32_16x16x32_bf16 v[14:17], v[154:157], v[78:81], v[14:17]
v_add_f32 v200, v200, v212
v_add_f32 v201, v201, v213
v_mfma_f32_16x16x32_bf16 v[18:21], v[158:161], v[78:81], v[18:21]
v_add_f32 v200, v200, v214
v_add_f32 v201, v201, v215
v_mfma_f32_16x16x32_bf16 v[22:25], v[162:165], v[78:81], v[22:25]
v_mul_f32 v202, 0x3acccccd, v200
v_mul_f32 v201, 0x3acccccd, v201
v_mfma_f32_16x16x32_bf16 v[26:29], v[166:169], v[78:81], v[26:29]
v_fma_f32 v201, -v202, v202, v201
v_max_f32 v201, 0, v201
v_mfma_f32_16x16x32_bf16 v[30:33], v[170:173], v[78:81], v[30:33]
v_add_f32 v201, 0x3727c5ac, v201
v_rsq_f32 v203, v201
s_waitcnt vmcnt(0) lgkmcnt(0)
s_barrier
v_mfma_f32_16x16x32_bf16 v[14:17], v[174:177], v[82:85], v[14:17]
s_nop 0
v_mul_f32 v202, v203, v203
v_mfma_f32_16x16x32_bf16 v[18:21], v[178:181], v[82:85], v[18:21]
v_mfma_f32_16x16x32_bf16 v[22:25], v[182:185], v[82:85], v[22:25]
v_mfma_f32_16x16x32_bf16 v[26:29], v[186:189], v[82:85], v[26:29]
v_mfma_f32_16x16x32_bf16 v[30:33], v[190:193], v[82:85], v[30:33]
s_add_u32 s67, s64, 10485760
s_lshl_b32 s80, s13, 3
s_add_u32 s80, s80, s6
s_lshl_b32 s80, s80, 2
s_add_u32 s80, s80, 51798016
s_add_u32 s81, s8, 6
v_mov_b32 v1, 0
v_mov_b32 v2, s81
v_pk_fma_f32 v[14:15], v[14:15], v[202:203], v[34:35] op_sel_hi:[1,0,1]
v_cvt_pk_bf16_f32 v60, v14, v15
v_pk_fma_f32 v[16:17], v[16:17], v[202:203], v[36:37] op_sel_hi:[1,0,1]
v_cvt_pk_bf16_f32 v61, v16, v17
v_pk_fma_f32 v[18:19], v[18:19], v[202:203], v[38:39] op_sel_hi:[1,0,1]
v_cvt_pk_bf16_f32 v62, v18, v19
v_pk_fma_f32 v[20:21], v[20:21], v[202:203], v[40:41] op_sel_hi:[1,0,1]
v_cvt_pk_bf16_f32 v63, v20, v21
v_pk_fma_f32 v[22:23], v[22:23], v[202:203], v[42:43] op_sel_hi:[1,0,1]
v_cvt_pk_bf16_f32 v64, v22, v23
v_pk_fma_f32 v[24:25], v[24:25], v[202:203], v[44:45] op_sel_hi:[1,0,1]
v_cvt_pk_bf16_f32 v65, v24, v25
v_pk_fma_f32 v[26:27], v[26:27], v[202:203], v[46:47] op_sel_hi:[1,0,1]
v_cvt_pk_bf16_f32 v66, v26, v27
v_pk_fma_f32 v[28:29], v[28:29], v[202:203], v[48:49] op_sel_hi:[1,0,1]
v_cvt_pk_bf16_f32 v67, v28, v29
v_pk_fma_f32 v[30:31], v[30:31], v[202:203], v[50:51] op_sel_hi:[1,0,1]
v_cvt_pk_bf16_f32 v68, v30, v31
v_pk_fma_f32 v[32:33], v[32:33], v[202:203], v[52:53] op_sel_hi:[1,0,1]
v_cvt_pk_bf16_f32 v69, v32, v33
s_cmp_eq_u32 s3, 0
s_cbranch_scc1 prj_o1_112
s_mov_b32 s56, s30
s_mov_b32 s57, s31
s_mov_b32 s58, 2621440
s_mov_b32 s59, 0x20000
buffer_store_dwordx4 v[60:63], v12, s[56:59], s65 offen
buffer_store_dwordx4 v[64:67], v12, s[56:59], s65 offen offset:64
buffer_store_dwordx2 v[68:69], v13, s[56:59], s65 offen offset:128
s_branch L_end
prj_o1_112:
buffer_store_dwordx4 v[60:63], v10, s[36:39], s67 offen
buffer_store_dwordx4 v[64:67], v10, s[36:39], s67 offen offset:2048
buffer_store_dwordx2 v[68:69], v11, s[36:39], s67 offen offset:0
v_pk_add_f32 v[72:73], v[14:15], v[16:17]
v_pk_mul_f32 v[74:75], v[14:15], v[14:15]
v_pk_fma_f32 v[74:75], v[16:17], v[16:17], v[74:75]
v_pk_add_f32 v[72:73], v[72:73], v[18:19]
v_pk_fma_f32 v[74:75], v[18:19], v[18:19], v[74:75]
v_pk_add_f32 v[72:73], v[72:73], v[20:21]
v_pk_fma_f32 v[74:75], v[20:21], v[20:21], v[74:75]
v_pk_add_f32 v[72:73], v[72:73], v[22:23]
v_pk_fma_f32 v[74:75], v[22:23], v[22:23], v[74:75]
v_pk_add_f32 v[72:73], v[72:73], v[24:25]
v_pk_fma_f32 v[74:75], v[24:25], v[24:25], v[74:75]
v_pk_add_f32 v[72:73], v[72:73], v[26:27]
v_pk_fma_f32 v[74:75], v[26:27], v[26:27], v[74:75]
v_pk_add_f32 v[72:73], v[72:73], v[28:29]
v_pk_fma_f32 v[74:75], v[28:29], v[28:29], v[74:75]
v_pk_add_f32 v[72:73], v[72:73], v[30:31]
v_pk_fma_f32 v[74:75], v[30:31], v[30:31], v[74:75]
v_pk_add_f32 v[72:73], v[72:73], v[32:33]
v_pk_fma_f32 v[74:75], v[32:33], v[32:33], v[74:75]
v_add_f32 v72, v72, v73
v_add_f32 v73, v74, v75
s_lshr_b32 s67, s61, 1
s_lshl_b32 s67, s67, 10
v_permlane32_swap_b32 v72, v73
s_and_b32 s68, s61, 1
s_lshl_b32 s68, s68, 3
v_add_f32 v72, v72, v73
v_mov_b32 v73, v72
s_add_u32 s67, s67, s68
s_add_u32 s67, s67, s72
v_permlane16_swap_b32 v72, v73
s_add_u32 s67, s67, 22151168
v_lshrrev_b32 v8, 5, v0
v_lshlrev_b32 v8, 2, v8
v_lshl_add_u32 v8, v3, 4, v8
v_add_f32 v72, v72, v73
buffer_store_dword v72, v8, s[36:39], s67 offen
s_waitcnt vmcnt(1)
s_mov_b64 exec, 1
buffer_store_dword v2, v1, s[36:39], s80 offen
s_mov_b64 exec, -1
s_barrier
v_add_u32 v253, 1, v2
v_mov_b32 v252, 0
s_mov_b32 s100, s80
s_lshr_b32 s60, s13, 4
s_and_b32 s61, s5, 15
s_cmp_lg_u32 s61, 15
s_cbranch_scc1 L_fast_q2
s_waitcnt vmcnt(0)
s_mov_b64 exec, 1
buffer_store_dword v253, v252, s[36:39], s100 offen
s_mov_b64 exec, -1
s_branch L_fast_idle
L_fast_q2:
s_mul_i32 s62, s61, 52
s_lshr_b32 s62, s62, 8
s_mul_i32 s63, s62, 5
s_sub_u32 s63, s61, s63
s_lshl_b32 s63, s63, 7
s_and_b32 s65, s6, 1
s_lshr_b32 s66, s6, 1
v_lshrrev_b32 v14, 4, v0
v_and_b32 v15, 15, v0
s_lshl_b32 s75, s13, 9
s_lshl_b32 s67, s66, 8
s_add_u32 s75, s75, s67
s_add_u32 s75, s75, 51666944
v_lshlrev_b32 v210, 4, v14
v_lshlrev_b32 v211, 2, v15
s_lshl_b32 s67, s65, 13
v_lshlrev_b32 v2, 4, v15
v_lshl_add_u32 v2, v14, 9, v2
v_add_u32 v2, s67, v2
v_bfe_u32 v12, v0, 2, 2
v_lshl_add_u32 v13, v14, 3, v12
v_lshlrev_b32 v13, 8, v13
v_and_b32 v1, 3, v0
v_lshl_add_u32 v13, v1, 3, v13
v_add_u32 v13, 65536, v13
v_bfe_u32 v12, v0, 2, 3
s_lshl_b32 s67, s66, 2
v_xor_b32 v12, s67, v12
v_xor_b32 v1, 0, v12
v_lshl_add_u32 v4, v1, 5, v13
v_add_u32 v8, 49152, v4
v_xor_b32 v1, 1, v12
v_lshl_add_u32 v5, v1, 5, v13
v_add_u32 v9, 49152, v5
v_xor_b32 v1, 2, v12
v_lshl_add_u32 v6, v1, 5, v13
v_add_u32 v10, 49152, v6
v_xor_b32 v1, 3, v12
v_lshl_add_u32 v7, v1, 5, v13
v_add_u32 v11, 49152, v7
s_cmp_eq_u32 s62, 2
s_cbranch_scc1 qkv_v_113
s_mul_i32 s72, s62, 2621440
s_lshl_b32 s68, s60, 2
s_lshl_b32 s67, s65, 1
s_add_u32 s68, s68, s67
s_mul_i32 s68, s68, 1280
s_add_u32 s72, s72, s68
s_add_u32 s72, s72, 22315008
s_lshr_b32 s68, s63, 3
s_lshl_b32 s67, s66, 3
s_add_u32 s68, s68, s67
v_lshrrev_b32 v80, 5, v0
v_add_u32 v80, s68, v80
v_and_b32 v87, 31, v0
s_mov_b32 s73, 81920
v_mov_b32 v86, 0x7fffffff
s_mov_b32 s71, 0
s_add_u32 s96, s72, 1280
s_lshl_b32 s68, s60, 1
s_add_u32 s68, s68, s65
s_mul_i32 s68, s68, 196608
s_add_u32 s68, s68, 57344
s_add_u32 s67, s68, 98304
s_cmp_eq_u32 s62, 0
s_cselect_b32 s72, s68, s72
s_cselect_b32 s96, s67, s96
s_cselect_b32 s73, 1280, s73
s_add_u32 s74, s72, s73
s_add_u32 s97, s96, s73
v_add_u32 v81, 0, v80
v_mul_u32_u24 v82, 205, v81
v_lshrrev_b32 v82, 10, v82
v_mad_i32_i24 v81, v82, -5, v81
v_cmp_lt_u32 vcc, 2, v81
v_lshlrev_b32 v82, 1, v82
v_add_u32 v83, -3, v81
v_cndmask_b32 v83, v81, v83, vcc
v_addc_co_u32 v82, vcc, 0, v82, vcc
v_lshlrev_b32 v83, 9, v83
v_lshl_add_u32 v83, v87, 4, v83
v_lshlrev_b32 v85, 3, v87
v_add_u32 v85, 1024, v85
v_cmp_eq_u32 vcc, 2, v81
v_mul_lo_u32 v84, v82, s73
s_cmp_lg_u64 vcc, 0
v_cndmask_b32 v83, v83, v86, vcc
v_cndmask_b32 v85, v86, v85, vcc
s_cselect_b32 s67, 1, 0
s_or_b32 s71, s71, s67
v_add_u32 v202, v83, v84
v_add_u32 v206, v85, v84
v_add_u32 v81, 2, v80
v_mul_u32_u24 v82, 205, v81
v_lshrrev_b32 v82, 10, v82
v_mad_i32_i24 v81, v82, -5, v81
v_cmp_lt_u32 vcc, 2, v81
v_lshlrev_b32 v82, 1, v82
v_add_u32 v83, -3, v81
v_cndmask_b32 v83, v81, v83, vcc
v_addc_co_u32 v82, vcc, 0, v82, vcc
v_lshlrev_b32 v83, 9, v83
v_lshl_add_u32 v83, v87, 4, v83
v_lshlrev_b32 v85, 3, v87
v_add_u32 v85, 1024, v85
v_cmp_eq_u32 vcc, 2, v81
v_mul_lo_u32 v84, v82, s73
s_cmp_lg_u64 vcc, 0
v_cndmask_b32 v83, v83, v86, vcc
v_cndmask_b32 v85, v86, v85, vcc
s_cselect_b32 s67, 2, 0
s_or_b32 s71, s71, s67
v_add_u32 v203, v83, v84
v_add_u32 v207, v85, v84
v_add_u32 v81, 4, v80
v_mul_u32_u24 v82, 205, v81
v_lshrrev_b32 v82, 10, v82
v_mad_i32_i24 v81, v82, -5, v81
v_cmp_lt_u32 vcc, 2, v81
v_lshlrev_b32 v82, 1, v82
v_add_u32 v83, -3, v81
v_cndmask_b32 v83, v81, v83, vcc
v_addc_co_u32 v82, vcc, 0, v82, vcc
v_lshlrev_b32 v83, 9, v83
v_lshl_add_u32 v83, v87, 4, v83
v_lshlrev_b32 v85, 3, v87
v_add_u32 v85, 1024, v85
v_cmp_eq_u32 vcc, 2, v81
v_mul_lo_u32 v84, v82, s73
s_cmp_lg_u64 vcc, 0
v_cndmask_b32 v83, v83, v86, vcc
v_cndmask_b32 v85, v86, v85, vcc
s_cselect_b32 s67, 4, 0
s_or_b32 s71, s71, s67
v_add_u32 v204, v83, v84
v_add_u32 v208, v85, v84
v_add_u32 v81, 6, v80
v_mul_u32_u24 v82, 205, v81
v_lshrrev_b32 v82, 10, v82
v_mad_i32_i24 v81, v82, -5, v81
v_cmp_lt_u32 vcc, 2, v81
v_lshlrev_b32 v82, 1, v82
v_add_u32 v83, -3, v81
v_cndmask_b32 v83, v81, v83, vcc
v_addc_co_u32 v82, vcc, 0, v82, vcc
v_lshlrev_b32 v83, 9, v83
v_lshl_add_u32 v83, v87, 4, v83
v_lshlrev_b32 v85, 3, v87
v_add_u32 v85, 1024, v85
v_cmp_eq_u32 vcc, 2, v81
v_mul_lo_u32 v84, v82, s73
s_cmp_lg_u64 vcc, 0
v_cndmask_b32 v83, v83, v86, vcc
v_cndmask_b32 v85, v86, v85, vcc
s_cselect_b32 s67, 8, 0
s_or_b32 s71, s71, s67
v_add_u32 v205, v83, v84
v_add_u32 v209, v85, v84
s_cmp_eq_u32 s62, 0
s_cselect_b32 s70, 0x3ea52b5c, 1.0
s_lshl_b32 s69, s60, 1
s_add_u32 s69, s69, s65
s_lshl_b32 s69, s69, 12
s_add_u32 s69, s69, 22151168
v_lshlrev_b32 v3, 4, v0
s_waitcnt vmcnt(0)
s_mov_b64 exec, 1
buffer_store_dword v253, v252, s[36:39], s100 offen
s_mov_b64 exec, -1
s_barrier
ds_read_b128 v[16:19], v2 offset:0
ds_read_b128 v[20:23], v2 offset:256
ds_read_b128 v[24:27], v2 offset:4096
ds_read_b128 v[28:31], v2 offset:4352
ds_read_b64_tr_b16 v[32:33], v8 offset:16384
ds_read_b64_tr_b16 v[34:35], v8 offset:17408
ds_read_b64_tr_b16 v[36:37], v9 offset:16384
ds_read_b64_tr_b16 v[38:39], v9 offset:17408
ds_read_b64_tr_b16 v[40:41], v10 offset:16384
ds_read_b64_tr_b16 v[42:43], v10 offset:17408
ds_read_b64_tr_b16 v[44:45], v11 offset:16384
ds_read_b64_tr_b16 v[46:47], v11 offset:17408
s_waitcnt lgkmcnt(0)
v_mfma_f32_16x16x32_bf16 v[128:131], v[32:35], v[16:19], 0
ds_read_b128 v[48:51], v2 offset:2048
ds_read_b128 v[52:55], v2 offset:2304
v_mfma_f32_16x16x32_bf16 v[132:135], v[32:35], v[20:23], 0
ds_read_b128 v[56:59], v2 offset:6144
v_mfma_f32_16x16x32_bf16 v[136:139], v[32:35], v[24:27], 0
ds_read_b128 v[60:63], v2 offset:6400
v_mfma_f32_16x16x32_bf16 v[140:143], v[32:35], v[28:31], 0
ds_read_b64_tr_b16 v[64:65], v8 offset:24576
v_mfma_f32_16x16x32_bf16 v[144:147], v[36:39], v[16:19], 0
ds_read_b64_tr_b16 v[66:67], v8 offset:25600
v_mfma_f32_16x16x32_bf16 v[148:151], v[36:39], v[20:23], 0
ds_read_b64_tr_b16 v[68:69], v9 offset:24576
ds_read_b64_tr_b16 v[70:71], v9 offset:25600
v_mfma_f32_16x16x32_bf16 v[152:155], v[36:39], v[24:27], 0
ds_read_b64_tr_b16 v[72:73], v10 offset:24576
v_mfma_f32_16x16x32_bf16 v[156:159], v[36:39], v[28:31], 0
ds_read_b64_tr_b16 v[74:75], v10 offset:25600
v_mfma_f32_16x16x32_bf16 v[160:163], v[40:43], v[16:19], 0
ds_read_b64_tr_b16 v[76:77], v11 offset:24576
v_mfma_f32_16x16x32_bf16 v[164:167], v[40:43], v[20:23], 0
ds_read_b64_tr_b16 v[78:79], v11 offset:25600
v_mfma_f32_16x16x32_bf16 v[168:171], v[40:43], v[24:27], 0
v_mfma_f32_16x16x32_bf16 v[172:175], v[40:43], v[28:31], 0
v_mfma_f32_16x16x32_bf16 v[176:179], v[44:47], v[16:19], 0
v_mfma_f32_16x16x32_bf16 v[180:183], v[44:47], v[20:23], 0
v_mfma_f32_16x16x32_bf16 v[184:187], v[44:47], v[24:27], 0
s_waitcnt lgkmcnt(0)
v_mfma_f32_16x16x32_bf16 v[188:191], v[44:47], v[28:31], 0
s_barrier
v_mfma_f32_16x16x32_bf16 v[128:131], v[64:67], v[48:51], v[128:131]
ds_read_b128 v[16:19], v2 offset:16384
ds_read_b128 v[20:23], v2 offset:16640
v_mfma_f32_16x16x32_bf16 v[132:135], v[64:67], v[52:55], v[132:135]
ds_read_b128 v[24:27], v2 offset:20480
v_mfma_f32_16x16x32_bf16 v[136:139], v[64:67], v[56:59], v[136:139]
ds_read_b128 v[28:31], v2 offset:20736
v_mfma_f32_16x16x32_bf16 v[140:143], v[64:67], v[60:63], v[140:143]
ds_read_b64_tr_b16 v[32:33], v8 offset:32768
v_mfma_f32_16x16x32_bf16 v[144:147], v[68:71], v[48:51], v[144:147]
ds_read_b64_tr_b16 v[34:35], v8 offset:33792
v_mfma_f32_16x16x32_bf16 v[148:151], v[68:71], v[52:55], v[148:151]
ds_read_b64_tr_b16 v[36:37], v9 offset:32768
ds_read_b64_tr_b16 v[38:39], v9 offset:33792
v_mfma_f32_16x16x32_bf16 v[152:155], v[68:71], v[56:59], v[152:155]
ds_read_b64_tr_b16 v[40:41], v10 offset:32768
v_mfma_f32_16x16x32_bf16 v[156:159], v[68:71], v[60:63], v[156:159]
ds_read_b64_tr_b16 v[42:43], v10 offset:33792
v_mfma_f32_16x16x32_bf16 v[160:163], v[72:75], v[48:51], v[160:163]
ds_read_b64_tr_b16 v[44:45], v11 offset:32768
v_mfma_f32_16x16x32_bf16 v[164:167], v[72:75], v[52:55], v[164:167]
ds_read_b64_tr_b16 v[46:47], v11 offset:33792
v_mfma_f32_16x16x32_bf16 v[168:171], v[72:75], v[56:59], v[168:171]
buffer_load_dwordx4 v[96:99], v210, s[36:39], s75 offen offset:0 sc1
v_mfma_f32_16x16x32_bf16 v[172:175], v[72:75], v[60:63], v[172:175]
buffer_load_dwordx4 v[100:103], v210, s[36:39], s75 offen offset:64 sc1
v_mfma_f32_16x16x32_bf16 v[176:179], v[76:79], v[48:51], v[176:179]
buffer_load_dwordx4 v[104:107], v210, s[36:39], s75 offen offset:128 sc1
v_mfma_f32_16x16x32_bf16 v[180:183], v[76:79], v[52:55], v[180:183]
buffer_load_dwordx4 v[108:111], v210, s[36:39], s75 offen offset:192 sc1
v_mfma_f32_16x16x32_bf16 v[184:187], v[76:79], v[56:59], v[184:187]
v_mfma_f32_16x16x32_bf16 v[188:191], v[76:79], v[60:63], v[188:191]
s_waitcnt lgkmcnt(0)
v_mfma_f32_16x16x32_bf16 v[128:131], v[32:35], v[16:19], v[128:131]
ds_read_b128 v[48:51], v2 offset:18432
ds_read_b128 v[52:55], v2 offset:18688
v_mfma_f32_16x16x32_bf16 v[132:135], v[32:35], v[20:23], v[132:135]
ds_read_b128 v[56:59], v2 offset:22528
v_mfma_f32_16x16x32_bf16 v[136:139], v[32:35], v[24:27], v[136:139]
ds_read_b128 v[60:63], v2 offset:22784
v_mfma_f32_16x16x32_bf16 v[140:143], v[32:35], v[28:31], v[140:143]
ds_read_b64_tr_b16 v[64:65], v8 offset:40960
v_mfma_f32_16x16x32_bf16 v[144:147], v[36:39], v[16:19], v[144:147]
ds_read_b64_tr_b16 v[66:67], v8 offset:41984
v_mfma_f32_16x16x32_bf16 v[148:151], v[36:39], v[20:23], v[148:151]
ds_read_b64_tr_b16 v[68:69], v9 offset:40960
ds_read_b64_tr_b16 v[70:71], v9 offset:41984
v_mfma_f32_16x16x32_bf16 v[152:155], v[36:39], v[24:27], v[152:155]
ds_read_b64_tr_b16 v[72:73], v10 offset:40960
v_mfma_f32_16x16x32_bf16 v[156:159], v[36:39], v[28:31], v[156:159]
ds_read_b64_tr_b16 v[74:75], v10 offset:41984
v_mfma_f32_16x16x32_bf16 v[160:163], v[40:43], v[16:19], v[160:163]
ds_read_b64_tr_b16 v[76:77], v11 offset:40960
v_mfma_f32_16x16x32_bf16 v[164:167], v[40:43], v[20:23], v[164:167]
ds_read_b64_tr_b16 v[78:79], v11 offset:41984
v_mfma_f32_16x16x32_bf16 v[168:171], v[40:43], v[24:27], v[168:171]
v_mfma_f32_16x16x32_bf16 v[172:175], v[40:43], v[28:31], v[172:175]
v_mfma_f32_16x16x32_bf16 v[176:179], v[44:47], v[16:19], v[176:179]
v_mfma_f32_16x16x32_bf16 v[180:183], v[44:47], v[20:23], v[180:183]
v_mfma_f32_16x16x32_bf16 v[184:187], v[44:47], v[24:27], v[184:187]
s_waitcnt lgkmcnt(0)
v_mfma_f32_16x16x32_bf16 v[188:191], v[44:47], v[28:31], v[188:191]
s_barrier
v_mfma_f32_16x16x32_bf16 v[128:131], v[64:67], v[48:51], v[128:131]
ds_read_b128 v[16:19], v2 offset:32768
ds_read_b128 v[20:23], v2 offset:33024
v_mfma_f32_16x16x32_bf16 v[132:135], v[64:67], v[52:55], v[132:135]
ds_read_b128 v[24:27], v2 offset:36864
v_mfma_f32_16x16x32_bf16 v[136:139], v[64:67], v[56:59], v[136:139]
ds_read_b128 v[28:31], v2 offset:37120
v_mfma_f32_16x16x32_bf16 v[140:143], v[64:67], v[60:63], v[140:143]
ds_read_b64_tr_b16 v[32:33], v4 offset:0
v_mfma_f32_16x16x32_bf16 v[144:147], v[68:71], v[48:51], v[144:147]
ds_read_b64_tr_b16 v[34:35], v4 offset:1024
v_mfma_f32_16x16x32_bf16 v[148:151], v[68:71], v[52:55], v[148:151]
ds_read_b64_tr_b16 v[36:37], v5 offset:0
ds_read_b64_tr_b16 v[38:39], v5 offset:1024
v_mfma_f32_16x16x32_bf16 v[152:155], v[68:71], v[56:59], v[152:155]
ds_read_b64_tr_b16 v[40:41], v6 offset:0
v_mfma_f32_16x16x32_bf16 v[156:159], v[68:71], v[60:63], v[156:159]
ds_read_b64_tr_b16 v[42:43], v6 offset:1024
v_mfma_f32_16x16x32_bf16 v[160:163], v[72:75], v[48:51], v[160:163]
ds_read_b64_tr_b16 v[44:45], v7 offset:0
v_mfma_f32_16x16x32_bf16 v[164:167], v[72:75], v[52:55], v[164:167]
ds_read_b64_tr_b16 v[46:47], v7 offset:1024
v_mfma_f32_16x16x32_bf16 v[168:171], v[72:75], v[56:59], v[168:171]
buffer_load_dwordx4 v[80:83], v3, s[36:39], s69 offen offset:0 sc1
v_mfma_f32_16x16x32_bf16 v[172:175], v[72:75], v[60:63], v[172:175]
buffer_load_dwordx4 v[84:87], v3, s[36:39], s69 offen offset:1024 sc1
v_mfma_f32_16x16x32_bf16 v[176:179], v[76:79], v[48:51], v[176:179]
v_mfma_f32_16x16x32_bf16 v[180:183], v[76:79], v[52:55], v[180:183]
v_mfma_f32_16x16x32_bf16 v[184:187], v[76:79], v[56:59], v[184:187]
v_mfma_f32_16x16x32_bf16 v[188:191], v[76:79], v[60:63], v[188:191]
s_waitcnt lgkmcnt(0)
v_mfma_f32_16x16x32_bf16 v[128:131], v[32:35], v[16:19], v[128:131]
ds_read_b128 v[48:51], v2 offset:34816
ds_read_b128 v[52:55], v2 offset:35072
v_mfma_f32_16x16x32_bf16 v[132:135], v[32:35], v[20:23], v[132:135]
ds_read_b128 v[56:59], v2 offset:38912
v_mfma_f32_16x16x32_bf16 v[136:139], v[32:35], v[24:27], v[136:139]
ds_read_b128 v[60:63], v2 offset:39168
v_mfma_f32_16x16x32_bf16 v[140:143], v[32:35], v[28:31], v[140:143]
ds_read_b64_tr_b16 v[64:65], v4 offset:8192
v_mfma_f32_16x16x32_bf16 v[144:147], v[36:39], v[16:19], v[144:147]
ds_read_b64_tr_b16 v[66:67], v4 offset:9216
v_mfma_f32_16x16x32_bf16 v[148:151], v[36:39], v[20:23], v[148:151]
ds_read_b64_tr_b16 v[68:69], v5 offset:8192
ds_read_b64_tr_b16 v[70:71], v5 offset:9216
v_mfma_f32_16x16x32_bf16 v[152:155], v[36:39], v[24:27], v[152:155]
ds_read_b64_tr_b16 v[72:73], v6 offset:8192
v_mfma_f32_16x16x32_bf16 v[156:159], v[36:39], v[28:31], v[156:159]
ds_read_b64_tr_b16 v[74:75], v6 offset:9216
v_mfma_f32_16x16x32_bf16 v[160:163], v[40:43], v[16:19], v[160:163]
ds_read_b64_tr_b16 v[76:77], v7 offset:8192
buffer_load_dwordx4 v[88:91], v3, s[36:39], s69 offen offset:2048 sc1
v_mfma_f32_16x16x32_bf16 v[164:167], v[40:43], v[20:23], v[164:167]
ds_read_b64_tr_b16 v[78:79], v7 offset:9216
buffer_load_dwordx4 v[92:95], v3, s[36:39], s69 offen offset:3072 sc1
v_mfma_f32_16x16x32_bf16 v[168:171], v[40:43], v[24:27], v[168:171]
v_mfma_f32_16x16x32_bf16 v[172:175], v[40:43], v[28:31], v[172:175]
v_mfma_f32_16x16x32_bf16 v[176:179], v[44:47], v[16:19], v[176:179]
v_mfma_f32_16x16x32_bf16 v[180:183], v[44:47], v[20:23], v[180:183]
v_mfma_f32_16x16x32_bf16 v[184:187], v[44:47], v[24:27], v[184:187]
s_waitcnt lgkmcnt(0)
v_mfma_f32_16x16x32_bf16 v[188:191], v[44:47], v[28:31], v[188:191]
s_barrier
v_mfma_f32_16x16x32_bf16 v[128:131], v[64:67], v[48:51], v[128:131]
ds_read_b128 v[16:19], v2 offset:49152
ds_read_b128 v[20:23], v2 offset:49408
v_mfma_f32_16x16x32_bf16 v[132:135], v[64:67], v[52:55], v[132:135]
ds_read_b128 v[24:27], v2 offset:53248
v_mfma_f32_16x16x32_bf16 v[136:139], v[64:67], v[56:59], v[136:139]
ds_read_b128 v[28:31], v2 offset:53504
v_mfma_f32_16x16x32_bf16 v[140:143], v[64:67], v[60:63], v[140:143]
ds_read_b64_tr_b16 v[32:33], v4 offset:16384
v_mfma_f32_16x16x32_bf16 v[144:147], v[68:71], v[48:51], v[144:147]
ds_read_b64_tr_b16 v[34:35], v4 offset:17408
v_mfma_f32_16x16x32_bf16 v[148:151], v[68:71], v[52:55], v[148:151]
ds_read_b64_tr_b16 v[36:37], v5 offset:16384
ds_read_b64_tr_b16 v[38:39], v5 offset:17408
v_mfma_f32_16x16x32_bf16 v[152:155], v[68:71], v[56:59], v[152:155]
ds_read_b64_tr_b16 v[40:41], v6 offset:16384
v_mfma_f32_16x16x32_bf16 v[156:159], v[68:71], v[60:63], v[156:159]
ds_read_b64_tr_b16 v[42:43], v6 offset:17408
v_mfma_f32_16x16x32_bf16 v[160:163], v[72:75], v[48:51], v[160:163]
ds_read_b64_tr_b16 v[44:45], v7 offset:16384
v_mfma_f32_16x16x32_bf16 v[164:167], v[72:75], v[52:55], v[164:167]
ds_read_b64_tr_b16 v[46:47], v7 offset:17408
v_mfma_f32_16x16x32_bf16 v[168:171], v[72:75], v[56:59], v[168:171]
v_mfma_f32_16x16x32_bf16 v[172:175], v[72:75], v[60:63], v[172:175]
v_mfma_f32_16x16x32_bf16 v[176:179], v[76:79], v[48:51], v[176:179]
v_mfma_f32_16x16x32_bf16 v[180:183], v[76:79], v[52:55], v[180:183]
v_mfma_f32_16x16x32_bf16 v[184:187], v[76:79], v[56:59], v[184:187]
v_mfma_f32_16x16x32_bf16 v[188:191], v[76:79], v[60:63], v[188:191]
s_waitcnt lgkmcnt(0)
v_mfma_f32_16x16x32_bf16 v[128:131], v[32:35], v[16:19], v[128:131]
ds_read_b128 v[48:51], v2 offset:51200
ds_read_b128 v[52:55], v2 offset:51456
v_mfma_f32_16x16x32_bf16 v[132:135], v[32:35], v[20:23], v[132:135]
ds_read_b128 v[56:59], v2 offset:55296
v_mfma_f32_16x16x32_bf16 v[136:139], v[32:35], v[24:27], v[136:139]
ds_read_b128 v[60:63], v2 offset:55552
v_mfma_f32_16x16x32_bf16 v[140:143], v[32:35], v[28:31], v[140:143]
ds_read_b64_tr_b16 v[64:65], v4 offset:24576
v_mfma_f32_16x16x32_bf16 v[144:147], v[36:39], v[16:19], v[144:147]
ds_read_b64_tr_b16 v[66:67], v4 offset:25600
v_mfma_f32_16x16x32_bf16 v[148:151], v[36:39], v[20:23], v[148:151]
ds_read_b64_tr_b16 v[68:69], v5 offset:24576
ds_read_b64_tr_b16 v[70:71], v5 offset:25600
v_mfma_f32_16x16x32_bf16 v[152:155], v[36:39], v[24:27], v[152:155]
ds_read_b64_tr_b16 v[72:73], v6 offset:24576
v_mfma_f32_16x16x32_bf16 v[156:159], v[36:39], v[28:31], v[156:159]
ds_read_b64_tr_b16 v[74:75], v6 offset:25600
v_mfma_f32_16x16x32_bf16 v[160:163], v[40:43], v[16:19], v[160:163]
ds_read_b64_tr_b16 v[76:77], v7 offset:24576
v_mfma_f32_16x16x32_bf16 v[164:167], v[40:43], v[20:23], v[164:167]
ds_read_b64_tr_b16 v[78:79], v7 offset:25600
v_mfma_f32_16x16x32_bf16 v[168:171], v[40:43], v[24:27], v[168:171]
v_mfma_f32_16x16x32_bf16 v[172:175], v[40:43], v[28:31], v[172:175]
v_mfma_f32_16x16x32_bf16 v[176:179], v[44:47], v[16:19], v[176:179]
s_waitcnt vmcnt(0)
v_add_f32 v80, v80, v82
v_mfma_f32_16x16x32_bf16 v[180:183], v[44:47], v[20:23], v[180:183]
v_add_f32 v81, v81, v83
v_add_f32 v80, v80, v84
v_mfma_f32_16x16x32_bf16 v[184:187], v[44:47], v[24:27], v[184:187]
s_waitcnt lgkmcnt(0)
v_add_f32 v81, v81, v85
v_mfma_f32_16x16x32_bf16 v[188:191], v[44:47], v[28:31], v[188:191]
s_barrier
v_mfma_f32_16x16x32_bf16 v[128:131], v[64:67], v[48:51], v[128:131]
ds_read_b128 v[16:19], v2 offset:0
ds_read_b128 v[20:23], v2 offset:256
v_mfma_f32_16x16x32_bf16 v[132:135], v[64:67], v[52:55], v[132:135]
ds_read_b128 v[24:27], v2 offset:4096
v_add_f32 v80, v80, v86
v_mfma_f32_16x16x32_bf16 v[136:139], v[64:67], v[56:59], v[136:139]
ds_read_b128 v[28:31], v2 offset:4352
v_add_f32 v81, v81, v87
v_mfma_f32_16x16x32_bf16 v[140:143], v[64:67], v[60:63], v[140:143]
ds_read_b64_tr_b16 v[32:33], v4 offset:32768
v_add_f32 v80, v80, v88
v_mfma_f32_16x16x32_bf16 v[144:147], v[68:71], v[48:51], v[144:147]
ds_read_b64_tr_b16 v[34:35], v4 offset:33792
v_add_f32 v81, v81, v89
v_mfma_f32_16x16x32_bf16 v[148:151], v[68:71], v[52:55], v[148:151]
ds_read_b64_tr_b16 v[36:37], v5 offset:32768
ds_read_b64_tr_b16 v[38:39], v5 offset:33792
v_mfma_f32_16x16x32_bf16 v[152:155], v[68:71], v[56:59], v[152:155]
ds_read_b64_tr_b16 v[40:41], v6 offset:32768
v_add_f32 v80, v80, v90
v_mfma_f32_16x16x32_bf16 v[156:159], v[68:71], v[60:63], v[156:159]
ds_read_b64_tr_b16 v[42:43], v6 offset:33792
v_add_f32 v81, v81, v91
v_mfma_f32_16x16x32_bf16 v[160:163], v[72:75], v[48:51], v[160:163]
ds_read_b64_tr_b16 v[44:45], v7 offset:32768
v_add_f32 v80, v80, v92
v_mfma_f32_16x16x32_bf16 v[164:167], v[72:75], v[52:55], v[164:167]
ds_read_b64_tr_b16 v[46:47], v7 offset:33792
v_add_f32 v81, v81, v93
v_mfma_f32_16x16x32_bf16 v[168:171], v[72:75], v[56:59], v[168:171]
v_add_f32 v80, v80, v94
v_add_f32 v81, v81, v95
v_mfma_f32_16x16x32_bf16 v[172:175], v[72:75], v[60:63], v[172:175]
v_mul_f32 v82, 0x3acccccd, v80
v_mul_f32 v81, 0x3acccccd, v81
v_mfma_f32_16x16x32_bf16 v[176:179], v[76:79], v[48:51], v[176:179]
v_fma_f32 v81, -v82, v82, v81
v_max_f32 v81, 0, v81
v_mfma_f32_16x16x32_bf16 v[180:183], v[76:79], v[52:55], v[180:183]
v_add_f32 v81, 0x3727c5ac, v81
v_rsq_f32 v83, v81
v_mfma_f32_16x16x32_bf16 v[184:187], v[76:79], v[56:59], v[184:187]
s_nop 0
v_sub_f32 v212, 0, v82
v_mfma_f32_16x16x32_bf16 v[188:191], v[76:79], v[60:63], v[188:191]
v_sub_f32 v214, 0, v82
s_waitcnt lgkmcnt(0)
v_mfma_f32_16x16x32_bf16 v[128:131], v[32:35], v[16:19], v[128:131]
ds_read_b128 v[48:51], v2 offset:2048
ds_read_b128 v[52:55], v2 offset:2304
v_mfma_f32_16x16x32_bf16 v[132:135], v[32:35], v[20:23], v[132:135]
ds_read_b128 v[56:59], v2 offset:6144
s_nop 1
v_mfma_f32_16x16x32_bf16 v[136:139], v[32:35], v[24:27], v[136:139]
ds_read_b128 v[60:63], v2 offset:6400
v_permlane16_swap_b32 v212, v214
v_mfma_f32_16x16x32_bf16 v[140:143], v[32:35], v[28:31], v[140:143]
ds_read_b64_tr_b16 v[64:65], v4 offset:40960
v_mov_b32 v216, v212
v_mfma_f32_16x16x32_bf16 v[144:147], v[36:39], v[16:19], v[144:147]
ds_read_b64_tr_b16 v[66:67], v4 offset:41984
v_mov_b32 v218, v214
v_mfma_f32_16x16x32_bf16 v[148:151], v[36:39], v[20:23], v[148:151]
ds_read_b64_tr_b16 v[68:69], v5 offset:40960
ds_read_b64_tr_b16 v[70:71], v5 offset:41984
v_mfma_f32_16x16x32_bf16 v[152:155], v[36:39], v[24:27], v[152:155]
ds_read_b64_tr_b16 v[72:73], v6 offset:40960
s_nop 1
v_mfma_f32_16x16x32_bf16 v[156:159], v[36:39], v[28:31], v[156:159]
ds_read_b64_tr_b16 v[74:75], v6 offset:41984
v_permlane32_swap_b32 v212, v216
v_mfma_f32_16x16x32_bf16 v[160:163], v[40:43], v[16:19], v[160:163]
ds_read_b64_tr_b16 v[76:77], v7 offset:40960
v_permlane32_swap_b32 v214, v218
v_mfma_f32_16x16x32_bf16 v[164:167], v[40:43], v[20:23], v[164:167]
ds_read_b64_tr_b16 v[78:79], v7 offset:41984
v_mul_f32 v240, s70, v83
v_mfma_f32_16x16x32_bf16 v[168:171], v[40:43], v[24:27], v[168:171]
v_mul_f32 v242, s70, v83
s_nop 1
v_mfma_f32_16x16x32_bf16 v[172:175], v[40:43], v[28:31], v[172:175]
v_permlane16_swap_b32 v240, v242
v_mfma_f32_16x16x32_bf16 v[176:179], v[44:47], v[16:19], v[176:179]
v_mov_b32 v244, v240
v_mov_b32 v246, v242
v_mfma_f32_16x16x32_bf16 v[180:183], v[44:47], v[20:23], v[180:183]
s_nop 1
v_mfma_f32_16x16x32_bf16 v[184:187], v[44:47], v[24:27], v[184:187]
s_waitcnt lgkmcnt(0)
v_permlane32_swap_b32 v240, v244
v_mfma_f32_16x16x32_bf16 v[188:191], v[44:47], v[28:31], v[188:191]
s_barrier
v_mfma_f32_16x16x32_bf16 v[128:131], v[64:67], v[48:51], v[128:131]
ds_read_b128 v[16:19], v2 offset:16384
ds_read_b128 v[20:23], v2 offset:16640
v_mfma_f32_16x16x32_bf16 v[132:135], v[64:67], v[52:55], v[132:135]
ds_read_b128 v[24:27], v2 offset:20480
v_permlane32_swap_b32 v242, v246
v_mfma_f32_16x16x32_bf16 v[136:139], v[64:67], v[56:59], v[136:139]
ds_read_b128 v[28:31], v2 offset:20736
v_mfma_f32_16x16x32_bf16 v[140:143], v[64:67], v[60:63], v[140:143]
ds_read_b64_tr_b16 v[32:33], v8 offset:0
v_mfma_f32_16x16x32_bf16 v[144:147], v[68:71], v[48:51], v[144:147]
ds_read_b64_tr_b16 v[34:35], v8 offset:1024
v_mfma_f32_16x16x32_bf16 v[148:151], v[68:71], v[52:55], v[148:151]
ds_read_b64_tr_b16 v[36:37], v9 offset:0
ds_read_b64_tr_b16 v[38:39], v9 offset:1024
v_mfma_f32_16x16x32_bf16 v[152:155], v[68:71], v[56:59], v[152:155]
ds_read_b64_tr_b16 v[40:41], v10 offset:0
v_mfma_f32_16x16x32_bf16 v[156:159], v[68:71], v[60:63], v[156:159]
ds_read_b64_tr_b16 v[42:43], v10 offset:1024
v_mfma_f32_16x16x32_bf16 v[160:163], v[72:75], v[48:51], v[160:163]
ds_read_b64_tr_b16 v[44:45], v11 offset:0
v_mfma_f32_16x16x32_bf16 v[164:167], v[72:75], v[52:55], v[164:167]
ds_read_b64_tr_b16 v[46:47], v11 offset:1024
v_mfma_f32_16x16x32_bf16 v[168:171], v[72:75], v[56:59], v[168:171]
v_mfma_f32_16x16x32_bf16 v[172:175], v[72:75], v[60:63], v[172:175]
v_mfma_f32_16x16x32_bf16 v[176:179], v[76:79], v[48:51], v[176:179]
v_mfma_f32_16x16x32_bf16 v[180:183], v[76:79], v[52:55], v[180:183]
v_mfma_f32_16x16x32_bf16 v[184:187], v[76:79], v[56:59], v[184:187]
v_mfma_f32_16x16x32_bf16 v[188:191], v[76:79], v[60:63], v[188:191]
s_waitcnt lgkmcnt(0)
v_mfma_f32_16x16x32_bf16 v[128:131], v[32:35], v[16:19], v[128:131]
ds_read_b128 v[48:51], v2 offset:18432
ds_read_b128 v[52:55], v2 offset:18688
v_mfma_f32_16x16x32_bf16 v[132:135], v[32:35], v[20:23], v[132:135]
ds_read_b128 v[56:59], v2 offset:22528
v_mfma_f32_16x16x32_bf16 v[136:139], v[32:35], v[24:27], v[136:139]
ds_read_b128 v[60:63], v2 offset:22784
v_mfma_f32_16x16x32_bf16 v[140:143], v[32:35], v[28:31], v[140:143]
ds_read_b64_tr_b16 v[64:65], v8 offset:8192
v_mfma_f32_16x16x32_bf16 v[144:147], v[36:39], v[16:19], v[144:147]
ds_read_b64_tr_b16 v[66:67], v8 offset:9216
v_mfma_f32_16x16x32_bf16 v[148:151], v[36:39], v[20:23], v[148:151]
ds_read_b64_tr_b16 v[68:69], v9 offset:8192
ds_read_b64_tr_b16 v[70:71], v9 offset:9216
v_mfma_f32_16x16x32_bf16 v[152:155], v[36:39], v[24:27], v[152:155]
ds_read_b64_tr_b16 v[72:73], v10 offset:8192
v_mfma_f32_16x16x32_bf16 v[156:159], v[36:39], v[28:31], v[156:159]
ds_read_b64_tr_b16 v[74:75], v10 offset:9216
v_mfma_f32_16x16x32_bf16 v[160:163], v[40:43], v[16:19], v[160:163]
ds_read_b64_tr_b16 v[76:77], v11 offset:8192
v_mfma_f32_16x16x32_bf16 v[164:167], v[40:43], v[20:23], v[164:167]
ds_read_b64_tr_b16 v[78:79], v11 offset:9216
v_mfma_f32_16x16x32_bf16 v[168:171], v[40:43], v[24:27], v[168:171]
v_mfma_f32_16x16x32_bf16 v[172:175], v[40:43], v[28:31], v[172:175]
v_mfma_f32_16x16x32_bf16 v[176:179], v[44:47], v[16:19], v[176:179]
v_mfma_f32_16x16x32_bf16 v[180:183], v[44:47], v[20:23], v[180:183]
v_mfma_f32_16x16x32_bf16 v[184:187], v[44:47], v[24:27], v[184:187]
s_waitcnt lgkmcnt(0)
v_mfma_f32_16x16x32_bf16 v[188:191], v[44:47], v[28:31], v[188:191]
s_barrier
v_mfma_f32_16x16x32_bf16 v[128:131], v[64:67], v[48:51], v[128:131]
ds_read_b128 v[16:19], v2 offset:32768
ds_read_b128 v[20:23], v2 offset:33024
v_mfma_f32_16x16x32_bf16 v[132:135], v[64:67], v[52:55], v[132:135]
ds_read_b128 v[24:27], v2 offset:36864
v_mfma_f32_16x16x32_bf16 v[136:139], v[64:67], v[56:59], v[136:139]
ds_read_b128 v[28:31], v2 offset:37120
v_fmac_f32 v148, v214, v100
v_mfma_f32_16x16x32_bf16 v[140:143], v[64:67], v[60:63], v[140:143]
ds_read_b64_tr_b16 v[32:33], v8 offset:16384
v_fmac_f32 v152, v216, v100
v_mfma_f32_16x16x32_bf16 v[144:147], v[68:71], v[48:51], v[144:147]
ds_read_b64_tr_b16 v[34:35], v8 offset:17408
v_fmac_f32 v156, v218, v100
v_mfma_f32_16x16x32_bf16 v[148:151], v[68:71], v[52:55], v[148:151]
ds_read_b64_tr_b16 v[36:37], v9 offset:16384
ds_read_b64_tr_b16 v[38:39], v9 offset:17408
v_mfma_f32_16x16x32_bf16 v[152:155], v[68:71], v[56:59], v[152:155]
ds_read_b64_tr_b16 v[40:41], v10 offset:16384
v_fmac_f32 v164, v214, v104
v_mfma_f32_16x16x32_bf16 v[156:159], v[68:71], v[60:63], v[156:159]
ds_read_b64_tr_b16 v[42:43], v10 offset:17408
v_fmac_f32 v168, v216, v104
v_mfma_f32_16x16x32_bf16 v[160:163], v[72:75], v[48:51], v[160:163]
ds_read_b64_tr_b16 v[44:45], v11 offset:16384
v_fmac_f32 v172, v218, v104
v_mfma_f32_16x16x32_bf16 v[164:167], v[72:75], v[52:55], v[164:167]
ds_read_b64_tr_b16 v[46:47], v11 offset:17408
v_fmac_f32 v176, v212, v108
v_mfma_f32_16x16x32_bf16 v[168:171], v[72:75], v[56:59], v[168:171]
v_fmac_f32 v180, v214, v108
v_fmac_f32 v181, v214, v109
v_mfma_f32_16x16x32_bf16 v[172:175], v[72:75], v[60:63], v[172:175]
v_fmac_f32 v184, v216, v108
v_fmac_f32 v185, v216, v109
v_mfma_f32_16x16x32_bf16 v[176:179], v[76:79], v[48:51], v[176:179]
v_fmac_f32 v188, v218, v108
v_fmac_f32 v189, v218, v109
v_mfma_f32_16x16x32_bf16 v[180:183], v[76:79], v[52:55], v[180:183]
v_fmac_f32 v128, v212, v96
v_fmac_f32 v129, v212, v97
v_mfma_f32_16x16x32_bf16 v[184:187], v[76:79], v[56:59], v[184:187]
v_fmac_f32 v132, v214, v96
v_fmac_f32 v133, v214, v97
v_mfma_f32_16x16x32_bf16 v[188:191], v[76:79], v[60:63], v[188:191]
v_fmac_f32 v136, v216, v96
s_waitcnt lgkmcnt(0)
v_mfma_f32_16x16x32_bf16 v[128:131], v[32:35], v[16:19], v[128:131]
ds_read_b128 v[48:51], v2 offset:34816
ds_read_b128 v[52:55], v2 offset:35072
v_mfma_f32_16x16x32_bf16 v[132:135], v[32:35], v[20:23], v[132:135]
ds_read_b128 v[56:59], v2 offset:38912
v_fmac_f32 v144, v212, v100
v_mfma_f32_16x16x32_bf16 v[136:139], v[32:35], v[24:27], v[136:139]
ds_read_b128 v[60:63], v2 offset:39168
v_fmac_f32 v160, v212, v104
v_mfma_f32_16x16x32_bf16 v[140:143], v[32:35], v[28:31], v[140:143]
ds_read_b64_tr_b16 v[64:65], v8 offset:24576
v_fmac_f32 v153, v216, v101
v_mfma_f32_16x16x32_bf16 v[144:147], v[36:39], v[16:19], v[144:147]
ds_read_b64_tr_b16 v[66:67], v8 offset:25600
v_fmac_f32 v157, v218, v101
v_mfma_f32_16x16x32_bf16 v[148:151], v[36:39], v[20:23], v[148:151]
ds_read_b64_tr_b16 v[68:69], v9 offset:24576
ds_read_b64_tr_b16 v[70:71], v9 offset:25600
v_mfma_f32_16x16x32_bf16 v[152:155], v[36:39], v[24:27], v[152:155]
ds_read_b64_tr_b16 v[72:73], v10 offset:24576
v_fmac_f32 v165, v214, v105
v_mfma_f32_16x16x32_bf16 v[156:159], v[36:39], v[28:31], v[156:159]
ds_read_b64_tr_b16 v[74:75], v10 offset:25600
v_fmac_f32 v140, v218, v96
v_mfma_f32_16x16x32_bf16 v[160:163], v[40:43], v[16:19], v[160:163]
ds_read_b64_tr_b16 v[76:77], v11 offset:24576
v_fmac_f32 v173, v218, v105
v_mfma_f32_16x16x32_bf16 v[164:167], v[40:43], v[20:23], v[164:167]
ds_read_b64_tr_b16 v[78:79], v11 offset:25600
v_fmac_f32 v177, v212, v109
v_mfma_f32_16x16x32_bf16 v[168:171], v[40:43], v[24:27], v[168:171]
v_fmac_f32 v137, v216, v97
v_fmac_f32 v138, v216, v98
v_mfma_f32_16x16x32_bf16 v[172:175], v[40:43], v[28:31], v[172:175]
v_fmac_f32 v141, v218, v97
v_fmac_f32 v142, v218, v98
v_mfma_f32_16x16x32_bf16 v[176:179], v[44:47], v[16:19], v[176:179]
v_fmac_f32 v145, v212, v101
v_fmac_f32 v146, v212, v102
v_mfma_f32_16x16x32_bf16 v[180:183], v[44:47], v[20:23], v[180:183]
v_fmac_f32 v149, v214, v101
v_fmac_f32 v150, v214, v102
v_mfma_f32_16x16x32_bf16 v[184:187], v[44:47], v[24:27], v[184:187]
s_waitcnt lgkmcnt(0)
v_fmac_f32 v161, v212, v105
v_mfma_f32_16x16x32_bf16 v[188:191], v[44:47], v[28:31], v[188:191]
s_barrier
v_mfma_f32_16x16x32_bf16 v[128:131], v[64:67], v[48:51], v[128:131]
ds_read_b128 v[16:19], v2 offset:49152
ds_read_b128 v[20:23], v2 offset:49408
v_mfma_f32_16x16x32_bf16 v[132:135], v[64:67], v[52:55], v[132:135]
ds_read_b128 v[24:27], v2 offset:53248
v_fmac_f32 v169, v216, v105
v_mfma_f32_16x16x32_bf16 v[136:139], v[64:67], v[56:59], v[136:139]
ds_read_b128 v[28:31], v2 offset:53504
v_fmac_f32 v154, v216, v102
v_mfma_f32_16x16x32_bf16 v[140:143], v[64:67], v[60:63], v[140:143]
ds_read_b64_tr_b16 v[32:33], v8 offset:32768
v_fmac_f32 v158, v218, v102
v_mfma_f32_16x16x32_bf16 v[144:147], v[68:71], v[48:51], v[144:147]
ds_read_b64_tr_b16 v[34:35], v8 offset:33792
v_fmac_f32 v162, v212, v106
v_mfma_f32_16x16x32_bf16 v[148:151], v[68:71], v[52:55], v[148:151]
ds_read_b64_tr_b16 v[36:37], v9 offset:32768
ds_read_b64_tr_b16 v[38:39], v9 offset:33792
v_mfma_f32_16x16x32_bf16 v[152:155], v[68:71], v[56:59], v[152:155]
ds_read_b64_tr_b16 v[40:41], v10 offset:32768
v_fmac_f32 v166, v214, v106
v_mfma_f32_16x16x32_bf16 v[156:159], v[68:71], v[60:63], v[156:159]
ds_read_b64_tr_b16 v[42:43], v10 offset:33792
v_fmac_f32 v170, v216, v106
v_mfma_f32_16x16x32_bf16 v[160:163], v[72:75], v[48:51], v[160:163]
ds_read_b64_tr_b16 v[44:45], v11 offset:32768
v_fmac_f32 v174, v218, v106
v_mfma_f32_16x16x32_bf16 v[164:167], v[72:75], v[52:55], v[164:167]
ds_read_b64_tr_b16 v[46:47], v11 offset:33792
v_fmac_f32 v178, v212, v110
v_mfma_f32_16x16x32_bf16 v[168:171], v[72:75], v[56:59], v[168:171]
v_fmac_f32 v182, v214, v110
v_fmac_f32 v183, v214, v111
v_mfma_f32_16x16x32_bf16 v[172:175], v[72:75], v[60:63], v[172:175]
v_fmac_f32 v186, v216, v110
v_fmac_f32 v187, v216, v111
v_mfma_f32_16x16x32_bf16 v[176:179], v[76:79], v[48:51], v[176:179]
v_fmac_f32 v190, v218, v110
v_fmac_f32 v191, v218, v111
v_mfma_f32_16x16x32_bf16 v[180:183], v[76:79], v[52:55], v[180:183]
v_fmac_f32 v130, v212, v98
v_fmac_f32 v131, v212, v99
v_mfma_f32_16x16x32_bf16 v[184:187], v[76:79], v[56:59], v[184:187]
v_fmac_f32 v134, v214, v98
v_fmac_f32 v135, v214, v99
v_mfma_f32_16x16x32_bf16 v[188:191], v[76:79], v[60:63], v[188:191]
v_fmac_f32 v139, v216, v99
s_waitcnt lgkmcnt(0)
v_mfma_f32_16x16x32_bf16 v[128:131], v[32:35], v[16:19], v[128:131]
ds_read_b128 v[48:51], v2 offset:51200
ds_read_b128 v[52:55], v2 offset:51456
v_mfma_f32_16x16x32_bf16 v[132:135], v[32:35], v[20:23], v[132:135]
ds_read_b128 v[56:59], v2 offset:55296
v_fmac_f32 v147, v212, v103
v_mfma_f32_16x16x32_bf16 v[136:139], v[32:35], v[24:27], v[136:139]
ds_read_b128 v[60:63], v2 offset:55552
v_fmac_f32 v151, v214, v103
v_mfma_f32_16x16x32_bf16 v[140:143], v[32:35], v[28:31], v[140:143]
ds_read_b64_tr_b16 v[64:65], v8 offset:40960
v_fmac_f32 v155, v216, v103
v_mfma_f32_16x16x32_bf16 v[144:147], v[36:39], v[16:19], v[144:147]
ds_read_b64_tr_b16 v[66:67], v8 offset:41984
v_fmac_f32 v159, v218, v103
v_mfma_f32_16x16x32_bf16 v[148:151], v[36:39], v[20:23], v[148:151]
ds_read_b64_tr_b16 v[68:69], v9 offset:40960
ds_read_b64_tr_b16 v[70:71], v9 offset:41984
v_mfma_f32_16x16x32_bf16 v[152:155], v[36:39], v[24:27], v[152:155]
ds_read_b64_tr_b16 v[72:73], v10 offset:40960
v_fmac_f32 v167, v214, v107
v_mfma_f32_16x16x32_bf16 v[156:159], v[36:39], v[28:31], v[156:159]
ds_read_b64_tr_b16 v[74:75], v10 offset:41984
v_fmac_f32 v171, v216, v107
v_mfma_f32_16x16x32_bf16 v[160:163], v[40:43], v[16:19], v[160:163]
ds_read_b64_tr_b16 v[76:77], v11 offset:40960
v_fmac_f32 v175, v218, v107
v_mfma_f32_16x16x32_bf16 v[164:167], v[40:43], v[20:23], v[164:167]
ds_read_b64_tr_b16 v[78:79], v11 offset:41984
v_fmac_f32 v179, v212, v111
v_mfma_f32_16x16x32_bf16 v[168:171], v[40:43], v[24:27], v[168:171]
v_fmac_f32 v143, v218, v99
v_mfma_f32_16x16x32_bf16 v[172:175], v[40:43], v[28:31], v[172:175]
v_mfma_f32_16x16x32_bf16 v[176:179], v[44:47], v[16:19], v[176:179]
v_fmac_f32 v163, v212, v107
v_mfma_f32_16x16x32_bf16 v[180:183], v[44:47], v[20:23], v[180:183]
v_mfma_f32_16x16x32_bf16 v[184:187], v[44:47], v[24:27], v[184:187]
s_waitcnt lgkmcnt(0)
v_mfma_f32_16x16x32_bf16 v[188:191], v[44:47], v[28:31], v[188:191]
s_barrier
v_mfma_f32_16x16x32_bf16 v[128:131], v[64:67], v[48:51], v[128:131]
ds_read_b128 v[16:19], v2 offset:0
ds_read_b128 v[20:23], v2 offset:256
v_mfma_f32_16x16x32_bf16 v[132:135], v[64:67], v[52:55], v[132:135]
ds_read_b128 v[24:27], v2 offset:4096
v_mfma_f32_16x16x32_bf16 v[136:139], v[64:67], v[56:59], v[136:139]
ds_read_b128 v[28:31], v2 offset:4352
v_mfma_f32_16x16x32_bf16 v[140:143], v[64:67], v[60:63], v[140:143]
ds_read_b64_tr_b16 v[32:33], v4 offset:0
v_mfma_f32_16x16x32_bf16 v[144:147], v[68:71], v[48:51], v[144:147]
ds_read_b64_tr_b16 v[34:35], v4 offset:1024
v_mfma_f32_16x16x32_bf16 v[148:151], v[68:71], v[52:55], v[148:151]
ds_read_b64_tr_b16 v[36:37], v5 offset:0
ds_read_b64_tr_b16 v[38:39], v5 offset:1024
v_mfma_f32_16x16x32_bf16 v[152:155], v[68:71], v[56:59], v[152:155]
ds_read_b64_tr_b16 v[40:41], v6 offset:0
v_mfma_f32_16x16x32_bf16 v[156:159], v[68:71], v[60:63], v[156:159]
ds_read_b64_tr_b16 v[42:43], v6 offset:1024
v_mfma_f32_16x16x32_bf16 v[160:163], v[72:75], v[48:51], v[160:163]
ds_read_b64_tr_b16 v[44:45], v7 offset:0
v_mfma_f32_16x16x32_bf16 v[164:167], v[72:75], v[52:55], v[164:167]
ds_read_b64_tr_b16 v[46:47], v7 offset:1024
v_mfma_f32_16x16x32_bf16 v[168:171], v[72:75], v[56:59], v[168:171]
v_mfma_f32_16x16x32_bf16 v[172:175], v[72:75], v[60:63], v[172:175]
v_mfma_f32_16x16x32_bf16 v[176:179], v[76:79], v[48:51], v[176:179]
v_mfma_f32_16x16x32_bf16 v[180:183], v[76:79], v[52:55], v[180:183]
v_mfma_f32_16x16x32_bf16 v[184:187], v[76:79], v[56:59], v[184:187]
v_mfma_f32_16x16x32_bf16 v[188:191], v[76:79], v[60:63], v[188:191]
s_waitcnt lgkmcnt(0)
v_mfma_f32_16x16x32_bf16 v[128:131], v[32:35], v[16:19], v[128:131]
ds_read_b128 v[48:51], v2 offset:2048
ds_read_b128 v[52:55], v2 offset:2304
v_mfma_f32_16x16x32_bf16 v[132:135], v[32:35], v[20:23], v[132:135]
ds_read_b128 v[56:59], v2 offset:6144
v_mfma_f32_16x16x32_bf16 v[136:139], v[32:35], v[24:27], v[136:139]
ds_read_b128 v[60:63], v2 offset:6400
v_mfma_f32_16x16x32_bf16 v[140:143], v[32:35], v[28:31], v[140:143]
ds_read_b64_tr_b16 v[64:65], v4 offset:8192
v_mfma_f32_16x16x32_bf16 v[144:147], v[36:39], v[16:19], v[144:147]
ds_read_b64_tr_b16 v[66:67], v4 offset:9216
v_mfma_f32_16x16x32_bf16 v[148:151], v[36:39], v[20:23], v[148:151]
ds_read_b64_tr_b16 v[68:69], v5 offset:8192
ds_read_b64_tr_b16 v[70:71], v5 offset:9216
v_mfma_f32_16x16x32_bf16 v[152:155], v[36:39], v[24:27], v[152:155]
ds_read_b64_tr_b16 v[72:73], v6 offset:8192
v_mfma_f32_16x16x32_bf16 v[156:159], v[36:39], v[28:31], v[156:159]
ds_read_b64_tr_b16 v[74:75], v6 offset:9216
v_mfma_f32_16x16x32_bf16 v[160:163], v[40:43], v[16:19], v[160:163]
ds_read_b64_tr_b16 v[76:77], v7 offset:8192
v_mfma_f32_16x16x32_bf16 v[164:167], v[40:43], v[20:23], v[164:167]
ds_read_b64_tr_b16 v[78:79], v7 offset:9216
v_mfma_f32_16x16x32_bf16 v[168:171], v[40:43], v[24:27], v[168:171]
v_mfma_f32_16x16x32_bf16 v[172:175], v[40:43], v[28:31], v[172:175]
v_mfma_f32_16x16x32_bf16 v[176:179], v[44:47], v[16:19], v[176:179]
v_mfma_f32_16x16x32_bf16 v[180:183], v[44:47], v[20:23], v[180:183]
v_mfma_f32_16x16x32_bf16 v[184:187], v[44:47], v[24:27], v[184:187]
s_waitcnt lgkmcnt(0)
v_mfma_f32_16x16x32_bf16 v[188:191], v[44:47], v[28:31], v[188:191]
s_barrier
v_mfma_f32_16x16x32_bf16 v[128:131], v[64:67], v[48:51], v[128:131]
ds_read_b128 v[16:19], v2 offset:16384
ds_read_b128 v[20:23], v2 offset:16640
v_mfma_f32_16x16x32_bf16 v[132:135], v[64:67], v[52:55], v[132:135]
ds_read_b128 v[24:27], v2 offset:20480
v_mfma_f32_16x16x32_bf16 v[136:139], v[64:67], v[56:59], v[136:139]
ds_read_b128 v[28:31], v2 offset:20736
v_mfma_f32_16x16x32_bf16 v[140:143], v[64:67], v[60:63], v[140:143]
ds_read_b64_tr_b16 v[32:33], v4 offset:16384
v_mfma_f32_16x16x32_bf16 v[144:147], v[68:71], v[48:51], v[144:147]
ds_read_b64_tr_b16 v[34:35], v4 offset:17408
v_mfma_f32_16x16x32_bf16 v[148:151], v[68:71], v[52:55], v[148:151]
ds_read_b64_tr_b16 v[36:37], v5 offset:16384
ds_read_b64_tr_b16 v[38:39], v5 offset:17408
v_mfma_f32_16x16x32_bf16 v[152:155], v[68:71], v[56:59], v[152:155]
ds_read_b64_tr_b16 v[40:41], v6 offset:16384
v_mfma_f32_16x16x32_bf16 v[156:159], v[68:71], v[60:63], v[156:159]
ds_read_b64_tr_b16 v[42:43], v6 offset:17408
v_mfma_f32_16x16x32_bf16 v[160:163], v[72:75], v[48:51], v[160:163]
ds_read_b64_tr_b16 v[44:45], v7 offset:16384
v_mfma_f32_16x16x32_bf16 v[164:167], v[72:75], v[52:55], v[164:167]
ds_read_b64_tr_b16 v[46:47], v7 offset:17408
v_mfma_f32_16x16x32_bf16 v[168:171], v[72:75], v[56:59], v[168:171]
v_mfma_f32_16x16x32_bf16 v[172:175], v[72:75], v[60:63], v[172:175]
v_mfma_f32_16x16x32_bf16 v[176:179], v[76:79], v[48:51], v[176:179]
v_mfma_f32_16x16x32_bf16 v[180:183], v[76:79], v[52:55], v[180:183]
v_mfma_f32_16x16x32_bf16 v[184:187], v[76:79], v[56:59], v[184:187]
v_mfma_f32_16x16x32_bf16 v[188:191], v[76:79], v[60:63], v[188:191]
s_waitcnt lgkmcnt(0)
v_mfma_f32_16x16x32_bf16 v[128:131], v[32:35], v[16:19], v[128:131]
ds_read_b128 v[48:51], v2 offset:18432
v_mfma_f32_16x16x32_bf16 v[132:135], v[32:35], v[20:23], v[132:135]
ds_read_b128 v[52:55], v2 offset:18688
v_mfma_f32_16x16x32_bf16 v[136:139], v[32:35], v[24:27], v[136:139]
ds_read_b128 v[56:59], v2 offset:22528
v_mfma_f32_16x16x32_bf16 v[140:143], v[32:35], v[28:31], v[140:143]
ds_read_b128 v[60:63], v2 offset:22784
v_mfma_f32_16x16x32_bf16 v[144:147], v[36:39], v[16:19], v[144:147]
ds_read_b64_tr_b16 v[64:65], v4 offset:24576
v_mfma_f32_16x16x32_bf16 v[148:151], v[36:39], v[20:23], v[148:151]
ds_read_b64_tr_b16 v[66:67], v4 offset:25600
v_mfma_f32_16x16x32_bf16 v[152:155], v[36:39], v[24:27], v[152:155]
ds_read_b64_tr_b16 v[68:69], v5 offset:24576
v_mfma_f32_16x16x32_bf16 v[156:159], v[36:39], v[28:31], v[156:159]
ds_read_b64_tr_b16 v[70:71], v5 offset:25600
v_mfma_f32_16x16x32_bf16 v[160:163], v[40:43], v[16:19], v[160:163]
ds_read_b64_tr_b16 v[72:73], v6 offset:24576
v_mfma_f32_16x16x32_bf16 v[164:167], v[40:43], v[20:23], v[164:167]
ds_read_b64_tr_b16 v[74:75], v6 offset:25600
v_mfma_f32_16x16x32_bf16 v[168:171], v[40:43], v[24:27], v[168:171]
ds_read_b64_tr_b16 v[76:77], v7 offset:24576
v_mfma_f32_16x16x32_bf16 v[172:175], v[40:43], v[28:31], v[172:175]
ds_read_b64_tr_b16 v[78:79], v7 offset:25600
s_waitcnt lgkmcnt(0)
v_mfma_f32_16x16x32_bf16 v[128:131], v[64:67], v[48:51], v[128:131]
s_barrier
v_mfma_f32_16x16x32_bf16 v[132:135], v[64:67], v[52:55], v[132:135]
v_mfma_f32_16x16x32_bf16 v[136:139], v[64:67], v[56:59], v[136:139]
v_mfma_f32_16x16x32_bf16 v[140:143], v[64:67], v[60:63], v[140:143]
s_cmp_eq_u32 s62, 0
s_cbranch_scc1 alt_115
v_mfma_f32_16x16x32_bf16 v[144:147], v[68:71], v[48:51], v[144:147]
s_nop 1
v_mfma_f32_16x16x32_bf16 v[148:151], v[68:71], v[52:55], v[148:151]
s_nop 1
v_mfma_f32_16x16x32_bf16 v[152:155], v[68:71], v[56:59], v[152:155]
v_mul_f32 v128, v240, v128
v_mul_f32 v129, v240, v129
v_mul_f32 v130, v240, v130
v_mfma_f32_16x16x32_bf16 v[156:159], v[68:71], v[60:63], v[156:159]
v_mul_f32 v131, v240, v131
v_mul_f32 v132, v242, v132
v_mul_f32 v133, v242, v133
v_mfma_f32_16x16x32_bf16 v[160:163], v[72:75], v[48:51], v[160:163]
v_mul_f32 v134, v242, v134
v_mul_f32 v135, v242, v135
v_cvt_pk_bf16_f32 v128, v128, v129
v_mfma_f32_16x16x32_bf16 v[164:167], v[72:75], v[52:55], v[164:167]
v_cvt_pk_bf16_f32 v129, v130, v131
v_cvt_pk_bf16_f32 v130, v132, v133
v_cvt_pk_bf16_f32 v131, v134, v135
v_mfma_f32_16x16x32_bf16 v[168:171], v[72:75], v[56:59], v[168:171]
s_nop 0
v_permlane16_swap_b32 v128, v130
v_permlane16_swap_b32 v129, v131
v_mfma_f32_16x16x32_bf16 v[172:175], v[72:75], v[60:63], v[172:175]
buffer_store_dwordx4 v[128:131], v202, s[36:39], s72 offen sc1
v_mul_f32 v136, v244, v136
v_mul_f32 v137, v244, v137
v_mfma_f32_16x16x32_bf16 v[176:179], v[44:47], v[16:19], v[176:179]
v_mul_f32 v138, v244, v138
v_mul_f32 v139, v244, v139
v_mul_f32 v140, v246, v140
v_mfma_f32_16x16x32_bf16 v[180:183], v[44:47], v[20:23], v[180:183]
v_mul_f32 v141, v246, v141
v_mul_f32 v142, v246, v142
v_mul_f32 v143, v246, v143
v_mfma_f32_16x16x32_bf16 v[184:187], v[44:47], v[24:27], v[184:187]
v_cvt_pk_bf16_f32 v136, v136, v137
v_cvt_pk_bf16_f32 v137, v138, v139
v_cvt_pk_bf16_f32 v138, v140, v141
v_mfma_f32_16x16x32_bf16 v[188:191], v[44:47], v[28:31], v[188:191]
v_cvt_pk_bf16_f32 v139, v142, v143
s_nop 0
v_permlane16_swap_b32 v136, v138
v_mfma_f32_16x16x32_bf16 v[176:179], v[76:79], v[48:51], v[176:179]
v_permlane16_swap_b32 v137, v139
buffer_store_dwordx4 v[136:139], v202, s[36:39], s96 offen sc1
v_mul_f32 v144, v240, v144
v_mfma_f32_16x16x32_bf16 v[180:183], v[76:79], v[52:55], v[180:183]
v_mul_f32 v145, v240, v145
v_mul_f32 v146, v240, v146
v_mul_f32 v147, v240, v147
v_mfma_f32_16x16x32_bf16 v[184:187], v[76:79], v[56:59], v[184:187]
v_mul_f32 v148, v242, v148
v_mul_f32 v149, v242, v149
v_mul_f32 v150, v242, v150
v_mfma_f32_16x16x32_bf16 v[188:191], v[76:79], v[60:63], v[188:191]
v_mul_f32 v151, v242, v151
v_cvt_pk_bf16_f32 v144, v144, v145
v_cvt_pk_bf16_f32 v145, v146, v147
v_cvt_pk_bf16_f32 v146, v148, v149
v_cvt_pk_bf16_f32 v147, v150, v151
s_nop 0
v_permlane16_swap_b32 v144, v146
v_permlane16_swap_b32 v145, v147
buffer_store_dwordx4 v[144:147], v203, s[36:39], s72 offen sc1
v_mul_f32 v152, v244, v152
v_mul_f32 v153, v244, v153
v_mul_f32 v154, v244, v154
v_mul_f32 v155, v244, v155
v_mul_f32 v156, v246, v156
v_mul_f32 v157, v246, v157
v_mul_f32 v158, v246, v158
v_mul_f32 v159, v246, v159
v_cvt_pk_bf16_f32 v152, v152, v153
v_cvt_pk_bf16_f32 v153, v154, v155
v_cvt_pk_bf16_f32 v154, v156, v157
v_cvt_pk_bf16_f32 v155, v158, v159
s_nop 0
v_permlane16_swap_b32 v152, v154
v_permlane16_swap_b32 v153, v155
buffer_store_dwordx4 v[152:155], v203, s[36:39], s96 offen sc1
v_pk_mul_f32 v[160:161], v[160:161], v[240:241] op_sel_hi:[1,0]
v_pk_mul_f32 v[162:163], v[162:163], v[240:241] op_sel_hi:[1,0]
v_pk_mul_f32 v[164:165], v[164:165], v[242:243] op_sel_hi:[1,0]
v_pk_mul_f32 v[166:167], v[166:167], v[242:243] op_sel_hi:[1,0]
v_cvt_pk_bf16_f32 v160, v160, v161
v_cvt_pk_bf16_f32 v161, v162, v163
v_cvt_pk_bf16_f32 v162, v164, v165
v_cvt_pk_bf16_f32 v163, v166, v167
s_nop 0
v_permlane16_swap_b32 v160, v162
v_permlane16_swap_b32 v161, v163
buffer_store_dwordx4 v[160:163], v204, s[36:39], s72 offen sc1
v_pk_mul_f32 v[168:169], v[168:169], v[244:245] op_sel_hi:[1,0]
v_pk_mul_f32 v[170:171], v[170:171], v[244:245] op_sel_hi:[1,0]
v_pk_mul_f32 v[172:173], v[172:173], v[246:247] op_sel_hi:[1,0]
v_pk_mul_f32 v[174:175], v[174:175], v[246:247] op_sel_hi:[1,0]
v_cvt_pk_bf16_f32 v168, v168, v169
v_cvt_pk_bf16_f32 v169, v170, v171
v_cvt_pk_bf16_f32 v170, v172, v173
v_cvt_pk_bf16_f32 v171, v174, v175
s_nop 0
v_permlane16_swap_b32 v168, v170
v_permlane16_swap_b32 v169, v171
buffer_store_dwordx4 v[168:171], v204, s[36:39], s96 offen sc1
v_pk_mul_f32 v[176:177], v[176:177], v[240:241] op_sel_hi:[1,0]
v_pk_mul_f32 v[178:179], v[178:179], v[240:241] op_sel_hi:[1,0]
v_pk_mul_f32 v[180:181], v[180:181], v[242:243] op_sel_hi:[1,0]
v_pk_mul_f32 v[182:183], v[182:183], v[242:243] op_sel_hi:[1,0]
v_cvt_pk_bf16_f32 v176, v176, v177
v_cvt_pk_bf16_f32 v177, v178, v179
v_cvt_pk_bf16_f32 v178, v180, v181
v_cvt_pk_bf16_f32 v179, v182, v183
s_nop 0
v_permlane16_swap_b32 v176, v178
v_permlane16_swap_b32 v177, v179
buffer_store_dwordx4 v[176:179], v205, s[36:39], s72 offen sc1
v_pk_mul_f32 v[184:185], v[184:185], v[244:245] op_sel_hi:[1,0]
v_pk_mul_f32 v[186:187], v[186:187], v[244:245] op_sel_hi:[1,0]
v_pk_mul_f32 v[188:189], v[188:189], v[246:247] op_sel_hi:[1,0]
v_pk_mul_f32 v[190:191], v[190:191], v[246:247] op_sel_hi:[1,0]
v_cvt_pk_bf16_f32 v184, v184, v185
v_cvt_pk_bf16_f32 v185, v186, v187
v_cvt_pk_bf16_f32 v186, v188, v189
v_cvt_pk_bf16_f32 v187, v190, v191
s_nop 0
v_permlane16_swap_b32 v184, v186
v_permlane16_swap_b32 v185, v187
buffer_store_dwordx4 v[184:187], v205, s[36:39], s96 offen sc1
s_bitcmp0_b32 s71, 0
s_cbranch_scc1 qk_b_116
buffer_store_dwordx2 v[128:129], v206, s[36:39], s72 offen sc1
buffer_store_dwordx2 v[130:131], v206, s[36:39], s74 offen sc1
buffer_store_dwordx2 v[136:137], v206, s[36:39], s96 offen sc1
buffer_store_dwordx2 v[138:139], v206, s[36:39], s97 offen sc1
qk_b_116:
s_bitcmp0_b32 s71, 1
s_cbranch_scc1 qk_b_117
buffer_store_dwordx2 v[144:145], v207, s[36:39], s72 offen sc1
buffer_store_dwordx2 v[146:147], v207, s[36:39], s74 offen sc1
buffer_store_dwordx2 v[152:153], v207, s[36:39], s96 offen sc1
buffer_store_dwordx2 v[154:155], v207, s[36:39], s97 offen sc1
qk_b_117:
s_bitcmp0_b32 s71, 2
s_cbranch_scc1 qk_b_118
buffer_store_dwordx2 v[160:161], v208, s[36:39], s72 offen sc1
buffer_store_dwordx2 v[162:163], v208, s[36:39], s74 offen sc1
buffer_store_dwordx2 v[168:169], v208, s[36:39], s96 offen sc1
buffer_store_dwordx2 v[170:171], v208, s[36:39], s97 offen sc1
qk_b_118:
s_bitcmp0_b32 s71, 3
s_cbranch_scc1 qk_b_119
buffer_store_dwordx2 v[176:177], v209, s[36:39], s72 offen sc1
buffer_store_dwordx2 v[178:179], v209, s[36:39], s74 offen sc1
buffer_store_dwordx2 v[184:185], v209, s[36:39], s96 offen sc1
buffer_store_dwordx2 v[186:187], v209, s[36:39], s97 offen sc1
qk_b_119:
s_branch qkv_fin_114
alt_115:
v_mfma_f32_16x16x32_bf16 v[144:147], v[68:71], v[48:51], v[144:147]
s_nop 1
v_mfma_f32_16x16x32_bf16 v[148:151], v[68:71], v[52:55], v[148:151]
s_nop 1
v_mfma_f32_16x16x32_bf16 v[152:155], v[68:71], v[56:59], v[152:155]
v_mul_f32 v128, v240, v128
v_mul_f32 v129, v240, v129
v_mul_f32 v130, v240, v130
v_mfma_f32_16x16x32_bf16 v[156:159], v[68:71], v[60:63], v[156:159]
v_mul_f32 v131, v240, v131
v_mul_f32 v132, v242, v132
v_mul_f32 v133, v242, v133
v_mfma_f32_16x16x32_bf16 v[160:163], v[72:75], v[48:51], v[160:163]
v_mul_f32 v134, v242, v134
v_mul_f32 v135, v242, v135
v_cvt_pk_bf16_f32 v128, v128, v129
v_mfma_f32_16x16x32_bf16 v[164:167], v[72:75], v[52:55], v[164:167]
v_cvt_pk_bf16_f32 v129, v130, v131
v_cvt_pk_bf16_f32 v130, v132, v133
v_cvt_pk_bf16_f32 v131, v134, v135
v_mfma_f32_16x16x32_bf16 v[168:171], v[72:75], v[56:59], v[168:171]
s_nop 0
v_permlane16_swap_b32 v128, v130
v_permlane16_swap_b32 v129, v131
v_mfma_f32_16x16x32_bf16 v[172:175], v[72:75], v[60:63], v[172:175]
buffer_store_dwordx4 v[128:131], v202, s[36:39], s72 offen
v_mul_f32 v136, v244, v136
v_mul_f32 v137, v244, v137
v_mfma_f32_16x16x32_bf16 v[176:179], v[44:47], v[16:19], v[176:179]
v_mul_f32 v138, v244, v138
v_mul_f32 v139, v244, v139
v_mul_f32 v140, v246, v140
v_mfma_f32_16x16x32_bf16 v[180:183], v[44:47], v[20:23], v[180:183]
v_mul_f32 v141, v246, v141
v_mul_f32 v142, v246, v142
v_mul_f32 v143, v246, v143
v_mfma_f32_16x16x32_bf16 v[184:187], v[44:47], v[24:27], v[184:187]
v_cvt_pk_bf16_f32 v136, v136, v137
v_cvt_pk_bf16_f32 v137, v138, v139
v_cvt_pk_bf16_f32 v138, v140, v141
v_mfma_f32_16x16x32_bf16 v[188:191], v[44:47], v[28:31], v[188:191]
v_cvt_pk_bf16_f32 v139, v142, v143
s_nop 0
v_permlane16_swap_b32 v136, v138
v_mfma_f32_16x16x32_bf16 v[176:179], v[76:79], v[48:51], v[176:179]
v_permlane16_swap_b32 v137, v139
buffer_store_dwordx4 v[136:139], v202, s[36:39], s96 offen
v_mul_f32 v144, v240, v144
v_mfma_f32_16x16x32_bf16 v[180:183], v[76:79], v[52:55], v[180:183]
v_mul_f32 v145, v240, v145
v_mul_f32 v146, v240, v146
v_mul_f32 v147, v240, v147
v_mfma_f32_16x16x32_bf16 v[184:187], v[76:79], v[56:59], v[184:187]
v_mul_f32 v148, v242, v148
v_mul_f32 v149, v242, v149
v_mul_f32 v150, v242, v150
v_mfma_f32_16x16x32_bf16 v[188:191], v[76:79], v[60:63], v[188:191]
v_mul_f32 v151, v242, v151
v_cvt_pk_bf16_f32 v144, v144, v145
v_cvt_pk_bf16_f32 v145, v146, v147
v_cvt_pk_bf16_f32 v146, v148, v149
v_cvt_pk_bf16_f32 v147, v150, v151
s_nop 0
v_permlane16_swap_b32 v144, v146
v_permlane16_swap_b32 v145, v147
buffer_store_dwordx4 v[144:147], v203, s[36:39], s72 offen
v_mul_f32 v152, v244, v152
v_mul_f32 v153, v244, v153
v_mul_f32 v154, v244, v154
v_mul_f32 v155, v244, v155
v_mul_f32 v156, v246, v156
v_mul_f32 v157, v246, v157
v_mul_f32 v158, v246, v158
v_mul_f32 v159, v246, v159
v_cvt_pk_bf16_f32 v152, v152, v153
v_cvt_pk_bf16_f32 v153, v154, v155
v_cvt_pk_bf16_f32 v154, v156, v157
v_cvt_pk_bf16_f32 v155, v158, v159
s_nop 0
v_permlane16_swap_b32 v152, v154
v_permlane16_swap_b32 v153, v155
buffer_store_dwordx4 v[152:155], v203, s[36:39], s96 offen
v_pk_mul_f32 v[160:161], v[160:161], v[240:241] op_sel_hi:[1,0]
v_pk_mul_f32 v[162:163], v[162:163], v[240:241] op_sel_hi:[1,0]
v_pk_mul_f32 v[164:165], v[164:165], v[242:243] op_sel_hi:[1,0]
v_pk_mul_f32 v[166:167], v[166:167], v[242:243] op_sel_hi:[1,0]
v_cvt_pk_bf16_f32 v160, v160, v161
v_cvt_pk_bf16_f32 v161, v162, v163
v_cvt_pk_bf16_f32 v162, v164, v165
v_cvt_pk_bf16_f32 v163, v166, v167
s_nop 0
v_permlane16_swap_b32 v160, v162
v_permlane16_swap_b32 v161, v163
buffer_store_dwordx4 v[160:163], v204, s[36:39], s72 offen
v_pk_mul_f32 v[168:169], v[168:169], v[244:245] op_sel_hi:[1,0]
v_pk_mul_f32 v[170:171], v[170:171], v[244:245] op_sel_hi:[1,0]
v_pk_mul_f32 v[172:173], v[172:173], v[246:247] op_sel_hi:[1,0]
v_pk_mul_f32 v[174:175], v[174:175], v[246:247] op_sel_hi:[1,0]
v_cvt_pk_bf16_f32 v168, v168, v169
v_cvt_pk_bf16_f32 v169, v170, v171
v_cvt_pk_bf16_f32 v170, v172, v173
v_cvt_pk_bf16_f32 v171, v174, v175
s_nop 0
v_permlane16_swap_b32 v168, v170
v_permlane16_swap_b32 v169, v171
buffer_store_dwordx4 v[168:171], v204, s[36:39], s96 offen
v_pk_mul_f32 v[176:177], v[176:177], v[240:241] op_sel_hi:[1,0]
v_pk_mul_f32 v[178:179], v[178:179], v[240:241] op_sel_hi:[1,0]
v_pk_mul_f32 v[180:181], v[180:181], v[242:243] op_sel_hi:[1,0]
v_pk_mul_f32 v[182:183], v[182:183], v[242:243] op_sel_hi:[1,0]
v_cvt_pk_bf16_f32 v176, v176, v177
v_cvt_pk_bf16_f32 v177, v178, v179
v_cvt_pk_bf16_f32 v178, v180, v181
v_cvt_pk_bf16_f32 v179, v182, v183
s_nop 0
v_permlane16_swap_b32 v176, v178
v_permlane16_swap_b32 v177, v179
buffer_store_dwordx4 v[176:179], v205, s[36:39], s72 offen
v_pk_mul_f32 v[184:185], v[184:185], v[244:245] op_sel_hi:[1,0]
v_pk_mul_f32 v[186:187], v[186:187], v[244:245] op_sel_hi:[1,0]
v_pk_mul_f32 v[188:189], v[188:189], v[246:247] op_sel_hi:[1,0]
v_pk_mul_f32 v[190:191], v[190:191], v[246:247] op_sel_hi:[1,0]
v_cvt_pk_bf16_f32 v184, v184, v185
v_cvt_pk_bf16_f32 v185, v186, v187
v_cvt_pk_bf16_f32 v186, v188, v189
v_cvt_pk_bf16_f32 v187, v190, v191
s_nop 0
v_permlane16_swap_b32 v184, v186
v_permlane16_swap_b32 v185, v187
buffer_store_dwordx4 v[184:187], v205, s[36:39], s96 offen
s_bitcmp0_b32 s71, 0
s_cbranch_scc1 qk_b_120
buffer_store_dwordx2 v[128:129], v206, s[36:39], s72 offen
buffer_store_dwordx2 v[130:131], v206, s[36:39], s74 offen
buffer_store_dwordx2 v[136:137], v206, s[36:39], s96 offen
buffer_store_dwordx2 v[138:139], v206, s[36:39], s97 offen
qk_b_120:
s_bitcmp0_b32 s71, 1
s_cbranch_scc1 qk_b_121
buffer_store_dwordx2 v[144:145], v207, s[36:39], s72 offen
buffer_store_dwordx2 v[146:147], v207, s[36:39], s74 offen
buffer_store_dwordx2 v[152:153], v207, s[36:39], s96 offen
buffer_store_dwordx2 v[154:155], v207, s[36:39], s97 offen
qk_b_121:
s_bitcmp0_b32 s71, 2
s_cbranch_scc1 qk_b_122
buffer_store_dwordx2 v[160:161], v208, s[36:39], s72 offen
buffer_store_dwordx2 v[162:163], v208, s[36:39], s74 offen
buffer_store_dwordx2 v[168:169], v208, s[36:39], s96 offen
buffer_store_dwordx2 v[170:171], v208, s[36:39], s97 offen
qk_b_122:
s_bitcmp0_b32 s71, 3
s_cbranch_scc1 qk_b_123
buffer_store_dwordx2 v[176:177], v209, s[36:39], s72 offen
buffer_store_dwordx2 v[178:179], v209, s[36:39], s74 offen
buffer_store_dwordx2 v[184:185], v209, s[36:39], s96 offen
buffer_store_dwordx2 v[186:187], v209, s[36:39], s97 offen
qk_b_123:
s_branch qkv_fin_114
qkv_v_113:
s_lshl_b32 s68, s60, 3
s_lshl_b32 s67, s65, 2
s_add_u32 s68, s68, s67
s_mul_i32 s72, s68, 640
s_add_u32 s72, s72, 27557888
s_lshl_b32 s67, s66, 6
s_add_u32 s68, s63, s67
v_lshrrev_b32 v80, 5, v0
v_lshl_add_u32 v80, v80, 4, v15
v_add_u32 v80, s68, v80
v_and_b32 v81, 1, v14
v_mul_u32_u24 v81, 320, v81
s_mov_b32 s73, 81920
s_movk_i32 s74, 3277
s_movk_i32 s67, -20
v_add_u32 v83, 0, v80
v_mul_u32_u24 v84, s74, v83
v_lshrrev_b32 v84, 16, v84
v_mad_i32_i24 v83, v84, s67, v83
v_lshl_add_u32 v83, v83, 4, v81
v_mul_lo_u32 v85, v84, s73
v_add_u32 v202, v83, v85
v_add_u32 v83, 32, v80
v_mul_u32_u24 v84, s74, v83
v_lshrrev_b32 v84, 16, v84
v_mad_i32_i24 v83, v84, s67, v83
v_lshl_add_u32 v83, v83, 4, v81
v_mul_lo_u32 v85, v84, s73
v_add_u32 v203, v83, v85
s_cmp_eq_u32 s62, 0
s_cselect_b32 s70, 0x3ea52b5c, 1.0
s_lshl_b32 s69, s60, 1
s_add_u32 s69, s69, s65
s_lshl_b32 s69, s69, 12
s_add_u32 s69, s69, 22151168
v_lshlrev_b32 v3, 4, v0
s_lshl_b32 s67, s6, 9
s_add_u32 s67, s67, 98304
v_lshlrev_b32 v12, 2, v0
v_add_u32 v12, s67, v12
v_add_u32 v13, s67, v210
s_waitcnt vmcnt(0)
s_mov_b64 exec, 1
buffer_store_dword v253, v252, s[36:39], s100 offen
s_mov_b64 exec, -1
s_barrier
ds_read_b128 v[16:19], v2 offset:0
ds_read_b128 v[20:23], v2 offset:256
ds_read_b128 v[24:27], v2 offset:4096
ds_read_b128 v[28:31], v2 offset:4352
ds_read_b64_tr_b16 v[32:33], v8 offset:16384
ds_read_b64_tr_b16 v[34:35], v8 offset:17408
ds_read_b64_tr_b16 v[36:37], v9 offset:16384
ds_read_b64_tr_b16 v[38:39], v9 offset:17408
ds_read_b64_tr_b16 v[40:41], v10 offset:16384
ds_read_b64_tr_b16 v[42:43], v10 offset:17408
ds_read_b64_tr_b16 v[44:45], v11 offset:16384
ds_read_b64_tr_b16 v[46:47], v11 offset:17408
s_waitcnt lgkmcnt(0)
v_mfma_f32_16x16x32_bf16 v[128:131], v[16:19], v[32:35], 0
ds_read_b128 v[48:51], v2 offset:2048
ds_read_b128 v[52:55], v2 offset:2304
v_mfma_f32_16x16x32_bf16 v[132:135], v[16:19], v[36:39], 0
ds_read_b128 v[56:59], v2 offset:6144
v_mfma_f32_16x16x32_bf16 v[136:139], v[16:19], v[40:43], 0
ds_read_b128 v[60:63], v2 offset:6400
v_mfma_f32_16x16x32_bf16 v[140:143], v[16:19], v[44:47], 0
ds_read_b64_tr_b16 v[64:65], v8 offset:24576
v_mfma_f32_16x16x32_bf16 v[144:147], v[20:23], v[32:35], 0
ds_read_b64_tr_b16 v[66:67], v8 offset:25600
v_mfma_f32_16x16x32_bf16 v[148:151], v[20:23], v[36:39], 0
ds_read_b64_tr_b16 v[68:69], v9 offset:24576
ds_read_b64_tr_b16 v[70:71], v9 offset:25600
v_mfma_f32_16x16x32_bf16 v[152:155], v[20:23], v[40:43], 0
ds_read_b64_tr_b16 v[72:73], v10 offset:24576
v_mfma_f32_16x16x32_bf16 v[156:159], v[20:23], v[44:47], 0
ds_read_b64_tr_b16 v[74:75], v10 offset:25600
v_mfma_f32_16x16x32_bf16 v[160:163], v[24:27], v[32:35], 0
ds_read_b64_tr_b16 v[76:77], v11 offset:24576
v_mfma_f32_16x16x32_bf16 v[164:167], v[24:27], v[36:39], 0
ds_read_b64_tr_b16 v[78:79], v11 offset:25600
v_mfma_f32_16x16x32_bf16 v[168:171], v[24:27], v[40:43], 0
v_mfma_f32_16x16x32_bf16 v[172:175], v[24:27], v[44:47], 0
v_mfma_f32_16x16x32_bf16 v[176:179], v[28:31], v[32:35], 0
v_mfma_f32_16x16x32_bf16 v[180:183], v[28:31], v[36:39], 0
v_mfma_f32_16x16x32_bf16 v[184:187], v[28:31], v[40:43], 0
s_waitcnt lgkmcnt(0)
v_mfma_f32_16x16x32_bf16 v[188:191], v[28:31], v[44:47], 0
s_barrier
v_mfma_f32_16x16x32_bf16 v[128:131], v[48:51], v[64:67], v[128:131]
ds_read_b128 v[16:19], v2 offset:16384
ds_read_b128 v[20:23], v2 offset:16640
v_mfma_f32_16x16x32_bf16 v[132:135], v[48:51], v[68:71], v[132:135]
ds_read_b128 v[24:27], v2 offset:20480
v_mfma_f32_16x16x32_bf16 v[136:139], v[48:51], v[72:75], v[136:139]
ds_read_b128 v[28:31], v2 offset:20736
v_mfma_f32_16x16x32_bf16 v[140:143], v[48:51], v[76:79], v[140:143]
ds_read_b64_tr_b16 v[32:33], v8 offset:32768
v_mfma_f32_16x16x32_bf16 v[144:147], v[52:55], v[64:67], v[144:147]
ds_read_b64_tr_b16 v[34:35], v8 offset:33792
v_mfma_f32_16x16x32_bf16 v[148:151], v[52:55], v[68:71], v[148:151]
ds_read_b64_tr_b16 v[36:37], v9 offset:32768
ds_read_b64_tr_b16 v[38:39], v9 offset:33792
v_mfma_f32_16x16x32_bf16 v[152:155], v[52:55], v[72:75], v[152:155]
ds_read_b64_tr_b16 v[40:41], v10 offset:32768
v_mfma_f32_16x16x32_bf16 v[156:159], v[52:55], v[76:79], v[156:159]
ds_read_b64_tr_b16 v[42:43], v10 offset:33792
v_mfma_f32_16x16x32_bf16 v[160:163], v[56:59], v[64:67], v[160:163]
ds_read_b64_tr_b16 v[44:45], v11 offset:32768
v_mfma_f32_16x16x32_bf16 v[164:167], v[56:59], v[68:71], v[164:167]
ds_read_b64_tr_b16 v[46:47], v11 offset:33792
v_mfma_f32_16x16x32_bf16 v[168:171], v[56:59], v[72:75], v[168:171]
buffer_load_dword v192, v211, s[36:39], s75 offen offset:0 sc1
v_mfma_f32_16x16x32_bf16 v[172:175], v[56:59], v[76:79], v[172:175]
buffer_load_dword v194, v211, s[36:39], s75 offen offset:64 sc1
v_mfma_f32_16x16x32_bf16 v[176:179], v[60:63], v[64:67], v[176:179]
buffer_load_dword v196, v211, s[36:39], s75 offen offset:128 sc1
v_mfma_f32_16x16x32_bf16 v[180:183], v[60:63], v[68:71], v[180:183]
buffer_load_dword v198, v211, s[36:39], s75 offen offset:192 sc1
v_mfma_f32_16x16x32_bf16 v[184:187], v[60:63], v[72:75], v[184:187]
v_mfma_f32_16x16x32_bf16 v[188:191], v[60:63], v[76:79], v[188:191]
s_waitcnt lgkmcnt(0)
v_mfma_f32_16x16x32_bf16 v[128:131], v[16:19], v[32:35], v[128:131]
ds_read_b128 v[48:51], v2 offset:18432
ds_read_b128 v[52:55], v2 offset:18688
v_mfma_f32_16x16x32_bf16 v[132:135], v[16:19], v[36:39], v[132:135]
ds_read_b128 v[56:59], v2 offset:22528
v_mfma_f32_16x16x32_bf16 v[136:139], v[16:19], v[40:43], v[136:139]
ds_read_b128 v[60:63], v2 offset:22784
v_mfma_f32_16x16x32_bf16 v[140:143], v[16:19], v[44:47], v[140:143]
ds_read_b64_tr_b16 v[64:65], v8 offset:40960
v_mfma_f32_16x16x32_bf16 v[144:147], v[20:23], v[32:35], v[144:147]
ds_read_b64_tr_b16 v[66:67], v8 offset:41984
v_mfma_f32_16x16x32_bf16 v[148:151], v[20:23], v[36:39], v[148:151]
ds_read_b64_tr_b16 v[68:69], v9 offset:40960
ds_read_b64_tr_b16 v[70:71], v9 offset:41984
v_mfma_f32_16x16x32_bf16 v[152:155], v[20:23], v[40:43], v[152:155]
ds_read_b64_tr_b16 v[72:73], v10 offset:40960
v_mfma_f32_16x16x32_bf16 v[156:159], v[20:23], v[44:47], v[156:159]
ds_read_b64_tr_b16 v[74:75], v10 offset:41984
v_mfma_f32_16x16x32_bf16 v[160:163], v[24:27], v[32:35], v[160:163]
ds_read_b64_tr_b16 v[76:77], v11 offset:40960
v_mfma_f32_16x16x32_bf16 v[164:167], v[24:27], v[36:39], v[164:167]
ds_read_b64_tr_b16 v[78:79], v11 offset:41984
v_mfma_f32_16x16x32_bf16 v[168:171], v[24:27], v[40:43], v[168:171]
v_mfma_f32_16x16x32_bf16 v[172:175], v[24:27], v[44:47], v[172:175]
v_mfma_f32_16x16x32_bf16 v[176:179], v[28:31], v[32:35], v[176:179]
v_mfma_f32_16x16x32_bf16 v[180:183], v[28:31], v[36:39], v[180:183]
v_mfma_f32_16x16x32_bf16 v[184:187], v[28:31], v[40:43], v[184:187]
s_waitcnt lgkmcnt(0)
v_mfma_f32_16x16x32_bf16 v[188:191], v[28:31], v[44:47], v[188:191]
s_barrier
v_mfma_f32_16x16x32_bf16 v[128:131], v[48:51], v[64:67], v[128:131]
ds_read_b128 v[16:19], v2 offset:32768
ds_read_b128 v[20:23], v2 offset:33024
v_mfma_f32_16x16x32_bf16 v[132:135], v[48:51], v[68:71], v[132:135]
ds_read_b128 v[24:27], v2 offset:36864
v_mfma_f32_16x16x32_bf16 v[136:139], v[48:51], v[72:75], v[136:139]
ds_read_b128 v[28:31], v2 offset:37120
v_mfma_f32_16x16x32_bf16 v[140:143], v[48:51], v[76:79], v[140:143]
ds_read_b64_tr_b16 v[32:33], v4 offset:0
v_mfma_f32_16x16x32_bf16 v[144:147], v[52:55], v[64:67], v[144:147]
ds_read_b64_tr_b16 v[34:35], v4 offset:1024
v_mfma_f32_16x16x32_bf16 v[148:151], v[52:55], v[68:71], v[148:151]
ds_read_b64_tr_b16 v[36:37], v5 offset:0
ds_read_b64_tr_b16 v[38:39], v5 offset:1024
v_mfma_f32_16x16x32_bf16 v[152:155], v[52:55], v[72:75], v[152:155]
ds_read_b64_tr_b16 v[40:41], v6 offset:0
v_mfma_f32_16x16x32_bf16 v[156:159], v[52:55], v[76:79], v[156:159]
ds_read_b64_tr_b16 v[42:43], v6 offset:1024
v_mfma_f32_16x16x32_bf16 v[160:163], v[56:59], v[64:67], v[160:163]
ds_read_b64_tr_b16 v[44:45], v7 offset:0
v_mfma_f32_16x16x32_bf16 v[164:167], v[56:59], v[68:71], v[164:167]
ds_read_b64_tr_b16 v[46:47], v7 offset:1024
v_mfma_f32_16x16x32_bf16 v[168:171], v[56:59], v[72:75], v[168:171]
buffer_load_dwordx4 v[80:83], v3, s[36:39], s69 offen offset:0 sc1
v_mfma_f32_16x16x32_bf16 v[172:175], v[56:59], v[76:79], v[172:175]
buffer_load_dwordx4 v[84:87], v3, s[36:39], s69 offen offset:1024 sc1
v_mfma_f32_16x16x32_bf16 v[176:179], v[60:63], v[64:67], v[176:179]
v_mfma_f32_16x16x32_bf16 v[180:183], v[60:63], v[68:71], v[180:183]
v_mfma_f32_16x16x32_bf16 v[184:187], v[60:63], v[72:75], v[184:187]
v_mfma_f32_16x16x32_bf16 v[188:191], v[60:63], v[76:79], v[188:191]
s_waitcnt lgkmcnt(0)
v_mfma_f32_16x16x32_bf16 v[128:131], v[16:19], v[32:35], v[128:131]
ds_read_b128 v[48:51], v2 offset:34816
ds_read_b128 v[52:55], v2 offset:35072
v_mfma_f32_16x16x32_bf16 v[132:135], v[16:19], v[36:39], v[132:135]
ds_read_b128 v[56:59], v2 offset:38912
v_mfma_f32_16x16x32_bf16 v[136:139], v[16:19], v[40:43], v[136:139]
ds_read_b128 v[60:63], v2 offset:39168
v_mfma_f32_16x16x32_bf16 v[140:143], v[16:19], v[44:47], v[140:143]
ds_read_b64_tr_b16 v[64:65], v4 offset:8192
v_mfma_f32_16x16x32_bf16 v[144:147], v[20:23], v[32:35], v[144:147]
ds_read_b64_tr_b16 v[66:67], v4 offset:9216
v_mfma_f32_16x16x32_bf16 v[148:151], v[20:23], v[36:39], v[148:151]
ds_read_b64_tr_b16 v[68:69], v5 offset:8192
ds_read_b64_tr_b16 v[70:71], v5 offset:9216
v_mfma_f32_16x16x32_bf16 v[152:155], v[20:23], v[40:43], v[152:155]
ds_read_b64_tr_b16 v[72:73], v6 offset:8192
v_mfma_f32_16x16x32_bf16 v[156:159], v[20:23], v[44:47], v[156:159]
ds_read_b64_tr_b16 v[74:75], v6 offset:9216
v_mfma_f32_16x16x32_bf16 v[160:163], v[24:27], v[32:35], v[160:163]
ds_read_b64_tr_b16 v[76:77], v7 offset:8192
buffer_load_dwordx4 v[88:91], v3, s[36:39], s69 offen offset:2048 sc1
v_mfma_f32_16x16x32_bf16 v[164:167], v[24:27], v[36:39], v[164:167]
ds_read_b64_tr_b16 v[78:79], v7 offset:9216
buffer_load_dwordx4 v[92:95], v3, s[36:39], s69 offen offset:3072 sc1
v_mfma_f32_16x16x32_bf16 v[168:171], v[24:27], v[40:43], v[168:171]
v_mfma_f32_16x16x32_bf16 v[172:175], v[24:27], v[44:47], v[172:175]
v_mfma_f32_16x16x32_bf16 v[176:179], v[28:31], v[32:35], v[176:179]
v_mfma_f32_16x16x32_bf16 v[180:183], v[28:31], v[36:39], v[180:183]
v_mfma_f32_16x16x32_bf16 v[184:187], v[28:31], v[40:43], v[184:187]
s_waitcnt lgkmcnt(0)
v_mfma_f32_16x16x32_bf16 v[188:191], v[28:31], v[44:47], v[188:191]
s_barrier
v_mfma_f32_16x16x32_bf16 v[128:131], v[48:51], v[64:67], v[128:131]
ds_read_b128 v[16:19], v2 offset:49152
ds_read_b128 v[20:23], v2 offset:49408
v_mfma_f32_16x16x32_bf16 v[132:135], v[48:51], v[68:71], v[132:135]
ds_read_b128 v[24:27], v2 offset:53248
v_mfma_f32_16x16x32_bf16 v[136:139], v[48:51], v[72:75], v[136:139]
ds_read_b128 v[28:31], v2 offset:53504
v_mfma_f32_16x16x32_bf16 v[140:143], v[48:51], v[76:79], v[140:143]
ds_read_b64_tr_b16 v[32:33], v4 offset:16384
v_mfma_f32_16x16x32_bf16 v[144:147], v[52:55], v[64:67], v[144:147]
ds_read_b64_tr_b16 v[34:35], v4 offset:17408
v_mfma_f32_16x16x32_bf16 v[148:151], v[52:55], v[68:71], v[148:151]
ds_read_b64_tr_b16 v[36:37], v5 offset:16384
ds_read_b64_tr_b16 v[38:39], v5 offset:17408
v_mfma_f32_16x16x32_bf16 v[152:155], v[52:55], v[72:75], v[152:155]
ds_read_b64_tr_b16 v[40:41], v6 offset:16384
v_mfma_f32_16x16x32_bf16 v[156:159], v[52:55], v[76:79], v[156:159]
ds_read_b64_tr_b16 v[42:43], v6 offset:17408
v_mfma_f32_16x16x32_bf16 v[160:163], v[56:59], v[64:67], v[160:163]
ds_read_b64_tr_b16 v[44:45], v7 offset:16384
v_mfma_f32_16x16x32_bf16 v[164:167], v[56:59], v[68:71], v[164:167]
ds_read_b64_tr_b16 v[46:47], v7 offset:17408
v_mfma_f32_16x16x32_bf16 v[168:171], v[56:59], v[72:75], v[168:171]
v_mfma_f32_16x16x32_bf16 v[172:175], v[56:59], v[76:79], v[172:175]
v_mfma_f32_16x16x32_bf16 v[176:179], v[60:63], v[64:67], v[176:179]
v_mfma_f32_16x16x32_bf16 v[180:183], v[60:63], v[68:71], v[180:183]
v_mfma_f32_16x16x32_bf16 v[184:187], v[60:63], v[72:75], v[184:187]
v_mfma_f32_16x16x32_bf16 v[188:191], v[60:63], v[76:79], v[188:191]
s_waitcnt lgkmcnt(0)
v_mfma_f32_16x16x32_bf16 v[128:131], v[16:19], v[32:35], v[128:131]
ds_read_b128 v[48:51], v2 offset:51200
ds_read_b128 v[52:55], v2 offset:51456
v_mfma_f32_16x16x32_bf16 v[132:135], v[16:19], v[36:39], v[132:135]
ds_read_b128 v[56:59], v2 offset:55296
v_mfma_f32_16x16x32_bf16 v[136:139], v[16:19], v[40:43], v[136:139]
ds_read_b128 v[60:63], v2 offset:55552
v_mfma_f32_16x16x32_bf16 v[140:143], v[16:19], v[44:47], v[140:143]
ds_read_b64_tr_b16 v[64:65], v4 offset:24576
v_mfma_f32_16x16x32_bf16 v[144:147], v[20:23], v[32:35], v[144:147]
ds_read_b64_tr_b16 v[66:67], v4 offset:25600
v_mfma_f32_16x16x32_bf16 v[148:151], v[20:23], v[36:39], v[148:151]
ds_read_b64_tr_b16 v[68:69], v5 offset:24576
ds_read_b64_tr_b16 v[70:71], v5 offset:25600
v_mfma_f32_16x16x32_bf16 v[152:155], v[20:23], v[40:43], v[152:155]
ds_read_b64_tr_b16 v[72:73], v6 offset:24576
v_mfma_f32_16x16x32_bf16 v[156:159], v[20:23], v[44:47], v[156:159]
ds_read_b64_tr_b16 v[74:75], v6 offset:25600
v_mfma_f32_16x16x32_bf16 v[160:163], v[24:27], v[32:35], v[160:163]
ds_read_b64_tr_b16 v[76:77], v7 offset:24576
v_mfma_f32_16x16x32_bf16 v[164:167], v[24:27], v[36:39], v[164:167]
ds_read_b64_tr_b16 v[78:79], v7 offset:25600
v_mfma_f32_16x16x32_bf16 v[168:171], v[24:27], v[40:43], v[168:171]
v_mfma_f32_16x16x32_bf16 v[172:175], v[24:27], v[44:47], v[172:175]
v_mfma_f32_16x16x32_bf16 v[176:179], v[28:31], v[32:35], v[176:179]
s_waitcnt vmcnt(0)
v_add_f32 v80, v80, v82
v_mfma_f32_16x16x32_bf16 v[180:183], v[28:31], v[36:39], v[180:183]
v_add_f32 v81, v81, v83
v_add_f32 v80, v80, v84
v_mfma_f32_16x16x32_bf16 v[184:187], v[28:31], v[40:43], v[184:187]
s_waitcnt lgkmcnt(0)
v_add_f32 v81, v81, v85
v_mfma_f32_16x16x32_bf16 v[188:191], v[28:31], v[44:47], v[188:191]
s_barrier
v_mfma_f32_16x16x32_bf16 v[128:131], v[48:51], v[64:67], v[128:131]
ds_read_b128 v[16:19], v2 offset:0
ds_read_b128 v[20:23], v2 offset:256
v_mfma_f32_16x16x32_bf16 v[132:135], v[48:51], v[68:71], v[132:135]
ds_read_b128 v[24:27], v2 offset:4096
v_add_f32 v80, v80, v86
v_mfma_f32_16x16x32_bf16 v[136:139], v[48:51], v[72:75], v[136:139]
ds_read_b128 v[28:31], v2 offset:4352
v_add_f32 v81, v81, v87
v_mfma_f32_16x16x32_bf16 v[140:143], v[48:51], v[76:79], v[140:143]
ds_read_b64_tr_b16 v[32:33], v4 offset:32768
v_add_f32 v80, v80, v88
v_mfma_f32_16x16x32_bf16 v[144:147], v[52:55], v[64:67], v[144:147]
ds_read_b64_tr_b16 v[34:35], v4 offset:33792
v_add_f32 v81, v81, v89
v_mfma_f32_16x16x32_bf16 v[148:151], v[52:55], v[68:71], v[148:151]
ds_read_b64_tr_b16 v[36:37], v5 offset:32768
ds_read_b64_tr_b16 v[38:39], v5 offset:33792
v_mfma_f32_16x16x32_bf16 v[152:155], v[52:55], v[72:75], v[152:155]
ds_read_b64_tr_b16 v[40:41], v6 offset:32768
v_add_f32 v80, v80, v90
v_mfma_f32_16x16x32_bf16 v[156:159], v[52:55], v[76:79], v[156:159]
ds_read_b64_tr_b16 v[42:43], v6 offset:33792
v_add_f32 v81, v81, v91
v_mfma_f32_16x16x32_bf16 v[160:163], v[56:59], v[64:67], v[160:163]
ds_read_b64_tr_b16 v[44:45], v7 offset:32768
v_add_f32 v80, v80, v92
v_mfma_f32_16x16x32_bf16 v[164:167], v[56:59], v[68:71], v[164:167]
ds_read_b64_tr_b16 v[46:47], v7 offset:33792
v_add_f32 v81, v81, v93
v_mfma_f32_16x16x32_bf16 v[168:171], v[56:59], v[72:75], v[168:171]
v_add_f32 v80, v80, v94
v_add_f32 v81, v81, v95
v_mfma_f32_16x16x32_bf16 v[172:175], v[56:59], v[76:79], v[172:175]
v_mul_f32 v82, 0x3acccccd, v80
v_mul_f32 v81, 0x3acccccd, v81
v_mfma_f32_16x16x32_bf16 v[176:179], v[60:63], v[64:67], v[176:179]
v_fma_f32 v81, -v82, v82, v81
v_max_f32 v81, 0, v81
v_mfma_f32_16x16x32_bf16 v[180:183], v[60:63], v[68:71], v[180:183]
v_add_f32 v81, 0x3727c5ac, v81
v_rsq_f32 v83, v81
v_mfma_f32_16x16x32_bf16 v[184:187], v[60:63], v[72:75], v[184:187]
s_nop 0
v_sub_f32 v192, 0, v192
v_mfma_f32_16x16x32_bf16 v[188:191], v[60:63], v[76:79], v[188:191]
v_sub_f32 v194, 0, v194
s_waitcnt lgkmcnt(0)
v_mfma_f32_16x16x32_bf16 v[128:131], v[16:19], v[32:35], v[128:131]
ds_read_b128 v[48:51], v2 offset:2048
ds_read_b128 v[52:55], v2 offset:2304
v_mfma_f32_16x16x32_bf16 v[132:135], v[16:19], v[36:39], v[132:135]
ds_read_b128 v[56:59], v2 offset:6144
v_sub_f32 v196, 0, v196
v_mfma_f32_16x16x32_bf16 v[136:139], v[16:19], v[40:43], v[136:139]
ds_read_b128 v[60:63], v2 offset:6400
v_sub_f32 v198, 0, v198
v_mfma_f32_16x16x32_bf16 v[140:143], v[16:19], v[44:47], v[140:143]
ds_read_b64_tr_b16 v[64:65], v4 offset:40960
v_mfma_f32_16x16x32_bf16 v[144:147], v[20:23], v[32:35], v[144:147]
ds_read_b64_tr_b16 v[66:67], v4 offset:41984
v_mfma_f32_16x16x32_bf16 v[148:151], v[20:23], v[36:39], v[148:151]
ds_read_b64_tr_b16 v[68:69], v5 offset:40960
ds_read_b64_tr_b16 v[70:71], v5 offset:41984
v_mfma_f32_16x16x32_bf16 v[152:155], v[20:23], v[40:43], v[152:155]
ds_read_b64_tr_b16 v[72:73], v6 offset:40960
v_mfma_f32_16x16x32_bf16 v[156:159], v[20:23], v[44:47], v[156:159]
ds_read_b64_tr_b16 v[74:75], v6 offset:41984
v_mfma_f32_16x16x32_bf16 v[160:163], v[24:27], v[32:35], v[160:163]
ds_read_b64_tr_b16 v[76:77], v7 offset:40960
v_mfma_f32_16x16x32_bf16 v[164:167], v[24:27], v[36:39], v[164:167]
ds_read_b64_tr_b16 v[78:79], v7 offset:41984
v_mfma_f32_16x16x32_bf16 v[168:171], v[24:27], v[40:43], v[168:171]
v_mfma_f32_16x16x32_bf16 v[172:175], v[24:27], v[44:47], v[172:175]
v_mfma_f32_16x16x32_bf16 v[176:179], v[28:31], v[32:35], v[176:179]
v_mfma_f32_16x16x32_bf16 v[180:183], v[28:31], v[36:39], v[180:183]
v_mfma_f32_16x16x32_bf16 v[184:187], v[28:31], v[40:43], v[184:187]
s_waitcnt lgkmcnt(0)
v_mfma_f32_16x16x32_bf16 v[188:191], v[28:31], v[44:47], v[188:191]
s_barrier
v_mfma_f32_16x16x32_bf16 v[128:131], v[48:51], v[64:67], v[128:131]
ds_read_b128 v[16:19], v2 offset:16384
ds_read_b128 v[20:23], v2 offset:16640
v_mfma_f32_16x16x32_bf16 v[132:135], v[48:51], v[68:71], v[132:135]
ds_read_b128 v[24:27], v2 offset:20480
v_mfma_f32_16x16x32_bf16 v[136:139], v[48:51], v[72:75], v[136:139]
ds_read_b128 v[28:31], v2 offset:20736
ds_write_b32 v12, v82
v_mfma_f32_16x16x32_bf16 v[140:143], v[48:51], v[76:79], v[140:143]
ds_read_b64_tr_b16 v[32:33], v8 offset:0
ds_write_b32 v12, v83 offset:256
v_mfma_f32_16x16x32_bf16 v[144:147], v[52:55], v[64:67], v[144:147]
ds_read_b64_tr_b16 v[34:35], v8 offset:1024
ds_read_b128 v[96:99], v13 offset:0
v_mfma_f32_16x16x32_bf16 v[148:151], v[52:55], v[68:71], v[148:151]
ds_read_b64_tr_b16 v[36:37], v9 offset:0
ds_read_b64_tr_b16 v[38:39], v9 offset:1024
v_mfma_f32_16x16x32_bf16 v[152:155], v[52:55], v[72:75], v[152:155]
ds_read_b64_tr_b16 v[40:41], v10 offset:0
ds_read_b128 v[100:103], v13 offset:64
v_mfma_f32_16x16x32_bf16 v[156:159], v[52:55], v[76:79], v[156:159]
ds_read_b64_tr_b16 v[42:43], v10 offset:1024
ds_read_b128 v[104:107], v13 offset:128
v_mfma_f32_16x16x32_bf16 v[160:163], v[56:59], v[64:67], v[160:163]
ds_read_b64_tr_b16 v[44:45], v11 offset:0
ds_read_b128 v[108:111], v13 offset:192
v_mfma_f32_16x16x32_bf16 v[164:167], v[56:59], v[68:71], v[164:167]
ds_read_b64_tr_b16 v[46:47], v11 offset:1024
ds_read_b128 v[112:115], v13 offset:256
v_mfma_f32_16x16x32_bf16 v[168:171], v[56:59], v[72:75], v[168:171]
ds_read_b128 v[116:119], v13 offset:320
ds_read_b128 v[120:123], v13 offset:384
v_mfma_f32_16x16x32_bf16 v[172:175], v[56:59], v[76:79], v[172:175]
ds_read_b128 v[124:127], v13 offset:448
v_mfma_f32_16x16x32_bf16 v[176:179], v[60:63], v[64:67], v[176:179]
v_mfma_f32_16x16x32_bf16 v[180:183], v[60:63], v[68:71], v[180:183]
v_mfma_f32_16x16x32_bf16 v[184:187], v[60:63], v[72:75], v[184:187]
v_mfma_f32_16x16x32_bf16 v[188:191], v[60:63], v[76:79], v[188:191]
s_waitcnt lgkmcnt(0)
v_mfma_f32_16x16x32_bf16 v[128:131], v[16:19], v[32:35], v[128:131]
ds_read_b128 v[48:51], v2 offset:18432
ds_read_b128 v[52:55], v2 offset:18688
v_mfma_f32_16x16x32_bf16 v[132:135], v[16:19], v[36:39], v[132:135]
ds_read_b128 v[56:59], v2 offset:22528
v_mfma_f32_16x16x32_bf16 v[136:139], v[16:19], v[40:43], v[136:139]
ds_read_b128 v[60:63], v2 offset:22784
v_mfma_f32_16x16x32_bf16 v[140:143], v[16:19], v[44:47], v[140:143]
ds_read_b64_tr_b16 v[64:65], v8 offset:8192
v_mfma_f32_16x16x32_bf16 v[144:147], v[20:23], v[32:35], v[144:147]
ds_read_b64_tr_b16 v[66:67], v8 offset:9216
v_mfma_f32_16x16x32_bf16 v[148:151], v[20:23], v[36:39], v[148:151]
ds_read_b64_tr_b16 v[68:69], v9 offset:8192
ds_read_b64_tr_b16 v[70:71], v9 offset:9216
v_mfma_f32_16x16x32_bf16 v[152:155], v[20:23], v[40:43], v[152:155]
ds_read_b64_tr_b16 v[72:73], v10 offset:8192
v_mfma_f32_16x16x32_bf16 v[156:159], v[20:23], v[44:47], v[156:159]
ds_read_b64_tr_b16 v[74:75], v10 offset:9216
v_mfma_f32_16x16x32_bf16 v[160:163], v[24:27], v[32:35], v[160:163]
ds_read_b64_tr_b16 v[76:77], v11 offset:8192
v_mfma_f32_16x16x32_bf16 v[164:167], v[24:27], v[36:39], v[164:167]
ds_read_b64_tr_b16 v[78:79], v11 offset:9216
v_mfma_f32_16x16x32_bf16 v[168:171], v[24:27], v[40:43], v[168:171]
v_mfma_f32_16x16x32_bf16 v[172:175], v[24:27], v[44:47], v[172:175]
v_mfma_f32_16x16x32_bf16 v[176:179], v[28:31], v[32:35], v[176:179]
v_mfma_f32_16x16x32_bf16 v[180:183], v[28:31], v[36:39], v[180:183]
v_mfma_f32_16x16x32_bf16 v[184:187], v[28:31], v[40:43], v[184:187]
s_waitcnt lgkmcnt(0)
v_mfma_f32_16x16x32_bf16 v[188:191], v[28:31], v[44:47], v[188:191]
s_barrier
v_mfma_f32_16x16x32_bf16 v[128:131], v[48:51], v[64:67], v[128:131]
ds_read_b128 v[16:19], v2 offset:32768
ds_read_b128 v[20:23], v2 offset:33024
v_mfma_f32_16x16x32_bf16 v[132:135], v[48:51], v[68:71], v[132:135]
ds_read_b128 v[24:27], v2 offset:36864
v_mfma_f32_16x16x32_bf16 v[136:139], v[48:51], v[72:75], v[136:139]
ds_read_b128 v[28:31], v2 offset:37120
v_fmac_f32 v148, v194, v100
v_mfma_f32_16x16x32_bf16 v[140:143], v[48:51], v[76:79], v[140:143]
ds_read_b64_tr_b16 v[32:33], v8 offset:16384
v_fmac_f32 v152, v196, v100
v_mfma_f32_16x16x32_bf16 v[144:147], v[52:55], v[64:67], v[144:147]
ds_read_b64_tr_b16 v[34:35], v8 offset:17408
v_fmac_f32 v156, v198, v100
v_mfma_f32_16x16x32_bf16 v[148:151], v[52:55], v[68:71], v[148:151]
ds_read_b64_tr_b16 v[36:37], v9 offset:16384
ds_read_b64_tr_b16 v[38:39], v9 offset:17408
v_mfma_f32_16x16x32_bf16 v[152:155], v[52:55], v[72:75], v[152:155]
ds_read_b64_tr_b16 v[40:41], v10 offset:16384
v_fmac_f32 v164, v194, v104
v_mfma_f32_16x16x32_bf16 v[156:159], v[52:55], v[76:79], v[156:159]
ds_read_b64_tr_b16 v[42:43], v10 offset:17408
v_fmac_f32 v168, v196, v104
v_mfma_f32_16x16x32_bf16 v[160:163], v[56:59], v[64:67], v[160:163]
ds_read_b64_tr_b16 v[44:45], v11 offset:16384
v_fmac_f32 v172, v198, v104
v_mfma_f32_16x16x32_bf16 v[164:167], v[56:59], v[68:71], v[164:167]
ds_read_b64_tr_b16 v[46:47], v11 offset:17408
v_fmac_f32 v176, v192, v108
v_mfma_f32_16x16x32_bf16 v[168:171], v[56:59], v[72:75], v[168:171]
v_fmac_f32 v180, v194, v108
v_fmac_f32 v181, v194, v109
v_mfma_f32_16x16x32_bf16 v[172:175], v[56:59], v[76:79], v[172:175]
v_fmac_f32 v184, v196, v108
v_fmac_f32 v185, v196, v109
v_mfma_f32_16x16x32_bf16 v[176:179], v[60:63], v[64:67], v[176:179]
v_fmac_f32 v188, v198, v108
v_fmac_f32 v189, v198, v109
v_mfma_f32_16x16x32_bf16 v[180:183], v[60:63], v[68:71], v[180:183]
v_fmac_f32 v128, v192, v96
v_fmac_f32 v129, v192, v97
v_mfma_f32_16x16x32_bf16 v[184:187], v[60:63], v[72:75], v[184:187]
v_fmac_f32 v132, v194, v96
v_fmac_f32 v133, v194, v97
v_mfma_f32_16x16x32_bf16 v[188:191], v[60:63], v[76:79], v[188:191]
v_fmac_f32 v136, v196, v96
s_waitcnt lgkmcnt(0)
v_mfma_f32_16x16x32_bf16 v[128:131], v[16:19], v[32:35], v[128:131]
ds_read_b128 v[48:51], v2 offset:34816
ds_read_b128 v[52:55], v2 offset:35072
v_mfma_f32_16x16x32_bf16 v[132:135], v[16:19], v[36:39], v[132:135]
ds_read_b128 v[56:59], v2 offset:38912
v_fmac_f32 v144, v192, v100
v_mfma_f32_16x16x32_bf16 v[136:139], v[16:19], v[40:43], v[136:139]
ds_read_b128 v[60:63], v2 offset:39168
v_fmac_f32 v160, v192, v104
v_mfma_f32_16x16x32_bf16 v[140:143], v[16:19], v[44:47], v[140:143]
ds_read_b64_tr_b16 v[64:65], v8 offset:24576
v_fmac_f32 v153, v196, v101
v_mfma_f32_16x16x32_bf16 v[144:147], v[20:23], v[32:35], v[144:147]
ds_read_b64_tr_b16 v[66:67], v8 offset:25600
v_fmac_f32 v157, v198, v101
v_mfma_f32_16x16x32_bf16 v[148:151], v[20:23], v[36:39], v[148:151]
ds_read_b64_tr_b16 v[68:69], v9 offset:24576
ds_read_b64_tr_b16 v[70:71], v9 offset:25600
v_mfma_f32_16x16x32_bf16 v[152:155], v[20:23], v[40:43], v[152:155]
ds_read_b64_tr_b16 v[72:73], v10 offset:24576
v_fmac_f32 v165, v194, v105
v_mfma_f32_16x16x32_bf16 v[156:159], v[20:23], v[44:47], v[156:159]
ds_read_b64_tr_b16 v[74:75], v10 offset:25600
v_fmac_f32 v140, v198, v96
v_mfma_f32_16x16x32_bf16 v[160:163], v[24:27], v[32:35], v[160:163]
ds_read_b64_tr_b16 v[76:77], v11 offset:24576
v_fmac_f32 v173, v198, v105
v_mfma_f32_16x16x32_bf16 v[164:167], v[24:27], v[36:39], v[164:167]
ds_read_b64_tr_b16 v[78:79], v11 offset:25600
v_fmac_f32 v177, v192, v109
v_mfma_f32_16x16x32_bf16 v[168:171], v[24:27], v[40:43], v[168:171]
v_fmac_f32 v137, v196, v97
v_fmac_f32 v138, v196, v98
v_mfma_f32_16x16x32_bf16 v[172:175], v[24:27], v[44:47], v[172:175]
v_fmac_f32 v141, v198, v97
v_fmac_f32 v142, v198, v98
v_mfma_f32_16x16x32_bf16 v[176:179], v[28:31], v[32:35], v[176:179]
v_fmac_f32 v145, v192, v101
v_fmac_f32 v146, v192, v102
v_mfma_f32_16x16x32_bf16 v[180:183], v[28:31], v[36:39], v[180:183]
v_fmac_f32 v149, v194, v101
v_fmac_f32 v150, v194, v102
v_mfma_f32_16x16x32_bf16 v[184:187], v[28:31], v[40:43], v[184:187]
s_waitcnt lgkmcnt(0)
v_fmac_f32 v161, v192, v105
v_mfma_f32_16x16x32_bf16 v[188:191], v[28:31], v[44:47], v[188:191]
s_barrier
v_mfma_f32_16x16x32_bf16 v[128:131], v[48:51], v[64:67], v[128:131]
ds_read_b128 v[16:19], v2 offset:49152
ds_read_b128 v[20:23], v2 offset:49408
v_mfma_f32_16x16x32_bf16 v[132:135], v[48:51], v[68:71], v[132:135]
ds_read_b128 v[24:27], v2 offset:53248
v_fmac_f32 v169, v196, v105
v_mfma_f32_16x16x32_bf16 v[136:139], v[48:51], v[72:75], v[136:139]
ds_read_b128 v[28:31], v2 offset:53504
v_fmac_f32 v154, v196, v102
v_mfma_f32_16x16x32_bf16 v[140:143], v[48:51], v[76:79], v[140:143]
ds_read_b64_tr_b16 v[32:33], v8 offset:32768
v_fmac_f32 v158, v198, v102
v_mfma_f32_16x16x32_bf16 v[144:147], v[52:55], v[64:67], v[144:147]
ds_read_b64_tr_b16 v[34:35], v8 offset:33792
v_fmac_f32 v162, v192, v106
v_mfma_f32_16x16x32_bf16 v[148:151], v[52:55], v[68:71], v[148:151]
ds_read_b64_tr_b16 v[36:37], v9 offset:32768
ds_read_b64_tr_b16 v[38:39], v9 offset:33792
v_mfma_f32_16x16x32_bf16 v[152:155], v[52:55], v[72:75], v[152:155]
ds_read_b64_tr_b16 v[40:41], v10 offset:32768
v_fmac_f32 v166, v194, v106
v_mfma_f32_16x16x32_bf16 v[156:159], v[52:55], v[76:79], v[156:159]
ds_read_b64_tr_b16 v[42:43], v10 offset:33792
v_fmac_f32 v170, v196, v106
v_mfma_f32_16x16x32_bf16 v[160:163], v[56:59], v[64:67], v[160:163]
ds_read_b64_tr_b16 v[44:45], v11 offset:32768
v_fmac_f32 v174, v198, v106
v_mfma_f32_16x16x32_bf16 v[164:167], v[56:59], v[68:71], v[164:167]
ds_read_b64_tr_b16 v[46:47], v11 offset:33792
v_fmac_f32 v178, v192, v110
v_mfma_f32_16x16x32_bf16 v[168:171], v[56:59], v[72:75], v[168:171]
v_fmac_f32 v182, v194, v110
v_fmac_f32 v183, v194, v111
v_mfma_f32_16x16x32_bf16 v[172:175], v[56:59], v[76:79], v[172:175]
v_fmac_f32 v186, v196, v110
v_fmac_f32 v187, v196, v111
v_mfma_f32_16x16x32_bf16 v[176:179], v[60:63], v[64:67], v[176:179]
v_fmac_f32 v190, v198, v110
v_fmac_f32 v191, v198, v111
v_mfma_f32_16x16x32_bf16 v[180:183], v[60:63], v[68:71], v[180:183]
v_fmac_f32 v130, v192, v98
v_fmac_f32 v131, v192, v99
v_mfma_f32_16x16x32_bf16 v[184:187], v[60:63], v[72:75], v[184:187]
v_fmac_f32 v134, v194, v98
v_fmac_f32 v135, v194, v99
v_mfma_f32_16x16x32_bf16 v[188:191], v[60:63], v[76:79], v[188:191]
v_fmac_f32 v139, v196, v99
s_waitcnt lgkmcnt(0)
v_mfma_f32_16x16x32_bf16 v[128:131], v[16:19], v[32:35], v[128:131]
ds_read_b128 v[48:51], v2 offset:51200
ds_read_b128 v[52:55], v2 offset:51456
v_mfma_f32_16x16x32_bf16 v[132:135], v[16:19], v[36:39], v[132:135]
ds_read_b128 v[56:59], v2 offset:55296
v_fmac_f32 v147, v192, v103
v_mfma_f32_16x16x32_bf16 v[136:139], v[16:19], v[40:43], v[136:139]
ds_read_b128 v[60:63], v2 offset:55552
v_fmac_f32 v151, v194, v103
v_mfma_f32_16x16x32_bf16 v[140:143], v[16:19], v[44:47], v[140:143]
ds_read_b64_tr_b16 v[64:65], v8 offset:40960
v_fmac_f32 v155, v196, v103
v_mfma_f32_16x16x32_bf16 v[144:147], v[20:23], v[32:35], v[144:147]
ds_read_b64_tr_b16 v[66:67], v8 offset:41984
v_fmac_f32 v159, v198, v103
v_mfma_f32_16x16x32_bf16 v[148:151], v[20:23], v[36:39], v[148:151]
ds_read_b64_tr_b16 v[68:69], v9 offset:40960
ds_read_b64_tr_b16 v[70:71], v9 offset:41984
v_mfma_f32_16x16x32_bf16 v[152:155], v[20:23], v[40:43], v[152:155]
ds_read_b64_tr_b16 v[72:73], v10 offset:40960
v_fmac_f32 v167, v194, v107
v_mfma_f32_16x16x32_bf16 v[156:159], v[20:23], v[44:47], v[156:159]
ds_read_b64_tr_b16 v[74:75], v10 offset:41984
v_fmac_f32 v171, v196, v107
v_mfma_f32_16x16x32_bf16 v[160:163], v[24:27], v[32:35], v[160:163]
ds_read_b64_tr_b16 v[76:77], v11 offset:40960
v_fmac_f32 v175, v198, v107
v_mfma_f32_16x16x32_bf16 v[164:167], v[24:27], v[36:39], v[164:167]
ds_read_b64_tr_b16 v[78:79], v11 offset:41984
v_fmac_f32 v179, v192, v111
v_mfma_f32_16x16x32_bf16 v[168:171], v[24:27], v[40:43], v[168:171]
v_fmac_f32 v143, v198, v99
v_mfma_f32_16x16x32_bf16 v[172:175], v[24:27], v[44:47], v[172:175]
v_mfma_f32_16x16x32_bf16 v[176:179], v[28:31], v[32:35], v[176:179]
v_fmac_f32 v163, v192, v107
v_mfma_f32_16x16x32_bf16 v[180:183], v[28:31], v[36:39], v[180:183]
v_mfma_f32_16x16x32_bf16 v[184:187], v[28:31], v[40:43], v[184:187]
s_waitcnt lgkmcnt(0)
v_mfma_f32_16x16x32_bf16 v[188:191], v[28:31], v[44:47], v[188:191]
s_barrier
v_mfma_f32_16x16x32_bf16 v[128:131], v[48:51], v[64:67], v[128:131]
ds_read_b128 v[16:19], v2 offset:0
ds_read_b128 v[20:23], v2 offset:256
v_mfma_f32_16x16x32_bf16 v[132:135], v[48:51], v[68:71], v[132:135]
ds_read_b128 v[24:27], v2 offset:4096
v_mfma_f32_16x16x32_bf16 v[136:139], v[48:51], v[72:75], v[136:139]
ds_read_b128 v[28:31], v2 offset:4352
v_mfma_f32_16x16x32_bf16 v[140:143], v[48:51], v[76:79], v[140:143]
ds_read_b64_tr_b16 v[32:33], v4 offset:0
v_mfma_f32_16x16x32_bf16 v[144:147], v[52:55], v[64:67], v[144:147]
ds_read_b64_tr_b16 v[34:35], v4 offset:1024
v_mfma_f32_16x16x32_bf16 v[148:151], v[52:55], v[68:71], v[148:151]
ds_read_b64_tr_b16 v[36:37], v5 offset:0
ds_read_b64_tr_b16 v[38:39], v5 offset:1024
v_mfma_f32_16x16x32_bf16 v[152:155], v[52:55], v[72:75], v[152:155]
ds_read_b64_tr_b16 v[40:41], v6 offset:0
v_mfma_f32_16x16x32_bf16 v[156:159], v[52:55], v[76:79], v[156:159]
ds_read_b64_tr_b16 v[42:43], v6 offset:1024
v_mfma_f32_16x16x32_bf16 v[160:163], v[56:59], v[64:67], v[160:163]
ds_read_b64_tr_b16 v[44:45], v7 offset:0
v_mfma_f32_16x16x32_bf16 v[164:167], v[56:59], v[68:71], v[164:167]
ds_read_b64_tr_b16 v[46:47], v7 offset:1024
v_mfma_f32_16x16x32_bf16 v[168:171], v[56:59], v[72:75], v[168:171]
v_mfma_f32_16x16x32_bf16 v[172:175], v[56:59], v[76:79], v[172:175]
v_mfma_f32_16x16x32_bf16 v[176:179], v[60:63], v[64:67], v[176:179]
v_mfma_f32_16x16x32_bf16 v[180:183], v[60:63], v[68:71], v[180:183]
v_mfma_f32_16x16x32_bf16 v[184:187], v[60:63], v[72:75], v[184:187]
v_mfma_f32_16x16x32_bf16 v[188:191], v[60:63], v[76:79], v[188:191]
s_waitcnt lgkmcnt(0)
v_mfma_f32_16x16x32_bf16 v[128:131], v[16:19], v[32:35], v[128:131]
ds_read_b128 v[48:51], v2 offset:2048
ds_read_b128 v[52:55], v2 offset:2304
v_mfma_f32_16x16x32_bf16 v[132:135], v[16:19], v[36:39], v[132:135]
ds_read_b128 v[56:59], v2 offset:6144
v_mfma_f32_16x16x32_bf16 v[136:139], v[16:19], v[40:43], v[136:139]
ds_read_b128 v[60:63], v2 offset:6400
v_mfma_f32_16x16x32_bf16 v[140:143], v[16:19], v[44:47], v[140:143]
ds_read_b64_tr_b16 v[64:65], v4 offset:8192
v_mfma_f32_16x16x32_bf16 v[144:147], v[20:23], v[32:35], v[144:147]
ds_read_b64_tr_b16 v[66:67], v4 offset:9216
v_mfma_f32_16x16x32_bf16 v[148:151], v[20:23], v[36:39], v[148:151]
ds_read_b64_tr_b16 v[68:69], v5 offset:8192
ds_read_b64_tr_b16 v[70:71], v5 offset:9216
v_mfma_f32_16x16x32_bf16 v[152:155], v[20:23], v[40:43], v[152:155]
ds_read_b64_tr_b16 v[72:73], v6 offset:8192
v_mfma_f32_16x16x32_bf16 v[156:159], v[20:23], v[44:47], v[156:159]
ds_read_b64_tr_b16 v[74:75], v6 offset:9216
v_mfma_f32_16x16x32_bf16 v[160:163], v[24:27], v[32:35], v[160:163]
ds_read_b64_tr_b16 v[76:77], v7 offset:8192
v_mfma_f32_16x16x32_bf16 v[164:167], v[24:27], v[36:39], v[164:167]
ds_read_b64_tr_b16 v[78:79], v7 offset:9216
v_mfma_f32_16x16x32_bf16 v[168:171], v[24:27], v[40:43], v[168:171]
v_mfma_f32_16x16x32_bf16 v[172:175], v[24:27], v[44:47], v[172:175]
v_mfma_f32_16x16x32_bf16 v[176:179], v[28:31], v[32:35], v[176:179]
v_mfma_f32_16x16x32_bf16 v[180:183], v[28:31], v[36:39], v[180:183]
v_mfma_f32_16x16x32_bf16 v[184:187], v[28:31], v[40:43], v[184:187]
s_waitcnt lgkmcnt(0)
v_mfma_f32_16x16x32_bf16 v[188:191], v[28:31], v[44:47], v[188:191]
s_barrier
v_mfma_f32_16x16x32_bf16 v[128:131], v[48:51], v[64:67], v[128:131]
ds_read_b128 v[16:19], v2 offset:16384
ds_read_b128 v[20:23], v2 offset:16640
v_mfma_f32_16x16x32_bf16 v[132:135], v[48:51], v[68:71], v[132:135]
ds_read_b128 v[24:27], v2 offset:20480
v_mfma_f32_16x16x32_bf16 v[136:139], v[48:51], v[72:75], v[136:139]
ds_read_b128 v[28:31], v2 offset:20736
v_mfma_f32_16x16x32_bf16 v[140:143], v[48:51], v[76:79], v[140:143]
ds_read_b64_tr_b16 v[32:33], v4 offset:16384
v_mfma_f32_16x16x32_bf16 v[144:147], v[52:55], v[64:67], v[144:147]
ds_read_b64_tr_b16 v[34:35], v4 offset:17408
v_mfma_f32_16x16x32_bf16 v[148:151], v[52:55], v[68:71], v[148:151]
ds_read_b64_tr_b16 v[36:37], v5 offset:16384
ds_read_b64_tr_b16 v[38:39], v5 offset:17408
v_mfma_f32_16x16x32_bf16 v[152:155], v[52:55], v[72:75], v[152:155]
ds_read_b64_tr_b16 v[40:41], v6 offset:16384
v_mfma_f32_16x16x32_bf16 v[156:159], v[52:55], v[76:79], v[156:159]
ds_read_b64_tr_b16 v[42:43], v6 offset:17408
v_mfma_f32_16x16x32_bf16 v[160:163], v[56:59], v[64:67], v[160:163]
ds_read_b64_tr_b16 v[44:45], v7 offset:16384
v_mfma_f32_16x16x32_bf16 v[164:167], v[56:59], v[68:71], v[164:167]
ds_read_b64_tr_b16 v[46:47], v7 offset:17408
v_mfma_f32_16x16x32_bf16 v[168:171], v[56:59], v[72:75], v[168:171]
v_mfma_f32_16x16x32_bf16 v[172:175], v[56:59], v[76:79], v[172:175]
v_mfma_f32_16x16x32_bf16 v[176:179], v[60:63], v[64:67], v[176:179]
v_mfma_f32_16x16x32_bf16 v[180:183], v[60:63], v[68:71], v[180:183]
v_mfma_f32_16x16x32_bf16 v[184:187], v[60:63], v[72:75], v[184:187]
v_mfma_f32_16x16x32_bf16 v[188:191], v[60:63], v[76:79], v[188:191]
s_waitcnt lgkmcnt(0)
v_mfma_f32_16x16x32_bf16 v[128:131], v[16:19], v[32:35], v[128:131]
ds_read_b128 v[48:51], v2 offset:18432
v_mfma_f32_16x16x32_bf16 v[132:135], v[16:19], v[36:39], v[132:135]
ds_read_b128 v[52:55], v2 offset:18688
v_mfma_f32_16x16x32_bf16 v[136:139], v[16:19], v[40:43], v[136:139]
ds_read_b128 v[56:59], v2 offset:22528
v_mfma_f32_16x16x32_bf16 v[140:143], v[16:19], v[44:47], v[140:143]
ds_read_b128 v[60:63], v2 offset:22784
v_mfma_f32_16x16x32_bf16 v[144:147], v[20:23], v[32:35], v[144:147]
ds_read_b64_tr_b16 v[64:65], v4 offset:24576
v_mfma_f32_16x16x32_bf16 v[148:151], v[20:23], v[36:39], v[148:151]
ds_read_b64_tr_b16 v[66:67], v4 offset:25600
v_mfma_f32_16x16x32_bf16 v[152:155], v[20:23], v[40:43], v[152:155]
ds_read_b64_tr_b16 v[68:69], v5 offset:24576
v_mfma_f32_16x16x32_bf16 v[156:159], v[20:23], v[44:47], v[156:159]
ds_read_b64_tr_b16 v[70:71], v5 offset:25600
v_mfma_f32_16x16x32_bf16 v[160:163], v[24:27], v[32:35], v[160:163]
ds_read_b64_tr_b16 v[72:73], v6 offset:24576
v_mfma_f32_16x16x32_bf16 v[164:167], v[24:27], v[36:39], v[164:167]
ds_read_b64_tr_b16 v[74:75], v6 offset:25600
v_mfma_f32_16x16x32_bf16 v[168:171], v[24:27], v[40:43], v[168:171]
ds_read_b64_tr_b16 v[76:77], v7 offset:24576
v_mfma_f32_16x16x32_bf16 v[172:175], v[24:27], v[44:47], v[172:175]
ds_read_b64_tr_b16 v[78:79], v7 offset:25600
s_waitcnt lgkmcnt(0)
v_mfma_f32_16x16x32_bf16 v[128:131], v[48:51], v[64:67], v[128:131]
s_barrier
v_mfma_f32_16x16x32_bf16 v[132:135], v[48:51], v[68:71], v[132:135]
v_mfma_f32_16x16x32_bf16 v[136:139], v[48:51], v[72:75], v[136:139]
v_mfma_f32_16x16x32_bf16 v[140:143], v[48:51], v[76:79], v[140:143]
v_mfma_f32_16x16x32_bf16 v[144:147], v[52:55], v[64:67], v[144:147]
s_nop 1
v_mfma_f32_16x16x32_bf16 v[148:151], v[52:55], v[68:71], v[148:151]
s_nop 1
v_mfma_f32_16x16x32_bf16 v[152:155], v[52:55], v[72:75], v[152:155]
v_mul_f32 v128, v112, v128
v_mul_f32 v129, v113, v129
v_mul_f32 v130, v114, v130
v_mfma_f32_16x16x32_bf16 v[156:159], v[52:55], v[76:79], v[156:159]
v_mul_f32 v131, v115, v131
v_mul_f32 v132, v112, v132
v_mul_f32 v133, v113, v133
v_mfma_f32_16x16x32_bf16 v[160:163], v[56:59], v[64:67], v[160:163]
v_mul_f32 v134, v114, v134
v_mul_f32 v135, v115, v135
v_cvt_pk_bf16_f32 v128, v128, v129
v_mfma_f32_16x16x32_bf16 v[164:167], v[56:59], v[68:71], v[164:167]
v_cvt_pk_bf16_f32 v129, v130, v131
v_cvt_pk_bf16_f32 v130, v132, v133
v_cvt_pk_bf16_f32 v131, v134, v135
v_mfma_f32_16x16x32_bf16 v[168:171], v[56:59], v[72:75], v[168:171]
s_nop 0
v_permlane32_swap_b32 v128, v130
v_permlane32_swap_b32 v129, v131
v_mfma_f32_16x16x32_bf16 v[172:175], v[56:59], v[76:79], v[172:175]
buffer_store_dwordx4 v[128:131], v202, s[36:39], s72 offen offset:0 sc1
v_mul_f32 v136, v112, v136
v_mul_f32 v137, v113, v137
v_mfma_f32_16x16x32_bf16 v[176:179], v[28:31], v[32:35], v[176:179]
v_mul_f32 v138, v114, v138
v_mul_f32 v139, v115, v139
v_mul_f32 v140, v112, v140
v_mfma_f32_16x16x32_bf16 v[180:183], v[28:31], v[36:39], v[180:183]
v_mul_f32 v141, v113, v141
v_mul_f32 v142, v114, v142
v_mul_f32 v143, v115, v143
v_mfma_f32_16x16x32_bf16 v[184:187], v[28:31], v[40:43], v[184:187]
v_cvt_pk_bf16_f32 v136, v136, v137
v_cvt_pk_bf16_f32 v137, v138, v139
v_cvt_pk_bf16_f32 v138, v140, v141
v_mfma_f32_16x16x32_bf16 v[188:191], v[28:31], v[44:47], v[188:191]
v_cvt_pk_bf16_f32 v139, v142, v143
s_nop 0
v_permlane32_swap_b32 v136, v138
v_mfma_f32_16x16x32_bf16 v[176:179], v[60:63], v[64:67], v[176:179]
v_permlane32_swap_b32 v137, v139
buffer_store_dwordx4 v[136:139], v203, s[36:39], s72 offen offset:0 sc1
v_mul_f32 v144, v116, v144
v_mfma_f32_16x16x32_bf16 v[180:183], v[60:63], v[68:71], v[180:183]
v_mul_f32 v145, v117, v145
v_mul_f32 v146, v118, v146
v_mul_f32 v147, v119, v147
v_mfma_f32_16x16x32_bf16 v[184:187], v[60:63], v[72:75], v[184:187]
v_mul_f32 v148, v116, v148
v_mul_f32 v149, v117, v149
v_mul_f32 v150, v118, v150
v_mfma_f32_16x16x32_bf16 v[188:191], v[60:63], v[76:79], v[188:191]
v_mul_f32 v151, v119, v151
v_cvt_pk_bf16_f32 v144, v144, v145
v_cvt_pk_bf16_f32 v145, v146, v147
v_cvt_pk_bf16_f32 v146, v148, v149
v_cvt_pk_bf16_f32 v147, v150, v151
s_nop 0
v_permlane32_swap_b32 v144, v146
v_permlane32_swap_b32 v145, v147
buffer_store_dwordx4 v[144:147], v202, s[36:39], s72 offen offset:640 sc1
v_mul_f32 v152, v116, v152
v_mul_f32 v153, v117, v153
v_mul_f32 v154, v118, v154
v_mul_f32 v155, v119, v155
v_mul_f32 v156, v116, v156
v_mul_f32 v157, v117, v157
v_mul_f32 v158, v118, v158
v_mul_f32 v159, v119, v159
v_cvt_pk_bf16_f32 v152, v152, v153
v_cvt_pk_bf16_f32 v153, v154, v155
v_cvt_pk_bf16_f32 v154, v156, v157
v_cvt_pk_bf16_f32 v155, v158, v159
s_nop 0
v_permlane32_swap_b32 v152, v154
v_permlane32_swap_b32 v153, v155
buffer_store_dwordx4 v[152:155], v203, s[36:39], s72 offen offset:640 sc1
v_pk_mul_f32 v[160:161], v[160:161], v[120:121]
v_pk_mul_f32 v[162:163], v[162:163], v[122:123]
v_pk_mul_f32 v[164:165], v[164:165], v[120:121]
v_pk_mul_f32 v[166:167], v[166:167], v[122:123]
v_cvt_pk_bf16_f32 v160, v160, v161
v_cvt_pk_bf16_f32 v161, v162, v163
v_cvt_pk_bf16_f32 v162, v164, v165
v_cvt_pk_bf16_f32 v163, v166, v167
s_nop 0
v_permlane32_swap_b32 v160, v162
v_permlane32_swap_b32 v161, v163
buffer_store_dwordx4 v[160:163], v202, s[36:39], s72 offen offset:1280 sc1
v_pk_mul_f32 v[168:169], v[168:169], v[120:121]
v_pk_mul_f32 v[170:171], v[170:171], v[122:123]
v_pk_mul_f32 v[172:173], v[172:173], v[120:121]
v_pk_mul_f32 v[174:175], v[174:175], v[122:123]
v_cvt_pk_bf16_f32 v168, v168, v169
v_cvt_pk_bf16_f32 v169, v170, v171
v_cvt_pk_bf16_f32 v170, v172, v173
v_cvt_pk_bf16_f32 v171, v174, v175
s_nop 0
v_permlane32_swap_b32 v168, v170
v_permlane32_swap_b32 v169, v171
buffer_store_dwordx4 v[168:171], v203, s[36:39], s72 offen offset:1280 sc1
v_pk_mul_f32 v[176:177], v[176:177], v[124:125]
v_pk_mul_f32 v[178:179], v[178:179], v[126:127]
v_pk_mul_f32 v[180:181], v[180:181], v[124:125]
v_pk_mul_f32 v[182:183], v[182:183], v[126:127]
v_cvt_pk_bf16_f32 v176, v176, v177
v_cvt_pk_bf16_f32 v177, v178, v179
v_cvt_pk_bf16_f32 v178, v180, v181
v_cvt_pk_bf16_f32 v179, v182, v183
s_nop 0
v_permlane32_swap_b32 v176, v178
v_permlane32_swap_b32 v177, v179
buffer_store_dwordx4 v[176:179], v202, s[36:39], s72 offen offset:1920 sc1
v_pk_mul_f32 v[184:185], v[184:185], v[124:125]
v_pk_mul_f32 v[186:187], v[186:187], v[126:127]
v_pk_mul_f32 v[188:189], v[188:189], v[124:125]
v_pk_mul_f32 v[190:191], v[190:191], v[126:127]
v_cvt_pk_bf16_f32 v184, v184, v185
v_cvt_pk_bf16_f32 v185, v186, v187
v_cvt_pk_bf16_f32 v186, v188, v189
v_cvt_pk_bf16_f32 v187, v190, v191
s_nop 0
v_permlane32_swap_b32 v184, v186
v_permlane32_swap_b32 v185, v187
buffer_store_dwordx4 v[184:187], v203, s[36:39], s72 offen offset:1920 sc1
qkv_fin_114:
s_lshl_b32 s80, s13, 3
s_add_u32 s80, s80, s6
s_lshl_b32 s80, s80, 2
s_add_u32 s80, s80, 51798016
s_add_u32 s81, s8, 8
v_mov_b32 v1, 0
v_mov_b32 v2, s81
s_lshl_b32 s67, s13, 5
s_add_u32 s67, s67, s6
s_lshl_b32 s67, s67, 2
s_add_u32 s67, s67, 44597248
s_waitcnt vmcnt(0)
s_mov_b64 exec, 1
buffer_store_dword v2, v1, s[36:39], s80 offen
s_mov_b64 exec, -1
s_mov_b64 exec, 1
buffer_store_dword v2, v1, s[36:39], s67 offen sc1
s_mov_b64 exec, -1
s_branch L_fast_next
L_fast_ld:
s_sub_u32 s60, s6, 4
v_lshlrev_b32 v8, 4, v0
s_mul_i32 s63, s60, 6144
s_and_b32 s66, s5, 15
s_mul_i32 s66, s66, 245760
s_add_u32 s66, s66, s63
s_add_u32 s66, s66, 47415296
s_lshr_b32 s77, s5, 4
s_mul_i32 s77, s77, 0
s_sub_u32 s74, 10, s77
s_mul_i32 s76, s77, 24576
s_add_u32 s66, s66, s76
s_sub_u32 s67, s66, 245760
s_add_u32 m0, s63, 139264
s_add_u32 s79, s66, 0
buffer_load_dwordx4 v8, s[36:39], s79 offen offset:0  lds
buffer_load_dwordx4 v8, s[36:39], s79 offen offset:1024  lds
buffer_load_dwordx4 v8, s[36:39], s79 offen offset:2048  lds
buffer_load_dwordx4 v8, s[36:39], s79 offen offset:3072  lds
s_add_u32 m0, s63, 143360
s_add_u32 s79, s66, 4096
buffer_load_dwordx4 v8, s[36:39], s79 offen offset:0  lds
buffer_load_dwordx4 v8, s[36:39], s79 offen offset:1024  lds
s_add_u32 m0, s63, 114688
s_add_u32 s79, s66, 24576
buffer_load_dwordx4 v8, s[36:39], s79 offen offset:0  lds
buffer_load_dwordx4 v8, s[36:39], s79 offen offset:1024  lds
buffer_load_dwordx4 v8, s[36:39], s79 offen offset:2048  lds
buffer_load_dwordx4 v8, s[36:39], s79 offen offset:3072  lds
s_add_u32 m0, s63, 118784
s_add_u32 s79, s66, 28672
buffer_load_dwordx4 v8, s[36:39], s79 offen offset:0  lds
buffer_load_dwordx4 v8, s[36:39], s79 offen offset:1024  lds
s_lshl_b32 s61, s60, 12
s_mul_i32 s62, s60, 5120
s_lshr_b32 s70, s13, 4
s_lshl_b32 s70, s70, 2
s_add_u32 s70, s70, s60
s_mul_i32 s70, s70, 40960
s_add_u32 s64, s70, 10485760
s_add_u32 s70, s70, 10485760
s_and_b32 s68, s5, 15
v_lshrrev_b32 v2, 4, v0
v_mul_u32_u24 v1, 3840, v2
v_lshlrev_b32 v7, 1, v2
v_and_b32 v3, 15, v0
v_xor_b32 v3, v3, v7
v_lshl_add_u32 v6, v3, 4, v1
v_xor_b32 v3, 8, v3
v_lshl_add_u32 v7, v3, 4, v1
s_mul_i32 s72, s60, 61440
s_lshl_b32 s76, s68, 8
s_add_u32 s72, s72, s76
s_sub_u32 s77, 10, s74
s_mul_i32 s76, s77, 4096
s_add_u32 s64, s64, s76
s_sub_u32 s65, s64, 40960
s_lshr_b32 s77, s5, 4
s_mul_i32 s77, s77, 0
s_sub_u32 s78, 10, s77
s_mul_i32 s76, s77, 4096
s_add_u32 s70, s70, s76
s_sub_u32 s71, s70, 40960
s_mul_i32 s76, s77, 245760
s_add_u32 s72, s72, s76
s_sub_u32 s73, s72, 2457600
s_and_b32 s68, s5, 7
s_mul_i32 s68, s68, 245760
s_add_u32 s68, s68, s62
s_add_u32 s68, s68, 45449216
s_lshr_b32 s77, s5, 3
s_mul_i32 s77, s77, 0
s_sub_u32 s75, 12, s77
s_mul_i32 s76, s77, 20480
s_add_u32 s68, s68, s76
s_sub_u32 s69, s68, 245760
s_cmp_lg_u32 s3, 0
s_cbranch_scc1 wpf_124
s_lshr_b32 s76, s5, 4
s_lshl_b32 s77, s60, 1
s_add_u32 s76, s76, s77
s_mul_i32 s76, s76, 24576
s_sub_u32 s77, s66, s63
s_add_u32 s76, s76, s77
s_add_u32 s76, s76, 49152
v_lshlrev_b32 v4, 7, v0
s_mov_b32 exec_lo, 0xffff
s_mov_b32 exec_hi, 0
s_waitcnt vmcnt(0)
buffer_load_dword v5, v4, s[36:39], s76 offen
s_add_u32 s76, s76, 2048
s_waitcnt vmcnt(0)
buffer_load_dword v5, v4, s[36:39], s76 offen
s_add_u32 s76, s76, 2048
s_waitcnt vmcnt(0)
buffer_load_dword v5, v4, s[36:39], s76 offen
s_add_u32 s76, s76, 2048
s_waitcnt vmcnt(0)
buffer_load_dword v5, v4, s[36:39], s76 offen
s_add_u32 s76, s76, 2048
s_mov_b64 exec, -1
wpf_124:
s_barrier
s_barrier
s_lshr_b32 s76, s5, 4
s_mul_i32 s76, s76, 0
v_lshrrev_b32 v1, 1, v0
v_add_u32 v1, s76, v1
v_and_b32 v1, 7, v1
v_lshlrev_b32 v1, 5, v1
v_and_b32 v2, 1, v0
v_lshl_add_u32 v1, v2, 2, v1
s_lshr_b32 s94, s5, 4
s_lshl_b32 s94, s94, 9
s_bfe_u32 s81, s6, 0x10001
s_lshl_b32 s81, s81, 8
s_add_u32 s94, s94, s81
s_and_b32 s81, s6, 1
s_lshl_b32 s81, s81, 3
s_add_u32 s94, s94, s81
s_lshl_b32 s81, s4, 10
s_add_u32 s94, s94, s81
s_add_u32 s94, s94, 51798016
s_add_u32 s95, s8, 3
s_mov_b32 s92, -1
s_and_b32 s82, s92, 0x3
s_cbranch_scc0 gt_125k
s_mov_b32 s82, s9
gt_125:
buffer_load_dword v2, v1, s[36:39], s94 offen sc1
s_waitcnt vmcnt(0)
v_subrev_u32 v2, s95, v2
v_cmp_lt_u32 s[92:93], 15, v2
s_and_b32 s83, s92, 0x3
s_cbranch_scc0 gt_125k
s_add_u32 s82, s82, 1
s_cmp_lt_u32 s82, 200000
s_cbranch_scc1 gt_125
s_mov_b32 s9, 200000
gt_125k:
s_add_u32 m0, s61, 0
s_add_u32 s79, s64, 0
buffer_load_dwordx4 v8, s[36:39], s79 offen offset:0 sc1 lds
buffer_load_dwordx4 v8, s[36:39], s79 offen offset:1024 sc1 lds
buffer_load_dwordx4 v8, s[36:39], s79 offen offset:2048 sc1 lds
buffer_load_dwordx4 v8, s[36:39], s79 offen offset:3072 sc1 lds
s_and_b32 s82, s92, 0xc
s_cbranch_scc0 gt_126k
s_mov_b32 s82, s9
gt_126:
buffer_load_dword v2, v1, s[36:39], s94 offen sc1
s_waitcnt vmcnt(0)
v_subrev_u32 v2, s95, v2
v_cmp_lt_u32 s[92:93], 15, v2
s_and_b32 s83, s92, 0xc
s_cbranch_scc0 gt_126k
s_add_u32 s82, s82, 1
s_cmp_lt_u32 s82, 200000
s_cbranch_scc1 gt_126
s_mov_b32 s9, 200000
gt_126k:
s_add_u32 m0, s61, 16384
s_add_u32 s79, s64, 4096
buffer_load_dwordx4 v8, s[36:39], s79 offen offset:0 sc1 lds
buffer_load_dwordx4 v8, s[36:39], s79 offen offset:1024 sc1 lds
s_add_u32 m0, s61, 18432
s_add_u32 s79, s64, 6144
buffer_load_dwordx4 v8, s[36:39], s79 offen offset:0 sc1 lds
buffer_load_dwordx4 v8, s[36:39], s79 offen offset:1024 sc1 lds
s_add_u32 m0, s63, 90112
s_add_u32 s79, s66, 49152
buffer_load_dwordx4 v8, s[36:39], s79 offen offset:0  lds
buffer_load_dwordx4 v8, s[36:39], s79 offen offset:1024  lds
s_waitcnt vmcnt(6)
s_barrier
s_add_u32 m0, s63, 92160
s_add_u32 s79, s66, 51200
buffer_load_dwordx4 v8, s[36:39], s79 offen offset:0  lds
buffer_load_dwordx4 v8, s[36:39], s79 offen offset:1024  lds
s_add_u32 m0, s63, 94208
s_add_u32 s79, s66, 53248
buffer_load_dwordx4 v8, s[36:39], s79 offen offset:0  lds
buffer_load_dwordx4 v8, s[36:39], s79 offen offset:1024  lds
s_and_b32 s82, s92, 0x30
s_cbranch_scc0 gt_127k
s_mov_b32 s82, s9
gt_127:
buffer_load_dword v2, v1, s[36:39], s94 offen sc1
s_waitcnt vmcnt(0)
v_subrev_u32 v2, s95, v2
v_cmp_lt_u32 s[92:93], 15, v2
s_and_b32 s83, s92, 0x30
s_cbranch_scc0 gt_127k
s_add_u32 s82, s82, 1
s_cmp_lt_u32 s82, 200000
s_cbranch_scc1 gt_127
s_mov_b32 s9, 200000
gt_127k:
s_add_u32 m0, s61, 32768
s_add_u32 s79, s64, 8192
buffer_load_dwordx4 v8, s[36:39], s79 offen offset:0 sc1 lds
buffer_load_dwordx4 v8, s[36:39], s79 offen offset:1024 sc1 lds
s_add_u32 m0, s61, 34816
s_add_u32 s79, s64, 10240
buffer_load_dwordx4 v8, s[36:39], s79 offen offset:0 sc1 lds
buffer_load_dwordx4 v8, s[36:39], s79 offen offset:1024 sc1 lds
s_add_u32 m0, s63, 65536
s_add_u32 s79, s66, 73728
buffer_load_dwordx4 v8, s[36:39], s79 offen offset:0  lds
buffer_load_dwordx4 v8, s[36:39], s79 offen offset:1024  lds
buffer_load_dword v3, v1, s[36:39], s94 offen sc1
s_waitcnt vmcnt(13)
s_barrier
s_add_u32 m0, s63, 67584
s_add_u32 s79, s66, 75776
buffer_load_dwordx4 v8, s[36:39], s79 offen offset:0  lds
buffer_load_dwordx4 v8, s[36:39], s79 offen offset:1024  lds
s_add_u32 m0, s63, 69632
s_add_u32 s79, s66, 77824
buffer_load_dwordx4 v8, s[36:39], s79 offen offset:0  lds
buffer_load_dwordx4 v8, s[36:39], s79 offen offset:1024  lds
s_and_b32 s82, s92, 0xc0
s_cbranch_scc0 gt_128k
s_mov_b32 s82, s9
gt_128:
buffer_load_dword v2, v1, s[36:39], s94 offen sc1
s_waitcnt vmcnt(0)
v_subrev_u32 v2, s95, v2
v_cmp_lt_u32 s[92:93], 15, v2
s_and_b32 s83, s92, 0xc0
s_cbranch_scc0 gt_128k
s_add_u32 s82, s82, 1
s_cmp_lt_u32 s82, 200000
s_cbranch_scc1 gt_128
s_mov_b32 s9, 200000
gt_128k:
s_add_u32 m0, s61, 49152
s_add_u32 s79, s64, 12288
buffer_load_dwordx4 v8, s[36:39], s79 offen offset:0 sc1 lds
buffer_load_dwordx4 v8, s[36:39], s79 offen offset:1024 sc1 lds
s_add_u32 m0, s61, 51200
s_add_u32 s79, s64, 14336
buffer_load_dwordx4 v8, s[36:39], s79 offen offset:0 sc1 lds
buffer_load_dwordx4 v8, s[36:39], s79 offen offset:1024 sc1 lds
s_add_u32 m0, s63, 139264
s_add_u32 s79, s66, 98304
buffer_load_dwordx4 v8, s[36:39], s79 offen offset:0  lds
buffer_load_dwordx4 v8, s[36:39], s79 offen offset:1024  lds
s_add_u32 s95, s95, 1
s_waitcnt vmcnt(10)
v_subrev_u32 v3, s95, v3
v_cmp_lt_u32 s[92:93], 15, v3
s_and_b32 s82, s92, 0xffff
s_cbranch_scc0 gt_129k
s_mov_b32 s82, s9
gt_129:
buffer_load_dword v2, v1, s[36:39], s94 offen sc1
s_waitcnt vmcnt(0)
v_subrev_u32 v2, s95, v2
v_cmp_lt_u32 s[92:93], 15, v2
s_and_b32 s83, s92, 0xffff
s_cbranch_scc0 gt_129k
s_add_u32 s82, s82, 1
s_cmp_lt_u32 s82, 200000
s_cbranch_scc1 gt_129
s_mov_b32 s9, 200000
gt_129k:
s_cmp_lg_u32 s3, 0
s_cbranch_scc1 t0_130
s_waitcnt vmcnt(5)
t0_130:
s_waitcnt vmcnt(13)
s_barrier
s_add_u32 m0, s63, 141312
s_add_u32 s79, s66, 100352
buffer_load_dwordx4 v8, s[36:39], s79 offen offset:0  lds
buffer_load_dwordx4 v8, s[36:39], s79 offen offset:1024  lds
s_add_u32 m0, s63, 143360
s_add_u32 s79, s66, 102400
buffer_load_dwordx4 v8, s[36:39], s79 offen offset:0  lds
buffer_load_dwordx4 v8, s[36:39], s79 offen offset:1024  lds
s_add_u32 m0, s61, 0
s_add_u32 s79, s64, 16384
buffer_load_dwordx4 v8, s[36:39], s79 offen offset:0 sc1 lds
buffer_load_dwordx4 v8, s[36:39], s79 offen offset:1024 sc1 lds
s_add_u32 m0, s61, 2048
s_add_u32 s79, s64, 18432
buffer_load_dwordx4 v8, s[36:39], s79 offen offset:0 sc1 lds
buffer_load_dwordx4 v8, s[36:39], s79 offen offset:1024 sc1 lds
s_add_u32 m0, s63, 114688
s_add_u32 s79, s66, 122880
buffer_load_dwordx4 v8, s[36:39], s79 offen offset:0  lds
buffer_load_dwordx4 v8, s[36:39], s79 offen offset:1024  lds
s_cmp_lg_u32 s3, 0
s_cbranch_scc1 t0_131
s_waitcnt vmcnt(5)
t0_131:
s_waitcnt vmcnt(12)
s_barrier
s_add_u32 m0, s63, 116736
s_add_u32 s79, s66, 124928
buffer_load_dwordx4 v8, s[36:39], s79 offen offset:0  lds
buffer_load_dwordx4 v8, s[36:39], s79 offen offset:1024  lds
s_add_u32 m0, s63, 118784
s_add_u32 s79, s66, 126976
buffer_load_dwordx4 v8, s[36:39], s79 offen offset:0  lds
buffer_load_dwordx4 v8, s[36:39], s79 offen offset:1024  lds
s_add_u32 m0, s61, 16384
s_add_u32 s79, s64, 20480
buffer_load_dwordx4 v8, s[36:39], s79 offen offset:0 sc1 lds
buffer_load_dwordx4 v8, s[36:39], s79 offen offset:1024 sc1 lds
s_add_u32 m0, s61, 18432
s_add_u32 s79, s64, 22528
buffer_load_dwordx4 v8, s[36:39], s79 offen offset:0 sc1 lds
buffer_load_dwordx4 v8, s[36:39], s79 offen offset:1024 sc1 lds
s_add_u32 m0, s63, 90112
s_add_u32 s79, s66, 147456
buffer_load_dwordx4 v8, s[36:39], s79 offen offset:0  lds
buffer_load_dwordx4 v8, s[36:39], s79 offen offset:1024  lds
s_cmp_lg_u32 s3, 0
s_cbranch_scc1 t0_132
s_waitcnt vmcnt(5)
t0_132:
s_waitcnt vmcnt(12)
s_barrier
s_add_u32 m0, s63, 92160
s_add_u32 s79, s66, 149504
buffer_load_dwordx4 v8, s[36:39], s79 offen offset:0  lds
buffer_load_dwordx4 v8, s[36:39], s79 offen offset:1024  lds
s_add_u32 m0, s63, 94208
s_add_u32 s79, s66, 151552
buffer_load_dwordx4 v8, s[36:39], s79 offen offset:0  lds
buffer_load_dwordx4 v8, s[36:39], s79 offen offset:1024  lds
s_add_u32 m0, s61, 32768
s_add_u32 s79, s64, 24576
buffer_load_dwordx4 v8, s[36:39], s79 offen offset:0 sc1 lds
buffer_load_dwordx4 v8, s[36:39], s79 offen offset:1024 sc1 lds
s_add_u32 m0, s61, 34816
s_add_u32 s79, s64, 26624
buffer_load_dwordx4 v8, s[36:39], s79 offen offset:0 sc1 lds
buffer_load_dwordx4 v8, s[36:39], s79 offen offset:1024 sc1 lds
s_add_u32 m0, s63, 65536
s_add_u32 s79, s66, 172032
buffer_load_dwordx4 v8, s[36:39], s79 offen offset:0  lds
buffer_load_dwordx4 v8, s[36:39], s79 offen offset:1024  lds
s_cmp_lg_u32 s3, 0
s_cbranch_scc1 t0_133
s_waitcnt vmcnt(5)
t0_133:
s_waitcnt vmcnt(12)
s_barrier
s_add_u32 m0, s63, 67584
s_add_u32 s79, s66, 174080
buffer_load_dwordx4 v8, s[36:39], s79 offen offset:0  lds
buffer_load_dwordx4 v8, s[36:39], s79 offen offset:1024  lds
s_add_u32 m0, s63, 69632
s_add_u32 s79, s66, 176128
buffer_load_dwordx4 v8, s[36:39], s79 offen offset:0  lds
buffer_load_dwordx4 v8, s[36:39], s79 offen offset:1024  lds
s_add_u32 m0, s61, 49152
s_add_u32 s79, s64, 28672
buffer_load_dwordx4 v8, s[36:39], s79 offen offset:0 sc1 lds
buffer_load_dwordx4 v8, s[36:39], s79 offen offset:1024 sc1 lds
s_add_u32 m0, s61, 51200
s_add_u32 s79, s64, 30720
buffer_load_dwordx4 v8, s[36:39], s79 offen offset:0 sc1 lds
buffer_load_dwordx4 v8, s[36:39], s79 offen offset:1024 sc1 lds
s_add_u32 m0, s63, 139264
s_add_u32 s79, s66, 196608
buffer_load_dwordx4 v8, s[36:39], s79 offen offset:0  lds
buffer_load_dwordx4 v8, s[36:39], s79 offen offset:1024  lds
s_cmp_lg_u32 s3, 0
s_cbranch_scc1 t0_134
s_waitcnt vmcnt(5)
t0_134:
v_and_b32 v4, 7, v0
v_lshlrev_b32 v4, 10, v4
s_lshl_b32 s78, s60, 13
s_add_u32 s78, s78, 22282280
buffer_load_dword v5, v4, s[36:39], s78 offen sc1
s_waitcnt vmcnt(13)
s_barrier
s_add_u32 m0, s63, 141312
s_add_u32 s79, s66, 198656
buffer_load_dwordx4 v8, s[36:39], s79 offen offset:0  lds
buffer_load_dwordx4 v8, s[36:39], s79 offen offset:1024  lds
s_add_u32 m0, s63, 143360
s_add_u32 s79, s66, 200704
buffer_load_dwordx4 v8, s[36:39], s79 offen offset:0  lds
buffer_load_dwordx4 v8, s[36:39], s79 offen offset:1024  lds
s_add_u32 m0, s61, 0
s_add_u32 s79, s64, 32768
buffer_load_dwordx4 v8, s[36:39], s79 offen offset:0 sc1 lds
buffer_load_dwordx4 v8, s[36:39], s79 offen offset:1024 sc1 lds
s_add_u32 m0, s61, 2048
s_add_u32 s79, s64, 34816
buffer_load_dwordx4 v8, s[36:39], s79 offen offset:0 sc1 lds
buffer_load_dwordx4 v8, s[36:39], s79 offen offset:1024 sc1 lds
s_add_u32 m0, s63, 114688
s_add_u32 s79, s66, 221184
buffer_load_dwordx4 v8, s[36:39], s79 offen offset:0  lds
buffer_load_dwordx4 v8, s[36:39], s79 offen offset:1024  lds
s_cmp_lg_u32 s3, 0
s_cbranch_scc1 t0_135
s_waitcnt vmcnt(5)
t0_135:
s_waitcnt vmcnt(13)
s_barrier
s_add_u32 m0, s63, 116736
s_add_u32 s79, s66, 223232
buffer_load_dwordx4 v8, s[36:39], s79 offen offset:0  lds
buffer_load_dwordx4 v8, s[36:39], s79 offen offset:1024  lds
s_add_u32 m0, s63, 118784
s_add_u32 s79, s66, 225280
buffer_load_dwordx4 v8, s[36:39], s79 offen offset:0  lds
buffer_load_dwordx4 v8, s[36:39], s79 offen offset:1024  lds
s_add_u32 m0, s61, 16384
s_add_u32 s79, s64, 36864
buffer_load_dwordx4 v8, s[36:39], s79 offen offset:0 sc1 lds
buffer_load_dwordx4 v8, s[36:39], s79 offen offset:1024 sc1 lds
s_add_u32 m0, s61, 18432
s_add_u32 s79, s64, 38912
buffer_load_dwordx4 v8, s[36:39], s79 offen offset:0 sc1 lds
buffer_load_dwordx4 v8, s[36:39], s79 offen offset:1024 sc1 lds
s_cmp_lg_u32 s3, 0
s_cbranch_scc1 t0_136
s_waitcnt vmcnt(5)
t0_136:
s_cmp_lg_u32 s3, 0
s_cbranch_scc1 fkc_137
s_mov_b32 s82, s9
s_waitcnt vmcnt(18)
s_branch poll_138c
poll_138:
buffer_load_dword v5, v4, s[36:39], s78 offen sc1
s_waitcnt vmcnt(0)
poll_138c:
v_subrev_u32 v5, s8, v5
v_cmp_lt_u32 vcc, 15, v5
s_cbranch_vccz pollok_139
s_sleep 2
s_add_u32 s82, s82, 1
s_cmp_lt_u32 s82, 200000
s_cbranch_scc1 poll_138
s_mov_b32 s9, 200000
pollok_139:
fkc_137:
s_waitcnt vmcnt(10)
s_barrier
s_add_u32 m0, s62, 40960
s_add_u32 s79, s68, 0
buffer_load_dwordx4 v8, s[36:39], s79 offen offset:0  lds
buffer_load_dwordx4 v8, s[36:39], s79 offen offset:1024  lds
s_add_u32 m0, s62, 43008
s_add_u32 s79, s68, 2048
buffer_load_dwordx4 v8, s[36:39], s79 offen offset:0  lds
buffer_load_dwordx4 v8, s[36:39], s79 offen offset:1024  lds
s_add_u32 m0, s62, 45056
s_add_u32 s79, s68, 4096
buffer_load_dwordx4 v8, s[36:39], s79 offen offset:0  lds
s_add_u32 m0, s62, 61440
s_add_u32 s79, s68, 20480
buffer_load_dwordx4 v8, s[36:39], s79 offen offset:0  lds
buffer_load_dwordx4 v8, s[36:39], s79 offen offset:1024  lds
s_add_u32 m0, s62, 63488
s_add_u32 s79, s68, 22528
buffer_load_dwordx4 v8, s[36:39], s79 offen offset:0  lds
buffer_load_dwordx4 v8, s[36:39], s79 offen offset:1024  lds
s_waitcnt vmcnt(9)
s_barrier
s_add_u32 m0, s62, 65536
s_add_u32 s79, s68, 24576
buffer_load_dwordx4 v8, s[36:39], s79 offen offset:0  lds
s_add_u32 m0, s62, 81920
s_add_u32 s79, s68, 40960
buffer_load_dwordx4 v8, s[36:39], s79 offen offset:0  lds
buffer_load_dwordx4 v8, s[36:39], s79 offen offset:1024  lds
buffer_load_dwordx4 v8, s[36:39], s79 offen offset:2048  lds
buffer_load_dwordx4 v8, s[36:39], s79 offen offset:3072  lds
s_add_u32 m0, s62, 86016
s_add_u32 s79, s68, 45056
buffer_load_dwordx4 v8, s[36:39], s79 offen offset:0  lds
s_barrier
s_add_u32 m0, s62, 102400
s_add_u32 s79, s68, 61440
buffer_load_dwordx4 v8, s[36:39], s79 offen offset:0  lds
buffer_load_dwordx4 v8, s[36:39], s79 offen offset:1024  lds
buffer_load_dwordx4 v8, s[36:39], s79 offen offset:2048  lds
buffer_load_dwordx4 v8, s[36:39], s79 offen offset:3072  lds
s_waitcnt vmcnt(14)
s_barrier
s_add_u32 m0, s62, 106496
s_add_u32 s79, s68, 65536
buffer_load_dwordx4 v8, s[36:39], s79 offen offset:0  lds
s_add_u32 m0, s62, 122880
s_add_u32 s79, s68, 81920
buffer_load_dwordx4 v8, s[36:39], s79 offen offset:0  lds
buffer_load_dwordx4 v8, s[36:39], s79 offen offset:1024  lds
buffer_load_dwordx4 v8, s[36:39], s79 offen offset:2048  lds
buffer_load_dwordx4 v8, s[36:39], s79 offen offset:3072  lds
s_add_u32 m0, s62, 126976
s_add_u32 s79, s68, 86016
buffer_load_dwordx4 v8, s[36:39], s79 offen offset:0  lds
s_add_u32 m0, s62, 143360
s_add_u32 s79, s68, 102400
buffer_load_dwordx4 v8, s[36:39], s79 offen offset:0  lds
buffer_load_dwordx4 v8, s[36:39], s79 offen offset:1024  lds
buffer_load_dwordx4 v8, s[36:39], s79 offen offset:2048  lds
buffer_load_dwordx4 v8, s[36:39], s79 offen offset:3072  lds
s_add_u32 m0, s62, 147456
s_add_u32 s79, s68, 106496
buffer_load_dwordx4 v8, s[36:39], s79 offen offset:0  lds
s_add_u32 m0, s62, 0
s_add_u32 s79, s68, 122880
buffer_load_dwordx4 v8, s[36:39], s79 offen offset:0  lds
buffer_load_dwordx4 v8, s[36:39], s79 offen offset:1024  lds
buffer_load_dwordx4 v8, s[36:39], s79 offen offset:2048  lds
buffer_load_dwordx4 v8, s[36:39], s79 offen offset:3072  lds
s_add_u32 m0, s62, 4096
s_add_u32 s79, s68, 126976
buffer_load_dwordx4 v8, s[36:39], s79 offen offset:0  lds
s_add_u32 m0, s62, 20480
s_add_u32 s79, s68, 143360
buffer_load_dwordx4 v8, s[36:39], s79 offen offset:0  lds
buffer_load_dwordx4 v8, s[36:39], s79 offen offset:1024  lds
buffer_load_dwordx4 v8, s[36:39], s79 offen offset:2048  lds
buffer_load_dwordx4 v8, s[36:39], s79 offen offset:3072  lds
s_add_u32 m0, s62, 24576
s_add_u32 s79, s68, 147456
buffer_load_dwordx4 v8, s[36:39], s79 offen offset:0  lds
s_waitcnt vmcnt(30)
s_barrier
s_waitcnt vmcnt(25)
s_barrier
s_add_u32 m0, s62, 40960
s_add_u32 s79, s68, 163840
buffer_load_dwordx4 v8, s[36:39], s79 offen offset:0  lds
buffer_load_dwordx4 v8, s[36:39], s79 offen offset:1024  lds
s_add_u32 m0, s62, 43008
s_add_u32 s79, s68, 165888
buffer_load_dwordx4 v8, s[36:39], s79 offen offset:0  lds
buffer_load_dwordx4 v8, s[36:39], s79 offen offset:1024  lds
s_waitcnt vmcnt(24)
s_barrier
s_add_u32 m0, s62, 45056
s_add_u32 s79, s68, 167936
buffer_load_dwordx4 v8, s[36:39], s79 offen offset:0  lds
s_add_u32 m0, s62, 61440
s_add_u32 s79, s68, 184320
buffer_load_dwordx4 v8, s[36:39], s79 offen offset:0  lds
buffer_load_dwordx4 v8, s[36:39], s79 offen offset:1024  lds
s_waitcnt vmcnt(22)
s_barrier
s_add_u32 m0, s62, 63488
s_add_u32 s79, s68, 186368
buffer_load_dwordx4 v8, s[36:39], s79 offen offset:0  lds
buffer_load_dwordx4 v8, s[36:39], s79 offen offset:1024  lds
s_add_u32 m0, s62, 65536
s_add_u32 s79, s68, 188416
buffer_load_dwordx4 v8, s[36:39], s79 offen offset:0  lds
s_waitcnt vmcnt(20)
s_barrier
s_add_u32 m0, s62, 81920
s_add_u32 s79, s68, 204800
buffer_load_dwordx4 v8, s[36:39], s79 offen offset:0  lds
buffer_load_dwordx4 v8, s[36:39], s79 offen offset:1024  lds
s_add_u32 m0, s62, 83968
s_add_u32 s79, s68, 206848
buffer_load_dwordx4 v8, s[36:39], s79 offen offset:0  lds
buffer_load_dwordx4 v8, s[36:39], s79 offen offset:1024  lds
s_waitcnt vmcnt(19)
s_barrier
s_add_u32 m0, s62, 86016
s_add_u32 s79, s68, 208896
buffer_load_dwordx4 v8, s[36:39], s79 offen offset:0  lds
s_add_u32 m0, s62, 102400
s_add_u32 s79, s68, 225280
buffer_load_dwordx4 v8, s[36:39], s79 offen offset:0  lds
buffer_load_dwordx4 v8, s[36:39], s79 offen offset:1024  lds
s_waitcnt vmcnt(17)
s_barrier
s_add_u32 m0, s62, 104448
s_add_u32 s79, s68, 227328
buffer_load_dwordx4 v8, s[36:39], s79 offen offset:0  lds
buffer_load_dwordx4 v8, s[36:39], s79 offen offset:1024  lds
s_add_u32 m0, s62, 106496
s_add_u32 s79, s68, 229376
buffer_load_dwordx4 v8, s[36:39], s79 offen offset:0  lds
s_waitcnt vmcnt(15)
s_barrier
s_cmp_eq_u32 s3, 0
s_cbranch_scc1 lx_140
s_waitcnt vmcnt(10)
s_barrier
s_waitcnt vmcnt(5)
s_barrier
s_waitcnt vmcnt(0)
s_barrier
s_barrier
s_branch L_end
lx_140:
s_add_u32 m0, s61, 131072
s_add_u32 s76, s72, 0
buffer_load_dwordx4 v6, s[44:47], s76 offen lds
s_add_u32 m0, s61, 132096
s_add_u32 s76, s72, 15360
buffer_load_dwordx4 v6, s[44:47], s76 offen lds
s_add_u32 m0, s61, 133120
s_add_u32 s76, s72, 30720
buffer_load_dwordx4 v7, s[44:47], s76 offen lds
s_add_u32 m0, s61, 134144
s_add_u32 s76, s72, 46080
buffer_load_dwordx4 v7, s[44:47], s76 offen lds
s_waitcnt vmcnt(14)
s_barrier
s_add_u32 m0, s61, 147456
s_add_u32 s76, s72, 245760
buffer_load_dwordx4 v6, s[44:47], s76 offen lds
s_add_u32 m0, s61, 148480
s_add_u32 s76, s72, 261120
buffer_load_dwordx4 v6, s[44:47], s76 offen lds
s_add_u32 m0, s61, 149504
s_add_u32 s76, s72, 276480
buffer_load_dwordx4 v7, s[44:47], s76 offen lds
s_add_u32 m0, s61, 150528
s_add_u32 s76, s72, 291840
buffer_load_dwordx4 v7, s[44:47], s76 offen lds
s_waitcnt vmcnt(13)
s_barrier
s_waitcnt vmcnt(8)
s_barrier
s_add_u32 m0, s61, 65536
s_add_u32 s76, s72, 491520
buffer_load_dwordx4 v6, s[44:47], s76 offen lds
s_add_u32 m0, s61, 66560
s_add_u32 s76, s72, 506880
buffer_load_dwordx4 v6, s[44:47], s76 offen lds
s_add_u32 m0, s61, 67584
s_add_u32 s76, s72, 522240
buffer_load_dwordx4 v7, s[44:47], s76 offen lds
s_barrier
s_cmp_lg_u32 s3, 0
s_cbranch_scc1 L_end
s_barrier
s_and_b32 s76, s5, 15
s_cmp_eq_u32 s76, 15
s_cbranch_scc1 L_fast_idle
s_lshr_b32 s76, s5, 4
s_mul_i32 s76, s76, 0
v_lshrrev_b32 v1, 1, v0
v_add_u32 v1, s76, v1
v_and_b32 v1, 7, v1
v_lshlrev_b32 v1, 5, v1
v_and_b32 v2, 1, v0
v_lshl_add_u32 v1, v2, 2, v1
s_lshr_b32 s94, s5, 4
s_lshl_b32 s94, s94, 9
s_bfe_u32 s81, s6, 0x10001
s_lshl_b32 s81, s81, 8
s_add_u32 s94, s94, s81
s_and_b32 s81, s6, 1
s_lshl_b32 s81, s81, 3
s_add_u32 s94, s94, s81
s_lshl_b32 s81, s4, 10
s_add_u32 s94, s94, s81
s_add_u32 s94, s94, 51798016
s_add_u32 s95, s8, 6
s_mov_b32 s92, -1
s_and_b32 s82, s92, 0x3
s_cbranch_scc0 gt_141k
s_mov_b32 s82, s9
gt_141:
buffer_load_dword v2, v1, s[36:39], s94 offen sc1
s_waitcnt vmcnt(0)
v_subrev_u32 v2, s95, v2
v_cmp_lt_u32 s[92:93], 15, v2
s_and_b32 s83, s92, 0x3
s_cbranch_scc0 gt_141k
s_add_u32 s82, s82, 1
s_cmp_lt_u32 s82, 200000
s_cbranch_scc1 gt_141
s_mov_b32 s9, 200000
gt_141k:
s_add_u32 m0, s61, 0
s_add_u32 s79, s70, 0
buffer_load_dwordx4 v8, s[36:39], s79 offen offset:0 sc1 lds
buffer_load_dwordx4 v8, s[36:39], s79 offen offset:1024 sc1 lds
buffer_load_dwordx4 v8, s[36:39], s79 offen offset:2048 sc1 lds
buffer_load_dwordx4 v8, s[36:39], s79 offen offset:3072 sc1 lds
s_and_b32 s82, s92, 0xc
s_cbranch_scc0 gt_142k
s_mov_b32 s82, s9
gt_142:
buffer_load_dword v2, v1, s[36:39], s94 offen sc1
s_waitcnt vmcnt(0)
v_subrev_u32 v2, s95, v2
v_cmp_lt_u32 s[92:93], 15, v2
s_and_b32 s83, s92, 0xc
s_cbranch_scc0 gt_142k
s_add_u32 s82, s82, 1
s_cmp_lt_u32 s82, 200000
s_cbranch_scc1 gt_142
s_mov_b32 s9, 200000
gt_142k:
s_add_u32 m0, s61, 16384
s_add_u32 s79, s70, 4096
buffer_load_dwordx4 v8, s[36:39], s79 offen offset:0 sc1 lds
buffer_load_dwordx4 v8, s[36:39], s79 offen offset:1024 sc1 lds
s_add_u32 m0, s61, 18432
s_add_u32 s79, s70, 6144
buffer_load_dwordx4 v8, s[36:39], s79 offen offset:0 sc1 lds
buffer_load_dwordx4 v8, s[36:39], s79 offen offset:1024 sc1 lds
s_add_u32 m0, s61, 68608
s_add_u32 s76, s72, 537600
buffer_load_dwordx4 v7, s[44:47], s76 offen lds
s_and_b32 s82, s92, 0x30
s_cbranch_scc0 gt_143k
s_mov_b32 s82, s9
gt_143:
buffer_load_dword v2, v1, s[36:39], s94 offen sc1
s_waitcnt vmcnt(0)
v_subrev_u32 v2, s95, v2
v_cmp_lt_u32 s[92:93], 15, v2
s_and_b32 s83, s92, 0x30
s_cbranch_scc0 gt_143k
s_add_u32 s82, s82, 1
s_cmp_lt_u32 s82, 200000
s_cbranch_scc1 gt_143
s_mov_b32 s9, 200000
gt_143k:
s_add_u32 m0, s61, 32768
s_add_u32 s79, s70, 8192
buffer_load_dwordx4 v8, s[36:39], s79 offen offset:0 sc1 lds
buffer_load_dwordx4 v8, s[36:39], s79 offen offset:1024 sc1 lds
s_waitcnt vmcnt(7)
s_barrier
s_add_u32 m0, s61, 34816
s_add_u32 s79, s70, 10240
buffer_load_dwordx4 v8, s[36:39], s79 offen offset:0 sc1 lds
buffer_load_dwordx4 v8, s[36:39], s79 offen offset:1024 sc1 lds
s_add_u32 m0, s61, 81920
s_add_u32 s76, s72, 737280
buffer_load_dwordx4 v6, s[44:47], s76 offen lds
s_add_u32 m0, s61, 82944
s_add_u32 s76, s72, 752640
buffer_load_dwordx4 v6, s[44:47], s76 offen lds
s_add_u32 m0, s61, 83968
s_add_u32 s76, s72, 768000
buffer_load_dwordx4 v7, s[44:47], s76 offen lds
s_add_u32 m0, s61, 84992
s_add_u32 s76, s72, 783360
buffer_load_dwordx4 v7, s[44:47], s76 offen lds
buffer_load_dword v3, v1, s[36:39], s94 offen sc1
s_waitcnt vmcnt(10)
s_barrier
s_and_b32 s82, s92, 0xc0
s_cbranch_scc0 gt_144k
s_mov_b32 s82, s9
gt_144:
buffer_load_dword v2, v1, s[36:39], s94 offen sc1
s_waitcnt vmcnt(0)
v_subrev_u32 v2, s95, v2
v_cmp_lt_u32 s[92:93], 15, v2
s_and_b32 s83, s92, 0xc0
s_cbranch_scc0 gt_144k
s_add_u32 s82, s82, 1
s_cmp_lt_u32 s82, 200000
s_cbranch_scc1 gt_144
s_mov_b32 s9, 200000
gt_144k:
s_add_u32 m0, s61, 49152
s_add_u32 s79, s70, 12288
buffer_load_dwordx4 v8, s[36:39], s79 offen offset:0 sc1 lds
buffer_load_dwordx4 v8, s[36:39], s79 offen offset:1024 sc1 lds
s_add_u32 m0, s61, 51200
s_add_u32 s79, s70, 14336
buffer_load_dwordx4 v8, s[36:39], s79 offen offset:0 sc1 lds
buffer_load_dwordx4 v8, s[36:39], s79 offen offset:1024 sc1 lds
s_add_u32 m0, s61, 98304
s_add_u32 s76, s72, 983040
buffer_load_dwordx4 v6, s[44:47], s76 offen lds
s_add_u32 m0, s61, 99328
s_add_u32 s76, s72, 998400
buffer_load_dwordx4 v6, s[44:47], s76 offen lds
s_add_u32 s95, s95, 1
s_waitcnt vmcnt(6)
v_subrev_u32 v3, s95, v3
v_cmp_lt_u32 s[92:93], 15, v3
s_and_b32 s82, s92, 0xffff
s_cbranch_scc0 gt_145k
s_mov_b32 s82, s9
gt_145:
buffer_load_dword v2, v1, s[36:39], s94 offen sc1
s_waitcnt vmcnt(0)
v_subrev_u32 v2, s95, v2
v_cmp_lt_u32 s[92:93], 15, v2
s_and_b32 s83, s92, 0xffff
s_cbranch_scc0 gt_145k
s_add_u32 s82, s82, 1
s_cmp_lt_u32 s82, 200000
s_cbranch_scc1 gt_145
s_mov_b32 s9, 200000
gt_145k:
s_waitcnt vmcnt(11)
s_barrier
s_add_u32 m0, s61, 100352
s_add_u32 s76, s72, 1013760
buffer_load_dwordx4 v7, s[44:47], s76 offen lds
s_add_u32 m0, s61, 101376
s_add_u32 s76, s72, 1029120
buffer_load_dwordx4 v7, s[44:47], s76 offen lds
s_add_u32 m0, s61, 0
s_add_u32 s79, s70, 16384
buffer_load_dwordx4 v8, s[36:39], s79 offen offset:0 sc1 lds
buffer_load_dwordx4 v8, s[36:39], s79 offen offset:1024 sc1 lds
s_add_u32 m0, s61, 2048
s_add_u32 s79, s70, 18432
buffer_load_dwordx4 v8, s[36:39], s79 offen offset:0 sc1 lds
buffer_load_dwordx4 v8, s[36:39], s79 offen offset:1024 sc1 lds
s_waitcnt vmcnt(8)
s_barrier
s_add_u32 m0, s61, 114688
s_add_u32 s76, s72, 1228800
buffer_load_dwordx4 v6, s[44:47], s76 offen lds
s_add_u32 m0, s61, 115712
s_add_u32 s76, s72, 1244160
buffer_load_dwordx4 v6, s[44:47], s76 offen lds
s_add_u32 m0, s61, 116736
s_add_u32 s76, s72, 1259520
buffer_load_dwordx4 v7, s[44:47], s76 offen lds
s_add_u32 m0, s61, 117760
s_add_u32 s76, s72, 1274880
buffer_load_dwordx4 v7, s[44:47], s76 offen lds
s_add_u32 m0, s61, 16384
s_add_u32 s79, s70, 20480
buffer_load_dwordx4 v8, s[36:39], s79 offen offset:0 sc1 lds
buffer_load_dwordx4 v8, s[36:39], s79 offen offset:1024 sc1 lds
s_waitcnt vmcnt(6)
s_barrier
s_add_u32 m0, s61, 18432
s_add_u32 s79, s70, 22528
buffer_load_dwordx4 v8, s[36:39], s79 offen offset:0 sc1 lds
buffer_load_dwordx4 v8, s[36:39], s79 offen offset:1024 sc1 lds
s_add_u32 m0, s61, 131072
s_add_u32 s76, s72, 1474560
buffer_load_dwordx4 v6, s[44:47], s76 offen lds
s_add_u32 m0, s61, 132096
s_add_u32 s76, s72, 1489920
buffer_load_dwordx4 v6, s[44:47], s76 offen lds
s_add_u32 m0, s61, 133120
s_add_u32 s76, s72, 1505280
buffer_load_dwordx4 v7, s[44:47], s76 offen lds
s_add_u32 m0, s61, 134144
s_add_u32 s76, s72, 1520640
buffer_load_dwordx4 v7, s[44:47], s76 offen lds
s_add_u32 m0, s61, 32768
s_add_u32 s79, s70, 24576
buffer_load_dwordx4 v8, s[36:39], s79 offen offset:0 sc1 lds
buffer_load_dwordx4 v8, s[36:39], s79 offen offset:1024 sc1 lds
s_waitcnt vmcnt(6)
s_barrier
s_add_u32 m0, s61, 34816
s_add_u32 s79, s70, 26624
buffer_load_dwordx4 v8, s[36:39], s79 offen offset:0 sc1 lds
buffer_load_dwordx4 v8, s[36:39], s79 offen offset:1024 sc1 lds
s_add_u32 m0, s61, 147456
s_add_u32 s76, s72, 1720320
buffer_load_dwordx4 v6, s[44:47], s76 offen lds
s_add_u32 m0, s61, 148480
s_add_u32 s76, s72, 1735680
buffer_load_dwordx4 v6, s[44:47], s76 offen lds
s_add_u32 m0, s61, 149504
s_add_u32 s76, s72, 1751040
buffer_load_dwordx4 v7, s[44:47], s76 offen lds
s_add_u32 m0, s61, 150528
s_add_u32 s76, s72, 1766400
buffer_load_dwordx4 v7, s[44:47], s76 offen lds
s_add_u32 m0, s61, 49152
s_add_u32 s79, s70, 28672
buffer_load_dwordx4 v8, s[36:39], s79 offen offset:0 sc1 lds
buffer_load_dwordx4 v8, s[36:39], s79 offen offset:1024 sc1 lds
s_waitcnt vmcnt(6)
s_barrier
s_add_u32 m0, s61, 51200
s_add_u32 s79, s70, 30720
buffer_load_dwordx4 v8, s[36:39], s79 offen offset:0 sc1 lds
buffer_load_dwordx4 v8, s[36:39], s79 offen offset:1024 sc1 lds
s_add_u32 m0, s61, 65536
s_add_u32 s76, s72, 1966080
buffer_load_dwordx4 v6, s[44:47], s76 offen lds
s_add_u32 m0, s61, 66560
s_add_u32 s76, s72, 1981440
buffer_load_dwordx4 v6, s[44:47], s76 offen lds
s_add_u32 m0, s61, 67584
s_add_u32 s76, s72, 1996800
buffer_load_dwordx4 v7, s[44:47], s76 offen lds
s_add_u32 m0, s61, 68608
s_add_u32 s76, s72, 2012160
buffer_load_dwordx4 v7, s[44:47], s76 offen lds
s_add_u32 m0, s61, 0
s_add_u32 s79, s70, 32768
buffer_load_dwordx4 v8, s[36:39], s79 offen offset:0 sc1 lds
buffer_load_dwordx4 v8, s[36:39], s79 offen offset:1024 sc1 lds
s_waitcnt vmcnt(6)
s_barrier
s_add_u32 m0, s61, 2048
s_add_u32 s79, s70, 34816
buffer_load_dwordx4 v8, s[36:39], s79 offen offset:0 sc1 lds
buffer_load_dwordx4 v8, s[36:39], s79 offen offset:1024 sc1 lds
s_add_u32 m0, s61, 81920
s_add_u32 s76, s72, 2211840
buffer_load_dwordx4 v6, s[44:47], s76 offen lds
s_add_u32 m0, s61, 82944
s_add_u32 s76, s72, 2227200
buffer_load_dwordx4 v6, s[44:47], s76 offen lds
s_add_u32 m0, s61, 83968
s_add_u32 s76, s72, 2242560
buffer_load_dwordx4 v7, s[44:47], s76 offen lds
s_add_u32 m0, s61, 84992
s_add_u32 s76, s72, 2257920
buffer_load_dwordx4 v7, s[44:47], s76 offen lds
s_add_u32 m0, s61, 16384
s_add_u32 s79, s70, 36864
buffer_load_dwordx4 v8, s[36:39], s79 offen offset:0 sc1 lds
buffer_load_dwordx4 v8, s[36:39], s79 offen offset:1024 sc1 lds
s_waitcnt vmcnt(6)
s_barrier
s_add_u32 m0, s61, 18432
s_add_u32 s79, s70, 38912
buffer_load_dwordx4 v8, s[36:39], s79 offen offset:0 sc1 lds
buffer_load_dwordx4 v8, s[36:39], s79 offen offset:1024 sc1 lds
s_waitcnt vmcnt(0)
s_barrier
s_barrier
s_branch L_fast_next
L_fast_idle:
s_waitcnt vmcnt(0)
s_barrier
L_fast_next:
s_mov_b32 s3, 1
s_mov_b32 s7, 22315008
s_add_u32 s8, s8, 7
s_mov_b32 s46, 0
s_branch L_fast
L_end:
s_xor_b32 s60, s6, 7
s_or_b32 s60, s60, s2
s_cmp_lg_u32 s60, 0
s_cbranch_scc1 L_end2
v_mov_b32 v1, 0
s_mov_b64 exec, 1
global_store_dword v1, v1, s[32:33] sc1
s_mov_b64 exec, -1
L_end2:
L_exit:
s_endpgm
L_fast_end:
L_slow:
s_and_b32 s60, s6, 3
s_lshr_b32 s61, s6, 2
v_lshlrev_b32 v5, 4, v0
s_mul_i32 s68, s5, 81920
s_add_u32 s68, s68, s7
s_and_b32 s64, s60, 1
s_mul_i32 s62, s64, 5120
s_mul_i32 s63, s64, 10240
s_lshr_b32 s64, s60, 1
s_mul_i32 s65, s64, 5120
s_add_u32 s63, s63, s65
s_mul_i32 s65, s64, 2621440
s_add_u32 s62, s62, s65
s_add_u32 s62, s62, s68
s_add_u32 s62, s62, 2621440
v_lshrrev_b32 v14, 5, v0
v_and_b32 v15, 31, v0
v_lshlrev_b32 v6, 3, v15
s_mul_i32 s64, s61, 10240
v_add_u32 v2, s64, v5
v_add_u32 v3, s64, v6
v_mul_u32_u24 v7, 320, v14
v_lshl_add_u32 v7, v15, 4, v7
v_add_u32 v4, s64, v7
s_mov_b32 s66, 0x000fffff
s_mov_b32 s67, 0x000fffff
s_mov_b32 s76, -1
s_mov_b32 s77, 0
v_and_b32 v9, 27, v0
v_cmp_eq_u32 vcc, 24, v9
v_mov_b32 v8, 0x3f803f80
s_nop 0
v_cndmask_b32 v8, 0, v8, vcc
v_mov_b32 v9, v8
v_lshlrev_b32 v13, 7, v0
v_mov_b32 v12, 0
v_mov_b64 v[144:145], v[8:9]
v_mov_b64 v[146:147], v[8:9]
v_mov_b64 v[148:149], v[8:9]
v_mov_b64 v[150:151], v[8:9]
v_mov_b64 v[152:153], v[8:9]
v_mov_b64 v[154:155], v[8:9]
v_mov_b64 v[156:157], v[8:9]
v_mov_b64 v[158:159], v[8:9]
v_mov_b64 v[160:161], v[8:9]
v_mov_b64 v[162:163], v[8:9]
v_mov_b64 v[164:165], v[8:9]
v_mov_b64 v[166:167], v[8:9]
v_mov_b64 v[168:169], v[8:9]
v_mov_b64 v[170:171], v[8:9]
v_mov_b64 v[172:173], v[8:9]
v_mov_b64 v[174:175], v[8:9]
v_mov_b64 v[40:41], v[8:9]
v_mov_b64 v[42:43], v[8:9]
v_mov_b64 v[44:45], v[8:9]
v_mov_b64 v[46:47], v[8:9]
v_mov_b64 v[112:113], 0
v_mov_b64 v[114:115], 0
v_mov_b64 v[116:117], 0
v_mov_b64 v[118:119], 0
v_mov_b64 v[120:121], 0
v_mov_b64 v[122:123], 0
v_mov_b64 v[124:125], 0
v_mov_b64 v[126:127], 0
v_mov_b64 v[128:129], 0
v_mov_b64 v[130:131], 0
v_mov_b64 v[132:133], 0
v_mov_b64 v[134:135], 0
v_mov_b64 v[136:137], 0
v_mov_b64 v[138:139], 0
v_mov_b64 v[140:141], 0
v_mov_b64 v[142:143], 0
v_mov_b64 v[104:105], 0
v_mov_b64 v[106:107], 0
v_mov_b64 v[108:109], 0
v_mov_b64 v[110:111], 0
v_mov_b64 v[20:21], 0
v_mov_b64 v[26:27], 0
s_mul_i32 s65, s60, 7168
s_add_u32 s65, s65, 102400
v_add_u32 v28, s65, v5
v_lshrrev_b32 v29, 1, v5
v_add_u32 v29, s65, v29
s_lshl_b32 s64, s60, 2
s_add_u32 s64, s64, 131072
v_mov_b32 v177, s64
s_mul_i32 s64, s5, 5
v_add_u32 v30, s64, v14
v_lshrrev_b32 v10, 1, v30
v_and_b32 v30, 1, v30
v_lshlrev_b32 v30, 3, v30
v_lshl_add_u32 v30, v10, 9, v30
v_lshl_add_u32 v30, v15, 4, v30
s_lshl_b32 s64, s4, 2
s_add_u32 s64, s64, s60
s_mul_i32 s96, s64, 81920
s_add_u32 s96, s96, s7
s_add_u32 s96, s96, 7864320
s_add_u32 s97, s96, 40960
s_mov_b32 s99, 0
v_mov_b32 v52, 0x3f803f80
v_mov_b32 v53, 0x3f80
v_mov_b32 v58, 0x3f803f80
v_mov_b32 v59, 0x3f80
v_mov_b32 v240, 0x3f803f80
v_mov_b32 v241, 0x3f80
v_mov_b32 v246, 0x3f803f80
v_mov_b32 v247, 0x3f80
v_mov_b32 v252, 0x3f803f80
v_mov_b32 v253, 0x3f80
s_cmp_eq_u32 s61, 0
s_cbranch_scc1 att_old_146
v_and_b32 v10, 1, v0
v_mul_u32_u24 v10, 19, v10
s_mul_i32 s64, s5, 20
v_add_u32 v10, s64, v10
v_lshrrev_b32 v10, 7, v10
v_lshlrev_b32 v10, 5, v10
s_lshr_b32 s64, s60, 1
s_and_b32 s65, s60, 1
s_lshl_b32 s71, s64, 9
s_lshl_b32 s69, s65, 2
s_add_u32 s71, s71, s69
v_and_b32 v11, 2, v0
v_lshl_add_u32 v11, v11, 2, v10
v_add_u32 v11, s71, v11
s_mul_i32 s71, s64, 160
s_lshl_b32 s69, s65, 9
s_add_u32 s71, s71, s69
s_add_u32 s71, s71, 160
v_and_b32 v12, 6, v0
v_lshl_add_u32 v12, v12, 1, v10
v_add_u32 v12, s71, v12
v_cmp_gt_u32 vcc, 8, v0
s_lshl_b32 s94, s4, 10
s_add_u32 s94, s94, 51798016
v_cndmask_b32 v12, v12, v11, vcc
s_add_u32 s95, s8, 1
s_mul_i32 s74, s4, 10240
s_add_u32 s74, s74, s62
s_mov_b32 s92, -1
s_setprio 1
s_mul_i32 s65, s60, 2560
s_add_u32 s71, s65, 102400
s_mul_i32 s64, s4, 10240
s_add_u32 s64, s64, s65
s_add_u32 s64, s64, s68
s_add_u32 s65, s64, 1280
s_and_b32 s82, s92, 0xff
s_cbranch_scc0 gt_148k
s_mov_b32 s82, s9
gt_148:
buffer_load_dword v11, v12, s[36:39], s94 offen sc1
s_waitcnt vmcnt(0)
v_subrev_u32 v11, s95, v11
v_cmp_lt_u32 s[92:93], 15, v11
s_and_b32 s83, s92, 0xff
s_cbranch_scc0 gt_148k
s_add_u32 s82, s82, 1
s_cmp_lt_u32 s82, 200000
s_cbranch_scc1 gt_148
s_mov_b32 s9, 200000
gt_148k:
s_add_u32 m0, s71, 0
s_mov_b64 exec, -1
buffer_load_dwordx4 v5, s[36:39], s64 offen sc1 lds
s_mov_b64 exec, 0xffff
buffer_load_dwordx4 v5, s[36:39], s64 offen offset:1024 sc1 lds
s_add_u32 m0, s71, 1280
s_mov_b64 exec, -1
buffer_load_dwordx4 v5, s[36:39], s65 offen sc1 lds
s_mov_b64 exec, 0xffff
buffer_load_dwordx4 v5, s[36:39], s65 offen offset:1024 sc1 lds
s_mov_b64 exec, -1
s_and_b32 s82, s92, 0xff00
s_cbranch_scc0 gt_149k
s_mov_b32 s82, s9
gt_149:
buffer_load_dword v11, v12, s[36:39], s94 offen sc1
s_waitcnt vmcnt(0)
v_subrev_u32 v11, s95, v11
v_cmp_lt_u32 s[92:93], 15, v11
s_and_b32 s83, s92, 0xff00
s_cbranch_scc0 gt_149k
s_add_u32 s82, s82, 1
s_cmp_lt_u32 s82, 200000
s_cbranch_scc1 gt_149
s_mov_b32 s9, 200000
gt_149k:
s_cmp_ge_u32 s60, 2
s_cbranch_scc1 att_v_150
s_add_u32 m0, s63, 0
s_add_u32 s79, s74, 0
buffer_load_dwordx4 v5, s[36:39], s79 offen offset:0 sc1 lds
buffer_load_dwordx4 v5, s[36:39], s79 offen offset:1024 sc1 lds
s_waitcnt vmcnt(0)
s_add_u32 m0, s63, 2048
s_add_u32 s79, s74, 2048
buffer_load_dwordx4 v5, s[36:39], s79 offen offset:0 sc1 lds
buffer_load_dwordx4 v5, s[36:39], s79 offen offset:1024 sc1 lds
buffer_load_dwordx4 v5, s[36:39], s79 offen offset:2048 sc1 lds
s_branch att_j_147
att_v_150:
s_add_u32 m0, s63, 0
s_add_u32 s79, s74, 0
buffer_load_dwordx4 v5, s[36:39], s79 offen offset:0 sc1 lds
buffer_load_dwordx4 v5, s[36:39], s79 offen offset:1024 sc1 lds
s_waitcnt vmcnt(2)
s_branch att_j_147
att_old_146:
s_setprio 2
v_add_u32 v10, s4, v0
v_and_b32 v10, 7, v10
v_bfe_u32 v11, v0, 3, 1
v_mul_u32_u24 v11, 19, v11
s_mul_i32 s64, s5, 20
v_add_u32 v11, s64, v11
v_lshrrev_b32 v11, 7, v11
v_lshl_add_u32 v10, v10, 5, v11
s_and_b32 s64, s60, 1
s_lshl_b32 s64, s64, 4
s_lshr_b32 s65, s60, 1
s_mul_i32 s65, s65, 5
s_add_u32 s64, s64, s65
s_add_u32 s64, s64, 5
v_add_u32 v10, s64, v10
v_lshlrev_b32 v12, 7, v10
v_lshrrev_b32 v11, 4, v0
v_lshl_add_u32 v12, v11, 2, v12
s_and_b32 s69, s5, 7
s_mul_i32 s69, s69, 102400
s_mul_i32 s70, s6, 5120
s_add_u32 s69, s69, s70
s_add_u32 s69, s69, 44630016
s_add_u32 s94, s7, 22282240
s_add_u32 s95, s8, 1
att_j_147:
s_mul_i32 s65, s60, 2560
s_add_u32 s65, s65, 102400
v_add_u32 v10, s65, v5
v_add_u32 v11, s65, v6
s_barrier
ds_read_b128 v[16:19], v10
ds_read_b128 v[22:25], v10 offset:1280
s_mov_b32 exec_hi, 0
ds_read_b64 v[20:21], v11 offset:1024
ds_read_b64 v[26:27], v11 offset:2304
s_mov_b32 exec_hi, -1
s_cmp_lg_u32 s61, 0
s_cbranch_scc1 att_ap_151
buffer_load_dword v180, v12, s[36:39], s94 offen sc1
att_ap_151:
s_cmp_lt_u32 s6, 6
s_cbranch_scc1 att_v2_152
s_add_u32 m0, s63, 2048
s_add_u32 s79, s74, 2048
buffer_load_dwordx4 v5, s[36:39], s79 offen offset:0 sc1 lds
buffer_load_dwordx4 v5, s[36:39], s79 offen offset:1024 sc1 lds
buffer_load_dwordx4 v5, s[36:39], s79 offen offset:2048 sc1 lds
att_v2_152:
s_mov_b64 exec, s[76:77]
ds_read_b64 v[52:53], v3 offset:1024
s_mov_b64 exec, -1
ds_read_b128 v[48:51], v2 offset:0
s_waitcnt lgkmcnt(0)
v_mfma_f32_32x32x16_bf16 v[64:79], v[48:51], v[16:19], 0
v_mfma_f32_32x32x8_bf16 v[64:79], v[52:53], v[20:21], v[64:79]
v_mfma_f32_32x32x16_bf16 v[80:95], v[48:51], v[22:25], 0
v_mfma_f32_32x32x8_bf16 v[80:95], v[52:53], v[26:27], v[80:95]
s_nop 9
v_max3_f32 v8, v64, v65, v66
v_max3_f32 v8, v8, v67, v68
v_max3_f32 v8, v8, v69, v70
v_max3_f32 v8, v8, v71, v72
v_max3_f32 v8, v8, v73, v74
v_max3_f32 v8, v8, v75, v76
v_max3_f32 v8, v8, v77, v78
v_max_f32 v8, v8, v79
v_max3_f32 v9, v80, v81, v82
v_max3_f32 v9, v9, v83, v84
v_max3_f32 v9, v9, v85, v86
v_max3_f32 v9, v9, v87, v88
v_max3_f32 v9, v9, v89, v90
v_max3_f32 v9, v9, v91, v92
v_max3_f32 v9, v9, v93, v94
v_max_f32 v9, v9, v95
v_mov_b32 v10, v8
v_mov_b32 v11, v9
s_nop 0
v_permlane32_swap_b32 v8, v10
v_permlane32_swap_b32 v9, v11
s_nop 0
v_max_f32 v8, v8, v10
v_max_f32 v9, v9, v11
s_mov_b32 exec_lo, 0
v_sub_f32 v32, 0, v8
v_and_b32 v33, 0xffff0000, v32
v_sub_f32 v34, v32, v33
v_and_b32 v35, 0xffff0000, v34
v_sub_f32 v34, v34, v35
v_lshrrev_b32 v33, 16, v33
v_or_b32 v20, v33, v35
v_lshrrev_b32 v21, 16, v34
v_sub_f32 v36, 0, v9
v_and_b32 v37, 0xffff0000, v36
v_sub_f32 v38, v36, v37
v_and_b32 v39, 0xffff0000, v38
v_sub_f32 v38, v38, v39
v_lshrrev_b32 v37, 16, v37
v_or_b32 v26, v37, v39
v_lshrrev_b32 v27, 16, v38
s_mov_b32 exec_lo, -1
v_sub_f32 v64, v64, v8
v_sub_f32 v65, v65, v8
v_sub_f32 v66, v66, v8
v_sub_f32 v67, v67, v8
v_sub_f32 v68, v68, v8
v_sub_f32 v69, v69, v8
v_sub_f32 v70, v70, v8
v_sub_f32 v71, v71, v8
v_sub_f32 v72, v72, v8
v_sub_f32 v73, v73, v8
v_sub_f32 v74, v74, v8
v_sub_f32 v75, v75, v8
v_sub_f32 v76, v76, v8
v_sub_f32 v77, v77, v8
v_sub_f32 v78, v78, v8
v_sub_f32 v79, v79, v8
s_cmp_eq_u32 s61, 0
s_cbranch_scc1 att_w0_153
s_waitcnt vmcnt(3)
s_cmp_ge_u32 s60, 2
s_cbranch_scc1 att_w1_154b
s_waitcnt vmcnt(2)
att_w1_154b:
s_barrier
s_branch att_w1_154
att_w0_153:
s_barrier
s_waitcnt vmcnt(0)
v_subrev_u32 v180, s95, v180
v_cmp_lt_u32 s[92:93], 15, v180
s_or_b32 s92, s92, s93
s_and_b32 s75, s92, 0x02020202
s_cbranch_scc1 att_w1_154
s_add_u32 s64, s4, 1
s_and_b32 s64, s64, 7
s_mul_i32 s64, s64, 10240
s_add_u32 s64, s64, s62
s_add_u32 m0, s63, 20480
s_add_u32 s79, s64, 0
buffer_load_dwordx4 v5, s[36:39], s79 offen offset:0 sc1 lds
buffer_load_dwordx4 v5, s[36:39], s79 offen offset:1024 sc1 lds
buffer_load_dwordx4 v5, s[36:39], s79 offen offset:2048 sc1 lds
buffer_load_dwordx4 v5, s[36:39], s79 offen offset:3072 sc1 lds
s_add_u32 m0, s63, 24576
s_add_u32 s79, s64, 4096
buffer_load_dwordx4 v5, s[36:39], s79 offen offset:0 sc1 lds
att_w1_154:
v_mfma_f32_32x32x16_bf16 v[80:95], v[48:51], v[22:25], 0
ds_read_b128 v[54:57], v2 offset:1280
s_mov_b64 exec, s[76:77]
ds_read_b64 v[58:59], v3 offset:2304
s_mov_b64 exec, s[66:67]
ds_read_b128 v[144:147], v4 offset:5120
ds_read_b128 v[148:151], v4 offset:5760
s_mov_b64 exec, -1
v_exp_f32 v64, v64
v_exp_f32 v65, v65
v_exp_f32 v66, v66
v_exp_f32 v67, v67
v_cvt_pk_bf16_f32 v96, v64, v65
v_exp_f32 v68, v68
v_mfma_f32_32x32x16_bf16 v[128:143], v[40:43], v[104:107], v[128:143]
v_exp_f32 v69, v69
v_cvt_pk_bf16_f32 v97, v66, v67
v_exp_f32 v70, v70
v_exp_f32 v71, v71
v_cvt_pk_bf16_f32 v98, v68, v69
v_exp_f32 v72, v72
v_mfma_f32_32x32x8_bf16 v[80:95], v[52:53], v[26:27], v[80:95]
v_exp_f32 v73, v73
v_cvt_pk_bf16_f32 v99, v70, v71
v_exp_f32 v74, v74
v_exp_f32 v75, v75
v_cvt_pk_bf16_f32 v100, v72, v73
v_exp_f32 v76, v76
v_mfma_f32_32x32x16_bf16 v[128:143], v[44:47], v[108:111], v[128:143]
v_exp_f32 v77, v77
v_cvt_pk_bf16_f32 v101, v74, v75
v_exp_f32 v78, v78
v_exp_f32 v79, v79
v_cvt_pk_bf16_f32 v102, v76, v77
v_cvt_pk_bf16_f32 v103, v78, v79
s_waitcnt lgkmcnt(0)
v_mfma_f32_32x32x16_bf16 v[64:79], v[54:57], v[16:19], 0
v_exp_f32 v80, v80
v_exp_f32 v81, v81
v_exp_f32 v82, v82
v_exp_f32 v83, v83
v_cvt_pk_bf16_f32 v104, v80, v81
v_exp_f32 v84, v84
v_mfma_f32_32x32x16_bf16 v[112:127], v[144:147], v[96:99], v[112:127]
v_exp_f32 v85, v85
v_cvt_pk_bf16_f32 v105, v82, v83
v_exp_f32 v86, v86
v_exp_f32 v87, v87
v_cvt_pk_bf16_f32 v106, v84, v85
v_exp_f32 v88, v88
v_mfma_f32_32x32x8_bf16 v[64:79], v[58:59], v[20:21], v[64:79]
v_exp_f32 v89, v89
v_cvt_pk_bf16_f32 v107, v86, v87
v_exp_f32 v90, v90
v_exp_f32 v91, v91
v_cvt_pk_bf16_f32 v108, v88, v89
v_exp_f32 v92, v92
v_mfma_f32_32x32x16_bf16 v[112:127], v[148:151], v[100:103], v[112:127]
v_exp_f32 v93, v93
v_cvt_pk_bf16_f32 v109, v90, v91
v_exp_f32 v94, v94
v_exp_f32 v95, v95
v_cvt_pk_bf16_f32 v110, v92, v93
v_cvt_pk_bf16_f32 v111, v94, v95
s_cmp_eq_u32 s61, 0
s_cbranch_scc1 att_hk_155
s_waitcnt vmcnt(0)
s_barrier
att_hk_155r:
v_mfma_f32_32x32x16_bf16 v[80:95], v[54:57], v[22:25], 0
ds_read_b128 v[236:239], v2 offset:2560
s_mov_b64 exec, s[76:77]
ds_read_b64 v[240:241], v3 offset:3584
ds_read_b64 v[246:247], v3 offset:4864
s_mov_b64 exec, s[66:67]
ds_read_b128 v[152:155], v4 offset:6400
ds_read_b128 v[156:159], v4 offset:7040
ds_read_b128 v[160:163], v4 offset:7680
ds_read_b128 v[164:167], v4 offset:8320
s_mov_b64 exec, -1
v_exp_f32 v64, v64
v_exp_f32 v65, v65
v_exp_f32 v66, v66
v_exp_f32 v67, v67
v_cvt_pk_bf16_f32 v96, v64, v65
v_exp_f32 v68, v68
v_mfma_f32_32x32x16_bf16 v[128:143], v[144:147], v[104:107], v[128:143]
ds_read_b128 v[242:245], v2 offset:3840
v_exp_f32 v69, v69
v_cvt_pk_bf16_f32 v97, v66, v67
v_exp_f32 v70, v70
v_exp_f32 v71, v71
v_cvt_pk_bf16_f32 v98, v68, v69
v_exp_f32 v72, v72
v_mfma_f32_32x32x8_bf16 v[80:95], v[58:59], v[26:27], v[80:95]
v_exp_f32 v73, v73
v_cvt_pk_bf16_f32 v99, v70, v71
v_exp_f32 v74, v74
v_exp_f32 v75, v75
v_cvt_pk_bf16_f32 v100, v72, v73
v_exp_f32 v76, v76
v_mfma_f32_32x32x16_bf16 v[128:143], v[148:151], v[108:111], v[128:143]
v_exp_f32 v77, v77
v_cvt_pk_bf16_f32 v101, v74, v75
v_exp_f32 v78, v78
v_exp_f32 v79, v79
v_cvt_pk_bf16_f32 v102, v76, v77
v_cvt_pk_bf16_f32 v103, v78, v79
s_waitcnt lgkmcnt(0)
v_mfma_f32_32x32x16_bf16 v[64:79], v[236:239], v[16:19], 0
v_exp_f32 v80, v80
v_exp_f32 v81, v81
v_exp_f32 v82, v82
v_exp_f32 v83, v83
v_cvt_pk_bf16_f32 v104, v80, v81
v_exp_f32 v84, v84
v_mfma_f32_32x32x16_bf16 v[112:127], v[152:155], v[96:99], v[112:127]
v_exp_f32 v85, v85
v_cvt_pk_bf16_f32 v105, v82, v83
v_exp_f32 v86, v86
v_exp_f32 v87, v87
v_cvt_pk_bf16_f32 v106, v84, v85
v_exp_f32 v88, v88
v_mfma_f32_32x32x8_bf16 v[64:79], v[240:241], v[20:21], v[64:79]
v_exp_f32 v89, v89
v_cvt_pk_bf16_f32 v107, v86, v87
v_exp_f32 v90, v90
v_exp_f32 v91, v91
v_cvt_pk_bf16_f32 v108, v88, v89
v_exp_f32 v92, v92
v_mfma_f32_32x32x16_bf16 v[112:127], v[156:159], v[100:103], v[112:127]
v_exp_f32 v93, v93
v_cvt_pk_bf16_f32 v109, v90, v91
v_exp_f32 v94, v94
v_exp_f32 v95, v95
v_cvt_pk_bf16_f32 v110, v92, v93
v_cvt_pk_bf16_f32 v111, v94, v95
v_mfma_f32_32x32x16_bf16 v[80:95], v[236:239], v[22:25], 0
v_exp_f32 v64, v64
v_exp_f32 v65, v65
v_exp_f32 v66, v66
v_exp_f32 v67, v67
v_cvt_pk_bf16_f32 v96, v64, v65
v_exp_f32 v68, v68
v_mfma_f32_32x32x16_bf16 v[128:143], v[152:155], v[104:107], v[128:143]
v_exp_f32 v69, v69
v_cvt_pk_bf16_f32 v97, v66, v67
v_exp_f32 v70, v70
v_exp_f32 v71, v71
v_cvt_pk_bf16_f32 v98, v68, v69
v_exp_f32 v72, v72
v_mfma_f32_32x32x8_bf16 v[80:95], v[240:241], v[26:27], v[80:95]
v_exp_f32 v73, v73
v_cvt_pk_bf16_f32 v99, v70, v71
v_exp_f32 v74, v74
v_exp_f32 v75, v75
v_cvt_pk_bf16_f32 v100, v72, v73
v_exp_f32 v76, v76
v_mfma_f32_32x32x16_bf16 v[128:143], v[156:159], v[108:111], v[128:143]
v_exp_f32 v77, v77
v_cvt_pk_bf16_f32 v101, v74, v75
v_exp_f32 v78, v78
v_exp_f32 v79, v79
v_cvt_pk_bf16_f32 v102, v76, v77
v_cvt_pk_bf16_f32 v103, v78, v79
v_mfma_f32_32x32x16_bf16 v[64:79], v[242:245], v[16:19], 0
v_exp_f32 v80, v80
v_exp_f32 v81, v81
v_exp_f32 v82, v82
v_exp_f32 v83, v83
v_cvt_pk_bf16_f32 v104, v80, v81
v_exp_f32 v84, v84
v_mfma_f32_32x32x16_bf16 v[112:127], v[160:163], v[96:99], v[112:127]
v_exp_f32 v85, v85
v_cvt_pk_bf16_f32 v105, v82, v83
v_exp_f32 v86, v86
v_exp_f32 v87, v87
v_cvt_pk_bf16_f32 v106, v84, v85
v_exp_f32 v88, v88
v_mfma_f32_32x32x8_bf16 v[64:79], v[246:247], v[20:21], v[64:79]
v_exp_f32 v89, v89
v_cvt_pk_bf16_f32 v107, v86, v87
v_exp_f32 v90, v90
v_exp_f32 v91, v91
v_cvt_pk_bf16_f32 v108, v88, v89
v_exp_f32 v92, v92
v_mfma_f32_32x32x16_bf16 v[112:127], v[164:167], v[100:103], v[112:127]
v_exp_f32 v93, v93
v_cvt_pk_bf16_f32 v109, v90, v91
v_exp_f32 v94, v94
v_exp_f32 v95, v95
v_cvt_pk_bf16_f32 v110, v92, v93
v_cvt_pk_bf16_f32 v111, v94, v95
s_cmp_eq_u32 s61, 0
s_cbranch_scc1 att_hk_156
att_hk_156r:
s_barrier
v_mfma_f32_32x32x16_bf16 v[80:95], v[242:245], v[22:25], 0
ds_read_b128 v[248:251], v2 offset:20480
s_mov_b64 exec, s[76:77]
ds_read_b64 v[252:253], v3 offset:21504
ds_read_b64 v[52:53], v3 offset:22784
s_mov_b64 exec, s[66:67]
ds_read_b128 v[168:171], v4 offset:8960
ds_read_b128 v[172:175], v4 offset:9600
ds_read_b128 v[40:43], v4 offset:25600
ds_read_b128 v[44:47], v4 offset:26240
s_mov_b64 exec, -1
v_exp_f32 v64, v64
v_exp_f32 v65, v65
v_exp_f32 v66, v66
v_exp_f32 v67, v67
v_cvt_pk_bf16_f32 v96, v64, v65
v_exp_f32 v68, v68
v_mfma_f32_32x32x16_bf16 v[128:143], v[160:163], v[104:107], v[128:143]
ds_read_b128 v[48:51], v2 offset:21760
v_exp_f32 v69, v69
v_cvt_pk_bf16_f32 v97, v66, v67
v_exp_f32 v70, v70
v_exp_f32 v71, v71
v_cvt_pk_bf16_f32 v98, v68, v69
v_exp_f32 v72, v72
v_mfma_f32_32x32x8_bf16 v[80:95], v[246:247], v[26:27], v[80:95]
v_exp_f32 v73, v73
v_cvt_pk_bf16_f32 v99, v70, v71
v_exp_f32 v74, v74
v_exp_f32 v75, v75
v_cvt_pk_bf16_f32 v100, v72, v73
v_exp_f32 v76, v76
v_mfma_f32_32x32x16_bf16 v[128:143], v[164:167], v[108:111], v[128:143]
v_exp_f32 v77, v77
v_cvt_pk_bf16_f32 v101, v74, v75
v_exp_f32 v78, v78
v_exp_f32 v79, v79
v_cvt_pk_bf16_f32 v102, v76, v77
v_cvt_pk_bf16_f32 v103, v78, v79
s_waitcnt lgkmcnt(0)
v_mfma_f32_32x32x16_bf16 v[64:79], v[248:251], v[16:19], 0
v_exp_f32 v80, v80
v_exp_f32 v81, v81
v_exp_f32 v82, v82
v_exp_f32 v83, v83
v_cvt_pk_bf16_f32 v104, v80, v81
v_exp_f32 v84, v84
v_mfma_f32_32x32x16_bf16 v[112:127], v[168:171], v[96:99], v[112:127]
v_exp_f32 v85, v85
v_cvt_pk_bf16_f32 v105, v82, v83
v_exp_f32 v86, v86
v_exp_f32 v87, v87
v_cvt_pk_bf16_f32 v106, v84, v85
v_exp_f32 v88, v88
v_mfma_f32_32x32x8_bf16 v[64:79], v[252:253], v[20:21], v[64:79]
v_exp_f32 v89, v89
v_cvt_pk_bf16_f32 v107, v86, v87
v_exp_f32 v90, v90
v_exp_f32 v91, v91
v_cvt_pk_bf16_f32 v108, v88, v89
v_exp_f32 v92, v92
v_mfma_f32_32x32x16_bf16 v[112:127], v[172:175], v[100:103], v[112:127]
v_exp_f32 v93, v93
v_cvt_pk_bf16_f32 v109, v90, v91
v_exp_f32 v94, v94
v_exp_f32 v95, v95
v_cvt_pk_bf16_f32 v110, v92, v93
v_cvt_pk_bf16_f32 v111, v94, v95
v_mfma_f32_32x32x16_bf16 v[80:95], v[248:251], v[22:25], 0
v_exp_f32 v64, v64
v_exp_f32 v65, v65
v_exp_f32 v66, v66
v_exp_f32 v67, v67
v_cvt_pk_bf16_f32 v96, v64, v65
v_exp_f32 v68, v68
v_mfma_f32_32x32x16_bf16 v[128:143], v[168:171], v[104:107], v[128:143]
v_exp_f32 v69, v69
v_cvt_pk_bf16_f32 v97, v66, v67
v_exp_f32 v70, v70
v_exp_f32 v71, v71
v_cvt_pk_bf16_f32 v98, v68, v69
v_exp_f32 v72, v72
v_mfma_f32_32x32x8_bf16 v[80:95], v[252:253], v[26:27], v[80:95]
v_exp_f32 v73, v73
v_cvt_pk_bf16_f32 v99, v70, v71
v_exp_f32 v74, v74
v_exp_f32 v75, v75
v_cvt_pk_bf16_f32 v100, v72, v73
v_exp_f32 v76, v76
v_mfma_f32_32x32x16_bf16 v[128:143], v[172:175], v[108:111], v[128:143]
v_exp_f32 v77, v77
v_cvt_pk_bf16_f32 v101, v74, v75
v_exp_f32 v78, v78
v_exp_f32 v79, v79
v_cvt_pk_bf16_f32 v102, v76, v77
v_cvt_pk_bf16_f32 v103, v78, v79
v_mfma_f32_32x32x16_bf16 v[64:79], v[48:51], v[16:19], 0
v_exp_f32 v80, v80
v_exp_f32 v81, v81
v_exp_f32 v82, v82
v_exp_f32 v83, v83
v_cvt_pk_bf16_f32 v104, v80, v81
v_exp_f32 v84, v84
v_mfma_f32_32x32x16_bf16 v[112:127], v[40:43], v[96:99], v[112:127]
v_exp_f32 v85, v85
v_cvt_pk_bf16_f32 v105, v82, v83
v_exp_f32 v86, v86
v_exp_f32 v87, v87
v_cvt_pk_bf16_f32 v106, v84, v85
v_exp_f32 v88, v88
v_mfma_f32_32x32x8_bf16 v[64:79], v[52:53], v[20:21], v[64:79]
v_exp_f32 v89, v89
v_cvt_pk_bf16_f32 v107, v86, v87
v_exp_f32 v90, v90
v_exp_f32 v91, v91
v_cvt_pk_bf16_f32 v108, v88, v89
v_exp_f32 v92, v92
v_mfma_f32_32x32x16_bf16 v[112:127], v[44:47], v[100:103], v[112:127]
v_exp_f32 v93, v93
v_cvt_pk_bf16_f32 v109, v90, v91
v_exp_f32 v94, v94
v_exp_f32 v95, v95
v_cvt_pk_bf16_f32 v110, v92, v93
v_cvt_pk_bf16_f32 v111, v94, v95
v_mfma_f32_32x32x16_bf16 v[80:95], v[48:51], v[22:25], 0
ds_read_b128 v[54:57], v2 offset:23040
s_mov_b64 exec, s[76:77]
ds_read_b64 v[58:59], v3 offset:24064
ds_read_b64 v[240:241], v3 offset:25344
s_mov_b64 exec, s[66:67]
ds_read_b128 v[144:147], v4 offset:26880
ds_read_b128 v[148:151], v4 offset:27520
ds_read_b128 v[152:155], v4 offset:28160
ds_read_b128 v[156:159], v4 offset:28800
s_mov_b64 exec, -1
v_exp_f32 v64, v64
v_exp_f32 v65, v65
v_exp_f32 v66, v66
v_exp_f32 v67, v67
v_cvt_pk_bf16_f32 v96, v64, v65
v_exp_f32 v68, v68
v_mfma_f32_32x32x16_bf16 v[128:143], v[40:43], v[104:107], v[128:143]
ds_read_b128 v[236:239], v2 offset:24320
v_exp_f32 v69, v69
v_cvt_pk_bf16_f32 v97, v66, v67
v_exp_f32 v70, v70
v_exp_f32 v71, v71
v_cvt_pk_bf16_f32 v98, v68, v69
v_exp_f32 v72, v72
v_mfma_f32_32x32x8_bf16 v[80:95], v[52:53], v[26:27], v[80:95]
v_exp_f32 v73, v73
v_cvt_pk_bf16_f32 v99, v70, v71
v_exp_f32 v74, v74
v_exp_f32 v75, v75
v_cvt_pk_bf16_f32 v100, v72, v73
v_exp_f32 v76, v76
v_mfma_f32_32x32x16_bf16 v[128:143], v[44:47], v[108:111], v[128:143]
v_exp_f32 v77, v77
v_cvt_pk_bf16_f32 v101, v74, v75
v_exp_f32 v78, v78
v_exp_f32 v79, v79
v_cvt_pk_bf16_f32 v102, v76, v77
v_cvt_pk_bf16_f32 v103, v78, v79
s_waitcnt lgkmcnt(0)
v_mfma_f32_32x32x16_bf16 v[64:79], v[54:57], v[16:19], 0
v_exp_f32 v80, v80
v_exp_f32 v81, v81
v_exp_f32 v82, v82
v_exp_f32 v83, v83
v_cvt_pk_bf16_f32 v104, v80, v81
v_exp_f32 v84, v84
v_mfma_f32_32x32x16_bf16 v[112:127], v[144:147], v[96:99], v[112:127]
v_exp_f32 v85, v85
v_cvt_pk_bf16_f32 v105, v82, v83
v_exp_f32 v86, v86
v_exp_f32 v87, v87
v_cvt_pk_bf16_f32 v106, v84, v85
v_exp_f32 v88, v88
v_mfma_f32_32x32x8_bf16 v[64:79], v[58:59], v[20:21], v[64:79]
v_exp_f32 v89, v89
v_cvt_pk_bf16_f32 v107, v86, v87
v_exp_f32 v90, v90
v_exp_f32 v91, v91
v_cvt_pk_bf16_f32 v108, v88, v89
v_exp_f32 v92, v92
v_mfma_f32_32x32x16_bf16 v[112:127], v[148:151], v[100:103], v[112:127]
v_exp_f32 v93, v93
v_cvt_pk_bf16_f32 v109, v90, v91
v_exp_f32 v94, v94
v_exp_f32 v95, v95
v_cvt_pk_bf16_f32 v110, v92, v93
v_cvt_pk_bf16_f32 v111, v94, v95
v_mfma_f32_32x32x16_bf16 v[80:95], v[54:57], v[22:25], 0
v_exp_f32 v64, v64
v_exp_f32 v65, v65
v_exp_f32 v66, v66
v_exp_f32 v67, v67
v_cvt_pk_bf16_f32 v96, v64, v65
v_exp_f32 v68, v68
v_mfma_f32_32x32x16_bf16 v[128:143], v[144:147], v[104:107], v[128:143]
v_exp_f32 v69, v69
v_cvt_pk_bf16_f32 v97, v66, v67
v_exp_f32 v70, v70
v_exp_f32 v71, v71
v_cvt_pk_bf16_f32 v98, v68, v69
v_exp_f32 v72, v72
v_mfma_f32_32x32x8_bf16 v[80:95], v[58:59], v[26:27], v[80:95]
v_exp_f32 v73, v73
v_cvt_pk_bf16_f32 v99, v70, v71
v_exp_f32 v74, v74
v_exp_f32 v75, v75
v_cvt_pk_bf16_f32 v100, v72, v73
v_exp_f32 v76, v76
v_mfma_f32_32x32x16_bf16 v[128:143], v[148:151], v[108:111], v[128:143]
v_exp_f32 v77, v77
v_cvt_pk_bf16_f32 v101, v74, v75
v_exp_f32 v78, v78
v_exp_f32 v79, v79
v_cvt_pk_bf16_f32 v102, v76, v77
v_cvt_pk_bf16_f32 v103, v78, v79
v_mfma_f32_32x32x16_bf16 v[64:79], v[236:239], v[16:19], 0
v_exp_f32 v80, v80
v_exp_f32 v81, v81
v_exp_f32 v82, v82
v_exp_f32 v83, v83
v_cvt_pk_bf16_f32 v104, v80, v81
v_exp_f32 v84, v84
v_mfma_f32_32x32x16_bf16 v[112:127], v[152:155], v[96:99], v[112:127]
v_exp_f32 v85, v85
v_cvt_pk_bf16_f32 v105, v82, v83
v_exp_f32 v86, v86
v_exp_f32 v87, v87
v_cvt_pk_bf16_f32 v106, v84, v85
v_exp_f32 v88, v88
v_mfma_f32_32x32x8_bf16 v[64:79], v[240:241], v[20:21], v[64:79]
v_exp_f32 v89, v89
v_cvt_pk_bf16_f32 v107, v86, v87
v_exp_f32 v90, v90
v_exp_f32 v91, v91
v_cvt_pk_bf16_f32 v108, v88, v89
v_exp_f32 v92, v92
v_mfma_f32_32x32x16_bf16 v[112:127], v[156:159], v[100:103], v[112:127]
v_exp_f32 v93, v93
v_cvt_pk_bf16_f32 v109, v90, v91
v_exp_f32 v94, v94
v_exp_f32 v95, v95
v_cvt_pk_bf16_f32 v110, v92, v93
v_cvt_pk_bf16_f32 v111, v94, v95
s_cmp_eq_u32 s61, 0
s_cbranch_scc1 att_hk_157
att_hk_157r:
s_barrier
v_mfma_f32_32x32x16_bf16 v[80:95], v[236:239], v[22:25], 0
ds_read_b128 v[242:245], v2 offset:40960
s_mov_b64 exec, s[76:77]
ds_read_b64 v[246:247], v3 offset:41984
ds_read_b64 v[252:253], v3 offset:43264
s_mov_b64 exec, s[66:67]
ds_read_b128 v[160:163], v4 offset:29440
ds_read_b128 v[164:167], v4 offset:30080
ds_read_b128 v[168:171], v4 offset:46080
ds_read_b128 v[172:175], v4 offset:46720
s_mov_b64 exec, -1
v_exp_f32 v64, v64
v_exp_f32 v65, v65
v_exp_f32 v66, v66
v_exp_f32 v67, v67
v_cvt_pk_bf16_f32 v96, v64, v65
v_exp_f32 v68, v68
v_mfma_f32_32x32x16_bf16 v[128:143], v[152:155], v[104:107], v[128:143]
ds_read_b128 v[248:251], v2 offset:42240
v_exp_f32 v69, v69
v_cvt_pk_bf16_f32 v97, v66, v67
v_exp_f32 v70, v70
v_exp_f32 v71, v71
v_cvt_pk_bf16_f32 v98, v68, v69
v_exp_f32 v72, v72
v_mfma_f32_32x32x8_bf16 v[80:95], v[240:241], v[26:27], v[80:95]
v_exp_f32 v73, v73
v_cvt_pk_bf16_f32 v99, v70, v71
v_exp_f32 v74, v74
v_exp_f32 v75, v75
v_cvt_pk_bf16_f32 v100, v72, v73
v_exp_f32 v76, v76
v_mfma_f32_32x32x16_bf16 v[128:143], v[156:159], v[108:111], v[128:143]
v_exp_f32 v77, v77
v_cvt_pk_bf16_f32 v101, v74, v75
v_exp_f32 v78, v78
v_exp_f32 v79, v79
v_cvt_pk_bf16_f32 v102, v76, v77
v_cvt_pk_bf16_f32 v103, v78, v79
s_waitcnt lgkmcnt(0)
v_mfma_f32_32x32x16_bf16 v[64:79], v[242:245], v[16:19], 0
v_exp_f32 v80, v80
v_exp_f32 v81, v81
v_exp_f32 v82, v82
v_exp_f32 v83, v83
v_cvt_pk_bf16_f32 v104, v80, v81
v_exp_f32 v84, v84
v_mfma_f32_32x32x16_bf16 v[112:127], v[160:163], v[96:99], v[112:127]
v_exp_f32 v85, v85
v_cvt_pk_bf16_f32 v105, v82, v83
v_exp_f32 v86, v86
v_exp_f32 v87, v87
v_cvt_pk_bf16_f32 v106, v84, v85
v_exp_f32 v88, v88
v_mfma_f32_32x32x8_bf16 v[64:79], v[246:247], v[20:21], v[64:79]
v_exp_f32 v89, v89
v_cvt_pk_bf16_f32 v107, v86, v87
v_exp_f32 v90, v90
v_exp_f32 v91, v91
v_cvt_pk_bf16_f32 v108, v88, v89
v_exp_f32 v92, v92
v_mfma_f32_32x32x16_bf16 v[112:127], v[164:167], v[100:103], v[112:127]
v_exp_f32 v93, v93
v_cvt_pk_bf16_f32 v109, v90, v91
v_exp_f32 v94, v94
v_exp_f32 v95, v95
v_cvt_pk_bf16_f32 v110, v92, v93
v_cvt_pk_bf16_f32 v111, v94, v95
v_mfma_f32_32x32x16_bf16 v[80:95], v[242:245], v[22:25], 0
v_exp_f32 v64, v64
v_exp_f32 v65, v65
v_exp_f32 v66, v66
v_exp_f32 v67, v67
v_cvt_pk_bf16_f32 v96, v64, v65
v_exp_f32 v68, v68
v_mfma_f32_32x32x16_bf16 v[128:143], v[160:163], v[104:107], v[128:143]
v_exp_f32 v69, v69
v_cvt_pk_bf16_f32 v97, v66, v67
v_exp_f32 v70, v70
v_exp_f32 v71, v71
v_cvt_pk_bf16_f32 v98, v68, v69
v_exp_f32 v72, v72
v_mfma_f32_32x32x8_bf16 v[80:95], v[246:247], v[26:27], v[80:95]
v_exp_f32 v73, v73
v_cvt_pk_bf16_f32 v99, v70, v71
v_exp_f32 v74, v74
v_exp_f32 v75, v75
v_cvt_pk_bf16_f32 v100, v72, v73
v_exp_f32 v76, v76
v_mfma_f32_32x32x16_bf16 v[128:143], v[164:167], v[108:111], v[128:143]
v_exp_f32 v77, v77
v_cvt_pk_bf16_f32 v101, v74, v75
v_exp_f32 v78, v78
v_exp_f32 v79, v79
v_cvt_pk_bf16_f32 v102, v76, v77
v_cvt_pk_bf16_f32 v103, v78, v79
v_mfma_f32_32x32x16_bf16 v[64:79], v[248:251], v[16:19], 0
v_exp_f32 v80, v80
v_exp_f32 v81, v81
v_exp_f32 v82, v82
v_exp_f32 v83, v83
v_cvt_pk_bf16_f32 v104, v80, v81
v_exp_f32 v84, v84
v_mfma_f32_32x32x16_bf16 v[112:127], v[168:171], v[96:99], v[112:127]
v_exp_f32 v85, v85
v_cvt_pk_bf16_f32 v105, v82, v83
v_exp_f32 v86, v86
v_exp_f32 v87, v87
v_cvt_pk_bf16_f32 v106, v84, v85
v_exp_f32 v88, v88
v_mfma_f32_32x32x8_bf16 v[64:79], v[252:253], v[20:21], v[64:79]
v_exp_f32 v89, v89
v_cvt_pk_bf16_f32 v107, v86, v87
v_exp_f32 v90, v90
v_exp_f32 v91, v91
v_cvt_pk_bf16_f32 v108, v88, v89
v_exp_f32 v92, v92
v_mfma_f32_32x32x16_bf16 v[112:127], v[172:175], v[100:103], v[112:127]
v_exp_f32 v93, v93
v_cvt_pk_bf16_f32 v109, v90, v91
v_exp_f32 v94, v94
v_exp_f32 v95, v95
v_cvt_pk_bf16_f32 v110, v92, v93
v_cvt_pk_bf16_f32 v111, v94, v95
v_mfma_f32_32x32x16_bf16 v[80:95], v[248:251], v[22:25], 0
ds_read_b128 v[48:51], v2 offset:43520
s_mov_b64 exec, s[76:77]
ds_read_b64 v[52:53], v3 offset:44544
ds_read_b64 v[58:59], v3 offset:45824
s_mov_b64 exec, s[66:67]
ds_read_b128 v[40:43], v4 offset:47360
ds_read_b128 v[44:47], v4 offset:48000
ds_read_b128 v[144:147], v4 offset:48640
ds_read_b128 v[148:151], v4 offset:49280
s_mov_b64 exec, -1
v_exp_f32 v64, v64
v_exp_f32 v65, v65
v_exp_f32 v66, v66
v_exp_f32 v67, v67
v_cvt_pk_bf16_f32 v96, v64, v65
v_exp_f32 v68, v68
v_mfma_f32_32x32x16_bf16 v[128:143], v[168:171], v[104:107], v[128:143]
ds_read_b128 v[54:57], v2 offset:44800
v_exp_f32 v69, v69
v_cvt_pk_bf16_f32 v97, v66, v67
v_exp_f32 v70, v70
v_exp_f32 v71, v71
v_cvt_pk_bf16_f32 v98, v68, v69
v_exp_f32 v72, v72
v_mfma_f32_32x32x8_bf16 v[80:95], v[252:253], v[26:27], v[80:95]
v_exp_f32 v73, v73
v_cvt_pk_bf16_f32 v99, v70, v71
v_exp_f32 v74, v74
v_exp_f32 v75, v75
v_cvt_pk_bf16_f32 v100, v72, v73
v_exp_f32 v76, v76
v_mfma_f32_32x32x16_bf16 v[128:143], v[172:175], v[108:111], v[128:143]
v_exp_f32 v77, v77
v_cvt_pk_bf16_f32 v101, v74, v75
v_exp_f32 v78, v78
v_exp_f32 v79, v79
v_cvt_pk_bf16_f32 v102, v76, v77
v_cvt_pk_bf16_f32 v103, v78, v79
s_waitcnt lgkmcnt(0)
v_mfma_f32_32x32x16_bf16 v[64:79], v[48:51], v[16:19], 0
v_exp_f32 v80, v80
v_exp_f32 v81, v81
v_exp_f32 v82, v82
v_exp_f32 v83, v83
v_cvt_pk_bf16_f32 v104, v80, v81
v_exp_f32 v84, v84
v_mfma_f32_32x32x16_bf16 v[112:127], v[40:43], v[96:99], v[112:127]
v_exp_f32 v85, v85
v_cvt_pk_bf16_f32 v105, v82, v83
v_exp_f32 v86, v86
v_exp_f32 v87, v87
v_cvt_pk_bf16_f32 v106, v84, v85
v_exp_f32 v88, v88
v_mfma_f32_32x32x8_bf16 v[64:79], v[52:53], v[20:21], v[64:79]
v_exp_f32 v89, v89
v_cvt_pk_bf16_f32 v107, v86, v87
v_exp_f32 v90, v90
v_exp_f32 v91, v91
v_cvt_pk_bf16_f32 v108, v88, v89
v_exp_f32 v92, v92
v_mfma_f32_32x32x16_bf16 v[112:127], v[44:47], v[100:103], v[112:127]
v_exp_f32 v93, v93
v_cvt_pk_bf16_f32 v109, v90, v91
v_exp_f32 v94, v94
v_exp_f32 v95, v95
v_cvt_pk_bf16_f32 v110, v92, v93
v_cvt_pk_bf16_f32 v111, v94, v95
v_mfma_f32_32x32x16_bf16 v[80:95], v[48:51], v[22:25], 0
v_exp_f32 v64, v64
v_exp_f32 v65, v65
v_exp_f32 v66, v66
v_exp_f32 v67, v67
v_cvt_pk_bf16_f32 v96, v64, v65
v_exp_f32 v68, v68
v_mfma_f32_32x32x16_bf16 v[128:143], v[40:43], v[104:107], v[128:143]
v_exp_f32 v69, v69
v_cvt_pk_bf16_f32 v97, v66, v67
v_exp_f32 v70, v70
v_exp_f32 v71, v71
v_cvt_pk_bf16_f32 v98, v68, v69
v_exp_f32 v72, v72
v_mfma_f32_32x32x8_bf16 v[80:95], v[52:53], v[26:27], v[80:95]
v_exp_f32 v73, v73
v_cvt_pk_bf16_f32 v99, v70, v71
v_exp_f32 v74, v74
v_exp_f32 v75, v75
v_cvt_pk_bf16_f32 v100, v72, v73
v_exp_f32 v76, v76
v_mfma_f32_32x32x16_bf16 v[128:143], v[44:47], v[108:111], v[128:143]
v_exp_f32 v77, v77
v_cvt_pk_bf16_f32 v101, v74, v75
v_exp_f32 v78, v78
v_exp_f32 v79, v79
v_cvt_pk_bf16_f32 v102, v76, v77
v_cvt_pk_bf16_f32 v103, v78, v79
v_mfma_f32_32x32x16_bf16 v[64:79], v[54:57], v[16:19], 0
v_exp_f32 v80, v80
v_exp_f32 v81, v81
v_exp_f32 v82, v82
v_exp_f32 v83, v83
v_cvt_pk_bf16_f32 v104, v80, v81
v_exp_f32 v84, v84
v_mfma_f32_32x32x16_bf16 v[112:127], v[144:147], v[96:99], v[112:127]
v_exp_f32 v85, v85
v_cvt_pk_bf16_f32 v105, v82, v83
v_exp_f32 v86, v86
v_exp_f32 v87, v87
v_cvt_pk_bf16_f32 v106, v84, v85
v_exp_f32 v88, v88
v_mfma_f32_32x32x8_bf16 v[64:79], v[58:59], v[20:21], v[64:79]
v_exp_f32 v89, v89
v_cvt_pk_bf16_f32 v107, v86, v87
v_exp_f32 v90, v90
v_exp_f32 v91, v91
v_cvt_pk_bf16_f32 v108, v88, v89
v_exp_f32 v92, v92
v_mfma_f32_32x32x16_bf16 v[112:127], v[148:151], v[100:103], v[112:127]
v_exp_f32 v93, v93
v_cvt_pk_bf16_f32 v109, v90, v91
v_exp_f32 v94, v94
v_exp_f32 v95, v95
v_cvt_pk_bf16_f32 v110, v92, v93
v_cvt_pk_bf16_f32 v111, v94, v95
s_cmp_eq_u32 s61, 0
s_cbranch_scc1 att_hk_158
att_hk_158r:
s_barrier
v_mfma_f32_32x32x16_bf16 v[80:95], v[54:57], v[22:25], 0
v_add_u32 v2, 40960, v2
v_add_u32 v3, 40960, v3
v_add_u32 v4, 40960, v4
ds_read_b128 v[236:239], v2 offset:20480
s_mov_b64 exec, s[76:77]
ds_read_b64 v[240:241], v3 offset:21504
ds_read_b64 v[246:247], v3 offset:22784
s_mov_b64 exec, s[66:67]
ds_read_b128 v[152:155], v4 offset:8960
ds_read_b128 v[156:159], v4 offset:9600
ds_read_b128 v[160:163], v4 offset:25600
ds_read_b128 v[164:167], v4 offset:26240
s_mov_b64 exec, -1
v_exp_f32 v64, v64
v_exp_f32 v65, v65
v_exp_f32 v66, v66
v_exp_f32 v67, v67
v_cvt_pk_bf16_f32 v96, v64, v65
v_exp_f32 v68, v68
v_mfma_f32_32x32x16_bf16 v[128:143], v[144:147], v[104:107], v[128:143]
ds_read_b128 v[242:245], v2 offset:21760
v_exp_f32 v69, v69
v_cvt_pk_bf16_f32 v97, v66, v67
v_exp_f32 v70, v70
v_exp_f32 v71, v71
v_cvt_pk_bf16_f32 v98, v68, v69
v_exp_f32 v72, v72
v_mfma_f32_32x32x8_bf16 v[80:95], v[58:59], v[26:27], v[80:95]
v_exp_f32 v73, v73
v_cvt_pk_bf16_f32 v99, v70, v71
v_exp_f32 v74, v74
v_exp_f32 v75, v75
v_cvt_pk_bf16_f32 v100, v72, v73
v_exp_f32 v76, v76
v_mfma_f32_32x32x16_bf16 v[128:143], v[148:151], v[108:111], v[128:143]
v_exp_f32 v77, v77
v_cvt_pk_bf16_f32 v101, v74, v75
v_exp_f32 v78, v78
v_exp_f32 v79, v79
v_cvt_pk_bf16_f32 v102, v76, v77
v_cvt_pk_bf16_f32 v103, v78, v79
s_waitcnt lgkmcnt(0)
v_mfma_f32_32x32x16_bf16 v[64:79], v[236:239], v[16:19], 0
v_exp_f32 v80, v80
v_exp_f32 v81, v81
v_exp_f32 v82, v82
v_exp_f32 v83, v83
v_cvt_pk_bf16_f32 v104, v80, v81
v_exp_f32 v84, v84
v_mfma_f32_32x32x16_bf16 v[112:127], v[152:155], v[96:99], v[112:127]
v_exp_f32 v85, v85
v_cvt_pk_bf16_f32 v105, v82, v83
v_exp_f32 v86, v86
v_exp_f32 v87, v87
v_cvt_pk_bf16_f32 v106, v84, v85
v_exp_f32 v88, v88
v_mfma_f32_32x32x8_bf16 v[64:79], v[240:241], v[20:21], v[64:79]
v_exp_f32 v89, v89
v_cvt_pk_bf16_f32 v107, v86, v87
v_exp_f32 v90, v90
v_exp_f32 v91, v91
v_cvt_pk_bf16_f32 v108, v88, v89
v_exp_f32 v92, v92
v_mfma_f32_32x32x16_bf16 v[112:127], v[156:159], v[100:103], v[112:127]
v_exp_f32 v93, v93
v_cvt_pk_bf16_f32 v109, v90, v91
v_exp_f32 v94, v94
v_exp_f32 v95, v95
v_cvt_pk_bf16_f32 v110, v92, v93
v_cvt_pk_bf16_f32 v111, v94, v95
v_mfma_f32_32x32x16_bf16 v[80:95], v[236:239], v[22:25], 0
v_exp_f32 v64, v64
v_exp_f32 v65, v65
v_exp_f32 v66, v66
v_exp_f32 v67, v67
v_cvt_pk_bf16_f32 v96, v64, v65
v_exp_f32 v68, v68
v_mfma_f32_32x32x16_bf16 v[128:143], v[152:155], v[104:107], v[128:143]
v_exp_f32 v69, v69
v_cvt_pk_bf16_f32 v97, v66, v67
v_exp_f32 v70, v70
v_exp_f32 v71, v71
v_cvt_pk_bf16_f32 v98, v68, v69
v_exp_f32 v72, v72
v_mfma_f32_32x32x8_bf16 v[80:95], v[240:241], v[26:27], v[80:95]
v_exp_f32 v73, v73
v_cvt_pk_bf16_f32 v99, v70, v71
v_exp_f32 v74, v74
v_exp_f32 v75, v75
v_cvt_pk_bf16_f32 v100, v72, v73
v_exp_f32 v76, v76
v_mfma_f32_32x32x16_bf16 v[128:143], v[156:159], v[108:111], v[128:143]
v_exp_f32 v77, v77
v_cvt_pk_bf16_f32 v101, v74, v75
v_exp_f32 v78, v78
v_exp_f32 v79, v79
v_cvt_pk_bf16_f32 v102, v76, v77
v_cvt_pk_bf16_f32 v103, v78, v79
v_mfma_f32_32x32x16_bf16 v[64:79], v[242:245], v[16:19], 0
v_exp_f32 v80, v80
v_exp_f32 v81, v81
v_exp_f32 v82, v82
v_exp_f32 v83, v83
v_cvt_pk_bf16_f32 v104, v80, v81
v_exp_f32 v84, v84
v_mfma_f32_32x32x16_bf16 v[112:127], v[160:163], v[96:99], v[112:127]
v_exp_f32 v85, v85
v_cvt_pk_bf16_f32 v105, v82, v83
v_exp_f32 v86, v86
v_exp_f32 v87, v87
v_cvt_pk_bf16_f32 v106, v84, v85
v_exp_f32 v88, v88
v_mfma_f32_32x32x8_bf16 v[64:79], v[246:247], v[20:21], v[64:79]
v_exp_f32 v89, v89
v_cvt_pk_bf16_f32 v107, v86, v87
v_exp_f32 v90, v90
v_exp_f32 v91, v91
v_cvt_pk_bf16_f32 v108, v88, v89
v_exp_f32 v92, v92
v_mfma_f32_32x32x16_bf16 v[112:127], v[164:167], v[100:103], v[112:127]
v_exp_f32 v93, v93
v_cvt_pk_bf16_f32 v109, v90, v91
v_exp_f32 v94, v94
v_exp_f32 v95, v95
v_cvt_pk_bf16_f32 v110, v92, v93
v_cvt_pk_bf16_f32 v111, v94, v95
v_mfma_f32_32x32x16_bf16 v[80:95], v[242:245], v[22:25], 0
ds_read_b128 v[248:251], v2 offset:23040
s_mov_b64 exec, s[76:77]
ds_read_b64 v[252:253], v3 offset:24064
ds_read_b64 v[52:53], v3 offset:25344
s_mov_b64 exec, s[66:67]
ds_read_b128 v[168:171], v4 offset:26880
ds_read_b128 v[172:175], v4 offset:27520
ds_read_b128 v[40:43], v4 offset:28160
ds_read_b128 v[44:47], v4 offset:28800
s_mov_b64 exec, -1
v_exp_f32 v64, v64
v_exp_f32 v65, v65
v_exp_f32 v66, v66
v_exp_f32 v67, v67
v_cvt_pk_bf16_f32 v96, v64, v65
v_exp_f32 v68, v68
v_mfma_f32_32x32x16_bf16 v[128:143], v[160:163], v[104:107], v[128:143]
ds_read_b128 v[48:51], v2 offset:24320
v_exp_f32 v69, v69
v_cvt_pk_bf16_f32 v97, v66, v67
v_exp_f32 v70, v70
v_exp_f32 v71, v71
v_cvt_pk_bf16_f32 v98, v68, v69
v_exp_f32 v72, v72
v_mfma_f32_32x32x8_bf16 v[80:95], v[246:247], v[26:27], v[80:95]
v_exp_f32 v73, v73
v_cvt_pk_bf16_f32 v99, v70, v71
v_exp_f32 v74, v74
v_exp_f32 v75, v75
v_cvt_pk_bf16_f32 v100, v72, v73
v_exp_f32 v76, v76
v_mfma_f32_32x32x16_bf16 v[128:143], v[164:167], v[108:111], v[128:143]
v_exp_f32 v77, v77
v_cvt_pk_bf16_f32 v101, v74, v75
v_exp_f32 v78, v78
v_exp_f32 v79, v79
v_cvt_pk_bf16_f32 v102, v76, v77
v_cvt_pk_bf16_f32 v103, v78, v79
s_waitcnt lgkmcnt(0)
v_mfma_f32_32x32x16_bf16 v[64:79], v[248:251], v[16:19], 0
v_exp_f32 v80, v80
v_exp_f32 v81, v81
v_exp_f32 v82, v82
v_exp_f32 v83, v83
v_cvt_pk_bf16_f32 v104, v80, v81
v_exp_f32 v84, v84
v_mfma_f32_32x32x16_bf16 v[112:127], v[168:171], v[96:99], v[112:127]
v_exp_f32 v85, v85
v_cvt_pk_bf16_f32 v105, v82, v83
v_exp_f32 v86, v86
v_exp_f32 v87, v87
v_cvt_pk_bf16_f32 v106, v84, v85
v_exp_f32 v88, v88
v_mfma_f32_32x32x8_bf16 v[64:79], v[252:253], v[20:21], v[64:79]
v_exp_f32 v89, v89
v_cvt_pk_bf16_f32 v107, v86, v87
v_exp_f32 v90, v90
v_exp_f32 v91, v91
v_cvt_pk_bf16_f32 v108, v88, v89
v_exp_f32 v92, v92
v_mfma_f32_32x32x16_bf16 v[112:127], v[172:175], v[100:103], v[112:127]
v_exp_f32 v93, v93
v_cvt_pk_bf16_f32 v109, v90, v91
v_exp_f32 v94, v94
v_exp_f32 v95, v95
v_cvt_pk_bf16_f32 v110, v92, v93
v_cvt_pk_bf16_f32 v111, v94, v95
v_mfma_f32_32x32x16_bf16 v[80:95], v[248:251], v[22:25], 0
v_exp_f32 v64, v64
v_exp_f32 v65, v65
v_exp_f32 v66, v66
v_exp_f32 v67, v67
v_cvt_pk_bf16_f32 v96, v64, v65
v_exp_f32 v68, v68
v_mfma_f32_32x32x16_bf16 v[128:143], v[168:171], v[104:107], v[128:143]
v_exp_f32 v69, v69
v_cvt_pk_bf16_f32 v97, v66, v67
v_exp_f32 v70, v70
v_exp_f32 v71, v71
v_cvt_pk_bf16_f32 v98, v68, v69
v_exp_f32 v72, v72
v_mfma_f32_32x32x8_bf16 v[80:95], v[252:253], v[26:27], v[80:95]
v_exp_f32 v73, v73
v_cvt_pk_bf16_f32 v99, v70, v71
v_exp_f32 v74, v74
v_exp_f32 v75, v75
v_cvt_pk_bf16_f32 v100, v72, v73
v_exp_f32 v76, v76
v_mfma_f32_32x32x16_bf16 v[128:143], v[172:175], v[108:111], v[128:143]
v_exp_f32 v77, v77
v_cvt_pk_bf16_f32 v101, v74, v75
v_exp_f32 v78, v78
v_exp_f32 v79, v79
v_cvt_pk_bf16_f32 v102, v76, v77
v_cvt_pk_bf16_f32 v103, v78, v79
v_mfma_f32_32x32x16_bf16 v[64:79], v[48:51], v[16:19], 0
v_exp_f32 v80, v80
v_exp_f32 v81, v81
v_exp_f32 v82, v82
v_exp_f32 v83, v83
v_cvt_pk_bf16_f32 v104, v80, v81
v_exp_f32 v84, v84
v_mfma_f32_32x32x16_bf16 v[112:127], v[40:43], v[96:99], v[112:127]
v_exp_f32 v85, v85
v_cvt_pk_bf16_f32 v105, v82, v83
v_exp_f32 v86, v86
v_exp_f32 v87, v87
v_cvt_pk_bf16_f32 v106, v84, v85
v_exp_f32 v88, v88
v_mfma_f32_32x32x8_bf16 v[64:79], v[52:53], v[20:21], v[64:79]
v_exp_f32 v89, v89
v_cvt_pk_bf16_f32 v107, v86, v87
v_exp_f32 v90, v90
v_exp_f32 v91, v91
v_cvt_pk_bf16_f32 v108, v88, v89
v_exp_f32 v92, v92
v_mfma_f32_32x32x16_bf16 v[112:127], v[44:47], v[100:103], v[112:127]
v_exp_f32 v93, v93
v_cvt_pk_bf16_f32 v109, v90, v91
v_exp_f32 v94, v94
v_exp_f32 v95, v95
v_cvt_pk_bf16_f32 v110, v92, v93
v_cvt_pk_bf16_f32 v111, v94, v95
s_cmp_eq_u32 s61, 0
s_cbranch_scc1 att_hk_159
att_hk_159r:
s_barrier
v_mfma_f32_32x32x16_bf16 v[80:95], v[48:51], v[22:25], 0
ds_read_b128 v[54:57], v2 offset:40960
s_mov_b64 exec, s[76:77]
ds_read_b64 v[58:59], v3 offset:41984
ds_read_b64 v[240:241], v3 offset:43264
s_mov_b64 exec, s[66:67]
ds_read_b128 v[144:147], v4 offset:29440
ds_read_b128 v[148:151], v4 offset:30080
ds_read_b128 v[152:155], v4 offset:46080
ds_read_b128 v[156:159], v4 offset:46720
s_mov_b64 exec, -1
v_exp_f32 v64, v64
v_exp_f32 v65, v65
v_exp_f32 v66, v66
v_exp_f32 v67, v67
v_cvt_pk_bf16_f32 v96, v64, v65
v_exp_f32 v68, v68
v_mfma_f32_32x32x16_bf16 v[128:143], v[40:43], v[104:107], v[128:143]
ds_read_b128 v[236:239], v2 offset:42240
v_exp_f32 v69, v69
v_cvt_pk_bf16_f32 v97, v66, v67
v_exp_f32 v70, v70
v_exp_f32 v71, v71
v_cvt_pk_bf16_f32 v98, v68, v69
v_exp_f32 v72, v72
v_mfma_f32_32x32x8_bf16 v[80:95], v[52:53], v[26:27], v[80:95]
v_exp_f32 v73, v73
v_cvt_pk_bf16_f32 v99, v70, v71
v_exp_f32 v74, v74
v_exp_f32 v75, v75
v_cvt_pk_bf16_f32 v100, v72, v73
v_exp_f32 v76, v76
v_mfma_f32_32x32x16_bf16 v[128:143], v[44:47], v[108:111], v[128:143]
v_exp_f32 v77, v77
v_cvt_pk_bf16_f32 v101, v74, v75
v_exp_f32 v78, v78
v_exp_f32 v79, v79
v_cvt_pk_bf16_f32 v102, v76, v77
v_cvt_pk_bf16_f32 v103, v78, v79
s_waitcnt lgkmcnt(0)
v_mfma_f32_32x32x16_bf16 v[64:79], v[54:57], v[16:19], 0
v_exp_f32 v80, v80
v_exp_f32 v81, v81
v_exp_f32 v82, v82
v_exp_f32 v83, v83
v_cvt_pk_bf16_f32 v104, v80, v81
v_exp_f32 v84, v84
v_mfma_f32_32x32x16_bf16 v[112:127], v[144:147], v[96:99], v[112:127]
v_exp_f32 v85, v85
v_cvt_pk_bf16_f32 v105, v82, v83
v_exp_f32 v86, v86
v_exp_f32 v87, v87
v_cvt_pk_bf16_f32 v106, v84, v85
v_exp_f32 v88, v88
v_mfma_f32_32x32x8_bf16 v[64:79], v[58:59], v[20:21], v[64:79]
v_exp_f32 v89, v89
v_cvt_pk_bf16_f32 v107, v86, v87
v_exp_f32 v90, v90
v_exp_f32 v91, v91
v_cvt_pk_bf16_f32 v108, v88, v89
v_exp_f32 v92, v92
v_mfma_f32_32x32x16_bf16 v[112:127], v[148:151], v[100:103], v[112:127]
v_exp_f32 v93, v93
v_cvt_pk_bf16_f32 v109, v90, v91
v_exp_f32 v94, v94
v_exp_f32 v95, v95
v_cvt_pk_bf16_f32 v110, v92, v93
v_cvt_pk_bf16_f32 v111, v94, v95
v_mfma_f32_32x32x16_bf16 v[80:95], v[54:57], v[22:25], 0
v_exp_f32 v64, v64
v_exp_f32 v65, v65
v_exp_f32 v66, v66
v_exp_f32 v67, v67
v_cvt_pk_bf16_f32 v96, v64, v65
v_exp_f32 v68, v68
v_mfma_f32_32x32x16_bf16 v[128:143], v[144:147], v[104:107], v[128:143]
v_exp_f32 v69, v69
v_cvt_pk_bf16_f32 v97, v66, v67
v_exp_f32 v70, v70
v_exp_f32 v71, v71
v_cvt_pk_bf16_f32 v98, v68, v69
v_exp_f32 v72, v72
v_mfma_f32_32x32x8_bf16 v[80:95], v[58:59], v[26:27], v[80:95]
v_exp_f32 v73, v73
v_cvt_pk_bf16_f32 v99, v70, v71
v_exp_f32 v74, v74
v_exp_f32 v75, v75
v_cvt_pk_bf16_f32 v100, v72, v73
v_exp_f32 v76, v76
v_mfma_f32_32x32x16_bf16 v[128:143], v[148:151], v[108:111], v[128:143]
v_exp_f32 v77, v77
v_cvt_pk_bf16_f32 v101, v74, v75
v_exp_f32 v78, v78
v_exp_f32 v79, v79
v_cvt_pk_bf16_f32 v102, v76, v77
v_cvt_pk_bf16_f32 v103, v78, v79
v_mfma_f32_32x32x16_bf16 v[64:79], v[236:239], v[16:19], 0
v_exp_f32 v80, v80
v_exp_f32 v81, v81
v_exp_f32 v82, v82
v_exp_f32 v83, v83
v_cvt_pk_bf16_f32 v104, v80, v81
v_exp_f32 v84, v84
v_mfma_f32_32x32x16_bf16 v[112:127], v[152:155], v[96:99], v[112:127]
v_exp_f32 v85, v85
v_cvt_pk_bf16_f32 v105, v82, v83
v_exp_f32 v86, v86
v_exp_f32 v87, v87
v_cvt_pk_bf16_f32 v106, v84, v85
v_exp_f32 v88, v88
v_mfma_f32_32x32x8_bf16 v[64:79], v[240:241], v[20:21], v[64:79]
v_exp_f32 v89, v89
v_cvt_pk_bf16_f32 v107, v86, v87
v_exp_f32 v90, v90
v_exp_f32 v91, v91
v_cvt_pk_bf16_f32 v108, v88, v89
v_exp_f32 v92, v92
v_mfma_f32_32x32x16_bf16 v[112:127], v[156:159], v[100:103], v[112:127]
v_exp_f32 v93, v93
v_cvt_pk_bf16_f32 v109, v90, v91
v_exp_f32 v94, v94
v_exp_f32 v95, v95
v_cvt_pk_bf16_f32 v110, v92, v93
v_cvt_pk_bf16_f32 v111, v94, v95
v_mfma_f32_32x32x16_bf16 v[80:95], v[236:239], v[22:25], 0
ds_read_b128 v[242:245], v2 offset:43520
s_mov_b64 exec, s[76:77]
ds_read_b64 v[246:247], v3 offset:44544
ds_read_b64 v[252:253], v3 offset:45824
s_mov_b64 exec, s[66:67]
ds_read_b128 v[160:163], v4 offset:47360
ds_read_b128 v[164:167], v4 offset:48000
ds_read_b128 v[168:171], v4 offset:48640
ds_read_b128 v[172:175], v4 offset:49280
s_mov_b64 exec, -1
v_exp_f32 v64, v64
v_exp_f32 v65, v65
v_exp_f32 v66, v66
v_exp_f32 v67, v67
v_cvt_pk_bf16_f32 v96, v64, v65
v_exp_f32 v68, v68
v_mfma_f32_32x32x16_bf16 v[128:143], v[152:155], v[104:107], v[128:143]
ds_read_b128 v[248:251], v2 offset:44800
v_exp_f32 v69, v69
v_cvt_pk_bf16_f32 v97, v66, v67
v_exp_f32 v70, v70
v_exp_f32 v71, v71
v_cvt_pk_bf16_f32 v98, v68, v69
v_exp_f32 v72, v72
v_mfma_f32_32x32x8_bf16 v[80:95], v[240:241], v[26:27], v[80:95]
v_exp_f32 v73, v73
v_cvt_pk_bf16_f32 v99, v70, v71
v_exp_f32 v74, v74
v_exp_f32 v75, v75
v_cvt_pk_bf16_f32 v100, v72, v73
v_exp_f32 v76, v76
v_mfma_f32_32x32x16_bf16 v[128:143], v[156:159], v[108:111], v[128:143]
v_exp_f32 v77, v77
v_cvt_pk_bf16_f32 v101, v74, v75
v_exp_f32 v78, v78
v_exp_f32 v79, v79
v_cvt_pk_bf16_f32 v102, v76, v77
v_cvt_pk_bf16_f32 v103, v78, v79
s_waitcnt lgkmcnt(0)
v_mfma_f32_32x32x16_bf16 v[64:79], v[242:245], v[16:19], 0
v_exp_f32 v80, v80
v_exp_f32 v81, v81
v_exp_f32 v82, v82
v_exp_f32 v83, v83
v_cvt_pk_bf16_f32 v104, v80, v81
v_exp_f32 v84, v84
v_mfma_f32_32x32x16_bf16 v[112:127], v[160:163], v[96:99], v[112:127]
v_exp_f32 v85, v85
v_cvt_pk_bf16_f32 v105, v82, v83
v_exp_f32 v86, v86
v_exp_f32 v87, v87
v_cvt_pk_bf16_f32 v106, v84, v85
v_exp_f32 v88, v88
v_mfma_f32_32x32x8_bf16 v[64:79], v[246:247], v[20:21], v[64:79]
v_exp_f32 v89, v89
v_cvt_pk_bf16_f32 v107, v86, v87
v_exp_f32 v90, v90
v_exp_f32 v91, v91
v_cvt_pk_bf16_f32 v108, v88, v89
v_exp_f32 v92, v92
v_mfma_f32_32x32x16_bf16 v[112:127], v[164:167], v[100:103], v[112:127]
v_exp_f32 v93, v93
v_cvt_pk_bf16_f32 v109, v90, v91
v_exp_f32 v94, v94
v_exp_f32 v95, v95
v_cvt_pk_bf16_f32 v110, v92, v93
v_cvt_pk_bf16_f32 v111, v94, v95
v_mfma_f32_32x32x16_bf16 v[80:95], v[242:245], v[22:25], 0
v_exp_f32 v64, v64
v_exp_f32 v65, v65
v_exp_f32 v66, v66
v_exp_f32 v67, v67
v_cvt_pk_bf16_f32 v96, v64, v65
v_exp_f32 v68, v68
v_mfma_f32_32x32x16_bf16 v[128:143], v[160:163], v[104:107], v[128:143]
v_exp_f32 v69, v69
v_cvt_pk_bf16_f32 v97, v66, v67
v_exp_f32 v70, v70
v_exp_f32 v71, v71
v_cvt_pk_bf16_f32 v98, v68, v69
v_exp_f32 v72, v72
v_mfma_f32_32x32x8_bf16 v[80:95], v[246:247], v[26:27], v[80:95]
v_exp_f32 v73, v73
v_cvt_pk_bf16_f32 v99, v70, v71
v_exp_f32 v74, v74
v_exp_f32 v75, v75
v_cvt_pk_bf16_f32 v100, v72, v73
v_exp_f32 v76, v76
v_mfma_f32_32x32x16_bf16 v[128:143], v[164:167], v[108:111], v[128:143]
v_exp_f32 v77, v77
v_cvt_pk_bf16_f32 v101, v74, v75
v_exp_f32 v78, v78
v_exp_f32 v79, v79
v_cvt_pk_bf16_f32 v102, v76, v77
v_cvt_pk_bf16_f32 v103, v78, v79
v_mfma_f32_32x32x16_bf16 v[64:79], v[248:251], v[16:19], 0
v_exp_f32 v80, v80
v_exp_f32 v81, v81
v_exp_f32 v82, v82
v_exp_f32 v83, v83
v_cvt_pk_bf16_f32 v104, v80, v81
v_exp_f32 v84, v84
v_mfma_f32_32x32x16_bf16 v[112:127], v[168:171], v[96:99], v[112:127]
v_exp_f32 v85, v85
v_cvt_pk_bf16_f32 v105, v82, v83
v_exp_f32 v86, v86
v_exp_f32 v87, v87
v_cvt_pk_bf16_f32 v106, v84, v85
v_exp_f32 v88, v88
v_mfma_f32_32x32x8_bf16 v[64:79], v[252:253], v[20:21], v[64:79]
v_exp_f32 v89, v89
v_cvt_pk_bf16_f32 v107, v86, v87
v_exp_f32 v90, v90
v_exp_f32 v91, v91
v_cvt_pk_bf16_f32 v108, v88, v89
v_exp_f32 v92, v92
v_mfma_f32_32x32x16_bf16 v[112:127], v[172:175], v[100:103], v[112:127]
v_exp_f32 v93, v93
v_cvt_pk_bf16_f32 v109, v90, v91
v_exp_f32 v94, v94
v_exp_f32 v95, v95
v_cvt_pk_bf16_f32 v110, v92, v93
v_cvt_pk_bf16_f32 v111, v94, v95
s_cmp_eq_u32 s61, 0
s_cbranch_scc1 att_hk_160
att_hk_160r:
s_barrier
v_mfma_f32_32x32x16_bf16 v[80:95], v[248:251], v[22:25], 0
v_add_u32 v2, 40960, v2
v_add_u32 v3, 40960, v3
v_add_u32 v4, 40960, v4
ds_read_b128 v[48:51], v2 offset:20480
s_mov_b64 exec, s[76:77]
ds_read_b64 v[52:53], v3 offset:21504
ds_read_b64 v[58:59], v3 offset:22784
s_mov_b64 exec, s[66:67]
ds_read_b128 v[40:43], v4 offset:8960
ds_read_b128 v[44:47], v4 offset:9600
ds_read_b128 v[144:147], v4 offset:25600
ds_read_b128 v[148:151], v4 offset:26240
s_mov_b64 exec, -1
v_exp_f32 v64, v64
v_exp_f32 v65, v65
v_exp_f32 v66, v66
v_exp_f32 v67, v67
v_cvt_pk_bf16_f32 v96, v64, v65
v_exp_f32 v68, v68
v_mfma_f32_32x32x16_bf16 v[128:143], v[168:171], v[104:107], v[128:143]
ds_read_b128 v[54:57], v2 offset:21760
v_exp_f32 v69, v69
v_cvt_pk_bf16_f32 v97, v66, v67
v_exp_f32 v70, v70
v_exp_f32 v71, v71
v_cvt_pk_bf16_f32 v98, v68, v69
v_exp_f32 v72, v72
v_mfma_f32_32x32x8_bf16 v[80:95], v[252:253], v[26:27], v[80:95]
v_exp_f32 v73, v73
v_cvt_pk_bf16_f32 v99, v70, v71
v_exp_f32 v74, v74
v_exp_f32 v75, v75
v_cvt_pk_bf16_f32 v100, v72, v73
v_exp_f32 v76, v76
v_mfma_f32_32x32x16_bf16 v[128:143], v[172:175], v[108:111], v[128:143]
v_exp_f32 v77, v77
v_cvt_pk_bf16_f32 v101, v74, v75
v_exp_f32 v78, v78
v_exp_f32 v79, v79
v_cvt_pk_bf16_f32 v102, v76, v77
v_cvt_pk_bf16_f32 v103, v78, v79
s_waitcnt lgkmcnt(0)
v_mfma_f32_32x32x16_bf16 v[64:79], v[48:51], v[16:19], 0
v_exp_f32 v80, v80
v_exp_f32 v81, v81
v_exp_f32 v82, v82
v_exp_f32 v83, v83
v_cvt_pk_bf16_f32 v104, v80, v81
v_exp_f32 v84, v84
v_mfma_f32_32x32x16_bf16 v[112:127], v[40:43], v[96:99], v[112:127]
v_exp_f32 v85, v85
v_cvt_pk_bf16_f32 v105, v82, v83
v_exp_f32 v86, v86
v_exp_f32 v87, v87
v_cvt_pk_bf16_f32 v106, v84, v85
v_exp_f32 v88, v88
v_mfma_f32_32x32x8_bf16 v[64:79], v[52:53], v[20:21], v[64:79]
v_exp_f32 v89, v89
v_cvt_pk_bf16_f32 v107, v86, v87
v_exp_f32 v90, v90
v_exp_f32 v91, v91
v_cvt_pk_bf16_f32 v108, v88, v89
v_exp_f32 v92, v92
v_mfma_f32_32x32x16_bf16 v[112:127], v[44:47], v[100:103], v[112:127]
v_exp_f32 v93, v93
v_cvt_pk_bf16_f32 v109, v90, v91
v_exp_f32 v94, v94
v_exp_f32 v95, v95
v_cvt_pk_bf16_f32 v110, v92, v93
v_cvt_pk_bf16_f32 v111, v94, v95
v_mfma_f32_32x32x16_bf16 v[80:95], v[48:51], v[22:25], 0
v_exp_f32 v64, v64
v_exp_f32 v65, v65
v_exp_f32 v66, v66
v_exp_f32 v67, v67
v_cvt_pk_bf16_f32 v96, v64, v65
v_exp_f32 v68, v68
v_mfma_f32_32x32x16_bf16 v[128:143], v[40:43], v[104:107], v[128:143]
v_exp_f32 v69, v69
v_cvt_pk_bf16_f32 v97, v66, v67
v_exp_f32 v70, v70
v_exp_f32 v71, v71
v_cvt_pk_bf16_f32 v98, v68, v69
v_exp_f32 v72, v72
v_mfma_f32_32x32x8_bf16 v[80:95], v[52:53], v[26:27], v[80:95]
v_exp_f32 v73, v73
v_cvt_pk_bf16_f32 v99, v70, v71
v_exp_f32 v74, v74
v_exp_f32 v75, v75
v_cvt_pk_bf16_f32 v100, v72, v73
v_exp_f32 v76, v76
v_mfma_f32_32x32x16_bf16 v[128:143], v[44:47], v[108:111], v[128:143]
v_exp_f32 v77, v77
v_cvt_pk_bf16_f32 v101, v74, v75
v_exp_f32 v78, v78
v_exp_f32 v79, v79
v_cvt_pk_bf16_f32 v102, v76, v77
v_cvt_pk_bf16_f32 v103, v78, v79
v_mfma_f32_32x32x16_bf16 v[64:79], v[54:57], v[16:19], 0
v_exp_f32 v80, v80
v_exp_f32 v81, v81
v_exp_f32 v82, v82
v_exp_f32 v83, v83
v_cvt_pk_bf16_f32 v104, v80, v81
v_exp_f32 v84, v84
v_mfma_f32_32x32x16_bf16 v[112:127], v[144:147], v[96:99], v[112:127]
v_exp_f32 v85, v85
v_cvt_pk_bf16_f32 v105, v82, v83
v_exp_f32 v86, v86
v_exp_f32 v87, v87
v_cvt_pk_bf16_f32 v106, v84, v85
v_exp_f32 v88, v88
v_mfma_f32_32x32x8_bf16 v[64:79], v[58:59], v[20:21], v[64:79]
v_exp_f32 v89, v89
v_cvt_pk_bf16_f32 v107, v86, v87
v_exp_f32 v90, v90
v_exp_f32 v91, v91
v_cvt_pk_bf16_f32 v108, v88, v89
v_exp_f32 v92, v92
v_mfma_f32_32x32x16_bf16 v[112:127], v[148:151], v[100:103], v[112:127]
v_exp_f32 v93, v93
v_cvt_pk_bf16_f32 v109, v90, v91
v_exp_f32 v94, v94
v_exp_f32 v95, v95
v_cvt_pk_bf16_f32 v110, v92, v93
v_cvt_pk_bf16_f32 v111, v94, v95
v_mfma_f32_32x32x16_bf16 v[80:95], v[54:57], v[22:25], 0
ds_read_b128 v[236:239], v2 offset:23040
s_mov_b64 exec, s[76:77]
ds_read_b64 v[240:241], v3 offset:24064
ds_read_b64 v[246:247], v3 offset:25344
s_mov_b64 exec, s[66:67]
ds_read_b128 v[152:155], v4 offset:26880
ds_read_b128 v[156:159], v4 offset:27520
ds_read_b128 v[160:163], v4 offset:28160
ds_read_b128 v[164:167], v4 offset:28800
s_mov_b64 exec, -1
v_exp_f32 v64, v64
v_exp_f32 v65, v65
v_exp_f32 v66, v66
v_exp_f32 v67, v67
v_cvt_pk_bf16_f32 v96, v64, v65
v_exp_f32 v68, v68
v_mfma_f32_32x32x16_bf16 v[128:143], v[144:147], v[104:107], v[128:143]
ds_read_b128 v[242:245], v2 offset:24320
v_exp_f32 v69, v69
v_cvt_pk_bf16_f32 v97, v66, v67
v_exp_f32 v70, v70
v_exp_f32 v71, v71
v_cvt_pk_bf16_f32 v98, v68, v69
v_exp_f32 v72, v72
v_mfma_f32_32x32x8_bf16 v[80:95], v[58:59], v[26:27], v[80:95]
v_exp_f32 v73, v73
v_cvt_pk_bf16_f32 v99, v70, v71
v_exp_f32 v74, v74
v_exp_f32 v75, v75
v_cvt_pk_bf16_f32 v100, v72, v73
v_exp_f32 v76, v76
v_mfma_f32_32x32x16_bf16 v[128:143], v[148:151], v[108:111], v[128:143]
v_exp_f32 v77, v77
v_cvt_pk_bf16_f32 v101, v74, v75
v_exp_f32 v78, v78
v_exp_f32 v79, v79
v_cvt_pk_bf16_f32 v102, v76, v77
v_cvt_pk_bf16_f32 v103, v78, v79
s_waitcnt lgkmcnt(0)
v_mfma_f32_32x32x16_bf16 v[64:79], v[236:239], v[16:19], 0
v_exp_f32 v80, v80
v_exp_f32 v81, v81
v_exp_f32 v82, v82
v_exp_f32 v83, v83
v_cvt_pk_bf16_f32 v104, v80, v81
v_exp_f32 v84, v84
v_mfma_f32_32x32x16_bf16 v[112:127], v[152:155], v[96:99], v[112:127]
v_exp_f32 v85, v85
v_cvt_pk_bf16_f32 v105, v82, v83
v_exp_f32 v86, v86
v_exp_f32 v87, v87
v_cvt_pk_bf16_f32 v106, v84, v85
v_exp_f32 v88, v88
v_mfma_f32_32x32x8_bf16 v[64:79], v[240:241], v[20:21], v[64:79]
v_exp_f32 v89, v89
v_cvt_pk_bf16_f32 v107, v86, v87
v_exp_f32 v90, v90
v_exp_f32 v91, v91
v_cvt_pk_bf16_f32 v108, v88, v89
v_exp_f32 v92, v92
v_mfma_f32_32x32x16_bf16 v[112:127], v[156:159], v[100:103], v[112:127]
v_exp_f32 v93, v93
v_cvt_pk_bf16_f32 v109, v90, v91
v_exp_f32 v94, v94
v_exp_f32 v95, v95
v_cvt_pk_bf16_f32 v110, v92, v93
v_cvt_pk_bf16_f32 v111, v94, v95
v_mfma_f32_32x32x16_bf16 v[80:95], v[236:239], v[22:25], 0
v_exp_f32 v64, v64
v_exp_f32 v65, v65
v_exp_f32 v66, v66
v_exp_f32 v67, v67
v_cvt_pk_bf16_f32 v96, v64, v65
v_exp_f32 v68, v68
v_mfma_f32_32x32x16_bf16 v[128:143], v[152:155], v[104:107], v[128:143]
v_exp_f32 v69, v69
v_cvt_pk_bf16_f32 v97, v66, v67
v_exp_f32 v70, v70
v_exp_f32 v71, v71
v_cvt_pk_bf16_f32 v98, v68, v69
v_exp_f32 v72, v72
v_mfma_f32_32x32x8_bf16 v[80:95], v[240:241], v[26:27], v[80:95]
v_exp_f32 v73, v73
v_cvt_pk_bf16_f32 v99, v70, v71
v_exp_f32 v74, v74
v_exp_f32 v75, v75
v_cvt_pk_bf16_f32 v100, v72, v73
v_exp_f32 v76, v76
v_mfma_f32_32x32x16_bf16 v[128:143], v[156:159], v[108:111], v[128:143]
v_exp_f32 v77, v77
v_cvt_pk_bf16_f32 v101, v74, v75
v_exp_f32 v78, v78
v_exp_f32 v79, v79
v_cvt_pk_bf16_f32 v102, v76, v77
v_cvt_pk_bf16_f32 v103, v78, v79
v_mfma_f32_32x32x16_bf16 v[64:79], v[242:245], v[16:19], 0
v_exp_f32 v80, v80
v_exp_f32 v81, v81
v_exp_f32 v82, v82
v_exp_f32 v83, v83
v_cvt_pk_bf16_f32 v104, v80, v81
v_exp_f32 v84, v84
v_mfma_f32_32x32x16_bf16 v[112:127], v[160:163], v[96:99], v[112:127]
v_exp_f32 v85, v85
v_cvt_pk_bf16_f32 v105, v82, v83
v_exp_f32 v86, v86
v_exp_f32 v87, v87
v_cvt_pk_bf16_f32 v106, v84, v85
v_exp_f32 v88, v88
v_mfma_f32_32x32x8_bf16 v[64:79], v[246:247], v[20:21], v[64:79]
v_exp_f32 v89, v89
v_cvt_pk_bf16_f32 v107, v86, v87
v_exp_f32 v90, v90
v_exp_f32 v91, v91
v_cvt_pk_bf16_f32 v108, v88, v89
v_exp_f32 v92, v92
v_mfma_f32_32x32x16_bf16 v[112:127], v[164:167], v[100:103], v[112:127]
v_exp_f32 v93, v93
v_cvt_pk_bf16_f32 v109, v90, v91
v_exp_f32 v94, v94
v_exp_f32 v95, v95
v_cvt_pk_bf16_f32 v110, v92, v93
v_cvt_pk_bf16_f32 v111, v94, v95
s_cmp_eq_u32 s61, 0
s_cbranch_scc1 att_hk_161
att_hk_161r:
s_barrier
v_mfma_f32_32x32x16_bf16 v[80:95], v[242:245], v[22:25], 0
ds_read_b128 v[248:251], v2 offset:40960
s_mov_b64 exec, s[76:77]
ds_read_b64 v[252:253], v3 offset:41984
ds_read_b64 v[52:53], v3 offset:43264
s_mov_b64 exec, s[66:67]
ds_read_b128 v[168:171], v4 offset:29440
ds_read_b128 v[172:175], v4 offset:30080
ds_read_b128 v[40:43], v4 offset:46080
ds_read_b128 v[44:47], v4 offset:46720
s_mov_b64 exec, -1
v_exp_f32 v64, v64
v_exp_f32 v65, v65
v_exp_f32 v66, v66
v_exp_f32 v67, v67
v_cvt_pk_bf16_f32 v96, v64, v65
v_exp_f32 v68, v68
v_mfma_f32_32x32x16_bf16 v[128:143], v[160:163], v[104:107], v[128:143]
ds_read_b128 v[48:51], v2 offset:42240
v_exp_f32 v69, v69
v_cvt_pk_bf16_f32 v97, v66, v67
v_exp_f32 v70, v70
v_exp_f32 v71, v71
v_cvt_pk_bf16_f32 v98, v68, v69
v_exp_f32 v72, v72
v_mfma_f32_32x32x8_bf16 v[80:95], v[246:247], v[26:27], v[80:95]
v_exp_f32 v73, v73
v_cvt_pk_bf16_f32 v99, v70, v71
v_exp_f32 v74, v74
v_exp_f32 v75, v75
v_cvt_pk_bf16_f32 v100, v72, v73
v_exp_f32 v76, v76
v_mfma_f32_32x32x16_bf16 v[128:143], v[164:167], v[108:111], v[128:143]
v_exp_f32 v77, v77
v_cvt_pk_bf16_f32 v101, v74, v75
v_exp_f32 v78, v78
v_exp_f32 v79, v79
v_cvt_pk_bf16_f32 v102, v76, v77
v_cvt_pk_bf16_f32 v103, v78, v79
s_waitcnt lgkmcnt(0)
v_mfma_f32_32x32x16_bf16 v[64:79], v[248:251], v[16:19], 0
v_exp_f32 v80, v80
v_exp_f32 v81, v81
v_exp_f32 v82, v82
v_exp_f32 v83, v83
v_cvt_pk_bf16_f32 v104, v80, v81
v_exp_f32 v84, v84
v_mfma_f32_32x32x16_bf16 v[112:127], v[168:171], v[96:99], v[112:127]
v_exp_f32 v85, v85
v_cvt_pk_bf16_f32 v105, v82, v83
v_exp_f32 v86, v86
v_exp_f32 v87, v87
v_cvt_pk_bf16_f32 v106, v84, v85
v_exp_f32 v88, v88
v_mfma_f32_32x32x8_bf16 v[64:79], v[252:253], v[20:21], v[64:79]
v_exp_f32 v89, v89
v_cvt_pk_bf16_f32 v107, v86, v87
v_exp_f32 v90, v90
v_exp_f32 v91, v91
v_cvt_pk_bf16_f32 v108, v88, v89
v_exp_f32 v92, v92
v_mfma_f32_32x32x16_bf16 v[112:127], v[172:175], v[100:103], v[112:127]
v_exp_f32 v93, v93
v_cvt_pk_bf16_f32 v109, v90, v91
v_exp_f32 v94, v94
v_exp_f32 v95, v95
v_cvt_pk_bf16_f32 v110, v92, v93
v_cvt_pk_bf16_f32 v111, v94, v95
v_mfma_f32_32x32x16_bf16 v[80:95], v[248:251], v[22:25], 0
v_exp_f32 v64, v64
v_exp_f32 v65, v65
v_exp_f32 v66, v66
v_exp_f32 v67, v67
v_cvt_pk_bf16_f32 v96, v64, v65
v_exp_f32 v68, v68
v_mfma_f32_32x32x16_bf16 v[128:143], v[168:171], v[104:107], v[128:143]
v_exp_f32 v69, v69
v_cvt_pk_bf16_f32 v97, v66, v67
v_exp_f32 v70, v70
v_exp_f32 v71, v71
v_cvt_pk_bf16_f32 v98, v68, v69
v_exp_f32 v72, v72
v_mfma_f32_32x32x8_bf16 v[80:95], v[252:253], v[26:27], v[80:95]
v_exp_f32 v73, v73
v_cvt_pk_bf16_f32 v99, v70, v71
v_exp_f32 v74, v74
v_exp_f32 v75, v75
v_cvt_pk_bf16_f32 v100, v72, v73
v_exp_f32 v76, v76
v_mfma_f32_32x32x16_bf16 v[128:143], v[172:175], v[108:111], v[128:143]
v_exp_f32 v77, v77
v_cvt_pk_bf16_f32 v101, v74, v75
v_exp_f32 v78, v78
v_exp_f32 v79, v79
v_cvt_pk_bf16_f32 v102, v76, v77
v_cvt_pk_bf16_f32 v103, v78, v79
v_mfma_f32_32x32x16_bf16 v[64:79], v[48:51], v[16:19], 0
v_exp_f32 v80, v80
v_exp_f32 v81, v81
v_exp_f32 v82, v82
v_exp_f32 v83, v83
v_cvt_pk_bf16_f32 v104, v80, v81
v_exp_f32 v84, v84
v_mfma_f32_32x32x16_bf16 v[112:127], v[40:43], v[96:99], v[112:127]
v_exp_f32 v85, v85
v_cvt_pk_bf16_f32 v105, v82, v83
v_exp_f32 v86, v86
v_exp_f32 v87, v87
v_cvt_pk_bf16_f32 v106, v84, v85
v_exp_f32 v88, v88
v_mfma_f32_32x32x8_bf16 v[64:79], v[52:53], v[20:21], v[64:79]
v_exp_f32 v89, v89
v_cvt_pk_bf16_f32 v107, v86, v87
v_exp_f32 v90, v90
v_exp_f32 v91, v91
v_cvt_pk_bf16_f32 v108, v88, v89
v_exp_f32 v92, v92
v_mfma_f32_32x32x16_bf16 v[112:127], v[44:47], v[100:103], v[112:127]
v_exp_f32 v93, v93
v_cvt_pk_bf16_f32 v109, v90, v91
v_exp_f32 v94, v94
v_exp_f32 v95, v95
v_cvt_pk_bf16_f32 v110, v92, v93
v_cvt_pk_bf16_f32 v111, v94, v95
v_mfma_f32_32x32x16_bf16 v[80:95], v[48:51], v[22:25], 0
ds_read_b128 v[54:57], v2 offset:43520
s_mov_b64 exec, s[76:77]
ds_read_b64 v[58:59], v3 offset:44544
ds_read_b64 v[240:241], v3 offset:45824
s_mov_b64 exec, s[66:67]
ds_read_b128 v[144:147], v4 offset:47360
ds_read_b128 v[148:151], v4 offset:48000
ds_read_b128 v[152:155], v4 offset:48640
ds_read_b128 v[156:159], v4 offset:49280
s_mov_b64 exec, -1
v_exp_f32 v64, v64
v_exp_f32 v65, v65
v_exp_f32 v66, v66
v_exp_f32 v67, v67
v_cvt_pk_bf16_f32 v96, v64, v65
v_exp_f32 v68, v68
v_mfma_f32_32x32x16_bf16 v[128:143], v[40:43], v[104:107], v[128:143]
ds_read_b128 v[236:239], v2 offset:44800
v_exp_f32 v69, v69
v_cvt_pk_bf16_f32 v97, v66, v67
v_exp_f32 v70, v70
v_exp_f32 v71, v71
v_cvt_pk_bf16_f32 v98, v68, v69
v_exp_f32 v72, v72
v_mfma_f32_32x32x8_bf16 v[80:95], v[52:53], v[26:27], v[80:95]
v_exp_f32 v73, v73
v_cvt_pk_bf16_f32 v99, v70, v71
v_exp_f32 v74, v74
v_exp_f32 v75, v75
v_cvt_pk_bf16_f32 v100, v72, v73
v_exp_f32 v76, v76
v_mfma_f32_32x32x16_bf16 v[128:143], v[44:47], v[108:111], v[128:143]
v_exp_f32 v77, v77
v_cvt_pk_bf16_f32 v101, v74, v75
v_exp_f32 v78, v78
v_exp_f32 v79, v79
v_cvt_pk_bf16_f32 v102, v76, v77
v_cvt_pk_bf16_f32 v103, v78, v79
s_waitcnt lgkmcnt(0)
v_mfma_f32_32x32x16_bf16 v[64:79], v[54:57], v[16:19], 0
v_exp_f32 v80, v80
v_exp_f32 v81, v81
v_exp_f32 v82, v82
v_exp_f32 v83, v83
v_cvt_pk_bf16_f32 v104, v80, v81
v_exp_f32 v84, v84
v_mfma_f32_32x32x16_bf16 v[112:127], v[144:147], v[96:99], v[112:127]
v_exp_f32 v85, v85
v_cvt_pk_bf16_f32 v105, v82, v83
v_exp_f32 v86, v86
v_exp_f32 v87, v87
v_cvt_pk_bf16_f32 v106, v84, v85
v_exp_f32 v88, v88
v_mfma_f32_32x32x8_bf16 v[64:79], v[58:59], v[20:21], v[64:79]
v_exp_f32 v89, v89
v_cvt_pk_bf16_f32 v107, v86, v87
v_exp_f32 v90, v90
v_exp_f32 v91, v91
v_cvt_pk_bf16_f32 v108, v88, v89
v_exp_f32 v92, v92
v_mfma_f32_32x32x16_bf16 v[112:127], v[148:151], v[100:103], v[112:127]
v_exp_f32 v93, v93
v_cvt_pk_bf16_f32 v109, v90, v91
v_exp_f32 v94, v94
v_exp_f32 v95, v95
v_cvt_pk_bf16_f32 v110, v92, v93
v_cvt_pk_bf16_f32 v111, v94, v95
v_mfma_f32_32x32x16_bf16 v[80:95], v[54:57], v[22:25], 0
v_exp_f32 v64, v64
v_exp_f32 v65, v65
v_exp_f32 v66, v66
v_exp_f32 v67, v67
v_cvt_pk_bf16_f32 v96, v64, v65
v_exp_f32 v68, v68
v_mfma_f32_32x32x16_bf16 v[128:143], v[144:147], v[104:107], v[128:143]
v_exp_f32 v69, v69
v_cvt_pk_bf16_f32 v97, v66, v67
v_exp_f32 v70, v70
v_exp_f32 v71, v71
v_cvt_pk_bf16_f32 v98, v68, v69
v_exp_f32 v72, v72
v_mfma_f32_32x32x8_bf16 v[80:95], v[58:59], v[26:27], v[80:95]
v_exp_f32 v73, v73
v_cvt_pk_bf16_f32 v99, v70, v71
v_exp_f32 v74, v74
v_exp_f32 v75, v75
v_cvt_pk_bf16_f32 v100, v72, v73
v_exp_f32 v76, v76
v_mfma_f32_32x32x16_bf16 v[128:143], v[148:151], v[108:111], v[128:143]
v_exp_f32 v77, v77
v_cvt_pk_bf16_f32 v101, v74, v75
v_exp_f32 v78, v78
v_exp_f32 v79, v79
v_cvt_pk_bf16_f32 v102, v76, v77
v_cvt_pk_bf16_f32 v103, v78, v79
v_mfma_f32_32x32x16_bf16 v[64:79], v[236:239], v[16:19], 0
v_exp_f32 v80, v80
v_exp_f32 v81, v81
v_exp_f32 v82, v82
v_exp_f32 v83, v83
v_cvt_pk_bf16_f32 v104, v80, v81
v_exp_f32 v84, v84
v_mfma_f32_32x32x16_bf16 v[112:127], v[152:155], v[96:99], v[112:127]
v_exp_f32 v85, v85
v_cvt_pk_bf16_f32 v105, v82, v83
v_exp_f32 v86, v86
v_exp_f32 v87, v87
v_cvt_pk_bf16_f32 v106, v84, v85
v_exp_f32 v88, v88
v_mfma_f32_32x32x8_bf16 v[64:79], v[240:241], v[20:21], v[64:79]
v_exp_f32 v89, v89
v_cvt_pk_bf16_f32 v107, v86, v87
v_exp_f32 v90, v90
v_exp_f32 v91, v91
v_cvt_pk_bf16_f32 v108, v88, v89
v_exp_f32 v92, v92
v_mfma_f32_32x32x16_bf16 v[112:127], v[156:159], v[100:103], v[112:127]
v_exp_f32 v93, v93
v_cvt_pk_bf16_f32 v109, v90, v91
v_exp_f32 v94, v94
v_exp_f32 v95, v95
v_cvt_pk_bf16_f32 v110, v92, v93
v_cvt_pk_bf16_f32 v111, v94, v95
v_mfma_f32_32x32x16_bf16 v[80:95], v[236:239], v[22:25], 0
v_add_u32 v2, 40960, v2
v_add_u32 v3, 40960, v3
v_add_u32 v4, 40960, v4
ds_read_b128 v[242:245], v2 offset:20480
s_mov_b64 exec, s[76:77]
ds_read_b64 v[246:247], v3 offset:21504
ds_read_b64 v[252:253], v3 offset:22784
s_mov_b64 exec, s[66:67]
ds_read_b128 v[160:163], v4 offset:8960
ds_read_b128 v[164:167], v4 offset:9600
ds_read_b128 v[168:171], v4 offset:25600
ds_read_b128 v[172:175], v4 offset:26240
s_mov_b64 exec, -1
v_exp_f32 v64, v64
v_exp_f32 v65, v65
v_exp_f32 v66, v66
v_exp_f32 v67, v67
v_cvt_pk_bf16_f32 v96, v64, v65
v_exp_f32 v68, v68
v_mfma_f32_32x32x16_bf16 v[128:143], v[152:155], v[104:107], v[128:143]
ds_read_b128 v[248:251], v2 offset:21760
v_exp_f32 v69, v69
v_cvt_pk_bf16_f32 v97, v66, v67
v_exp_f32 v70, v70
v_exp_f32 v71, v71
v_cvt_pk_bf16_f32 v98, v68, v69
v_exp_f32 v72, v72
v_mfma_f32_32x32x8_bf16 v[80:95], v[240:241], v[26:27], v[80:95]
v_exp_f32 v73, v73
v_cvt_pk_bf16_f32 v99, v70, v71
v_exp_f32 v74, v74
v_exp_f32 v75, v75
v_cvt_pk_bf16_f32 v100, v72, v73
v_exp_f32 v76, v76
v_mfma_f32_32x32x16_bf16 v[128:143], v[156:159], v[108:111], v[128:143]
v_exp_f32 v77, v77
v_cvt_pk_bf16_f32 v101, v74, v75
v_exp_f32 v78, v78
v_exp_f32 v79, v79
v_cvt_pk_bf16_f32 v102, v76, v77
v_cvt_pk_bf16_f32 v103, v78, v79
s_waitcnt lgkmcnt(0)
v_mfma_f32_32x32x16_bf16 v[64:79], v[242:245], v[16:19], 0
v_exp_f32 v80, v80
v_exp_f32 v81, v81
v_exp_f32 v82, v82
v_exp_f32 v83, v83
v_cvt_pk_bf16_f32 v104, v80, v81
v_exp_f32 v84, v84
v_mfma_f32_32x32x16_bf16 v[112:127], v[160:163], v[96:99], v[112:127]
v_exp_f32 v85, v85
v_cvt_pk_bf16_f32 v105, v82, v83
v_exp_f32 v86, v86
v_exp_f32 v87, v87
v_cvt_pk_bf16_f32 v106, v84, v85
v_exp_f32 v88, v88
v_mfma_f32_32x32x8_bf16 v[64:79], v[246:247], v[20:21], v[64:79]
v_exp_f32 v89, v89
v_cvt_pk_bf16_f32 v107, v86, v87
v_exp_f32 v90, v90
v_exp_f32 v91, v91
v_cvt_pk_bf16_f32 v108, v88, v89
v_exp_f32 v92, v92
v_mfma_f32_32x32x16_bf16 v[112:127], v[164:167], v[100:103], v[112:127]
v_exp_f32 v93, v93
v_cvt_pk_bf16_f32 v109, v90, v91
v_exp_f32 v94, v94
v_exp_f32 v95, v95
v_cvt_pk_bf16_f32 v110, v92, v93
v_cvt_pk_bf16_f32 v111, v94, v95
s_cmp_eq_u32 s61, 0
s_cbranch_scc1 att_hk_162
att_hk_162r:
s_barrier
v_mfma_f32_32x32x16_bf16 v[80:95], v[242:245], v[22:25], 0
v_exp_f32 v64, v64
v_exp_f32 v65, v65
v_exp_f32 v66, v66
v_exp_f32 v67, v67
v_cvt_pk_bf16_f32 v96, v64, v65
v_exp_f32 v68, v68
v_mfma_f32_32x32x16_bf16 v[128:143], v[160:163], v[104:107], v[128:143]
v_exp_f32 v69, v69
v_cvt_pk_bf16_f32 v97, v66, v67
v_exp_f32 v70, v70
v_exp_f32 v71, v71
v_cvt_pk_bf16_f32 v98, v68, v69
v_exp_f32 v72, v72
v_mfma_f32_32x32x8_bf16 v[80:95], v[246:247], v[26:27], v[80:95]
v_exp_f32 v73, v73
v_cvt_pk_bf16_f32 v99, v70, v71
v_exp_f32 v74, v74
v_exp_f32 v75, v75
v_cvt_pk_bf16_f32 v100, v72, v73
v_exp_f32 v76, v76
v_mfma_f32_32x32x16_bf16 v[128:143], v[164:167], v[108:111], v[128:143]
v_exp_f32 v77, v77
v_cvt_pk_bf16_f32 v101, v74, v75
v_exp_f32 v78, v78
v_exp_f32 v79, v79
v_cvt_pk_bf16_f32 v102, v76, v77
v_cvt_pk_bf16_f32 v103, v78, v79
v_mfma_f32_32x32x16_bf16 v[64:79], v[248:251], v[16:19], 0
v_exp_f32 v80, v80
v_exp_f32 v81, v81
v_exp_f32 v82, v82
v_exp_f32 v83, v83
v_cvt_pk_bf16_f32 v104, v80, v81
v_exp_f32 v84, v84
v_mfma_f32_32x32x16_bf16 v[112:127], v[168:171], v[96:99], v[112:127]
v_exp_f32 v85, v85
v_cvt_pk_bf16_f32 v105, v82, v83
v_exp_f32 v86, v86
v_exp_f32 v87, v87
v_cvt_pk_bf16_f32 v106, v84, v85
v_exp_f32 v88, v88
v_mfma_f32_32x32x8_bf16 v[64:79], v[252:253], v[20:21], v[64:79]
v_exp_f32 v89, v89
v_cvt_pk_bf16_f32 v107, v86, v87
v_exp_f32 v90, v90
v_exp_f32 v91, v91
v_cvt_pk_bf16_f32 v108, v88, v89
v_exp_f32 v92, v92
v_mfma_f32_32x32x16_bf16 v[112:127], v[172:175], v[100:103], v[112:127]
v_exp_f32 v93, v93
v_cvt_pk_bf16_f32 v109, v90, v91
v_exp_f32 v94, v94
v_exp_f32 v95, v95
v_cvt_pk_bf16_f32 v110, v92, v93
v_cvt_pk_bf16_f32 v111, v94, v95
v_mfma_f32_32x32x16_bf16 v[80:95], v[248:251], v[22:25], 0
ds_read_b128 v[48:51], v2 offset:23040
s_mov_b64 exec, s[76:77]
ds_read_b64 v[52:53], v3 offset:24064
ds_read_b64 v[58:59], v3 offset:25344
s_mov_b64 exec, s[66:67]
ds_read_b128 v[40:43], v4 offset:26880
ds_read_b128 v[44:47], v4 offset:27520
ds_read_b128 v[144:147], v4 offset:28160
ds_read_b128 v[148:151], v4 offset:28800
s_mov_b64 exec, -1
v_exp_f32 v64, v64
v_exp_f32 v65, v65
v_exp_f32 v66, v66
v_exp_f32 v67, v67
v_cvt_pk_bf16_f32 v96, v64, v65
v_exp_f32 v68, v68
v_mfma_f32_32x32x16_bf16 v[128:143], v[168:171], v[104:107], v[128:143]
ds_read_b128 v[54:57], v2 offset:24320
v_exp_f32 v69, v69
v_cvt_pk_bf16_f32 v97, v66, v67
v_exp_f32 v70, v70
v_exp_f32 v71, v71
v_cvt_pk_bf16_f32 v98, v68, v69
v_exp_f32 v72, v72
v_mfma_f32_32x32x8_bf16 v[80:95], v[252:253], v[26:27], v[80:95]
v_exp_f32 v73, v73
v_cvt_pk_bf16_f32 v99, v70, v71
v_exp_f32 v74, v74
v_exp_f32 v75, v75
v_cvt_pk_bf16_f32 v100, v72, v73
v_exp_f32 v76, v76
v_mfma_f32_32x32x16_bf16 v[128:143], v[172:175], v[108:111], v[128:143]
v_exp_f32 v77, v77
v_cvt_pk_bf16_f32 v101, v74, v75
v_exp_f32 v78, v78
v_exp_f32 v79, v79
v_cvt_pk_bf16_f32 v102, v76, v77
v_cvt_pk_bf16_f32 v103, v78, v79
s_waitcnt lgkmcnt(0)
v_mfma_f32_32x32x16_bf16 v[64:79], v[48:51], v[16:19], 0
v_exp_f32 v80, v80
v_exp_f32 v81, v81
v_exp_f32 v82, v82
v_exp_f32 v83, v83
v_cvt_pk_bf16_f32 v104, v80, v81
v_exp_f32 v84, v84
v_mfma_f32_32x32x16_bf16 v[112:127], v[40:43], v[96:99], v[112:127]
v_exp_f32 v85, v85
v_cvt_pk_bf16_f32 v105, v82, v83
v_exp_f32 v86, v86
v_exp_f32 v87, v87
v_cvt_pk_bf16_f32 v106, v84, v85
v_exp_f32 v88, v88
v_mfma_f32_32x32x8_bf16 v[64:79], v[52:53], v[20:21], v[64:79]
v_exp_f32 v89, v89
v_cvt_pk_bf16_f32 v107, v86, v87
v_exp_f32 v90, v90
v_exp_f32 v91, v91
v_cvt_pk_bf16_f32 v108, v88, v89
v_exp_f32 v92, v92
v_mfma_f32_32x32x16_bf16 v[112:127], v[44:47], v[100:103], v[112:127]
v_exp_f32 v93, v93
v_cvt_pk_bf16_f32 v109, v90, v91
v_exp_f32 v94, v94
v_exp_f32 v95, v95
v_cvt_pk_bf16_f32 v110, v92, v93
v_cvt_pk_bf16_f32 v111, v94, v95
v_mfma_f32_32x32x16_bf16 v[80:95], v[48:51], v[22:25], 0
v_exp_f32 v64, v64
v_exp_f32 v65, v65
v_exp_f32 v66, v66
v_exp_f32 v67, v67
v_cvt_pk_bf16_f32 v96, v64, v65
v_exp_f32 v68, v68
v_mfma_f32_32x32x16_bf16 v[128:143], v[40:43], v[104:107], v[128:143]
v_exp_f32 v69, v69
v_cvt_pk_bf16_f32 v97, v66, v67
v_exp_f32 v70, v70
v_exp_f32 v71, v71
v_cvt_pk_bf16_f32 v98, v68, v69
v_exp_f32 v72, v72
v_mfma_f32_32x32x8_bf16 v[80:95], v[52:53], v[26:27], v[80:95]
v_exp_f32 v73, v73
v_cvt_pk_bf16_f32 v99, v70, v71
v_exp_f32 v74, v74
v_exp_f32 v75, v75
v_cvt_pk_bf16_f32 v100, v72, v73
v_exp_f32 v76, v76
v_mfma_f32_32x32x16_bf16 v[128:143], v[44:47], v[108:111], v[128:143]
v_exp_f32 v77, v77
v_cvt_pk_bf16_f32 v101, v74, v75
v_exp_f32 v78, v78
v_exp_f32 v79, v79
v_cvt_pk_bf16_f32 v102, v76, v77
v_cvt_pk_bf16_f32 v103, v78, v79
v_mfma_f32_32x32x16_bf16 v[64:79], v[54:57], v[16:19], 0
v_exp_f32 v80, v80
v_exp_f32 v81, v81
v_exp_f32 v82, v82
v_exp_f32 v83, v83
v_cvt_pk_bf16_f32 v104, v80, v81
v_exp_f32 v84, v84
v_mfma_f32_32x32x16_bf16 v[112:127], v[144:147], v[96:99], v[112:127]
v_exp_f32 v85, v85
v_cvt_pk_bf16_f32 v105, v82, v83
v_exp_f32 v86, v86
v_exp_f32 v87, v87
v_cvt_pk_bf16_f32 v106, v84, v85
v_exp_f32 v88, v88
v_mfma_f32_32x32x8_bf16 v[64:79], v[58:59], v[20:21], v[64:79]
v_exp_f32 v89, v89
v_cvt_pk_bf16_f32 v107, v86, v87
v_exp_f32 v90, v90
v_exp_f32 v91, v91
v_cvt_pk_bf16_f32 v108, v88, v89
v_exp_f32 v92, v92
v_mfma_f32_32x32x16_bf16 v[112:127], v[148:151], v[100:103], v[112:127]
v_exp_f32 v93, v93
v_cvt_pk_bf16_f32 v109, v90, v91
v_exp_f32 v94, v94
v_exp_f32 v95, v95
v_cvt_pk_bf16_f32 v110, v92, v93
v_cvt_pk_bf16_f32 v111, v94, v95
v_mfma_f32_32x32x16_bf16 v[80:95], v[54:57], v[22:25], 0
s_mov_b64 exec, s[66:67]
ds_read_b128 v[152:155], v4 offset:29440
ds_read_b128 v[156:159], v4 offset:30080
s_mov_b64 exec, -1
v_exp_f32 v64, v64
v_exp_f32 v65, v65
v_exp_f32 v66, v66
v_exp_f32 v67, v67
v_cvt_pk_bf16_f32 v96, v64, v65
v_exp_f32 v68, v68
v_mfma_f32_32x32x16_bf16 v[128:143], v[144:147], v[104:107], v[128:143]
v_exp_f32 v69, v69
v_cvt_pk_bf16_f32 v97, v66, v67
v_exp_f32 v70, v70
v_exp_f32 v71, v71
v_cvt_pk_bf16_f32 v98, v68, v69
v_exp_f32 v72, v72
v_mfma_f32_32x32x8_bf16 v[80:95], v[58:59], v[26:27], v[80:95]
v_exp_f32 v73, v73
v_cvt_pk_bf16_f32 v99, v70, v71
v_exp_f32 v74, v74
v_exp_f32 v75, v75
v_cvt_pk_bf16_f32 v100, v72, v73
v_exp_f32 v76, v76
v_mfma_f32_32x32x16_bf16 v[128:143], v[148:151], v[108:111], v[128:143]
v_exp_f32 v77, v77
v_cvt_pk_bf16_f32 v101, v74, v75
v_exp_f32 v78, v78
v_exp_f32 v79, v79
v_cvt_pk_bf16_f32 v102, v76, v77
v_cvt_pk_bf16_f32 v103, v78, v79
s_waitcnt lgkmcnt(0)
v_mfma_f32_32x32x16_bf16 v[112:127], v[152:155], v[96:99], v[112:127]
v_exp_f32 v80, v80
v_exp_f32 v81, v81
v_exp_f32 v82, v82
v_exp_f32 v83, v83
v_cvt_pk_bf16_f32 v104, v80, v81
v_exp_f32 v84, v84
v_mfma_f32_32x32x16_bf16 v[112:127], v[156:159], v[100:103], v[112:127]
ds_read_b32 v31, v177
ds_read_b64 v[196:197], v29 offset:3072
ds_read_b64 v[212:213], v29 offset:6656
ds_read_b128 v[184:187], v28 offset:0
ds_read_b128 v[188:191], v28 offset:1024
ds_read_b128 v[192:195], v28 offset:2048
ds_read_b128 v[200:203], v28 offset:3584
ds_read_b128 v[204:207], v28 offset:4608
ds_read_b128 v[208:211], v28 offset:5632
v_exp_f32 v85, v85
v_cvt_pk_bf16_f32 v105, v82, v83
v_exp_f32 v86, v86
v_exp_f32 v87, v87
v_cvt_pk_bf16_f32 v106, v84, v85
v_exp_f32 v88, v88
v_exp_f32 v89, v89
v_cvt_pk_bf16_f32 v107, v86, v87
v_exp_f32 v90, v90
v_exp_f32 v91, v91
v_mfma_f32_32x32x16_bf16 v[128:143], v[152:155], v[104:107], v[128:143]
v_cvt_pk_bf16_f32 v108, v88, v89
v_exp_f32 v92, v92
v_exp_f32 v93, v93
v_cvt_pk_bf16_f32 v109, v90, v91
v_exp_f32 v94, v94
v_exp_f32 v95, v95
v_cvt_pk_bf16_f32 v110, v92, v93
v_cvt_pk_bf16_f32 v111, v94, v95
s_nop 1
v_mfma_f32_32x32x16_bf16 v[128:143], v[156:159], v[108:111], v[128:143]
s_cmp_eq_u32 s61, 0
s_cbranch_scc1 att_y_166
s_waitcnt lgkmcnt(0)
v_cmp_ne_u32 vcc, s8, v31
s_cbranch_vccnz att_x_167
att_x_167k:
v_max_f32 v66, v8, v197
v_sub_f32 v64, v8, v66
v_sub_f32 v65, v197, v66
v_max_f32 v70, v9, v213
v_sub_f32 v68, v9, v70
v_sub_f32 v69, v213, v70
v_exp_f32 v64, v64
v_exp_f32 v65, v65
v_exp_f32 v68, v68
v_exp_f32 v69, v69
v_mul_f32 v66, v64, v124
v_fmac_f32 v66, v65, v196
v_rcp_f32 v66, v66
s_nop 0
v_mul_f32 v64, v64, v66
v_mul_f32 v66, v65, v66
v_pk_mul_f32 v[112:113], v[112:113], v[64:65] op_sel_hi:[1,0]
v_pk_mul_f32 v[114:115], v[114:115], v[64:65] op_sel_hi:[1,0]
v_pk_mul_f32 v[116:117], v[116:117], v[64:65] op_sel_hi:[1,0]
v_pk_mul_f32 v[118:119], v[118:119], v[64:65] op_sel_hi:[1,0]
v_pk_mul_f32 v[120:121], v[120:121], v[64:65] op_sel_hi:[1,0]
v_pk_mul_f32 v[122:123], v[122:123], v[64:65] op_sel_hi:[1,0]
v_pk_fma_f32 v[112:113], v[184:185], v[66:67], v[112:113] op_sel_hi:[1,0,1]
v_pk_fma_f32 v[114:115], v[186:187], v[66:67], v[114:115] op_sel_hi:[1,0,1]
v_pk_fma_f32 v[116:117], v[188:189], v[66:67], v[116:117] op_sel_hi:[1,0,1]
v_pk_fma_f32 v[118:119], v[190:191], v[66:67], v[118:119] op_sel_hi:[1,0,1]
v_pk_fma_f32 v[120:121], v[192:193], v[66:67], v[120:121] op_sel_hi:[1,0,1]
v_pk_fma_f32 v[122:123], v[194:195], v[66:67], v[122:123] op_sel_hi:[1,0,1]
v_cvt_pk_bf16_f32 v72, v112, v113
v_cvt_pk_bf16_f32 v73, v114, v115
v_cvt_pk_bf16_f32 v74, v116, v117
v_cvt_pk_bf16_f32 v75, v118, v119
v_cvt_pk_bf16_f32 v76, v120, v121
v_cvt_pk_bf16_f32 v77, v122, v123
buffer_store_dwordx2 v[72:73], v30, s[36:39], s96 offen sc1
buffer_store_dwordx2 v[74:75], v30, s[36:39], s96 offen offset:512 sc1
s_mov_b32 exec_hi, 0
buffer_store_dwordx2 v[76:77], v30, s[36:39], s96 offen offset:1024 sc1
s_mov_b32 exec_hi, -1
v_mul_f32 v70, v68, v140
v_fmac_f32 v70, v69, v212
v_rcp_f32 v70, v70
s_nop 0
v_mul_f32 v68, v68, v70
v_mul_f32 v70, v69, v70
v_pk_mul_f32 v[128:129], v[128:129], v[68:69] op_sel_hi:[1,0]
v_pk_mul_f32 v[130:131], v[130:131], v[68:69] op_sel_hi:[1,0]
v_pk_mul_f32 v[132:133], v[132:133], v[68:69] op_sel_hi:[1,0]
v_pk_mul_f32 v[134:135], v[134:135], v[68:69] op_sel_hi:[1,0]
v_pk_mul_f32 v[136:137], v[136:137], v[68:69] op_sel_hi:[1,0]
v_pk_mul_f32 v[138:139], v[138:139], v[68:69] op_sel_hi:[1,0]
v_pk_fma_f32 v[128:129], v[200:201], v[70:71], v[128:129] op_sel_hi:[1,0,1]
v_pk_fma_f32 v[130:131], v[202:203], v[70:71], v[130:131] op_sel_hi:[1,0,1]
v_pk_fma_f32 v[132:133], v[204:205], v[70:71], v[132:133] op_sel_hi:[1,0,1]
v_pk_fma_f32 v[134:135], v[206:207], v[70:71], v[134:135] op_sel_hi:[1,0,1]
v_pk_fma_f32 v[136:137], v[208:209], v[70:71], v[136:137] op_sel_hi:[1,0,1]
v_pk_fma_f32 v[138:139], v[210:211], v[70:71], v[138:139] op_sel_hi:[1,0,1]
v_cvt_pk_bf16_f32 v78, v128, v129
v_cvt_pk_bf16_f32 v79, v130, v131
v_cvt_pk_bf16_f32 v80, v132, v133
v_cvt_pk_bf16_f32 v81, v134, v135
v_cvt_pk_bf16_f32 v82, v136, v137
v_cvt_pk_bf16_f32 v83, v138, v139
buffer_store_dwordx2 v[78:79], v30, s[36:39], s97 offen sc1
buffer_store_dwordx2 v[80:81], v30, s[36:39], s97 offen offset:512 sc1
s_mov_b32 exec_hi, 0
buffer_store_dwordx2 v[82:83], v30, s[36:39], s97 offen offset:1024 sc1
s_mov_b32 exec_hi, -1
s_cmp_lg_u32 s99, 0
s_cbranch_scc1 att_nc_168
v_add_f32 v10, v124, v196
v_add_f32 v11, v140, v212
v_mul_f32 v10, 0x5f000000, v10
v_mul_f32 v11, 0x5f000000, v11
v_add_f32 v10, v10, v10
v_add_f32 v11, v11, v11
v_mul_f32 v10, 0, v10
v_mul_f32 v11, 0, v11
v_fmac_f32 v10, 0, v112
v_fmac_f32 v11, 0, v128
v_fmac_f32 v10, 0, v113
v_fmac_f32 v11, 0, v129
v_fmac_f32 v10, 0, v114
v_fmac_f32 v11, 0, v130
v_fmac_f32 v10, 0, v115
v_fmac_f32 v11, 0, v131
v_fmac_f32 v10, 0, v116
v_fmac_f32 v11, 0, v132
v_fmac_f32 v10, 0, v117
v_fmac_f32 v11, 0, v133
v_fmac_f32 v10, 0, v118
v_fmac_f32 v11, 0, v134
v_fmac_f32 v10, 0, v119
v_fmac_f32 v11, 0, v135
v_fmac_f32 v10, 0, v120
v_fmac_f32 v11, 0, v136
v_fmac_f32 v10, 0, v121
v_fmac_f32 v11, 0, v137
v_fmac_f32 v10, 0, v122
v_fmac_f32 v11, 0, v138
v_fmac_f32 v10, 0, v123
v_fmac_f32 v11, 0, v139
v_cmp_u_f32 vcc, v10, v11
s_cbranch_vccnz att_fb_163
att_nc_168:
s_lshl_b32 s80, s13, 3
s_add_u32 s80, s80, s6
s_lshl_b32 s80, s80, 2
s_add_u32 s80, s80, 51798016
s_add_u32 s81, s8, 2
v_mov_b32 v1, 0
v_mov_b32 v2, s81
s_setprio 0
s_waitcnt vmcnt(0)
s_mov_b64 exec, 1
buffer_store_dword v2, v1, s[36:39], s80 offen sc1
s_mov_b64 exec, -1
s_barrier
s_branch L_slow_ld
att_hk_155:
s_barrier
s_cmp_eq_u32 s75, 0
s_cbranch_scc1 h0_169
s_and_b32 s82, s92, 0x2020202
s_cbranch_scc0 gt_170k
s_mov_b32 s82, s9
gt_170:
buffer_load_dword v180, v12, s[36:39], s94 offen sc1
s_waitcnt vmcnt(0)
v_subrev_u32 v180, s95, v180
v_cmp_lt_u32 s[92:93], 15, v180
s_or_b32 s92, s92, s93
s_and_b32 s83, s92, 0x2020202
s_cbranch_scc0 gt_170k
s_sleep 2
s_add_u32 s82, s82, 1
s_cmp_lt_u32 s82, 200000
s_cbranch_scc1 gt_170
s_mov_b32 s9, 200000
gt_170k:
s_add_u32 s64, s4, 1
s_and_b32 s64, s64, 7
s_mul_i32 s64, s64, 10240
s_add_u32 s64, s64, s62
s_add_u32 m0, s63, 20480
s_add_u32 s79, s64, 0
buffer_load_dwordx4 v5, s[36:39], s79 offen offset:0 sc1 lds
buffer_load_dwordx4 v5, s[36:39], s79 offen offset:1024 sc1 lds
buffer_load_dwordx4 v5, s[36:39], s79 offen offset:2048 sc1 lds
buffer_load_dwordx4 v5, s[36:39], s79 offen offset:3072 sc1 lds
s_add_u32 m0, s63, 24576
s_add_u32 s79, s64, 4096
buffer_load_dwordx4 v5, s[36:39], s79 offen offset:0 sc1 lds
h0_169:
s_branch att_hk_155r
att_hk_156:
s_and_b32 s82, s92, 0x4040404
s_cbranch_scc0 gt_171k
s_mov_b32 s82, s9
gt_171:
buffer_load_dword v180, v12, s[36:39], s94 offen sc1
s_waitcnt vmcnt(0)
v_subrev_u32 v180, s95, v180
v_cmp_lt_u32 s[92:93], 15, v180
s_or_b32 s92, s92, s93
s_and_b32 s83, s92, 0x4040404
s_cbranch_scc0 gt_171k
s_sleep 2
s_add_u32 s82, s82, 1
s_cmp_lt_u32 s82, 200000
s_cbranch_scc1 gt_171
s_mov_b32 s9, 200000
gt_171k:
s_add_u32 s64, s4, 2
s_and_b32 s64, s64, 7
s_mul_i32 s64, s64, 10240
s_add_u32 s64, s64, s62
s_add_u32 m0, s63, 40960
s_add_u32 s79, s64, 0
buffer_load_dwordx4 v5, s[36:39], s79 offen offset:0 sc1 lds
buffer_load_dwordx4 v5, s[36:39], s79 offen offset:1024 sc1 lds
buffer_load_dwordx4 v5, s[36:39], s79 offen offset:2048 sc1 lds
buffer_load_dwordx4 v5, s[36:39], s79 offen offset:3072 sc1 lds
s_add_u32 m0, s63, 45056
s_add_u32 s79, s64, 4096
buffer_load_dwordx4 v5, s[36:39], s79 offen offset:0 sc1 lds
s_and_b32 s82, s92, 0x8080808
s_cbranch_scc0 gt_172k
s_mov_b32 s82, s9
gt_172:
buffer_load_dword v180, v12, s[36:39], s94 offen sc1
s_waitcnt vmcnt(0)
v_subrev_u32 v180, s95, v180
v_cmp_lt_u32 s[92:93], 15, v180
s_or_b32 s92, s92, s93
s_and_b32 s83, s92, 0x8080808
s_cbranch_scc0 gt_172k
s_sleep 2
s_add_u32 s82, s82, 1
s_cmp_lt_u32 s82, 200000
s_cbranch_scc1 gt_172
s_mov_b32 s9, 200000
gt_172k:
s_add_u32 s64, s4, 3
s_and_b32 s64, s64, 7
s_mul_i32 s64, s64, 10240
s_add_u32 s64, s64, s62
s_add_u32 m0, s63, 61440
s_add_u32 s79, s64, 0
buffer_load_dwordx4 v5, s[36:39], s79 offen offset:0 sc1 lds
buffer_load_dwordx4 v5, s[36:39], s79 offen offset:1024 sc1 lds
buffer_load_dwordx4 v5, s[36:39], s79 offen offset:2048 sc1 lds
buffer_load_dwordx4 v5, s[36:39], s79 offen offset:3072 sc1 lds
s_add_u32 m0, s63, 65536
s_add_u32 s79, s64, 4096
buffer_load_dwordx4 v5, s[36:39], s79 offen offset:0 sc1 lds
s_waitcnt vmcnt(10)
s_branch att_hk_156r
att_hk_157:
s_cmp_lg_u32 s3, 0
s_cbranch_scc1 l0_173
s_waitcnt vmcnt(0)
s_sub_u32 s85, s6, 1
s_lshl_b32 s84, s85, 8
s_add_u32 s84, s84, s13
s_add_u32 s84, s84, 160
s_mul_i32 s85, s85, 5120
s_add_u32 s85, s85, 147456
s_cmp_eq_u32 s6, 0
s_cbranch_scc1 pg_174
s_cmp_eq_u32 s6, 3
s_cbranch_scc1 pg_174
s_cmp_ge_u32 s84, 544
s_cbranch_scc1 pe_175
s_and_b32 s86, s84, 7
s_lshr_b32 s87, s84, 3
s_cmp_lt_u32 s87, 20
s_cselect_b32 s56, s20, s28
s_cselect_b32 s57, s21, s29
s_mov_b32 s58, 1966080
s_cselect_b32 s58, 819200, s58
s_mov_b32 s59, 0x20000
s_cselect_b32 s88, 0, 20
s_cselect_b32 s89, 20, 48
s_mov_b32 s90, 45449216
s_cselect_b32 s90, 44630016, s90
s_sub_u32 s87, s87, s88
s_mul_i32 s89, s89, s86
s_add_u32 s89, s89, s87
s_mul_i32 s89, s89, 5120
s_add_u32 s90, s90, s89
s_mul_i32 s87, s87, 40960
s_mul_i32 s86, s86, 160
s_add_u32 s87, s87, s86
s_movk_i32 s88, 6554
v_add_u32 v180, 0, v0
v_mul_u32_u24 v181, s88, v180
v_lshrrev_b32 v181, 16, v181
v_mad_i32_i24 v180, v181, -10, v180
v_mul_u32_u24 v181, 1280, v181
v_lshl_add_u32 v180, v180, 4, v181
s_add_u32 m0, s85, 0
s_nop 0
buffer_load_dwordx4 v180, s[56:59], s87 offen lds
v_add_u32 v180, 64, v0
v_mul_u32_u24 v181, s88, v180
v_lshrrev_b32 v181, 16, v181
v_mad_i32_i24 v180, v181, -10, v180
v_mul_u32_u24 v181, 1280, v181
v_lshl_add_u32 v180, v180, 4, v181
s_add_u32 m0, s85, 1024
s_nop 0
buffer_load_dwordx4 v180, s[56:59], s87 offen lds
v_add_u32 v180, 128, v0
v_mul_u32_u24 v181, s88, v180
v_lshrrev_b32 v181, 16, v181
v_mad_i32_i24 v180, v181, -10, v180
v_mul_u32_u24 v181, 1280, v181
v_lshl_add_u32 v180, v180, 4, v181
s_add_u32 m0, s85, 2048
s_nop 0
buffer_load_dwordx4 v180, s[56:59], s87 offen lds
v_add_u32 v180, 192, v0
v_mul_u32_u24 v181, s88, v180
v_lshrrev_b32 v181, 16, v181
v_mad_i32_i24 v180, v181, -10, v180
v_mul_u32_u24 v181, 1280, v181
v_lshl_add_u32 v180, v180, 4, v181
s_add_u32 m0, s85, 3072
s_nop 0
buffer_load_dwordx4 v180, s[56:59], s87 offen lds
v_add_u32 v180, 256, v0
v_mul_u32_u24 v181, s88, v180
v_lshrrev_b32 v181, 16, v181
v_mad_i32_i24 v180, v181, -10, v180
v_mul_u32_u24 v181, 1280, v181
v_lshl_add_u32 v180, v180, 4, v181
s_add_u32 m0, s85, 4096
s_nop 0
buffer_load_dwordx4 v180, s[56:59], s87 offen lds
s_branch pe_175
pg_174:
s_cmp_ge_u32 s13, 240
s_cbranch_scc1 pe_175
s_mul_i32 s86, s13, 2731
s_lshr_b32 s86, s86, 16
s_mul_i32 s87, s86, 24
s_sub_u32 s87, s13, s87
s_mul_i32 s88, s86, 196608
s_lshl_b32 s89, s87, 7
s_add_u32 s88, s88, s89
v_lshrrev_b32 v180, 3, v0
v_mul_u32_u24 v180, 3072, v180
v_and_b32 v181, 7, v0
v_lshl_add_u32 v180, v181, 4, v180
s_and_b32 s85, s6, 1
s_cselect_b32 s56, s26, s24
s_cselect_b32 s57, s27, s25
s_mov_b32 s58, 1966080
s_mov_b32 s59, 0x20000
s_lshl_b32 s90, s85, 13
s_add_u32 m0, s90, 131072
s_add_u32 s89, s88, 0
buffer_load_dwordx4 v180, s[56:59], s89 offen lds
s_add_u32 m0, s90, 132096
s_add_u32 s89, s88, 24576
buffer_load_dwordx4 v180, s[56:59], s89 offen lds
s_add_u32 m0, s90, 133120
s_add_u32 s89, s88, 49152
buffer_load_dwordx4 v180, s[56:59], s89 offen lds
s_add_u32 m0, s90, 134144
s_add_u32 s89, s88, 73728
buffer_load_dwordx4 v180, s[56:59], s89 offen lds
s_add_u32 m0, s90, 135168
s_add_u32 s89, s88, 98304
buffer_load_dwordx4 v180, s[56:59], s89 offen lds
s_add_u32 m0, s90, 136192
s_add_u32 s89, s88, 122880
buffer_load_dwordx4 v180, s[56:59], s89 offen lds
s_add_u32 m0, s90, 137216
s_add_u32 s89, s88, 147456
buffer_load_dwordx4 v180, s[56:59], s89 offen lds
s_add_u32 m0, s90, 138240
s_add_u32 s89, s88, 172032
buffer_load_dwordx4 v180, s[56:59], s89 offen lds
pe_175:
l0_173:
s_cmp_eq_u32 s3, 0
s_cbranch_scc1 l1_176
s_waitcnt vmcnt(5)
s_and_b32 s82, s92, 0x10101010
s_cbranch_scc0 gt_177k
s_mov_b32 s82, s9
gt_177:
buffer_load_dword v180, v12, s[36:39], s94 offen sc1
s_waitcnt vmcnt(0)
v_subrev_u32 v180, s95, v180
v_cmp_lt_u32 s[92:93], 15, v180
s_or_b32 s92, s92, s93
s_and_b32 s83, s92, 0x10101010
s_cbranch_scc0 gt_177k
s_sleep 2
s_add_u32 s82, s82, 1
s_cmp_lt_u32 s82, 200000
s_cbranch_scc1 gt_177
s_mov_b32 s9, 200000
gt_177k:
s_add_u32 s64, s4, 4
s_and_b32 s64, s64, 7
s_mul_i32 s64, s64, 10240
s_add_u32 s64, s64, s62
s_add_u32 m0, s63, 81920
s_add_u32 s79, s64, 0
buffer_load_dwordx4 v5, s[36:39], s79 offen offset:0 sc1 lds
buffer_load_dwordx4 v5, s[36:39], s79 offen offset:1024 sc1 lds
buffer_load_dwordx4 v5, s[36:39], s79 offen offset:2048 sc1 lds
buffer_load_dwordx4 v5, s[36:39], s79 offen offset:3072 sc1 lds
s_add_u32 m0, s63, 86016
s_add_u32 s79, s64, 4096
buffer_load_dwordx4 v5, s[36:39], s79 offen offset:0 sc1 lds
l1_176:
s_branch att_hk_157r
att_hk_158:
s_cmp_lg_u32 s3, 0
s_cbranch_scc1 l0_178
s_and_b32 s82, s92, 0x10101010
s_cbranch_scc0 gt_179k
s_mov_b32 s82, s9
gt_179:
buffer_load_dword v180, v12, s[36:39], s94 offen sc1
s_waitcnt vmcnt(0)
v_subrev_u32 v180, s95, v180
v_cmp_lt_u32 s[92:93], 15, v180
s_or_b32 s92, s92, s93
s_and_b32 s83, s92, 0x10101010
s_cbranch_scc0 gt_179k
s_sleep 2
s_add_u32 s82, s82, 1
s_cmp_lt_u32 s82, 200000
s_cbranch_scc1 gt_179
s_mov_b32 s9, 200000
gt_179k:
s_add_u32 s64, s4, 4
s_and_b32 s64, s64, 7
s_mul_i32 s64, s64, 10240
s_add_u32 s64, s64, s62
s_add_u32 m0, s63, 81920
s_add_u32 s79, s64, 0
buffer_load_dwordx4 v5, s[36:39], s79 offen offset:0 sc1 lds
buffer_load_dwordx4 v5, s[36:39], s79 offen offset:1024 sc1 lds
buffer_load_dwordx4 v5, s[36:39], s79 offen offset:2048 sc1 lds
buffer_load_dwordx4 v5, s[36:39], s79 offen offset:3072 sc1 lds
s_add_u32 m0, s63, 86016
s_add_u32 s79, s64, 4096
buffer_load_dwordx4 v5, s[36:39], s79 offen offset:0 sc1 lds
s_and_b32 s82, s92, 0x20202020
s_cbranch_scc0 gt_180k
s_mov_b32 s82, s9
gt_180:
buffer_load_dword v180, v12, s[36:39], s94 offen sc1
s_waitcnt vmcnt(0)
v_subrev_u32 v180, s95, v180
v_cmp_lt_u32 s[92:93], 15, v180
s_or_b32 s92, s92, s93
s_and_b32 s83, s92, 0x20202020
s_cbranch_scc0 gt_180k
s_sleep 2
s_add_u32 s82, s82, 1
s_cmp_lt_u32 s82, 200000
s_cbranch_scc1 gt_180
s_mov_b32 s9, 200000
gt_180k:
s_add_u32 s64, s4, 5
s_and_b32 s64, s64, 7
s_mul_i32 s64, s64, 10240
s_add_u32 s64, s64, s62
s_add_u32 m0, s63, 102400
s_add_u32 s79, s64, 0
buffer_load_dwordx4 v5, s[36:39], s79 offen offset:0 sc1 lds
buffer_load_dwordx4 v5, s[36:39], s79 offen offset:1024 sc1 lds
buffer_load_dwordx4 v5, s[36:39], s79 offen offset:2048 sc1 lds
buffer_load_dwordx4 v5, s[36:39], s79 offen offset:3072 sc1 lds
s_add_u32 m0, s63, 106496
s_add_u32 s79, s64, 4096
buffer_load_dwordx4 v5, s[36:39], s79 offen offset:0 sc1 lds
l0_178:
s_cmp_eq_u32 s3, 0
s_cbranch_scc1 l1_181
s_waitcnt vmcnt(5)
s_and_b32 s82, s92, 0x20202020
s_cbranch_scc0 gt_182k
s_mov_b32 s82, s9
gt_182:
buffer_load_dword v180, v12, s[36:39], s94 offen sc1
s_waitcnt vmcnt(0)
v_subrev_u32 v180, s95, v180
v_cmp_lt_u32 s[92:93], 15, v180
s_or_b32 s92, s92, s93
s_and_b32 s83, s92, 0x20202020
s_cbranch_scc0 gt_182k
s_sleep 2
s_add_u32 s82, s82, 1
s_cmp_lt_u32 s82, 200000
s_cbranch_scc1 gt_182
s_mov_b32 s9, 200000
gt_182k:
s_add_u32 s64, s4, 5
s_and_b32 s64, s64, 7
s_mul_i32 s64, s64, 10240
s_add_u32 s64, s64, s62
s_add_u32 m0, s63, 102400
s_add_u32 s79, s64, 0
buffer_load_dwordx4 v5, s[36:39], s79 offen offset:0 sc1 lds
buffer_load_dwordx4 v5, s[36:39], s79 offen offset:1024 sc1 lds
buffer_load_dwordx4 v5, s[36:39], s79 offen offset:2048 sc1 lds
buffer_load_dwordx4 v5, s[36:39], s79 offen offset:3072 sc1 lds
s_add_u32 m0, s63, 106496
s_add_u32 s79, s64, 4096
buffer_load_dwordx4 v5, s[36:39], s79 offen offset:0 sc1 lds
s_and_b32 s82, s92, 0x40404040
s_cbranch_scc0 gt_183k
s_mov_b32 s82, s9
gt_183:
buffer_load_dword v180, v12, s[36:39], s94 offen sc1
s_waitcnt vmcnt(0)
v_subrev_u32 v180, s95, v180
v_cmp_lt_u32 s[92:93], 15, v180
s_or_b32 s92, s92, s93
s_and_b32 s83, s92, 0x40404040
s_cbranch_scc0 gt_183k
s_sleep 2
s_add_u32 s82, s82, 1
s_cmp_lt_u32 s82, 200000
s_cbranch_scc1 gt_183
s_mov_b32 s9, 200000
gt_183k:
s_add_u32 s64, s4, 6
s_and_b32 s64, s64, 7
s_mul_i32 s64, s64, 10240
s_add_u32 s64, s64, s62
s_add_u32 m0, s63, 122880
s_add_u32 s79, s64, 0
buffer_load_dwordx4 v5, s[36:39], s79 offen offset:0 sc1 lds
buffer_load_dwordx4 v5, s[36:39], s79 offen offset:1024 sc1 lds
buffer_load_dwordx4 v5, s[36:39], s79 offen offset:2048 sc1 lds
buffer_load_dwordx4 v5, s[36:39], s79 offen offset:3072 sc1 lds
s_add_u32 m0, s63, 126976
s_add_u32 s79, s64, 4096
buffer_load_dwordx4 v5, s[36:39], s79 offen offset:0 sc1 lds
l1_181:
s_branch att_hk_158r
att_hk_159:
s_cmp_lg_u32 s3, 0
s_cbranch_scc1 l0_184
s_waitcnt vmcnt(5)
s_cmp_eq_u32 s6, 0
s_cbranch_scc1 pg_185
s_cmp_eq_u32 s6, 3
s_cbranch_scc1 pg_185
s_cmp_ge_u32 s84, 544
s_cbranch_scc1 pe_186
v_lshrrev_b32 v180, 4, v0
v_bfe_u32 v181, v0, 2, 2
v_lshl_add_u32 v180, v180, 3, v181
v_mul_u32_u24 v180, 160, v180
v_add_u32 v180, s85, v180
v_and_b32 v181, 3, v0
v_lshl_add_u32 v182, v181, 3, v180
v_lshl_add_u32 v181, v181, 4, v180
ds_read_b64_tr_b16 v[184:185], v181 offset:0
ds_read_b64_tr_b16 v[186:187], v181 offset:640
ds_read_b64_tr_b16 v[188:189], v181 offset:8
ds_read_b64_tr_b16 v[190:191], v181 offset:648
ds_read_b64_tr_b16 v[192:193], v181 offset:64
ds_read_b64_tr_b16 v[194:195], v181 offset:704
ds_read_b64_tr_b16 v[196:197], v181 offset:72
ds_read_b64_tr_b16 v[198:199], v181 offset:712
ds_read_b64_tr_b16 v[200:201], v182 offset:128
ds_read_b64_tr_b16 v[202:203], v182 offset:768
s_add_u32 s89, s90, 4096
s_waitcnt lgkmcnt(0)
buffer_store_dwordx4 v[184:187], v5, s[36:39], s90 offen offset:0 sc1
buffer_store_dwordx4 v[188:191], v5, s[36:39], s90 offen offset:1024 sc1
buffer_store_dwordx4 v[192:195], v5, s[36:39], s90 offen offset:2048 sc1
buffer_store_dwordx4 v[196:199], v5, s[36:39], s90 offen offset:3072 sc1
buffer_store_dwordx4 v[200:203], v5, s[36:39], s89 offen offset:0 sc1
s_branch pe_186
pg_185:
s_cmp_ge_u32 s13, 240
s_cbranch_scc1 pe_186
v_lshrrev_b32 v182, 4, v0
v_bfe_u32 v180, v0, 2, 2
v_lshl_add_u32 v180, v182, 3, v180
v_lshlrev_b32 v180, 7, v180
v_and_b32 v181, 3, v0
v_lshl_add_u32 v180, v181, 3, v180
s_add_u32 s90, s90, 131072
v_add_u32 v180, s90, v180
v_lshlrev_b32 v182, 4, v182
ds_read_b64_tr_b16 v[188:189], v180 offset:0
ds_read_b64_tr_b16 v[190:191], v180 offset:512
ds_read_b64_tr_b16 v[192:193], v180 offset:4096
ds_read_b64_tr_b16 v[194:195], v180 offset:4608
ds_read_b64_tr_b16 v[196:197], v180 offset:32
ds_read_b64_tr_b16 v[198:199], v180 offset:544
ds_read_b64_tr_b16 v[200:201], v180 offset:4128
ds_read_b64_tr_b16 v[202:203], v180 offset:4640
ds_read_b64_tr_b16 v[204:205], v180 offset:64
ds_read_b64_tr_b16 v[206:207], v180 offset:576
ds_read_b64_tr_b16 v[208:209], v180 offset:4160
ds_read_b64_tr_b16 v[210:211], v180 offset:4672
ds_read_b64_tr_b16 v[212:213], v180 offset:96
ds_read_b64_tr_b16 v[214:215], v180 offset:608
ds_read_b64_tr_b16 v[216:217], v180 offset:4192
ds_read_b64_tr_b16 v[218:219], v180 offset:4704
s_mul_i32 s90, s86, 12288
s_lshl_b32 s89, s87, 9
s_add_u32 s90, s90, s89
s_lshl_b32 s89, s85, 6
s_add_u32 s90, s90, s89
s_add_u32 s90, s90, 51347456
v_mov_b32 v184, 0x3f803f80
v_mov_b32 v185, 0x3f803f80
v_mov_b32 v186, 0x3f803f80
v_mov_b32 v187, 0x3f803f80
s_nop 0
s_waitcnt lgkmcnt(0)
v_mfma_f32_16x16x32_bf16 v[220:223], v[188:191], v[184:187], 0
v_mfma_f32_16x16x32_bf16 v[224:227], v[196:199], v[184:187], 0
v_mfma_f32_16x16x32_bf16 v[228:231], v[204:207], v[184:187], 0
v_mfma_f32_16x16x32_bf16 v[232:235], v[212:215], v[184:187], 0
v_mfma_f32_16x16x32_bf16 v[220:223], v[192:195], v[184:187], v[220:223]
v_mfma_f32_16x16x32_bf16 v[224:227], v[200:203], v[184:187], v[224:227]
v_mfma_f32_16x16x32_bf16 v[228:231], v[208:211], v[184:187], v[228:231]
v_mfma_f32_16x16x32_bf16 v[232:235], v[216:219], v[184:187], v[232:235]
s_lshl_b32 s88, s87, 2
s_add_u32 s88, s88, 0
s_mul_i32 s89, s88, 43
s_lshr_b32 s89, s89, 8
s_mul_i32 s89, s89, 228
s_lshl_b32 s88, s88, 1
s_add_u32 s88, s88, s89
s_mul_i32 s89, s86, 24
s_add_u32 s88, s88, s89
s_add_u32 s88, s88, s85
s_lshl_b32 s88, s88, 10
s_add_u32 s88, s88, 47415296
s_add_u32 s89, s88, 12288
buffer_store_dwordx4 v[188:191], v5, s[36:39], s88 offen sc1
buffer_store_dwordx4 v[192:195], v5, s[36:39], s89 offen sc1
s_lshl_b32 s88, s87, 2
s_add_u32 s88, s88, 1
s_mul_i32 s89, s88, 43
s_lshr_b32 s89, s89, 8
s_mul_i32 s89, s89, 228
s_lshl_b32 s88, s88, 1
s_add_u32 s88, s88, s89
s_mul_i32 s89, s86, 24
s_add_u32 s88, s88, s89
s_add_u32 s88, s88, s85
s_lshl_b32 s88, s88, 10
s_add_u32 s88, s88, 47415296
s_add_u32 s89, s88, 12288
buffer_store_dwordx4 v[196:199], v5, s[36:39], s88 offen sc1
buffer_store_dwordx4 v[200:203], v5, s[36:39], s89 offen sc1
s_lshl_b32 s88, s87, 2
s_add_u32 s88, s88, 2
s_mul_i32 s89, s88, 43
s_lshr_b32 s89, s89, 8
s_mul_i32 s89, s89, 228
s_lshl_b32 s88, s88, 1
s_add_u32 s88, s88, s89
s_mul_i32 s89, s86, 24
s_add_u32 s88, s88, s89
s_add_u32 s88, s88, s85
s_lshl_b32 s88, s88, 10
s_add_u32 s88, s88, 47415296
s_add_u32 s89, s88, 12288
buffer_store_dwordx4 v[204:207], v5, s[36:39], s88 offen sc1
buffer_store_dwordx4 v[208:211], v5, s[36:39], s89 offen sc1
s_lshl_b32 s88, s87, 2
s_add_u32 s88, s88, 3
s_mul_i32 s89, s88, 43
s_lshr_b32 s89, s89, 8
s_mul_i32 s89, s89, 228
s_lshl_b32 s88, s88, 1
s_add_u32 s88, s88, s89
s_mul_i32 s89, s86, 24
s_add_u32 s88, s88, s89
s_add_u32 s88, s88, s85
s_lshl_b32 s88, s88, 10
s_add_u32 s88, s88, 47415296
s_add_u32 s89, s88, 12288
buffer_store_dwordx4 v[212:215], v5, s[36:39], s88 offen sc1
buffer_store_dwordx4 v[216:219], v5, s[36:39], s89 offen sc1
s_mov_b32 exec_lo, 0x10001
s_mov_b32 exec_hi, 0x10001
buffer_store_dwordx4 v[220:223], v182, s[36:39], s90 offen offset:0 sc1
buffer_store_dwordx4 v[224:227], v182, s[36:39], s90 offen offset:128 sc1
buffer_store_dwordx4 v[228:231], v182, s[36:39], s90 offen offset:256 sc1
buffer_store_dwordx4 v[232:235], v182, s[36:39], s90 offen offset:384 sc1
s_mov_b64 exec, -1
pe_186:
l0_184:
s_cmp_eq_u32 s3, 0
s_cbranch_scc1 l1_187
s_waitcnt vmcnt(10)
s_and_b32 s82, s92, 0x80808080
s_cbranch_scc0 gt_188k
s_mov_b32 s82, s9
gt_188:
buffer_load_dword v180, v12, s[36:39], s94 offen sc1
s_waitcnt vmcnt(0)
v_subrev_u32 v180, s95, v180
v_cmp_lt_u32 s[92:93], 15, v180
s_or_b32 s92, s92, s93
s_and_b32 s83, s92, 0x80808080
s_cbranch_scc0 gt_188k
s_sleep 2
s_add_u32 s82, s82, 1
s_cmp_lt_u32 s82, 200000
s_cbranch_scc1 gt_188
s_mov_b32 s9, 200000
gt_188k:
s_add_u32 s64, s4, 7
s_and_b32 s64, s64, 7
s_mul_i32 s64, s64, 10240
s_add_u32 s64, s64, s62
s_add_u32 m0, s63, 143360
s_add_u32 s79, s64, 0
buffer_load_dwordx4 v5, s[36:39], s79 offen offset:0 sc1 lds
buffer_load_dwordx4 v5, s[36:39], s79 offen offset:1024 sc1 lds
buffer_load_dwordx4 v5, s[36:39], s79 offen offset:2048 sc1 lds
buffer_load_dwordx4 v5, s[36:39], s79 offen offset:3072 sc1 lds
s_add_u32 m0, s63, 147456
s_add_u32 s79, s64, 4096
buffer_load_dwordx4 v5, s[36:39], s79 offen offset:0 sc1 lds
l1_187:
s_branch att_hk_159r
att_hk_160:
s_cmp_lg_u32 s3, 0
s_cbranch_scc1 l0_189
v_and_b32 v181, 15, v0
v_lshlrev_b32 v181, 11, v181
s_mov_b32 s65, 22284196
s_mov_b32 s82, s9
poll_190:
buffer_load_dword v180, v181, s[36:39], s65 offen sc1
s_waitcnt vmcnt(0)
v_subrev_u32 v180, s8, v180
v_cmp_lt_u32 vcc, 15, v180
s_cbranch_vccz pollok_191
s_sleep 2
s_add_u32 s82, s82, 1
s_cmp_lt_u32 s82, 200000
s_cbranch_scc1 poll_190
s_mov_b32 s9, 200000
pollok_191:
s_lshl_b32 s65, s13, 5
s_add_u32 s65, s65, s6
s_lshl_b32 s65, s65, 2
s_add_u32 s65, s65, 22282256
v_mov_b32 v10, 0
v_mov_b32 v11, s8
s_mov_b64 exec, 1
buffer_store_dword v11, v10, s[36:39], s65 offen sc1
s_mov_b64 exec, -1
s_and_b32 s82, s92, 0x40404040
s_cbranch_scc0 gt_192k
s_mov_b32 s82, s9
gt_192:
buffer_load_dword v180, v12, s[36:39], s94 offen sc1
s_waitcnt vmcnt(0)
v_subrev_u32 v180, s95, v180
v_cmp_lt_u32 s[92:93], 15, v180
s_or_b32 s92, s92, s93
s_and_b32 s83, s92, 0x40404040
s_cbranch_scc0 gt_192k
s_sleep 2
s_add_u32 s82, s82, 1
s_cmp_lt_u32 s82, 200000
s_cbranch_scc1 gt_192
s_mov_b32 s9, 200000
gt_192k:
s_add_u32 s64, s4, 6
s_and_b32 s64, s64, 7
s_mul_i32 s64, s64, 10240
s_add_u32 s64, s64, s62
s_add_u32 m0, s63, 122880
s_add_u32 s79, s64, 0
buffer_load_dwordx4 v5, s[36:39], s79 offen offset:0 sc1 lds
buffer_load_dwordx4 v5, s[36:39], s79 offen offset:1024 sc1 lds
buffer_load_dwordx4 v5, s[36:39], s79 offen offset:2048 sc1 lds
buffer_load_dwordx4 v5, s[36:39], s79 offen offset:3072 sc1 lds
s_add_u32 m0, s63, 126976
s_add_u32 s79, s64, 4096
buffer_load_dwordx4 v5, s[36:39], s79 offen offset:0 sc1 lds
s_and_b32 s82, s92, 0x80808080
s_cbranch_scc0 gt_193k
s_mov_b32 s82, s9
gt_193:
buffer_load_dword v180, v12, s[36:39], s94 offen sc1
s_waitcnt vmcnt(0)
v_subrev_u32 v180, s95, v180
v_cmp_lt_u32 s[92:93], 15, v180
s_or_b32 s92, s92, s93
s_and_b32 s83, s92, 0x80808080
s_cbranch_scc0 gt_193k
s_sleep 2
s_add_u32 s82, s82, 1
s_cmp_lt_u32 s82, 200000
s_cbranch_scc1 gt_193
s_mov_b32 s9, 200000
gt_193k:
s_add_u32 s64, s4, 7
s_and_b32 s64, s64, 7
s_mul_i32 s64, s64, 10240
s_add_u32 s64, s64, s62
s_add_u32 m0, s63, 143360
s_add_u32 s79, s64, 0
buffer_load_dwordx4 v5, s[36:39], s79 offen offset:0 sc1 lds
buffer_load_dwordx4 v5, s[36:39], s79 offen offset:1024 sc1 lds
buffer_load_dwordx4 v5, s[36:39], s79 offen offset:2048 sc1 lds
buffer_load_dwordx4 v5, s[36:39], s79 offen offset:3072 sc1 lds
s_add_u32 m0, s63, 147456
s_add_u32 s79, s64, 4096
buffer_load_dwordx4 v5, s[36:39], s79 offen offset:0 sc1 lds
l0_189:
s_cmp_eq_u32 s3, 0
s_cbranch_scc1 l1_194
s_waitcnt vmcnt(10)
s_add_u32 m0, s70, 0
s_add_u32 s79, s69, 0
buffer_load_dwordx4 v5, s[36:39], s79 offen offset:0  lds
buffer_load_dwordx4 v5, s[36:39], s79 offen offset:1024  lds
buffer_load_dwordx4 v5, s[36:39], s79 offen offset:2048  lds
buffer_load_dwordx4 v5, s[36:39], s79 offen offset:3072  lds
s_add_u32 m0, s70, 4096
s_add_u32 s79, s69, 4096
buffer_load_dwordx4 v5, s[36:39], s79 offen offset:0  lds
s_add_u32 m0, s70, 20480
s_add_u32 s79, s69, 20480
buffer_load_dwordx4 v5, s[36:39], s79 offen offset:0  lds
buffer_load_dwordx4 v5, s[36:39], s79 offen offset:1024  lds
buffer_load_dwordx4 v5, s[36:39], s79 offen offset:2048  lds
buffer_load_dwordx4 v5, s[36:39], s79 offen offset:3072  lds
s_add_u32 m0, s70, 24576
s_add_u32 s79, s69, 24576
buffer_load_dwordx4 v5, s[36:39], s79 offen offset:0  lds
s_cmp_ge_u32 s6, 8
s_cbranch_scc1 pfs_195
s_lshr_b32 s71, s5, 4
s_mul_i32 s71, s71, 1
s_mul_i32 s65, s6, 2
s_add_u32 s71, s71, s65
s_add_u32 s71, s71, 0
s_lshl_b32 s71, s71, 13
s_and_b32 s65, s5, 15
s_mul_i32 s65, s65, 245760
s_add_u32 s71, s71, s65
s_add_u32 s71, s71, 47415296
buffer_load_dword v176, v13, s[36:39], s71 offen
pfs_195:
l1_194:
s_branch att_hk_160r
att_hk_161:
s_cmp_lg_u32 s3, 0
s_cbranch_scc1 l0_196
s_waitcnt vmcnt(0)
s_add_u32 m0, s70, 0
s_add_u32 s79, s69, 0
buffer_load_dwordx4 v5, s[36:39], s79 offen offset:0  lds
buffer_load_dwordx4 v5, s[36:39], s79 offen offset:1024  lds
buffer_load_dwordx4 v5, s[36:39], s79 offen offset:2048  lds
buffer_load_dwordx4 v5, s[36:39], s79 offen offset:3072  lds
s_add_u32 m0, s70, 4096
s_add_u32 s79, s69, 4096
buffer_load_dwordx4 v5, s[36:39], s79 offen offset:0  lds
s_add_u32 m0, s70, 20480
s_add_u32 s79, s69, 20480
buffer_load_dwordx4 v5, s[36:39], s79 offen offset:0  lds
buffer_load_dwordx4 v5, s[36:39], s79 offen offset:1024  lds
buffer_load_dwordx4 v5, s[36:39], s79 offen offset:2048  lds
buffer_load_dwordx4 v5, s[36:39], s79 offen offset:3072  lds
s_add_u32 m0, s70, 24576
s_add_u32 s79, s69, 24576
buffer_load_dwordx4 v5, s[36:39], s79 offen offset:0  lds
l0_196:
s_cmp_eq_u32 s3, 0
s_cbranch_scc1 l1_197
s_waitcnt vmcnt(10)
l1_197:
s_add_u32 m0, s70, 40960
s_add_u32 s79, s69, 40960
buffer_load_dwordx4 v5, s[36:39], s79 offen offset:0  lds
buffer_load_dwordx4 v5, s[36:39], s79 offen offset:1024  lds
buffer_load_dwordx4 v5, s[36:39], s79 offen offset:2048  lds
buffer_load_dwordx4 v5, s[36:39], s79 offen offset:3072  lds
s_add_u32 m0, s70, 45056
s_add_u32 s79, s69, 45056
buffer_load_dwordx4 v5, s[36:39], s79 offen offset:0  lds
s_add_u32 m0, s70, 61440
s_add_u32 s79, s69, 61440
buffer_load_dwordx4 v5, s[36:39], s79 offen offset:0  lds
buffer_load_dwordx4 v5, s[36:39], s79 offen offset:1024  lds
buffer_load_dwordx4 v5, s[36:39], s79 offen offset:2048  lds
buffer_load_dwordx4 v5, s[36:39], s79 offen offset:3072  lds
s_add_u32 m0, s70, 65536
s_add_u32 s79, s69, 65536
buffer_load_dwordx4 v5, s[36:39], s79 offen offset:0  lds
s_cmp_eq_u32 s3, 0
s_cbranch_scc1 l1_198
s_cmp_ge_u32 s6, 4
s_cbranch_scc1 pfs_199
s_lshr_b32 s71, s5, 4
s_mul_i32 s71, s71, 1
s_mul_i32 s65, s6, 2
s_add_u32 s71, s71, s65
s_add_u32 s71, s71, 8
s_lshl_b32 s71, s71, 13
s_and_b32 s65, s5, 15
s_mul_i32 s65, s65, 245760
s_add_u32 s71, s71, s65
s_add_u32 s71, s71, 47415296
buffer_load_dword v176, v13, s[36:39], s71 offen
pfs_199:
l1_198:
s_branch att_hk_161r
att_hk_162:
s_cmp_lg_u32 s3, 0
s_cbranch_scc1 l0_200
s_lshl_b32 s65, s6, 13
s_add_u32 s65, s65, 22282256
s_mov_b32 s82, s9
poll_201:
buffer_load_dwordx4 v[180:183], v13, s[36:39], s65 offen sc1
s_waitcnt vmcnt(0)
v_subrev_u32 v180, s8, v180
v_subrev_u32 v181, s8, v181
v_max_u32 v180, v180, v181
v_subrev_u32 v182, s8, v182
v_max_u32 v180, v180, v182
v_subrev_u32 v183, s8, v183
v_max_u32 v180, v180, v183
v_cmp_lt_u32 vcc, 15, v180
s_cbranch_vccz pollok_202
s_sleep 2
s_add_u32 s82, s82, 1
s_cmp_lt_u32 s82, 200000
s_cbranch_scc1 poll_201
s_mov_b32 s9, 200000
pollok_202:
l0_200:
s_add_u32 m0, s70, 81920
s_add_u32 s79, s69, 81920
buffer_load_dwordx4 v5, s[36:39], s79 offen offset:0  lds
buffer_load_dwordx4 v5, s[36:39], s79 offen offset:1024  lds
buffer_load_dwordx4 v5, s[36:39], s79 offen offset:2048  lds
buffer_load_dwordx4 v5, s[36:39], s79 offen offset:3072  lds
s_add_u32 m0, s70, 86016
s_add_u32 s79, s69, 86016
buffer_load_dwordx4 v5, s[36:39], s79 offen offset:0  lds
s_cmp_eq_u32 s3, 0
s_cbranch_scc1 l1_203
l1_203:
s_branch att_hk_162r
att_comb_164:
s_mov_b32 s99, 1
v_mov_b32 v184, 0
v_mov_b32 v185, 0
v_mov_b32 v186, 0
v_mov_b32 v187, 0
v_mov_b32 v188, 0
v_mov_b32 v189, 0
v_mov_b32 v190, 0
v_mov_b32 v191, 0
v_mov_b32 v192, 0
v_mov_b32 v193, 0
v_mov_b32 v194, 0
v_mov_b32 v195, 0
v_mov_b32 v196, 0
v_mov_b32 v197, v8
v_mov_b32 v200, 0
v_mov_b32 v201, 0
v_mov_b32 v202, 0
v_mov_b32 v203, 0
v_mov_b32 v204, 0
v_mov_b32 v205, 0
v_mov_b32 v206, 0
v_mov_b32 v207, 0
v_mov_b32 v208, 0
v_mov_b32 v209, 0
v_mov_b32 v210, 0
v_mov_b32 v211, 0
v_mov_b32 v212, 0
v_mov_b32 v213, v9
s_branch att_x_167k
att_x_167:
s_mov_b32 s72, 0
att_x_167l:
ds_read_b32 v31, v177
ds_read_b64 v[196:197], v29 offset:3072
ds_read_b64 v[212:213], v29 offset:6656
ds_read_b128 v[184:187], v28 offset:0
ds_read_b128 v[188:191], v28 offset:1024
ds_read_b128 v[192:195], v28 offset:2048
ds_read_b128 v[200:203], v28 offset:3584
ds_read_b128 v[204:207], v28 offset:4608
ds_read_b128 v[208:211], v28 offset:5632
s_waitcnt lgkmcnt(0)
v_cmp_ne_u32 vcc, s8, v31
s_cbranch_vccz att_x_167k
s_add_u32 s72, s72, 1
s_cmp_lt_u32 s72, 800000
s_cbranch_scc1 att_x_167l
s_branch att_x_167k
att_y_166:
s_waitcnt lgkmcnt(0)
s_nop 8
v_mov_b32 v125, v8
v_mov_b32 v141, v9
v_mov_b32 v10, s8
ds_write_b128 v28, v[112:115] offset:0
ds_write_b128 v28, v[116:119] offset:1024
ds_write_b128 v28, v[120:123] offset:2048
ds_write_b64 v29, v[124:125] offset:3072
ds_write_b128 v28, v[128:131] offset:3584
ds_write_b128 v28, v[132:135] offset:4608
ds_write_b128 v28, v[136:139] offset:5632
ds_write_b64 v29, v[140:141] offset:6656
ds_write_b32 v177, v10
s_cmp_lg_u32 s3, 0
s_cbranch_scc1 l0_204
s_cmp_lg_u32 s6, 3
s_cbranch_scc1 cs_205
s_mov_b32 exec_hi, 0xffff
s_and_b32 s65, s5, 15
s_mul_i32 s65, s65, 768
s_add_u32 s65, s65, 51347456
buffer_load_dwordx4 v[180:183], v5, s[36:39], s65 offen
s_add_u32 s65, s65, 12288
buffer_load_dwordx4 v[184:187], v5, s[36:39], s65 offen
s_add_u32 s65, s65, 12288
buffer_load_dwordx4 v[188:191], v5, s[36:39], s65 offen
s_add_u32 s65, s65, 12288
buffer_load_dwordx4 v[192:195], v5, s[36:39], s65 offen
s_add_u32 s65, s65, 12288
buffer_load_dwordx4 v[196:199], v5, s[36:39], s65 offen
s_add_u32 s65, s65, 12288
buffer_load_dwordx4 v[200:203], v5, s[36:39], s65 offen
s_add_u32 s65, s65, 12288
buffer_load_dwordx4 v[204:207], v5, s[36:39], s65 offen
s_add_u32 s65, s65, 12288
buffer_load_dwordx4 v[208:211], v5, s[36:39], s65 offen
s_add_u32 s65, s65, 12288
buffer_load_dwordx4 v[212:215], v5, s[36:39], s65 offen
s_add_u32 s65, s65, 12288
buffer_load_dwordx4 v[216:219], v5, s[36:39], s65 offen
s_add_u32 s65, s65, 12288
s_mov_b32 exec_hi, -1
cs_205:
l0_204:
s_waitcnt lgkmcnt(0)
s_lshr_b32 s60, s13, 3
s_and_b32 s61, s5, 7
v_and_b32 v3, 15, v0
v_lshrrev_b32 v7, 4, v0
s_lshl_b32 s66, s60, 1
s_lshr_b32 s67, s6, 1
s_add_u32 s66, s66, s67
s_and_b32 s68, s6, 1
s_lshl_b32 s68, s68, 8
s_mul_i32 s62, s66, 40960
s_add_u32 s62, s62, s68
s_add_u32 s62, s62, s7
s_add_u32 s62, s62, 7864320
s_mul_i32 s64, s66, 40960
s_mul_i32 s67, s61, 5120
s_add_u32 s64, s64, s67
s_add_u32 s64, s64, s68
s_lshl_b32 s72, s6, 8
s_lshl_b32 s67, s60, 12
s_add_u32 s72, s72, s67
s_add_u32 s72, s72, s7
s_lshl_b32 s65, s60, 2
s_add_u32 s65, s65, s6
s_mul_i32 s65, s65, 20480
s_mul_i32 s67, s61, 160
s_add_u32 s65, s65, s67
v_lshlrev_b32 v1, 4, v3
v_lshl_add_u32 v10, v7, 9, v1
v_lshrrev_b32 v2, 5, v0
v_lshl_add_u32 v1, v2, 9, v1
v_and_b32 v2, 1, v7
v_lshl_add_u32 v11, v2, 3, v1
v_add_u32 v11, 4096, v11
v_mul_u32_u24 v1, 1280, v3
v_lshl_add_u32 v12, v7, 4, v1
v_lshl_add_u32 v13, v7, 3, v1
v_add_u32 v9, 4096, v10
s_cmp_lg_u32 s3, 0
s_cbranch_scc1 prj_r1_206
buffer_load_dwordx4 v[54:57], v12, s[40:43], s65 offen
buffer_load_dwordx4 v[58:61], v12, s[40:43], s65 offen offset:64
buffer_load_dwordx2 v[62:63], v13, s[40:43], s65 offen offset:128
s_branch prj_r2_207
prj_r1_206:
s_add_u32 s67, s64, 13107200
buffer_load_dwordx4 v[54:57], v10, s[36:39], s67 offen sc1
buffer_load_dwordx4 v[58:61], v10, s[36:39], s67 offen offset:2048 sc1
buffer_load_dwordx2 v[62:63], v11, s[36:39], s67 offen offset:0 sc1
prj_r2_207:
s_setprio 0
s_waitcnt vmcnt(0)
s_barrier
s_cmp_lg_u32 s3, 0
s_cbranch_scc1 l0_208
s_cmp_lg_u32 s6, 3
s_cbranch_scc1 cs_209
s_mov_b32 exec_hi, 0xffff
v_pk_add_f32 v[180:181], v[180:181], v[184:185]
v_pk_add_f32 v[182:183], v[182:183], v[186:187]
v_pk_add_f32 v[180:181], v[180:181], v[188:189]
v_pk_add_f32 v[182:183], v[182:183], v[190:191]
v_pk_add_f32 v[180:181], v[180:181], v[192:193]
v_pk_add_f32 v[182:183], v[182:183], v[194:195]
v_pk_add_f32 v[180:181], v[180:181], v[196:197]
v_pk_add_f32 v[182:183], v[182:183], v[198:199]
v_pk_add_f32 v[180:181], v[180:181], v[200:201]
v_pk_add_f32 v[182:183], v[182:183], v[202:203]
v_pk_add_f32 v[180:181], v[180:181], v[204:205]
v_pk_add_f32 v[182:183], v[182:183], v[206:207]
v_pk_add_f32 v[180:181], v[180:181], v[208:209]
v_pk_add_f32 v[182:183], v[182:183], v[210:211]
v_pk_add_f32 v[180:181], v[180:181], v[212:213]
v_pk_add_f32 v[182:183], v[182:183], v[214:215]
v_pk_add_f32 v[180:181], v[180:181], v[216:217]
v_pk_add_f32 v[182:183], v[182:183], v[218:219]
s_mul_i32 s78, s13, 768
s_add_u32 s78, s78, 51470336
v_lshlrev_b32 v184, 4, v0
buffer_store_dwordx4 v[180:183], v184, s[36:39], s78 offen
s_mov_b32 exec_hi, -1
s_nop 1
cs_209:
l0_208:
v_lshlrev_b32 v4, 4, v0
v_add_u32 v5, 61440, v4
v_add_u32 v6, 122880, v4
s_mov_b32 s68, 0xffff0000
v_and_b32 v1, 31, v0
v_lshlrev_b32 v1, 5, v1
s_lshr_b32 s94, s5, 3
s_lshl_b32 s94, s94, 2
s_add_u32 s94, s94, 16
s_lshl_b32 s81, s4, 10
s_add_u32 s94, s94, s81
s_add_u32 s94, s94, 51798016
s_add_u32 s95, s8, 2
s_mov_b32 s92, -1
buffer_load_dword v2, v1, s[36:39], s94 offen sc1
ds_read_b128 v[134:137], v4 offset:0
ds_read_b128 v[138:141], v4 offset:1024
ds_read_b128 v[142:145], v4 offset:2048
ds_read_b128 v[146:149], v4 offset:3072
ds_read_b128 v[150:153], v4 offset:4096
ds_read_b128 v[154:157], v4 offset:5120
ds_read_b128 v[158:161], v4 offset:6144
ds_read_b128 v[162:165], v4 offset:7168
ds_read_b128 v[166:169], v4 offset:8192
ds_read_b128 v[170:173], v4 offset:9216
ds_read_b128 v[174:177], v4 offset:10240
ds_read_b128 v[178:181], v4 offset:11264
ds_read_b128 v[182:185], v4 offset:12288
ds_read_b128 v[186:189], v4 offset:13312
ds_read_b128 v[190:193], v4 offset:14336
ds_read_b128 v[194:197], v4 offset:15360
ds_read_b128 v[198:201], v4 offset:16384
ds_read_b128 v[202:205], v4 offset:17408
ds_read_b128 v[206:209], v4 offset:18432
ds_read_b128 v[210:213], v4 offset:19456
ds_read_b128 v[214:217], v4 offset:20480
ds_read_b128 v[218:221], v4 offset:21504
ds_read_b128 v[222:225], v4 offset:22528
ds_read_b128 v[226:229], v4 offset:23552
ds_read_b128 v[230:233], v4 offset:24576
v_lshlrev_b32 v34, 16, v54
v_and_b32 v35, s68, v54
v_lshlrev_b32 v36, 16, v55
v_and_b32 v37, s68, v55
v_lshlrev_b32 v38, 16, v56
v_and_b32 v39, s68, v56
v_lshlrev_b32 v40, 16, v57
v_and_b32 v41, s68, v57
v_lshlrev_b32 v42, 16, v58
v_and_b32 v43, s68, v58
v_lshlrev_b32 v44, 16, v59
v_and_b32 v45, s68, v59
v_lshlrev_b32 v46, 16, v60
v_and_b32 v47, s68, v60
v_lshlrev_b32 v48, 16, v61
v_and_b32 v49, s68, v61
v_lshlrev_b32 v50, 16, v62
v_and_b32 v51, s68, v62
v_lshlrev_b32 v52, 16, v63
v_and_b32 v53, s68, v63
s_waitcnt vmcnt(0)
v_subrev_u32 v2, s95, v2
v_cmp_lt_u32 s[92:93], 15, v2
s_and_b32 s82, s92, 0x7f
s_cbranch_scc0 gt_210k
s_mov_b32 s82, s9
gt_210:
buffer_load_dword v2, v1, s[36:39], s94 offen sc1
s_waitcnt vmcnt(0)
v_subrev_u32 v2, s95, v2
v_cmp_lt_u32 s[92:93], 15, v2
s_and_b32 s83, s92, 0x7f
s_cbranch_scc0 gt_210k
s_add_u32 s82, s82, 1
s_cmp_lt_u32 s82, 200000
s_cbranch_scc1 gt_210
s_mov_b32 s9, 200000
gt_210k:
s_add_u32 s70, s62, 0
buffer_load_dwordx4 v[54:57], v10, s[36:39], s70 offen offset:0 sc1
buffer_load_dwordx4 v[58:61], v10, s[36:39], s70 offen offset:2048 sc1
buffer_load_dwordx4 v[62:65], v9, s[36:39], s70 offen offset:0 sc1
buffer_load_dwordx4 v[66:69], v9, s[36:39], s70 offen offset:2048 sc1
s_and_b32 s82, s92, 0x1f80
s_cbranch_scc0 gt_211k
s_mov_b32 s82, s9
gt_211:
buffer_load_dword v2, v1, s[36:39], s94 offen sc1
s_waitcnt vmcnt(0)
v_subrev_u32 v2, s95, v2
v_cmp_lt_u32 s[92:93], 15, v2
s_and_b32 s83, s92, 0x1f80
s_cbranch_scc0 gt_211k
s_add_u32 s82, s82, 1
s_cmp_lt_u32 s82, 200000
s_cbranch_scc1 gt_211
s_mov_b32 s9, 200000
gt_211k:
s_add_u32 s70, s62, 8192
buffer_load_dwordx4 v[70:73], v10, s[36:39], s70 offen offset:0 sc1
buffer_load_dwordx4 v[74:77], v10, s[36:39], s70 offen offset:2048 sc1
buffer_load_dwordx4 v[78:81], v9, s[36:39], s70 offen offset:0 sc1
buffer_load_dwordx4 v[82:85], v9, s[36:39], s70 offen offset:2048 sc1
s_waitcnt vmcnt(7) lgkmcnt(15)
s_and_b32 s82, s92, 0xfe000
s_cbranch_scc0 gt_212k
s_mov_b32 s82, s9
gt_212:
buffer_load_dword v2, v1, s[36:39], s94 offen sc1
s_waitcnt vmcnt(0)
v_subrev_u32 v2, s95, v2
v_cmp_lt_u32 s[92:93], 15, v2
s_and_b32 s83, s92, 0xfe000
s_cbranch_scc0 gt_212k
s_add_u32 s82, s82, 1
s_cmp_lt_u32 s82, 200000
s_cbranch_scc1 gt_212
s_mov_b32 s9, 200000
gt_212k:
s_add_u32 s70, s62, 16384
v_mfma_f32_16x16x32_bf16 v[14:17], v[134:137], v[54:57], 0
ds_read_b128 v[234:237], v4 offset:25600
v_mfma_f32_16x16x32_bf16 v[18:21], v[138:141], v[54:57], 0
ds_read_b128 v[238:241], v4 offset:26624
buffer_load_dwordx4 v[86:89], v10, s[36:39], s70 offen offset:0 sc1
v_mfma_f32_16x16x32_bf16 v[22:25], v[142:145], v[54:57], 0
ds_read_b128 v[242:245], v4 offset:27648
v_mfma_f32_16x16x32_bf16 v[26:29], v[146:149], v[54:57], 0
ds_read_b128 v[246:249], v4 offset:28672
v_mfma_f32_16x16x32_bf16 v[30:33], v[150:153], v[54:57], 0
ds_read_b128 v[250:253], v4 offset:29696
buffer_load_dwordx4 v[90:93], v10, s[36:39], s70 offen offset:2048 sc1
s_waitcnt vmcnt(8) lgkmcnt(15)
v_mfma_f32_16x16x32_bf16 v[14:17], v[154:157], v[58:61], v[14:17]
ds_read_b128 v[134:137], v4 offset:30720
v_mfma_f32_16x16x32_bf16 v[18:21], v[158:161], v[58:61], v[18:21]
ds_read_b128 v[138:141], v4 offset:31744
buffer_load_dwordx4 v[94:97], v9, s[36:39], s70 offen offset:0 sc1
v_mfma_f32_16x16x32_bf16 v[22:25], v[162:165], v[58:61], v[22:25]
ds_read_b128 v[142:145], v4 offset:32768
v_mfma_f32_16x16x32_bf16 v[26:29], v[166:169], v[58:61], v[26:29]
ds_read_b128 v[146:149], v4 offset:33792
v_mfma_f32_16x16x32_bf16 v[30:33], v[170:173], v[58:61], v[30:33]
ds_read_b128 v[150:153], v4 offset:34816
buffer_load_dwordx4 v[98:101], v9, s[36:39], s70 offen offset:2048 sc1
s_waitcnt vmcnt(9) lgkmcnt(15)
s_and_b32 s82, s92, 0x3f00000
s_cbranch_scc0 gt_213k
s_mov_b32 s82, s9
gt_213:
buffer_load_dword v2, v1, s[36:39], s94 offen sc1
s_waitcnt vmcnt(0)
v_subrev_u32 v2, s95, v2
v_cmp_lt_u32 s[92:93], 15, v2
s_and_b32 s83, s92, 0x3f00000
s_cbranch_scc0 gt_213k
s_add_u32 s82, s82, 1
s_cmp_lt_u32 s82, 200000
s_cbranch_scc1 gt_213
s_mov_b32 s9, 200000
gt_213k:
s_add_u32 s70, s62, 24576
v_mfma_f32_16x16x32_bf16 v[14:17], v[174:177], v[62:65], v[14:17]
ds_read_b128 v[154:157], v4 offset:35840
v_mfma_f32_16x16x32_bf16 v[18:21], v[178:181], v[62:65], v[18:21]
ds_read_b128 v[158:161], v4 offset:36864
buffer_load_dwordx4 v[102:105], v10, s[36:39], s70 offen offset:0 sc1
v_mfma_f32_16x16x32_bf16 v[22:25], v[182:185], v[62:65], v[22:25]
ds_read_b128 v[162:165], v4 offset:37888
v_mfma_f32_16x16x32_bf16 v[26:29], v[186:189], v[62:65], v[26:29]
ds_read_b128 v[166:169], v4 offset:38912
v_mfma_f32_16x16x32_bf16 v[30:33], v[190:193], v[62:65], v[30:33]
ds_read_b128 v[170:173], v4 offset:39936
buffer_load_dwordx4 v[106:109], v10, s[36:39], s70 offen offset:2048 sc1
s_waitcnt vmcnt(10) lgkmcnt(15)
v_mfma_f32_16x16x32_bf16 v[14:17], v[194:197], v[66:69], v[14:17]
ds_read_b128 v[174:177], v4 offset:40960
v_mfma_f32_16x16x32_bf16 v[18:21], v[198:201], v[66:69], v[18:21]
ds_read_b128 v[178:181], v4 offset:41984
buffer_load_dwordx4 v[110:113], v9, s[36:39], s70 offen offset:0 sc1
v_mfma_f32_16x16x32_bf16 v[22:25], v[202:205], v[66:69], v[22:25]
ds_read_b128 v[182:185], v4 offset:43008
v_mfma_f32_16x16x32_bf16 v[26:29], v[206:209], v[66:69], v[26:29]
ds_read_b128 v[186:189], v4 offset:44032
v_mfma_f32_16x16x32_bf16 v[30:33], v[210:213], v[66:69], v[30:33]
ds_read_b128 v[190:193], v4 offset:45056
buffer_load_dwordx4 v[114:117], v9, s[36:39], s70 offen offset:2048 sc1
s_waitcnt vmcnt(11) lgkmcnt(15)
s_and_b32 s82, s92, 0xfc000000
s_cbranch_scc0 gt_214k
s_mov_b32 s82, s9
gt_214:
buffer_load_dword v2, v1, s[36:39], s94 offen sc1
s_waitcnt vmcnt(0)
v_subrev_u32 v2, s95, v2
v_cmp_lt_u32 s[92:93], 15, v2
s_and_b32 s83, s92, 0xfc000000
s_cbranch_scc0 gt_214k
s_add_u32 s82, s82, 1
s_cmp_lt_u32 s82, 200000
s_cbranch_scc1 gt_214
s_mov_b32 s9, 200000
gt_214k:
s_add_u32 s70, s62, 32768
v_mfma_f32_16x16x32_bf16 v[14:17], v[214:217], v[70:73], v[14:17]
ds_read_b128 v[194:197], v4 offset:46080
v_mfma_f32_16x16x32_bf16 v[18:21], v[218:221], v[70:73], v[18:21]
ds_read_b128 v[198:201], v4 offset:47104
buffer_load_dwordx4 v[118:121], v10, s[36:39], s70 offen offset:0 sc1
v_mfma_f32_16x16x32_bf16 v[22:25], v[222:225], v[70:73], v[22:25]
ds_read_b128 v[202:205], v4 offset:48128
v_mfma_f32_16x16x32_bf16 v[26:29], v[226:229], v[70:73], v[26:29]
ds_read_b128 v[206:209], v4 offset:49152
v_mfma_f32_16x16x32_bf16 v[30:33], v[230:233], v[70:73], v[30:33]
ds_read_b128 v[210:213], v4 offset:50176
buffer_load_dwordx4 v[122:125], v10, s[36:39], s70 offen offset:2048 sc1
s_waitcnt vmcnt(12) lgkmcnt(15)
v_mfma_f32_16x16x32_bf16 v[14:17], v[234:237], v[74:77], v[14:17]
ds_read_b128 v[214:217], v4 offset:51200
v_mfma_f32_16x16x32_bf16 v[18:21], v[238:241], v[74:77], v[18:21]
ds_read_b128 v[218:221], v4 offset:52224
buffer_load_dwordx4 v[126:129], v9, s[36:39], s70 offen offset:0 sc1
v_mfma_f32_16x16x32_bf16 v[22:25], v[242:245], v[74:77], v[22:25]
ds_read_b128 v[222:225], v4 offset:53248
v_mfma_f32_16x16x32_bf16 v[26:29], v[246:249], v[74:77], v[26:29]
ds_read_b128 v[226:229], v4 offset:54272
v_mfma_f32_16x16x32_bf16 v[30:33], v[250:253], v[74:77], v[30:33]
ds_read_b128 v[230:233], v4 offset:55296
buffer_load_dwordx4 v[130:133], v9, s[36:39], s70 offen offset:2048 sc1
s_waitcnt vmcnt(13) lgkmcnt(15)
v_mfma_f32_16x16x32_bf16 v[14:17], v[134:137], v[78:81], v[14:17]
ds_read_b128 v[234:237], v4 offset:56320
v_mfma_f32_16x16x32_bf16 v[18:21], v[138:141], v[78:81], v[18:21]
ds_read_b128 v[238:241], v4 offset:57344
v_mfma_f32_16x16x32_bf16 v[22:25], v[142:145], v[78:81], v[22:25]
ds_read_b128 v[242:245], v4 offset:58368
v_mfma_f32_16x16x32_bf16 v[26:29], v[146:149], v[78:81], v[26:29]
ds_read_b128 v[246:249], v4 offset:59392
v_mfma_f32_16x16x32_bf16 v[30:33], v[150:153], v[78:81], v[30:33]
ds_read_b128 v[250:253], v4 offset:60416
s_waitcnt vmcnt(12) lgkmcnt(15)
v_mfma_f32_16x16x32_bf16 v[14:17], v[154:157], v[82:85], v[14:17]
ds_read_b128 v[134:137], v5 offset:0
v_mfma_f32_16x16x32_bf16 v[18:21], v[158:161], v[82:85], v[18:21]
ds_read_b128 v[138:141], v5 offset:1024
v_mfma_f32_16x16x32_bf16 v[22:25], v[162:165], v[82:85], v[22:25]
ds_read_b128 v[142:145], v5 offset:2048
v_mfma_f32_16x16x32_bf16 v[26:29], v[166:169], v[82:85], v[26:29]
ds_read_b128 v[146:149], v5 offset:3072
v_mfma_f32_16x16x32_bf16 v[30:33], v[170:173], v[82:85], v[30:33]
ds_read_b128 v[150:153], v5 offset:4096
s_waitcnt vmcnt(11) lgkmcnt(15)
v_mfma_f32_16x16x32_bf16 v[14:17], v[174:177], v[86:89], v[14:17]
ds_read_b128 v[154:157], v5 offset:5120
v_mfma_f32_16x16x32_bf16 v[18:21], v[178:181], v[86:89], v[18:21]
ds_read_b128 v[158:161], v5 offset:6144
v_mfma_f32_16x16x32_bf16 v[22:25], v[182:185], v[86:89], v[22:25]
ds_read_b128 v[162:165], v5 offset:7168
v_mfma_f32_16x16x32_bf16 v[26:29], v[186:189], v[86:89], v[26:29]
ds_read_b128 v[166:169], v5 offset:8192
v_mfma_f32_16x16x32_bf16 v[30:33], v[190:193], v[86:89], v[30:33]
ds_read_b128 v[170:173], v5 offset:9216
s_waitcnt vmcnt(10) lgkmcnt(15)
v_mfma_f32_16x16x32_bf16 v[14:17], v[194:197], v[90:93], v[14:17]
ds_read_b128 v[174:177], v5 offset:10240
v_mfma_f32_16x16x32_bf16 v[18:21], v[198:201], v[90:93], v[18:21]
ds_read_b128 v[178:181], v5 offset:11264
v_mfma_f32_16x16x32_bf16 v[22:25], v[202:205], v[90:93], v[22:25]
ds_read_b128 v[182:185], v5 offset:12288
v_mfma_f32_16x16x32_bf16 v[26:29], v[206:209], v[90:93], v[26:29]
ds_read_b128 v[186:189], v5 offset:13312
v_mfma_f32_16x16x32_bf16 v[30:33], v[210:213], v[90:93], v[30:33]
ds_read_b128 v[190:193], v5 offset:14336
s_waitcnt vmcnt(9) lgkmcnt(15)
v_mfma_f32_16x16x32_bf16 v[14:17], v[214:217], v[94:97], v[14:17]
ds_read_b128 v[194:197], v5 offset:15360
v_mfma_f32_16x16x32_bf16 v[18:21], v[218:221], v[94:97], v[18:21]
ds_read_b128 v[198:201], v5 offset:16384
v_mfma_f32_16x16x32_bf16 v[22:25], v[222:225], v[94:97], v[22:25]
ds_read_b128 v[202:205], v5 offset:17408
v_mfma_f32_16x16x32_bf16 v[26:29], v[226:229], v[94:97], v[26:29]
ds_read_b128 v[206:209], v5 offset:18432
v_mfma_f32_16x16x32_bf16 v[30:33], v[230:233], v[94:97], v[30:33]
ds_read_b128 v[210:213], v5 offset:19456
s_waitcnt vmcnt(8) lgkmcnt(15)
v_mfma_f32_16x16x32_bf16 v[14:17], v[234:237], v[98:101], v[14:17]
ds_read_b128 v[214:217], v5 offset:20480
v_mfma_f32_16x16x32_bf16 v[18:21], v[238:241], v[98:101], v[18:21]
ds_read_b128 v[218:221], v5 offset:21504
v_mfma_f32_16x16x32_bf16 v[22:25], v[242:245], v[98:101], v[22:25]
ds_read_b128 v[222:225], v5 offset:22528
v_mfma_f32_16x16x32_bf16 v[26:29], v[246:249], v[98:101], v[26:29]
ds_read_b128 v[226:229], v5 offset:23552
v_mfma_f32_16x16x32_bf16 v[30:33], v[250:253], v[98:101], v[30:33]
ds_read_b128 v[230:233], v5 offset:24576
s_waitcnt vmcnt(7) lgkmcnt(15)
v_mfma_f32_16x16x32_bf16 v[14:17], v[134:137], v[102:105], v[14:17]
ds_read_b128 v[234:237], v5 offset:25600
v_mfma_f32_16x16x32_bf16 v[18:21], v[138:141], v[102:105], v[18:21]
ds_read_b128 v[238:241], v5 offset:26624
v_mfma_f32_16x16x32_bf16 v[22:25], v[142:145], v[102:105], v[22:25]
ds_read_b128 v[242:245], v5 offset:27648
v_mfma_f32_16x16x32_bf16 v[26:29], v[146:149], v[102:105], v[26:29]
ds_read_b128 v[246:249], v5 offset:28672
v_mfma_f32_16x16x32_bf16 v[30:33], v[150:153], v[102:105], v[30:33]
ds_read_b128 v[250:253], v5 offset:29696
s_waitcnt vmcnt(6) lgkmcnt(15)
v_mfma_f32_16x16x32_bf16 v[14:17], v[154:157], v[106:109], v[14:17]
ds_read_b128 v[134:137], v5 offset:30720
v_mfma_f32_16x16x32_bf16 v[18:21], v[158:161], v[106:109], v[18:21]
ds_read_b128 v[138:141], v5 offset:31744
v_mfma_f32_16x16x32_bf16 v[22:25], v[162:165], v[106:109], v[22:25]
ds_read_b128 v[142:145], v5 offset:32768
v_mfma_f32_16x16x32_bf16 v[26:29], v[166:169], v[106:109], v[26:29]
ds_read_b128 v[146:149], v5 offset:33792
v_mfma_f32_16x16x32_bf16 v[30:33], v[170:173], v[106:109], v[30:33]
ds_read_b128 v[150:153], v5 offset:34816
s_waitcnt vmcnt(5) lgkmcnt(15)
v_mfma_f32_16x16x32_bf16 v[14:17], v[174:177], v[110:113], v[14:17]
ds_read_b128 v[154:157], v5 offset:35840
v_mfma_f32_16x16x32_bf16 v[18:21], v[178:181], v[110:113], v[18:21]
ds_read_b128 v[158:161], v5 offset:36864
v_mfma_f32_16x16x32_bf16 v[22:25], v[182:185], v[110:113], v[22:25]
ds_read_b128 v[162:165], v5 offset:37888
v_mfma_f32_16x16x32_bf16 v[26:29], v[186:189], v[110:113], v[26:29]
ds_read_b128 v[166:169], v5 offset:38912
v_mfma_f32_16x16x32_bf16 v[30:33], v[190:193], v[110:113], v[30:33]
ds_read_b128 v[170:173], v5 offset:39936
s_waitcnt vmcnt(4) lgkmcnt(15)
v_mfma_f32_16x16x32_bf16 v[14:17], v[194:197], v[114:117], v[14:17]
v_mfma_f32_16x16x32_bf16 v[18:21], v[198:201], v[114:117], v[18:21]
v_mfma_f32_16x16x32_bf16 v[22:25], v[202:205], v[114:117], v[22:25]
v_mfma_f32_16x16x32_bf16 v[26:29], v[206:209], v[114:117], v[26:29]
v_mfma_f32_16x16x32_bf16 v[30:33], v[210:213], v[114:117], v[30:33]
s_waitcnt vmcnt(3) lgkmcnt(15)
v_mfma_f32_16x16x32_bf16 v[14:17], v[214:217], v[118:121], v[14:17]
v_mfma_f32_16x16x32_bf16 v[18:21], v[218:221], v[118:121], v[18:21]
v_mfma_f32_16x16x32_bf16 v[22:25], v[222:225], v[118:121], v[22:25]
v_mfma_f32_16x16x32_bf16 v[26:29], v[226:229], v[118:121], v[26:29]
v_mfma_f32_16x16x32_bf16 v[30:33], v[230:233], v[118:121], v[30:33]
s_waitcnt vmcnt(2) lgkmcnt(10)
v_mfma_f32_16x16x32_bf16 v[14:17], v[234:237], v[122:125], v[14:17]
v_mfma_f32_16x16x32_bf16 v[18:21], v[238:241], v[122:125], v[18:21]
v_mfma_f32_16x16x32_bf16 v[22:25], v[242:245], v[122:125], v[22:25]
v_mfma_f32_16x16x32_bf16 v[26:29], v[246:249], v[122:125], v[26:29]
v_mfma_f32_16x16x32_bf16 v[30:33], v[250:253], v[122:125], v[30:33]
s_waitcnt vmcnt(1) lgkmcnt(5)
v_mfma_f32_16x16x32_bf16 v[14:17], v[134:137], v[126:129], v[14:17]
v_mfma_f32_16x16x32_bf16 v[18:21], v[138:141], v[126:129], v[18:21]
v_mfma_f32_16x16x32_bf16 v[22:25], v[142:145], v[126:129], v[22:25]
v_mfma_f32_16x16x32_bf16 v[26:29], v[146:149], v[126:129], v[26:29]
v_mfma_f32_16x16x32_bf16 v[30:33], v[150:153], v[126:129], v[30:33]
s_waitcnt vmcnt(0) lgkmcnt(0)
s_barrier
v_mfma_f32_16x16x32_bf16 v[14:17], v[154:157], v[130:133], v[14:17]
v_mfma_f32_16x16x32_bf16 v[18:21], v[158:161], v[130:133], v[18:21]
v_mfma_f32_16x16x32_bf16 v[22:25], v[162:165], v[130:133], v[22:25]
v_mfma_f32_16x16x32_bf16 v[26:29], v[166:169], v[130:133], v[26:29]
v_mfma_f32_16x16x32_bf16 v[30:33], v[170:173], v[130:133], v[30:33]
s_add_u32 s67, s64, 10485760
s_add_u32 s67, s67, s7
s_lshl_b32 s80, s13, 3
s_add_u32 s80, s80, s6
s_lshl_b32 s80, s80, 2
s_add_u32 s80, s80, 51798016
s_add_u32 s81, s8, 3
v_mov_b32 v1, 0
v_mov_b32 v2, s81
v_pk_add_f32 v[14:15], v[14:15], v[34:35]
v_cvt_pk_bf16_f32 v60, v14, v15
v_pk_add_f32 v[16:17], v[16:17], v[36:37]
v_cvt_pk_bf16_f32 v61, v16, v17
v_pk_add_f32 v[18:19], v[18:19], v[38:39]
v_cvt_pk_bf16_f32 v62, v18, v19
v_pk_add_f32 v[20:21], v[20:21], v[40:41]
v_cvt_pk_bf16_f32 v63, v20, v21
v_pk_add_f32 v[22:23], v[22:23], v[42:43]
v_cvt_pk_bf16_f32 v64, v22, v23
v_pk_add_f32 v[24:25], v[24:25], v[44:45]
v_cvt_pk_bf16_f32 v65, v24, v25
v_pk_add_f32 v[26:27], v[26:27], v[46:47]
v_cvt_pk_bf16_f32 v66, v26, v27
v_pk_add_f32 v[28:29], v[28:29], v[48:49]
v_cvt_pk_bf16_f32 v67, v28, v29
v_pk_add_f32 v[30:31], v[30:31], v[50:51]
v_cvt_pk_bf16_f32 v68, v30, v31
v_pk_add_f32 v[32:33], v[32:33], v[52:53]
v_cvt_pk_bf16_f32 v69, v32, v33
buffer_store_dwordx4 v[60:63], v10, s[36:39], s67 offen sc1
buffer_store_dwordx4 v[64:67], v10, s[36:39], s67 offen offset:2048 sc1
buffer_store_dwordx2 v[68:69], v11, s[36:39], s67 offen offset:0 sc1
v_pk_add_f32 v[72:73], v[14:15], v[16:17]
v_pk_mul_f32 v[74:75], v[14:15], v[14:15]
v_pk_fma_f32 v[74:75], v[16:17], v[16:17], v[74:75]
v_pk_add_f32 v[72:73], v[72:73], v[18:19]
v_pk_fma_f32 v[74:75], v[18:19], v[18:19], v[74:75]
v_pk_add_f32 v[72:73], v[72:73], v[20:21]
v_pk_fma_f32 v[74:75], v[20:21], v[20:21], v[74:75]
v_pk_add_f32 v[72:73], v[72:73], v[22:23]
v_pk_fma_f32 v[74:75], v[22:23], v[22:23], v[74:75]
v_pk_add_f32 v[72:73], v[72:73], v[24:25]
v_pk_fma_f32 v[74:75], v[24:25], v[24:25], v[74:75]
v_pk_add_f32 v[72:73], v[72:73], v[26:27]
v_pk_fma_f32 v[74:75], v[26:27], v[26:27], v[74:75]
v_pk_add_f32 v[72:73], v[72:73], v[28:29]
v_pk_fma_f32 v[74:75], v[28:29], v[28:29], v[74:75]
v_pk_add_f32 v[72:73], v[72:73], v[30:31]
v_pk_fma_f32 v[74:75], v[30:31], v[30:31], v[74:75]
v_pk_add_f32 v[72:73], v[72:73], v[32:33]
v_pk_fma_f32 v[74:75], v[32:33], v[32:33], v[74:75]
v_add_f32 v72, v72, v73
v_add_f32 v73, v74, v75
s_lshr_b32 s67, s61, 1
s_lshl_b32 s67, s67, 10
v_permlane32_swap_b32 v72, v73
s_and_b32 s68, s61, 1
s_lshl_b32 s68, s68, 3
v_add_f32 v72, v72, v73
v_mov_b32 v73, v72
s_add_u32 s67, s67, s68
s_add_u32 s67, s67, s72
v_permlane16_swap_b32 v72, v73
s_add_u32 s67, s67, 22020096
v_lshrrev_b32 v8, 5, v0
v_lshlrev_b32 v8, 2, v8
v_lshl_add_u32 v8, v3, 4, v8
v_add_f32 v72, v72, v73
buffer_store_dword v72, v8, s[36:39], s67 offen sc1
s_waitcnt vmcnt(1)
s_mov_b64 exec, 1
buffer_store_dword v2, v1, s[36:39], s80 offen sc1
s_mov_b64 exec, -1
s_barrier
v_add_u32 v253, 1, v2
v_mov_b32 v252, 0
s_mov_b32 s100, s80
s_or_b32 s67, s6, s61
s_or_b32 s67, s67, s3
s_cbranch_scc1 fk_215
s_lshl_b32 s67, s13, 7
s_add_u32 s67, s67, 22282280
s_mov_b64 exec, 1
buffer_store_dword v2, v1, s[36:39], s67 offen sc1
s_mov_b64 exec, -1
fk_215:
s_lshr_b32 s60, s13, 4
s_and_b32 s61, s5, 15
s_and_b32 s62, s6, 1
s_lshr_b32 s63, s6, 1
s_lshl_b32 s64, s60, 1
s_add_u32 s64, s64, s62
s_mul_i32 s66, s61, 96
s_mul_i32 s65, s63, 48
s_add_u32 s66, s66, s65
s_mul_i32 s65, s13, 768
s_mul_i32 s67, s63, 384
s_add_u32 s65, s65, s67
s_add_u32 s73, s65, 51470336
v_lshrrev_b32 v12, 4, v0
v_lshlrev_b32 v7, 4, v12
v_and_b32 v13, 15, v0
v_lshlrev_b32 v3, 4, v13
v_lshl_add_u32 v3, v12, 9, v3
s_lshl_b32 s65, s62, 13
v_add_u32 v3, s65, v3
v_lshlrev_b32 v11, 4, v0
s_mul_i32 s65, s63, 6144
s_add_u32 s65, s65, 65536
v_add_u32 v4, s65, v11
v_add_u32 v5, 49152, v4
v_lshlrev_b32 v6, 2, v13
s_mul_i32 s71, s64, 196608
s_lshl_b32 s67, s66, 6
s_add_u32 s71, s71, s67
s_add_u32 s71, s71, s7
s_add_u32 s71, s71, 15728640
s_add_u32 s72, s71, 98304
s_lshl_b32 s80, s13, 3
s_add_u32 s80, s80, s6
s_lshl_b32 s80, s80, 2
s_add_u32 s80, s80, 51798016
s_add_u32 s81, s8, 5
v_mov_b32 v1, 0
v_mov_b32 v2, s81
s_lshl_b32 s65, s64, 12
s_add_u32 s65, s65, s7
s_add_u32 s65, s65, 22020096
s_waitcnt vmcnt(0)
s_mov_b64 exec, 1
buffer_store_dword v253, v252, s[36:39], s100 offen sc1
s_mov_b64 exec, -1
s_barrier
ds_read_b128 v[16:19], v3 offset:0
ds_read_b128 v[20:23], v3 offset:256
ds_read_b128 v[24:27], v3 offset:4096
ds_read_b128 v[28:31], v3 offset:4352
ds_read_b128 v[32:35], v5 offset:24576
ds_read_b128 v[36:39], v5 offset:25600
ds_read_b128 v[40:43], v5 offset:26624
ds_read_b128 v[44:47], v5 offset:27648
ds_read_b128 v[48:51], v5 offset:28672
ds_read_b128 v[52:55], v5 offset:29696
s_waitcnt lgkmcnt(0)
v_mfma_f32_16x16x32_bf16 v[96:99], v[32:35], v[16:19], 0
ds_read_b128 v[56:59], v3 offset:2048
v_mfma_f32_16x16x32_bf16 v[100:103], v[32:35], v[20:23], 0
ds_read_b128 v[60:63], v3 offset:2304
v_mfma_f32_16x16x32_bf16 v[104:107], v[32:35], v[24:27], 0
ds_read_b128 v[64:67], v3 offset:6144
v_mfma_f32_16x16x32_bf16 v[108:111], v[32:35], v[28:31], 0
ds_read_b128 v[68:71], v3 offset:6400
v_mfma_f32_16x16x32_bf16 v[112:115], v[36:39], v[16:19], 0
ds_read_b128 v[72:75], v5 offset:36864
v_mfma_f32_16x16x32_bf16 v[116:119], v[36:39], v[20:23], 0
ds_read_b128 v[76:79], v5 offset:37888
v_mfma_f32_16x16x32_bf16 v[120:123], v[36:39], v[24:27], 0
ds_read_b128 v[80:83], v5 offset:38912
v_mfma_f32_16x16x32_bf16 v[124:127], v[36:39], v[28:31], 0
ds_read_b128 v[84:87], v5 offset:39936
v_mfma_f32_16x16x32_bf16 v[128:131], v[40:43], v[16:19], 0
ds_read_b128 v[88:91], v5 offset:40960
v_mfma_f32_16x16x32_bf16 v[132:135], v[40:43], v[20:23], 0
ds_read_b128 v[92:95], v5 offset:41984
v_mfma_f32_16x16x32_bf16 v[136:139], v[40:43], v[24:27], 0
v_mfma_f32_16x16x32_bf16 v[140:143], v[40:43], v[28:31], 0
v_mfma_f32_16x16x32_bf16 v[144:147], v[44:47], v[16:19], 0
v_mfma_f32_16x16x32_bf16 v[148:151], v[44:47], v[20:23], 0
v_mfma_f32_16x16x32_bf16 v[152:155], v[44:47], v[24:27], 0
v_mfma_f32_16x16x32_bf16 v[156:159], v[44:47], v[28:31], 0
v_mfma_f32_16x16x32_bf16 v[160:163], v[48:51], v[16:19], 0
v_mfma_f32_16x16x32_bf16 v[164:167], v[48:51], v[20:23], 0
v_mfma_f32_16x16x32_bf16 v[168:171], v[48:51], v[24:27], 0
v_mfma_f32_16x16x32_bf16 v[172:175], v[48:51], v[28:31], 0
v_mfma_f32_16x16x32_bf16 v[176:179], v[52:55], v[16:19], 0
v_mfma_f32_16x16x32_bf16 v[180:183], v[52:55], v[20:23], 0
v_mfma_f32_16x16x32_bf16 v[184:187], v[52:55], v[24:27], 0
s_waitcnt lgkmcnt(0)
v_mfma_f32_16x16x32_bf16 v[188:191], v[52:55], v[28:31], 0
s_barrier
v_mfma_f32_16x16x32_bf16 v[96:99], v[72:75], v[56:59], v[96:99]
ds_read_b128 v[16:19], v3 offset:16384
v_mfma_f32_16x16x32_bf16 v[100:103], v[72:75], v[60:63], v[100:103]
ds_read_b128 v[20:23], v3 offset:16640
v_mfma_f32_16x16x32_bf16 v[104:107], v[72:75], v[64:67], v[104:107]
ds_read_b128 v[24:27], v3 offset:20480
v_mfma_f32_16x16x32_bf16 v[108:111], v[72:75], v[68:71], v[108:111]
ds_read_b128 v[28:31], v3 offset:20736
v_mfma_f32_16x16x32_bf16 v[112:115], v[76:79], v[56:59], v[112:115]
ds_read_b128 v[32:35], v5 offset:0
v_mfma_f32_16x16x32_bf16 v[116:119], v[76:79], v[60:63], v[116:119]
ds_read_b128 v[36:39], v5 offset:1024
v_mfma_f32_16x16x32_bf16 v[120:123], v[76:79], v[64:67], v[120:123]
ds_read_b128 v[40:43], v5 offset:2048
v_mfma_f32_16x16x32_bf16 v[124:127], v[76:79], v[68:71], v[124:127]
ds_read_b128 v[44:47], v5 offset:3072
v_mfma_f32_16x16x32_bf16 v[128:131], v[80:83], v[56:59], v[128:131]
ds_read_b128 v[48:51], v5 offset:4096
v_mfma_f32_16x16x32_bf16 v[132:135], v[80:83], v[60:63], v[132:135]
ds_read_b128 v[52:55], v5 offset:5120
v_mfma_f32_16x16x32_bf16 v[136:139], v[80:83], v[64:67], v[136:139]
v_mfma_f32_16x16x32_bf16 v[140:143], v[80:83], v[68:71], v[140:143]
buffer_load_dwordx4 v[192:195], v7, s[36:39], s73 offen offset:0 sc1
v_mfma_f32_16x16x32_bf16 v[144:147], v[84:87], v[56:59], v[144:147]
v_mfma_f32_16x16x32_bf16 v[148:151], v[84:87], v[60:63], v[148:151]
buffer_load_dwordx4 v[196:199], v7, s[36:39], s73 offen offset:64 sc1
v_mfma_f32_16x16x32_bf16 v[152:155], v[84:87], v[64:67], v[152:155]
v_mfma_f32_16x16x32_bf16 v[156:159], v[84:87], v[68:71], v[156:159]
buffer_load_dwordx4 v[200:203], v7, s[36:39], s73 offen offset:128 sc1
v_mfma_f32_16x16x32_bf16 v[160:163], v[88:91], v[56:59], v[160:163]
v_mfma_f32_16x16x32_bf16 v[164:167], v[88:91], v[60:63], v[164:167]
buffer_load_dwordx4 v[204:207], v7, s[36:39], s73 offen offset:192 sc1
v_mfma_f32_16x16x32_bf16 v[168:171], v[88:91], v[64:67], v[168:171]
v_mfma_f32_16x16x32_bf16 v[172:175], v[88:91], v[68:71], v[172:175]
buffer_load_dwordx4 v[208:211], v7, s[36:39], s73 offen offset:256 sc1
v_mfma_f32_16x16x32_bf16 v[176:179], v[92:95], v[56:59], v[176:179]
v_mfma_f32_16x16x32_bf16 v[180:183], v[92:95], v[60:63], v[180:183]
buffer_load_dwordx4 v[212:215], v7, s[36:39], s73 offen offset:320 sc1
v_mfma_f32_16x16x32_bf16 v[184:187], v[92:95], v[64:67], v[184:187]
v_mfma_f32_16x16x32_bf16 v[188:191], v[92:95], v[68:71], v[188:191]
s_waitcnt lgkmcnt(0)
v_mfma_f32_16x16x32_bf16 v[96:99], v[32:35], v[16:19], v[96:99]
ds_read_b128 v[56:59], v3 offset:18432
v_mfma_f32_16x16x32_bf16 v[100:103], v[32:35], v[20:23], v[100:103]
ds_read_b128 v[60:63], v3 offset:18688
v_mfma_f32_16x16x32_bf16 v[104:107], v[32:35], v[24:27], v[104:107]
ds_read_b128 v[64:67], v3 offset:22528
v_mfma_f32_16x16x32_bf16 v[108:111], v[32:35], v[28:31], v[108:111]
ds_read_b128 v[68:71], v3 offset:22784
v_mfma_f32_16x16x32_bf16 v[112:115], v[36:39], v[16:19], v[112:115]
ds_read_b128 v[72:75], v5 offset:12288
v_mfma_f32_16x16x32_bf16 v[116:119], v[36:39], v[20:23], v[116:119]
ds_read_b128 v[76:79], v5 offset:13312
v_mfma_f32_16x16x32_bf16 v[120:123], v[36:39], v[24:27], v[120:123]
ds_read_b128 v[80:83], v5 offset:14336
v_mfma_f32_16x16x32_bf16 v[124:127], v[36:39], v[28:31], v[124:127]
ds_read_b128 v[84:87], v5 offset:15360
v_mfma_f32_16x16x32_bf16 v[128:131], v[40:43], v[16:19], v[128:131]
ds_read_b128 v[88:91], v5 offset:16384
v_mfma_f32_16x16x32_bf16 v[132:135], v[40:43], v[20:23], v[132:135]
ds_read_b128 v[92:95], v5 offset:17408
v_mfma_f32_16x16x32_bf16 v[136:139], v[40:43], v[24:27], v[136:139]
v_mfma_f32_16x16x32_bf16 v[140:143], v[40:43], v[28:31], v[140:143]
v_mfma_f32_16x16x32_bf16 v[144:147], v[44:47], v[16:19], v[144:147]
v_mfma_f32_16x16x32_bf16 v[148:151], v[44:47], v[20:23], v[148:151]
v_mfma_f32_16x16x32_bf16 v[152:155], v[44:47], v[24:27], v[152:155]
v_mfma_f32_16x16x32_bf16 v[156:159], v[44:47], v[28:31], v[156:159]
v_mfma_f32_16x16x32_bf16 v[160:163], v[48:51], v[16:19], v[160:163]
v_mfma_f32_16x16x32_bf16 v[164:167], v[48:51], v[20:23], v[164:167]
v_mfma_f32_16x16x32_bf16 v[168:171], v[48:51], v[24:27], v[168:171]
v_mfma_f32_16x16x32_bf16 v[172:175], v[48:51], v[28:31], v[172:175]
v_mfma_f32_16x16x32_bf16 v[176:179], v[52:55], v[16:19], v[176:179]
v_mfma_f32_16x16x32_bf16 v[180:183], v[52:55], v[20:23], v[180:183]
v_mfma_f32_16x16x32_bf16 v[184:187], v[52:55], v[24:27], v[184:187]
s_waitcnt lgkmcnt(0)
v_mfma_f32_16x16x32_bf16 v[188:191], v[52:55], v[28:31], v[188:191]
s_barrier
v_mfma_f32_16x16x32_bf16 v[96:99], v[72:75], v[56:59], v[96:99]
ds_read_b128 v[16:19], v3 offset:32768
v_mfma_f32_16x16x32_bf16 v[100:103], v[72:75], v[60:63], v[100:103]
ds_read_b128 v[20:23], v3 offset:33024
v_mfma_f32_16x16x32_bf16 v[104:107], v[72:75], v[64:67], v[104:107]
ds_read_b128 v[24:27], v3 offset:36864
v_mfma_f32_16x16x32_bf16 v[108:111], v[72:75], v[68:71], v[108:111]
ds_read_b128 v[28:31], v3 offset:37120
v_mfma_f32_16x16x32_bf16 v[112:115], v[76:79], v[56:59], v[112:115]
ds_read_b128 v[32:35], v4 offset:24576
v_mfma_f32_16x16x32_bf16 v[116:119], v[76:79], v[60:63], v[116:119]
ds_read_b128 v[36:39], v4 offset:25600
v_mfma_f32_16x16x32_bf16 v[120:123], v[76:79], v[64:67], v[120:123]
ds_read_b128 v[40:43], v4 offset:26624
v_mfma_f32_16x16x32_bf16 v[124:127], v[76:79], v[68:71], v[124:127]
ds_read_b128 v[44:47], v4 offset:27648
v_mfma_f32_16x16x32_bf16 v[128:131], v[80:83], v[56:59], v[128:131]
ds_read_b128 v[48:51], v4 offset:28672
v_mfma_f32_16x16x32_bf16 v[132:135], v[80:83], v[60:63], v[132:135]
ds_read_b128 v[52:55], v4 offset:29696
v_mfma_f32_16x16x32_bf16 v[136:139], v[80:83], v[64:67], v[136:139]
v_mfma_f32_16x16x32_bf16 v[140:143], v[80:83], v[68:71], v[140:143]
v_mfma_f32_16x16x32_bf16 v[144:147], v[84:87], v[56:59], v[144:147]
buffer_load_dwordx4 v[216:219], v11, s[36:39], s65 offen offset:0 sc1
v_mfma_f32_16x16x32_bf16 v[148:151], v[84:87], v[60:63], v[148:151]
v_mfma_f32_16x16x32_bf16 v[152:155], v[84:87], v[64:67], v[152:155]
v_mfma_f32_16x16x32_bf16 v[156:159], v[84:87], v[68:71], v[156:159]
buffer_load_dwordx4 v[220:223], v11, s[36:39], s65 offen offset:1024 sc1
v_mfma_f32_16x16x32_bf16 v[160:163], v[88:91], v[56:59], v[160:163]
v_mfma_f32_16x16x32_bf16 v[164:167], v[88:91], v[60:63], v[164:167]
v_mfma_f32_16x16x32_bf16 v[168:171], v[88:91], v[64:67], v[168:171]
buffer_load_dwordx4 v[224:227], v11, s[36:39], s65 offen offset:2048 sc1
v_mfma_f32_16x16x32_bf16 v[172:175], v[88:91], v[68:71], v[172:175]
v_mfma_f32_16x16x32_bf16 v[176:179], v[92:95], v[56:59], v[176:179]
v_mfma_f32_16x16x32_bf16 v[180:183], v[92:95], v[60:63], v[180:183]
buffer_load_dwordx4 v[228:231], v11, s[36:39], s65 offen offset:3072 sc1
v_mfma_f32_16x16x32_bf16 v[184:187], v[92:95], v[64:67], v[184:187]
v_mfma_f32_16x16x32_bf16 v[188:191], v[92:95], v[68:71], v[188:191]
s_waitcnt lgkmcnt(0)
v_mfma_f32_16x16x32_bf16 v[96:99], v[32:35], v[16:19], v[96:99]
ds_read_b128 v[56:59], v3 offset:34816
v_mfma_f32_16x16x32_bf16 v[100:103], v[32:35], v[20:23], v[100:103]
ds_read_b128 v[60:63], v3 offset:35072
v_mfma_f32_16x16x32_bf16 v[104:107], v[32:35], v[24:27], v[104:107]
ds_read_b128 v[64:67], v3 offset:38912
v_mfma_f32_16x16x32_bf16 v[108:111], v[32:35], v[28:31], v[108:111]
ds_read_b128 v[68:71], v3 offset:39168
v_mfma_f32_16x16x32_bf16 v[112:115], v[36:39], v[16:19], v[112:115]
ds_read_b128 v[72:75], v4 offset:36864
v_mfma_f32_16x16x32_bf16 v[116:119], v[36:39], v[20:23], v[116:119]
ds_read_b128 v[76:79], v4 offset:37888
v_mfma_f32_16x16x32_bf16 v[120:123], v[36:39], v[24:27], v[120:123]
ds_read_b128 v[80:83], v4 offset:38912
v_mfma_f32_16x16x32_bf16 v[124:127], v[36:39], v[28:31], v[124:127]
ds_read_b128 v[84:87], v4 offset:39936
v_mfma_f32_16x16x32_bf16 v[128:131], v[40:43], v[16:19], v[128:131]
ds_read_b128 v[88:91], v4 offset:40960
v_mfma_f32_16x16x32_bf16 v[132:135], v[40:43], v[20:23], v[132:135]
ds_read_b128 v[92:95], v4 offset:41984
v_mfma_f32_16x16x32_bf16 v[136:139], v[40:43], v[24:27], v[136:139]
v_mfma_f32_16x16x32_bf16 v[140:143], v[40:43], v[28:31], v[140:143]
v_mfma_f32_16x16x32_bf16 v[144:147], v[44:47], v[16:19], v[144:147]
v_mfma_f32_16x16x32_bf16 v[148:151], v[44:47], v[20:23], v[148:151]
v_mfma_f32_16x16x32_bf16 v[152:155], v[44:47], v[24:27], v[152:155]
v_mfma_f32_16x16x32_bf16 v[156:159], v[44:47], v[28:31], v[156:159]
v_mfma_f32_16x16x32_bf16 v[160:163], v[48:51], v[16:19], v[160:163]
v_mfma_f32_16x16x32_bf16 v[164:167], v[48:51], v[20:23], v[164:167]
v_mfma_f32_16x16x32_bf16 v[168:171], v[48:51], v[24:27], v[168:171]
v_mfma_f32_16x16x32_bf16 v[172:175], v[48:51], v[28:31], v[172:175]
v_mfma_f32_16x16x32_bf16 v[176:179], v[52:55], v[16:19], v[176:179]
v_mfma_f32_16x16x32_bf16 v[180:183], v[52:55], v[20:23], v[180:183]
v_mfma_f32_16x16x32_bf16 v[184:187], v[52:55], v[24:27], v[184:187]
s_waitcnt lgkmcnt(0)
v_mfma_f32_16x16x32_bf16 v[188:191], v[52:55], v[28:31], v[188:191]
s_barrier
v_mfma_f32_16x16x32_bf16 v[96:99], v[72:75], v[56:59], v[96:99]
ds_read_b128 v[16:19], v3 offset:49152
v_mfma_f32_16x16x32_bf16 v[100:103], v[72:75], v[60:63], v[100:103]
ds_read_b128 v[20:23], v3 offset:49408
v_mfma_f32_16x16x32_bf16 v[104:107], v[72:75], v[64:67], v[104:107]
ds_read_b128 v[24:27], v3 offset:53248
v_mfma_f32_16x16x32_bf16 v[108:111], v[72:75], v[68:71], v[108:111]
ds_read_b128 v[28:31], v3 offset:53504
v_mfma_f32_16x16x32_bf16 v[112:115], v[76:79], v[56:59], v[112:115]
ds_read_b128 v[32:35], v4 offset:0
v_mfma_f32_16x16x32_bf16 v[116:119], v[76:79], v[60:63], v[116:119]
ds_read_b128 v[36:39], v4 offset:1024
v_mfma_f32_16x16x32_bf16 v[120:123], v[76:79], v[64:67], v[120:123]
ds_read_b128 v[40:43], v4 offset:2048
v_mfma_f32_16x16x32_bf16 v[124:127], v[76:79], v[68:71], v[124:127]
ds_read_b128 v[44:47], v4 offset:3072
v_mfma_f32_16x16x32_bf16 v[128:131], v[80:83], v[56:59], v[128:131]
ds_read_b128 v[48:51], v4 offset:4096
v_mfma_f32_16x16x32_bf16 v[132:135], v[80:83], v[60:63], v[132:135]
ds_read_b128 v[52:55], v4 offset:5120
v_mfma_f32_16x16x32_bf16 v[136:139], v[80:83], v[64:67], v[136:139]
s_waitcnt vmcnt(0)
v_mfma_f32_16x16x32_bf16 v[140:143], v[80:83], v[68:71], v[140:143]
v_add_f32 v216, v216, v218
v_mfma_f32_16x16x32_bf16 v[144:147], v[84:87], v[56:59], v[144:147]
v_add_f32 v216, v216, v220
v_mfma_f32_16x16x32_bf16 v[148:151], v[84:87], v[60:63], v[148:151]
v_add_f32 v216, v216, v222
v_mfma_f32_16x16x32_bf16 v[152:155], v[84:87], v[64:67], v[152:155]
v_add_f32 v216, v216, v224
v_mfma_f32_16x16x32_bf16 v[156:159], v[84:87], v[68:71], v[156:159]
v_add_f32 v216, v216, v226
v_mfma_f32_16x16x32_bf16 v[160:163], v[88:91], v[56:59], v[160:163]
v_add_f32 v216, v216, v228
v_mfma_f32_16x16x32_bf16 v[164:167], v[88:91], v[60:63], v[164:167]
v_add_f32 v216, v216, v230
v_mfma_f32_16x16x32_bf16 v[168:171], v[88:91], v[64:67], v[168:171]
v_mul_f32 v232, 0xbacccccd, v216
v_mfma_f32_16x16x32_bf16 v[172:175], v[88:91], v[68:71], v[172:175]
v_mul_f32 v233, 0xbacccccd, v216
v_mfma_f32_16x16x32_bf16 v[176:179], v[92:95], v[56:59], v[176:179]
s_nop 0
v_mfma_f32_16x16x32_bf16 v[180:183], v[92:95], v[60:63], v[180:183]
v_permlane16_swap_b32 v232, v233
v_mfma_f32_16x16x32_bf16 v[184:187], v[92:95], v[64:67], v[184:187]
v_mov_b32 v234, v232
v_mfma_f32_16x16x32_bf16 v[188:191], v[92:95], v[68:71], v[188:191]
s_waitcnt lgkmcnt(0)
v_mfma_f32_16x16x32_bf16 v[96:99], v[32:35], v[16:19], v[96:99]
ds_read_b128 v[56:59], v3 offset:51200
v_mfma_f32_16x16x32_bf16 v[100:103], v[32:35], v[20:23], v[100:103]
ds_read_b128 v[60:63], v3 offset:51456
v_mfma_f32_16x16x32_bf16 v[104:107], v[32:35], v[24:27], v[104:107]
ds_read_b128 v[64:67], v3 offset:55296
v_mfma_f32_16x16x32_bf16 v[108:111], v[32:35], v[28:31], v[108:111]
ds_read_b128 v[68:71], v3 offset:55552
v_mfma_f32_16x16x32_bf16 v[112:115], v[36:39], v[16:19], v[112:115]
ds_read_b128 v[72:75], v4 offset:12288
v_mfma_f32_16x16x32_bf16 v[116:119], v[36:39], v[20:23], v[116:119]
ds_read_b128 v[76:79], v4 offset:13312
v_mfma_f32_16x16x32_bf16 v[120:123], v[36:39], v[24:27], v[120:123]
ds_read_b128 v[80:83], v4 offset:14336
v_mfma_f32_16x16x32_bf16 v[124:127], v[36:39], v[28:31], v[124:127]
ds_read_b128 v[84:87], v4 offset:15360
v_mfma_f32_16x16x32_bf16 v[128:131], v[40:43], v[16:19], v[128:131]
ds_read_b128 v[88:91], v4 offset:16384
v_mfma_f32_16x16x32_bf16 v[132:135], v[40:43], v[20:23], v[132:135]
ds_read_b128 v[92:95], v4 offset:17408
v_mfma_f32_16x16x32_bf16 v[136:139], v[40:43], v[24:27], v[136:139]
v_mov_b32 v235, v233
v_mfma_f32_16x16x32_bf16 v[140:143], v[40:43], v[28:31], v[140:143]
s_nop 0
v_mfma_f32_16x16x32_bf16 v[144:147], v[44:47], v[16:19], v[144:147]
v_permlane32_swap_b32 v232, v234
v_mfma_f32_16x16x32_bf16 v[148:151], v[44:47], v[20:23], v[148:151]
v_permlane32_swap_b32 v233, v235
v_mfma_f32_16x16x32_bf16 v[152:155], v[44:47], v[24:27], v[152:155]
v_mfma_f32_16x16x32_bf16 v[156:159], v[44:47], v[28:31], v[156:159]
v_mfma_f32_16x16x32_bf16 v[160:163], v[48:51], v[16:19], v[160:163]
v_mfma_f32_16x16x32_bf16 v[164:167], v[48:51], v[20:23], v[164:167]
v_mfma_f32_16x16x32_bf16 v[168:171], v[48:51], v[24:27], v[168:171]
v_mfma_f32_16x16x32_bf16 v[172:175], v[48:51], v[28:31], v[172:175]
v_mfma_f32_16x16x32_bf16 v[176:179], v[52:55], v[16:19], v[176:179]
v_mfma_f32_16x16x32_bf16 v[180:183], v[52:55], v[20:23], v[180:183]
v_mfma_f32_16x16x32_bf16 v[184:187], v[52:55], v[24:27], v[184:187]
s_waitcnt lgkmcnt(0)
v_mfma_f32_16x16x32_bf16 v[188:191], v[52:55], v[28:31], v[188:191]
s_barrier
v_mfma_f32_16x16x32_bf16 v[96:99], v[72:75], v[56:59], v[96:99]
ds_read_b128 v[16:19], v3 offset:0
v_mfma_f32_16x16x32_bf16 v[100:103], v[72:75], v[60:63], v[100:103]
ds_read_b128 v[20:23], v3 offset:256
v_mfma_f32_16x16x32_bf16 v[104:107], v[72:75], v[64:67], v[104:107]
ds_read_b128 v[24:27], v3 offset:4096
v_mfma_f32_16x16x32_bf16 v[108:111], v[72:75], v[68:71], v[108:111]
ds_read_b128 v[28:31], v3 offset:4352
v_mfma_f32_16x16x32_bf16 v[112:115], v[76:79], v[56:59], v[112:115]
ds_read_b128 v[32:35], v5 offset:24576
v_mfma_f32_16x16x32_bf16 v[116:119], v[76:79], v[60:63], v[116:119]
ds_read_b128 v[36:39], v5 offset:25600
v_mfma_f32_16x16x32_bf16 v[120:123], v[76:79], v[64:67], v[120:123]
ds_read_b128 v[40:43], v5 offset:26624
v_mfma_f32_16x16x32_bf16 v[124:127], v[76:79], v[68:71], v[124:127]
ds_read_b128 v[44:47], v5 offset:27648
v_mfma_f32_16x16x32_bf16 v[128:131], v[80:83], v[56:59], v[128:131]
ds_read_b128 v[48:51], v5 offset:28672
v_mfma_f32_16x16x32_bf16 v[132:135], v[80:83], v[60:63], v[132:135]
ds_read_b128 v[52:55], v5 offset:29696
v_mfma_f32_16x16x32_bf16 v[136:139], v[80:83], v[64:67], v[136:139]
v_fmac_f32 v148, v233, v204
v_mfma_f32_16x16x32_bf16 v[140:143], v[80:83], v[68:71], v[140:143]
v_fmac_f32 v152, v234, v204
v_mfma_f32_16x16x32_bf16 v[144:147], v[84:87], v[56:59], v[144:147]
v_fmac_f32 v156, v235, v204
v_mfma_f32_16x16x32_bf16 v[148:151], v[84:87], v[60:63], v[148:151]
v_fmac_f32 v160, v232, v208
v_mfma_f32_16x16x32_bf16 v[152:155], v[84:87], v[64:67], v[152:155]
v_fmac_f32 v164, v233, v208
v_mfma_f32_16x16x32_bf16 v[156:159], v[84:87], v[68:71], v[156:159]
v_fmac_f32 v168, v234, v208
v_mfma_f32_16x16x32_bf16 v[160:163], v[88:91], v[56:59], v[160:163]
v_fmac_f32 v172, v235, v208
v_mfma_f32_16x16x32_bf16 v[164:167], v[88:91], v[60:63], v[164:167]
v_fmac_f32 v176, v232, v212
v_mfma_f32_16x16x32_bf16 v[168:171], v[88:91], v[64:67], v[168:171]
v_fmac_f32 v180, v233, v212
v_mfma_f32_16x16x32_bf16 v[172:175], v[88:91], v[68:71], v[172:175]
v_fmac_f32 v184, v234, v212
v_mfma_f32_16x16x32_bf16 v[176:179], v[92:95], v[56:59], v[176:179]
v_fmac_f32 v188, v235, v212
v_mfma_f32_16x16x32_bf16 v[180:183], v[92:95], v[60:63], v[180:183]
v_fmac_f32 v96, v232, v192
v_mfma_f32_16x16x32_bf16 v[184:187], v[92:95], v[64:67], v[184:187]
v_fmac_f32 v100, v233, v192
v_mfma_f32_16x16x32_bf16 v[188:191], v[92:95], v[68:71], v[188:191]
s_waitcnt lgkmcnt(0)
v_mfma_f32_16x16x32_bf16 v[96:99], v[32:35], v[16:19], v[96:99]
ds_read_b128 v[56:59], v3 offset:2048
v_mfma_f32_16x16x32_bf16 v[100:103], v[32:35], v[20:23], v[100:103]
ds_read_b128 v[60:63], v3 offset:2304
v_mfma_f32_16x16x32_bf16 v[104:107], v[32:35], v[24:27], v[104:107]
ds_read_b128 v[64:67], v3 offset:6144
v_mfma_f32_16x16x32_bf16 v[108:111], v[32:35], v[28:31], v[108:111]
ds_read_b128 v[68:71], v3 offset:6400
v_mfma_f32_16x16x32_bf16 v[112:115], v[36:39], v[16:19], v[112:115]
ds_read_b128 v[72:75], v5 offset:36864
v_mfma_f32_16x16x32_bf16 v[116:119], v[36:39], v[20:23], v[116:119]
ds_read_b128 v[76:79], v5 offset:37888
v_mfma_f32_16x16x32_bf16 v[120:123], v[36:39], v[24:27], v[120:123]
ds_read_b128 v[80:83], v5 offset:38912
v_mfma_f32_16x16x32_bf16 v[124:127], v[36:39], v[28:31], v[124:127]
ds_read_b128 v[84:87], v5 offset:39936
v_mfma_f32_16x16x32_bf16 v[128:131], v[40:43], v[16:19], v[128:131]
ds_read_b128 v[88:91], v5 offset:40960
v_mfma_f32_16x16x32_bf16 v[132:135], v[40:43], v[20:23], v[132:135]
ds_read_b128 v[92:95], v5 offset:41984
v_mfma_f32_16x16x32_bf16 v[136:139], v[40:43], v[24:27], v[136:139]
v_fmac_f32 v104, v234, v192
v_mfma_f32_16x16x32_bf16 v[140:143], v[40:43], v[28:31], v[140:143]
v_fmac_f32 v108, v235, v192
v_mfma_f32_16x16x32_bf16 v[144:147], v[44:47], v[16:19], v[144:147]
v_fmac_f32 v112, v232, v196
v_mfma_f32_16x16x32_bf16 v[148:151], v[44:47], v[20:23], v[148:151]
v_fmac_f32 v116, v233, v196
v_mfma_f32_16x16x32_bf16 v[152:155], v[44:47], v[24:27], v[152:155]
v_fmac_f32 v120, v234, v196
v_mfma_f32_16x16x32_bf16 v[156:159], v[44:47], v[28:31], v[156:159]
v_fmac_f32 v124, v235, v196
v_mfma_f32_16x16x32_bf16 v[160:163], v[48:51], v[16:19], v[160:163]
v_fmac_f32 v128, v232, v200
v_mfma_f32_16x16x32_bf16 v[164:167], v[48:51], v[20:23], v[164:167]
v_fmac_f32 v132, v233, v200
v_mfma_f32_16x16x32_bf16 v[168:171], v[48:51], v[24:27], v[168:171]
v_fmac_f32 v136, v234, v200
v_mfma_f32_16x16x32_bf16 v[172:175], v[48:51], v[28:31], v[172:175]
v_fmac_f32 v140, v235, v200
v_mfma_f32_16x16x32_bf16 v[176:179], v[52:55], v[16:19], v[176:179]
v_fmac_f32 v144, v232, v204
v_mfma_f32_16x16x32_bf16 v[180:183], v[52:55], v[20:23], v[180:183]
v_fmac_f32 v97, v232, v193
v_mfma_f32_16x16x32_bf16 v[184:187], v[52:55], v[24:27], v[184:187]
s_waitcnt lgkmcnt(0)
v_mfma_f32_16x16x32_bf16 v[188:191], v[52:55], v[28:31], v[188:191]
s_barrier
v_mfma_f32_16x16x32_bf16 v[96:99], v[72:75], v[56:59], v[96:99]
ds_read_b128 v[16:19], v3 offset:16384
v_mfma_f32_16x16x32_bf16 v[100:103], v[72:75], v[60:63], v[100:103]
ds_read_b128 v[20:23], v3 offset:16640
v_mfma_f32_16x16x32_bf16 v[104:107], v[72:75], v[64:67], v[104:107]
ds_read_b128 v[24:27], v3 offset:20480
v_mfma_f32_16x16x32_bf16 v[108:111], v[72:75], v[68:71], v[108:111]
ds_read_b128 v[28:31], v3 offset:20736
v_mfma_f32_16x16x32_bf16 v[112:115], v[76:79], v[56:59], v[112:115]
ds_read_b128 v[32:35], v5 offset:0
v_mfma_f32_16x16x32_bf16 v[116:119], v[76:79], v[60:63], v[116:119]
ds_read_b128 v[36:39], v5 offset:1024
v_mfma_f32_16x16x32_bf16 v[120:123], v[76:79], v[64:67], v[120:123]
ds_read_b128 v[40:43], v5 offset:2048
v_mfma_f32_16x16x32_bf16 v[124:127], v[76:79], v[68:71], v[124:127]
ds_read_b128 v[44:47], v5 offset:3072
v_mfma_f32_16x16x32_bf16 v[128:131], v[80:83], v[56:59], v[128:131]
ds_read_b128 v[48:51], v5 offset:4096
v_mfma_f32_16x16x32_bf16 v[132:135], v[80:83], v[60:63], v[132:135]
ds_read_b128 v[52:55], v5 offset:5120
v_mfma_f32_16x16x32_bf16 v[136:139], v[80:83], v[64:67], v[136:139]
v_fmac_f32 v149, v233, v205
v_mfma_f32_16x16x32_bf16 v[140:143], v[80:83], v[68:71], v[140:143]
v_fmac_f32 v153, v234, v205
v_mfma_f32_16x16x32_bf16 v[144:147], v[84:87], v[56:59], v[144:147]
v_fmac_f32 v157, v235, v205
v_mfma_f32_16x16x32_bf16 v[148:151], v[84:87], v[60:63], v[148:151]
v_fmac_f32 v161, v232, v209
v_mfma_f32_16x16x32_bf16 v[152:155], v[84:87], v[64:67], v[152:155]
v_fmac_f32 v165, v233, v209
v_mfma_f32_16x16x32_bf16 v[156:159], v[84:87], v[68:71], v[156:159]
v_fmac_f32 v169, v234, v209
v_mfma_f32_16x16x32_bf16 v[160:163], v[88:91], v[56:59], v[160:163]
v_fmac_f32 v173, v235, v209
v_mfma_f32_16x16x32_bf16 v[164:167], v[88:91], v[60:63], v[164:167]
v_fmac_f32 v177, v232, v213
v_mfma_f32_16x16x32_bf16 v[168:171], v[88:91], v[64:67], v[168:171]
v_fmac_f32 v181, v233, v213
v_mfma_f32_16x16x32_bf16 v[172:175], v[88:91], v[68:71], v[172:175]
v_fmac_f32 v185, v234, v213
v_mfma_f32_16x16x32_bf16 v[176:179], v[92:95], v[56:59], v[176:179]
v_fmac_f32 v189, v235, v213
v_mfma_f32_16x16x32_bf16 v[180:183], v[92:95], v[60:63], v[180:183]
v_fmac_f32 v101, v233, v193
v_mfma_f32_16x16x32_bf16 v[184:187], v[92:95], v[64:67], v[184:187]
v_fmac_f32 v105, v234, v193
v_mfma_f32_16x16x32_bf16 v[188:191], v[92:95], v[68:71], v[188:191]
s_waitcnt lgkmcnt(0)
v_mfma_f32_16x16x32_bf16 v[96:99], v[32:35], v[16:19], v[96:99]
ds_read_b128 v[56:59], v3 offset:18432
v_mfma_f32_16x16x32_bf16 v[100:103], v[32:35], v[20:23], v[100:103]
ds_read_b128 v[60:63], v3 offset:18688
v_mfma_f32_16x16x32_bf16 v[104:107], v[32:35], v[24:27], v[104:107]
ds_read_b128 v[64:67], v3 offset:22528
v_mfma_f32_16x16x32_bf16 v[108:111], v[32:35], v[28:31], v[108:111]
ds_read_b128 v[68:71], v3 offset:22784
v_mfma_f32_16x16x32_bf16 v[112:115], v[36:39], v[16:19], v[112:115]
ds_read_b128 v[72:75], v5 offset:12288
v_mfma_f32_16x16x32_bf16 v[116:119], v[36:39], v[20:23], v[116:119]
ds_read_b128 v[76:79], v5 offset:13312
v_mfma_f32_16x16x32_bf16 v[120:123], v[36:39], v[24:27], v[120:123]
ds_read_b128 v[80:83], v5 offset:14336
v_mfma_f32_16x16x32_bf16 v[124:127], v[36:39], v[28:31], v[124:127]
ds_read_b128 v[84:87], v5 offset:15360
v_mfma_f32_16x16x32_bf16 v[128:131], v[40:43], v[16:19], v[128:131]
ds_read_b128 v[88:91], v5 offset:16384
v_mfma_f32_16x16x32_bf16 v[132:135], v[40:43], v[20:23], v[132:135]
ds_read_b128 v[92:95], v5 offset:17408
v_mfma_f32_16x16x32_bf16 v[136:139], v[40:43], v[24:27], v[136:139]
v_fmac_f32 v109, v235, v193
v_mfma_f32_16x16x32_bf16 v[140:143], v[40:43], v[28:31], v[140:143]
v_fmac_f32 v113, v232, v197
v_mfma_f32_16x16x32_bf16 v[144:147], v[44:47], v[16:19], v[144:147]
v_fmac_f32 v117, v233, v197
v_mfma_f32_16x16x32_bf16 v[148:151], v[44:47], v[20:23], v[148:151]
v_fmac_f32 v121, v234, v197
v_mfma_f32_16x16x32_bf16 v[152:155], v[44:47], v[24:27], v[152:155]
v_fmac_f32 v125, v235, v197
v_mfma_f32_16x16x32_bf16 v[156:159], v[44:47], v[28:31], v[156:159]
v_fmac_f32 v129, v232, v201
v_mfma_f32_16x16x32_bf16 v[160:163], v[48:51], v[16:19], v[160:163]
v_fmac_f32 v133, v233, v201
v_mfma_f32_16x16x32_bf16 v[164:167], v[48:51], v[20:23], v[164:167]
v_fmac_f32 v137, v234, v201
v_mfma_f32_16x16x32_bf16 v[168:171], v[48:51], v[24:27], v[168:171]
v_fmac_f32 v141, v235, v201
v_mfma_f32_16x16x32_bf16 v[172:175], v[48:51], v[28:31], v[172:175]
v_fmac_f32 v145, v232, v205
v_mfma_f32_16x16x32_bf16 v[176:179], v[52:55], v[16:19], v[176:179]
v_fmac_f32 v190, v235, v214
v_mfma_f32_16x16x32_bf16 v[180:183], v[52:55], v[20:23], v[180:183]
v_fmac_f32 v98, v232, v194
v_mfma_f32_16x16x32_bf16 v[184:187], v[52:55], v[24:27], v[184:187]
s_waitcnt lgkmcnt(0)
v_mfma_f32_16x16x32_bf16 v[188:191], v[52:55], v[28:31], v[188:191]
s_barrier
v_mfma_f32_16x16x32_bf16 v[96:99], v[72:75], v[56:59], v[96:99]
ds_read_b128 v[16:19], v3 offset:32768
v_mfma_f32_16x16x32_bf16 v[100:103], v[72:75], v[60:63], v[100:103]
ds_read_b128 v[20:23], v3 offset:33024
v_mfma_f32_16x16x32_bf16 v[104:107], v[72:75], v[64:67], v[104:107]
ds_read_b128 v[24:27], v3 offset:36864
v_mfma_f32_16x16x32_bf16 v[108:111], v[72:75], v[68:71], v[108:111]
ds_read_b128 v[28:31], v3 offset:37120
v_mfma_f32_16x16x32_bf16 v[112:115], v[76:79], v[56:59], v[112:115]
ds_read_b128 v[32:35], v4 offset:24576
v_mfma_f32_16x16x32_bf16 v[116:119], v[76:79], v[60:63], v[116:119]
ds_read_b128 v[36:39], v4 offset:25600
v_mfma_f32_16x16x32_bf16 v[120:123], v[76:79], v[64:67], v[120:123]
ds_read_b128 v[40:43], v4 offset:26624
v_mfma_f32_16x16x32_bf16 v[124:127], v[76:79], v[68:71], v[124:127]
ds_read_b128 v[44:47], v4 offset:27648
v_mfma_f32_16x16x32_bf16 v[128:131], v[80:83], v[56:59], v[128:131]
ds_read_b128 v[48:51], v4 offset:28672
v_mfma_f32_16x16x32_bf16 v[132:135], v[80:83], v[60:63], v[132:135]
ds_read_b128 v[52:55], v4 offset:29696
v_mfma_f32_16x16x32_bf16 v[136:139], v[80:83], v[64:67], v[136:139]
v_fmac_f32 v150, v233, v206
v_mfma_f32_16x16x32_bf16 v[140:143], v[80:83], v[68:71], v[140:143]
v_fmac_f32 v154, v234, v206
v_mfma_f32_16x16x32_bf16 v[144:147], v[84:87], v[56:59], v[144:147]
v_fmac_f32 v158, v235, v206
v_mfma_f32_16x16x32_bf16 v[148:151], v[84:87], v[60:63], v[148:151]
v_fmac_f32 v162, v232, v210
v_mfma_f32_16x16x32_bf16 v[152:155], v[84:87], v[64:67], v[152:155]
v_fmac_f32 v166, v233, v210
v_mfma_f32_16x16x32_bf16 v[156:159], v[84:87], v[68:71], v[156:159]
v_fmac_f32 v170, v234, v210
v_mfma_f32_16x16x32_bf16 v[160:163], v[88:91], v[56:59], v[160:163]
v_fmac_f32 v174, v235, v210
v_mfma_f32_16x16x32_bf16 v[164:167], v[88:91], v[60:63], v[164:167]
v_fmac_f32 v178, v232, v214
v_mfma_f32_16x16x32_bf16 v[168:171], v[88:91], v[64:67], v[168:171]
v_fmac_f32 v182, v233, v214
v_mfma_f32_16x16x32_bf16 v[172:175], v[88:91], v[68:71], v[172:175]
v_fmac_f32 v186, v234, v214
v_mfma_f32_16x16x32_bf16 v[176:179], v[92:95], v[56:59], v[176:179]
v_fmac_f32 v102, v233, v194
v_mfma_f32_16x16x32_bf16 v[180:183], v[92:95], v[60:63], v[180:183]
v_fmac_f32 v106, v234, v194
v_mfma_f32_16x16x32_bf16 v[184:187], v[92:95], v[64:67], v[184:187]
v_fmac_f32 v110, v235, v194
v_mfma_f32_16x16x32_bf16 v[188:191], v[92:95], v[68:71], v[188:191]
s_waitcnt lgkmcnt(0)
v_mfma_f32_16x16x32_bf16 v[96:99], v[32:35], v[16:19], v[96:99]
ds_read_b128 v[56:59], v3 offset:34816
v_mfma_f32_16x16x32_bf16 v[100:103], v[32:35], v[20:23], v[100:103]
ds_read_b128 v[60:63], v3 offset:35072
v_mfma_f32_16x16x32_bf16 v[104:107], v[32:35], v[24:27], v[104:107]
ds_read_b128 v[64:67], v3 offset:38912
v_mfma_f32_16x16x32_bf16 v[108:111], v[32:35], v[28:31], v[108:111]
ds_read_b128 v[68:71], v3 offset:39168
v_mfma_f32_16x16x32_bf16 v[112:115], v[36:39], v[16:19], v[112:115]
ds_read_b128 v[72:75], v4 offset:36864
v_mfma_f32_16x16x32_bf16 v[116:119], v[36:39], v[20:23], v[116:119]
ds_read_b128 v[76:79], v4 offset:37888
v_mfma_f32_16x16x32_bf16 v[120:123], v[36:39], v[24:27], v[120:123]
ds_read_b128 v[80:83], v4 offset:38912
v_mfma_f32_16x16x32_bf16 v[124:127], v[36:39], v[28:31], v[124:127]
ds_read_b128 v[84:87], v4 offset:39936
v_mfma_f32_16x16x32_bf16 v[128:131], v[40:43], v[16:19], v[128:131]
ds_read_b128 v[88:91], v4 offset:40960
v_mfma_f32_16x16x32_bf16 v[132:135], v[40:43], v[20:23], v[132:135]
ds_read_b128 v[92:95], v4 offset:41984
v_mfma_f32_16x16x32_bf16 v[136:139], v[40:43], v[24:27], v[136:139]
v_fmac_f32 v114, v232, v198
v_mfma_f32_16x16x32_bf16 v[140:143], v[40:43], v[28:31], v[140:143]
v_fmac_f32 v118, v233, v198
v_mfma_f32_16x16x32_bf16 v[144:147], v[44:47], v[16:19], v[144:147]
v_fmac_f32 v122, v234, v198
v_mfma_f32_16x16x32_bf16 v[148:151], v[44:47], v[20:23], v[148:151]
v_fmac_f32 v126, v235, v198
v_mfma_f32_16x16x32_bf16 v[152:155], v[44:47], v[24:27], v[152:155]
v_fmac_f32 v130, v232, v202
v_mfma_f32_16x16x32_bf16 v[156:159], v[44:47], v[28:31], v[156:159]
v_fmac_f32 v134, v233, v202
v_mfma_f32_16x16x32_bf16 v[160:163], v[48:51], v[16:19], v[160:163]
v_fmac_f32 v138, v234, v202
v_mfma_f32_16x16x32_bf16 v[164:167], v[48:51], v[20:23], v[164:167]
v_fmac_f32 v142, v235, v202
v_mfma_f32_16x16x32_bf16 v[168:171], v[48:51], v[24:27], v[168:171]
v_fmac_f32 v146, v232, v206
v_mfma_f32_16x16x32_bf16 v[172:175], v[48:51], v[28:31], v[172:175]
v_fmac_f32 v187, v234, v215
v_mfma_f32_16x16x32_bf16 v[176:179], v[52:55], v[16:19], v[176:179]
v_fmac_f32 v191, v235, v215
v_mfma_f32_16x16x32_bf16 v[180:183], v[52:55], v[20:23], v[180:183]
v_fmac_f32 v99, v232, v195
v_mfma_f32_16x16x32_bf16 v[184:187], v[52:55], v[24:27], v[184:187]
s_waitcnt lgkmcnt(0)
v_mfma_f32_16x16x32_bf16 v[188:191], v[52:55], v[28:31], v[188:191]
s_barrier
v_mfma_f32_16x16x32_bf16 v[96:99], v[72:75], v[56:59], v[96:99]
ds_read_b128 v[16:19], v3 offset:49152
v_mfma_f32_16x16x32_bf16 v[100:103], v[72:75], v[60:63], v[100:103]
ds_read_b128 v[20:23], v3 offset:49408
v_mfma_f32_16x16x32_bf16 v[104:107], v[72:75], v[64:67], v[104:107]
ds_read_b128 v[24:27], v3 offset:53248
v_mfma_f32_16x16x32_bf16 v[108:111], v[72:75], v[68:71], v[108:111]
ds_read_b128 v[28:31], v3 offset:53504
v_mfma_f32_16x16x32_bf16 v[112:115], v[76:79], v[56:59], v[112:115]
ds_read_b128 v[32:35], v4 offset:0
v_mfma_f32_16x16x32_bf16 v[116:119], v[76:79], v[60:63], v[116:119]
ds_read_b128 v[36:39], v4 offset:1024
v_mfma_f32_16x16x32_bf16 v[120:123], v[76:79], v[64:67], v[120:123]
ds_read_b128 v[40:43], v4 offset:2048
v_mfma_f32_16x16x32_bf16 v[124:127], v[76:79], v[68:71], v[124:127]
ds_read_b128 v[44:47], v4 offset:3072
v_mfma_f32_16x16x32_bf16 v[128:131], v[80:83], v[56:59], v[128:131]
ds_read_b128 v[48:51], v4 offset:4096
v_mfma_f32_16x16x32_bf16 v[132:135], v[80:83], v[60:63], v[132:135]
ds_read_b128 v[52:55], v4 offset:5120
v_mfma_f32_16x16x32_bf16 v[136:139], v[80:83], v[64:67], v[136:139]
v_fmac_f32 v151, v233, v207
v_mfma_f32_16x16x32_bf16 v[140:143], v[80:83], v[68:71], v[140:143]
v_fmac_f32 v155, v234, v207
v_mfma_f32_16x16x32_bf16 v[144:147], v[84:87], v[56:59], v[144:147]
v_fmac_f32 v159, v235, v207
v_mfma_f32_16x16x32_bf16 v[148:151], v[84:87], v[60:63], v[148:151]
v_fmac_f32 v163, v232, v211
v_mfma_f32_16x16x32_bf16 v[152:155], v[84:87], v[64:67], v[152:155]
v_fmac_f32 v167, v233, v211
v_mfma_f32_16x16x32_bf16 v[156:159], v[84:87], v[68:71], v[156:159]
v_fmac_f32 v171, v234, v211
v_mfma_f32_16x16x32_bf16 v[160:163], v[88:91], v[56:59], v[160:163]
v_fmac_f32 v175, v235, v211
v_mfma_f32_16x16x32_bf16 v[164:167], v[88:91], v[60:63], v[164:167]
v_fmac_f32 v179, v232, v215
v_mfma_f32_16x16x32_bf16 v[168:171], v[88:91], v[64:67], v[168:171]
v_fmac_f32 v183, v233, v215
v_mfma_f32_16x16x32_bf16 v[172:175], v[88:91], v[68:71], v[172:175]
v_fmac_f32 v103, v233, v195
v_mfma_f32_16x16x32_bf16 v[176:179], v[92:95], v[56:59], v[176:179]
v_fmac_f32 v107, v234, v195
v_mfma_f32_16x16x32_bf16 v[180:183], v[92:95], v[60:63], v[180:183]
v_fmac_f32 v111, v235, v195
v_mfma_f32_16x16x32_bf16 v[184:187], v[92:95], v[64:67], v[184:187]
v_fmac_f32 v115, v232, v199
v_mfma_f32_16x16x32_bf16 v[188:191], v[92:95], v[68:71], v[188:191]
s_waitcnt lgkmcnt(0)
v_mfma_f32_16x16x32_bf16 v[96:99], v[32:35], v[16:19], v[96:99]
ds_read_b128 v[56:59], v3 offset:51200
v_mfma_f32_16x16x32_bf16 v[100:103], v[32:35], v[20:23], v[100:103]
ds_read_b128 v[60:63], v3 offset:51456
v_mfma_f32_16x16x32_bf16 v[104:107], v[32:35], v[24:27], v[104:107]
ds_read_b128 v[64:67], v3 offset:55296
v_mfma_f32_16x16x32_bf16 v[108:111], v[32:35], v[28:31], v[108:111]
ds_read_b128 v[68:71], v3 offset:55552
v_mfma_f32_16x16x32_bf16 v[112:115], v[36:39], v[16:19], v[112:115]
ds_read_b128 v[72:75], v4 offset:12288
v_mfma_f32_16x16x32_bf16 v[116:119], v[36:39], v[20:23], v[116:119]
ds_read_b128 v[76:79], v4 offset:13312
v_mfma_f32_16x16x32_bf16 v[120:123], v[36:39], v[24:27], v[120:123]
ds_read_b128 v[80:83], v4 offset:14336
v_mfma_f32_16x16x32_bf16 v[124:127], v[36:39], v[28:31], v[124:127]
ds_read_b128 v[84:87], v4 offset:15360
v_mfma_f32_16x16x32_bf16 v[128:131], v[40:43], v[16:19], v[128:131]
ds_read_b128 v[88:91], v4 offset:16384
v_mfma_f32_16x16x32_bf16 v[132:135], v[40:43], v[20:23], v[132:135]
ds_read_b128 v[92:95], v4 offset:17408
v_mfma_f32_16x16x32_bf16 v[136:139], v[40:43], v[24:27], v[136:139]
v_fmac_f32 v119, v233, v199
v_mfma_f32_16x16x32_bf16 v[140:143], v[40:43], v[28:31], v[140:143]
v_fmac_f32 v123, v234, v199
v_mfma_f32_16x16x32_bf16 v[144:147], v[44:47], v[16:19], v[144:147]
v_fmac_f32 v127, v235, v199
v_mfma_f32_16x16x32_bf16 v[148:151], v[44:47], v[20:23], v[148:151]
v_fmac_f32 v131, v232, v203
v_mfma_f32_16x16x32_bf16 v[152:155], v[44:47], v[24:27], v[152:155]
v_fmac_f32 v135, v233, v203
v_mfma_f32_16x16x32_bf16 v[156:159], v[44:47], v[28:31], v[156:159]
v_fmac_f32 v139, v234, v203
v_mfma_f32_16x16x32_bf16 v[160:163], v[48:51], v[16:19], v[160:163]
v_fmac_f32 v143, v235, v203
v_mfma_f32_16x16x32_bf16 v[164:167], v[48:51], v[20:23], v[164:167]
v_fmac_f32 v147, v232, v207
v_mfma_f32_16x16x32_bf16 v[168:171], v[48:51], v[24:27], v[168:171]
v_mfma_f32_16x16x32_bf16 v[172:175], v[48:51], v[28:31], v[172:175]
v_mfma_f32_16x16x32_bf16 v[176:179], v[52:55], v[16:19], v[176:179]
v_mfma_f32_16x16x32_bf16 v[180:183], v[52:55], v[20:23], v[180:183]
v_mfma_f32_16x16x32_bf16 v[184:187], v[52:55], v[24:27], v[184:187]
s_waitcnt lgkmcnt(0)
v_mfma_f32_16x16x32_bf16 v[188:191], v[52:55], v[28:31], v[188:191]
s_barrier
v_mfma_f32_16x16x32_bf16 v[96:99], v[72:75], v[56:59], v[96:99]
ds_read_b128 v[16:19], v3 offset:0
v_mfma_f32_16x16x32_bf16 v[100:103], v[72:75], v[60:63], v[100:103]
ds_read_b128 v[20:23], v3 offset:256
v_mfma_f32_16x16x32_bf16 v[104:107], v[72:75], v[64:67], v[104:107]
ds_read_b128 v[24:27], v3 offset:4096
v_mfma_f32_16x16x32_bf16 v[108:111], v[72:75], v[68:71], v[108:111]
ds_read_b128 v[28:31], v3 offset:4352
v_mfma_f32_16x16x32_bf16 v[112:115], v[76:79], v[56:59], v[112:115]
ds_read_b128 v[32:35], v5 offset:24576
v_mfma_f32_16x16x32_bf16 v[116:119], v[76:79], v[60:63], v[116:119]
ds_read_b128 v[36:39], v5 offset:25600
v_mfma_f32_16x16x32_bf16 v[120:123], v[76:79], v[64:67], v[120:123]
ds_read_b128 v[40:43], v5 offset:26624
v_mfma_f32_16x16x32_bf16 v[124:127], v[76:79], v[68:71], v[124:127]
ds_read_b128 v[44:47], v5 offset:27648
v_mfma_f32_16x16x32_bf16 v[128:131], v[80:83], v[56:59], v[128:131]
ds_read_b128 v[48:51], v5 offset:28672
v_mfma_f32_16x16x32_bf16 v[132:135], v[80:83], v[60:63], v[132:135]
ds_read_b128 v[52:55], v5 offset:29696
v_mfma_f32_16x16x32_bf16 v[136:139], v[80:83], v[64:67], v[136:139]
v_mfma_f32_16x16x32_bf16 v[140:143], v[80:83], v[68:71], v[140:143]
v_mfma_f32_16x16x32_bf16 v[144:147], v[84:87], v[56:59], v[144:147]
v_mfma_f32_16x16x32_bf16 v[148:151], v[84:87], v[60:63], v[148:151]
v_mfma_f32_16x16x32_bf16 v[152:155], v[84:87], v[64:67], v[152:155]
v_mfma_f32_16x16x32_bf16 v[156:159], v[84:87], v[68:71], v[156:159]
v_mfma_f32_16x16x32_bf16 v[160:163], v[88:91], v[56:59], v[160:163]
v_mfma_f32_16x16x32_bf16 v[164:167], v[88:91], v[60:63], v[164:167]
v_mfma_f32_16x16x32_bf16 v[168:171], v[88:91], v[64:67], v[168:171]
v_mfma_f32_16x16x32_bf16 v[172:175], v[88:91], v[68:71], v[172:175]
v_mfma_f32_16x16x32_bf16 v[176:179], v[92:95], v[56:59], v[176:179]
v_mfma_f32_16x16x32_bf16 v[180:183], v[92:95], v[60:63], v[180:183]
v_mfma_f32_16x16x32_bf16 v[184:187], v[92:95], v[64:67], v[184:187]
v_mfma_f32_16x16x32_bf16 v[188:191], v[92:95], v[68:71], v[188:191]
s_waitcnt lgkmcnt(0)
v_mfma_f32_16x16x32_bf16 v[96:99], v[32:35], v[16:19], v[96:99]
ds_read_b128 v[56:59], v3 offset:2048
v_mfma_f32_16x16x32_bf16 v[100:103], v[32:35], v[20:23], v[100:103]
ds_read_b128 v[60:63], v3 offset:2304
v_mfma_f32_16x16x32_bf16 v[104:107], v[32:35], v[24:27], v[104:107]
ds_read_b128 v[64:67], v3 offset:6144
v_mfma_f32_16x16x32_bf16 v[108:111], v[32:35], v[28:31], v[108:111]
ds_read_b128 v[68:71], v3 offset:6400
v_mfma_f32_16x16x32_bf16 v[112:115], v[36:39], v[16:19], v[112:115]
ds_read_b128 v[72:75], v5 offset:36864
v_mfma_f32_16x16x32_bf16 v[116:119], v[36:39], v[20:23], v[116:119]
ds_read_b128 v[76:79], v5 offset:37888
v_mfma_f32_16x16x32_bf16 v[120:123], v[36:39], v[24:27], v[120:123]
ds_read_b128 v[80:83], v5 offset:38912
v_mfma_f32_16x16x32_bf16 v[124:127], v[36:39], v[28:31], v[124:127]
ds_read_b128 v[84:87], v5 offset:39936
v_mfma_f32_16x16x32_bf16 v[128:131], v[40:43], v[16:19], v[128:131]
ds_read_b128 v[88:91], v5 offset:40960
v_mfma_f32_16x16x32_bf16 v[132:135], v[40:43], v[20:23], v[132:135]
ds_read_b128 v[92:95], v5 offset:41984
v_mfma_f32_16x16x32_bf16 v[136:139], v[40:43], v[24:27], v[136:139]
v_mfma_f32_16x16x32_bf16 v[140:143], v[40:43], v[28:31], v[140:143]
v_mfma_f32_16x16x32_bf16 v[144:147], v[44:47], v[16:19], v[144:147]
v_mfma_f32_16x16x32_bf16 v[148:151], v[44:47], v[20:23], v[148:151]
v_mfma_f32_16x16x32_bf16 v[152:155], v[44:47], v[24:27], v[152:155]
v_mfma_f32_16x16x32_bf16 v[156:159], v[44:47], v[28:31], v[156:159]
v_mfma_f32_16x16x32_bf16 v[160:163], v[48:51], v[16:19], v[160:163]
v_mfma_f32_16x16x32_bf16 v[164:167], v[48:51], v[20:23], v[164:167]
v_mfma_f32_16x16x32_bf16 v[168:171], v[48:51], v[24:27], v[168:171]
v_mfma_f32_16x16x32_bf16 v[172:175], v[48:51], v[28:31], v[172:175]
v_mfma_f32_16x16x32_bf16 v[176:179], v[52:55], v[16:19], v[176:179]
v_mfma_f32_16x16x32_bf16 v[180:183], v[52:55], v[20:23], v[180:183]
v_mfma_f32_16x16x32_bf16 v[184:187], v[52:55], v[24:27], v[184:187]
s_waitcnt lgkmcnt(0)
v_mfma_f32_16x16x32_bf16 v[188:191], v[52:55], v[28:31], v[188:191]
s_barrier
v_mfma_f32_16x16x32_bf16 v[96:99], v[72:75], v[56:59], v[96:99]
ds_read_b128 v[16:19], v3 offset:16384
v_mfma_f32_16x16x32_bf16 v[100:103], v[72:75], v[60:63], v[100:103]
ds_read_b128 v[20:23], v3 offset:16640
v_mfma_f32_16x16x32_bf16 v[104:107], v[72:75], v[64:67], v[104:107]
ds_read_b128 v[24:27], v3 offset:20480
v_mfma_f32_16x16x32_bf16 v[108:111], v[72:75], v[68:71], v[108:111]
ds_read_b128 v[28:31], v3 offset:20736
v_mfma_f32_16x16x32_bf16 v[112:115], v[76:79], v[56:59], v[112:115]
ds_read_b128 v[32:35], v5 offset:0
v_mfma_f32_16x16x32_bf16 v[116:119], v[76:79], v[60:63], v[116:119]
ds_read_b128 v[36:39], v5 offset:1024
v_mfma_f32_16x16x32_bf16 v[120:123], v[76:79], v[64:67], v[120:123]
ds_read_b128 v[40:43], v5 offset:2048
v_mfma_f32_16x16x32_bf16 v[124:127], v[76:79], v[68:71], v[124:127]
ds_read_b128 v[44:47], v5 offset:3072
v_mfma_f32_16x16x32_bf16 v[128:131], v[80:83], v[56:59], v[128:131]
ds_read_b128 v[48:51], v5 offset:4096
v_mfma_f32_16x16x32_bf16 v[132:135], v[80:83], v[60:63], v[132:135]
ds_read_b128 v[52:55], v5 offset:5120
v_mfma_f32_16x16x32_bf16 v[136:139], v[80:83], v[64:67], v[136:139]
v_mfma_f32_16x16x32_bf16 v[140:143], v[80:83], v[68:71], v[140:143]
v_mfma_f32_16x16x32_bf16 v[144:147], v[84:87], v[56:59], v[144:147]
v_mfma_f32_16x16x32_bf16 v[148:151], v[84:87], v[60:63], v[148:151]
v_mfma_f32_16x16x32_bf16 v[152:155], v[84:87], v[64:67], v[152:155]
v_mfma_f32_16x16x32_bf16 v[156:159], v[84:87], v[68:71], v[156:159]
v_mfma_f32_16x16x32_bf16 v[160:163], v[88:91], v[56:59], v[160:163]
v_mfma_f32_16x16x32_bf16 v[164:167], v[88:91], v[60:63], v[164:167]
v_mfma_f32_16x16x32_bf16 v[168:171], v[88:91], v[64:67], v[168:171]
v_mfma_f32_16x16x32_bf16 v[172:175], v[88:91], v[68:71], v[172:175]
v_mfma_f32_16x16x32_bf16 v[176:179], v[92:95], v[56:59], v[176:179]
v_mfma_f32_16x16x32_bf16 v[180:183], v[92:95], v[60:63], v[180:183]
v_mfma_f32_16x16x32_bf16 v[184:187], v[92:95], v[64:67], v[184:187]
v_mfma_f32_16x16x32_bf16 v[188:191], v[92:95], v[68:71], v[188:191]
s_waitcnt lgkmcnt(0)
v_mfma_f32_16x16x32_bf16 v[96:99], v[32:35], v[16:19], v[96:99]
ds_read_b128 v[56:59], v3 offset:18432
v_mfma_f32_16x16x32_bf16 v[100:103], v[32:35], v[20:23], v[100:103]
ds_read_b128 v[60:63], v3 offset:18688
v_mfma_f32_16x16x32_bf16 v[104:107], v[32:35], v[24:27], v[104:107]
ds_read_b128 v[64:67], v3 offset:22528
v_mfma_f32_16x16x32_bf16 v[108:111], v[32:35], v[28:31], v[108:111]
ds_read_b128 v[68:71], v3 offset:22784
v_mfma_f32_16x16x32_bf16 v[112:115], v[36:39], v[16:19], v[112:115]
ds_read_b128 v[72:75], v5 offset:12288
v_mfma_f32_16x16x32_bf16 v[116:119], v[36:39], v[20:23], v[116:119]
ds_read_b128 v[76:79], v5 offset:13312
v_mfma_f32_16x16x32_bf16 v[120:123], v[36:39], v[24:27], v[120:123]
ds_read_b128 v[80:83], v5 offset:14336
v_mfma_f32_16x16x32_bf16 v[124:127], v[36:39], v[28:31], v[124:127]
ds_read_b128 v[84:87], v5 offset:15360
v_mfma_f32_16x16x32_bf16 v[128:131], v[40:43], v[16:19], v[128:131]
ds_read_b128 v[88:91], v5 offset:16384
v_mfma_f32_16x16x32_bf16 v[132:135], v[40:43], v[20:23], v[132:135]
ds_read_b128 v[92:95], v5 offset:17408
v_mfma_f32_16x16x32_bf16 v[136:139], v[40:43], v[24:27], v[136:139]
v_mfma_f32_16x16x32_bf16 v[140:143], v[40:43], v[28:31], v[140:143]
v_mfma_f32_16x16x32_bf16 v[144:147], v[44:47], v[16:19], v[144:147]
v_mfma_f32_16x16x32_bf16 v[148:151], v[44:47], v[20:23], v[148:151]
v_mfma_f32_16x16x32_bf16 v[152:155], v[44:47], v[24:27], v[152:155]
v_mfma_f32_16x16x32_bf16 v[156:159], v[44:47], v[28:31], v[156:159]
s_waitcnt lgkmcnt(0)
v_mfma_f32_16x16x32_bf16 v[96:99], v[72:75], v[56:59], v[96:99]
s_barrier
v_mfma_f32_16x16x32_bf16 v[100:103], v[72:75], v[60:63], v[100:103]
v_mfma_f32_16x16x32_bf16 v[104:107], v[72:75], v[64:67], v[104:107]
v_mfma_f32_16x16x32_bf16 v[108:111], v[72:75], v[68:71], v[108:111]
v_mfma_f32_16x16x32_bf16 v[112:115], v[76:79], v[56:59], v[112:115]
v_mfma_f32_16x16x32_bf16 v[116:119], v[76:79], v[60:63], v[116:119]
v_mfma_f32_16x16x32_bf16 v[120:123], v[76:79], v[64:67], v[120:123]
v_mfma_f32_16x16x32_bf16 v[124:127], v[76:79], v[68:71], v[124:127]
v_mfma_f32_16x16x32_bf16 v[128:131], v[80:83], v[56:59], v[128:131]
s_nop 1
v_mfma_f32_16x16x32_bf16 v[132:135], v[80:83], v[60:63], v[132:135]
s_nop 1
v_mfma_f32_16x16x32_bf16 v[136:139], v[80:83], v[64:67], v[136:139]
v_max_f32 v96, 0, v96
v_max_f32 v97, 0, v97
v_max_f32 v98, 0, v98
v_mfma_f32_16x16x32_bf16 v[140:143], v[80:83], v[68:71], v[140:143]
v_max_f32 v99, 0, v99
v_max_f32 v100, 0, v100
v_max_f32 v101, 0, v101
v_mfma_f32_16x16x32_bf16 v[144:147], v[84:87], v[56:59], v[144:147]
v_max_f32 v102, 0, v102
v_max_f32 v103, 0, v103
v_mul_f32 v96, v96, v112
v_mfma_f32_16x16x32_bf16 v[148:151], v[84:87], v[60:63], v[148:151]
v_mul_f32 v97, v97, v113
v_mul_f32 v98, v98, v114
v_mul_f32 v99, v99, v115
v_mfma_f32_16x16x32_bf16 v[152:155], v[84:87], v[64:67], v[152:155]
v_mul_f32 v100, v100, v116
v_mul_f32 v101, v101, v117
v_mul_f32 v102, v102, v118
v_mfma_f32_16x16x32_bf16 v[156:159], v[84:87], v[68:71], v[156:159]
v_mul_f32 v103, v103, v119
v_cvt_pk_bf16_f32 v96, v96, v97
v_cvt_pk_bf16_f32 v97, v98, v99
v_mfma_f32_16x16x32_bf16 v[160:163], v[48:51], v[16:19], v[160:163]
v_cvt_pk_bf16_f32 v98, v100, v101
v_cvt_pk_bf16_f32 v99, v102, v103
s_nop 0
v_mfma_f32_16x16x32_bf16 v[164:167], v[48:51], v[20:23], v[164:167]
v_permlane16_swap_b32 v96, v98
v_permlane16_swap_b32 v97, v99
buffer_store_dwordx4 v[96:99], v11, s[36:39], s71 offen offset:0 sc1
v_mfma_f32_16x16x32_bf16 v[168:171], v[48:51], v[24:27], v[168:171]
v_max_f32 v104, 0, v104
v_max_f32 v105, 0, v105
v_max_f32 v106, 0, v106
v_mfma_f32_16x16x32_bf16 v[172:175], v[48:51], v[28:31], v[172:175]
v_max_f32 v107, 0, v107
v_max_f32 v108, 0, v108
v_max_f32 v109, 0, v109
v_mfma_f32_16x16x32_bf16 v[176:179], v[52:55], v[16:19], v[176:179]
v_max_f32 v110, 0, v110
v_max_f32 v111, 0, v111
v_mul_f32 v104, v104, v120
v_mfma_f32_16x16x32_bf16 v[180:183], v[52:55], v[20:23], v[180:183]
v_mul_f32 v105, v105, v121
v_mul_f32 v106, v106, v122
v_mul_f32 v107, v107, v123
v_mfma_f32_16x16x32_bf16 v[184:187], v[52:55], v[24:27], v[184:187]
v_mul_f32 v108, v108, v124
v_mul_f32 v109, v109, v125
v_mul_f32 v110, v110, v126
v_mfma_f32_16x16x32_bf16 v[188:191], v[52:55], v[28:31], v[188:191]
v_mul_f32 v111, v111, v127
v_cvt_pk_bf16_f32 v104, v104, v105
v_cvt_pk_bf16_f32 v105, v106, v107
v_mfma_f32_16x16x32_bf16 v[160:163], v[88:91], v[56:59], v[160:163]
v_cvt_pk_bf16_f32 v106, v108, v109
v_cvt_pk_bf16_f32 v107, v110, v111
s_nop 0
v_mfma_f32_16x16x32_bf16 v[164:167], v[88:91], v[60:63], v[164:167]
v_permlane16_swap_b32 v104, v106
v_permlane16_swap_b32 v105, v107
buffer_store_dwordx4 v[104:107], v11, s[36:39], s72 offen offset:0 sc1
v_mfma_f32_16x16x32_bf16 v[168:171], v[88:91], v[64:67], v[168:171]
v_max_f32 v128, 0, v128
v_max_f32 v129, 0, v129
v_max_f32 v130, 0, v130
v_mfma_f32_16x16x32_bf16 v[172:175], v[88:91], v[68:71], v[172:175]
v_max_f32 v131, 0, v131
v_max_f32 v132, 0, v132
v_max_f32 v133, 0, v133
v_mfma_f32_16x16x32_bf16 v[176:179], v[92:95], v[56:59], v[176:179]
v_max_f32 v134, 0, v134
v_max_f32 v135, 0, v135
v_mul_f32 v128, v128, v144
v_mfma_f32_16x16x32_bf16 v[180:183], v[92:95], v[60:63], v[180:183]
v_mul_f32 v129, v129, v145
v_mul_f32 v130, v130, v146
v_mul_f32 v131, v131, v147
v_mfma_f32_16x16x32_bf16 v[184:187], v[92:95], v[64:67], v[184:187]
v_mul_f32 v132, v132, v148
v_mul_f32 v133, v133, v149
v_mul_f32 v134, v134, v150
v_mfma_f32_16x16x32_bf16 v[188:191], v[92:95], v[68:71], v[188:191]
v_mul_f32 v135, v135, v151
v_cvt_pk_bf16_f32 v128, v128, v129
v_cvt_pk_bf16_f32 v129, v130, v131
v_cvt_pk_bf16_f32 v130, v132, v133
v_cvt_pk_bf16_f32 v131, v134, v135
s_nop 0
v_permlane16_swap_b32 v128, v130
v_permlane16_swap_b32 v129, v131
buffer_store_dwordx4 v[128:131], v11, s[36:39], s71 offen offset:1024 sc1
v_max_f32 v136, 0, v136
v_max_f32 v137, 0, v137
v_max_f32 v138, 0, v138
v_max_f32 v139, 0, v139
v_max_f32 v140, 0, v140
v_max_f32 v141, 0, v141
v_max_f32 v142, 0, v142
v_max_f32 v143, 0, v143
v_mul_f32 v136, v136, v152
v_mul_f32 v137, v137, v153
v_mul_f32 v138, v138, v154
v_mul_f32 v139, v139, v155
v_mul_f32 v140, v140, v156
v_mul_f32 v141, v141, v157
v_mul_f32 v142, v142, v158
v_mul_f32 v143, v143, v159
v_cvt_pk_bf16_f32 v136, v136, v137
v_cvt_pk_bf16_f32 v137, v138, v139
v_cvt_pk_bf16_f32 v138, v140, v141
v_cvt_pk_bf16_f32 v139, v142, v143
s_nop 0
v_permlane16_swap_b32 v136, v138
v_permlane16_swap_b32 v137, v139
buffer_store_dwordx4 v[136:139], v11, s[36:39], s72 offen offset:1024 sc1
v_max_f32 v160, 0, v160
v_max_f32 v161, 0, v161
v_max_f32 v162, 0, v162
v_max_f32 v163, 0, v163
v_max_f32 v164, 0, v164
v_max_f32 v165, 0, v165
v_max_f32 v166, 0, v166
v_max_f32 v167, 0, v167
v_pk_mul_f32 v[160:161], v[160:161], v[176:177]
v_pk_mul_f32 v[162:163], v[162:163], v[178:179]
v_pk_mul_f32 v[164:165], v[164:165], v[180:181]
v_pk_mul_f32 v[166:167], v[166:167], v[182:183]
v_cvt_pk_bf16_f32 v160, v160, v161
v_cvt_pk_bf16_f32 v161, v162, v163
v_cvt_pk_bf16_f32 v162, v164, v165
v_cvt_pk_bf16_f32 v163, v166, v167
s_nop 0
v_permlane16_swap_b32 v160, v162
v_permlane16_swap_b32 v161, v163
buffer_store_dwordx4 v[160:163], v11, s[36:39], s71 offen offset:2048 sc1
v_max_f32 v168, 0, v168
v_max_f32 v169, 0, v169
v_max_f32 v170, 0, v170
v_max_f32 v171, 0, v171
v_max_f32 v172, 0, v172
v_max_f32 v173, 0, v173
v_max_f32 v174, 0, v174
v_max_f32 v175, 0, v175
v_pk_mul_f32 v[168:169], v[168:169], v[184:185]
v_pk_mul_f32 v[170:171], v[170:171], v[186:187]
v_pk_mul_f32 v[172:173], v[172:173], v[188:189]
v_pk_mul_f32 v[174:175], v[174:175], v[190:191]
v_cvt_pk_bf16_f32 v168, v168, v169
v_cvt_pk_bf16_f32 v169, v170, v171
v_cvt_pk_bf16_f32 v170, v172, v173
v_cvt_pk_bf16_f32 v171, v174, v175
s_nop 0
v_permlane16_swap_b32 v168, v170
v_permlane16_swap_b32 v169, v171
buffer_store_dwordx4 v[168:171], v11, s[36:39], s72 offen offset:2048 sc1
s_waitcnt vmcnt(0)
s_mov_b64 exec, 1
buffer_store_dword v2, v1, s[36:39], s80 offen sc1
s_mov_b64 exec, -1
s_barrier
s_lshr_b32 s60, s13, 3
s_and_b32 s61, s5, 7
v_and_b32 v3, 15, v0
v_lshrrev_b32 v7, 4, v0
s_lshl_b32 s66, s60, 1
s_lshr_b32 s67, s6, 1
s_add_u32 s66, s66, s67
s_and_b32 s68, s6, 1
s_lshl_b32 s68, s68, 8
s_mul_i32 s62, s66, 98304
s_add_u32 s62, s62, s68
s_add_u32 s62, s62, s7
s_add_u32 s62, s62, 15728640
s_mul_i32 s64, s66, 40960
s_mul_i32 s67, s61, 5120
s_add_u32 s64, s64, s67
s_add_u32 s64, s64, s68
s_lshl_b32 s72, s6, 8
s_lshl_b32 s67, s60, 12
s_add_u32 s72, s72, s67
s_add_u32 s72, s72, s7
s_lshl_b32 s65, s60, 2
s_add_u32 s65, s65, s6
s_mul_i32 s65, s65, 20480
s_mul_i32 s67, s61, 160
s_add_u32 s65, s65, s67
v_lshlrev_b32 v1, 4, v3
v_lshl_add_u32 v10, v7, 9, v1
v_lshrrev_b32 v2, 5, v0
v_lshl_add_u32 v1, v2, 9, v1
v_and_b32 v2, 1, v7
v_lshl_add_u32 v11, v2, 3, v1
v_add_u32 v11, 4096, v11
v_mul_u32_u24 v1, 1280, v3
v_lshl_add_u32 v12, v7, 4, v1
v_lshl_add_u32 v13, v7, 3, v1
v_add_u32 v9, 4096, v10
s_and_b32 s67, s60, 3
s_mul_i32 s67, s67, 0
s_sub_u32 s69, 12, s67
s_mul_i32 s68, s67, 8192
s_add_u32 s62, s62, s68
s_sub_u32 s63, s62, 98304
s_add_u32 s73, s64, 10485760
s_add_u32 s73, s73, s7
s_add_u32 s74, s72, 22020096
v_lshlrev_b32 v8, 4, v3
v_lshlrev_b32 v4, 4, v0
v_add_u32 v5, 61440, v4
v_add_u32 v6, 122880, v4
s_mov_b32 s68, 0xffff0000
s_and_b32 s67, s60, 3
s_mul_i32 s67, s67, 0
v_lshrrev_b32 v1, 1, v0
v_add_u32 v1, s67, v1
v_and_b32 v1, 15, v1
v_lshlrev_b32 v1, 5, v1
v_and_b32 v2, 1, v0
v_lshl_add_u32 v1, v2, 3, v1
s_lshr_b32 s94, s5, 4
s_lshl_b32 s94, s94, 9
s_bfe_u32 s81, s5, 0x10003
s_lshl_b32 s81, s81, 2
s_add_u32 s94, s94, s81
s_lshl_b32 s81, s4, 10
s_add_u32 s94, s94, s81
s_add_u32 s94, s94, 51798016
s_add_u32 s95, s8, 5
s_mov_b32 s92, -1
ds_read_b128 v[134:137], v4 offset:40960
ds_read_b128 v[138:141], v4 offset:41984
ds_read_b128 v[142:145], v4 offset:43008
ds_read_b128 v[146:149], v4 offset:44032
ds_read_b128 v[150:153], v4 offset:45056
ds_read_b128 v[154:157], v4 offset:46080
ds_read_b128 v[158:161], v4 offset:47104
ds_read_b128 v[162:165], v4 offset:48128
ds_read_b128 v[166:169], v4 offset:49152
ds_read_b128 v[170:173], v4 offset:50176
s_and_b32 s82, s92, 0xf
s_cbranch_scc0 gt_216k
s_mov_b32 s82, s9
gt_216:
buffer_load_dword v2, v1, s[36:39], s94 offen sc1
s_waitcnt vmcnt(0)
v_subrev_u32 v2, s95, v2
v_cmp_lt_u32 s[92:93], 15, v2
s_and_b32 s83, s92, 0xf
s_cbranch_scc0 gt_216k
s_add_u32 s82, s82, 1
s_cmp_lt_u32 s82, 200000
s_cbranch_scc1 gt_216
s_mov_b32 s9, 200000
gt_216k:
s_add_u32 s70, s62, 0
buffer_load_dwordx4 v[54:57], v10, s[36:39], s70 offen offset:0 sc1
buffer_load_dwordx4 v[58:61], v10, s[36:39], s70 offen offset:2048 sc1
buffer_load_dwordx4 v[62:65], v9, s[36:39], s70 offen offset:0 sc1
buffer_load_dwordx4 v[66:69], v9, s[36:39], s70 offen offset:2048 sc1
s_and_b32 s82, s92, 0x30
s_cbranch_scc0 gt_217k
s_mov_b32 s82, s9
gt_217:
buffer_load_dword v2, v1, s[36:39], s94 offen sc1
s_waitcnt vmcnt(0)
v_subrev_u32 v2, s95, v2
v_cmp_lt_u32 s[92:93], 15, v2
s_and_b32 s83, s92, 0x30
s_cbranch_scc0 gt_217k
s_add_u32 s82, s82, 1
s_cmp_lt_u32 s82, 200000
s_cbranch_scc1 gt_217
s_mov_b32 s9, 200000
gt_217k:
s_add_u32 s70, s62, 8192
buffer_load_dwordx4 v[70:73], v10, s[36:39], s70 offen offset:0 sc1
buffer_load_dwordx4 v[74:77], v10, s[36:39], s70 offen offset:2048 sc1
buffer_load_dwordx4 v[78:81], v9, s[36:39], s70 offen offset:0 sc1
buffer_load_dwordx4 v[82:85], v9, s[36:39], s70 offen offset:2048 sc1
s_and_b32 s82, s92, 0xc0
s_cbranch_scc0 gt_218k
s_mov_b32 s82, s9
gt_218:
buffer_load_dword v2, v1, s[36:39], s94 offen sc1
s_waitcnt vmcnt(0)
v_subrev_u32 v2, s95, v2
v_cmp_lt_u32 s[92:93], 15, v2
s_and_b32 s83, s92, 0xc0
s_cbranch_scc0 gt_218k
s_add_u32 s82, s82, 1
s_cmp_lt_u32 s82, 200000
s_cbranch_scc1 gt_218
s_mov_b32 s9, 200000
gt_218k:
s_add_u32 s70, s62, 16384
buffer_load_dwordx4 v[86:89], v10, s[36:39], s70 offen offset:0 sc1
buffer_load_dwordx4 v[90:93], v10, s[36:39], s70 offen offset:2048 sc1
buffer_load_dwordx4 v[94:97], v9, s[36:39], s70 offen offset:0 sc1
buffer_load_dwordx4 v[98:101], v9, s[36:39], s70 offen offset:2048 sc1
s_waitcnt vmcnt(11) lgkmcnt(5)
s_and_b32 s82, s92, 0xf00
s_cbranch_scc0 gt_219k
s_mov_b32 s82, s9
gt_219:
buffer_load_dword v2, v1, s[36:39], s94 offen sc1
s_waitcnt vmcnt(0)
v_subrev_u32 v2, s95, v2
v_cmp_lt_u32 s[92:93], 15, v2
s_and_b32 s83, s92, 0xf00
s_cbranch_scc0 gt_219k
s_add_u32 s82, s82, 1
s_cmp_lt_u32 s82, 200000
s_cbranch_scc1 gt_219
s_mov_b32 s9, 200000
gt_219k:
s_add_u32 s70, s62, 24576
v_mfma_f32_16x16x32_bf16 v[14:17], v[134:137], v[54:57], 0
ds_read_b128 v[174:177], v4 offset:51200
v_mfma_f32_16x16x32_bf16 v[18:21], v[138:141], v[54:57], 0
ds_read_b128 v[178:181], v4 offset:52224
v_mfma_f32_16x16x32_bf16 v[22:25], v[142:145], v[54:57], 0
ds_read_b128 v[182:185], v4 offset:53248
buffer_load_dwordx4 v[220:223], v10, s[36:39], s73 offen sc1
v_mfma_f32_16x16x32_bf16 v[26:29], v[146:149], v[54:57], 0
ds_read_b128 v[186:189], v4 offset:54272
v_mfma_f32_16x16x32_bf16 v[30:33], v[150:153], v[54:57], 0
ds_read_b128 v[190:193], v4 offset:55296
buffer_load_dwordx4 v[102:105], v10, s[36:39], s70 offen offset:0 sc1
s_waitcnt vmcnt(12) lgkmcnt(5)
v_mfma_f32_16x16x32_bf16 v[14:17], v[154:157], v[58:61], v[14:17]
ds_read_b128 v[134:137], v4 offset:56320
v_mfma_f32_16x16x32_bf16 v[18:21], v[158:161], v[58:61], v[18:21]
ds_read_b128 v[138:141], v4 offset:57344
v_mfma_f32_16x16x32_bf16 v[22:25], v[162:165], v[58:61], v[22:25]
ds_read_b128 v[142:145], v4 offset:58368
buffer_load_dwordx4 v[224:227], v10, s[36:39], s73 offen offset:2048 sc1
v_mfma_f32_16x16x32_bf16 v[26:29], v[166:169], v[58:61], v[26:29]
ds_read_b128 v[146:149], v4 offset:59392
v_mfma_f32_16x16x32_bf16 v[30:33], v[170:173], v[58:61], v[30:33]
ds_read_b128 v[150:153], v4 offset:60416
buffer_load_dwordx4 v[106:109], v10, s[36:39], s70 offen offset:2048 sc1
s_waitcnt vmcnt(13) lgkmcnt(5)
s_barrier
v_mfma_f32_16x16x32_bf16 v[14:17], v[174:177], v[62:65], v[14:17]
ds_read_b128 v[154:157], v5 offset:0
v_mfma_f32_16x16x32_bf16 v[18:21], v[178:181], v[62:65], v[18:21]
ds_read_b128 v[158:161], v5 offset:1024
v_mfma_f32_16x16x32_bf16 v[22:25], v[182:185], v[62:65], v[22:25]
ds_read_b128 v[162:165], v5 offset:2048
buffer_load_dwordx2 v[228:229], v11, s[36:39], s73 offen offset:0 sc1
v_mfma_f32_16x16x32_bf16 v[26:29], v[186:189], v[62:65], v[26:29]
ds_read_b128 v[166:169], v5 offset:3072
v_mfma_f32_16x16x32_bf16 v[30:33], v[190:193], v[62:65], v[30:33]
ds_read_b128 v[170:173], v5 offset:4096
buffer_load_dwordx4 v[110:113], v9, s[36:39], s70 offen offset:0 sc1
s_waitcnt vmcnt(14) lgkmcnt(5)
v_mfma_f32_16x16x32_bf16 v[14:17], v[134:137], v[66:69], v[14:17]
ds_read_b128 v[174:177], v5 offset:5120
v_mfma_f32_16x16x32_bf16 v[18:21], v[138:141], v[66:69], v[18:21]
ds_read_b128 v[178:181], v5 offset:6144
v_mfma_f32_16x16x32_bf16 v[22:25], v[142:145], v[66:69], v[22:25]
ds_read_b128 v[182:185], v5 offset:7168
buffer_load_dwordx4 v[200:203], v8, s[36:39], s74 offen offset:0 sc1
v_mfma_f32_16x16x32_bf16 v[26:29], v[146:149], v[66:69], v[26:29]
ds_read_b128 v[186:189], v5 offset:8192
v_mfma_f32_16x16x32_bf16 v[30:33], v[150:153], v[66:69], v[30:33]
ds_read_b128 v[190:193], v5 offset:9216
buffer_load_dwordx4 v[114:117], v9, s[36:39], s70 offen offset:2048 sc1
s_waitcnt vmcnt(15) lgkmcnt(5)
s_and_b32 s82, s92, 0x3000
s_cbranch_scc0 gt_220k
s_mov_b32 s82, s9
gt_220:
buffer_load_dword v2, v1, s[36:39], s94 offen sc1
s_waitcnt vmcnt(0)
v_subrev_u32 v2, s95, v2
v_cmp_lt_u32 s[92:93], 15, v2
s_and_b32 s83, s92, 0x3000
s_cbranch_scc0 gt_220k
s_add_u32 s82, s82, 1
s_cmp_lt_u32 s82, 200000
s_cbranch_scc1 gt_220
s_mov_b32 s9, 200000
gt_220k:
s_add_u32 s70, s62, 32768
v_mfma_f32_16x16x32_bf16 v[14:17], v[154:157], v[70:73], v[14:17]
ds_read_b128 v[134:137], v5 offset:10240
v_mfma_f32_16x16x32_bf16 v[18:21], v[158:161], v[70:73], v[18:21]
ds_read_b128 v[138:141], v5 offset:11264
v_mfma_f32_16x16x32_bf16 v[22:25], v[162:165], v[70:73], v[22:25]
ds_read_b128 v[142:145], v5 offset:12288
buffer_load_dwordx4 v[204:207], v8, s[36:39], s74 offen offset:1024 sc1
v_mfma_f32_16x16x32_bf16 v[26:29], v[166:169], v[70:73], v[26:29]
ds_read_b128 v[146:149], v5 offset:13312
v_mfma_f32_16x16x32_bf16 v[30:33], v[170:173], v[70:73], v[30:33]
ds_read_b128 v[150:153], v5 offset:14336
buffer_load_dwordx4 v[118:121], v10, s[36:39], s70 offen offset:0 sc1
s_waitcnt vmcnt(16) lgkmcnt(5)
v_mfma_f32_16x16x32_bf16 v[14:17], v[174:177], v[74:77], v[14:17]
ds_read_b128 v[154:157], v5 offset:15360
v_mfma_f32_16x16x32_bf16 v[18:21], v[178:181], v[74:77], v[18:21]
ds_read_b128 v[158:161], v5 offset:16384
v_mfma_f32_16x16x32_bf16 v[22:25], v[182:185], v[74:77], v[22:25]
ds_read_b128 v[162:165], v5 offset:17408
buffer_load_dwordx4 v[208:211], v8, s[36:39], s74 offen offset:2048 sc1
v_mfma_f32_16x16x32_bf16 v[26:29], v[186:189], v[74:77], v[26:29]
ds_read_b128 v[166:169], v5 offset:18432
v_mfma_f32_16x16x32_bf16 v[30:33], v[190:193], v[74:77], v[30:33]
ds_read_b128 v[170:173], v5 offset:19456
buffer_load_dwordx4 v[122:125], v10, s[36:39], s70 offen offset:2048 sc1
s_waitcnt vmcnt(17) lgkmcnt(5)
s_barrier
v_mfma_f32_16x16x32_bf16 v[14:17], v[134:137], v[78:81], v[14:17]
ds_read_b128 v[174:177], v5 offset:20480
v_mfma_f32_16x16x32_bf16 v[18:21], v[138:141], v[78:81], v[18:21]
ds_read_b128 v[178:181], v5 offset:21504
v_mfma_f32_16x16x32_bf16 v[22:25], v[142:145], v[78:81], v[22:25]
ds_read_b128 v[182:185], v5 offset:22528
buffer_load_dwordx4 v[212:215], v8, s[36:39], s74 offen offset:3072 sc1
v_mfma_f32_16x16x32_bf16 v[26:29], v[146:149], v[78:81], v[26:29]
ds_read_b128 v[186:189], v5 offset:23552
v_mfma_f32_16x16x32_bf16 v[30:33], v[150:153], v[78:81], v[30:33]
ds_read_b128 v[190:193], v5 offset:24576
buffer_load_dwordx4 v[126:129], v9, s[36:39], s70 offen offset:0 sc1
s_waitcnt vmcnt(18) lgkmcnt(5)
v_mfma_f32_16x16x32_bf16 v[14:17], v[154:157], v[82:85], v[14:17]
ds_read_b128 v[134:137], v5 offset:25600
v_mfma_f32_16x16x32_bf16 v[18:21], v[158:161], v[82:85], v[18:21]
ds_read_b128 v[138:141], v5 offset:26624
v_mfma_f32_16x16x32_bf16 v[22:25], v[162:165], v[82:85], v[22:25]
ds_read_b128 v[142:145], v5 offset:27648
v_mfma_f32_16x16x32_bf16 v[26:29], v[166:169], v[82:85], v[26:29]
ds_read_b128 v[146:149], v5 offset:28672
v_mfma_f32_16x16x32_bf16 v[30:33], v[170:173], v[82:85], v[30:33]
ds_read_b128 v[150:153], v5 offset:29696
buffer_load_dwordx4 v[130:133], v9, s[36:39], s70 offen offset:2048 sc1
s_waitcnt vmcnt(18) lgkmcnt(5)
s_and_b32 s82, s92, 0xffffc000
s_cbranch_scc0 gt_221k
s_mov_b32 s82, s9
gt_221:
buffer_load_dword v2, v1, s[36:39], s94 offen sc1
s_waitcnt vmcnt(0)
v_subrev_u32 v2, s95, v2
v_cmp_lt_u32 s[92:93], 15, v2
s_and_b32 s83, s92, 0xffffc000
s_cbranch_scc0 gt_221k
s_add_u32 s82, s82, 1
s_cmp_lt_u32 s82, 200000
s_cbranch_scc1 gt_221
s_mov_b32 s9, 200000
gt_221k:
s_add_u32 s70, s62, 40960
v_mfma_f32_16x16x32_bf16 v[14:17], v[174:177], v[86:89], v[14:17]
ds_read_b128 v[154:157], v5 offset:30720
v_mfma_f32_16x16x32_bf16 v[18:21], v[178:181], v[86:89], v[18:21]
ds_read_b128 v[158:161], v5 offset:31744
v_mfma_f32_16x16x32_bf16 v[22:25], v[182:185], v[86:89], v[22:25]
ds_read_b128 v[162:165], v5 offset:32768
v_mfma_f32_16x16x32_bf16 v[26:29], v[186:189], v[86:89], v[26:29]
ds_read_b128 v[166:169], v5 offset:33792
v_mfma_f32_16x16x32_bf16 v[30:33], v[190:193], v[86:89], v[30:33]
ds_read_b128 v[170:173], v5 offset:34816
buffer_load_dwordx4 v[54:57], v10, s[36:39], s70 offen offset:0 sc1
s_waitcnt vmcnt(18) lgkmcnt(5)
v_mfma_f32_16x16x32_bf16 v[14:17], v[134:137], v[90:93], v[14:17]
ds_read_b128 v[174:177], v5 offset:35840
v_mfma_f32_16x16x32_bf16 v[18:21], v[138:141], v[90:93], v[18:21]
ds_read_b128 v[178:181], v5 offset:36864
v_mfma_f32_16x16x32_bf16 v[22:25], v[142:145], v[90:93], v[22:25]
ds_read_b128 v[182:185], v5 offset:37888
v_mfma_f32_16x16x32_bf16 v[26:29], v[146:149], v[90:93], v[26:29]
ds_read_b128 v[186:189], v5 offset:38912
v_mfma_f32_16x16x32_bf16 v[30:33], v[150:153], v[90:93], v[30:33]
ds_read_b128 v[190:193], v5 offset:39936
buffer_load_dwordx4 v[58:61], v10, s[36:39], s70 offen offset:2048 sc1
s_waitcnt vmcnt(18) lgkmcnt(5)
s_barrier
v_mfma_f32_16x16x32_bf16 v[14:17], v[154:157], v[94:97], v[14:17]
ds_read_b128 v[134:137], v5 offset:40960
v_mfma_f32_16x16x32_bf16 v[18:21], v[158:161], v[94:97], v[18:21]
ds_read_b128 v[138:141], v5 offset:41984
v_mfma_f32_16x16x32_bf16 v[22:25], v[162:165], v[94:97], v[22:25]
ds_read_b128 v[142:145], v5 offset:43008
v_mfma_f32_16x16x32_bf16 v[26:29], v[166:169], v[94:97], v[26:29]
ds_read_b128 v[146:149], v5 offset:44032
v_mfma_f32_16x16x32_bf16 v[30:33], v[170:173], v[94:97], v[30:33]
ds_read_b128 v[150:153], v5 offset:45056
buffer_load_dwordx4 v[62:65], v9, s[36:39], s70 offen offset:0 sc1
s_waitcnt vmcnt(18) lgkmcnt(5)
v_mfma_f32_16x16x32_bf16 v[14:17], v[174:177], v[98:101], v[14:17]
ds_read_b128 v[154:157], v5 offset:46080
v_mfma_f32_16x16x32_bf16 v[18:21], v[178:181], v[98:101], v[18:21]
ds_read_b128 v[158:161], v5 offset:47104
v_mfma_f32_16x16x32_bf16 v[22:25], v[182:185], v[98:101], v[22:25]
ds_read_b128 v[162:165], v5 offset:48128
v_mfma_f32_16x16x32_bf16 v[26:29], v[186:189], v[98:101], v[26:29]
ds_read_b128 v[166:169], v5 offset:49152
v_mfma_f32_16x16x32_bf16 v[30:33], v[190:193], v[98:101], v[30:33]
ds_read_b128 v[170:173], v5 offset:50176
buffer_load_dwordx4 v[66:69], v9, s[36:39], s70 offen offset:2048 sc1
s_waitcnt vmcnt(17) lgkmcnt(5)
s_add_u32 s70, s62, 49152
v_mfma_f32_16x16x32_bf16 v[14:17], v[134:137], v[102:105], v[14:17]
ds_read_b128 v[174:177], v5 offset:51200
v_mfma_f32_16x16x32_bf16 v[18:21], v[138:141], v[102:105], v[18:21]
ds_read_b128 v[178:181], v5 offset:52224
v_mfma_f32_16x16x32_bf16 v[22:25], v[142:145], v[102:105], v[22:25]
ds_read_b128 v[182:185], v5 offset:53248
v_mfma_f32_16x16x32_bf16 v[26:29], v[146:149], v[102:105], v[26:29]
ds_read_b128 v[186:189], v5 offset:54272
v_mfma_f32_16x16x32_bf16 v[30:33], v[150:153], v[102:105], v[30:33]
ds_read_b128 v[190:193], v5 offset:55296
buffer_load_dwordx4 v[70:73], v10, s[36:39], s70 offen offset:0 sc1
s_waitcnt vmcnt(16) lgkmcnt(5)
v_mfma_f32_16x16x32_bf16 v[14:17], v[154:157], v[106:109], v[14:17]
ds_read_b128 v[134:137], v5 offset:56320
v_mfma_f32_16x16x32_bf16 v[18:21], v[158:161], v[106:109], v[18:21]
ds_read_b128 v[138:141], v5 offset:57344
v_mfma_f32_16x16x32_bf16 v[22:25], v[162:165], v[106:109], v[22:25]
ds_read_b128 v[142:145], v5 offset:58368
v_mfma_f32_16x16x32_bf16 v[26:29], v[166:169], v[106:109], v[26:29]
ds_read_b128 v[146:149], v5 offset:59392
v_mfma_f32_16x16x32_bf16 v[30:33], v[170:173], v[106:109], v[30:33]
ds_read_b128 v[150:153], v5 offset:60416
buffer_load_dwordx4 v[74:77], v10, s[36:39], s70 offen offset:2048 sc1
s_waitcnt vmcnt(15) lgkmcnt(5)
s_barrier
v_mfma_f32_16x16x32_bf16 v[14:17], v[174:177], v[110:113], v[14:17]
ds_read_b128 v[154:157], v6 offset:0
v_mfma_f32_16x16x32_bf16 v[18:21], v[178:181], v[110:113], v[18:21]
ds_read_b128 v[158:161], v6 offset:1024
v_mfma_f32_16x16x32_bf16 v[22:25], v[182:185], v[110:113], v[22:25]
ds_read_b128 v[162:165], v6 offset:2048
v_mfma_f32_16x16x32_bf16 v[26:29], v[186:189], v[110:113], v[26:29]
ds_read_b128 v[166:169], v6 offset:3072
v_mfma_f32_16x16x32_bf16 v[30:33], v[190:193], v[110:113], v[30:33]
ds_read_b128 v[170:173], v6 offset:4096
buffer_load_dwordx4 v[78:81], v9, s[36:39], s70 offen offset:0 sc1
s_waitcnt vmcnt(14) lgkmcnt(5)
v_mfma_f32_16x16x32_bf16 v[14:17], v[134:137], v[114:117], v[14:17]
ds_read_b128 v[174:177], v6 offset:5120
v_mfma_f32_16x16x32_bf16 v[18:21], v[138:141], v[114:117], v[18:21]
ds_read_b128 v[178:181], v6 offset:6144
v_mfma_f32_16x16x32_bf16 v[22:25], v[142:145], v[114:117], v[22:25]
ds_read_b128 v[182:185], v6 offset:7168
v_mfma_f32_16x16x32_bf16 v[26:29], v[146:149], v[114:117], v[26:29]
ds_read_b128 v[186:189], v6 offset:8192
v_mfma_f32_16x16x32_bf16 v[30:33], v[150:153], v[114:117], v[30:33]
ds_read_b128 v[190:193], v6 offset:9216
buffer_load_dwordx4 v[82:85], v9, s[36:39], s70 offen offset:2048 sc1
s_waitcnt vmcnt(13) lgkmcnt(5)
s_add_u32 s70, s62, 57344
v_mfma_f32_16x16x32_bf16 v[14:17], v[154:157], v[118:121], v[14:17]
ds_read_b128 v[134:137], v6 offset:10240
v_mfma_f32_16x16x32_bf16 v[18:21], v[158:161], v[118:121], v[18:21]
ds_read_b128 v[138:141], v6 offset:11264
v_mfma_f32_16x16x32_bf16 v[22:25], v[162:165], v[118:121], v[22:25]
ds_read_b128 v[142:145], v6 offset:12288
v_mfma_f32_16x16x32_bf16 v[26:29], v[166:169], v[118:121], v[26:29]
ds_read_b128 v[146:149], v6 offset:13312
v_mfma_f32_16x16x32_bf16 v[30:33], v[170:173], v[118:121], v[30:33]
ds_read_b128 v[150:153], v6 offset:14336
buffer_load_dwordx4 v[86:89], v10, s[36:39], s70 offen offset:0 sc1
s_waitcnt vmcnt(12) lgkmcnt(5)
v_mfma_f32_16x16x32_bf16 v[14:17], v[174:177], v[122:125], v[14:17]
ds_read_b128 v[154:157], v6 offset:15360
v_mfma_f32_16x16x32_bf16 v[18:21], v[178:181], v[122:125], v[18:21]
ds_read_b128 v[158:161], v6 offset:16384
v_mfma_f32_16x16x32_bf16 v[22:25], v[182:185], v[122:125], v[22:25]
ds_read_b128 v[162:165], v6 offset:17408
v_mfma_f32_16x16x32_bf16 v[26:29], v[186:189], v[122:125], v[26:29]
ds_read_b128 v[166:169], v6 offset:18432
v_mfma_f32_16x16x32_bf16 v[30:33], v[190:193], v[122:125], v[30:33]
ds_read_b128 v[170:173], v6 offset:19456
buffer_load_dwordx4 v[90:93], v10, s[36:39], s70 offen offset:2048 sc1
s_waitcnt vmcnt(11) lgkmcnt(5)
s_barrier
v_mfma_f32_16x16x32_bf16 v[14:17], v[134:137], v[126:129], v[14:17]
ds_read_b128 v[174:177], v6 offset:20480
v_mfma_f32_16x16x32_bf16 v[18:21], v[138:141], v[126:129], v[18:21]
ds_read_b128 v[178:181], v6 offset:21504
v_mfma_f32_16x16x32_bf16 v[22:25], v[142:145], v[126:129], v[22:25]
ds_read_b128 v[182:185], v6 offset:22528
v_mfma_f32_16x16x32_bf16 v[26:29], v[146:149], v[126:129], v[26:29]
ds_read_b128 v[186:189], v6 offset:23552
v_mfma_f32_16x16x32_bf16 v[30:33], v[150:153], v[126:129], v[30:33]
ds_read_b128 v[190:193], v6 offset:24576
buffer_load_dwordx4 v[94:97], v9, s[36:39], s70 offen offset:0 sc1
s_waitcnt vmcnt(11) lgkmcnt(5)
v_mfma_f32_16x16x32_bf16 v[14:17], v[154:157], v[130:133], v[14:17]
ds_read_b128 v[134:137], v6 offset:25600
v_mfma_f32_16x16x32_bf16 v[18:21], v[158:161], v[130:133], v[18:21]
ds_read_b128 v[138:141], v6 offset:26624
v_mfma_f32_16x16x32_bf16 v[22:25], v[162:165], v[130:133], v[22:25]
ds_read_b128 v[142:145], v6 offset:27648
v_mfma_f32_16x16x32_bf16 v[26:29], v[166:169], v[130:133], v[26:29]
ds_read_b128 v[146:149], v6 offset:28672
v_mfma_f32_16x16x32_bf16 v[30:33], v[170:173], v[130:133], v[30:33]
ds_read_b128 v[150:153], v6 offset:29696
buffer_load_dwordx4 v[98:101], v9, s[36:39], s70 offen offset:2048 sc1
s_waitcnt vmcnt(11) lgkmcnt(5)
s_add_u32 s70, s62, 65536
v_mfma_f32_16x16x32_bf16 v[14:17], v[174:177], v[54:57], v[14:17]
ds_read_b128 v[154:157], v6 offset:30720
v_mfma_f32_16x16x32_bf16 v[18:21], v[178:181], v[54:57], v[18:21]
ds_read_b128 v[158:161], v6 offset:31744
v_mfma_f32_16x16x32_bf16 v[22:25], v[182:185], v[54:57], v[22:25]
ds_read_b128 v[162:165], v6 offset:32768
v_mfma_f32_16x16x32_bf16 v[26:29], v[186:189], v[54:57], v[26:29]
ds_read_b128 v[166:169], v6 offset:33792
v_mfma_f32_16x16x32_bf16 v[30:33], v[190:193], v[54:57], v[30:33]
ds_read_b128 v[170:173], v6 offset:34816
buffer_load_dwordx4 v[102:105], v10, s[36:39], s70 offen offset:0 sc1
s_waitcnt vmcnt(11) lgkmcnt(5)
v_mfma_f32_16x16x32_bf16 v[14:17], v[134:137], v[58:61], v[14:17]
ds_read_b128 v[174:177], v6 offset:35840
v_mfma_f32_16x16x32_bf16 v[18:21], v[138:141], v[58:61], v[18:21]
ds_read_b128 v[178:181], v6 offset:36864
v_mfma_f32_16x16x32_bf16 v[22:25], v[142:145], v[58:61], v[22:25]
ds_read_b128 v[182:185], v6 offset:37888
v_mfma_f32_16x16x32_bf16 v[26:29], v[146:149], v[58:61], v[26:29]
ds_read_b128 v[186:189], v6 offset:38912
v_mfma_f32_16x16x32_bf16 v[30:33], v[150:153], v[58:61], v[30:33]
ds_read_b128 v[190:193], v6 offset:39936
buffer_load_dwordx4 v[106:109], v10, s[36:39], s70 offen offset:2048 sc1
s_waitcnt vmcnt(11) lgkmcnt(5)
s_barrier
v_mfma_f32_16x16x32_bf16 v[14:17], v[154:157], v[62:65], v[14:17]
ds_read_b128 v[134:137], v4 offset:0
v_mfma_f32_16x16x32_bf16 v[18:21], v[158:161], v[62:65], v[18:21]
ds_read_b128 v[138:141], v4 offset:1024
v_mfma_f32_16x16x32_bf16 v[22:25], v[162:165], v[62:65], v[22:25]
ds_read_b128 v[142:145], v4 offset:2048
v_mfma_f32_16x16x32_bf16 v[26:29], v[166:169], v[62:65], v[26:29]
ds_read_b128 v[146:149], v4 offset:3072
v_mfma_f32_16x16x32_bf16 v[30:33], v[170:173], v[62:65], v[30:33]
ds_read_b128 v[150:153], v4 offset:4096
buffer_load_dwordx4 v[110:113], v9, s[36:39], s70 offen offset:0 sc1
s_waitcnt vmcnt(11) lgkmcnt(5)
v_mfma_f32_16x16x32_bf16 v[14:17], v[174:177], v[66:69], v[14:17]
ds_read_b128 v[154:157], v4 offset:5120
v_mfma_f32_16x16x32_bf16 v[18:21], v[178:181], v[66:69], v[18:21]
ds_read_b128 v[158:161], v4 offset:6144
v_mfma_f32_16x16x32_bf16 v[22:25], v[182:185], v[66:69], v[22:25]
ds_read_b128 v[162:165], v4 offset:7168
v_mfma_f32_16x16x32_bf16 v[26:29], v[186:189], v[66:69], v[26:29]
ds_read_b128 v[166:169], v4 offset:8192
v_mfma_f32_16x16x32_bf16 v[30:33], v[190:193], v[66:69], v[30:33]
ds_read_b128 v[170:173], v4 offset:9216
buffer_load_dwordx4 v[114:117], v9, s[36:39], s70 offen offset:2048 sc1
s_waitcnt vmcnt(11) lgkmcnt(5)
s_add_u32 s70, s62, 73728
v_mfma_f32_16x16x32_bf16 v[14:17], v[134:137], v[70:73], v[14:17]
ds_read_b128 v[174:177], v4 offset:10240
v_mfma_f32_16x16x32_bf16 v[18:21], v[138:141], v[70:73], v[18:21]
ds_read_b128 v[178:181], v4 offset:11264
v_mfma_f32_16x16x32_bf16 v[22:25], v[142:145], v[70:73], v[22:25]
ds_read_b128 v[182:185], v4 offset:12288
v_mfma_f32_16x16x32_bf16 v[26:29], v[146:149], v[70:73], v[26:29]
ds_read_b128 v[186:189], v4 offset:13312
v_mfma_f32_16x16x32_bf16 v[30:33], v[150:153], v[70:73], v[30:33]
ds_read_b128 v[190:193], v4 offset:14336
buffer_load_dwordx4 v[118:121], v10, s[36:39], s70 offen offset:0 sc1
s_waitcnt vmcnt(11) lgkmcnt(5)
v_mfma_f32_16x16x32_bf16 v[14:17], v[154:157], v[74:77], v[14:17]
ds_read_b128 v[134:137], v4 offset:15360
v_mfma_f32_16x16x32_bf16 v[18:21], v[158:161], v[74:77], v[18:21]
ds_read_b128 v[138:141], v4 offset:16384
v_mfma_f32_16x16x32_bf16 v[22:25], v[162:165], v[74:77], v[22:25]
ds_read_b128 v[142:145], v4 offset:17408
v_mfma_f32_16x16x32_bf16 v[26:29], v[166:169], v[74:77], v[26:29]
ds_read_b128 v[146:149], v4 offset:18432
v_mfma_f32_16x16x32_bf16 v[30:33], v[170:173], v[74:77], v[30:33]
ds_read_b128 v[150:153], v4 offset:19456
buffer_load_dwordx4 v[122:125], v10, s[36:39], s70 offen offset:2048 sc1
s_waitcnt vmcnt(11) lgkmcnt(5)
s_barrier
v_mfma_f32_16x16x32_bf16 v[14:17], v[174:177], v[78:81], v[14:17]
ds_read_b128 v[154:157], v4 offset:20480
v_mfma_f32_16x16x32_bf16 v[18:21], v[178:181], v[78:81], v[18:21]
ds_read_b128 v[158:161], v4 offset:21504
v_mfma_f32_16x16x32_bf16 v[22:25], v[182:185], v[78:81], v[22:25]
ds_read_b128 v[162:165], v4 offset:22528
v_mfma_f32_16x16x32_bf16 v[26:29], v[186:189], v[78:81], v[26:29]
ds_read_b128 v[166:169], v4 offset:23552
v_mfma_f32_16x16x32_bf16 v[30:33], v[190:193], v[78:81], v[30:33]
ds_read_b128 v[170:173], v4 offset:24576
buffer_load_dwordx4 v[126:129], v9, s[36:39], s70 offen offset:0 sc1
s_waitcnt vmcnt(11) lgkmcnt(5)
v_mfma_f32_16x16x32_bf16 v[14:17], v[134:137], v[82:85], v[14:17]
ds_read_b128 v[174:177], v4 offset:25600
v_mfma_f32_16x16x32_bf16 v[18:21], v[138:141], v[82:85], v[18:21]
ds_read_b128 v[178:181], v4 offset:26624
v_mfma_f32_16x16x32_bf16 v[22:25], v[142:145], v[82:85], v[22:25]
ds_read_b128 v[182:185], v4 offset:27648
v_mfma_f32_16x16x32_bf16 v[26:29], v[146:149], v[82:85], v[26:29]
ds_read_b128 v[186:189], v4 offset:28672
v_mfma_f32_16x16x32_bf16 v[30:33], v[150:153], v[82:85], v[30:33]
ds_read_b128 v[190:193], v4 offset:29696
buffer_load_dwordx4 v[130:133], v9, s[36:39], s70 offen offset:2048 sc1
s_waitcnt vmcnt(11) lgkmcnt(5)
s_add_u32 s70, s62, 81920
v_mfma_f32_16x16x32_bf16 v[14:17], v[154:157], v[86:89], v[14:17]
ds_read_b128 v[134:137], v4 offset:30720
v_mfma_f32_16x16x32_bf16 v[18:21], v[158:161], v[86:89], v[18:21]
ds_read_b128 v[138:141], v4 offset:31744
v_mfma_f32_16x16x32_bf16 v[22:25], v[162:165], v[86:89], v[22:25]
ds_read_b128 v[142:145], v4 offset:32768
v_mfma_f32_16x16x32_bf16 v[26:29], v[166:169], v[86:89], v[26:29]
ds_read_b128 v[146:149], v4 offset:33792
v_mfma_f32_16x16x32_bf16 v[30:33], v[170:173], v[86:89], v[30:33]
ds_read_b128 v[150:153], v4 offset:34816
buffer_load_dwordx4 v[54:57], v10, s[36:39], s70 offen offset:0 sc1
s_waitcnt vmcnt(11) lgkmcnt(5)
v_mfma_f32_16x16x32_bf16 v[14:17], v[174:177], v[90:93], v[14:17]
ds_read_b128 v[154:157], v4 offset:35840
v_mfma_f32_16x16x32_bf16 v[18:21], v[178:181], v[90:93], v[18:21]
ds_read_b128 v[158:161], v4 offset:36864
v_mfma_f32_16x16x32_bf16 v[22:25], v[182:185], v[90:93], v[22:25]
ds_read_b128 v[162:165], v4 offset:37888
v_mfma_f32_16x16x32_bf16 v[26:29], v[186:189], v[90:93], v[26:29]
ds_read_b128 v[166:169], v4 offset:38912
v_mfma_f32_16x16x32_bf16 v[30:33], v[190:193], v[90:93], v[30:33]
ds_read_b128 v[170:173], v4 offset:39936
buffer_load_dwordx4 v[58:61], v10, s[36:39], s70 offen offset:2048 sc1
s_waitcnt vmcnt(11) lgkmcnt(5)
s_barrier
v_mfma_f32_16x16x32_bf16 v[14:17], v[134:137], v[94:97], v[14:17]
ds_read_b128 v[174:177], v4 offset:40960
v_mfma_f32_16x16x32_bf16 v[18:21], v[138:141], v[94:97], v[18:21]
ds_read_b128 v[178:181], v4 offset:41984
v_mfma_f32_16x16x32_bf16 v[22:25], v[142:145], v[94:97], v[22:25]
ds_read_b128 v[182:185], v4 offset:43008
v_mfma_f32_16x16x32_bf16 v[26:29], v[146:149], v[94:97], v[26:29]
ds_read_b128 v[186:189], v4 offset:44032
v_mfma_f32_16x16x32_bf16 v[30:33], v[150:153], v[94:97], v[30:33]
ds_read_b128 v[190:193], v4 offset:45056
buffer_load_dwordx4 v[62:65], v9, s[36:39], s70 offen offset:0 sc1
s_waitcnt vmcnt(11) lgkmcnt(5)
v_mfma_f32_16x16x32_bf16 v[14:17], v[154:157], v[98:101], v[14:17]
ds_read_b128 v[134:137], v4 offset:46080
v_mfma_f32_16x16x32_bf16 v[18:21], v[158:161], v[98:101], v[18:21]
ds_read_b128 v[138:141], v4 offset:47104
v_mfma_f32_16x16x32_bf16 v[22:25], v[162:165], v[98:101], v[22:25]
ds_read_b128 v[142:145], v4 offset:48128
v_mfma_f32_16x16x32_bf16 v[26:29], v[166:169], v[98:101], v[26:29]
ds_read_b128 v[146:149], v4 offset:49152
v_mfma_f32_16x16x32_bf16 v[30:33], v[170:173], v[98:101], v[30:33]
ds_read_b128 v[150:153], v4 offset:50176
buffer_load_dwordx4 v[66:69], v9, s[36:39], s70 offen offset:2048 sc1
s_waitcnt vmcnt(11) lgkmcnt(5)
s_add_u32 s70, s62, 90112
v_mfma_f32_16x16x32_bf16 v[14:17], v[174:177], v[102:105], v[14:17]
ds_read_b128 v[154:157], v4 offset:51200
v_mfma_f32_16x16x32_bf16 v[18:21], v[178:181], v[102:105], v[18:21]
ds_read_b128 v[158:161], v4 offset:52224
v_mfma_f32_16x16x32_bf16 v[22:25], v[182:185], v[102:105], v[22:25]
ds_read_b128 v[162:165], v4 offset:53248
v_mfma_f32_16x16x32_bf16 v[26:29], v[186:189], v[102:105], v[26:29]
ds_read_b128 v[166:169], v4 offset:54272
v_mfma_f32_16x16x32_bf16 v[30:33], v[190:193], v[102:105], v[30:33]
ds_read_b128 v[170:173], v4 offset:55296
buffer_load_dwordx4 v[70:73], v10, s[36:39], s70 offen offset:0 sc1
s_waitcnt vmcnt(11) lgkmcnt(5)
v_mfma_f32_16x16x32_bf16 v[14:17], v[134:137], v[106:109], v[14:17]
ds_read_b128 v[174:177], v4 offset:56320
v_mfma_f32_16x16x32_bf16 v[18:21], v[138:141], v[106:109], v[18:21]
ds_read_b128 v[178:181], v4 offset:57344
v_mfma_f32_16x16x32_bf16 v[22:25], v[142:145], v[106:109], v[22:25]
ds_read_b128 v[182:185], v4 offset:58368
v_mfma_f32_16x16x32_bf16 v[26:29], v[146:149], v[106:109], v[26:29]
ds_read_b128 v[186:189], v4 offset:59392
v_mfma_f32_16x16x32_bf16 v[30:33], v[150:153], v[106:109], v[30:33]
ds_read_b128 v[190:193], v4 offset:60416
buffer_load_dwordx4 v[74:77], v10, s[36:39], s70 offen offset:2048 sc1
s_waitcnt vmcnt(11) lgkmcnt(5)
s_barrier
v_mfma_f32_16x16x32_bf16 v[14:17], v[154:157], v[110:113], v[14:17]
ds_read_b128 v[134:137], v5 offset:0
v_mfma_f32_16x16x32_bf16 v[18:21], v[158:161], v[110:113], v[18:21]
ds_read_b128 v[138:141], v5 offset:1024
v_mfma_f32_16x16x32_bf16 v[22:25], v[162:165], v[110:113], v[22:25]
ds_read_b128 v[142:145], v5 offset:2048
v_mfma_f32_16x16x32_bf16 v[26:29], v[166:169], v[110:113], v[26:29]
ds_read_b128 v[146:149], v5 offset:3072
v_mfma_f32_16x16x32_bf16 v[30:33], v[170:173], v[110:113], v[30:33]
ds_read_b128 v[150:153], v5 offset:4096
buffer_load_dwordx4 v[78:81], v9, s[36:39], s70 offen offset:0 sc1
s_waitcnt vmcnt(11) lgkmcnt(5)
v_mfma_f32_16x16x32_bf16 v[14:17], v[174:177], v[114:117], v[14:17]
ds_read_b128 v[154:157], v5 offset:5120
v_mfma_f32_16x16x32_bf16 v[18:21], v[178:181], v[114:117], v[18:21]
ds_read_b128 v[158:161], v5 offset:6144
v_mfma_f32_16x16x32_bf16 v[22:25], v[182:185], v[114:117], v[22:25]
ds_read_b128 v[162:165], v5 offset:7168
v_mfma_f32_16x16x32_bf16 v[26:29], v[186:189], v[114:117], v[26:29]
ds_read_b128 v[166:169], v5 offset:8192
v_mfma_f32_16x16x32_bf16 v[30:33], v[190:193], v[114:117], v[30:33]
ds_read_b128 v[170:173], v5 offset:9216
buffer_load_dwordx4 v[82:85], v9, s[36:39], s70 offen offset:2048 sc1
s_waitcnt vmcnt(11) lgkmcnt(5)
v_mfma_f32_16x16x32_bf16 v[14:17], v[134:137], v[118:121], v[14:17]
ds_read_b128 v[174:177], v5 offset:10240
v_mfma_f32_16x16x32_bf16 v[18:21], v[138:141], v[118:121], v[18:21]
ds_read_b128 v[178:181], v5 offset:11264
v_mfma_f32_16x16x32_bf16 v[22:25], v[142:145], v[118:121], v[22:25]
ds_read_b128 v[182:185], v5 offset:12288
v_mfma_f32_16x16x32_bf16 v[26:29], v[146:149], v[118:121], v[26:29]
ds_read_b128 v[186:189], v5 offset:13312
v_mfma_f32_16x16x32_bf16 v[30:33], v[150:153], v[118:121], v[30:33]
ds_read_b128 v[190:193], v5 offset:14336
s_waitcnt vmcnt(10) lgkmcnt(5)
v_mfma_f32_16x16x32_bf16 v[14:17], v[154:157], v[122:125], v[14:17]
ds_read_b128 v[134:137], v5 offset:15360
v_mfma_f32_16x16x32_bf16 v[18:21], v[158:161], v[122:125], v[18:21]
ds_read_b128 v[138:141], v5 offset:16384
v_mfma_f32_16x16x32_bf16 v[22:25], v[162:165], v[122:125], v[22:25]
ds_read_b128 v[142:145], v5 offset:17408
v_mfma_f32_16x16x32_bf16 v[26:29], v[166:169], v[122:125], v[26:29]
ds_read_b128 v[146:149], v5 offset:18432
v_mfma_f32_16x16x32_bf16 v[30:33], v[170:173], v[122:125], v[30:33]
ds_read_b128 v[150:153], v5 offset:19456
s_waitcnt vmcnt(9) lgkmcnt(5)
s_barrier
v_mfma_f32_16x16x32_bf16 v[14:17], v[174:177], v[126:129], v[14:17]
ds_read_b128 v[154:157], v5 offset:20480
v_mfma_f32_16x16x32_bf16 v[18:21], v[178:181], v[126:129], v[18:21]
ds_read_b128 v[158:161], v5 offset:21504
v_mfma_f32_16x16x32_bf16 v[22:25], v[182:185], v[126:129], v[22:25]
ds_read_b128 v[162:165], v5 offset:22528
v_mfma_f32_16x16x32_bf16 v[26:29], v[186:189], v[126:129], v[26:29]
ds_read_b128 v[166:169], v5 offset:23552
v_mfma_f32_16x16x32_bf16 v[30:33], v[190:193], v[126:129], v[30:33]
ds_read_b128 v[170:173], v5 offset:24576
s_waitcnt vmcnt(8) lgkmcnt(5)
v_mfma_f32_16x16x32_bf16 v[14:17], v[134:137], v[130:133], v[14:17]
ds_read_b128 v[174:177], v5 offset:25600
v_mfma_f32_16x16x32_bf16 v[18:21], v[138:141], v[130:133], v[18:21]
ds_read_b128 v[178:181], v5 offset:26624
v_mfma_f32_16x16x32_bf16 v[22:25], v[142:145], v[130:133], v[22:25]
ds_read_b128 v[182:185], v5 offset:27648
v_mfma_f32_16x16x32_bf16 v[26:29], v[146:149], v[130:133], v[26:29]
ds_read_b128 v[186:189], v5 offset:28672
v_mfma_f32_16x16x32_bf16 v[30:33], v[150:153], v[130:133], v[30:33]
ds_read_b128 v[190:193], v5 offset:29696
s_waitcnt vmcnt(7) lgkmcnt(5)
v_mfma_f32_16x16x32_bf16 v[14:17], v[154:157], v[54:57], v[14:17]
ds_read_b128 v[134:137], v5 offset:30720
v_lshlrev_b32 v34, 16, v220
v_mfma_f32_16x16x32_bf16 v[18:21], v[158:161], v[54:57], v[18:21]
ds_read_b128 v[138:141], v5 offset:31744
v_and_b32 v35, s68, v220
v_mfma_f32_16x16x32_bf16 v[22:25], v[162:165], v[54:57], v[22:25]
ds_read_b128 v[142:145], v5 offset:32768
v_lshlrev_b32 v36, 16, v221
v_mfma_f32_16x16x32_bf16 v[26:29], v[166:169], v[54:57], v[26:29]
ds_read_b128 v[146:149], v5 offset:33792
v_and_b32 v37, s68, v221
v_mfma_f32_16x16x32_bf16 v[30:33], v[170:173], v[54:57], v[30:33]
ds_read_b128 v[150:153], v5 offset:34816
v_lshlrev_b32 v38, 16, v222
s_waitcnt vmcnt(6) lgkmcnt(5)
v_mfma_f32_16x16x32_bf16 v[14:17], v[174:177], v[58:61], v[14:17]
ds_read_b128 v[154:157], v5 offset:35840
v_and_b32 v39, s68, v222
v_mfma_f32_16x16x32_bf16 v[18:21], v[178:181], v[58:61], v[18:21]
ds_read_b128 v[158:161], v5 offset:36864
v_lshlrev_b32 v40, 16, v223
v_mfma_f32_16x16x32_bf16 v[22:25], v[182:185], v[58:61], v[22:25]
ds_read_b128 v[162:165], v5 offset:37888
v_and_b32 v41, s68, v223
v_mfma_f32_16x16x32_bf16 v[26:29], v[186:189], v[58:61], v[26:29]
ds_read_b128 v[166:169], v5 offset:38912
v_lshlrev_b32 v42, 16, v224
v_mfma_f32_16x16x32_bf16 v[30:33], v[190:193], v[58:61], v[30:33]
ds_read_b128 v[170:173], v5 offset:39936
v_and_b32 v43, s68, v224
s_waitcnt vmcnt(5) lgkmcnt(5)
s_barrier
v_mfma_f32_16x16x32_bf16 v[14:17], v[134:137], v[62:65], v[14:17]
ds_read_b128 v[174:177], v5 offset:40960
v_lshlrev_b32 v44, 16, v225
v_mfma_f32_16x16x32_bf16 v[18:21], v[138:141], v[62:65], v[18:21]
ds_read_b128 v[178:181], v5 offset:41984
v_and_b32 v45, s68, v225
v_mfma_f32_16x16x32_bf16 v[22:25], v[142:145], v[62:65], v[22:25]
ds_read_b128 v[182:185], v5 offset:43008
v_lshlrev_b32 v46, 16, v226
v_mfma_f32_16x16x32_bf16 v[26:29], v[146:149], v[62:65], v[26:29]
ds_read_b128 v[186:189], v5 offset:44032
v_and_b32 v47, s68, v226
v_mfma_f32_16x16x32_bf16 v[30:33], v[150:153], v[62:65], v[30:33]
ds_read_b128 v[190:193], v5 offset:45056
v_lshlrev_b32 v48, 16, v227
s_waitcnt vmcnt(4) lgkmcnt(5)
v_mfma_f32_16x16x32_bf16 v[14:17], v[154:157], v[66:69], v[14:17]
ds_read_b128 v[134:137], v5 offset:46080
v_and_b32 v49, s68, v227
v_mfma_f32_16x16x32_bf16 v[18:21], v[158:161], v[66:69], v[18:21]
ds_read_b128 v[138:141], v5 offset:47104
v_lshlrev_b32 v50, 16, v228
v_mfma_f32_16x16x32_bf16 v[22:25], v[162:165], v[66:69], v[22:25]
ds_read_b128 v[142:145], v5 offset:48128
v_and_b32 v51, s68, v228
v_mfma_f32_16x16x32_bf16 v[26:29], v[166:169], v[66:69], v[26:29]
ds_read_b128 v[146:149], v5 offset:49152
v_lshlrev_b32 v52, 16, v229
v_mfma_f32_16x16x32_bf16 v[30:33], v[170:173], v[66:69], v[30:33]
ds_read_b128 v[150:153], v5 offset:50176
v_and_b32 v53, s68, v229
s_waitcnt vmcnt(3) lgkmcnt(5)
v_mfma_f32_16x16x32_bf16 v[14:17], v[174:177], v[70:73], v[14:17]
ds_read_b128 v[154:157], v5 offset:51200
v_add_f32 v200, v200, v202
v_mfma_f32_16x16x32_bf16 v[18:21], v[178:181], v[70:73], v[18:21]
ds_read_b128 v[158:161], v5 offset:52224
v_add_f32 v201, v201, v203
v_mfma_f32_16x16x32_bf16 v[22:25], v[182:185], v[70:73], v[22:25]
ds_read_b128 v[162:165], v5 offset:53248
v_add_f32 v200, v200, v204
v_mfma_f32_16x16x32_bf16 v[26:29], v[186:189], v[70:73], v[26:29]
ds_read_b128 v[166:169], v5 offset:54272
v_add_f32 v201, v201, v205
v_mfma_f32_16x16x32_bf16 v[30:33], v[190:193], v[70:73], v[30:33]
ds_read_b128 v[170:173], v5 offset:55296
v_add_f32 v200, v200, v206
s_waitcnt vmcnt(2) lgkmcnt(5)
v_mfma_f32_16x16x32_bf16 v[14:17], v[134:137], v[74:77], v[14:17]
ds_read_b128 v[174:177], v5 offset:56320
v_add_f32 v201, v201, v207
v_mfma_f32_16x16x32_bf16 v[18:21], v[138:141], v[74:77], v[18:21]
ds_read_b128 v[178:181], v5 offset:57344
v_add_f32 v200, v200, v208
v_mfma_f32_16x16x32_bf16 v[22:25], v[142:145], v[74:77], v[22:25]
ds_read_b128 v[182:185], v5 offset:58368
v_add_f32 v201, v201, v209
v_mfma_f32_16x16x32_bf16 v[26:29], v[146:149], v[74:77], v[26:29]
ds_read_b128 v[186:189], v5 offset:59392
v_add_f32 v200, v200, v210
v_mfma_f32_16x16x32_bf16 v[30:33], v[150:153], v[74:77], v[30:33]
ds_read_b128 v[190:193], v5 offset:60416
v_add_f32 v201, v201, v211
s_waitcnt vmcnt(1) lgkmcnt(5)
v_mfma_f32_16x16x32_bf16 v[14:17], v[154:157], v[78:81], v[14:17]
v_add_f32 v200, v200, v212
v_add_f32 v201, v201, v213
v_mfma_f32_16x16x32_bf16 v[18:21], v[158:161], v[78:81], v[18:21]
v_add_f32 v200, v200, v214
v_add_f32 v201, v201, v215
v_mfma_f32_16x16x32_bf16 v[22:25], v[162:165], v[78:81], v[22:25]
v_mul_f32 v202, 0x3acccccd, v200
v_mul_f32 v201, 0x3acccccd, v201
v_mfma_f32_16x16x32_bf16 v[26:29], v[166:169], v[78:81], v[26:29]
v_fma_f32 v201, -v202, v202, v201
v_max_f32 v201, 0, v201
v_mfma_f32_16x16x32_bf16 v[30:33], v[170:173], v[78:81], v[30:33]
v_add_f32 v201, 0x3727c5ac, v201
v_rsq_f32 v203, v201
s_waitcnt vmcnt(0) lgkmcnt(0)
s_barrier
v_mfma_f32_16x16x32_bf16 v[14:17], v[174:177], v[82:85], v[14:17]
s_nop 0
v_mul_f32 v202, v203, v203
v_mfma_f32_16x16x32_bf16 v[18:21], v[178:181], v[82:85], v[18:21]
v_mfma_f32_16x16x32_bf16 v[22:25], v[182:185], v[82:85], v[22:25]
v_mfma_f32_16x16x32_bf16 v[26:29], v[186:189], v[82:85], v[26:29]
v_mfma_f32_16x16x32_bf16 v[30:33], v[190:193], v[82:85], v[30:33]
s_add_u32 s67, s64, 13107200
s_lshl_b32 s80, s13, 3
s_add_u32 s80, s80, s6
s_lshl_b32 s80, s80, 2
s_add_u32 s80, s80, 51798016
s_add_u32 s81, s8, 6
v_mov_b32 v1, 0
v_mov_b32 v2, s81
v_pk_fma_f32 v[14:15], v[14:15], v[202:203], v[34:35] op_sel_hi:[1,0,1]
v_cvt_pk_bf16_f32 v60, v14, v15
v_pk_fma_f32 v[16:17], v[16:17], v[202:203], v[36:37] op_sel_hi:[1,0,1]
v_cvt_pk_bf16_f32 v61, v16, v17
v_pk_fma_f32 v[18:19], v[18:19], v[202:203], v[38:39] op_sel_hi:[1,0,1]
v_cvt_pk_bf16_f32 v62, v18, v19
v_pk_fma_f32 v[20:21], v[20:21], v[202:203], v[40:41] op_sel_hi:[1,0,1]
v_cvt_pk_bf16_f32 v63, v20, v21
v_pk_fma_f32 v[22:23], v[22:23], v[202:203], v[42:43] op_sel_hi:[1,0,1]
v_cvt_pk_bf16_f32 v64, v22, v23
v_pk_fma_f32 v[24:25], v[24:25], v[202:203], v[44:45] op_sel_hi:[1,0,1]
v_cvt_pk_bf16_f32 v65, v24, v25
v_pk_fma_f32 v[26:27], v[26:27], v[202:203], v[46:47] op_sel_hi:[1,0,1]
v_cvt_pk_bf16_f32 v66, v26, v27
v_pk_fma_f32 v[28:29], v[28:29], v[202:203], v[48:49] op_sel_hi:[1,0,1]
v_cvt_pk_bf16_f32 v67, v28, v29
v_pk_fma_f32 v[30:31], v[30:31], v[202:203], v[50:51] op_sel_hi:[1,0,1]
v_cvt_pk_bf16_f32 v68, v30, v31
v_pk_fma_f32 v[32:33], v[32:33], v[202:203], v[52:53] op_sel_hi:[1,0,1]
v_cvt_pk_bf16_f32 v69, v32, v33
s_cmp_eq_u32 s3, 0
s_cbranch_scc1 prj_o1_222
s_mov_b32 s56, s30
s_mov_b32 s57, s31
s_mov_b32 s58, 2621440
s_mov_b32 s59, 0x20000
buffer_store_dwordx4 v[60:63], v12, s[56:59], s65 offen
buffer_store_dwordx4 v[64:67], v12, s[56:59], s65 offen offset:64
buffer_store_dwordx2 v[68:69], v13, s[56:59], s65 offen offset:128
s_branch L_end
prj_o1_222:
buffer_store_dwordx4 v[60:63], v10, s[36:39], s67 offen sc1
buffer_store_dwordx4 v[64:67], v10, s[36:39], s67 offen offset:2048 sc1
buffer_store_dwordx2 v[68:69], v11, s[36:39], s67 offen offset:0 sc1
v_pk_add_f32 v[72:73], v[14:15], v[16:17]
v_pk_mul_f32 v[74:75], v[14:15], v[14:15]
v_pk_fma_f32 v[74:75], v[16:17], v[16:17], v[74:75]
v_pk_add_f32 v[72:73], v[72:73], v[18:19]
v_pk_fma_f32 v[74:75], v[18:19], v[18:19], v[74:75]
v_pk_add_f32 v[72:73], v[72:73], v[20:21]
v_pk_fma_f32 v[74:75], v[20:21], v[20:21], v[74:75]
v_pk_add_f32 v[72:73], v[72:73], v[22:23]
v_pk_fma_f32 v[74:75], v[22:23], v[22:23], v[74:75]
v_pk_add_f32 v[72:73], v[72:73], v[24:25]
v_pk_fma_f32 v[74:75], v[24:25], v[24:25], v[74:75]
v_pk_add_f32 v[72:73], v[72:73], v[26:27]
v_pk_fma_f32 v[74:75], v[26:27], v[26:27], v[74:75]
v_pk_add_f32 v[72:73], v[72:73], v[28:29]
v_pk_fma_f32 v[74:75], v[28:29], v[28:29], v[74:75]
v_pk_add_f32 v[72:73], v[72:73], v[30:31]
v_pk_fma_f32 v[74:75], v[30:31], v[30:31], v[74:75]
v_pk_add_f32 v[72:73], v[72:73], v[32:33]
v_pk_fma_f32 v[74:75], v[32:33], v[32:33], v[74:75]
v_add_f32 v72, v72, v73
v_add_f32 v73, v74, v75
s_lshr_b32 s67, s61, 1
s_lshl_b32 s67, s67, 10
v_permlane32_swap_b32 v72, v73
s_and_b32 s68, s61, 1
s_lshl_b32 s68, s68, 3
v_add_f32 v72, v72, v73
v_mov_b32 v73, v72
s_add_u32 s67, s67, s68
s_add_u32 s67, s67, s72
v_permlane16_swap_b32 v72, v73
s_add_u32 s67, s67, 22151168
v_lshrrev_b32 v8, 5, v0
v_lshlrev_b32 v8, 2, v8
v_lshl_add_u32 v8, v3, 4, v8
v_add_f32 v72, v72, v73
buffer_store_dword v72, v8, s[36:39], s67 offen sc1
s_waitcnt vmcnt(1)
s_mov_b64 exec, 1
buffer_store_dword v2, v1, s[36:39], s80 offen sc1
s_mov_b64 exec, -1
s_barrier
v_add_u32 v253, 1, v2
v_mov_b32 v252, 0
s_mov_b32 s100, s80
s_lshr_b32 s60, s13, 4
s_and_b32 s61, s5, 15
s_cmp_lg_u32 s61, 15
s_cbranch_scc1 L_slow_q2
s_waitcnt vmcnt(0)
s_mov_b64 exec, 1
buffer_store_dword v253, v252, s[36:39], s100 offen sc1
s_mov_b64 exec, -1
s_branch L_slow_idle
L_slow_q2:
s_mul_i32 s62, s61, 52
s_lshr_b32 s62, s62, 8
s_mul_i32 s63, s62, 5
s_sub_u32 s63, s61, s63
s_lshl_b32 s63, s63, 7
s_and_b32 s65, s6, 1
s_lshr_b32 s66, s6, 1
v_lshrrev_b32 v14, 4, v0
v_and_b32 v15, 15, v0
s_lshl_b32 s75, s13, 9
s_lshl_b32 s67, s66, 8
s_add_u32 s75, s75, s67
s_add_u32 s75, s75, 51666944
v_lshlrev_b32 v210, 4, v14
v_lshlrev_b32 v211, 2, v15
s_lshl_b32 s67, s65, 13
v_lshlrev_b32 v2, 4, v15
v_lshl_add_u32 v2, v14, 9, v2
v_add_u32 v2, s67, v2
v_bfe_u32 v12, v0, 2, 2
v_lshl_add_u32 v13, v14, 3, v12
v_lshlrev_b32 v13, 8, v13
v_and_b32 v1, 3, v0
v_lshl_add_u32 v13, v1, 3, v13
v_add_u32 v13, 65536, v13
v_bfe_u32 v12, v0, 2, 3
s_lshl_b32 s67, s66, 2
v_xor_b32 v12, s67, v12
v_xor_b32 v1, 0, v12
v_lshl_add_u32 v4, v1, 5, v13
v_add_u32 v8, 49152, v4
v_xor_b32 v1, 1, v12
v_lshl_add_u32 v5, v1, 5, v13
v_add_u32 v9, 49152, v5
v_xor_b32 v1, 2, v12
v_lshl_add_u32 v6, v1, 5, v13
v_add_u32 v10, 49152, v6
v_xor_b32 v1, 3, v12
v_lshl_add_u32 v7, v1, 5, v13
v_add_u32 v11, 49152, v7
s_cmp_eq_u32 s62, 2
s_cbranch_scc1 qkv_v_223
s_mul_i32 s72, s62, 2621440
s_lshl_b32 s68, s60, 2
s_lshl_b32 s67, s65, 1
s_add_u32 s68, s68, s67
s_mul_i32 s68, s68, 1280
s_add_u32 s72, s72, s68
s_add_u32 s72, s72, 22315008
s_lshr_b32 s68, s63, 3
s_lshl_b32 s67, s66, 3
s_add_u32 s68, s68, s67
v_lshrrev_b32 v80, 5, v0
v_add_u32 v80, s68, v80
v_and_b32 v87, 31, v0
s_mov_b32 s73, 81920
v_mov_b32 v86, 0x7fffffff
s_mov_b32 s71, 0
s_add_u32 s96, s72, 1280
s_add_u32 s74, s72, s73
s_add_u32 s97, s96, s73
v_add_u32 v81, 0, v80
v_mul_u32_u24 v82, 205, v81
v_lshrrev_b32 v82, 10, v82
v_mad_i32_i24 v81, v82, -5, v81
v_cmp_lt_u32 vcc, 2, v81
v_lshlrev_b32 v82, 1, v82
v_add_u32 v83, -3, v81
v_cndmask_b32 v83, v81, v83, vcc
v_addc_co_u32 v82, vcc, 0, v82, vcc
v_lshlrev_b32 v83, 9, v83
v_lshl_add_u32 v83, v87, 4, v83
v_lshlrev_b32 v85, 3, v87
v_add_u32 v85, 1024, v85
v_cmp_eq_u32 vcc, 2, v81
v_mul_lo_u32 v84, v82, s73
s_cmp_lg_u64 vcc, 0
v_cndmask_b32 v83, v83, v86, vcc
v_cndmask_b32 v85, v86, v85, vcc
s_cselect_b32 s67, 1, 0
s_or_b32 s71, s71, s67
v_add_u32 v202, v83, v84
v_add_u32 v206, v85, v84
v_add_u32 v81, 2, v80
v_mul_u32_u24 v82, 205, v81
v_lshrrev_b32 v82, 10, v82
v_mad_i32_i24 v81, v82, -5, v81
v_cmp_lt_u32 vcc, 2, v81
v_lshlrev_b32 v82, 1, v82
v_add_u32 v83, -3, v81
v_cndmask_b32 v83, v81, v83, vcc
v_addc_co_u32 v82, vcc, 0, v82, vcc
v_lshlrev_b32 v83, 9, v83
v_lshl_add_u32 v83, v87, 4, v83
v_lshlrev_b32 v85, 3, v87
v_add_u32 v85, 1024, v85
v_cmp_eq_u32 vcc, 2, v81
v_mul_lo_u32 v84, v82, s73
s_cmp_lg_u64 vcc, 0
v_cndmask_b32 v83, v83, v86, vcc
v_cndmask_b32 v85, v86, v85, vcc
s_cselect_b32 s67, 2, 0
s_or_b32 s71, s71, s67
v_add_u32 v203, v83, v84
v_add_u32 v207, v85, v84
v_add_u32 v81, 4, v80
v_mul_u32_u24 v82, 205, v81
v_lshrrev_b32 v82, 10, v82
v_mad_i32_i24 v81, v82, -5, v81
v_cmp_lt_u32 vcc, 2, v81
v_lshlrev_b32 v82, 1, v82
v_add_u32 v83, -3, v81
v_cndmask_b32 v83, v81, v83, vcc
v_addc_co_u32 v82, vcc, 0, v82, vcc
v_lshlrev_b32 v83, 9, v83
v_lshl_add_u32 v83, v87, 4, v83
v_lshlrev_b32 v85, 3, v87
v_add_u32 v85, 1024, v85
v_cmp_eq_u32 vcc, 2, v81
v_mul_lo_u32 v84, v82, s73
s_cmp_lg_u64 vcc, 0
v_cndmask_b32 v83, v83, v86, vcc
v_cndmask_b32 v85, v86, v85, vcc
s_cselect_b32 s67, 4, 0
s_or_b32 s71, s71, s67
v_add_u32 v204, v83, v84
v_add_u32 v208, v85, v84
v_add_u32 v81, 6, v80
v_mul_u32_u24 v82, 205, v81
v_lshrrev_b32 v82, 10, v82
v_mad_i32_i24 v81, v82, -5, v81
v_cmp_lt_u32 vcc, 2, v81
v_lshlrev_b32 v82, 1, v82
v_add_u32 v83, -3, v81
v_cndmask_b32 v83, v81, v83, vcc
v_addc_co_u32 v82, vcc, 0, v82, vcc
v_lshlrev_b32 v83, 9, v83
v_lshl_add_u32 v83, v87, 4, v83
v_lshlrev_b32 v85, 3, v87
v_add_u32 v85, 1024, v85
v_cmp_eq_u32 vcc, 2, v81
v_mul_lo_u32 v84, v82, s73
s_cmp_lg_u64 vcc, 0
v_cndmask_b32 v83, v83, v86, vcc
v_cndmask_b32 v85, v86, v85, vcc
s_cselect_b32 s67, 8, 0
s_or_b32 s71, s71, s67
v_add_u32 v205, v83, v84
v_add_u32 v209, v85, v84
s_cmp_eq_u32 s62, 0
s_cselect_b32 s70, 0x3ea52b5c, 1.0
s_lshl_b32 s69, s60, 1
s_add_u32 s69, s69, s65
s_lshl_b32 s69, s69, 12
s_add_u32 s69, s69, 22151168
v_lshlrev_b32 v3, 4, v0
s_waitcnt vmcnt(0)
s_mov_b64 exec, 1
buffer_store_dword v253, v252, s[36:39], s100 offen sc1
s_mov_b64 exec, -1
s_barrier
ds_read_b128 v[16:19], v2 offset:0
ds_read_b128 v[20:23], v2 offset:256
ds_read_b128 v[24:27], v2 offset:4096
ds_read_b128 v[28:31], v2 offset:4352
ds_read_b64_tr_b16 v[32:33], v8 offset:16384
ds_read_b64_tr_b16 v[34:35], v8 offset:17408
ds_read_b64_tr_b16 v[36:37], v9 offset:16384
ds_read_b64_tr_b16 v[38:39], v9 offset:17408
ds_read_b64_tr_b16 v[40:41], v10 offset:16384
ds_read_b64_tr_b16 v[42:43], v10 offset:17408
ds_read_b64_tr_b16 v[44:45], v11 offset:16384
ds_read_b64_tr_b16 v[46:47], v11 offset:17408
s_waitcnt lgkmcnt(0)
v_mfma_f32_16x16x32_bf16 v[128:131], v[32:35], v[16:19], 0
ds_read_b128 v[48:51], v2 offset:2048
ds_read_b128 v[52:55], v2 offset:2304
v_mfma_f32_16x16x32_bf16 v[132:135], v[32:35], v[20:23], 0
ds_read_b128 v[56:59], v2 offset:6144
v_mfma_f32_16x16x32_bf16 v[136:139], v[32:35], v[24:27], 0
ds_read_b128 v[60:63], v2 offset:6400
v_mfma_f32_16x16x32_bf16 v[140:143], v[32:35], v[28:31], 0
ds_read_b64_tr_b16 v[64:65], v8 offset:24576
v_mfma_f32_16x16x32_bf16 v[144:147], v[36:39], v[16:19], 0
ds_read_b64_tr_b16 v[66:67], v8 offset:25600
v_mfma_f32_16x16x32_bf16 v[148:151], v[36:39], v[20:23], 0
ds_read_b64_tr_b16 v[68:69], v9 offset:24576
ds_read_b64_tr_b16 v[70:71], v9 offset:25600
v_mfma_f32_16x16x32_bf16 v[152:155], v[36:39], v[24:27], 0
ds_read_b64_tr_b16 v[72:73], v10 offset:24576
v_mfma_f32_16x16x32_bf16 v[156:159], v[36:39], v[28:31], 0
ds_read_b64_tr_b16 v[74:75], v10 offset:25600
v_mfma_f32_16x16x32_bf16 v[160:163], v[40:43], v[16:19], 0
ds_read_b64_tr_b16 v[76:77], v11 offset:24576
v_mfma_f32_16x16x32_bf16 v[164:167], v[40:43], v[20:23], 0
ds_read_b64_tr_b16 v[78:79], v11 offset:25600
v_mfma_f32_16x16x32_bf16 v[168:171], v[40:43], v[24:27], 0
v_mfma_f32_16x16x32_bf16 v[172:175], v[40:43], v[28:31], 0
v_mfma_f32_16x16x32_bf16 v[176:179], v[44:47], v[16:19], 0
v_mfma_f32_16x16x32_bf16 v[180:183], v[44:47], v[20:23], 0
v_mfma_f32_16x16x32_bf16 v[184:187], v[44:47], v[24:27], 0
s_waitcnt lgkmcnt(0)
v_mfma_f32_16x16x32_bf16 v[188:191], v[44:47], v[28:31], 0
s_barrier
v_mfma_f32_16x16x32_bf16 v[128:131], v[64:67], v[48:51], v[128:131]
ds_read_b128 v[16:19], v2 offset:16384
ds_read_b128 v[20:23], v2 offset:16640
v_mfma_f32_16x16x32_bf16 v[132:135], v[64:67], v[52:55], v[132:135]
ds_read_b128 v[24:27], v2 offset:20480
v_mfma_f32_16x16x32_bf16 v[136:139], v[64:67], v[56:59], v[136:139]
ds_read_b128 v[28:31], v2 offset:20736
v_mfma_f32_16x16x32_bf16 v[140:143], v[64:67], v[60:63], v[140:143]
ds_read_b64_tr_b16 v[32:33], v8 offset:32768
v_mfma_f32_16x16x32_bf16 v[144:147], v[68:71], v[48:51], v[144:147]
ds_read_b64_tr_b16 v[34:35], v8 offset:33792
v_mfma_f32_16x16x32_bf16 v[148:151], v[68:71], v[52:55], v[148:151]
ds_read_b64_tr_b16 v[36:37], v9 offset:32768
ds_read_b64_tr_b16 v[38:39], v9 offset:33792
v_mfma_f32_16x16x32_bf16 v[152:155], v[68:71], v[56:59], v[152:155]
ds_read_b64_tr_b16 v[40:41], v10 offset:32768
v_mfma_f32_16x16x32_bf16 v[156:159], v[68:71], v[60:63], v[156:159]
ds_read_b64_tr_b16 v[42:43], v10 offset:33792
v_mfma_f32_16x16x32_bf16 v[160:163], v[72:75], v[48:51], v[160:163]
ds_read_b64_tr_b16 v[44:45], v11 offset:32768
v_mfma_f32_16x16x32_bf16 v[164:167], v[72:75], v[52:55], v[164:167]
ds_read_b64_tr_b16 v[46:47], v11 offset:33792
v_mfma_f32_16x16x32_bf16 v[168:171], v[72:75], v[56:59], v[168:171]
buffer_load_dwordx4 v[96:99], v210, s[36:39], s75 offen offset:0 sc1
v_mfma_f32_16x16x32_bf16 v[172:175], v[72:75], v[60:63], v[172:175]
buffer_load_dwordx4 v[100:103], v210, s[36:39], s75 offen offset:64 sc1
v_mfma_f32_16x16x32_bf16 v[176:179], v[76:79], v[48:51], v[176:179]
buffer_load_dwordx4 v[104:107], v210, s[36:39], s75 offen offset:128 sc1
v_mfma_f32_16x16x32_bf16 v[180:183], v[76:79], v[52:55], v[180:183]
buffer_load_dwordx4 v[108:111], v210, s[36:39], s75 offen offset:192 sc1
v_mfma_f32_16x16x32_bf16 v[184:187], v[76:79], v[56:59], v[184:187]
v_mfma_f32_16x16x32_bf16 v[188:191], v[76:79], v[60:63], v[188:191]
s_waitcnt lgkmcnt(0)
v_mfma_f32_16x16x32_bf16 v[128:131], v[32:35], v[16:19], v[128:131]
ds_read_b128 v[48:51], v2 offset:18432
ds_read_b128 v[52:55], v2 offset:18688
v_mfma_f32_16x16x32_bf16 v[132:135], v[32:35], v[20:23], v[132:135]
ds_read_b128 v[56:59], v2 offset:22528
v_mfma_f32_16x16x32_bf16 v[136:139], v[32:35], v[24:27], v[136:139]
ds_read_b128 v[60:63], v2 offset:22784
v_mfma_f32_16x16x32_bf16 v[140:143], v[32:35], v[28:31], v[140:143]
ds_read_b64_tr_b16 v[64:65], v8 offset:40960
v_mfma_f32_16x16x32_bf16 v[144:147], v[36:39], v[16:19], v[144:147]
ds_read_b64_tr_b16 v[66:67], v8 offset:41984
v_mfma_f32_16x16x32_bf16 v[148:151], v[36:39], v[20:23], v[148:151]
ds_read_b64_tr_b16 v[68:69], v9 offset:40960
ds_read_b64_tr_b16 v[70:71], v9 offset:41984
v_mfma_f32_16x16x32_bf16 v[152:155], v[36:39], v[24:27], v[152:155]
ds_read_b64_tr_b16 v[72:73], v10 offset:40960
v_mfma_f32_16x16x32_bf16 v[156:159], v[36:39], v[28:31], v[156:159]
ds_read_b64_tr_b16 v[74:75], v10 offset:41984
v_mfma_f32_16x16x32_bf16 v[160:163], v[40:43], v[16:19], v[160:163]
ds_read_b64_tr_b16 v[76:77], v11 offset:40960
v_mfma_f32_16x16x32_bf16 v[164:167], v[40:43], v[20:23], v[164:167]
ds_read_b64_tr_b16 v[78:79], v11 offset:41984
v_mfma_f32_16x16x32_bf16 v[168:171], v[40:43], v[24:27], v[168:171]
v_mfma_f32_16x16x32_bf16 v[172:175], v[40:43], v[28:31], v[172:175]
v_mfma_f32_16x16x32_bf16 v[176:179], v[44:47], v[16:19], v[176:179]
v_mfma_f32_16x16x32_bf16 v[180:183], v[44:47], v[20:23], v[180:183]
v_mfma_f32_16x16x32_bf16 v[184:187], v[44:47], v[24:27], v[184:187]
s_waitcnt lgkmcnt(0)
v_mfma_f32_16x16x32_bf16 v[188:191], v[44:47], v[28:31], v[188:191]
s_barrier
v_mfma_f32_16x16x32_bf16 v[128:131], v[64:67], v[48:51], v[128:131]
ds_read_b128 v[16:19], v2 offset:32768
ds_read_b128 v[20:23], v2 offset:33024
v_mfma_f32_16x16x32_bf16 v[132:135], v[64:67], v[52:55], v[132:135]
ds_read_b128 v[24:27], v2 offset:36864
v_mfma_f32_16x16x32_bf16 v[136:139], v[64:67], v[56:59], v[136:139]
ds_read_b128 v[28:31], v2 offset:37120
v_mfma_f32_16x16x32_bf16 v[140:143], v[64:67], v[60:63], v[140:143]
ds_read_b64_tr_b16 v[32:33], v4 offset:0
v_mfma_f32_16x16x32_bf16 v[144:147], v[68:71], v[48:51], v[144:147]
ds_read_b64_tr_b16 v[34:35], v4 offset:1024
v_mfma_f32_16x16x32_bf16 v[148:151], v[68:71], v[52:55], v[148:151]
ds_read_b64_tr_b16 v[36:37], v5 offset:0
ds_read_b64_tr_b16 v[38:39], v5 offset:1024
v_mfma_f32_16x16x32_bf16 v[152:155], v[68:71], v[56:59], v[152:155]
ds_read_b64_tr_b16 v[40:41], v6 offset:0
v_mfma_f32_16x16x32_bf16 v[156:159], v[68:71], v[60:63], v[156:159]
ds_read_b64_tr_b16 v[42:43], v6 offset:1024
v_mfma_f32_16x16x32_bf16 v[160:163], v[72:75], v[48:51], v[160:163]
ds_read_b64_tr_b16 v[44:45], v7 offset:0
v_mfma_f32_16x16x32_bf16 v[164:167], v[72:75], v[52:55], v[164:167]
ds_read_b64_tr_b16 v[46:47], v7 offset:1024
v_mfma_f32_16x16x32_bf16 v[168:171], v[72:75], v[56:59], v[168:171]
buffer_load_dwordx4 v[80:83], v3, s[36:39], s69 offen offset:0 sc1
v_mfma_f32_16x16x32_bf16 v[172:175], v[72:75], v[60:63], v[172:175]
buffer_load_dwordx4 v[84:87], v3, s[36:39], s69 offen offset:1024 sc1
v_mfma_f32_16x16x32_bf16 v[176:179], v[76:79], v[48:51], v[176:179]
v_mfma_f32_16x16x32_bf16 v[180:183], v[76:79], v[52:55], v[180:183]
v_mfma_f32_16x16x32_bf16 v[184:187], v[76:79], v[56:59], v[184:187]
v_mfma_f32_16x16x32_bf16 v[188:191], v[76:79], v[60:63], v[188:191]
s_waitcnt lgkmcnt(0)
v_mfma_f32_16x16x32_bf16 v[128:131], v[32:35], v[16:19], v[128:131]
ds_read_b128 v[48:51], v2 offset:34816
ds_read_b128 v[52:55], v2 offset:35072
v_mfma_f32_16x16x32_bf16 v[132:135], v[32:35], v[20:23], v[132:135]
ds_read_b128 v[56:59], v2 offset:38912
v_mfma_f32_16x16x32_bf16 v[136:139], v[32:35], v[24:27], v[136:139]
ds_read_b128 v[60:63], v2 offset:39168
v_mfma_f32_16x16x32_bf16 v[140:143], v[32:35], v[28:31], v[140:143]
ds_read_b64_tr_b16 v[64:65], v4 offset:8192
v_mfma_f32_16x16x32_bf16 v[144:147], v[36:39], v[16:19], v[144:147]
ds_read_b64_tr_b16 v[66:67], v4 offset:9216
v_mfma_f32_16x16x32_bf16 v[148:151], v[36:39], v[20:23], v[148:151]
ds_read_b64_tr_b16 v[68:69], v5 offset:8192
ds_read_b64_tr_b16 v[70:71], v5 offset:9216
v_mfma_f32_16x16x32_bf16 v[152:155], v[36:39], v[24:27], v[152:155]
ds_read_b64_tr_b16 v[72:73], v6 offset:8192
v_mfma_f32_16x16x32_bf16 v[156:159], v[36:39], v[28:31], v[156:159]
ds_read_b64_tr_b16 v[74:75], v6 offset:9216
v_mfma_f32_16x16x32_bf16 v[160:163], v[40:43], v[16:19], v[160:163]
ds_read_b64_tr_b16 v[76:77], v7 offset:8192
buffer_load_dwordx4 v[88:91], v3, s[36:39], s69 offen offset:2048 sc1
v_mfma_f32_16x16x32_bf16 v[164:167], v[40:43], v[20:23], v[164:167]
ds_read_b64_tr_b16 v[78:79], v7 offset:9216
buffer_load_dwordx4 v[92:95], v3, s[36:39], s69 offen offset:3072 sc1
v_mfma_f32_16x16x32_bf16 v[168:171], v[40:43], v[24:27], v[168:171]
v_mfma_f32_16x16x32_bf16 v[172:175], v[40:43], v[28:31], v[172:175]
v_mfma_f32_16x16x32_bf16 v[176:179], v[44:47], v[16:19], v[176:179]
v_mfma_f32_16x16x32_bf16 v[180:183], v[44:47], v[20:23], v[180:183]
v_mfma_f32_16x16x32_bf16 v[184:187], v[44:47], v[24:27], v[184:187]
s_waitcnt lgkmcnt(0)
v_mfma_f32_16x16x32_bf16 v[188:191], v[44:47], v[28:31], v[188:191]
s_barrier
v_mfma_f32_16x16x32_bf16 v[128:131], v[64:67], v[48:51], v[128:131]
ds_read_b128 v[16:19], v2 offset:49152
ds_read_b128 v[20:23], v2 offset:49408
v_mfma_f32_16x16x32_bf16 v[132:135], v[64:67], v[52:55], v[132:135]
ds_read_b128 v[24:27], v2 offset:53248
v_mfma_f32_16x16x32_bf16 v[136:139], v[64:67], v[56:59], v[136:139]
ds_read_b128 v[28:31], v2 offset:53504
v_mfma_f32_16x16x32_bf16 v[140:143], v[64:67], v[60:63], v[140:143]
ds_read_b64_tr_b16 v[32:33], v4 offset:16384
v_mfma_f32_16x16x32_bf16 v[144:147], v[68:71], v[48:51], v[144:147]
ds_read_b64_tr_b16 v[34:35], v4 offset:17408
v_mfma_f32_16x16x32_bf16 v[148:151], v[68:71], v[52:55], v[148:151]
ds_read_b64_tr_b16 v[36:37], v5 offset:16384
ds_read_b64_tr_b16 v[38:39], v5 offset:17408
v_mfma_f32_16x16x32_bf16 v[152:155], v[68:71], v[56:59], v[152:155]
ds_read_b64_tr_b16 v[40:41], v6 offset:16384
v_mfma_f32_16x16x32_bf16 v[156:159], v[68:71], v[60:63], v[156:159]
ds_read_b64_tr_b16 v[42:43], v6 offset:17408
v_mfma_f32_16x16x32_bf16 v[160:163], v[72:75], v[48:51], v[160:163]
ds_read_b64_tr_b16 v[44:45], v7 offset:16384
v_mfma_f32_16x16x32_bf16 v[164:167], v[72:75], v[52:55], v[164:167]
ds_read_b64_tr_b16 v[46:47], v7 offset:17408
v_mfma_f32_16x16x32_bf16 v[168:171], v[72:75], v[56:59], v[168:171]
v_mfma_f32_16x16x32_bf16 v[172:175], v[72:75], v[60:63], v[172:175]
v_mfma_f32_16x16x32_bf16 v[176:179], v[76:79], v[48:51], v[176:179]
v_mfma_f32_16x16x32_bf16 v[180:183], v[76:79], v[52:55], v[180:183]
v_mfma_f32_16x16x32_bf16 v[184:187], v[76:79], v[56:59], v[184:187]
v_mfma_f32_16x16x32_bf16 v[188:191], v[76:79], v[60:63], v[188:191]
s_waitcnt lgkmcnt(0)
v_mfma_f32_16x16x32_bf16 v[128:131], v[32:35], v[16:19], v[128:131]
ds_read_b128 v[48:51], v2 offset:51200
ds_read_b128 v[52:55], v2 offset:51456
v_mfma_f32_16x16x32_bf16 v[132:135], v[32:35], v[20:23], v[132:135]
ds_read_b128 v[56:59], v2 offset:55296
v_mfma_f32_16x16x32_bf16 v[136:139], v[32:35], v[24:27], v[136:139]
ds_read_b128 v[60:63], v2 offset:55552
v_mfma_f32_16x16x32_bf16 v[140:143], v[32:35], v[28:31], v[140:143]
ds_read_b64_tr_b16 v[64:65], v4 offset:24576
v_mfma_f32_16x16x32_bf16 v[144:147], v[36:39], v[16:19], v[144:147]
ds_read_b64_tr_b16 v[66:67], v4 offset:25600
v_mfma_f32_16x16x32_bf16 v[148:151], v[36:39], v[20:23], v[148:151]
ds_read_b64_tr_b16 v[68:69], v5 offset:24576
ds_read_b64_tr_b16 v[70:71], v5 offset:25600
v_mfma_f32_16x16x32_bf16 v[152:155], v[36:39], v[24:27], v[152:155]
ds_read_b64_tr_b16 v[72:73], v6 offset:24576
v_mfma_f32_16x16x32_bf16 v[156:159], v[36:39], v[28:31], v[156:159]
ds_read_b64_tr_b16 v[74:75], v6 offset:25600
v_mfma_f32_16x16x32_bf16 v[160:163], v[40:43], v[16:19], v[160:163]
ds_read_b64_tr_b16 v[76:77], v7 offset:24576
v_mfma_f32_16x16x32_bf16 v[164:167], v[40:43], v[20:23], v[164:167]
ds_read_b64_tr_b16 v[78:79], v7 offset:25600
v_mfma_f32_16x16x32_bf16 v[168:171], v[40:43], v[24:27], v[168:171]
v_mfma_f32_16x16x32_bf16 v[172:175], v[40:43], v[28:31], v[172:175]
v_mfma_f32_16x16x32_bf16 v[176:179], v[44:47], v[16:19], v[176:179]
s_waitcnt vmcnt(0)
v_add_f32 v80, v80, v82
v_mfma_f32_16x16x32_bf16 v[180:183], v[44:47], v[20:23], v[180:183]
v_add_f32 v81, v81, v83
v_add_f32 v80, v80, v84
v_mfma_f32_16x16x32_bf16 v[184:187], v[44:47], v[24:27], v[184:187]
s_waitcnt lgkmcnt(0)
v_add_f32 v81, v81, v85
v_mfma_f32_16x16x32_bf16 v[188:191], v[44:47], v[28:31], v[188:191]
s_barrier
v_mfma_f32_16x16x32_bf16 v[128:131], v[64:67], v[48:51], v[128:131]
ds_read_b128 v[16:19], v2 offset:0
ds_read_b128 v[20:23], v2 offset:256
v_mfma_f32_16x16x32_bf16 v[132:135], v[64:67], v[52:55], v[132:135]
ds_read_b128 v[24:27], v2 offset:4096
v_add_f32 v80, v80, v86
v_mfma_f32_16x16x32_bf16 v[136:139], v[64:67], v[56:59], v[136:139]
ds_read_b128 v[28:31], v2 offset:4352
v_add_f32 v81, v81, v87
v_mfma_f32_16x16x32_bf16 v[140:143], v[64:67], v[60:63], v[140:143]
ds_read_b64_tr_b16 v[32:33], v4 offset:32768
v_add_f32 v80, v80, v88
v_mfma_f32_16x16x32_bf16 v[144:147], v[68:71], v[48:51], v[144:147]
ds_read_b64_tr_b16 v[34:35], v4 offset:33792
v_add_f32 v81, v81, v89
v_mfma_f32_16x16x32_bf16 v[148:151], v[68:71], v[52:55], v[148:151]
ds_read_b64_tr_b16 v[36:37], v5 offset:32768
ds_read_b64_tr_b16 v[38:39], v5 offset:33792
v_mfma_f32_16x16x32_bf16 v[152:155], v[68:71], v[56:59], v[152:155]
ds_read_b64_tr_b16 v[40:41], v6 offset:32768
v_add_f32 v80, v80, v90
v_mfma_f32_16x16x32_bf16 v[156:159], v[68:71], v[60:63], v[156:159]
ds_read_b64_tr_b16 v[42:43], v6 offset:33792
v_add_f32 v81, v81, v91
v_mfma_f32_16x16x32_bf16 v[160:163], v[72:75], v[48:51], v[160:163]
ds_read_b64_tr_b16 v[44:45], v7 offset:32768
v_add_f32 v80, v80, v92
v_mfma_f32_16x16x32_bf16 v[164:167], v[72:75], v[52:55], v[164:167]
ds_read_b64_tr_b16 v[46:47], v7 offset:33792
v_add_f32 v81, v81, v93
v_mfma_f32_16x16x32_bf16 v[168:171], v[72:75], v[56:59], v[168:171]
v_add_f32 v80, v80, v94
v_add_f32 v81, v81, v95
v_mfma_f32_16x16x32_bf16 v[172:175], v[72:75], v[60:63], v[172:175]
v_mul_f32 v82, 0x3acccccd, v80
v_mul_f32 v81, 0x3acccccd, v81
v_mfma_f32_16x16x32_bf16 v[176:179], v[76:79], v[48:51], v[176:179]
v_fma_f32 v81, -v82, v82, v81
v_max_f32 v81, 0, v81
v_mfma_f32_16x16x32_bf16 v[180:183], v[76:79], v[52:55], v[180:183]
v_add_f32 v81, 0x3727c5ac, v81
v_rsq_f32 v83, v81
v_mfma_f32_16x16x32_bf16 v[184:187], v[76:79], v[56:59], v[184:187]
s_nop 0
v_sub_f32 v212, 0, v82
v_mfma_f32_16x16x32_bf16 v[188:191], v[76:79], v[60:63], v[188:191]
v_sub_f32 v214, 0, v82
s_waitcnt lgkmcnt(0)
v_mfma_f32_16x16x32_bf16 v[128:131], v[32:35], v[16:19], v[128:131]
ds_read_b128 v[48:51], v2 offset:2048
ds_read_b128 v[52:55], v2 offset:2304
v_mfma_f32_16x16x32_bf16 v[132:135], v[32:35], v[20:23], v[132:135]
ds_read_b128 v[56:59], v2 offset:6144
s_nop 1
v_mfma_f32_16x16x32_bf16 v[136:139], v[32:35], v[24:27], v[136:139]
ds_read_b128 v[60:63], v2 offset:6400
v_permlane16_swap_b32 v212, v214
v_mfma_f32_16x16x32_bf16 v[140:143], v[32:35], v[28:31], v[140:143]
ds_read_b64_tr_b16 v[64:65], v4 offset:40960
v_mov_b32 v216, v212
v_mfma_f32_16x16x32_bf16 v[144:147], v[36:39], v[16:19], v[144:147]
ds_read_b64_tr_b16 v[66:67], v4 offset:41984
v_mov_b32 v218, v214
v_mfma_f32_16x16x32_bf16 v[148:151], v[36:39], v[20:23], v[148:151]
ds_read_b64_tr_b16 v[68:69], v5 offset:40960
ds_read_b64_tr_b16 v[70:71], v5 offset:41984
v_mfma_f32_16x16x32_bf16 v[152:155], v[36:39], v[24:27], v[152:155]
ds_read_b64_tr_b16 v[72:73], v6 offset:40960
s_nop 1
v_mfma_f32_16x16x32_bf16 v[156:159], v[36:39], v[28:31], v[156:159]
ds_read_b64_tr_b16 v[74:75], v6 offset:41984
v_permlane32_swap_b32 v212, v216
v_mfma_f32_16x16x32_bf16 v[160:163], v[40:43], v[16:19], v[160:163]
ds_read_b64_tr_b16 v[76:77], v7 offset:40960
v_permlane32_swap_b32 v214, v218
v_mfma_f32_16x16x32_bf16 v[164:167], v[40:43], v[20:23], v[164:167]
ds_read_b64_tr_b16 v[78:79], v7 offset:41984
v_mul_f32 v240, s70, v83
v_mfma_f32_16x16x32_bf16 v[168:171], v[40:43], v[24:27], v[168:171]
v_mul_f32 v242, s70, v83
s_nop 1
v_mfma_f32_16x16x32_bf16 v[172:175], v[40:43], v[28:31], v[172:175]
v_permlane16_swap_b32 v240, v242
v_mfma_f32_16x16x32_bf16 v[176:179], v[44:47], v[16:19], v[176:179]
v_mov_b32 v244, v240
v_mov_b32 v246, v242
v_mfma_f32_16x16x32_bf16 v[180:183], v[44:47], v[20:23], v[180:183]
s_nop 1
v_mfma_f32_16x16x32_bf16 v[184:187], v[44:47], v[24:27], v[184:187]
s_waitcnt lgkmcnt(0)
v_permlane32_swap_b32 v240, v244
v_mfma_f32_16x16x32_bf16 v[188:191], v[44:47], v[28:31], v[188:191]
s_barrier
v_mfma_f32_16x16x32_bf16 v[128:131], v[64:67], v[48:51], v[128:131]
ds_read_b128 v[16:19], v2 offset:16384
ds_read_b128 v[20:23], v2 offset:16640
v_mfma_f32_16x16x32_bf16 v[132:135], v[64:67], v[52:55], v[132:135]
ds_read_b128 v[24:27], v2 offset:20480
v_permlane32_swap_b32 v242, v246
v_mfma_f32_16x16x32_bf16 v[136:139], v[64:67], v[56:59], v[136:139]
ds_read_b128 v[28:31], v2 offset:20736
v_mfma_f32_16x16x32_bf16 v[140:143], v[64:67], v[60:63], v[140:143]
ds_read_b64_tr_b16 v[32:33], v8 offset:0
v_mfma_f32_16x16x32_bf16 v[144:147], v[68:71], v[48:51], v[144:147]
ds_read_b64_tr_b16 v[34:35], v8 offset:1024
v_mfma_f32_16x16x32_bf16 v[148:151], v[68:71], v[52:55], v[148:151]
ds_read_b64_tr_b16 v[36:37], v9 offset:0
ds_read_b64_tr_b16 v[38:39], v9 offset:1024
v_mfma_f32_16x16x32_bf16 v[152:155], v[68:71], v[56:59], v[152:155]
ds_read_b64_tr_b16 v[40:41], v10 offset:0
v_mfma_f32_16x16x32_bf16 v[156:159], v[68:71], v[60:63], v[156:159]
ds_read_b64_tr_b16 v[42:43], v10 offset:1024
v_mfma_f32_16x16x32_bf16 v[160:163], v[72:75], v[48:51], v[160:163]
ds_read_b64_tr_b16 v[44:45], v11 offset:0
v_mfma_f32_16x16x32_bf16 v[164:167], v[72:75], v[52:55], v[164:167]
ds_read_b64_tr_b16 v[46:47], v11 offset:1024
v_mfma_f32_16x16x32_bf16 v[168:171], v[72:75], v[56:59], v[168:171]
v_mfma_f32_16x16x32_bf16 v[172:175], v[72:75], v[60:63], v[172:175]
v_mfma_f32_16x16x32_bf16 v[176:179], v[76:79], v[48:51], v[176:179]
v_mfma_f32_16x16x32_bf16 v[180:183], v[76:79], v[52:55], v[180:183]
v_mfma_f32_16x16x32_bf16 v[184:187], v[76:79], v[56:59], v[184:187]
v_mfma_f32_16x16x32_bf16 v[188:191], v[76:79], v[60:63], v[188:191]
s_waitcnt lgkmcnt(0)
v_mfma_f32_16x16x32_bf16 v[128:131], v[32:35], v[16:19], v[128:131]
ds_read_b128 v[48:51], v2 offset:18432
ds_read_b128 v[52:55], v2 offset:18688
v_mfma_f32_16x16x32_bf16 v[132:135], v[32:35], v[20:23], v[132:135]
ds_read_b128 v[56:59], v2 offset:22528
v_mfma_f32_16x16x32_bf16 v[136:139], v[32:35], v[24:27], v[136:139]
ds_read_b128 v[60:63], v2 offset:22784
v_mfma_f32_16x16x32_bf16 v[140:143], v[32:35], v[28:31], v[140:143]
ds_read_b64_tr_b16 v[64:65], v8 offset:8192
v_mfma_f32_16x16x32_bf16 v[144:147], v[36:39], v[16:19], v[144:147]
ds_read_b64_tr_b16 v[66:67], v8 offset:9216
v_mfma_f32_16x16x32_bf16 v[148:151], v[36:39], v[20:23], v[148:151]
ds_read_b64_tr_b16 v[68:69], v9 offset:8192
ds_read_b64_tr_b16 v[70:71], v9 offset:9216
v_mfma_f32_16x16x32_bf16 v[152:155], v[36:39], v[24:27], v[152:155]
ds_read_b64_tr_b16 v[72:73], v10 offset:8192
v_mfma_f32_16x16x32_bf16 v[156:159], v[36:39], v[28:31], v[156:159]
ds_read_b64_tr_b16 v[74:75], v10 offset:9216
v_mfma_f32_16x16x32_bf16 v[160:163], v[40:43], v[16:19], v[160:163]
ds_read_b64_tr_b16 v[76:77], v11 offset:8192
v_mfma_f32_16x16x32_bf16 v[164:167], v[40:43], v[20:23], v[164:167]
ds_read_b64_tr_b16 v[78:79], v11 offset:9216
v_mfma_f32_16x16x32_bf16 v[168:171], v[40:43], v[24:27], v[168:171]
v_mfma_f32_16x16x32_bf16 v[172:175], v[40:43], v[28:31], v[172:175]
v_mfma_f32_16x16x32_bf16 v[176:179], v[44:47], v[16:19], v[176:179]
v_mfma_f32_16x16x32_bf16 v[180:183], v[44:47], v[20:23], v[180:183]
v_mfma_f32_16x16x32_bf16 v[184:187], v[44:47], v[24:27], v[184:187]
s_waitcnt lgkmcnt(0)
v_mfma_f32_16x16x32_bf16 v[188:191], v[44:47], v[28:31], v[188:191]
s_barrier
v_mfma_f32_16x16x32_bf16 v[128:131], v[64:67], v[48:51], v[128:131]
ds_read_b128 v[16:19], v2 offset:32768
ds_read_b128 v[20:23], v2 offset:33024
v_mfma_f32_16x16x32_bf16 v[132:135], v[64:67], v[52:55], v[132:135]
ds_read_b128 v[24:27], v2 offset:36864
v_mfma_f32_16x16x32_bf16 v[136:139], v[64:67], v[56:59], v[136:139]
ds_read_b128 v[28:31], v2 offset:37120
v_fmac_f32 v148, v214, v100
v_mfma_f32_16x16x32_bf16 v[140:143], v[64:67], v[60:63], v[140:143]
ds_read_b64_tr_b16 v[32:33], v8 offset:16384
v_fmac_f32 v152, v216, v100
v_mfma_f32_16x16x32_bf16 v[144:147], v[68:71], v[48:51], v[144:147]
ds_read_b64_tr_b16 v[34:35], v8 offset:17408
v_fmac_f32 v156, v218, v100
v_mfma_f32_16x16x32_bf16 v[148:151], v[68:71], v[52:55], v[148:151]
ds_read_b64_tr_b16 v[36:37], v9 offset:16384
ds_read_b64_tr_b16 v[38:39], v9 offset:17408
v_mfma_f32_16x16x32_bf16 v[152:155], v[68:71], v[56:59], v[152:155]
ds_read_b64_tr_b16 v[40:41], v10 offset:16384
v_fmac_f32 v164, v214, v104
v_mfma_f32_16x16x32_bf16 v[156:159], v[68:71], v[60:63], v[156:159]
ds_read_b64_tr_b16 v[42:43], v10 offset:17408
v_fmac_f32 v168, v216, v104
v_mfma_f32_16x16x32_bf16 v[160:163], v[72:75], v[48:51], v[160:163]
ds_read_b64_tr_b16 v[44:45], v11 offset:16384
v_fmac_f32 v172, v218, v104
v_mfma_f32_16x16x32_bf16 v[164:167], v[72:75], v[52:55], v[164:167]
ds_read_b64_tr_b16 v[46:47], v11 offset:17408
v_fmac_f32 v176, v212, v108
v_mfma_f32_16x16x32_bf16 v[168:171], v[72:75], v[56:59], v[168:171]
v_fmac_f32 v180, v214, v108
v_fmac_f32 v181, v214, v109
v_mfma_f32_16x16x32_bf16 v[172:175], v[72:75], v[60:63], v[172:175]
v_fmac_f32 v184, v216, v108
v_fmac_f32 v185, v216, v109
v_mfma_f32_16x16x32_bf16 v[176:179], v[76:79], v[48:51], v[176:179]
v_fmac_f32 v188, v218, v108
v_fmac_f32 v189, v218, v109
v_mfma_f32_16x16x32_bf16 v[180:183], v[76:79], v[52:55], v[180:183]
v_fmac_f32 v128, v212, v96
v_fmac_f32 v129, v212, v97
v_mfma_f32_16x16x32_bf16 v[184:187], v[76:79], v[56:59], v[184:187]
v_fmac_f32 v132, v214, v96
v_fmac_f32 v133, v214, v97
v_mfma_f32_16x16x32_bf16 v[188:191], v[76:79], v[60:63], v[188:191]
v_fmac_f32 v136, v216, v96
s_waitcnt lgkmcnt(0)
v_mfma_f32_16x16x32_bf16 v[128:131], v[32:35], v[16:19], v[128:131]
ds_read_b128 v[48:51], v2 offset:34816
ds_read_b128 v[52:55], v2 offset:35072
v_mfma_f32_16x16x32_bf16 v[132:135], v[32:35], v[20:23], v[132:135]
ds_read_b128 v[56:59], v2 offset:38912
v_fmac_f32 v144, v212, v100
v_mfma_f32_16x16x32_bf16 v[136:139], v[32:35], v[24:27], v[136:139]
ds_read_b128 v[60:63], v2 offset:39168
v_fmac_f32 v160, v212, v104
v_mfma_f32_16x16x32_bf16 v[140:143], v[32:35], v[28:31], v[140:143]
ds_read_b64_tr_b16 v[64:65], v8 offset:24576
v_fmac_f32 v153, v216, v101
v_mfma_f32_16x16x32_bf16 v[144:147], v[36:39], v[16:19], v[144:147]
ds_read_b64_tr_b16 v[66:67], v8 offset:25600
v_fmac_f32 v157, v218, v101
v_mfma_f32_16x16x32_bf16 v[148:151], v[36:39], v[20:23], v[148:151]
ds_read_b64_tr_b16 v[68:69], v9 offset:24576
ds_read_b64_tr_b16 v[70:71], v9 offset:25600
v_mfma_f32_16x16x32_bf16 v[152:155], v[36:39], v[24:27], v[152:155]
ds_read_b64_tr_b16 v[72:73], v10 offset:24576
v_fmac_f32 v165, v214, v105
v_mfma_f32_16x16x32_bf16 v[156:159], v[36:39], v[28:31], v[156:159]
ds_read_b64_tr_b16 v[74:75], v10 offset:25600
v_fmac_f32 v140, v218, v96
v_mfma_f32_16x16x32_bf16 v[160:163], v[40:43], v[16:19], v[160:163]
ds_read_b64_tr_b16 v[76:77], v11 offset:24576
v_fmac_f32 v173, v218, v105
v_mfma_f32_16x16x32_bf16 v[164:167], v[40:43], v[20:23], v[164:167]
ds_read_b64_tr_b16 v[78:79], v11 offset:25600
v_fmac_f32 v177, v212, v109
v_mfma_f32_16x16x32_bf16 v[168:171], v[40:43], v[24:27], v[168:171]
v_fmac_f32 v137, v216, v97
v_fmac_f32 v138, v216, v98
v_mfma_f32_16x16x32_bf16 v[172:175], v[40:43], v[28:31], v[172:175]
v_fmac_f32 v141, v218, v97
v_fmac_f32 v142, v218, v98
v_mfma_f32_16x16x32_bf16 v[176:179], v[44:47], v[16:19], v[176:179]
v_fmac_f32 v145, v212, v101
v_fmac_f32 v146, v212, v102
v_mfma_f32_16x16x32_bf16 v[180:183], v[44:47], v[20:23], v[180:183]
v_fmac_f32 v149, v214, v101
v_fmac_f32 v150, v214, v102
v_mfma_f32_16x16x32_bf16 v[184:187], v[44:47], v[24:27], v[184:187]
s_waitcnt lgkmcnt(0)
v_fmac_f32 v161, v212, v105
v_mfma_f32_16x16x32_bf16 v[188:191], v[44:47], v[28:31], v[188:191]
s_barrier
v_mfma_f32_16x16x32_bf16 v[128:131], v[64:67], v[48:51], v[128:131]
ds_read_b128 v[16:19], v2 offset:49152
ds_read_b128 v[20:23], v2 offset:49408
v_mfma_f32_16x16x32_bf16 v[132:135], v[64:67], v[52:55], v[132:135]
ds_read_b128 v[24:27], v2 offset:53248
v_fmac_f32 v169, v216, v105
v_mfma_f32_16x16x32_bf16 v[136:139], v[64:67], v[56:59], v[136:139]
ds_read_b128 v[28:31], v2 offset:53504
v_fmac_f32 v154, v216, v102
v_mfma_f32_16x16x32_bf16 v[140:143], v[64:67], v[60:63], v[140:143]
ds_read_b64_tr_b16 v[32:33], v8 offset:32768
v_fmac_f32 v158, v218, v102
v_mfma_f32_16x16x32_bf16 v[144:147], v[68:71], v[48:51], v[144:147]
ds_read_b64_tr_b16 v[34:35], v8 offset:33792
v_fmac_f32 v162, v212, v106
v_mfma_f32_16x16x32_bf16 v[148:151], v[68:71], v[52:55], v[148:151]
ds_read_b64_tr_b16 v[36:37], v9 offset:32768
ds_read_b64_tr_b16 v[38:39], v9 offset:33792
v_mfma_f32_16x16x32_bf16 v[152:155], v[68:71], v[56:59], v[152:155]
ds_read_b64_tr_b16 v[40:41], v10 offset:32768
v_fmac_f32 v166, v214, v106
v_mfma_f32_16x16x32_bf16 v[156:159], v[68:71], v[60:63], v[156:159]
ds_read_b64_tr_b16 v[42:43], v10 offset:33792
v_fmac_f32 v170, v216, v106
v_mfma_f32_16x16x32_bf16 v[160:163], v[72:75], v[48:51], v[160:163]
ds_read_b64_tr_b16 v[44:45], v11 offset:32768
v_fmac_f32 v174, v218, v106
v_mfma_f32_16x16x32_bf16 v[164:167], v[72:75], v[52:55], v[164:167]
ds_read_b64_tr_b16 v[46:47], v11 offset:33792
v_fmac_f32 v178, v212, v110
v_mfma_f32_16x16x32_bf16 v[168:171], v[72:75], v[56:59], v[168:171]
v_fmac_f32 v182, v214, v110
v_fmac_f32 v183, v214, v111
v_mfma_f32_16x16x32_bf16 v[172:175], v[72:75], v[60:63], v[172:175]
v_fmac_f32 v186, v216, v110
v_fmac_f32 v187, v216, v111
v_mfma_f32_16x16x32_bf16 v[176:179], v[76:79], v[48:51], v[176:179]
v_fmac_f32 v190, v218, v110
v_fmac_f32 v191, v218, v111
v_mfma_f32_16x16x32_bf16 v[180:183], v[76:79], v[52:55], v[180:183]
v_fmac_f32 v130, v212, v98
v_fmac_f32 v131, v212, v99
v_mfma_f32_16x16x32_bf16 v[184:187], v[76:79], v[56:59], v[184:187]
v_fmac_f32 v134, v214, v98
v_fmac_f32 v135, v214, v99
v_mfma_f32_16x16x32_bf16 v[188:191], v[76:79], v[60:63], v[188:191]
v_fmac_f32 v139, v216, v99
s_waitcnt lgkmcnt(0)
v_mfma_f32_16x16x32_bf16 v[128:131], v[32:35], v[16:19], v[128:131]
ds_read_b128 v[48:51], v2 offset:51200
ds_read_b128 v[52:55], v2 offset:51456
v_mfma_f32_16x16x32_bf16 v[132:135], v[32:35], v[20:23], v[132:135]
ds_read_b128 v[56:59], v2 offset:55296
v_fmac_f32 v147, v212, v103
v_mfma_f32_16x16x32_bf16 v[136:139], v[32:35], v[24:27], v[136:139]
ds_read_b128 v[60:63], v2 offset:55552
v_fmac_f32 v151, v214, v103
v_mfma_f32_16x16x32_bf16 v[140:143], v[32:35], v[28:31], v[140:143]
ds_read_b64_tr_b16 v[64:65], v8 offset:40960
v_fmac_f32 v155, v216, v103
v_mfma_f32_16x16x32_bf16 v[144:147], v[36:39], v[16:19], v[144:147]
ds_read_b64_tr_b16 v[66:67], v8 offset:41984
v_fmac_f32 v159, v218, v103
v_mfma_f32_16x16x32_bf16 v[148:151], v[36:39], v[20:23], v[148:151]
ds_read_b64_tr_b16 v[68:69], v9 offset:40960
ds_read_b64_tr_b16 v[70:71], v9 offset:41984
v_mfma_f32_16x16x32_bf16 v[152:155], v[36:39], v[24:27], v[152:155]
ds_read_b64_tr_b16 v[72:73], v10 offset:40960
v_fmac_f32 v167, v214, v107
v_mfma_f32_16x16x32_bf16 v[156:159], v[36:39], v[28:31], v[156:159]
ds_read_b64_tr_b16 v[74:75], v10 offset:41984
v_fmac_f32 v171, v216, v107
v_mfma_f32_16x16x32_bf16 v[160:163], v[40:43], v[16:19], v[160:163]
ds_read_b64_tr_b16 v[76:77], v11 offset:40960
v_fmac_f32 v175, v218, v107
v_mfma_f32_16x16x32_bf16 v[164:167], v[40:43], v[20:23], v[164:167]
ds_read_b64_tr_b16 v[78:79], v11 offset:41984
v_fmac_f32 v179, v212, v111
v_mfma_f32_16x16x32_bf16 v[168:171], v[40:43], v[24:27], v[168:171]
v_fmac_f32 v143, v218, v99
v_mfma_f32_16x16x32_bf16 v[172:175], v[40:43], v[28:31], v[172:175]
v_mfma_f32_16x16x32_bf16 v[176:179], v[44:47], v[16:19], v[176:179]
v_fmac_f32 v163, v212, v107
v_mfma_f32_16x16x32_bf16 v[180:183], v[44:47], v[20:23], v[180:183]
v_mfma_f32_16x16x32_bf16 v[184:187], v[44:47], v[24:27], v[184:187]
s_waitcnt lgkmcnt(0)
v_mfma_f32_16x16x32_bf16 v[188:191], v[44:47], v[28:31], v[188:191]
s_barrier
v_mfma_f32_16x16x32_bf16 v[128:131], v[64:67], v[48:51], v[128:131]
ds_read_b128 v[16:19], v2 offset:0
ds_read_b128 v[20:23], v2 offset:256
v_mfma_f32_16x16x32_bf16 v[132:135], v[64:67], v[52:55], v[132:135]
ds_read_b128 v[24:27], v2 offset:4096
v_mfma_f32_16x16x32_bf16 v[136:139], v[64:67], v[56:59], v[136:139]
ds_read_b128 v[28:31], v2 offset:4352
v_mfma_f32_16x16x32_bf16 v[140:143], v[64:67], v[60:63], v[140:143]
ds_read_b64_tr_b16 v[32:33], v4 offset:0
v_mfma_f32_16x16x32_bf16 v[144:147], v[68:71], v[48:51], v[144:147]
ds_read_b64_tr_b16 v[34:35], v4 offset:1024
v_mfma_f32_16x16x32_bf16 v[148:151], v[68:71], v[52:55], v[148:151]
ds_read_b64_tr_b16 v[36:37], v5 offset:0
ds_read_b64_tr_b16 v[38:39], v5 offset:1024
v_mfma_f32_16x16x32_bf16 v[152:155], v[68:71], v[56:59], v[152:155]
ds_read_b64_tr_b16 v[40:41], v6 offset:0
v_mfma_f32_16x16x32_bf16 v[156:159], v[68:71], v[60:63], v[156:159]
ds_read_b64_tr_b16 v[42:43], v6 offset:1024
v_mfma_f32_16x16x32_bf16 v[160:163], v[72:75], v[48:51], v[160:163]
ds_read_b64_tr_b16 v[44:45], v7 offset:0
v_mfma_f32_16x16x32_bf16 v[164:167], v[72:75], v[52:55], v[164:167]
ds_read_b64_tr_b16 v[46:47], v7 offset:1024
v_mfma_f32_16x16x32_bf16 v[168:171], v[72:75], v[56:59], v[168:171]
v_mfma_f32_16x16x32_bf16 v[172:175], v[72:75], v[60:63], v[172:175]
v_mfma_f32_16x16x32_bf16 v[176:179], v[76:79], v[48:51], v[176:179]
v_mfma_f32_16x16x32_bf16 v[180:183], v[76:79], v[52:55], v[180:183]
v_mfma_f32_16x16x32_bf16 v[184:187], v[76:79], v[56:59], v[184:187]
v_mfma_f32_16x16x32_bf16 v[188:191], v[76:79], v[60:63], v[188:191]
s_waitcnt lgkmcnt(0)
v_mfma_f32_16x16x32_bf16 v[128:131], v[32:35], v[16:19], v[128:131]
ds_read_b128 v[48:51], v2 offset:2048
ds_read_b128 v[52:55], v2 offset:2304
v_mfma_f32_16x16x32_bf16 v[132:135], v[32:35], v[20:23], v[132:135]
ds_read_b128 v[56:59], v2 offset:6144
v_mfma_f32_16x16x32_bf16 v[136:139], v[32:35], v[24:27], v[136:139]
ds_read_b128 v[60:63], v2 offset:6400
v_mfma_f32_16x16x32_bf16 v[140:143], v[32:35], v[28:31], v[140:143]
ds_read_b64_tr_b16 v[64:65], v4 offset:8192
v_mfma_f32_16x16x32_bf16 v[144:147], v[36:39], v[16:19], v[144:147]
ds_read_b64_tr_b16 v[66:67], v4 offset:9216
v_mfma_f32_16x16x32_bf16 v[148:151], v[36:39], v[20:23], v[148:151]
ds_read_b64_tr_b16 v[68:69], v5 offset:8192
ds_read_b64_tr_b16 v[70:71], v5 offset:9216
v_mfma_f32_16x16x32_bf16 v[152:155], v[36:39], v[24:27], v[152:155]
ds_read_b64_tr_b16 v[72:73], v6 offset:8192
v_mfma_f32_16x16x32_bf16 v[156:159], v[36:39], v[28:31], v[156:159]
ds_read_b64_tr_b16 v[74:75], v6 offset:9216
v_mfma_f32_16x16x32_bf16 v[160:163], v[40:43], v[16:19], v[160:163]
ds_read_b64_tr_b16 v[76:77], v7 offset:8192
v_mfma_f32_16x16x32_bf16 v[164:167], v[40:43], v[20:23], v[164:167]
ds_read_b64_tr_b16 v[78:79], v7 offset:9216
v_mfma_f32_16x16x32_bf16 v[168:171], v[40:43], v[24:27], v[168:171]
v_mfma_f32_16x16x32_bf16 v[172:175], v[40:43], v[28:31], v[172:175]
v_mfma_f32_16x16x32_bf16 v[176:179], v[44:47], v[16:19], v[176:179]
v_mfma_f32_16x16x32_bf16 v[180:183], v[44:47], v[20:23], v[180:183]
v_mfma_f32_16x16x32_bf16 v[184:187], v[44:47], v[24:27], v[184:187]
s_waitcnt lgkmcnt(0)
v_mfma_f32_16x16x32_bf16 v[188:191], v[44:47], v[28:31], v[188:191]
s_barrier
v_mfma_f32_16x16x32_bf16 v[128:131], v[64:67], v[48:51], v[128:131]
ds_read_b128 v[16:19], v2 offset:16384
ds_read_b128 v[20:23], v2 offset:16640
v_mfma_f32_16x16x32_bf16 v[132:135], v[64:67], v[52:55], v[132:135]
ds_read_b128 v[24:27], v2 offset:20480
v_mfma_f32_16x16x32_bf16 v[136:139], v[64:67], v[56:59], v[136:139]
ds_read_b128 v[28:31], v2 offset:20736
v_mfma_f32_16x16x32_bf16 v[140:143], v[64:67], v[60:63], v[140:143]
ds_read_b64_tr_b16 v[32:33], v4 offset:16384
v_mfma_f32_16x16x32_bf16 v[144:147], v[68:71], v[48:51], v[144:147]
ds_read_b64_tr_b16 v[34:35], v4 offset:17408
v_mfma_f32_16x16x32_bf16 v[148:151], v[68:71], v[52:55], v[148:151]
ds_read_b64_tr_b16 v[36:37], v5 offset:16384
ds_read_b64_tr_b16 v[38:39], v5 offset:17408
v_mfma_f32_16x16x32_bf16 v[152:155], v[68:71], v[56:59], v[152:155]
ds_read_b64_tr_b16 v[40:41], v6 offset:16384
v_mfma_f32_16x16x32_bf16 v[156:159], v[68:71], v[60:63], v[156:159]
ds_read_b64_tr_b16 v[42:43], v6 offset:17408
v_mfma_f32_16x16x32_bf16 v[160:163], v[72:75], v[48:51], v[160:163]
ds_read_b64_tr_b16 v[44:45], v7 offset:16384
v_mfma_f32_16x16x32_bf16 v[164:167], v[72:75], v[52:55], v[164:167]
ds_read_b64_tr_b16 v[46:47], v7 offset:17408
v_mfma_f32_16x16x32_bf16 v[168:171], v[72:75], v[56:59], v[168:171]
v_mfma_f32_16x16x32_bf16 v[172:175], v[72:75], v[60:63], v[172:175]
v_mfma_f32_16x16x32_bf16 v[176:179], v[76:79], v[48:51], v[176:179]
v_mfma_f32_16x16x32_bf16 v[180:183], v[76:79], v[52:55], v[180:183]
v_mfma_f32_16x16x32_bf16 v[184:187], v[76:79], v[56:59], v[184:187]
v_mfma_f32_16x16x32_bf16 v[188:191], v[76:79], v[60:63], v[188:191]
s_waitcnt lgkmcnt(0)
v_mfma_f32_16x16x32_bf16 v[128:131], v[32:35], v[16:19], v[128:131]
ds_read_b128 v[48:51], v2 offset:18432
v_mfma_f32_16x16x32_bf16 v[132:135], v[32:35], v[20:23], v[132:135]
ds_read_b128 v[52:55], v2 offset:18688
v_mfma_f32_16x16x32_bf16 v[136:139], v[32:35], v[24:27], v[136:139]
ds_read_b128 v[56:59], v2 offset:22528
v_mfma_f32_16x16x32_bf16 v[140:143], v[32:35], v[28:31], v[140:143]
ds_read_b128 v[60:63], v2 offset:22784
v_mfma_f32_16x16x32_bf16 v[144:147], v[36:39], v[16:19], v[144:147]
ds_read_b64_tr_b16 v[64:65], v4 offset:24576
v_mfma_f32_16x16x32_bf16 v[148:151], v[36:39], v[20:23], v[148:151]
ds_read_b64_tr_b16 v[66:67], v4 offset:25600
v_mfma_f32_16x16x32_bf16 v[152:155], v[36:39], v[24:27], v[152:155]
ds_read_b64_tr_b16 v[68:69], v5 offset:24576
v_mfma_f32_16x16x32_bf16 v[156:159], v[36:39], v[28:31], v[156:159]
ds_read_b64_tr_b16 v[70:71], v5 offset:25600
v_mfma_f32_16x16x32_bf16 v[160:163], v[40:43], v[16:19], v[160:163]
ds_read_b64_tr_b16 v[72:73], v6 offset:24576
v_mfma_f32_16x16x32_bf16 v[164:167], v[40:43], v[20:23], v[164:167]
ds_read_b64_tr_b16 v[74:75], v6 offset:25600
v_mfma_f32_16x16x32_bf16 v[168:171], v[40:43], v[24:27], v[168:171]
ds_read_b64_tr_b16 v[76:77], v7 offset:24576
v_mfma_f32_16x16x32_bf16 v[172:175], v[40:43], v[28:31], v[172:175]
ds_read_b64_tr_b16 v[78:79], v7 offset:25600
s_waitcnt lgkmcnt(0)
v_mfma_f32_16x16x32_bf16 v[128:131], v[64:67], v[48:51], v[128:131]
s_barrier
v_mfma_f32_16x16x32_bf16 v[132:135], v[64:67], v[52:55], v[132:135]
v_mfma_f32_16x16x32_bf16 v[136:139], v[64:67], v[56:59], v[136:139]
v_mfma_f32_16x16x32_bf16 v[140:143], v[64:67], v[60:63], v[140:143]
v_mfma_f32_16x16x32_bf16 v[144:147], v[68:71], v[48:51], v[144:147]
s_nop 1
v_mfma_f32_16x16x32_bf16 v[148:151], v[68:71], v[52:55], v[148:151]
s_nop 1
v_mfma_f32_16x16x32_bf16 v[152:155], v[68:71], v[56:59], v[152:155]
v_mul_f32 v128, v240, v128
v_mul_f32 v129, v240, v129
v_mul_f32 v130, v240, v130
v_mfma_f32_16x16x32_bf16 v[156:159], v[68:71], v[60:63], v[156:159]
v_mul_f32 v131, v240, v131
v_mul_f32 v132, v242, v132
v_mul_f32 v133, v242, v133
v_mfma_f32_16x16x32_bf16 v[160:163], v[72:75], v[48:51], v[160:163]
v_mul_f32 v134, v242, v134
v_mul_f32 v135, v242, v135
v_cvt_pk_bf16_f32 v128, v128, v129
v_mfma_f32_16x16x32_bf16 v[164:167], v[72:75], v[52:55], v[164:167]
v_cvt_pk_bf16_f32 v129, v130, v131
v_cvt_pk_bf16_f32 v130, v132, v133
v_cvt_pk_bf16_f32 v131, v134, v135
v_mfma_f32_16x16x32_bf16 v[168:171], v[72:75], v[56:59], v[168:171]
s_nop 0
v_permlane16_swap_b32 v128, v130
v_permlane16_swap_b32 v129, v131
v_mfma_f32_16x16x32_bf16 v[172:175], v[72:75], v[60:63], v[172:175]
buffer_store_dwordx4 v[128:131], v202, s[36:39], s72 offen sc1
v_mul_f32 v136, v244, v136
v_mul_f32 v137, v244, v137
v_mfma_f32_16x16x32_bf16 v[176:179], v[44:47], v[16:19], v[176:179]
v_mul_f32 v138, v244, v138
v_mul_f32 v139, v244, v139
v_mul_f32 v140, v246, v140
v_mfma_f32_16x16x32_bf16 v[180:183], v[44:47], v[20:23], v[180:183]
v_mul_f32 v141, v246, v141
v_mul_f32 v142, v246, v142
v_mul_f32 v143, v246, v143
v_mfma_f32_16x16x32_bf16 v[184:187], v[44:47], v[24:27], v[184:187]
v_cvt_pk_bf16_f32 v136, v136, v137
v_cvt_pk_bf16_f32 v137, v138, v139
v_cvt_pk_bf16_f32 v138, v140, v141
v_mfma_f32_16x16x32_bf16 v[188:191], v[44:47], v[28:31], v[188:191]
v_cvt_pk_bf16_f32 v139, v142, v143
s_nop 0
v_permlane16_swap_b32 v136, v138
v_mfma_f32_16x16x32_bf16 v[176:179], v[76:79], v[48:51], v[176:179]
v_permlane16_swap_b32 v137, v139
buffer_store_dwordx4 v[136:139], v202, s[36:39], s96 offen sc1
v_mul_f32 v144, v240, v144
v_mfma_f32_16x16x32_bf16 v[180:183], v[76:79], v[52:55], v[180:183]
v_mul_f32 v145, v240, v145
v_mul_f32 v146, v240, v146
v_mul_f32 v147, v240, v147
v_mfma_f32_16x16x32_bf16 v[184:187], v[76:79], v[56:59], v[184:187]
v_mul_f32 v148, v242, v148
v_mul_f32 v149, v242, v149
v_mul_f32 v150, v242, v150
v_mfma_f32_16x16x32_bf16 v[188:191], v[76:79], v[60:63], v[188:191]
v_mul_f32 v151, v242, v151
v_cvt_pk_bf16_f32 v144, v144, v145
v_cvt_pk_bf16_f32 v145, v146, v147
v_cvt_pk_bf16_f32 v146, v148, v149
v_cvt_pk_bf16_f32 v147, v150, v151
s_nop 0
v_permlane16_swap_b32 v144, v146
v_permlane16_swap_b32 v145, v147
buffer_store_dwordx4 v[144:147], v203, s[36:39], s72 offen sc1
v_mul_f32 v152, v244, v152
v_mul_f32 v153, v244, v153
v_mul_f32 v154, v244, v154
v_mul_f32 v155, v244, v155
v_mul_f32 v156, v246, v156
v_mul_f32 v157, v246, v157
v_mul_f32 v158, v246, v158
v_mul_f32 v159, v246, v159
v_cvt_pk_bf16_f32 v152, v152, v153
v_cvt_pk_bf16_f32 v153, v154, v155
v_cvt_pk_bf16_f32 v154, v156, v157
v_cvt_pk_bf16_f32 v155, v158, v159
s_nop 0
v_permlane16_swap_b32 v152, v154
v_permlane16_swap_b32 v153, v155
buffer_store_dwordx4 v[152:155], v203, s[36:39], s96 offen sc1
v_pk_mul_f32 v[160:161], v[160:161], v[240:241] op_sel_hi:[1,0]
v_pk_mul_f32 v[162:163], v[162:163], v[240:241] op_sel_hi:[1,0]
v_pk_mul_f32 v[164:165], v[164:165], v[242:243] op_sel_hi:[1,0]
v_pk_mul_f32 v[166:167], v[166:167], v[242:243] op_sel_hi:[1,0]
v_cvt_pk_bf16_f32 v160, v160, v161
v_cvt_pk_bf16_f32 v161, v162, v163
v_cvt_pk_bf16_f32 v162, v164, v165
v_cvt_pk_bf16_f32 v163, v166, v167
s_nop 0
v_permlane16_swap_b32 v160, v162
v_permlane16_swap_b32 v161, v163
buffer_store_dwordx4 v[160:163], v204, s[36:39], s72 offen sc1
v_pk_mul_f32 v[168:169], v[168:169], v[244:245] op_sel_hi:[1,0]
v_pk_mul_f32 v[170:171], v[170:171], v[244:245] op_sel_hi:[1,0]
v_pk_mul_f32 v[172:173], v[172:173], v[246:247] op_sel_hi:[1,0]
v_pk_mul_f32 v[174:175], v[174:175], v[246:247] op_sel_hi:[1,0]
v_cvt_pk_bf16_f32 v168, v168, v169
v_cvt_pk_bf16_f32 v169, v170, v171
v_cvt_pk_bf16_f32 v170, v172, v173
v_cvt_pk_bf16_f32 v171, v174, v175
s_nop 0
v_permlane16_swap_b32 v168, v170
v_permlane16_swap_b32 v169, v171
buffer_store_dwordx4 v[168:171], v204, s[36:39], s96 offen sc1
v_pk_mul_f32 v[176:177], v[176:177], v[240:241] op_sel_hi:[1,0]
v_pk_mul_f32 v[178:179], v[178:179], v[240:241] op_sel_hi:[1,0]
v_pk_mul_f32 v[180:181], v[180:181], v[242:243] op_sel_hi:[1,0]
v_pk_mul_f32 v[182:183], v[182:183], v[242:243] op_sel_hi:[1,0]
v_cvt_pk_bf16_f32 v176, v176, v177
v_cvt_pk_bf16_f32 v177, v178, v179
v_cvt_pk_bf16_f32 v178, v180, v181
v_cvt_pk_bf16_f32 v179, v182, v183
s_nop 0
v_permlane16_swap_b32 v176, v178
v_permlane16_swap_b32 v177, v179
buffer_store_dwordx4 v[176:179], v205, s[36:39], s72 offen sc1
v_pk_mul_f32 v[184:185], v[184:185], v[244:245] op_sel_hi:[1,0]
v_pk_mul_f32 v[186:187], v[186:187], v[244:245] op_sel_hi:[1,0]
v_pk_mul_f32 v[188:189], v[188:189], v[246:247] op_sel_hi:[1,0]
v_pk_mul_f32 v[190:191], v[190:191], v[246:247] op_sel_hi:[1,0]
v_cvt_pk_bf16_f32 v184, v184, v185
v_cvt_pk_bf16_f32 v185, v186, v187
v_cvt_pk_bf16_f32 v186, v188, v189
v_cvt_pk_bf16_f32 v187, v190, v191
s_nop 0
v_permlane16_swap_b32 v184, v186
v_permlane16_swap_b32 v185, v187
buffer_store_dwordx4 v[184:187], v205, s[36:39], s96 offen sc1
s_bitcmp0_b32 s71, 0
s_cbranch_scc1 qk_b_225
buffer_store_dwordx2 v[128:129], v206, s[36:39], s72 offen sc1
buffer_store_dwordx2 v[130:131], v206, s[36:39], s74 offen sc1
buffer_store_dwordx2 v[136:137], v206, s[36:39], s96 offen sc1
buffer_store_dwordx2 v[138:139], v206, s[36:39], s97 offen sc1
qk_b_225:
s_bitcmp0_b32 s71, 1
s_cbranch_scc1 qk_b_226
buffer_store_dwordx2 v[144:145], v207, s[36:39], s72 offen sc1
buffer_store_dwordx2 v[146:147], v207, s[36:39], s74 offen sc1
buffer_store_dwordx2 v[152:153], v207, s[36:39], s96 offen sc1
buffer_store_dwordx2 v[154:155], v207, s[36:39], s97 offen sc1
qk_b_226:
s_bitcmp0_b32 s71, 2
s_cbranch_scc1 qk_b_227
buffer_store_dwordx2 v[160:161], v208, s[36:39], s72 offen sc1
buffer_store_dwordx2 v[162:163], v208, s[36:39], s74 offen sc1
buffer_store_dwordx2 v[168:169], v208, s[36:39], s96 offen sc1
buffer_store_dwordx2 v[170:171], v208, s[36:39], s97 offen sc1
qk_b_227:
s_bitcmp0_b32 s71, 3
s_cbranch_scc1 qk_b_228
buffer_store_dwordx2 v[176:177], v209, s[36:39], s72 offen sc1
buffer_store_dwordx2 v[178:179], v209, s[36:39], s74 offen sc1
buffer_store_dwordx2 v[184:185], v209, s[36:39], s96 offen sc1
buffer_store_dwordx2 v[186:187], v209, s[36:39], s97 offen sc1
qk_b_228:
s_branch qkv_fin_224
qkv_v_223:
s_lshl_b32 s68, s60, 3
s_lshl_b32 s67, s65, 2
s_add_u32 s68, s68, s67
s_mul_i32 s72, s68, 640
s_add_u32 s72, s72, 27557888
s_lshl_b32 s67, s66, 6
s_add_u32 s68, s63, s67
v_lshrrev_b32 v80, 5, v0
v_lshl_add_u32 v80, v80, 4, v15
v_add_u32 v80, s68, v80
v_and_b32 v81, 1, v14
v_mul_u32_u24 v81, 320, v81
s_mov_b32 s73, 81920
s_movk_i32 s74, 3277
s_movk_i32 s67, -20
v_add_u32 v83, 0, v80
v_mul_u32_u24 v84, s74, v83
v_lshrrev_b32 v84, 16, v84
v_mad_i32_i24 v83, v84, s67, v83
v_lshl_add_u32 v83, v83, 4, v81
v_mul_lo_u32 v85, v84, s73
v_add_u32 v202, v83, v85
v_add_u32 v83, 32, v80
v_mul_u32_u24 v84, s74, v83
v_lshrrev_b32 v84, 16, v84
v_mad_i32_i24 v83, v84, s67, v83
v_lshl_add_u32 v83, v83, 4, v81
v_mul_lo_u32 v85, v84, s73
v_add_u32 v203, v83, v85
s_cmp_eq_u32 s62, 0
s_cselect_b32 s70, 0x3ea52b5c, 1.0
s_lshl_b32 s69, s60, 1
s_add_u32 s69, s69, s65
s_lshl_b32 s69, s69, 12
s_add_u32 s69, s69, 22151168
v_lshlrev_b32 v3, 4, v0
s_lshl_b32 s67, s6, 9
s_add_u32 s67, s67, 98304
v_lshlrev_b32 v12, 2, v0
v_add_u32 v12, s67, v12
v_add_u32 v13, s67, v210
s_waitcnt vmcnt(0)
s_mov_b64 exec, 1
buffer_store_dword v253, v252, s[36:39], s100 offen sc1
s_mov_b64 exec, -1
s_barrier
ds_read_b128 v[16:19], v2 offset:0
ds_read_b128 v[20:23], v2 offset:256
ds_read_b128 v[24:27], v2 offset:4096
ds_read_b128 v[28:31], v2 offset:4352
ds_read_b64_tr_b16 v[32:33], v8 offset:16384
ds_read_b64_tr_b16 v[34:35], v8 offset:17408
ds_read_b64_tr_b16 v[36:37], v9 offset:16384
ds_read_b64_tr_b16 v[38:39], v9 offset:17408
ds_read_b64_tr_b16 v[40:41], v10 offset:16384
ds_read_b64_tr_b16 v[42:43], v10 offset:17408
ds_read_b64_tr_b16 v[44:45], v11 offset:16384
ds_read_b64_tr_b16 v[46:47], v11 offset:17408
s_waitcnt lgkmcnt(0)
v_mfma_f32_16x16x32_bf16 v[128:131], v[16:19], v[32:35], 0
ds_read_b128 v[48:51], v2 offset:2048
ds_read_b128 v[52:55], v2 offset:2304
v_mfma_f32_16x16x32_bf16 v[132:135], v[16:19], v[36:39], 0
ds_read_b128 v[56:59], v2 offset:6144
v_mfma_f32_16x16x32_bf16 v[136:139], v[16:19], v[40:43], 0
ds_read_b128 v[60:63], v2 offset:6400
v_mfma_f32_16x16x32_bf16 v[140:143], v[16:19], v[44:47], 0
ds_read_b64_tr_b16 v[64:65], v8 offset:24576
v_mfma_f32_16x16x32_bf16 v[144:147], v[20:23], v[32:35], 0
ds_read_b64_tr_b16 v[66:67], v8 offset:25600
v_mfma_f32_16x16x32_bf16 v[148:151], v[20:23], v[36:39], 0
ds_read_b64_tr_b16 v[68:69], v9 offset:24576
ds_read_b64_tr_b16 v[70:71], v9 offset:25600
v_mfma_f32_16x16x32_bf16 v[152:155], v[20:23], v[40:43], 0
ds_read_b64_tr_b16 v[72:73], v10 offset:24576
v_mfma_f32_16x16x32_bf16 v[156:159], v[20:23], v[44:47], 0
ds_read_b64_tr_b16 v[74:75], v10 offset:25600
v_mfma_f32_16x16x32_bf16 v[160:163], v[24:27], v[32:35], 0
ds_read_b64_tr_b16 v[76:77], v11 offset:24576
v_mfma_f32_16x16x32_bf16 v[164:167], v[24:27], v[36:39], 0
ds_read_b64_tr_b16 v[78:79], v11 offset:25600
v_mfma_f32_16x16x32_bf16 v[168:171], v[24:27], v[40:43], 0
v_mfma_f32_16x16x32_bf16 v[172:175], v[24:27], v[44:47], 0
v_mfma_f32_16x16x32_bf16 v[176:179], v[28:31], v[32:35], 0
v_mfma_f32_16x16x32_bf16 v[180:183], v[28:31], v[36:39], 0
v_mfma_f32_16x16x32_bf16 v[184:187], v[28:31], v[40:43], 0
s_waitcnt lgkmcnt(0)
v_mfma_f32_16x16x32_bf16 v[188:191], v[28:31], v[44:47], 0
s_barrier
v_mfma_f32_16x16x32_bf16 v[128:131], v[48:51], v[64:67], v[128:131]
ds_read_b128 v[16:19], v2 offset:16384
ds_read_b128 v[20:23], v2 offset:16640
v_mfma_f32_16x16x32_bf16 v[132:135], v[48:51], v[68:71], v[132:135]
ds_read_b128 v[24:27], v2 offset:20480
v_mfma_f32_16x16x32_bf16 v[136:139], v[48:51], v[72:75], v[136:139]
ds_read_b128 v[28:31], v2 offset:20736
v_mfma_f32_16x16x32_bf16 v[140:143], v[48:51], v[76:79], v[140:143]
ds_read_b64_tr_b16 v[32:33], v8 offset:32768
v_mfma_f32_16x16x32_bf16 v[144:147], v[52:55], v[64:67], v[144:147]
ds_read_b64_tr_b16 v[34:35], v8 offset:33792
v_mfma_f32_16x16x32_bf16 v[148:151], v[52:55], v[68:71], v[148:151]
ds_read_b64_tr_b16 v[36:37], v9 offset:32768
ds_read_b64_tr_b16 v[38:39], v9 offset:33792
v_mfma_f32_16x16x32_bf16 v[152:155], v[52:55], v[72:75], v[152:155]
ds_read_b64_tr_b16 v[40:41], v10 offset:32768
v_mfma_f32_16x16x32_bf16 v[156:159], v[52:55], v[76:79], v[156:159]
ds_read_b64_tr_b16 v[42:43], v10 offset:33792
v_mfma_f32_16x16x32_bf16 v[160:163], v[56:59], v[64:67], v[160:163]
ds_read_b64_tr_b16 v[44:45], v11 offset:32768
v_mfma_f32_16x16x32_bf16 v[164:167], v[56:59], v[68:71], v[164:167]
ds_read_b64_tr_b16 v[46:47], v11 offset:33792
v_mfma_f32_16x16x32_bf16 v[168:171], v[56:59], v[72:75], v[168:171]
buffer_load_dword v192, v211, s[36:39], s75 offen offset:0 sc1
v_mfma_f32_16x16x32_bf16 v[172:175], v[56:59], v[76:79], v[172:175]
buffer_load_dword v194, v211, s[36:39], s75 offen offset:64 sc1
v_mfma_f32_16x16x32_bf16 v[176:179], v[60:63], v[64:67], v[176:179]
buffer_load_dword v196, v211, s[36:39], s75 offen offset:128 sc1
v_mfma_f32_16x16x32_bf16 v[180:183], v[60:63], v[68:71], v[180:183]
buffer_load_dword v198, v211, s[36:39], s75 offen offset:192 sc1
v_mfma_f32_16x16x32_bf16 v[184:187], v[60:63], v[72:75], v[184:187]
v_mfma_f32_16x16x32_bf16 v[188:191], v[60:63], v[76:79], v[188:191]
s_waitcnt lgkmcnt(0)
v_mfma_f32_16x16x32_bf16 v[128:131], v[16:19], v[32:35], v[128:131]
ds_read_b128 v[48:51], v2 offset:18432
ds_read_b128 v[52:55], v2 offset:18688
v_mfma_f32_16x16x32_bf16 v[132:135], v[16:19], v[36:39], v[132:135]
ds_read_b128 v[56:59], v2 offset:22528
v_mfma_f32_16x16x32_bf16 v[136:139], v[16:19], v[40:43], v[136:139]
ds_read_b128 v[60:63], v2 offset:22784
v_mfma_f32_16x16x32_bf16 v[140:143], v[16:19], v[44:47], v[140:143]
ds_read_b64_tr_b16 v[64:65], v8 offset:40960
v_mfma_f32_16x16x32_bf16 v[144:147], v[20:23], v[32:35], v[144:147]
ds_read_b64_tr_b16 v[66:67], v8 offset:41984
v_mfma_f32_16x16x32_bf16 v[148:151], v[20:23], v[36:39], v[148:151]
ds_read_b64_tr_b16 v[68:69], v9 offset:40960
ds_read_b64_tr_b16 v[70:71], v9 offset:41984
v_mfma_f32_16x16x32_bf16 v[152:155], v[20:23], v[40:43], v[152:155]
ds_read_b64_tr_b16 v[72:73], v10 offset:40960
v_mfma_f32_16x16x32_bf16 v[156:159], v[20:23], v[44:47], v[156:159]
ds_read_b64_tr_b16 v[74:75], v10 offset:41984
v_mfma_f32_16x16x32_bf16 v[160:163], v[24:27], v[32:35], v[160:163]
ds_read_b64_tr_b16 v[76:77], v11 offset:40960
v_mfma_f32_16x16x32_bf16 v[164:167], v[24:27], v[36:39], v[164:167]
ds_read_b64_tr_b16 v[78:79], v11 offset:41984
v_mfma_f32_16x16x32_bf16 v[168:171], v[24:27], v[40:43], v[168:171]
v_mfma_f32_16x16x32_bf16 v[172:175], v[24:27], v[44:47], v[172:175]
v_mfma_f32_16x16x32_bf16 v[176:179], v[28:31], v[32:35], v[176:179]
v_mfma_f32_16x16x32_bf16 v[180:183], v[28:31], v[36:39], v[180:183]
v_mfma_f32_16x16x32_bf16 v[184:187], v[28:31], v[40:43], v[184:187]
s_waitcnt lgkmcnt(0)
v_mfma_f32_16x16x32_bf16 v[188:191], v[28:31], v[44:47], v[188:191]
s_barrier
v_mfma_f32_16x16x32_bf16 v[128:131], v[48:51], v[64:67], v[128:131]
ds_read_b128 v[16:19], v2 offset:32768
ds_read_b128 v[20:23], v2 offset:33024
v_mfma_f32_16x16x32_bf16 v[132:135], v[48:51], v[68:71], v[132:135]
ds_read_b128 v[24:27], v2 offset:36864
v_mfma_f32_16x16x32_bf16 v[136:139], v[48:51], v[72:75], v[136:139]
ds_read_b128 v[28:31], v2 offset:37120
v_mfma_f32_16x16x32_bf16 v[140:143], v[48:51], v[76:79], v[140:143]
ds_read_b64_tr_b16 v[32:33], v4 offset:0
v_mfma_f32_16x16x32_bf16 v[144:147], v[52:55], v[64:67], v[144:147]
ds_read_b64_tr_b16 v[34:35], v4 offset:1024
v_mfma_f32_16x16x32_bf16 v[148:151], v[52:55], v[68:71], v[148:151]
ds_read_b64_tr_b16 v[36:37], v5 offset:0
ds_read_b64_tr_b16 v[38:39], v5 offset:1024
v_mfma_f32_16x16x32_bf16 v[152:155], v[52:55], v[72:75], v[152:155]
ds_read_b64_tr_b16 v[40:41], v6 offset:0
v_mfma_f32_16x16x32_bf16 v[156:159], v[52:55], v[76:79], v[156:159]
ds_read_b64_tr_b16 v[42:43], v6 offset:1024
v_mfma_f32_16x16x32_bf16 v[160:163], v[56:59], v[64:67], v[160:163]
ds_read_b64_tr_b16 v[44:45], v7 offset:0
v_mfma_f32_16x16x32_bf16 v[164:167], v[56:59], v[68:71], v[164:167]
ds_read_b64_tr_b16 v[46:47], v7 offset:1024
v_mfma_f32_16x16x32_bf16 v[168:171], v[56:59], v[72:75], v[168:171]
buffer_load_dwordx4 v[80:83], v3, s[36:39], s69 offen offset:0 sc1
v_mfma_f32_16x16x32_bf16 v[172:175], v[56:59], v[76:79], v[172:175]
buffer_load_dwordx4 v[84:87], v3, s[36:39], s69 offen offset:1024 sc1
v_mfma_f32_16x16x32_bf16 v[176:179], v[60:63], v[64:67], v[176:179]
v_mfma_f32_16x16x32_bf16 v[180:183], v[60:63], v[68:71], v[180:183]
v_mfma_f32_16x16x32_bf16 v[184:187], v[60:63], v[72:75], v[184:187]
v_mfma_f32_16x16x32_bf16 v[188:191], v[60:63], v[76:79], v[188:191]
s_waitcnt lgkmcnt(0)
v_mfma_f32_16x16x32_bf16 v[128:131], v[16:19], v[32:35], v[128:131]
ds_read_b128 v[48:51], v2 offset:34816
ds_read_b128 v[52:55], v2 offset:35072
v_mfma_f32_16x16x32_bf16 v[132:135], v[16:19], v[36:39], v[132:135]
ds_read_b128 v[56:59], v2 offset:38912
v_mfma_f32_16x16x32_bf16 v[136:139], v[16:19], v[40:43], v[136:139]
ds_read_b128 v[60:63], v2 offset:39168
v_mfma_f32_16x16x32_bf16 v[140:143], v[16:19], v[44:47], v[140:143]
ds_read_b64_tr_b16 v[64:65], v4 offset:8192
v_mfma_f32_16x16x32_bf16 v[144:147], v[20:23], v[32:35], v[144:147]
ds_read_b64_tr_b16 v[66:67], v4 offset:9216
v_mfma_f32_16x16x32_bf16 v[148:151], v[20:23], v[36:39], v[148:151]
ds_read_b64_tr_b16 v[68:69], v5 offset:8192
ds_read_b64_tr_b16 v[70:71], v5 offset:9216
v_mfma_f32_16x16x32_bf16 v[152:155], v[20:23], v[40:43], v[152:155]
ds_read_b64_tr_b16 v[72:73], v6 offset:8192
v_mfma_f32_16x16x32_bf16 v[156:159], v[20:23], v[44:47], v[156:159]
ds_read_b64_tr_b16 v[74:75], v6 offset:9216
v_mfma_f32_16x16x32_bf16 v[160:163], v[24:27], v[32:35], v[160:163]
ds_read_b64_tr_b16 v[76:77], v7 offset:8192
buffer_load_dwordx4 v[88:91], v3, s[36:39], s69 offen offset:2048 sc1
v_mfma_f32_16x16x32_bf16 v[164:167], v[24:27], v[36:39], v[164:167]
ds_read_b64_tr_b16 v[78:79], v7 offset:9216
buffer_load_dwordx4 v[92:95], v3, s[36:39], s69 offen offset:3072 sc1
v_mfma_f32_16x16x32_bf16 v[168:171], v[24:27], v[40:43], v[168:171]
v_mfma_f32_16x16x32_bf16 v[172:175], v[24:27], v[44:47], v[172:175]
v_mfma_f32_16x16x32_bf16 v[176:179], v[28:31], v[32:35], v[176:179]
v_mfma_f32_16x16x32_bf16 v[180:183], v[28:31], v[36:39], v[180:183]
v_mfma_f32_16x16x32_bf16 v[184:187], v[28:31], v[40:43], v[184:187]
s_waitcnt lgkmcnt(0)
v_mfma_f32_16x16x32_bf16 v[188:191], v[28:31], v[44:47], v[188:191]
s_barrier
v_mfma_f32_16x16x32_bf16 v[128:131], v[48:51], v[64:67], v[128:131]
ds_read_b128 v[16:19], v2 offset:49152
ds_read_b128 v[20:23], v2 offset:49408
v_mfma_f32_16x16x32_bf16 v[132:135], v[48:51], v[68:71], v[132:135]
ds_read_b128 v[24:27], v2 offset:53248
v_mfma_f32_16x16x32_bf16 v[136:139], v[48:51], v[72:75], v[136:139]
ds_read_b128 v[28:31], v2 offset:53504
v_mfma_f32_16x16x32_bf16 v[140:143], v[48:51], v[76:79], v[140:143]
ds_read_b64_tr_b16 v[32:33], v4 offset:16384
v_mfma_f32_16x16x32_bf16 v[144:147], v[52:55], v[64:67], v[144:147]
ds_read_b64_tr_b16 v[34:35], v4 offset:17408
v_mfma_f32_16x16x32_bf16 v[148:151], v[52:55], v[68:71], v[148:151]
ds_read_b64_tr_b16 v[36:37], v5 offset:16384
ds_read_b64_tr_b16 v[38:39], v5 offset:17408
v_mfma_f32_16x16x32_bf16 v[152:155], v[52:55], v[72:75], v[152:155]
ds_read_b64_tr_b16 v[40:41], v6 offset:16384
v_mfma_f32_16x16x32_bf16 v[156:159], v[52:55], v[76:79], v[156:159]
ds_read_b64_tr_b16 v[42:43], v6 offset:17408
v_mfma_f32_16x16x32_bf16 v[160:163], v[56:59], v[64:67], v[160:163]
ds_read_b64_tr_b16 v[44:45], v7 offset:16384
v_mfma_f32_16x16x32_bf16 v[164:167], v[56:59], v[68:71], v[164:167]
ds_read_b64_tr_b16 v[46:47], v7 offset:17408
v_mfma_f32_16x16x32_bf16 v[168:171], v[56:59], v[72:75], v[168:171]
v_mfma_f32_16x16x32_bf16 v[172:175], v[56:59], v[76:79], v[172:175]
v_mfma_f32_16x16x32_bf16 v[176:179], v[60:63], v[64:67], v[176:179]
v_mfma_f32_16x16x32_bf16 v[180:183], v[60:63], v[68:71], v[180:183]
v_mfma_f32_16x16x32_bf16 v[184:187], v[60:63], v[72:75], v[184:187]
v_mfma_f32_16x16x32_bf16 v[188:191], v[60:63], v[76:79], v[188:191]
s_waitcnt lgkmcnt(0)
v_mfma_f32_16x16x32_bf16 v[128:131], v[16:19], v[32:35], v[128:131]
ds_read_b128 v[48:51], v2 offset:51200
ds_read_b128 v[52:55], v2 offset:51456
v_mfma_f32_16x16x32_bf16 v[132:135], v[16:19], v[36:39], v[132:135]
ds_read_b128 v[56:59], v2 offset:55296
v_mfma_f32_16x16x32_bf16 v[136:139], v[16:19], v[40:43], v[136:139]
ds_read_b128 v[60:63], v2 offset:55552
v_mfma_f32_16x16x32_bf16 v[140:143], v[16:19], v[44:47], v[140:143]
ds_read_b64_tr_b16 v[64:65], v4 offset:24576
v_mfma_f32_16x16x32_bf16 v[144:147], v[20:23], v[32:35], v[144:147]
ds_read_b64_tr_b16 v[66:67], v4 offset:25600
v_mfma_f32_16x16x32_bf16 v[148:151], v[20:23], v[36:39], v[148:151]
ds_read_b64_tr_b16 v[68:69], v5 offset:24576
ds_read_b64_tr_b16 v[70:71], v5 offset:25600
v_mfma_f32_16x16x32_bf16 v[152:155], v[20:23], v[40:43], v[152:155]
ds_read_b64_tr_b16 v[72:73], v6 offset:24576
v_mfma_f32_16x16x32_bf16 v[156:159], v[20:23], v[44:47], v[156:159]
ds_read_b64_tr_b16 v[74:75], v6 offset:25600
v_mfma_f32_16x16x32_bf16 v[160:163], v[24:27], v[32:35], v[160:163]
ds_read_b64_tr_b16 v[76:77], v7 offset:24576
v_mfma_f32_16x16x32_bf16 v[164:167], v[24:27], v[36:39], v[164:167]
ds_read_b64_tr_b16 v[78:79], v7 offset:25600
v_mfma_f32_16x16x32_bf16 v[168:171], v[24:27], v[40:43], v[168:171]
v_mfma_f32_16x16x32_bf16 v[172:175], v[24:27], v[44:47], v[172:175]
v_mfma_f32_16x16x32_bf16 v[176:179], v[28:31], v[32:35], v[176:179]
s_waitcnt vmcnt(0)
v_add_f32 v80, v80, v82
v_mfma_f32_16x16x32_bf16 v[180:183], v[28:31], v[36:39], v[180:183]
v_add_f32 v81, v81, v83
v_add_f32 v80, v80, v84
v_mfma_f32_16x16x32_bf16 v[184:187], v[28:31], v[40:43], v[184:187]
s_waitcnt lgkmcnt(0)
v_add_f32 v81, v81, v85
v_mfma_f32_16x16x32_bf16 v[188:191], v[28:31], v[44:47], v[188:191]
s_barrier
v_mfma_f32_16x16x32_bf16 v[128:131], v[48:51], v[64:67], v[128:131]
ds_read_b128 v[16:19], v2 offset:0
ds_read_b128 v[20:23], v2 offset:256
v_mfma_f32_16x16x32_bf16 v[132:135], v[48:51], v[68:71], v[132:135]
ds_read_b128 v[24:27], v2 offset:4096
v_add_f32 v80, v80, v86
v_mfma_f32_16x16x32_bf16 v[136:139], v[48:51], v[72:75], v[136:139]
ds_read_b128 v[28:31], v2 offset:4352
v_add_f32 v81, v81, v87
v_mfma_f32_16x16x32_bf16 v[140:143], v[48:51], v[76:79], v[140:143]
ds_read_b64_tr_b16 v[32:33], v4 offset:32768
v_add_f32 v80, v80, v88
v_mfma_f32_16x16x32_bf16 v[144:147], v[52:55], v[64:67], v[144:147]
ds_read_b64_tr_b16 v[34:35], v4 offset:33792
v_add_f32 v81, v81, v89
v_mfma_f32_16x16x32_bf16 v[148:151], v[52:55], v[68:71], v[148:151]
ds_read_b64_tr_b16 v[36:37], v5 offset:32768
ds_read_b64_tr_b16 v[38:39], v5 offset:33792
v_mfma_f32_16x16x32_bf16 v[152:155], v[52:55], v[72:75], v[152:155]
ds_read_b64_tr_b16 v[40:41], v6 offset:32768
v_add_f32 v80, v80, v90
v_mfma_f32_16x16x32_bf16 v[156:159], v[52:55], v[76:79], v[156:159]
ds_read_b64_tr_b16 v[42:43], v6 offset:33792
v_add_f32 v81, v81, v91
v_mfma_f32_16x16x32_bf16 v[160:163], v[56:59], v[64:67], v[160:163]
ds_read_b64_tr_b16 v[44:45], v7 offset:32768
v_add_f32 v80, v80, v92
v_mfma_f32_16x16x32_bf16 v[164:167], v[56:59], v[68:71], v[164:167]
ds_read_b64_tr_b16 v[46:47], v7 offset:33792
v_add_f32 v81, v81, v93
v_mfma_f32_16x16x32_bf16 v[168:171], v[56:59], v[72:75], v[168:171]
v_add_f32 v80, v80, v94
v_add_f32 v81, v81, v95
v_mfma_f32_16x16x32_bf16 v[172:175], v[56:59], v[76:79], v[172:175]
v_mul_f32 v82, 0x3acccccd, v80
v_mul_f32 v81, 0x3acccccd, v81
v_mfma_f32_16x16x32_bf16 v[176:179], v[60:63], v[64:67], v[176:179]
v_fma_f32 v81, -v82, v82, v81
v_max_f32 v81, 0, v81
v_mfma_f32_16x16x32_bf16 v[180:183], v[60:63], v[68:71], v[180:183]
v_add_f32 v81, 0x3727c5ac, v81
v_rsq_f32 v83, v81
v_mfma_f32_16x16x32_bf16 v[184:187], v[60:63], v[72:75], v[184:187]
s_nop 0
v_sub_f32 v192, 0, v192
v_mfma_f32_16x16x32_bf16 v[188:191], v[60:63], v[76:79], v[188:191]
v_sub_f32 v194, 0, v194
s_waitcnt lgkmcnt(0)
v_mfma_f32_16x16x32_bf16 v[128:131], v[16:19], v[32:35], v[128:131]
ds_read_b128 v[48:51], v2 offset:2048
ds_read_b128 v[52:55], v2 offset:2304
v_mfma_f32_16x16x32_bf16 v[132:135], v[16:19], v[36:39], v[132:135]
ds_read_b128 v[56:59], v2 offset:6144
v_sub_f32 v196, 0, v196
v_mfma_f32_16x16x32_bf16 v[136:139], v[16:19], v[40:43], v[136:139]
ds_read_b128 v[60:63], v2 offset:6400
v_sub_f32 v198, 0, v198
v_mfma_f32_16x16x32_bf16 v[140:143], v[16:19], v[44:47], v[140:143]
ds_read_b64_tr_b16 v[64:65], v4 offset:40960
v_mfma_f32_16x16x32_bf16 v[144:147], v[20:23], v[32:35], v[144:147]
ds_read_b64_tr_b16 v[66:67], v4 offset:41984
v_mfma_f32_16x16x32_bf16 v[148:151], v[20:23], v[36:39], v[148:151]
ds_read_b64_tr_b16 v[68:69], v5 offset:40960
ds_read_b64_tr_b16 v[70:71], v5 offset:41984
v_mfma_f32_16x16x32_bf16 v[152:155], v[20:23], v[40:43], v[152:155]
ds_read_b64_tr_b16 v[72:73], v6 offset:40960
v_mfma_f32_16x16x32_bf16 v[156:159], v[20:23], v[44:47], v[156:159]
ds_read_b64_tr_b16 v[74:75], v6 offset:41984
v_mfma_f32_16x16x32_bf16 v[160:163], v[24:27], v[32:35], v[160:163]
ds_read_b64_tr_b16 v[76:77], v7 offset:40960
v_mfma_f32_16x16x32_bf16 v[164:167], v[24:27], v[36:39], v[164:167]
ds_read_b64_tr_b16 v[78:79], v7 offset:41984
v_mfma_f32_16x16x32_bf16 v[168:171], v[24:27], v[40:43], v[168:171]
v_mfma_f32_16x16x32_bf16 v[172:175], v[24:27], v[44:47], v[172:175]
v_mfma_f32_16x16x32_bf16 v[176:179], v[28:31], v[32:35], v[176:179]
v_mfma_f32_16x16x32_bf16 v[180:183], v[28:31], v[36:39], v[180:183]
v_mfma_f32_16x16x32_bf16 v[184:187], v[28:31], v[40:43], v[184:187]
s_waitcnt lgkmcnt(0)
v_mfma_f32_16x16x32_bf16 v[188:191], v[28:31], v[44:47], v[188:191]
s_barrier
v_mfma_f32_16x16x32_bf16 v[128:131], v[48:51], v[64:67], v[128:131]
ds_read_b128 v[16:19], v2 offset:16384
ds_read_b128 v[20:23], v2 offset:16640
v_mfma_f32_16x16x32_bf16 v[132:135], v[48:51], v[68:71], v[132:135]
ds_read_b128 v[24:27], v2 offset:20480
v_mfma_f32_16x16x32_bf16 v[136:139], v[48:51], v[72:75], v[136:139]
ds_read_b128 v[28:31], v2 offset:20736
ds_write_b32 v12, v82
v_mfma_f32_16x16x32_bf16 v[140:143], v[48:51], v[76:79], v[140:143]
ds_read_b64_tr_b16 v[32:33], v8 offset:0
ds_write_b32 v12, v83 offset:256
v_mfma_f32_16x16x32_bf16 v[144:147], v[52:55], v[64:67], v[144:147]
ds_read_b64_tr_b16 v[34:35], v8 offset:1024
ds_read_b128 v[96:99], v13 offset:0
v_mfma_f32_16x16x32_bf16 v[148:151], v[52:55], v[68:71], v[148:151]
ds_read_b64_tr_b16 v[36:37], v9 offset:0
ds_read_b64_tr_b16 v[38:39], v9 offset:1024
v_mfma_f32_16x16x32_bf16 v[152:155], v[52:55], v[72:75], v[152:155]
ds_read_b64_tr_b16 v[40:41], v10 offset:0
ds_read_b128 v[100:103], v13 offset:64
v_mfma_f32_16x16x32_bf16 v[156:159], v[52:55], v[76:79], v[156:159]
ds_read_b64_tr_b16 v[42:43], v10 offset:1024
ds_read_b128 v[104:107], v13 offset:128
v_mfma_f32_16x16x32_bf16 v[160:163], v[56:59], v[64:67], v[160:163]
ds_read_b64_tr_b16 v[44:45], v11 offset:0
ds_read_b128 v[108:111], v13 offset:192
v_mfma_f32_16x16x32_bf16 v[164:167], v[56:59], v[68:71], v[164:167]
ds_read_b64_tr_b16 v[46:47], v11 offset:1024
ds_read_b128 v[112:115], v13 offset:256
v_mfma_f32_16x16x32_bf16 v[168:171], v[56:59], v[72:75], v[168:171]
ds_read_b128 v[116:119], v13 offset:320
ds_read_b128 v[120:123], v13 offset:384
v_mfma_f32_16x16x32_bf16 v[172:175], v[56:59], v[76:79], v[172:175]
ds_read_b128 v[124:127], v13 offset:448
v_mfma_f32_16x16x32_bf16 v[176:179], v[60:63], v[64:67], v[176:179]
v_mfma_f32_16x16x32_bf16 v[180:183], v[60:63], v[68:71], v[180:183]
v_mfma_f32_16x16x32_bf16 v[184:187], v[60:63], v[72:75], v[184:187]
v_mfma_f32_16x16x32_bf16 v[188:191], v[60:63], v[76:79], v[188:191]
s_waitcnt lgkmcnt(0)
v_mfma_f32_16x16x32_bf16 v[128:131], v[16:19], v[32:35], v[128:131]
ds_read_b128 v[48:51], v2 offset:18432
ds_read_b128 v[52:55], v2 offset:18688
v_mfma_f32_16x16x32_bf16 v[132:135], v[16:19], v[36:39], v[132:135]
ds_read_b128 v[56:59], v2 offset:22528
v_mfma_f32_16x16x32_bf16 v[136:139], v[16:19], v[40:43], v[136:139]
ds_read_b128 v[60:63], v2 offset:22784
v_mfma_f32_16x16x32_bf16 v[140:143], v[16:19], v[44:47], v[140:143]
ds_read_b64_tr_b16 v[64:65], v8 offset:8192
v_mfma_f32_16x16x32_bf16 v[144:147], v[20:23], v[32:35], v[144:147]
ds_read_b64_tr_b16 v[66:67], v8 offset:9216
v_mfma_f32_16x16x32_bf16 v[148:151], v[20:23], v[36:39], v[148:151]
ds_read_b64_tr_b16 v[68:69], v9 offset:8192
ds_read_b64_tr_b16 v[70:71], v9 offset:9216
v_mfma_f32_16x16x32_bf16 v[152:155], v[20:23], v[40:43], v[152:155]
ds_read_b64_tr_b16 v[72:73], v10 offset:8192
v_mfma_f32_16x16x32_bf16 v[156:159], v[20:23], v[44:47], v[156:159]
ds_read_b64_tr_b16 v[74:75], v10 offset:9216
v_mfma_f32_16x16x32_bf16 v[160:163], v[24:27], v[32:35], v[160:163]
ds_read_b64_tr_b16 v[76:77], v11 offset:8192
v_mfma_f32_16x16x32_bf16 v[164:167], v[24:27], v[36:39], v[164:167]
ds_read_b64_tr_b16 v[78:79], v11 offset:9216
v_mfma_f32_16x16x32_bf16 v[168:171], v[24:27], v[40:43], v[168:171]
v_mfma_f32_16x16x32_bf16 v[172:175], v[24:27], v[44:47], v[172:175]
v_mfma_f32_16x16x32_bf16 v[176:179], v[28:31], v[32:35], v[176:179]
v_mfma_f32_16x16x32_bf16 v[180:183], v[28:31], v[36:39], v[180:183]
v_mfma_f32_16x16x32_bf16 v[184:187], v[28:31], v[40:43], v[184:187]
s_waitcnt lgkmcnt(0)
v_mfma_f32_16x16x32_bf16 v[188:191], v[28:31], v[44:47], v[188:191]
s_barrier
v_mfma_f32_16x16x32_bf16 v[128:131], v[48:51], v[64:67], v[128:131]
ds_read_b128 v[16:19], v2 offset:32768
ds_read_b128 v[20:23], v2 offset:33024
v_mfma_f32_16x16x32_bf16 v[132:135], v[48:51], v[68:71], v[132:135]
ds_read_b128 v[24:27], v2 offset:36864
v_mfma_f32_16x16x32_bf16 v[136:139], v[48:51], v[72:75], v[136:139]
ds_read_b128 v[28:31], v2 offset:37120
v_fmac_f32 v148, v194, v100
v_mfma_f32_16x16x32_bf16 v[140:143], v[48:51], v[76:79], v[140:143]
ds_read_b64_tr_b16 v[32:33], v8 offset:16384
v_fmac_f32 v152, v196, v100
v_mfma_f32_16x16x32_bf16 v[144:147], v[52:55], v[64:67], v[144:147]
ds_read_b64_tr_b16 v[34:35], v8 offset:17408
v_fmac_f32 v156, v198, v100
v_mfma_f32_16x16x32_bf16 v[148:151], v[52:55], v[68:71], v[148:151]
ds_read_b64_tr_b16 v[36:37], v9 offset:16384
ds_read_b64_tr_b16 v[38:39], v9 offset:17408
v_mfma_f32_16x16x32_bf16 v[152:155], v[52:55], v[72:75], v[152:155]
ds_read_b64_tr_b16 v[40:41], v10 offset:16384
v_fmac_f32 v164, v194, v104
v_mfma_f32_16x16x32_bf16 v[156:159], v[52:55], v[76:79], v[156:159]
ds_read_b64_tr_b16 v[42:43], v10 offset:17408
v_fmac_f32 v168, v196, v104
v_mfma_f32_16x16x32_bf16 v[160:163], v[56:59], v[64:67], v[160:163]
ds_read_b64_tr_b16 v[44:45], v11 offset:16384
v_fmac_f32 v172, v198, v104
v_mfma_f32_16x16x32_bf16 v[164:167], v[56:59], v[68:71], v[164:167]
ds_read_b64_tr_b16 v[46:47], v11 offset:17408
v_fmac_f32 v176, v192, v108
v_mfma_f32_16x16x32_bf16 v[168:171], v[56:59], v[72:75], v[168:171]
v_fmac_f32 v180, v194, v108
v_fmac_f32 v181, v194, v109
v_mfma_f32_16x16x32_bf16 v[172:175], v[56:59], v[76:79], v[172:175]
v_fmac_f32 v184, v196, v108
v_fmac_f32 v185, v196, v109
v_mfma_f32_16x16x32_bf16 v[176:179], v[60:63], v[64:67], v[176:179]
v_fmac_f32 v188, v198, v108
v_fmac_f32 v189, v198, v109
v_mfma_f32_16x16x32_bf16 v[180:183], v[60:63], v[68:71], v[180:183]
v_fmac_f32 v128, v192, v96
v_fmac_f32 v129, v192, v97
v_mfma_f32_16x16x32_bf16 v[184:187], v[60:63], v[72:75], v[184:187]
v_fmac_f32 v132, v194, v96
v_fmac_f32 v133, v194, v97
v_mfma_f32_16x16x32_bf16 v[188:191], v[60:63], v[76:79], v[188:191]
v_fmac_f32 v136, v196, v96
s_waitcnt lgkmcnt(0)
v_mfma_f32_16x16x32_bf16 v[128:131], v[16:19], v[32:35], v[128:131]
ds_read_b128 v[48:51], v2 offset:34816
ds_read_b128 v[52:55], v2 offset:35072
v_mfma_f32_16x16x32_bf16 v[132:135], v[16:19], v[36:39], v[132:135]
ds_read_b128 v[56:59], v2 offset:38912
v_fmac_f32 v144, v192, v100
v_mfma_f32_16x16x32_bf16 v[136:139], v[16:19], v[40:43], v[136:139]
ds_read_b128 v[60:63], v2 offset:39168
v_fmac_f32 v160, v192, v104
v_mfma_f32_16x16x32_bf16 v[140:143], v[16:19], v[44:47], v[140:143]
ds_read_b64_tr_b16 v[64:65], v8 offset:24576
v_fmac_f32 v153, v196, v101
v_mfma_f32_16x16x32_bf16 v[144:147], v[20:23], v[32:35], v[144:147]
ds_read_b64_tr_b16 v[66:67], v8 offset:25600
v_fmac_f32 v157, v198, v101
v_mfma_f32_16x16x32_bf16 v[148:151], v[20:23], v[36:39], v[148:151]
ds_read_b64_tr_b16 v[68:69], v9 offset:24576
ds_read_b64_tr_b16 v[70:71], v9 offset:25600
v_mfma_f32_16x16x32_bf16 v[152:155], v[20:23], v[40:43], v[152:155]
ds_read_b64_tr_b16 v[72:73], v10 offset:24576
v_fmac_f32 v165, v194, v105
v_mfma_f32_16x16x32_bf16 v[156:159], v[20:23], v[44:47], v[156:159]
ds_read_b64_tr_b16 v[74:75], v10 offset:25600
v_fmac_f32 v140, v198, v96
v_mfma_f32_16x16x32_bf16 v[160:163], v[24:27], v[32:35], v[160:163]
ds_read_b64_tr_b16 v[76:77], v11 offset:24576
v_fmac_f32 v173, v198, v105
v_mfma_f32_16x16x32_bf16 v[164:167], v[24:27], v[36:39], v[164:167]
ds_read_b64_tr_b16 v[78:79], v11 offset:25600
v_fmac_f32 v177, v192, v109
v_mfma_f32_16x16x32_bf16 v[168:171], v[24:27], v[40:43], v[168:171]
v_fmac_f32 v137, v196, v97
v_fmac_f32 v138, v196, v98
v_mfma_f32_16x16x32_bf16 v[172:175], v[24:27], v[44:47], v[172:175]
v_fmac_f32 v141, v198, v97
v_fmac_f32 v142, v198, v98
v_mfma_f32_16x16x32_bf16 v[176:179], v[28:31], v[32:35], v[176:179]
v_fmac_f32 v145, v192, v101
v_fmac_f32 v146, v192, v102
v_mfma_f32_16x16x32_bf16 v[180:183], v[28:31], v[36:39], v[180:183]
v_fmac_f32 v149, v194, v101
v_fmac_f32 v150, v194, v102
v_mfma_f32_16x16x32_bf16 v[184:187], v[28:31], v[40:43], v[184:187]
s_waitcnt lgkmcnt(0)
v_fmac_f32 v161, v192, v105
v_mfma_f32_16x16x32_bf16 v[188:191], v[28:31], v[44:47], v[188:191]
s_barrier
v_mfma_f32_16x16x32_bf16 v[128:131], v[48:51], v[64:67], v[128:131]
ds_read_b128 v[16:19], v2 offset:49152
ds_read_b128 v[20:23], v2 offset:49408
v_mfma_f32_16x16x32_bf16 v[132:135], v[48:51], v[68:71], v[132:135]
ds_read_b128 v[24:27], v2 offset:53248
v_fmac_f32 v169, v196, v105
v_mfma_f32_16x16x32_bf16 v[136:139], v[48:51], v[72:75], v[136:139]
ds_read_b128 v[28:31], v2 offset:53504
v_fmac_f32 v154, v196, v102
v_mfma_f32_16x16x32_bf16 v[140:143], v[48:51], v[76:79], v[140:143]
ds_read_b64_tr_b16 v[32:33], v8 offset:32768
v_fmac_f32 v158, v198, v102
v_mfma_f32_16x16x32_bf16 v[144:147], v[52:55], v[64:67], v[144:147]
ds_read_b64_tr_b16 v[34:35], v8 offset:33792
v_fmac_f32 v162, v192, v106
v_mfma_f32_16x16x32_bf16 v[148:151], v[52:55], v[68:71], v[148:151]
ds_read_b64_tr_b16 v[36:37], v9 offset:32768
ds_read_b64_tr_b16 v[38:39], v9 offset:33792
v_mfma_f32_16x16x32_bf16 v[152:155], v[52:55], v[72:75], v[152:155]
ds_read_b64_tr_b16 v[40:41], v10 offset:32768
v_fmac_f32 v166, v194, v106
v_mfma_f32_16x16x32_bf16 v[156:159], v[52:55], v[76:79], v[156:159]
ds_read_b64_tr_b16 v[42:43], v10 offset:33792
v_fmac_f32 v170, v196, v106
v_mfma_f32_16x16x32_bf16 v[160:163], v[56:59], v[64:67], v[160:163]
ds_read_b64_tr_b16 v[44:45], v11 offset:32768
v_fmac_f32 v174, v198, v106
v_mfma_f32_16x16x32_bf16 v[164:167], v[56:59], v[68:71], v[164:167]
ds_read_b64_tr_b16 v[46:47], v11 offset:33792
v_fmac_f32 v178, v192, v110
v_mfma_f32_16x16x32_bf16 v[168:171], v[56:59], v[72:75], v[168:171]
v_fmac_f32 v182, v194, v110
v_fmac_f32 v183, v194, v111
v_mfma_f32_16x16x32_bf16 v[172:175], v[56:59], v[76:79], v[172:175]
v_fmac_f32 v186, v196, v110
v_fmac_f32 v187, v196, v111
v_mfma_f32_16x16x32_bf16 v[176:179], v[60:63], v[64:67], v[176:179]
v_fmac_f32 v190, v198, v110
v_fmac_f32 v191, v198, v111
v_mfma_f32_16x16x32_bf16 v[180:183], v[60:63], v[68:71], v[180:183]
v_fmac_f32 v130, v192, v98
v_fmac_f32 v131, v192, v99
v_mfma_f32_16x16x32_bf16 v[184:187], v[60:63], v[72:75], v[184:187]
v_fmac_f32 v134, v194, v98
v_fmac_f32 v135, v194, v99
v_mfma_f32_16x16x32_bf16 v[188:191], v[60:63], v[76:79], v[188:191]
v_fmac_f32 v139, v196, v99
s_waitcnt lgkmcnt(0)
v_mfma_f32_16x16x32_bf16 v[128:131], v[16:19], v[32:35], v[128:131]
ds_read_b128 v[48:51], v2 offset:51200
ds_read_b128 v[52:55], v2 offset:51456
v_mfma_f32_16x16x32_bf16 v[132:135], v[16:19], v[36:39], v[132:135]
ds_read_b128 v[56:59], v2 offset:55296
v_fmac_f32 v147, v192, v103
v_mfma_f32_16x16x32_bf16 v[136:139], v[16:19], v[40:43], v[136:139]
ds_read_b128 v[60:63], v2 offset:55552
v_fmac_f32 v151, v194, v103
v_mfma_f32_16x16x32_bf16 v[140:143], v[16:19], v[44:47], v[140:143]
ds_read_b64_tr_b16 v[64:65], v8 offset:40960
v_fmac_f32 v155, v196, v103
v_mfma_f32_16x16x32_bf16 v[144:147], v[20:23], v[32:35], v[144:147]
ds_read_b64_tr_b16 v[66:67], v8 offset:41984
v_fmac_f32 v159, v198, v103
v_mfma_f32_16x16x32_bf16 v[148:151], v[20:23], v[36:39], v[148:151]
ds_read_b64_tr_b16 v[68:69], v9 offset:40960
ds_read_b64_tr_b16 v[70:71], v9 offset:41984
v_mfma_f32_16x16x32_bf16 v[152:155], v[20:23], v[40:43], v[152:155]
ds_read_b64_tr_b16 v[72:73], v10 offset:40960
v_fmac_f32 v167, v194, v107
v_mfma_f32_16x16x32_bf16 v[156:159], v[20:23], v[44:47], v[156:159]
ds_read_b64_tr_b16 v[74:75], v10 offset:41984
v_fmac_f32 v171, v196, v107
v_mfma_f32_16x16x32_bf16 v[160:163], v[24:27], v[32:35], v[160:163]
ds_read_b64_tr_b16 v[76:77], v11 offset:40960
v_fmac_f32 v175, v198, v107
v_mfma_f32_16x16x32_bf16 v[164:167], v[24:27], v[36:39], v[164:167]
ds_read_b64_tr_b16 v[78:79], v11 offset:41984
v_fmac_f32 v179, v192, v111
v_mfma_f32_16x16x32_bf16 v[168:171], v[24:27], v[40:43], v[168:171]
v_fmac_f32 v143, v198, v99
v_mfma_f32_16x16x32_bf16 v[172:175], v[24:27], v[44:47], v[172:175]
v_mfma_f32_16x16x32_bf16 v[176:179], v[28:31], v[32:35], v[176:179]
v_fmac_f32 v163, v192, v107
v_mfma_f32_16x16x32_bf16 v[180:183], v[28:31], v[36:39], v[180:183]
v_mfma_f32_16x16x32_bf16 v[184:187], v[28:31], v[40:43], v[184:187]
s_waitcnt lgkmcnt(0)
v_mfma_f32_16x16x32_bf16 v[188:191], v[28:31], v[44:47], v[188:191]
s_barrier
v_mfma_f32_16x16x32_bf16 v[128:131], v[48:51], v[64:67], v[128:131]
ds_read_b128 v[16:19], v2 offset:0
ds_read_b128 v[20:23], v2 offset:256
v_mfma_f32_16x16x32_bf16 v[132:135], v[48:51], v[68:71], v[132:135]
ds_read_b128 v[24:27], v2 offset:4096
v_mfma_f32_16x16x32_bf16 v[136:139], v[48:51], v[72:75], v[136:139]
ds_read_b128 v[28:31], v2 offset:4352
v_mfma_f32_16x16x32_bf16 v[140:143], v[48:51], v[76:79], v[140:143]
ds_read_b64_tr_b16 v[32:33], v4 offset:0
v_mfma_f32_16x16x32_bf16 v[144:147], v[52:55], v[64:67], v[144:147]
ds_read_b64_tr_b16 v[34:35], v4 offset:1024
v_mfma_f32_16x16x32_bf16 v[148:151], v[52:55], v[68:71], v[148:151]
ds_read_b64_tr_b16 v[36:37], v5 offset:0
ds_read_b64_tr_b16 v[38:39], v5 offset:1024
v_mfma_f32_16x16x32_bf16 v[152:155], v[52:55], v[72:75], v[152:155]
ds_read_b64_tr_b16 v[40:41], v6 offset:0
v_mfma_f32_16x16x32_bf16 v[156:159], v[52:55], v[76:79], v[156:159]
ds_read_b64_tr_b16 v[42:43], v6 offset:1024
v_mfma_f32_16x16x32_bf16 v[160:163], v[56:59], v[64:67], v[160:163]
ds_read_b64_tr_b16 v[44:45], v7 offset:0
v_mfma_f32_16x16x32_bf16 v[164:167], v[56:59], v[68:71], v[164:167]
ds_read_b64_tr_b16 v[46:47], v7 offset:1024
v_mfma_f32_16x16x32_bf16 v[168:171], v[56:59], v[72:75], v[168:171]
v_mfma_f32_16x16x32_bf16 v[172:175], v[56:59], v[76:79], v[172:175]
v_mfma_f32_16x16x32_bf16 v[176:179], v[60:63], v[64:67], v[176:179]
v_mfma_f32_16x16x32_bf16 v[180:183], v[60:63], v[68:71], v[180:183]
v_mfma_f32_16x16x32_bf16 v[184:187], v[60:63], v[72:75], v[184:187]
v_mfma_f32_16x16x32_bf16 v[188:191], v[60:63], v[76:79], v[188:191]
s_waitcnt lgkmcnt(0)
v_mfma_f32_16x16x32_bf16 v[128:131], v[16:19], v[32:35], v[128:131]
ds_read_b128 v[48:51], v2 offset:2048
ds_read_b128 v[52:55], v2 offset:2304
v_mfma_f32_16x16x32_bf16 v[132:135], v[16:19], v[36:39], v[132:135]
ds_read_b128 v[56:59], v2 offset:6144
v_mfma_f32_16x16x32_bf16 v[136:139], v[16:19], v[40:43], v[136:139]
ds_read_b128 v[60:63], v2 offset:6400
v_mfma_f32_16x16x32_bf16 v[140:143], v[16:19], v[44:47], v[140:143]
ds_read_b64_tr_b16 v[64:65], v4 offset:8192
v_mfma_f32_16x16x32_bf16 v[144:147], v[20:23], v[32:35], v[144:147]
ds_read_b64_tr_b16 v[66:67], v4 offset:9216
v_mfma_f32_16x16x32_bf16 v[148:151], v[20:23], v[36:39], v[148:151]
ds_read_b64_tr_b16 v[68:69], v5 offset:8192
ds_read_b64_tr_b16 v[70:71], v5 offset:9216
v_mfma_f32_16x16x32_bf16 v[152:155], v[20:23], v[40:43], v[152:155]
ds_read_b64_tr_b16 v[72:73], v6 offset:8192
v_mfma_f32_16x16x32_bf16 v[156:159], v[20:23], v[44:47], v[156:159]
ds_read_b64_tr_b16 v[74:75], v6 offset:9216
v_mfma_f32_16x16x32_bf16 v[160:163], v[24:27], v[32:35], v[160:163]
ds_read_b64_tr_b16 v[76:77], v7 offset:8192
v_mfma_f32_16x16x32_bf16 v[164:167], v[24:27], v[36:39], v[164:167]
ds_read_b64_tr_b16 v[78:79], v7 offset:9216
v_mfma_f32_16x16x32_bf16 v[168:171], v[24:27], v[40:43], v[168:171]
v_mfma_f32_16x16x32_bf16 v[172:175], v[24:27], v[44:47], v[172:175]
v_mfma_f32_16x16x32_bf16 v[176:179], v[28:31], v[32:35], v[176:179]
v_mfma_f32_16x16x32_bf16 v[180:183], v[28:31], v[36:39], v[180:183]
v_mfma_f32_16x16x32_bf16 v[184:187], v[28:31], v[40:43], v[184:187]
s_waitcnt lgkmcnt(0)
v_mfma_f32_16x16x32_bf16 v[188:191], v[28:31], v[44:47], v[188:191]
s_barrier
v_mfma_f32_16x16x32_bf16 v[128:131], v[48:51], v[64:67], v[128:131]
ds_read_b128 v[16:19], v2 offset:16384
ds_read_b128 v[20:23], v2 offset:16640
v_mfma_f32_16x16x32_bf16 v[132:135], v[48:51], v[68:71], v[132:135]
ds_read_b128 v[24:27], v2 offset:20480
v_mfma_f32_16x16x32_bf16 v[136:139], v[48:51], v[72:75], v[136:139]
ds_read_b128 v[28:31], v2 offset:20736
v_mfma_f32_16x16x32_bf16 v[140:143], v[48:51], v[76:79], v[140:143]
ds_read_b64_tr_b16 v[32:33], v4 offset:16384
v_mfma_f32_16x16x32_bf16 v[144:147], v[52:55], v[64:67], v[144:147]
ds_read_b64_tr_b16 v[34:35], v4 offset:17408
v_mfma_f32_16x16x32_bf16 v[148:151], v[52:55], v[68:71], v[148:151]
ds_read_b64_tr_b16 v[36:37], v5 offset:16384
ds_read_b64_tr_b16 v[38:39], v5 offset:17408
v_mfma_f32_16x16x32_bf16 v[152:155], v[52:55], v[72:75], v[152:155]
ds_read_b64_tr_b16 v[40:41], v6 offset:16384
v_mfma_f32_16x16x32_bf16 v[156:159], v[52:55], v[76:79], v[156:159]
ds_read_b64_tr_b16 v[42:43], v6 offset:17408
v_mfma_f32_16x16x32_bf16 v[160:163], v[56:59], v[64:67], v[160:163]
ds_read_b64_tr_b16 v[44:45], v7 offset:16384
v_mfma_f32_16x16x32_bf16 v[164:167], v[56:59], v[68:71], v[164:167]
ds_read_b64_tr_b16 v[46:47], v7 offset:17408
v_mfma_f32_16x16x32_bf16 v[168:171], v[56:59], v[72:75], v[168:171]
v_mfma_f32_16x16x32_bf16 v[172:175], v[56:59], v[76:79], v[172:175]
v_mfma_f32_16x16x32_bf16 v[176:179], v[60:63], v[64:67], v[176:179]
v_mfma_f32_16x16x32_bf16 v[180:183], v[60:63], v[68:71], v[180:183]
v_mfma_f32_16x16x32_bf16 v[184:187], v[60:63], v[72:75], v[184:187]
v_mfma_f32_16x16x32_bf16 v[188:191], v[60:63], v[76:79], v[188:191]
s_waitcnt lgkmcnt(0)
v_mfma_f32_16x16x32_bf16 v[128:131], v[16:19], v[32:35], v[128:131]
ds_read_b128 v[48:51], v2 offset:18432
v_mfma_f32_16x16x32_bf16 v[132:135], v[16:19], v[36:39], v[132:135]
ds_read_b128 v[52:55], v2 offset:18688
v_mfma_f32_16x16x32_bf16 v[136:139], v[16:19], v[40:43], v[136:139]
ds_read_b128 v[56:59], v2 offset:22528
v_mfma_f32_16x16x32_bf16 v[140:143], v[16:19], v[44:47], v[140:143]
ds_read_b128 v[60:63], v2 offset:22784
v_mfma_f32_16x16x32_bf16 v[144:147], v[20:23], v[32:35], v[144:147]
ds_read_b64_tr_b16 v[64:65], v4 offset:24576
v_mfma_f32_16x16x32_bf16 v[148:151], v[20:23], v[36:39], v[148:151]
ds_read_b64_tr_b16 v[66:67], v4 offset:25600
v_mfma_f32_16x16x32_bf16 v[152:155], v[20:23], v[40:43], v[152:155]
ds_read_b64_tr_b16 v[68:69], v5 offset:24576
v_mfma_f32_16x16x32_bf16 v[156:159], v[20:23], v[44:47], v[156:159]
ds_read_b64_tr_b16 v[70:71], v5 offset:25600
v_mfma_f32_16x16x32_bf16 v[160:163], v[24:27], v[32:35], v[160:163]
ds_read_b64_tr_b16 v[72:73], v6 offset:24576
v_mfma_f32_16x16x32_bf16 v[164:167], v[24:27], v[36:39], v[164:167]
ds_read_b64_tr_b16 v[74:75], v6 offset:25600
v_mfma_f32_16x16x32_bf16 v[168:171], v[24:27], v[40:43], v[168:171]
ds_read_b64_tr_b16 v[76:77], v7 offset:24576
v_mfma_f32_16x16x32_bf16 v[172:175], v[24:27], v[44:47], v[172:175]
ds_read_b64_tr_b16 v[78:79], v7 offset:25600
s_waitcnt lgkmcnt(0)
v_mfma_f32_16x16x32_bf16 v[128:131], v[48:51], v[64:67], v[128:131]
s_barrier
v_mfma_f32_16x16x32_bf16 v[132:135], v[48:51], v[68:71], v[132:135]
v_mfma_f32_16x16x32_bf16 v[136:139], v[48:51], v[72:75], v[136:139]
v_mfma_f32_16x16x32_bf16 v[140:143], v[48:51], v[76:79], v[140:143]
v_mfma_f32_16x16x32_bf16 v[144:147], v[52:55], v[64:67], v[144:147]
s_nop 1
v_mfma_f32_16x16x32_bf16 v[148:151], v[52:55], v[68:71], v[148:151]
s_nop 1
v_mfma_f32_16x16x32_bf16 v[152:155], v[52:55], v[72:75], v[152:155]
v_mul_f32 v128, v112, v128
v_mul_f32 v129, v113, v129
v_mul_f32 v130, v114, v130
v_mfma_f32_16x16x32_bf16 v[156:159], v[52:55], v[76:79], v[156:159]
v_mul_f32 v131, v115, v131
v_mul_f32 v132, v112, v132
v_mul_f32 v133, v113, v133
v_mfma_f32_16x16x32_bf16 v[160:163], v[56:59], v[64:67], v[160:163]
v_mul_f32 v134, v114, v134
v_mul_f32 v135, v115, v135
v_cvt_pk_bf16_f32 v128, v128, v129
v_mfma_f32_16x16x32_bf16 v[164:167], v[56:59], v[68:71], v[164:167]
v_cvt_pk_bf16_f32 v129, v130, v131
v_cvt_pk_bf16_f32 v130, v132, v133
v_cvt_pk_bf16_f32 v131, v134, v135
v_mfma_f32_16x16x32_bf16 v[168:171], v[56:59], v[72:75], v[168:171]
s_nop 0
v_permlane32_swap_b32 v128, v130
v_permlane32_swap_b32 v129, v131
v_mfma_f32_16x16x32_bf16 v[172:175], v[56:59], v[76:79], v[172:175]
buffer_store_dwordx4 v[128:131], v202, s[36:39], s72 offen offset:0 sc1
v_mul_f32 v136, v112, v136
v_mul_f32 v137, v113, v137
v_mfma_f32_16x16x32_bf16 v[176:179], v[28:31], v[32:35], v[176:179]
v_mul_f32 v138, v114, v138
v_mul_f32 v139, v115, v139
v_mul_f32 v140, v112, v140
v_mfma_f32_16x16x32_bf16 v[180:183], v[28:31], v[36:39], v[180:183]
v_mul_f32 v141, v113, v141
v_mul_f32 v142, v114, v142
v_mul_f32 v143, v115, v143
v_mfma_f32_16x16x32_bf16 v[184:187], v[28:31], v[40:43], v[184:187]
v_cvt_pk_bf16_f32 v136, v136, v137
v_cvt_pk_bf16_f32 v137, v138, v139
v_cvt_pk_bf16_f32 v138, v140, v141
v_mfma_f32_16x16x32_bf16 v[188:191], v[28:31], v[44:47], v[188:191]
v_cvt_pk_bf16_f32 v139, v142, v143
s_nop 0
v_permlane32_swap_b32 v136, v138
v_mfma_f32_16x16x32_bf16 v[176:179], v[60:63], v[64:67], v[176:179]
v_permlane32_swap_b32 v137, v139
buffer_store_dwordx4 v[136:139], v203, s[36:39], s72 offen offset:0 sc1
v_mul_f32 v144, v116, v144
v_mfma_f32_16x16x32_bf16 v[180:183], v[60:63], v[68:71], v[180:183]
v_mul_f32 v145, v117, v145
v_mul_f32 v146, v118, v146
v_mul_f32 v147, v119, v147
v_mfma_f32_16x16x32_bf16 v[184:187], v[60:63], v[72:75], v[184:187]
v_mul_f32 v148, v116, v148
v_mul_f32 v149, v117, v149
v_mul_f32 v150, v118, v150
v_mfma_f32_16x16x32_bf16 v[188:191], v[60:63], v[76:79], v[188:191]
v_mul_f32 v151, v119, v151
v_cvt_pk_bf16_f32 v144, v144, v145
v_cvt_pk_bf16_f32 v145, v146, v147
v_cvt_pk_bf16_f32 v146, v148, v149
v_cvt_pk_bf16_f32 v147, v150, v151
s_nop 0
v_permlane32_swap_b32 v144, v146
v_permlane32_swap_b32 v145, v147
buffer_store_dwordx4 v[144:147], v202, s[36:39], s72 offen offset:640 sc1
v_mul_f32 v152, v116, v152
v_mul_f32 v153, v117, v153
v_mul_f32 v154, v118, v154
v_mul_f32 v155, v119, v155
v_mul_f32 v156, v116, v156
v_mul_f32 v157, v117, v157
v_mul_f32 v158, v118, v158
v_mul_f32 v159, v119, v159
v_cvt_pk_bf16_f32 v152, v152, v153
v_cvt_pk_bf16_f32 v153, v154, v155
v_cvt_pk_bf16_f32 v154, v156, v157
v_cvt_pk_bf16_f32 v155, v158, v159
s_nop 0
v_permlane32_swap_b32 v152, v154
v_permlane32_swap_b32 v153, v155
buffer_store_dwordx4 v[152:155], v203, s[36:39], s72 offen offset:640 sc1
v_pk_mul_f32 v[160:161], v[160:161], v[120:121]
v_pk_mul_f32 v[162:163], v[162:163], v[122:123]
v_pk_mul_f32 v[164:165], v[164:165], v[120:121]
v_pk_mul_f32 v[166:167], v[166:167], v[122:123]
v_cvt_pk_bf16_f32 v160, v160, v161
v_cvt_pk_bf16_f32 v161, v162, v163
v_cvt_pk_bf16_f32 v162, v164, v165
v_cvt_pk_bf16_f32 v163, v166, v167
s_nop 0
v_permlane32_swap_b32 v160, v162
v_permlane32_swap_b32 v161, v163
buffer_store_dwordx4 v[160:163], v202, s[36:39], s72 offen offset:1280 sc1
v_pk_mul_f32 v[168:169], v[168:169], v[120:121]
v_pk_mul_f32 v[170:171], v[170:171], v[122:123]
v_pk_mul_f32 v[172:173], v[172:173], v[120:121]
v_pk_mul_f32 v[174:175], v[174:175], v[122:123]
v_cvt_pk_bf16_f32 v168, v168, v169
v_cvt_pk_bf16_f32 v169, v170, v171
v_cvt_pk_bf16_f32 v170, v172, v173
v_cvt_pk_bf16_f32 v171, v174, v175
s_nop 0
v_permlane32_swap_b32 v168, v170
v_permlane32_swap_b32 v169, v171
buffer_store_dwordx4 v[168:171], v203, s[36:39], s72 offen offset:1280 sc1
v_pk_mul_f32 v[176:177], v[176:177], v[124:125]
v_pk_mul_f32 v[178:179], v[178:179], v[126:127]
v_pk_mul_f32 v[180:181], v[180:181], v[124:125]
v_pk_mul_f32 v[182:183], v[182:183], v[126:127]
v_cvt_pk_bf16_f32 v176, v176, v177
v_cvt_pk_bf16_f32 v177, v178, v179
v_cvt_pk_bf16_f32 v178, v180, v181
v_cvt_pk_bf16_f32 v179, v182, v183
s_nop 0
v_permlane32_swap_b32 v176, v178
v_permlane32_swap_b32 v177, v179
buffer_store_dwordx4 v[176:179], v202, s[36:39], s72 offen offset:1920 sc1
v_pk_mul_f32 v[184:185], v[184:185], v[124:125]
v_pk_mul_f32 v[186:187], v[186:187], v[126:127]
v_pk_mul_f32 v[188:189], v[188:189], v[124:125]
v_pk_mul_f32 v[190:191], v[190:191], v[126:127]
v_cvt_pk_bf16_f32 v184, v184, v185
v_cvt_pk_bf16_f32 v185, v186, v187
v_cvt_pk_bf16_f32 v186, v188, v189
v_cvt_pk_bf16_f32 v187, v190, v191
s_nop 0
v_permlane32_swap_b32 v184, v186
v_permlane32_swap_b32 v185, v187
buffer_store_dwordx4 v[184:187], v203, s[36:39], s72 offen offset:1920 sc1
qkv_fin_224:
s_lshl_b32 s80, s13, 3
s_add_u32 s80, s80, s6
s_lshl_b32 s80, s80, 2
s_add_u32 s80, s80, 51798016
s_add_u32 s81, s8, 8
v_mov_b32 v1, 0
v_mov_b32 v2, s81
s_lshl_b32 s67, s13, 5
s_add_u32 s67, s67, s6
s_lshl_b32 s67, s67, 2
s_add_u32 s67, s67, 44597248
s_waitcnt vmcnt(0)
s_mov_b64 exec, 1
buffer_store_dword v2, v1, s[36:39], s80 offen sc1
s_mov_b64 exec, -1
s_mov_b64 exec, 1
buffer_store_dword v2, v1, s[36:39], s67 offen sc1
s_mov_b64 exec, -1
s_branch L_slow_next
L_slow_ld:
s_sub_u32 s60, s6, 4
v_lshlrev_b32 v8, 4, v0
s_mul_i32 s63, s60, 6144
s_and_b32 s66, s5, 15
s_mul_i32 s66, s66, 245760
s_add_u32 s66, s66, s63
s_add_u32 s66, s66, 47415296
s_lshr_b32 s77, s5, 4
s_mul_i32 s77, s77, 0
s_sub_u32 s74, 10, s77
s_mul_i32 s76, s77, 24576
s_add_u32 s66, s66, s76
s_sub_u32 s67, s66, 245760
s_add_u32 m0, s63, 139264
s_add_u32 s79, s66, 0
buffer_load_dwordx4 v8, s[36:39], s79 offen offset:0  lds
buffer_load_dwordx4 v8, s[36:39], s79 offen offset:1024  lds
buffer_load_dwordx4 v8, s[36:39], s79 offen offset:2048  lds
buffer_load_dwordx4 v8, s[36:39], s79 offen offset:3072  lds
s_add_u32 m0, s63, 143360
s_add_u32 s79, s66, 4096
buffer_load_dwordx4 v8, s[36:39], s79 offen offset:0  lds
buffer_load_dwordx4 v8, s[36:39], s79 offen offset:1024  lds
s_add_u32 m0, s63, 114688
s_add_u32 s79, s66, 24576
buffer_load_dwordx4 v8, s[36:39], s79 offen offset:0  lds
buffer_load_dwordx4 v8, s[36:39], s79 offen offset:1024  lds
buffer_load_dwordx4 v8, s[36:39], s79 offen offset:2048  lds
buffer_load_dwordx4 v8, s[36:39], s79 offen offset:3072  lds
s_add_u32 m0, s63, 118784
s_add_u32 s79, s66, 28672
buffer_load_dwordx4 v8, s[36:39], s79 offen offset:0  lds
buffer_load_dwordx4 v8, s[36:39], s79 offen offset:1024  lds
s_lshl_b32 s61, s60, 12
s_mul_i32 s62, s60, 5120
s_lshr_b32 s70, s13, 4
s_lshl_b32 s70, s70, 2
s_add_u32 s70, s70, s60
s_mul_i32 s70, s70, 40960
s_add_u32 s64, s70, 10485760
s_add_u32 s64, s64, s7
s_add_u32 s70, s70, 13107200
s_and_b32 s68, s5, 15
v_lshrrev_b32 v2, 4, v0
v_mul_u32_u24 v1, 3840, v2
v_lshlrev_b32 v7, 1, v2
v_and_b32 v3, 15, v0
v_xor_b32 v3, v3, v7
v_lshl_add_u32 v6, v3, 4, v1
v_xor_b32 v3, 8, v3
v_lshl_add_u32 v7, v3, 4, v1
s_mul_i32 s72, s60, 61440
s_lshl_b32 s76, s68, 8
s_add_u32 s72, s72, s76
s_sub_u32 s77, 10, s74
s_mul_i32 s76, s77, 4096
s_add_u32 s64, s64, s76
s_sub_u32 s65, s64, 40960
s_lshr_b32 s77, s5, 4
s_mul_i32 s77, s77, 0
s_sub_u32 s78, 10, s77
s_mul_i32 s76, s77, 4096
s_add_u32 s70, s70, s76
s_sub_u32 s71, s70, 40960
s_mul_i32 s76, s77, 245760
s_add_u32 s72, s72, s76
s_sub_u32 s73, s72, 2457600
s_and_b32 s68, s5, 7
s_mul_i32 s68, s68, 245760
s_add_u32 s68, s68, s62
s_add_u32 s68, s68, 45449216
s_lshr_b32 s77, s5, 3
s_mul_i32 s77, s77, 0
s_sub_u32 s75, 12, s77
s_mul_i32 s76, s77, 20480
s_add_u32 s68, s68, s76
s_sub_u32 s69, s68, 245760
s_cmp_lg_u32 s3, 0
s_cbranch_scc1 wpf_229
s_lshr_b32 s76, s5, 4
s_lshl_b32 s77, s60, 1
s_add_u32 s76, s76, s77
s_mul_i32 s76, s76, 24576
s_sub_u32 s77, s66, s63
s_add_u32 s76, s76, s77
s_add_u32 s76, s76, 49152
v_lshlrev_b32 v4, 7, v0
s_mov_b32 exec_lo, 0xffff
s_mov_b32 exec_hi, 0
s_waitcnt vmcnt(0)
buffer_load_dword v5, v4, s[36:39], s76 offen
s_add_u32 s76, s76, 2048
s_waitcnt vmcnt(0)
buffer_load_dword v5, v4, s[36:39], s76 offen
s_add_u32 s76, s76, 2048
s_waitcnt vmcnt(0)
buffer_load_dword v5, v4, s[36:39], s76 offen
s_add_u32 s76, s76, 2048
s_waitcnt vmcnt(0)
buffer_load_dword v5, v4, s[36:39], s76 offen
s_add_u32 s76, s76, 2048
s_mov_b64 exec, -1
wpf_229:
s_barrier
s_barrier
s_lshr_b32 s76, s5, 4
s_mul_i32 s76, s76, 0
v_lshrrev_b32 v1, 1, v0
v_add_u32 v1, s76, v1
v_and_b32 v1, 7, v1
v_lshlrev_b32 v1, 5, v1
v_and_b32 v2, 1, v0
v_lshl_add_u32 v1, v2, 2, v1
s_lshr_b32 s94, s5, 4
s_lshl_b32 s94, s94, 9
s_bfe_u32 s81, s6, 0x10001
s_lshl_b32 s81, s81, 8
s_add_u32 s94, s94, s81
s_and_b32 s81, s6, 1
s_lshl_b32 s81, s81, 3
s_add_u32 s94, s94, s81
s_lshl_b32 s81, s4, 10
s_add_u32 s94, s94, s81
s_add_u32 s94, s94, 51798016
s_add_u32 s95, s8, 3
s_mov_b32 s92, -1
s_and_b32 s82, s92, 0x3
s_cbranch_scc0 gt_230k
s_mov_b32 s82, s9
gt_230:
buffer_load_dword v2, v1, s[36:39], s94 offen sc1
s_waitcnt vmcnt(0)
v_subrev_u32 v2, s95, v2
v_cmp_lt_u32 s[92:93], 15, v2
s_and_b32 s83, s92, 0x3
s_cbranch_scc0 gt_230k
s_add_u32 s82, s82, 1
s_cmp_lt_u32 s82, 200000
s_cbranch_scc1 gt_230
s_mov_b32 s9, 200000
gt_230k:
s_add_u32 m0, s61, 0
s_add_u32 s79, s64, 0
buffer_load_dwordx4 v8, s[36:39], s79 offen offset:0 sc1 lds
buffer_load_dwordx4 v8, s[36:39], s79 offen offset:1024 sc1 lds
buffer_load_dwordx4 v8, s[36:39], s79 offen offset:2048 sc1 lds
buffer_load_dwordx4 v8, s[36:39], s79 offen offset:3072 sc1 lds
s_and_b32 s82, s92, 0xc
s_cbranch_scc0 gt_231k
s_mov_b32 s82, s9
gt_231:
buffer_load_dword v2, v1, s[36:39], s94 offen sc1
s_waitcnt vmcnt(0)
v_subrev_u32 v2, s95, v2
v_cmp_lt_u32 s[92:93], 15, v2
s_and_b32 s83, s92, 0xc
s_cbranch_scc0 gt_231k
s_add_u32 s82, s82, 1
s_cmp_lt_u32 s82, 200000
s_cbranch_scc1 gt_231
s_mov_b32 s9, 200000
gt_231k:
s_add_u32 m0, s61, 16384
s_add_u32 s79, s64, 4096
buffer_load_dwordx4 v8, s[36:39], s79 offen offset:0 sc1 lds
buffer_load_dwordx4 v8, s[36:39], s79 offen offset:1024 sc1 lds
s_add_u32 m0, s61, 18432
s_add_u32 s79, s64, 6144
buffer_load_dwordx4 v8, s[36:39], s79 offen offset:0 sc1 lds
buffer_load_dwordx4 v8, s[36:39], s79 offen offset:1024 sc1 lds
s_add_u32 m0, s63, 90112
s_add_u32 s79, s66, 49152
buffer_load_dwordx4 v8, s[36:39], s79 offen offset:0  lds
buffer_load_dwordx4 v8, s[36:39], s79 offen offset:1024  lds
s_waitcnt vmcnt(6)
s_barrier
s_add_u32 m0, s63, 92160
s_add_u32 s79, s66, 51200
buffer_load_dwordx4 v8, s[36:39], s79 offen offset:0  lds
buffer_load_dwordx4 v8, s[36:39], s79 offen offset:1024  lds
s_add_u32 m0, s63, 94208
s_add_u32 s79, s66, 53248
buffer_load_dwordx4 v8, s[36:39], s79 offen offset:0  lds
buffer_load_dwordx4 v8, s[36:39], s79 offen offset:1024  lds
s_and_b32 s82, s92, 0x30
s_cbranch_scc0 gt_232k
s_mov_b32 s82, s9
gt_232:
buffer_load_dword v2, v1, s[36:39], s94 offen sc1
s_waitcnt vmcnt(0)
v_subrev_u32 v2, s95, v2
v_cmp_lt_u32 s[92:93], 15, v2
s_and_b32 s83, s92, 0x30
s_cbranch_scc0 gt_232k
s_add_u32 s82, s82, 1
s_cmp_lt_u32 s82, 200000
s_cbranch_scc1 gt_232
s_mov_b32 s9, 200000
gt_232k:
s_add_u32 m0, s61, 32768
s_add_u32 s79, s64, 8192
buffer_load_dwordx4 v8, s[36:39], s79 offen offset:0 sc1 lds
buffer_load_dwordx4 v8, s[36:39], s79 offen offset:1024 sc1 lds
s_add_u32 m0, s61, 34816
s_add_u32 s79, s64, 10240
buffer_load_dwordx4 v8, s[36:39], s79 offen offset:0 sc1 lds
buffer_load_dwordx4 v8, s[36:39], s79 offen offset:1024 sc1 lds
s_add_u32 m0, s63, 65536
s_add_u32 s79, s66, 73728
buffer_load_dwordx4 v8, s[36:39], s79 offen offset:0  lds
buffer_load_dwordx4 v8, s[36:39], s79 offen offset:1024  lds
buffer_load_dword v3, v1, s[36:39], s94 offen sc1
s_waitcnt vmcnt(13)
s_barrier
s_add_u32 m0, s63, 67584
s_add_u32 s79, s66, 75776
buffer_load_dwordx4 v8, s[36:39], s79 offen offset:0  lds
buffer_load_dwordx4 v8, s[36:39], s79 offen offset:1024  lds
s_add_u32 m0, s63, 69632
s_add_u32 s79, s66, 77824
buffer_load_dwordx4 v8, s[36:39], s79 offen offset:0  lds
buffer_load_dwordx4 v8, s[36:39], s79 offen offset:1024  lds
s_and_b32 s82, s92, 0xc0
s_cbranch_scc0 gt_233k
s_mov_b32 s82, s9
gt_233:
buffer_load_dword v2, v1, s[36:39], s94 offen sc1
s_waitcnt vmcnt(0)
v_subrev_u32 v2, s95, v2
v_cmp_lt_u32 s[92:93], 15, v2
s_and_b32 s83, s92, 0xc0
s_cbranch_scc0 gt_233k
s_add_u32 s82, s82, 1
s_cmp_lt_u32 s82, 200000
s_cbranch_scc1 gt_233
s_mov_b32 s9, 200000
gt_233k:
s_add_u32 m0, s61, 49152
s_add_u32 s79, s64, 12288
buffer_load_dwordx4 v8, s[36:39], s79 offen offset:0 sc1 lds
buffer_load_dwordx4 v8, s[36:39], s79 offen offset:1024 sc1 lds
s_add_u32 m0, s61, 51200
s_add_u32 s79, s64, 14336
buffer_load_dwordx4 v8, s[36:39], s79 offen offset:0 sc1 lds
buffer_load_dwordx4 v8, s[36:39], s79 offen offset:1024 sc1 lds
s_add_u32 m0, s63, 139264
s_add_u32 s79, s66, 98304
buffer_load_dwordx4 v8, s[36:39], s79 offen offset:0  lds
buffer_load_dwordx4 v8, s[36:39], s79 offen offset:1024  lds
s_add_u32 s95, s95, 1
s_waitcnt vmcnt(10)
v_subrev_u32 v3, s95, v3
v_cmp_lt_u32 s[92:93], 15, v3
s_and_b32 s82, s92, 0xffff
s_cbranch_scc0 gt_234k
s_mov_b32 s82, s9
gt_234:
buffer_load_dword v2, v1, s[36:39], s94 offen sc1
s_waitcnt vmcnt(0)
v_subrev_u32 v2, s95, v2
v_cmp_lt_u32 s[92:93], 15, v2
s_and_b32 s83, s92, 0xffff
s_cbranch_scc0 gt_234k
s_add_u32 s82, s82, 1
s_cmp_lt_u32 s82, 200000
s_cbranch_scc1 gt_234
s_mov_b32 s9, 200000
gt_234k:
s_cmp_lg_u32 s3, 0
s_cbranch_scc1 t0_235
s_waitcnt vmcnt(5)
t0_235:
s_waitcnt vmcnt(13)
s_barrier
s_add_u32 m0, s63, 141312
s_add_u32 s79, s66, 100352
buffer_load_dwordx4 v8, s[36:39], s79 offen offset:0  lds
buffer_load_dwordx4 v8, s[36:39], s79 offen offset:1024  lds
s_add_u32 m0, s63, 143360
s_add_u32 s79, s66, 102400
buffer_load_dwordx4 v8, s[36:39], s79 offen offset:0  lds
buffer_load_dwordx4 v8, s[36:39], s79 offen offset:1024  lds
s_add_u32 m0, s61, 0
s_add_u32 s79, s64, 16384
buffer_load_dwordx4 v8, s[36:39], s79 offen offset:0 sc1 lds
buffer_load_dwordx4 v8, s[36:39], s79 offen offset:1024 sc1 lds
s_add_u32 m0, s61, 2048
s_add_u32 s79, s64, 18432
buffer_load_dwordx4 v8, s[36:39], s79 offen offset:0 sc1 lds
buffer_load_dwordx4 v8, s[36:39], s79 offen offset:1024 sc1 lds
s_add_u32 m0, s63, 114688
s_add_u32 s79, s66, 122880
buffer_load_dwordx4 v8, s[36:39], s79 offen offset:0  lds
buffer_load_dwordx4 v8, s[36:39], s79 offen offset:1024  lds
s_cmp_lg_u32 s3, 0
s_cbranch_scc1 t0_236
s_waitcnt vmcnt(5)
t0_236:
s_waitcnt vmcnt(12)
s_barrier
s_add_u32 m0, s63, 116736
s_add_u32 s79, s66, 124928
buffer_load_dwordx4 v8, s[36:39], s79 offen offset:0  lds
buffer_load_dwordx4 v8, s[36:39], s79 offen offset:1024  lds
s_add_u32 m0, s63, 118784
s_add_u32 s79, s66, 126976
buffer_load_dwordx4 v8, s[36:39], s79 offen offset:0  lds
buffer_load_dwordx4 v8, s[36:39], s79 offen offset:1024  lds
s_add_u32 m0, s61, 16384
s_add_u32 s79, s64, 20480
buffer_load_dwordx4 v8, s[36:39], s79 offen offset:0 sc1 lds
buffer_load_dwordx4 v8, s[36:39], s79 offen offset:1024 sc1 lds
s_add_u32 m0, s61, 18432
s_add_u32 s79, s64, 22528
buffer_load_dwordx4 v8, s[36:39], s79 offen offset:0 sc1 lds
buffer_load_dwordx4 v8, s[36:39], s79 offen offset:1024 sc1 lds
s_add_u32 m0, s63, 90112
s_add_u32 s79, s66, 147456
buffer_load_dwordx4 v8, s[36:39], s79 offen offset:0  lds
buffer_load_dwordx4 v8, s[36:39], s79 offen offset:1024  lds
s_cmp_lg_u32 s3, 0
s_cbranch_scc1 t0_237
s_waitcnt vmcnt(5)
t0_237:
s_waitcnt vmcnt(12)
s_barrier
s_add_u32 m0, s63, 92160
s_add_u32 s79, s66, 149504
buffer_load_dwordx4 v8, s[36:39], s79 offen offset:0  lds
buffer_load_dwordx4 v8, s[36:39], s79 offen offset:1024  lds
s_add_u32 m0, s63, 94208
s_add_u32 s79, s66, 151552
buffer_load_dwordx4 v8, s[36:39], s79 offen offset:0  lds
buffer_load_dwordx4 v8, s[36:39], s79 offen offset:1024  lds
s_add_u32 m0, s61, 32768
s_add_u32 s79, s64, 24576
buffer_load_dwordx4 v8, s[36:39], s79 offen offset:0 sc1 lds
buffer_load_dwordx4 v8, s[36:39], s79 offen offset:1024 sc1 lds
s_add_u32 m0, s61, 34816
s_add_u32 s79, s64, 26624
buffer_load_dwordx4 v8, s[36:39], s79 offen offset:0 sc1 lds
buffer_load_dwordx4 v8, s[36:39], s79 offen offset:1024 sc1 lds
s_add_u32 m0, s63, 65536
s_add_u32 s79, s66, 172032
buffer_load_dwordx4 v8, s[36:39], s79 offen offset:0  lds
buffer_load_dwordx4 v8, s[36:39], s79 offen offset:1024  lds
s_cmp_lg_u32 s3, 0
s_cbranch_scc1 t0_238
s_waitcnt vmcnt(5)
t0_238:
s_waitcnt vmcnt(12)
s_barrier
s_add_u32 m0, s63, 67584
s_add_u32 s79, s66, 174080
buffer_load_dwordx4 v8, s[36:39], s79 offen offset:0  lds
buffer_load_dwordx4 v8, s[36:39], s79 offen offset:1024  lds
s_add_u32 m0, s63, 69632
s_add_u32 s79, s66, 176128
buffer_load_dwordx4 v8, s[36:39], s79 offen offset:0  lds
buffer_load_dwordx4 v8, s[36:39], s79 offen offset:1024  lds
s_add_u32 m0, s61, 49152
s_add_u32 s79, s64, 28672
buffer_load_dwordx4 v8, s[36:39], s79 offen offset:0 sc1 lds
buffer_load_dwordx4 v8, s[36:39], s79 offen offset:1024 sc1 lds
s_add_u32 m0, s61, 51200
s_add_u32 s79, s64, 30720
buffer_load_dwordx4 v8, s[36:39], s79 offen offset:0 sc1 lds
buffer_load_dwordx4 v8, s[36:39], s79 offen offset:1024 sc1 lds
s_add_u32 m0, s63, 139264
s_add_u32 s79, s66, 196608
buffer_load_dwordx4 v8, s[36:39], s79 offen offset:0  lds
buffer_load_dwordx4 v8, s[36:39], s79 offen offset:1024  lds
s_cmp_lg_u32 s3, 0
s_cbranch_scc1 t0_239
s_waitcnt vmcnt(5)
t0_239:
s_waitcnt vmcnt(12)
s_barrier
s_add_u32 m0, s63, 141312
s_add_u32 s79, s66, 198656
buffer_load_dwordx4 v8, s[36:39], s79 offen offset:0  lds
buffer_load_dwordx4 v8, s[36:39], s79 offen offset:1024  lds
s_add_u32 m0, s63, 143360
s_add_u32 s79, s66, 200704
buffer_load_dwordx4 v8, s[36:39], s79 offen offset:0  lds
buffer_load_dwordx4 v8, s[36:39], s79 offen offset:1024  lds
s_add_u32 m0, s61, 0
s_add_u32 s79, s64, 32768
buffer_load_dwordx4 v8, s[36:39], s79 offen offset:0 sc1 lds
buffer_load_dwordx4 v8, s[36:39], s79 offen offset:1024 sc1 lds
s_add_u32 m0, s61, 2048
s_add_u32 s79, s64, 34816
buffer_load_dwordx4 v8, s[36:39], s79 offen offset:0 sc1 lds
buffer_load_dwordx4 v8, s[36:39], s79 offen offset:1024 sc1 lds
s_add_u32 m0, s63, 114688
s_add_u32 s79, s66, 221184
buffer_load_dwordx4 v8, s[36:39], s79 offen offset:0  lds
buffer_load_dwordx4 v8, s[36:39], s79 offen offset:1024  lds
s_cmp_lg_u32 s3, 0
s_cbranch_scc1 t0_240
s_waitcnt vmcnt(5)
t0_240:
s_waitcnt vmcnt(12)
s_barrier
s_add_u32 m0, s63, 116736
s_add_u32 s79, s66, 223232
buffer_load_dwordx4 v8, s[36:39], s79 offen offset:0  lds
buffer_load_dwordx4 v8, s[36:39], s79 offen offset:1024  lds
s_add_u32 m0, s63, 118784
s_add_u32 s79, s66, 225280
buffer_load_dwordx4 v8, s[36:39], s79 offen offset:0  lds
buffer_load_dwordx4 v8, s[36:39], s79 offen offset:1024  lds
s_add_u32 m0, s61, 16384
s_add_u32 s79, s64, 36864
buffer_load_dwordx4 v8, s[36:39], s79 offen offset:0 sc1 lds
buffer_load_dwordx4 v8, s[36:39], s79 offen offset:1024 sc1 lds
s_add_u32 m0, s61, 18432
s_add_u32 s79, s64, 38912
buffer_load_dwordx4 v8, s[36:39], s79 offen offset:0 sc1 lds
buffer_load_dwordx4 v8, s[36:39], s79 offen offset:1024 sc1 lds
s_cmp_lg_u32 s3, 0
s_cbranch_scc1 t0_241
s_waitcnt vmcnt(5)
t0_241:
s_waitcnt vmcnt(10)
s_barrier
s_add_u32 m0, s62, 40960
s_add_u32 s79, s68, 0
buffer_load_dwordx4 v8, s[36:39], s79 offen offset:0  lds
buffer_load_dwordx4 v8, s[36:39], s79 offen offset:1024  lds
s_add_u32 m0, s62, 43008
s_add_u32 s79, s68, 2048
buffer_load_dwordx4 v8, s[36:39], s79 offen offset:0  lds
buffer_load_dwordx4 v8, s[36:39], s79 offen offset:1024  lds
s_add_u32 m0, s62, 45056
s_add_u32 s79, s68, 4096
buffer_load_dwordx4 v8, s[36:39], s79 offen offset:0  lds
s_add_u32 m0, s62, 61440
s_add_u32 s79, s68, 20480
buffer_load_dwordx4 v8, s[36:39], s79 offen offset:0  lds
buffer_load_dwordx4 v8, s[36:39], s79 offen offset:1024  lds
s_add_u32 m0, s62, 63488
s_add_u32 s79, s68, 22528
buffer_load_dwordx4 v8, s[36:39], s79 offen offset:0  lds
buffer_load_dwordx4 v8, s[36:39], s79 offen offset:1024  lds
s_waitcnt vmcnt(9)
s_barrier
s_add_u32 m0, s62, 65536
s_add_u32 s79, s68, 24576
buffer_load_dwordx4 v8, s[36:39], s79 offen offset:0  lds
s_add_u32 m0, s62, 81920
s_add_u32 s79, s68, 40960
buffer_load_dwordx4 v8, s[36:39], s79 offen offset:0  lds
buffer_load_dwordx4 v8, s[36:39], s79 offen offset:1024  lds
buffer_load_dwordx4 v8, s[36:39], s79 offen offset:2048  lds
buffer_load_dwordx4 v8, s[36:39], s79 offen offset:3072  lds
s_add_u32 m0, s62, 86016
s_add_u32 s79, s68, 45056
buffer_load_dwordx4 v8, s[36:39], s79 offen offset:0  lds
s_barrier
s_add_u32 m0, s62, 102400
s_add_u32 s79, s68, 61440
buffer_load_dwordx4 v8, s[36:39], s79 offen offset:0  lds
buffer_load_dwordx4 v8, s[36:39], s79 offen offset:1024  lds
buffer_load_dwordx4 v8, s[36:39], s79 offen offset:2048  lds
buffer_load_dwordx4 v8, s[36:39], s79 offen offset:3072  lds
s_waitcnt vmcnt(14)
s_barrier
s_add_u32 m0, s62, 106496
s_add_u32 s79, s68, 65536
buffer_load_dwordx4 v8, s[36:39], s79 offen offset:0  lds
s_add_u32 m0, s62, 122880
s_add_u32 s79, s68, 81920
buffer_load_dwordx4 v8, s[36:39], s79 offen offset:0  lds
buffer_load_dwordx4 v8, s[36:39], s79 offen offset:1024  lds
buffer_load_dwordx4 v8, s[36:39], s79 offen offset:2048  lds
buffer_load_dwordx4 v8, s[36:39], s79 offen offset:3072  lds
s_add_u32 m0, s62, 126976
s_add_u32 s79, s68, 86016
buffer_load_dwordx4 v8, s[36:39], s79 offen offset:0  lds
s_add_u32 m0, s62, 143360
s_add_u32 s79, s68, 102400
buffer_load_dwordx4 v8, s[36:39], s79 offen offset:0  lds
buffer_load_dwordx4 v8, s[36:39], s79 offen offset:1024  lds
buffer_load_dwordx4 v8, s[36:39], s79 offen offset:2048  lds
buffer_load_dwordx4 v8, s[36:39], s79 offen offset:3072  lds
s_add_u32 m0, s62, 147456
s_add_u32 s79, s68, 106496
buffer_load_dwordx4 v8, s[36:39], s79 offen offset:0  lds
s_add_u32 m0, s62, 0
s_add_u32 s79, s68, 122880
buffer_load_dwordx4 v8, s[36:39], s79 offen offset:0  lds
buffer_load_dwordx4 v8, s[36:39], s79 offen offset:1024  lds
buffer_load_dwordx4 v8, s[36:39], s79 offen offset:2048  lds
buffer_load_dwordx4 v8, s[36:39], s79 offen offset:3072  lds
s_add_u32 m0, s62, 4096
s_add_u32 s79, s68, 126976
buffer_load_dwordx4 v8, s[36:39], s79 offen offset:0  lds
s_add_u32 m0, s62, 20480
s_add_u32 s79, s68, 143360
buffer_load_dwordx4 v8, s[36:39], s79 offen offset:0  lds
buffer_load_dwordx4 v8, s[36:39], s79 offen offset:1024  lds
buffer_load_dwordx4 v8, s[36:39], s79 offen offset:2048  lds
buffer_load_dwordx4 v8, s[36:39], s79 offen offset:3072  lds
s_add_u32 m0, s62, 24576
s_add_u32 s79, s68, 147456
buffer_load_dwordx4 v8, s[36:39], s79 offen offset:0  lds
s_waitcnt vmcnt(30)
s_barrier
s_waitcnt vmcnt(25)
s_barrier
s_add_u32 m0, s62, 40960
s_add_u32 s79, s68, 163840
buffer_load_dwordx4 v8, s[36:39], s79 offen offset:0  lds
buffer_load_dwordx4 v8, s[36:39], s79 offen offset:1024  lds
s_add_u32 m0, s62, 43008
s_add_u32 s79, s68, 165888
buffer_load_dwordx4 v8, s[36:39], s79 offen offset:0  lds
buffer_load_dwordx4 v8, s[36:39], s79 offen offset:1024  lds
s_waitcnt vmcnt(24)
s_barrier
s_add_u32 m0, s62, 45056
s_add_u32 s79, s68, 167936
buffer_load_dwordx4 v8, s[36:39], s79 offen offset:0  lds
s_add_u32 m0, s62, 61440
s_add_u32 s79, s68, 184320
buffer_load_dwordx4 v8, s[36:39], s79 offen offset:0  lds
buffer_load_dwordx4 v8, s[36:39], s79 offen offset:1024  lds
s_waitcnt vmcnt(22)
s_barrier
s_add_u32 m0, s62, 63488
s_add_u32 s79, s68, 186368
buffer_load_dwordx4 v8, s[36:39], s79 offen offset:0  lds
buffer_load_dwordx4 v8, s[36:39], s79 offen offset:1024  lds
s_add_u32 m0, s62, 65536
s_add_u32 s79, s68, 188416
buffer_load_dwordx4 v8, s[36:39], s79 offen offset:0  lds
s_waitcnt vmcnt(20)
s_barrier
s_add_u32 m0, s62, 81920
s_add_u32 s79, s68, 204800
buffer_load_dwordx4 v8, s[36:39], s79 offen offset:0  lds
buffer_load_dwordx4 v8, s[36:39], s79 offen offset:1024  lds
s_add_u32 m0, s62, 83968
s_add_u32 s79, s68, 206848
buffer_load_dwordx4 v8, s[36:39], s79 offen offset:0  lds
buffer_load_dwordx4 v8, s[36:39], s79 offen offset:1024  lds
s_waitcnt vmcnt(19)
s_barrier
s_add_u32 m0, s62, 86016
s_add_u32 s79, s68, 208896
buffer_load_dwordx4 v8, s[36:39], s79 offen offset:0  lds
s_add_u32 m0, s62, 102400
s_add_u32 s79, s68, 225280
buffer_load_dwordx4 v8, s[36:39], s79 offen offset:0  lds
buffer_load_dwordx4 v8, s[36:39], s79 offen offset:1024  lds
s_waitcnt vmcnt(17)
s_barrier
s_add_u32 m0, s62, 104448
s_add_u32 s79, s68, 227328
buffer_load_dwordx4 v8, s[36:39], s79 offen offset:0  lds
buffer_load_dwordx4 v8, s[36:39], s79 offen offset:1024  lds
s_add_u32 m0, s62, 106496
s_add_u32 s79, s68, 229376
buffer_load_dwordx4 v8, s[36:39], s79 offen offset:0  lds
s_waitcnt vmcnt(15)
s_barrier
s_cmp_eq_u32 s3, 0
s_cbranch_scc1 lx_242
s_waitcnt vmcnt(10)
s_barrier
s_waitcnt vmcnt(5)
s_barrier
s_waitcnt vmcnt(0)
s_barrier
s_barrier
s_branch L_end
lx_242:
s_add_u32 m0, s61, 131072
s_add_u32 s76, s72, 0
buffer_load_dwordx4 v6, s[44:47], s76 offen lds
s_add_u32 m0, s61, 132096
s_add_u32 s76, s72, 15360
buffer_load_dwordx4 v6, s[44:47], s76 offen lds
s_add_u32 m0, s61, 133120
s_add_u32 s76, s72, 30720
buffer_load_dwordx4 v7, s[44:47], s76 offen lds
s_add_u32 m0, s61, 134144
s_add_u32 s76, s72, 46080
buffer_load_dwordx4 v7, s[44:47], s76 offen lds
s_waitcnt vmcnt(14)
s_barrier
s_add_u32 m0, s61, 147456
s_add_u32 s76, s72, 245760
buffer_load_dwordx4 v6, s[44:47], s76 offen lds
s_add_u32 m0, s61, 148480
s_add_u32 s76, s72, 261120
buffer_load_dwordx4 v6, s[44:47], s76 offen lds
s_add_u32 m0, s61, 149504
s_add_u32 s76, s72, 276480
buffer_load_dwordx4 v7, s[44:47], s76 offen lds
s_add_u32 m0, s61, 150528
s_add_u32 s76, s72, 291840
buffer_load_dwordx4 v7, s[44:47], s76 offen lds
s_waitcnt vmcnt(13)
s_barrier
s_waitcnt vmcnt(8)
s_barrier
s_add_u32 m0, s61, 65536
s_add_u32 s76, s72, 491520
buffer_load_dwordx4 v6, s[44:47], s76 offen lds
s_add_u32 m0, s61, 66560
s_add_u32 s76, s72, 506880
buffer_load_dwordx4 v6, s[44:47], s76 offen lds
s_add_u32 m0, s61, 67584
s_add_u32 s76, s72, 522240
buffer_load_dwordx4 v7, s[44:47], s76 offen lds
s_barrier
s_cmp_lg_u32 s3, 0
s_cbranch_scc1 L_end
s_barrier
s_and_b32 s76, s5, 15
s_cmp_eq_u32 s76, 15
s_cbranch_scc1 L_slow_idle
s_lshr_b32 s76, s5, 4
s_mul_i32 s76, s76, 0
v_lshrrev_b32 v1, 1, v0
v_add_u32 v1, s76, v1
v_and_b32 v1, 7, v1
v_lshlrev_b32 v1, 5, v1
v_and_b32 v2, 1, v0
v_lshl_add_u32 v1, v2, 2, v1
s_lshr_b32 s94, s5, 4
s_lshl_b32 s94, s94, 9
s_bfe_u32 s81, s6, 0x10001
s_lshl_b32 s81, s81, 8
s_add_u32 s94, s94, s81
s_and_b32 s81, s6, 1
s_lshl_b32 s81, s81, 3
s_add_u32 s94, s94, s81
s_lshl_b32 s81, s4, 10
s_add_u32 s94, s94, s81
s_add_u32 s94, s94, 51798016
s_add_u32 s95, s8, 6
s_mov_b32 s92, -1
s_and_b32 s82, s92, 0x3
s_cbranch_scc0 gt_243k
s_mov_b32 s82, s9
gt_243:
buffer_load_dword v2, v1, s[36:39], s94 offen sc1
s_waitcnt vmcnt(0)
v_subrev_u32 v2, s95, v2
v_cmp_lt_u32 s[92:93], 15, v2
s_and_b32 s83, s92, 0x3
s_cbranch_scc0 gt_243k
s_add_u32 s82, s82, 1
s_cmp_lt_u32 s82, 200000
s_cbranch_scc1 gt_243
s_mov_b32 s9, 200000
gt_243k:
s_add_u32 m0, s61, 0
s_add_u32 s79, s70, 0
buffer_load_dwordx4 v8, s[36:39], s79 offen offset:0 sc1 lds
buffer_load_dwordx4 v8, s[36:39], s79 offen offset:1024 sc1 lds
buffer_load_dwordx4 v8, s[36:39], s79 offen offset:2048 sc1 lds
buffer_load_dwordx4 v8, s[36:39], s79 offen offset:3072 sc1 lds
s_and_b32 s82, s92, 0xc
s_cbranch_scc0 gt_244k
s_mov_b32 s82, s9
gt_244:
buffer_load_dword v2, v1, s[36:39], s94 offen sc1
s_waitcnt vmcnt(0)
v_subrev_u32 v2, s95, v2
v_cmp_lt_u32 s[92:93], 15, v2
s_and_b32 s83, s92, 0xc
s_cbranch_scc0 gt_244k
s_add_u32 s82, s82, 1
s_cmp_lt_u32 s82, 200000
s_cbranch_scc1 gt_244
s_mov_b32 s9, 200000
gt_244k:
s_add_u32 m0, s61, 16384
s_add_u32 s79, s70, 4096
buffer_load_dwordx4 v8, s[36:39], s79 offen offset:0 sc1 lds
buffer_load_dwordx4 v8, s[36:39], s79 offen offset:1024 sc1 lds
s_add_u32 m0, s61, 18432
s_add_u32 s79, s70, 6144
buffer_load_dwordx4 v8, s[36:39], s79 offen offset:0 sc1 lds
buffer_load_dwordx4 v8, s[36:39], s79 offen offset:1024 sc1 lds
s_add_u32 m0, s61, 68608
s_add_u32 s76, s72, 537600
buffer_load_dwordx4 v7, s[44:47], s76 offen lds
s_and_b32 s82, s92, 0x30
s_cbranch_scc0 gt_245k
s_mov_b32 s82, s9
gt_245:
buffer_load_dword v2, v1, s[36:39], s94 offen sc1
s_waitcnt vmcnt(0)
v_subrev_u32 v2, s95, v2
v_cmp_lt_u32 s[92:93], 15, v2
s_and_b32 s83, s92, 0x30
s_cbranch_scc0 gt_245k
s_add_u32 s82, s82, 1
s_cmp_lt_u32 s82, 200000
s_cbranch_scc1 gt_245
s_mov_b32 s9, 200000
gt_245k:
s_add_u32 m0, s61, 32768
s_add_u32 s79, s70, 8192
buffer_load_dwordx4 v8, s[36:39], s79 offen offset:0 sc1 lds
buffer_load_dwordx4 v8, s[36:39], s79 offen offset:1024 sc1 lds
s_waitcnt vmcnt(7)
s_barrier
s_add_u32 m0, s61, 34816
s_add_u32 s79, s70, 10240
buffer_load_dwordx4 v8, s[36:39], s79 offen offset:0 sc1 lds
buffer_load_dwordx4 v8, s[36:39], s79 offen offset:1024 sc1 lds
s_add_u32 m0, s61, 81920
s_add_u32 s76, s72, 737280
buffer_load_dwordx4 v6, s[44:47], s76 offen lds
s_add_u32 m0, s61, 82944
s_add_u32 s76, s72, 752640
buffer_load_dwordx4 v6, s[44:47], s76 offen lds
s_add_u32 m0, s61, 83968
s_add_u32 s76, s72, 768000
buffer_load_dwordx4 v7, s[44:47], s76 offen lds
s_add_u32 m0, s61, 84992
s_add_u32 s76, s72, 783360
buffer_load_dwordx4 v7, s[44:47], s76 offen lds
buffer_load_dword v3, v1, s[36:39], s94 offen sc1
s_waitcnt vmcnt(10)
s_barrier
s_and_b32 s82, s92, 0xc0
s_cbranch_scc0 gt_246k
s_mov_b32 s82, s9
gt_246:
buffer_load_dword v2, v1, s[36:39], s94 offen sc1
s_waitcnt vmcnt(0)
v_subrev_u32 v2, s95, v2
v_cmp_lt_u32 s[92:93], 15, v2
s_and_b32 s83, s92, 0xc0
s_cbranch_scc0 gt_246k
s_add_u32 s82, s82, 1
s_cmp_lt_u32 s82, 200000
s_cbranch_scc1 gt_246
s_mov_b32 s9, 200000
gt_246k:
s_add_u32 m0, s61, 49152
s_add_u32 s79, s70, 12288
buffer_load_dwordx4 v8, s[36:39], s79 offen offset:0 sc1 lds
buffer_load_dwordx4 v8, s[36:39], s79 offen offset:1024 sc1 lds
s_add_u32 m0, s61, 51200
s_add_u32 s79, s70, 14336
buffer_load_dwordx4 v8, s[36:39], s79 offen offset:0 sc1 lds
buffer_load_dwordx4 v8, s[36:39], s79 offen offset:1024 sc1 lds
s_add_u32 m0, s61, 98304
s_add_u32 s76, s72, 983040
buffer_load_dwordx4 v6, s[44:47], s76 offen lds
s_add_u32 m0, s61, 99328
s_add_u32 s76, s72, 998400
buffer_load_dwordx4 v6, s[44:47], s76 offen lds
s_add_u32 s95, s95, 1
s_waitcnt vmcnt(6)
v_subrev_u32 v3, s95, v3
v_cmp_lt_u32 s[92:93], 15, v3
s_and_b32 s82, s92, 0xffff
s_cbranch_scc0 gt_247k
s_mov_b32 s82, s9
gt_247:
buffer_load_dword v2, v1, s[36:39], s94 offen sc1
s_waitcnt vmcnt(0)
v_subrev_u32 v2, s95, v2
v_cmp_lt_u32 s[92:93], 15, v2
s_and_b32 s83, s92, 0xffff
s_cbranch_scc0 gt_247k
s_add_u32 s82, s82, 1
s_cmp_lt_u32 s82, 200000
s_cbranch_scc1 gt_247
s_mov_b32 s9, 200000
gt_247k:
s_waitcnt vmcnt(11)
s_barrier
s_add_u32 m0, s61, 100352
s_add_u32 s76, s72, 1013760
buffer_load_dwordx4 v7, s[44:47], s76 offen lds
s_add_u32 m0, s61, 101376
s_add_u32 s76, s72, 1029120
buffer_load_dwordx4 v7, s[44:47], s76 offen lds
s_add_u32 m0, s61, 0
s_add_u32 s79, s70, 16384
buffer_load_dwordx4 v8, s[36:39], s79 offen offset:0 sc1 lds
buffer_load_dwordx4 v8, s[36:39], s79 offen offset:1024 sc1 lds
s_add_u32 m0, s61, 2048
s_add_u32 s79, s70, 18432
buffer_load_dwordx4 v8, s[36:39], s79 offen offset:0 sc1 lds
buffer_load_dwordx4 v8, s[36:39], s79 offen offset:1024 sc1 lds
s_waitcnt vmcnt(8)
s_barrier
s_add_u32 m0, s61, 114688
s_add_u32 s76, s72, 1228800
buffer_load_dwordx4 v6, s[44:47], s76 offen lds
s_add_u32 m0, s61, 115712
s_add_u32 s76, s72, 1244160
buffer_load_dwordx4 v6, s[44:47], s76 offen lds
s_add_u32 m0, s61, 116736
s_add_u32 s76, s72, 1259520
buffer_load_dwordx4 v7, s[44:47], s76 offen lds
s_add_u32 m0, s61, 117760
s_add_u32 s76, s72, 1274880
buffer_load_dwordx4 v7, s[44:47], s76 offen lds
s_add_u32 m0, s61, 16384
s_add_u32 s79, s70, 20480
buffer_load_dwordx4 v8, s[36:39], s79 offen offset:0 sc1 lds
buffer_load_dwordx4 v8, s[36:39], s79 offen offset:1024 sc1 lds
s_waitcnt vmcnt(6)
s_barrier
s_add_u32 m0, s61, 18432
s_add_u32 s79, s70, 22528
buffer_load_dwordx4 v8, s[36:39], s79 offen offset:0 sc1 lds
buffer_load_dwordx4 v8, s[36:39], s79 offen offset:1024 sc1 lds
s_add_u32 m0, s61, 131072
s_add_u32 s76, s72, 1474560
buffer_load_dwordx4 v6, s[44:47], s76 offen lds
s_add_u32 m0, s61, 132096
s_add_u32 s76, s72, 1489920
buffer_load_dwordx4 v6, s[44:47], s76 offen lds
s_add_u32 m0, s61, 133120
s_add_u32 s76, s72, 1505280
buffer_load_dwordx4 v7, s[44:47], s76 offen lds
s_add_u32 m0, s61, 134144
s_add_u32 s76, s72, 1520640
buffer_load_dwordx4 v7, s[44:47], s76 offen lds
s_add_u32 m0, s61, 32768
s_add_u32 s79, s70, 24576
buffer_load_dwordx4 v8, s[36:39], s79 offen offset:0 sc1 lds
buffer_load_dwordx4 v8, s[36:39], s79 offen offset:1024 sc1 lds
s_waitcnt vmcnt(6)
s_barrier
s_add_u32 m0, s61, 34816
s_add_u32 s79, s70, 26624
buffer_load_dwordx4 v8, s[36:39], s79 offen offset:0 sc1 lds
buffer_load_dwordx4 v8, s[36:39], s79 offen offset:1024 sc1 lds
s_add_u32 m0, s61, 147456
s_add_u32 s76, s72, 1720320
buffer_load_dwordx4 v6, s[44:47], s76 offen lds
s_add_u32 m0, s61, 148480
s_add_u32 s76, s72, 1735680
buffer_load_dwordx4 v6, s[44:47], s76 offen lds
s_add_u32 m0, s61, 149504
s_add_u32 s76, s72, 1751040
buffer_load_dwordx4 v7, s[44:47], s76 offen lds
s_add_u32 m0, s61, 150528
s_add_u32 s76, s72, 1766400
buffer_load_dwordx4 v7, s[44:47], s76 offen lds
s_add_u32 m0, s61, 49152
s_add_u32 s79, s70, 28672
buffer_load_dwordx4 v8, s[36:39], s79 offen offset:0 sc1 lds
buffer_load_dwordx4 v8, s[36:39], s79 offen offset:1024 sc1 lds
s_waitcnt vmcnt(6)
s_barrier
s_add_u32 m0, s61, 51200
s_add_u32 s79, s70, 30720
buffer_load_dwordx4 v8, s[36:39], s79 offen offset:0 sc1 lds
buffer_load_dwordx4 v8, s[36:39], s79 offen offset:1024 sc1 lds
s_add_u32 m0, s61, 65536
s_add_u32 s76, s72, 1966080
buffer_load_dwordx4 v6, s[44:47], s76 offen lds
s_add_u32 m0, s61, 66560
s_add_u32 s76, s72, 1981440
buffer_load_dwordx4 v6, s[44:47], s76 offen lds
s_add_u32 m0, s61, 67584
s_add_u32 s76, s72, 1996800
buffer_load_dwordx4 v7, s[44:47], s76 offen lds
s_add_u32 m0, s61, 68608
s_add_u32 s76, s72, 2012160
buffer_load_dwordx4 v7, s[44:47], s76 offen lds
s_add_u32 m0, s61, 0
s_add_u32 s79, s70, 32768
buffer_load_dwordx4 v8, s[36:39], s79 offen offset:0 sc1 lds
buffer_load_dwordx4 v8, s[36:39], s79 offen offset:1024 sc1 lds
s_waitcnt vmcnt(6)
s_barrier
s_add_u32 m0, s61, 2048
s_add_u32 s79, s70, 34816
buffer_load_dwordx4 v8, s[36:39], s79 offen offset:0 sc1 lds
buffer_load_dwordx4 v8, s[36:39], s79 offen offset:1024 sc1 lds
s_add_u32 m0, s61, 81920
s_add_u32 s76, s72, 2211840
buffer_load_dwordx4 v6, s[44:47], s76 offen lds
s_add_u32 m0, s61, 82944
s_add_u32 s76, s72, 2227200
buffer_load_dwordx4 v6, s[44:47], s76 offen lds
s_add_u32 m0, s61, 83968
s_add_u32 s76, s72, 2242560
buffer_load_dwordx4 v7, s[44:47], s76 offen lds
s_add_u32 m0, s61, 84992
s_add_u32 s76, s72, 2257920
buffer_load_dwordx4 v7, s[44:47], s76 offen lds
s_add_u32 m0, s61, 16384
s_add_u32 s79, s70, 36864
buffer_load_dwordx4 v8, s[36:39], s79 offen offset:0 sc1 lds
buffer_load_dwordx4 v8, s[36:39], s79 offen offset:1024 sc1 lds
s_waitcnt vmcnt(6)
s_barrier
s_add_u32 m0, s61, 18432
s_add_u32 s79, s70, 38912
buffer_load_dwordx4 v8, s[36:39], s79 offen offset:0 sc1 lds
buffer_load_dwordx4 v8, s[36:39], s79 offen offset:1024 sc1 lds
s_waitcnt vmcnt(0)
s_barrier
s_barrier
s_branch L_slow_next
L_slow_idle:
s_waitcnt vmcnt(0)
s_barrier
L_slow_next:
s_mov_b32 s3, 1
s_mov_b32 s7, 22315008
s_add_u32 s8, s8, 7
s_mov_b32 s46, 0
s_branch L_slow
att_fb_51:
s_mov_b32 s74, 0
v_mov_b32 v8, 0xff800000
v_mov_b32 v9, 0xff800000
s_mov_b32 exec_lo, 0
v_mov_b64 v[20:21], 0
v_mov_b64 v[26:27], 0
s_mov_b32 exec_lo, -1
att_fb1_248:
s_mul_i32 s72, s74, 1280
s_add_u32 s72, s72, s68
s_add_u32 s73, s72, 5242880
s_add_u32 s72, s72, 2621440
buffer_load_dwordx4 v[48:51], v5, s[36:39], s72 offen sc1
s_mov_b32 exec_hi, 0
buffer_load_dwordx2 v[52:53], v6, s[36:39], s72 offen offset:1024 sc1
s_mov_b32 exec_hi, -1
s_waitcnt vmcnt(0)
v_mfma_f32_32x32x16_bf16 v[64:79], v[48:51], v[16:19], 0
v_mfma_f32_32x32x8_bf16 v[64:79], v[52:53], v[20:21], v[64:79]
v_mfma_f32_32x32x16_bf16 v[80:95], v[48:51], v[22:25], 0
v_mfma_f32_32x32x8_bf16 v[80:95], v[52:53], v[26:27], v[80:95]
s_nop 11
v_max3_f32 v8, v8, v64, v65
v_max3_f32 v8, v8, v66, v67
v_max3_f32 v8, v8, v68, v69
v_max3_f32 v8, v8, v70, v71
v_max3_f32 v8, v8, v72, v73
v_max3_f32 v8, v8, v74, v75
v_max3_f32 v8, v8, v76, v77
v_max3_f32 v8, v8, v78, v79
v_max3_f32 v9, v9, v80, v81
v_max3_f32 v9, v9, v82, v83
v_max3_f32 v9, v9, v84, v85
v_max3_f32 v9, v9, v86, v87
v_max3_f32 v9, v9, v88, v89
v_max3_f32 v9, v9, v90, v91
v_max3_f32 v9, v9, v92, v93
v_max3_f32 v9, v9, v94, v95
s_add_u32 s74, s74, 1
s_cmp_lt_u32 s74, 64
s_cbranch_scc1 att_fb1_248
v_mov_b32 v10, v8
v_mov_b32 v11, v9
s_nop 0
v_permlane32_swap_b32 v8, v10
v_permlane32_swap_b32 v9, v11
s_nop 0
v_max_f32 v8, v8, v10
v_max_f32 v9, v9, v11
s_mov_b32 exec_lo, 0
v_sub_f32 v32, 0, v8
v_and_b32 v33, 0xffff0000, v32
v_sub_f32 v34, v32, v33
v_and_b32 v35, 0xffff0000, v34
v_sub_f32 v34, v34, v35
v_lshrrev_b32 v33, 16, v33
v_or_b32 v20, v33, v35
v_lshrrev_b32 v21, 16, v34
v_sub_f32 v36, 0, v9
v_and_b32 v37, 0xffff0000, v36
v_sub_f32 v38, v36, v37
v_and_b32 v39, 0xffff0000, v38
v_sub_f32 v38, v38, v39
v_lshrrev_b32 v37, 16, v37
v_or_b32 v26, v37, v39
v_lshrrev_b32 v27, 16, v38
s_mov_b32 exec_lo, -1
v_mov_b32 v112, 0
v_mov_b32 v113, 0
v_mov_b32 v114, 0
v_mov_b32 v115, 0
v_mov_b32 v116, 0
v_mov_b32 v117, 0
v_mov_b32 v118, 0
v_mov_b32 v119, 0
v_mov_b32 v120, 0
v_mov_b32 v121, 0
v_mov_b32 v122, 0
v_mov_b32 v123, 0
v_mov_b32 v124, 0
v_mov_b32 v125, 0
v_mov_b32 v126, 0
v_mov_b32 v127, 0
v_mov_b32 v128, 0
v_mov_b32 v129, 0
v_mov_b32 v130, 0
v_mov_b32 v131, 0
v_mov_b32 v132, 0
v_mov_b32 v133, 0
v_mov_b32 v134, 0
v_mov_b32 v135, 0
v_mov_b32 v136, 0
v_mov_b32 v137, 0
v_mov_b32 v138, 0
v_mov_b32 v139, 0
v_mov_b32 v140, 0
v_mov_b32 v141, 0
v_mov_b32 v142, 0
v_mov_b32 v143, 0
s_mov_b32 s74, 0
att_fb2_249:
s_mul_i32 s72, s74, 1280
s_add_u32 s72, s72, s68
s_add_u32 s73, s72, 5242880
s_add_u32 s72, s72, 2621440
buffer_load_dwordx4 v[48:51], v5, s[36:39], s72 offen sc1
s_mov_b32 exec_hi, 0
buffer_load_dwordx2 v[52:53], v6, s[36:39], s72 offen offset:1024 sc1
s_mov_b32 exec_hi, -1
s_mov_b64 exec, s[66:67]
buffer_load_dwordx4 v[144:147], v7, s[36:39], s73 offen sc1
buffer_load_dwordx4 v[148:151], v7, s[36:39], s73 offen offset:640 sc1
s_mov_b64 exec, -1
s_waitcnt vmcnt(0)
v_mfma_f32_32x32x16_bf16 v[64:79], v[48:51], v[16:19], 0
v_mfma_f32_32x32x8_bf16 v[64:79], v[52:53], v[20:21], v[64:79]
v_mfma_f32_32x32x16_bf16 v[80:95], v[48:51], v[22:25], 0
v_mfma_f32_32x32x8_bf16 v[80:95], v[52:53], v[26:27], v[80:95]
s_nop 11
v_exp_f32 v64, v64
v_exp_f32 v65, v65
v_exp_f32 v66, v66
v_exp_f32 v67, v67
v_cvt_pk_bf16_f32 v96, v64, v65
v_exp_f32 v68, v68
v_exp_f32 v69, v69
v_cvt_pk_bf16_f32 v97, v66, v67
v_exp_f32 v70, v70
v_exp_f32 v71, v71
v_cvt_pk_bf16_f32 v98, v68, v69
v_exp_f32 v72, v72
v_exp_f32 v73, v73
v_cvt_pk_bf16_f32 v99, v70, v71
v_exp_f32 v74, v74
v_exp_f32 v75, v75
v_cvt_pk_bf16_f32 v100, v72, v73
v_exp_f32 v76, v76
v_exp_f32 v77, v77
v_cvt_pk_bf16_f32 v101, v74, v75
v_exp_f32 v78, v78
v_exp_f32 v79, v79
v_cvt_pk_bf16_f32 v102, v76, v77
v_cvt_pk_bf16_f32 v103, v78, v79
v_exp_f32 v80, v80
v_exp_f32 v81, v81
v_exp_f32 v82, v82
v_exp_f32 v83, v83
v_cvt_pk_bf16_f32 v104, v80, v81
v_exp_f32 v84, v84
v_exp_f32 v85, v85
v_cvt_pk_bf16_f32 v105, v82, v83
v_exp_f32 v86, v86
v_exp_f32 v87, v87
v_cvt_pk_bf16_f32 v106, v84, v85
v_exp_f32 v88, v88
v_exp_f32 v89, v89
v_cvt_pk_bf16_f32 v107, v86, v87
v_exp_f32 v90, v90
v_exp_f32 v91, v91
v_cvt_pk_bf16_f32 v108, v88, v89
v_exp_f32 v92, v92
v_exp_f32 v93, v93
v_cvt_pk_bf16_f32 v109, v90, v91
v_exp_f32 v94, v94
v_exp_f32 v95, v95
v_cvt_pk_bf16_f32 v110, v92, v93
v_cvt_pk_bf16_f32 v111, v94, v95
s_nop 1
v_mfma_f32_32x32x16_bf16 v[112:127], v[144:147], v[96:99], v[112:127]
v_mfma_f32_32x32x16_bf16 v[112:127], v[148:151], v[100:103], v[112:127]
v_mfma_f32_32x32x16_bf16 v[128:143], v[144:147], v[104:107], v[128:143]
v_mfma_f32_32x32x16_bf16 v[128:143], v[148:151], v[108:111], v[128:143]
s_add_u32 s74, s74, 1
s_cmp_lt_u32 s74, 64
s_cbranch_scc1 att_fb2_249
s_nop 11
s_branch att_comb_52
att_fb_163:
s_mov_b32 s74, 0
v_mov_b32 v8, 0xff800000
v_mov_b32 v9, 0xff800000
s_mov_b32 exec_lo, 0
v_mov_b64 v[20:21], 0
v_mov_b64 v[26:27], 0
s_mov_b32 exec_lo, -1
att_fb1_250:
s_mul_i32 s72, s74, 1280
s_add_u32 s72, s72, s68
s_add_u32 s73, s72, 5242880
s_add_u32 s72, s72, 2621440
buffer_load_dwordx4 v[48:51], v5, s[36:39], s72 offen sc1
s_mov_b32 exec_hi, 0
buffer_load_dwordx2 v[52:53], v6, s[36:39], s72 offen offset:1024 sc1
s_mov_b32 exec_hi, -1
s_waitcnt vmcnt(0)
v_mfma_f32_32x32x16_bf16 v[64:79], v[48:51], v[16:19], 0
v_mfma_f32_32x32x8_bf16 v[64:79], v[52:53], v[20:21], v[64:79]
v_mfma_f32_32x32x16_bf16 v[80:95], v[48:51], v[22:25], 0
v_mfma_f32_32x32x8_bf16 v[80:95], v[52:53], v[26:27], v[80:95]
s_nop 11
v_max3_f32 v8, v8, v64, v65
v_max3_f32 v8, v8, v66, v67
v_max3_f32 v8, v8, v68, v69
v_max3_f32 v8, v8, v70, v71
v_max3_f32 v8, v8, v72, v73
v_max3_f32 v8, v8, v74, v75
v_max3_f32 v8, v8, v76, v77
v_max3_f32 v8, v8, v78, v79
v_max3_f32 v9, v9, v80, v81
v_max3_f32 v9, v9, v82, v83
v_max3_f32 v9, v9, v84, v85
v_max3_f32 v9, v9, v86, v87
v_max3_f32 v9, v9, v88, v89
v_max3_f32 v9, v9, v90, v91
v_max3_f32 v9, v9, v92, v93
v_max3_f32 v9, v9, v94, v95
s_add_u32 s74, s74, 1
s_cmp_lt_u32 s74, 64
s_cbranch_scc1 att_fb1_250
v_mov_b32 v10, v8
v_mov_b32 v11, v9
s_nop 0
v_permlane32_swap_b32 v8, v10
v_permlane32_swap_b32 v9, v11
s_nop 0
v_max_f32 v8, v8, v10
v_max_f32 v9, v9, v11
s_mov_b32 exec_lo, 0
v_sub_f32 v32, 0, v8
v_and_b32 v33, 0xffff0000, v32
v_sub_f32 v34, v32, v33
v_and_b32 v35, 0xffff0000, v34
v_sub_f32 v34, v34, v35
v_lshrrev_b32 v33, 16, v33
v_or_b32 v20, v33, v35
v_lshrrev_b32 v21, 16, v34
v_sub_f32 v36, 0, v9
v_and_b32 v37, 0xffff0000, v36
v_sub_f32 v38, v36, v37
v_and_b32 v39, 0xffff0000, v38
v_sub_f32 v38, v38, v39
v_lshrrev_b32 v37, 16, v37
v_or_b32 v26, v37, v39
v_lshrrev_b32 v27, 16, v38
s_mov_b32 exec_lo, -1
v_mov_b32 v112, 0
v_mov_b32 v113, 0
v_mov_b32 v114, 0
v_mov_b32 v115, 0
v_mov_b32 v116, 0
v_mov_b32 v117, 0
v_mov_b32 v118, 0
v_mov_b32 v119, 0
v_mov_b32 v120, 0
v_mov_b32 v121, 0
v_mov_b32 v122, 0
v_mov_b32 v123, 0
v_mov_b32 v124, 0
v_mov_b32 v125, 0
v_mov_b32 v126, 0
v_mov_b32 v127, 0
v_mov_b32 v128, 0
v_mov_b32 v129, 0
v_mov_b32 v130, 0
v_mov_b32 v131, 0
v_mov_b32 v132, 0
v_mov_b32 v133, 0
v_mov_b32 v134, 0
v_mov_b32 v135, 0
v_mov_b32 v136, 0
v_mov_b32 v137, 0
v_mov_b32 v138, 0
v_mov_b32 v139, 0
v_mov_b32 v140, 0
v_mov_b32 v141, 0
v_mov_b32 v142, 0
v_mov_b32 v143, 0
s_mov_b32 s74, 0
att_fb2_251:
s_mul_i32 s72, s74, 1280
s_add_u32 s72, s72, s68
s_add_u32 s73, s72, 5242880
s_add_u32 s72, s72, 2621440
buffer_load_dwordx4 v[48:51], v5, s[36:39], s72 offen sc1
s_mov_b32 exec_hi, 0
buffer_load_dwordx2 v[52:53], v6, s[36:39], s72 offen offset:1024 sc1
s_mov_b32 exec_hi, -1
s_mov_b64 exec, s[66:67]
buffer_load_dwordx4 v[144:147], v7, s[36:39], s73 offen sc1
buffer_load_dwordx4 v[148:151], v7, s[36:39], s73 offen offset:640 sc1
s_mov_b64 exec, -1
s_waitcnt vmcnt(0)
v_mfma_f32_32x32x16_bf16 v[64:79], v[48:51], v[16:19], 0
v_mfma_f32_32x32x8_bf16 v[64:79], v[52:53], v[20:21], v[64:79]
v_mfma_f32_32x32x16_bf16 v[80:95], v[48:51], v[22:25], 0
v_mfma_f32_32x32x8_bf16 v[80:95], v[52:53], v[26:27], v[80:95]
s_nop 11
v_exp_f32 v64, v64
v_exp_f32 v65, v65
v_exp_f32 v66, v66
v_exp_f32 v67, v67
v_cvt_pk_bf16_f32 v96, v64, v65
v_exp_f32 v68, v68
v_exp_f32 v69, v69
v_cvt_pk_bf16_f32 v97, v66, v67
v_exp_f32 v70, v70
v_exp_f32 v71, v71
v_cvt_pk_bf16_f32 v98, v68, v69
v_exp_f32 v72, v72
v_exp_f32 v73, v73
v_cvt_pk_bf16_f32 v99, v70, v71
v_exp_f32 v74, v74
v_exp_f32 v75, v75
v_cvt_pk_bf16_f32 v100, v72, v73
v_exp_f32 v76, v76
v_exp_f32 v77, v77
v_cvt_pk_bf16_f32 v101, v74, v75
v_exp_f32 v78, v78
v_exp_f32 v79, v79
v_cvt_pk_bf16_f32 v102, v76, v77
v_cvt_pk_bf16_f32 v103, v78, v79
v_exp_f32 v80, v80
v_exp_f32 v81, v81
v_exp_f32 v82, v82
v_exp_f32 v83, v83
v_cvt_pk_bf16_f32 v104, v80, v81
v_exp_f32 v84, v84
v_exp_f32 v85, v85
v_cvt_pk_bf16_f32 v105, v82, v83
v_exp_f32 v86, v86
v_exp_f32 v87, v87
v_cvt_pk_bf16_f32 v106, v84, v85
v_exp_f32 v88, v88
v_exp_f32 v89, v89
v_cvt_pk_bf16_f32 v107, v86, v87
v_exp_f32 v90, v90
v_exp_f32 v91, v91
v_cvt_pk_bf16_f32 v108, v88, v89
v_exp_f32 v92, v92
v_exp_f32 v93, v93
v_cvt_pk_bf16_f32 v109, v90, v91
v_exp_f32 v94, v94
v_exp_f32 v95, v95
v_cvt_pk_bf16_f32 v110, v92, v93
v_cvt_pk_bf16_f32 v111, v94, v95
s_nop 1
v_mfma_f32_32x32x16_bf16 v[112:127], v[144:147], v[96:99], v[112:127]
v_mfma_f32_32x32x16_bf16 v[112:127], v[148:151], v[100:103], v[112:127]
v_mfma_f32_32x32x16_bf16 v[128:143], v[144:147], v[104:107], v[128:143]
v_mfma_f32_32x32x16_bf16 v[128:143], v[148:151], v[108:111], v[128:143]
s_add_u32 s74, s74, 1
s_cmp_lt_u32 s74, 64
s_cbranch_scc1 att_fb2_251
s_nop 11
s_branch att_comb_164
.section .rodata,"a"
.p2align 6
.amdhsa_kernel interleave_layers__softmax_full_mha__glu_gated_reglu__prompt_kernel
  .amdhsa_next_free_vgpr 256
  .amdhsa_next_free_sgpr 102
  .amdhsa_accum_offset 256
  .amdhsa_group_segment_fixed_size 0
  .amdhsa_kernarg_size 80
  .amdhsa_user_sgpr_count 2
  .amdhsa_user_sgpr_kernarg_segment_ptr 1
  .amdhsa_system_sgpr_workgroup_id_x 1
.end_amdhsa_kernel
```
